```python
import torch

def _softmax(x, axis=-1):
    return torch.softmax(x, dim=axis)
def _gelu(x):
    return torch.nn.functional.gelu(x, approximate="tanh")
def _silu(x):
    return torch.nn.functional.silu(x)
def _sigmoid(x):
    return torch.sigmoid(x)
def _layernorm(x, axis=-1, eps=1e-5):
    m = x.mean(dim=axis, keepdim=True)
    v = x.var(dim=axis, keepdim=True, unbiased=False)
    return (x - m) / torch.sqrt(v + eps)
def _scatter_add(tgt, idx, src, axis=0):
    return tgt.clone().index_add_(axis, idx, src)
def _segment_sum(src, seg, n):
    out = torch.zeros((n,) + src.shape[1:], dtype=src.dtype)
    return out.index_add_(0, seg, src)
def _pad(x, pw):
    flat = tuple(v for pair in reversed(pw) for v in pair)
    return torch.nn.functional.pad(x, flat)

kernel_name = 'gated_mix__compressed_kv_cla__glu_gated_swiglu__prompt'

def setup_inputs():

    _w = (lambda a: (lambda t: t.to(torch.bfloat16) if t.is_floating_point() else t)(torch.as_tensor(a)))
    def _A_setup():
        B, H, Sq, Sk, D, M = 1, 16, 2048, 2048, 256, 448
        Dc = 4 * D
        return {
            "x": _w((lambda *s: torch.randn(*s, dtype=torch.bfloat16) * 0.05)(B, Sq, M)),
            "c_kv": _w((lambda *s: torch.randn(*s, dtype=torch.bfloat16) * 0.4)(B, Sk, Dc)),
            "w_q": _w((lambda *s: torch.randn(*s, dtype=torch.bfloat16) * 6.4)(M, H, D) * (M ** -0.5)),
            "w_uk": _w((lambda *s: torch.randn(*s, dtype=torch.bfloat16) * 6.4)(Dc, H, D) * (Dc ** -0.5)),
            "w_uv": _w((lambda *s: torch.randn(*s, dtype=torch.bfloat16) * 0.4)(Dc, H, D) * (Dc ** -0.5)),
            "w_o": _w((lambda *s: torch.randn(*s, dtype=torch.bfloat16) * 0.4)(H, D, M) * ((H * D) ** -0.5)),
        }
    _A_in = _A_setup()

    def _B_setup():
        B, S, D, F = 1, 2048, 448, 1792
        return {
            "x": _w((lambda *s: torch.randn(*s, dtype=torch.bfloat16) * 0.05)(B, S, D)),
            "w1": _w((lambda *s: torch.randn(*s, dtype=torch.bfloat16) * 1.6)(D, F) * (2.0 / D) ** 0.5),
            "w3": _w((lambda *s: torch.randn(*s, dtype=torch.bfloat16) * 1.6)(D, F) * (2.0 / D) ** 0.5),
            "w2": _w((lambda *s: torch.randn(*s, dtype=torch.bfloat16) * 1.6)(F, D) * (2.0 / F) ** 0.5),
        }
    _B_in = _B_setup()

    return {
        "A_x": _A_in["x"],
        "A_c_kv": _A_in["c_kv"],
        "A_w_q": _A_in["w_q"],
        "A_w_uk": _A_in["w_uk"],
        "A_w_uv": _A_in["w_uv"],
        "A_w_o": _A_in["w_o"],
        "B_x": _B_in["x"],
        "B_w1": _B_in["w1"],
        "B_w3": _B_in["w3"],
        "B_w2": _B_in["w2"],
        "gate_w": _w((lambda *s: torch.randn(*s, dtype=torch.bfloat16) * 0.05)(448) * 16.0),
    }

def reference(A_x, A_c_kv, A_w_q, A_w_uk, A_w_uv, A_w_o, B_x, B_w1, B_w3, B_w2, gate_w):
    def _A_ref(x, c_kv, w_q, w_uk, w_uv, w_o):
        B, Sq, M = x.shape[0], x.shape[1], x.shape[2]
        Sk = c_kv.shape[1]
        H, D = w_q.shape[1], w_q.shape[2]
        q = torch.einsum("bqm,mhd->bhqd", x, w_q)
        k = torch.einsum("bkc,chd->bhkd", c_kv, w_uk)
        v = torch.einsum("bkc,chd->bhkd", c_kv, w_uv)
        scores = torch.einsum("bhqd,bhkd->bhqk", q, k) * (D ** -0.5)
        off = Sk - Sq
        qi = torch.arange(Sq)[:, None]
        kj = torch.arange(Sk)[None, :]
        cmask = kj <= (qi + off)
        scores = torch.where(cmask[None, None], scores, -1e9)
        p = _softmax(scores, axis=-1)
        ctx = torch.einsum("bhqk,bhkd->bhqd", p, v)
        return torch.einsum("bhqd,hdm->bqm", ctx, w_o)

    def _B_ref(x, w1, w3, w2):
        gate = torch.einsum("bsd,df->bsf", x, w1)
        up = torch.einsum("bsd,df->bsf", x, w3)
        h = _silu(gate) * up
        out = torch.einsum("bsf,fd->bsd", h, w2)
        return out

    x = A_x
    g = _sigmoid((x * gate_w).sum(-1, keepdims=True))
    a = _A_ref(x, A_c_kv, A_w_q, A_w_uk, A_w_uv, A_w_o)
    b = _B_ref(x, B_w1, B_w3, B_w2)
    return g * a + (1 - g) * b
```

```asm
; @launch grid=(256,1,1) block=(256,1,1) lds=163840
.amdgcn_target "amdgcn-amd-amdhsa--gfx950"
.text
.globl gated_mix__compressed_kv_cla__glu_gated_swiglu__prompt_kernel
.p2align 8
.type gated_mix__compressed_kv_cla__glu_gated_swiglu__prompt_kernel,@function
gated_mix__compressed_kv_cla__glu_gated_swiglu__prompt_kernel:
    s_cmp_lt_u32 s2, 256
    s_cbranch_scc1 gated_mix__compressed_kv_cla__glu_gated_swiglu__prompt_kernel_go
    s_endpgm
gated_mix__compressed_kv_cla__glu_gated_swiglu__prompt_kernel_go:
    s_load_dwordx16 s[32:47], s[0:1], 0
    s_load_dwordx8 s[48:55], s[0:1], 64
    s_load_dwordx4 s[56:59], s[0:1], 96
    s_getpc_b64 s[96:97]
pc_1:
    s_lshr_b32 s98, s2, 3
    s_lshl_b32 s98, s98, 8
    v_add_u32 v2, s98, v0
    v_and_b32 v2, 0x3ff, v2
    v_lshlrev_b32 v2, 7, v2
    v_min_u32 v2, gated_mix__compressed_kv_cla__glu_gated_swiglu__prompt_kernel_last-pc_1-4, v2
    v_mov_b32 v3, s97
    v_add_co_u32 v2, vcc, s96, v2
    s_nop 1
    v_addc_co_u32 v3, vcc, 0, v3, vcc
    global_load_dword a200, v[2:3], off
    v_lshrrev_b32 v2, 6, v0
    v_and_b32 v1, 63, v0
    v_readfirstlane_b32 s20, v2
    s_and_b32 s3, s2, 7
    s_lshl_b32 s3, s3, 1
    s_lshr_b32 s22, s2, 7
    s_add_u32 s21, s3, s22
    s_lshr_b32 s22, s2, 3
    s_and_b32 s22, s22, 15
    v_lshlrev_b32 v25, 4, v1
    v_lshrrev_b32 v2, 4, v1
    v_bfe_u32 v3, v1, 1, 3
    v_xor_b32 v3, v3, v2
    v_and_b32 v4, 1, v1
    v_lshlrev_b32 v3, 5, v3
    v_lshl_or_b32 v3, v4, 4, v3
    v_mul_u32_u24 v2, 8192, v2
    v_add_u32 v17, v2, v3
    v_add_u32 v18, 31744, v17
    v_xor_b32 v3, 128, v3
    v_add_u32 v2, v2, v3
    v_add_u32 v19, 63488, v2
    v_add_u32 v20, 95232, v2
    v_lshrrev_b32 v2, 3, v1
    v_and_b32 v3, 6, v2
    v_and_b32 v4, 7, v1
    v_xor_b32 v3, v3, v4
    v_lshlrev_b32 v3, 4, v3
    v_mul_u32_u24 v2, 2048, v2
    v_add_u32 v21, v2, v3
    v_add_u32 v22, 15360, v21
    v_add_u32 v23, 30720, v21
    v_add_u32 v24, 46080, v21
    s_and_b32 s3, s20, 1
    s_lshr_b32 s29, s20, 1
    s_lshl_b32 s24, s3, 17
    s_lshl_b32 s30, s21, 9
    s_add_u32 s24, s24, s30
    s_lshl_b32 s30, s29, 8
    s_add_u32 s24, s24, s30
    s_mov_b32 s66, s24
    s_lshl_b32 s30, s20, 12
    s_and_b32 s25, s22, 7
    s_lshl_b32 s25, s25, 2
    s_add_u32 s25, s25, s20
    s_lshl_b32 s25, s25, 17
    s_lshl_b32 s64, s20, 13
    s_add_u32 s64, s64, 65536
    s_mov_b32 s26, s64
    s_waitcnt lgkmcnt(0)
    s_mov_b32 s4, s58
    s_mov_b32 s5, s59
    s_mov_b32 s6, 125829120
    s_mov_b32 s7, 0x20000
    s_cmp_eq_u32 s20, 0
    s_cbranch_scc0 gated_mix__compressed_kv_cla__glu_gated_swiglu__prompt_kernel_nz
    s_lshl_b32 s97, s2, 8
    s_add_u32 s97, s97, 100663296
    v_lshlrev_b32 v2, 2, v1
    v_mov_b32 v3, 0
    buffer_store_dword v3, v2, s[4:7], s97 offen sc1
gated_mix__compressed_kv_cla__glu_gated_swiglu__prompt_kernel_nz:
    s_cmp_lt_u32 s22, 8
    s_cselect_b32 s12, s38, s40
    s_cselect_b32 s13, s39, s41
    s_mov_b32 s14, 8388608
    s_mov_b32 s15, 0x20000
    s_mov_b32 s8, s34
    s_mov_b32 s9, s35
    s_mov_b32 s10, 4194304
    s_mov_b32 s11, 0x20000
    s_mov_b32 m0, s26
    s_nop 0
    buffer_load_dwordx4 v21, s[8:11], s25 offen offset:0 sc1 lds
    buffer_load_dwordx4 v22, s[8:11], s25 offen offset:1024 sc1 lds
    buffer_load_dwordx4 v23, s[8:11], s25 offen offset:2048 sc1 lds
    buffer_load_dwordx4 v24, s[8:11], s25 offen offset:3072 sc1 lds
    s_add_u32 m0, s30, 0
    s_nop 0
    buffer_load_dwordx4 v17, s[12:15], s24 offen offset:0 sc1 lds
    buffer_load_dwordx4 v18, s[12:15], s24 offen offset:1024 sc1 lds
    buffer_load_dwordx4 v19, s[12:15], s24 offen offset:2048 sc1 lds
    buffer_load_dwordx4 v20, s[12:15], s24 offen offset:3072 sc1 lds
    s_add_u32 s24, s24, 262144
    s_add_u32 m0, s26, 4096
    s_add_u32 s31, s25, 65536
    buffer_load_dwordx4 v21, s[8:11], s31 offen offset:0 sc1 lds
    buffer_load_dwordx4 v22, s[8:11], s31 offen offset:1024 sc1 lds
    buffer_load_dwordx4 v23, s[8:11], s31 offen offset:2048 sc1 lds
    buffer_load_dwordx4 v24, s[8:11], s31 offen offset:3072 sc1 lds
    s_add_u32 s25, s25, 128
    s_add_u32 s26, s26, 32768
    s_cmp_eq_u32 s20, 3
    s_cbranch_scc0 pj_ng0
    s_mov_b32 s16, s52
    s_mov_b32 s17, s53
    s_mov_b32 s18, 896
    s_mov_b32 s19, 0x20000
    s_mov_b32 s60, s32
    s_mov_b32 s61, s33
    s_mov_b32 s62, 1835008
    s_mov_b32 s63, 0x20000
    v_lshrrev_b32 v2, 3, v1
    v_and_b32 v3, 7, v1
    v_lshlrev_b32 v30, 4, v3
    v_mul_u32_u24 v2, 896, v2
    v_add_u32 v31, v2, v30
    s_lshl_b32 s23, s22, 4
    s_add_u32 s23, s23, s21
    s_mul_i32 s3, s23, 7168
    buffer_load_dwordx4 v[32:35], v31, s[60:63], s3 offen offset:0
    buffer_load_dwordx4 v[36:39], v30, s[16:19], 0 offen offset:0
    buffer_load_dwordx4 v[40:43], v31, s[60:63], s3 offen offset:128
    buffer_load_dwordx4 v[44:47], v30, s[16:19], 0 offen offset:128
    buffer_load_dwordx4 v[48:51], v31, s[60:63], s3 offen offset:256
    buffer_load_dwordx4 v[52:55], v30, s[16:19], 0 offen offset:256
    buffer_load_dwordx4 v[56:59], v31, s[60:63], s3 offen offset:384
    buffer_load_dwordx4 v[60:63], v30, s[16:19], 0 offen offset:384
    buffer_load_dwordx4 v[64:67], v31, s[60:63], s3 offen offset:512
    buffer_load_dwordx4 v[68:71], v30, s[16:19], 0 offen offset:512
    buffer_load_dwordx4 v[72:75], v31, s[60:63], s3 offen offset:640
    buffer_load_dwordx4 v[76:79], v30, s[16:19], 0 offen offset:640
    buffer_load_dwordx4 v[80:83], v31, s[60:63], s3 offen offset:768
    buffer_load_dwordx4 v[84:87], v30, s[16:19], 0 offen offset:768
    s_and_b32 s3, s20, 1
pj_ng0:
    s_lshl_b32 s67, s3, 13
    v_lshrrev_b32 v2, 4, v1
    v_bfe_u32 v3, v1, 2, 2
    v_lshl_add_u32 v4, v2, 3, v3
    v_lshlrev_b32 v4, 8, v4
    v_and_b32 v2, 1, v2
    v_lshl_or_b32 v3, v2, 2, v3
    v_and_b32 v2, 3, v1
    v_lshl_or_b32 v4, v2, 3, v4
    v_add_u32 v4, s67, v4
    v_xor_b32 v2, 0, v3
    v_lshl_add_u32 v5, v2, 5, v4
    v_xor_b32 v2, 1, v3
    v_lshl_add_u32 v6, v2, 5, v4
    v_xor_b32 v2, 2, v3
    v_lshl_add_u32 v7, v2, 5, v4
    v_xor_b32 v2, 3, v3
    v_lshl_add_u32 v8, v2, 5, v4
    v_xor_b32 v2, 4, v3
    v_lshl_add_u32 v9, v2, 5, v4
    v_xor_b32 v2, 5, v3
    v_lshl_add_u32 v10, v2, 5, v4
    v_xor_b32 v2, 6, v3
    v_lshl_add_u32 v11, v2, 5, v4
    v_xor_b32 v2, 7, v3
    v_lshl_add_u32 v12, v2, 5, v4
    s_lshl_b32 s29, s29, 14
    s_add_u32 s29, s29, 65536
    v_and_b32 v2, 15, v1
    v_lshrrev_b32 v3, 4, v1
    v_and_b32 v4, 6, v2
    v_xor_b32 v3, v3, v4
    v_lshlrev_b32 v2, 7, v2
    v_add_u32 v2, s29, v2
    v_lshl_add_u32 v15, v3, 4, v2
    v_xor_b32 v3, 4, v3
    v_lshl_add_u32 v16, v3, 4, v2
    v_mov_b32 v13, v15
    v_mov_b32 v14, v16
    s_bitcmp1_b32 s2, 0
    s_cselect_b32 s97, 6, 8
    s_lshl_b32 s97, s97, 5
    v_lshrrev_b32 v2, 4, v1
    v_bfe_u32 v3, v1, 1, 3
    v_xor_b32 v3, v3, v2
    v_and_b32 v4, 1, v1
    v_lshlrev_b32 v3, 5, v3
    v_lshl_or_b32 v3, v4, 4, v3
    v_mul_u32_u24 v2, 3584, v2
    v_add_u32 v26, v2, v3
    v_add_u32 v27, 13312, v26
    v_xor_b32 v3, 128, v3
    v_add_u32 v2, v2, v3
    v_add_u32 v28, 26624, v2
    v_add_u32 v29, 39936, v2
    v_mov_b32 v4, 1073741824
    v_cmp_gt_u32 vcc, s97, v3
    s_nop 1
    v_cndmask_b32 v28, v4, v28, vcc
    v_cndmask_b32 v29, v4, v29, vcc
    v_xor_b32 v3, 128, v3
    v_cmp_gt_u32 vcc, s97, v3
    s_nop 1
    v_cndmask_b32 v26, v4, v26, vcc
    v_cndmask_b32 v27, v4, v27, vcc
    s_mov_b32 s27, 0
    s_mov_b32 s28, 0
    s_mov_b32 s29, 2
    s_add_u32 s65, s64, 98304
    s_mov_b32 s60, s56
    s_mov_b32 s61, s57
    s_mov_b32 s62, 256
    s_mov_b32 s63, 0x20000
    s_lshl_b32 s3, s20, 12
    s_add_u32 s75, s3, 98304
    v_and_b32 v2, 15, v1
    v_lshrrev_b32 v3, 4, v1
    v_and_b32 v4, 6, v2
    v_xor_b32 v3, v3, v4
    v_lshlrev_b32 v2, 7, v2
    v_add_u32 v2, s75, v2
    v_lshl_add_u32 v30, v3, 4, v2
    v_xor_b32 v3, 4, v3
    v_lshl_add_u32 v31, v3, 4, v2
    s_lshr_b32 s98, s2, 3
    s_lshl_b32 s98, s98, 2
    s_add_u32 s98, s98, s20
    s_bfe_u32 s96, s2, 0x20001
    s_and_b32 s77, s2, 1
    s_mov_b32 s71, 0x20000
    s_mov_b32 s68, s36
    s_mov_b32 s69, s37
    s_sub_u32 s97, s98, 0
    s_mul_i32 s97, s97, 114688
    s_mul_i32 s99, s96, 2048
    s_add_u32 s97, s97, s99
    s_mul_i32 s99, s77, 1024
    s_add_u32 s97, s97, s99
    s_cmp_ge_u32 s98, 0
    s_cselect_b32 s68, s36, s68
    s_cselect_b32 s69, s37, s69
    s_cselect_b32 s82, 3670016, s82
    s_cselect_b32 s74, s97, s74
    s_cselect_b32 s81, 8192, s81
    s_cselect_b32 s3, 0, s3
    s_cselect_b32 s83, 3, s83
    s_sub_u32 s97, s98, 32
    s_mul_i32 s97, s97, 100352
    s_mul_i32 s99, s96, 896
    s_add_u32 s97, s97, s99
    s_mul_i32 s99, s77, 512
    s_add_u32 s97, s97, s99
    s_cmp_ge_u32 s98, 32
    s_cselect_b32 s68, s46, s68
    s_cselect_b32 s69, s47, s69
    s_cselect_b32 s82, 1605632, s82
    s_cselect_b32 s74, s97, s74
    s_cselect_b32 s81, 7168, s81
    s_cselect_b32 s3, 3072, s3
    s_cselect_b32 s83, 3, s83
    s_sub_u32 s97, s98, 48
    s_mul_i32 s97, s97, 100352
    s_mul_i32 s99, s96, 896
    s_add_u32 s97, s97, s99
    s_mul_i32 s99, s77, 512
    s_add_u32 s97, s97, s99
    s_cmp_ge_u32 s98, 48
    s_cselect_b32 s68, s48, s68
    s_cselect_b32 s69, s49, s69
    s_cselect_b32 s82, 1605632, s82
    s_cselect_b32 s74, s97, s74
    s_cselect_b32 s81, 7168, s81
    s_cselect_b32 s3, 3072, s3
    s_cselect_b32 s83, 3, s83
    s_sub_u32 s97, s98, 64
    s_mul_i32 s97, s97, 14336
    s_mul_i32 s99, s96, 917504
    s_add_u32 s97, s97, s99
    s_mul_i32 s99, s77, 458752
    s_add_u32 s97, s97, s99
    s_cmp_ge_u32 s98, 64
    s_cselect_b32 s68, s42, s68
    s_cselect_b32 s69, s43, s69
    s_cselect_b32 s82, 3670016, s82
    s_cselect_b32 s74, s97, s74
    s_cselect_b32 s81, 1024, s81
    s_cselect_b32 s3, 0, s3
    s_cselect_b32 s83, 0, s83
    s_sub_u32 s97, s98, 96
    s_mul_i32 s97, s97, 14336
    s_mul_i32 s99, s96, 401408
    s_add_u32 s97, s97, s99
    s_mul_i32 s99, s77, 229376
    s_add_u32 s97, s97, s99
    s_cmp_ge_u32 s98, 96
    s_cselect_b32 s68, s50, s68
    s_cselect_b32 s69, s51, s69
    s_cselect_b32 s82, 1605632, s82
    s_cselect_b32 s74, s97, s74
    s_cselect_b32 s81, 1024, s81
    s_cselect_b32 s3, 0, s3
    s_cselect_b32 s83, 0, s83
    s_mul_i32 s97, s81, 14
    s_add_u32 s97, s97, s74
    s_min_u32 s82, s82, s97
    s_cmp_ge_u32 s98, 112
    s_cselect_b32 s82, 0, s82
    s_cmp_eq_u32 s83, 0
    s_cselect_b32 s80, s81, 0
    s_cselect_b32 s70, s82, 0
    v_and_b32 v4, 7, v1
    v_lshlrev_b32 v4, 7, v4
    v_bfe_u32 v2, v1, 2, 1
    v_mul_lo_u32 v2, v2, s3
    v_add_u32 v4, v4, v2
    s_lshr_b32 s76, s2, 3
    s_mul_i32 s76, s76, 6
    s_lshr_b32 s76, s76, 5
    s_add_u32 s76, s76, 1
    s_add_u32 m0, s30, 16384
    s_nop 0
    buffer_load_dwordx4 v17, s[12:15], s24 offen offset:0 sc1 lds
    buffer_load_dwordx4 v18, s[12:15], s24 offen offset:1024 sc1 lds
    buffer_load_dwordx4 v19, s[12:15], s24 offen offset:2048 sc1 lds
    buffer_load_dwordx4 v20, s[12:15], s24 offen offset:3072 sc1 lds
    s_add_u32 s24, s24, 262144
    s_mov_b32 m0, s26
    s_nop 0
    buffer_load_dwordx4 v21, s[8:11], s25 offen offset:0 sc1 lds
    buffer_load_dwordx4 v22, s[8:11], s25 offen offset:1024 sc1 lds
    buffer_load_dwordx4 v23, s[8:11], s25 offen offset:2048 sc1 lds
    buffer_load_dwordx4 v24, s[8:11], s25 offen offset:3072 sc1 lds
    s_add_u32 m0, s30, 32768
    s_nop 0
    buffer_load_dwordx4 v17, s[12:15], s24 offen offset:0 sc1 lds
    buffer_load_dwordx4 v18, s[12:15], s24 offen offset:1024 sc1 lds
    buffer_load_dwordx4 v19, s[12:15], s24 offen offset:2048 sc1 lds
    buffer_load_dwordx4 v20, s[12:15], s24 offen offset:3072 sc1 lds
    s_add_u32 s24, s24, 262144
    s_add_u32 m0, s26, 4096
    s_add_u32 s31, s25, 65536
    buffer_load_dwordx4 v21, s[8:11], s31 offen offset:0 sc1 lds
    buffer_load_dwordx4 v22, s[8:11], s31 offen offset:1024 sc1 lds
    buffer_load_dwordx4 v23, s[8:11], s31 offen offset:2048 sc1 lds
    buffer_load_dwordx4 v24, s[8:11], s31 offen offset:3072 sc1 lds
    s_add_u32 s25, s25, 128
    s_add_u32 s26, s26, 32768
    s_cmp_eq_u32 s20, 3
    s_cbranch_scc0 pj_ng1
    v_mov_b32 v2, 0
    s_waitcnt vmcnt(28)
    v_dot2_f32_bf16 v2, v32, v36, v2
    v_dot2_f32_bf16 v2, v33, v37, v2
    v_dot2_f32_bf16 v2, v34, v38, v2
    v_dot2_f32_bf16 v2, v35, v39, v2
    s_waitcnt vmcnt(26)
    v_dot2_f32_bf16 v2, v40, v44, v2
    v_dot2_f32_bf16 v2, v41, v45, v2
    v_dot2_f32_bf16 v2, v42, v46, v2
    v_dot2_f32_bf16 v2, v43, v47, v2
    s_waitcnt vmcnt(24)
    v_dot2_f32_bf16 v2, v48, v52, v2
    v_dot2_f32_bf16 v2, v49, v53, v2
    v_dot2_f32_bf16 v2, v50, v54, v2
    v_dot2_f32_bf16 v2, v51, v55, v2
    s_waitcnt vmcnt(22)
    v_dot2_f32_bf16 v2, v56, v60, v2
    v_dot2_f32_bf16 v2, v57, v61, v2
    v_dot2_f32_bf16 v2, v58, v62, v2
    v_dot2_f32_bf16 v2, v59, v63, v2
    s_waitcnt vmcnt(20)
    v_dot2_f32_bf16 v2, v64, v68, v2
    v_dot2_f32_bf16 v2, v65, v69, v2
    v_dot2_f32_bf16 v2, v66, v70, v2
    v_dot2_f32_bf16 v2, v67, v71, v2
    s_waitcnt vmcnt(18)
    v_dot2_f32_bf16 v2, v72, v76, v2
    v_dot2_f32_bf16 v2, v73, v77, v2
    v_dot2_f32_bf16 v2, v74, v78, v2
    v_dot2_f32_bf16 v2, v75, v79, v2
    s_waitcnt vmcnt(16)
    v_dot2_f32_bf16 v2, v80, v84, v2
    v_dot2_f32_bf16 v2, v81, v85, v2
    v_dot2_f32_bf16 v2, v82, v86, v2
    v_dot2_f32_bf16 v2, v83, v87, v2
    s_nop 3
    v_add_f32_dpp v2, v2, v2 quad_perm:[1,0,3,2] row_mask:0xf bank_mask:0xf
    s_nop 1
    v_add_f32_dpp v2, v2, v2 quad_perm:[2,3,0,1] row_mask:0xf bank_mask:0xf
    s_nop 1
    v_add_f32_dpp v2, v2, v2 row_half_mirror row_mask:0xf bank_mask:0xf
    v_mul_f32 v2, 0xbfb8aa3b, v2
    v_exp_f32 v2, v2
    s_nop 0
    v_add_f32 v2, 1.0, v2
    v_rcp_f32 v2, v2
    v_lshrrev_b32 v3, 3, v1
    v_lshlrev_b32 v3, 2, v3
    s_lshl_b32 s23, s23, 5
    s_add_u32 s23, s23, 75497472
    buffer_store_dword v2, v3, s[4:7], s23 offen sc1
pj_ng1:
    s_waitcnt vmcnt(16)
    s_barrier
    ds_read_b64_tr_b16 a[0:1], v5 offset:0
    ds_read_b64_tr_b16 a[2:3], v5 offset:1024
    ds_read_b128 a[32:35], v13 offset:0
    ds_read_b64_tr_b16 a[4:5], v6 offset:0
    ds_read_b64_tr_b16 a[6:7], v6 offset:1024
    ds_read_b128 a[36:39], v13 offset:2048
    ds_read_b64_tr_b16 a[8:9], v7 offset:0
    ds_read_b64_tr_b16 a[10:11], v7 offset:1024
    ds_read_b128 a[40:43], v13 offset:4096
    ds_read_b64_tr_b16 a[12:13], v8 offset:0
    ds_read_b64_tr_b16 a[14:15], v8 offset:1024
    ds_read_b128 a[44:47], v13 offset:6144
    ds_read_b64_tr_b16 a[16:17], v9 offset:0
    ds_read_b64_tr_b16 a[18:19], v9 offset:1024
    ds_read_b128 a[48:51], v13 offset:8192
    ds_read_b64_tr_b16 a[20:21], v10 offset:0
    ds_read_b64_tr_b16 a[22:23], v10 offset:1024
    ds_read_b128 a[52:55], v13 offset:10240
    ds_read_b64_tr_b16 a[24:25], v11 offset:0
    ds_read_b64_tr_b16 a[26:27], v11 offset:1024
    ds_read_b128 a[56:59], v13 offset:12288
    ds_read_b64_tr_b16 a[28:29], v12 offset:0
    ds_read_b64_tr_b16 a[30:31], v12 offset:1024
    ds_read_b128 a[60:63], v13 offset:14336
    s_cmp_lt_u32 s22, 8
    s_cbranch_scc0 pj_vloop0
pj_kloop0:
    s_waitcnt vmcnt(8)
    s_waitcnt lgkmcnt(0)
    s_barrier
    v_mfma_f32_16x16x32_bf16 v[32:35], a[0:3], a[32:35], 0
    s_add_u32 m0, s30, 49152
    v_mfma_f32_16x16x32_bf16 v[40:43], a[0:3], a[36:39], 0
    v_mfma_f32_16x16x32_bf16 v[48:51], a[0:3], a[40:43], 0
    buffer_load_dwordx4 v17, s[12:15], s24 offen offset:0 sc1 lds
    v_mfma_f32_16x16x32_bf16 v[56:59], a[0:3], a[44:47], 0
    ds_read_b64_tr_b16 a[64:65], v5 offset:16384
    v_mfma_f32_16x16x32_bf16 v[64:67], a[0:3], a[48:51], 0
    buffer_load_dwordx4 v18, s[12:15], s24 offen offset:1024 sc1 lds
    v_mfma_f32_16x16x32_bf16 v[72:75], a[0:3], a[52:55], 0
    ds_read_b64_tr_b16 a[66:67], v5 offset:17408
    v_mfma_f32_16x16x32_bf16 v[80:83], a[0:3], a[56:59], 0
    buffer_load_dwordx4 v19, s[12:15], s24 offen offset:2048 sc1 lds
    v_mfma_f32_16x16x32_bf16 v[88:91], a[0:3], a[60:63], 0
    ds_read_b128 a[96:99], v14 offset:0
    v_mfma_f32_16x16x32_bf16 v[92:95], a[4:7], a[60:63], 0
    buffer_load_dwordx4 v20, s[12:15], s24 offen offset:3072 sc1 lds
    v_mfma_f32_16x16x32_bf16 v[84:87], a[4:7], a[56:59], 0
    ds_read_b64_tr_b16 a[68:69], v6 offset:16384
    v_mfma_f32_16x16x32_bf16 v[76:79], a[4:7], a[52:55], 0
    s_add_u32 s24, s24, 262144
    v_mfma_f32_16x16x32_bf16 v[68:71], a[4:7], a[48:51], 0
    ds_read_b64_tr_b16 a[70:71], v6 offset:17408
    v_mfma_f32_16x16x32_bf16 v[60:63], a[4:7], a[44:47], 0
    s_mov_b32 m0, s26
    v_mfma_f32_16x16x32_bf16 v[52:55], a[4:7], a[40:43], 0
    ds_read_b128 a[100:103], v14 offset:2048
    v_mfma_f32_16x16x32_bf16 v[44:47], a[4:7], a[36:39], 0
    buffer_load_dwordx4 v21, s[8:11], s25 offen offset:0 sc1 lds
    v_mfma_f32_16x16x32_bf16 v[36:39], a[4:7], a[32:35], 0
    ds_read_b64_tr_b16 a[72:73], v7 offset:16384
    v_mfma_f32_16x16x32_bf16 v[96:99], a[8:11], a[32:35], 0
    v_mfma_f32_16x16x32_bf16 v[104:107], a[8:11], a[36:39], 0
    ds_read_b64_tr_b16 a[74:75], v7 offset:17408
    buffer_load_dwordx4 v22, s[8:11], s25 offen offset:1024 sc1 lds
    v_mfma_f32_16x16x32_bf16 v[112:115], a[8:11], a[40:43], 0
    v_mfma_f32_16x16x32_bf16 v[120:123], a[8:11], a[44:47], 0
    ds_read_b128 a[104:107], v14 offset:4096
    buffer_load_dwordx4 v23, s[8:11], s25 offen offset:2048 sc1 lds
    v_mfma_f32_16x16x32_bf16 v[128:131], a[8:11], a[48:51], 0
    v_mfma_f32_16x16x32_bf16 v[136:139], a[8:11], a[52:55], 0
    ds_read_b64_tr_b16 a[76:77], v8 offset:16384
    buffer_load_dwordx4 v24, s[8:11], s25 offen offset:3072 sc1 lds
    v_mfma_f32_16x16x32_bf16 v[144:147], a[8:11], a[56:59], 0
    v_mfma_f32_16x16x32_bf16 v[152:155], a[8:11], a[60:63], 0
    ds_read_b64_tr_b16 a[78:79], v8 offset:17408
    s_mov_b32 m0, s30
    v_mfma_f32_16x16x32_bf16 v[156:159], a[12:15], a[60:63], 0
    v_mfma_f32_16x16x32_bf16 v[148:151], a[12:15], a[56:59], 0
    ds_read_b128 a[108:111], v14 offset:6144
    buffer_load_dwordx4 v17, s[12:15], s24 offen offset:0 sc1 lds
    v_mfma_f32_16x16x32_bf16 v[140:143], a[12:15], a[52:55], 0
    v_mfma_f32_16x16x32_bf16 v[132:135], a[12:15], a[48:51], 0
    ds_read_b64_tr_b16 a[80:81], v9 offset:16384
    buffer_load_dwordx4 v18, s[12:15], s24 offen offset:1024 sc1 lds
    v_mfma_f32_16x16x32_bf16 v[124:127], a[12:15], a[44:47], 0
    v_mfma_f32_16x16x32_bf16 v[116:119], a[12:15], a[40:43], 0
    ds_read_b64_tr_b16 a[82:83], v9 offset:17408
    buffer_load_dwordx4 v19, s[12:15], s24 offen offset:2048 sc1 lds
    v_mfma_f32_16x16x32_bf16 v[108:111], a[12:15], a[36:39], 0
    v_mfma_f32_16x16x32_bf16 v[100:103], a[12:15], a[32:35], 0
    ds_read_b128 a[112:115], v14 offset:8192
    buffer_load_dwordx4 v20, s[12:15], s24 offen offset:3072 sc1 lds
    v_mfma_f32_16x16x32_bf16 v[160:163], a[16:19], a[32:35], 0
    v_mfma_f32_16x16x32_bf16 v[168:171], a[16:19], a[36:39], 0
    ds_read_b64_tr_b16 a[84:85], v10 offset:16384
    v_mfma_f32_16x16x32_bf16 v[176:179], a[16:19], a[40:43], 0
    s_add_u32 s24, s24, 262144
    v_mfma_f32_16x16x32_bf16 v[184:187], a[16:19], a[44:47], 0
    ds_read_b64_tr_b16 a[86:87], v10 offset:17408
    v_mfma_f32_16x16x32_bf16 v[192:195], a[16:19], a[48:51], 0
    s_add_u32 s31, s25, 65536
    v_mfma_f32_16x16x32_bf16 v[200:203], a[16:19], a[52:55], 0
    ds_read_b128 a[116:119], v14 offset:10240
    v_mfma_f32_16x16x32_bf16 v[208:211], a[16:19], a[56:59], 0
    s_add_u32 m0, s26, 4096
    v_mfma_f32_16x16x32_bf16 v[216:219], a[16:19], a[60:63], 0
    ds_read_b64_tr_b16 a[88:89], v11 offset:16384
    v_mfma_f32_16x16x32_bf16 v[220:223], a[20:23], a[60:63], 0
    buffer_load_dwordx4 v21, s[8:11], s31 offen offset:0 sc1 lds
    v_mfma_f32_16x16x32_bf16 v[212:215], a[20:23], a[56:59], 0
    ds_read_b64_tr_b16 a[90:91], v11 offset:17408
    v_mfma_f32_16x16x32_bf16 v[204:207], a[20:23], a[52:55], 0
    buffer_load_dwordx4 v22, s[8:11], s31 offen offset:1024 sc1 lds
    v_mfma_f32_16x16x32_bf16 v[196:199], a[20:23], a[48:51], 0
    ds_read_b128 a[120:123], v14 offset:12288
    v_mfma_f32_16x16x32_bf16 v[188:191], a[20:23], a[44:47], 0
    buffer_load_dwordx4 v23, s[8:11], s31 offen offset:2048 sc1 lds
    v_mfma_f32_16x16x32_bf16 v[180:183], a[20:23], a[40:43], 0
    ds_read_b64_tr_b16 a[92:93], v12 offset:16384
    v_mfma_f32_16x16x32_bf16 v[172:175], a[20:23], a[36:39], 0
    buffer_load_dwordx4 v24, s[8:11], s31 offen offset:3072 sc1 lds
    v_mfma_f32_16x16x32_bf16 v[164:167], a[20:23], a[32:35], 0
    ds_read_b64_tr_b16 a[94:95], v12 offset:17408
    v_mfma_f32_16x16x32_bf16 v[224:227], a[24:27], a[32:35], 0
    v_mfma_f32_16x16x32_bf16 v[232:235], a[24:27], a[36:39], 0
    ds_read_b128 a[124:127], v14 offset:14336
    v_mfma_f32_16x16x32_bf16 v[240:243], a[24:27], a[40:43], 0
    s_add_u32 s25, s25, 128
    s_add_u32 s29, s29, 1
    v_mfma_f32_16x16x32_bf16 v[248:251], a[24:27], a[44:47], 0
    v_mfma_f32_16x16x32_bf16 a[224:227], a[24:27], a[48:51], 0
    s_cmp_ge_u32 s29, 16
    s_cselect_b32 s25, 1073741824, s25
    v_mfma_f32_16x16x32_bf16 a[232:235], a[24:27], a[52:55], 0
    v_mfma_f32_16x16x32_bf16 a[240:243], a[24:27], a[56:59], 0
    s_add_u32 s26, s26, 32768
    s_cmp_eq_u32 s26, s65
    v_mfma_f32_16x16x32_bf16 a[248:251], a[24:27], a[60:63], 0
    s_cselect_b32 s26, s64, s26
    v_mfma_f32_16x16x32_bf16 a[252:255], a[28:31], a[60:63], 0
    v_mfma_f32_16x16x32_bf16 a[244:247], a[28:31], a[56:59], 0
    buffer_load_dword a201, v4, s[68:71], s74 offen
    v_mfma_f32_16x16x32_bf16 a[236:239], a[28:31], a[52:55], 0
    s_add_u32 s74, s74, s80
    v_mfma_f32_16x16x32_bf16 a[228:231], a[28:31], a[48:51], 0
    v_mfma_f32_16x16x32_bf16 v[252:255], a[28:31], a[44:47], 0
    v_mfma_f32_16x16x32_bf16 v[244:247], a[28:31], a[40:43], 0
    v_mfma_f32_16x16x32_bf16 v[236:239], a[28:31], a[36:39], 0
    v_mfma_f32_16x16x32_bf16 v[228:231], a[28:31], a[32:35], 0
    s_waitcnt vmcnt(17)
    s_waitcnt lgkmcnt(0)
    s_barrier
    v_mfma_f32_16x16x32_bf16 v[32:35], a[64:67], a[96:99], v[32:35]
    s_add_u32 s27, s27, 32768
    s_cmp_eq_u32 s27, 98304
    v_mfma_f32_16x16x32_bf16 v[40:43], a[64:67], a[100:103], v[40:43]
    s_cselect_b32 s27, 0, s27
    v_add_u32 v13, s27, v15
    v_mfma_f32_16x16x32_bf16 v[48:51], a[64:67], a[104:107], v[48:51]
    v_add_u32 v14, s27, v16
    s_add_u32 m0, s30, 16384
    v_mfma_f32_16x16x32_bf16 v[56:59], a[64:67], a[108:111], v[56:59]
    ds_read_b64_tr_b16 a[0:1], v5 offset:32768
    v_mfma_f32_16x16x32_bf16 v[64:67], a[64:67], a[112:115], v[64:67]
    buffer_load_dwordx4 v17, s[12:15], s24 offen offset:0 sc1 lds
    v_mfma_f32_16x16x32_bf16 v[72:75], a[64:67], a[116:119], v[72:75]
    ds_read_b64_tr_b16 a[2:3], v5 offset:33792
    v_mfma_f32_16x16x32_bf16 v[80:83], a[64:67], a[120:123], v[80:83]
    v_mfma_f32_16x16x32_bf16 v[88:91], a[64:67], a[124:127], v[88:91]
    ds_read_b128 a[32:35], v13 offset:0
    v_mfma_f32_16x16x32_bf16 v[92:95], a[68:71], a[124:127], v[92:95]
    v_mfma_f32_16x16x32_bf16 v[84:87], a[68:71], a[120:123], v[84:87]
    ds_read_b64_tr_b16 a[4:5], v6 offset:32768
    v_mfma_f32_16x16x32_bf16 v[76:79], a[68:71], a[116:119], v[76:79]
    buffer_load_dwordx4 v18, s[12:15], s24 offen offset:1024 sc1 lds
    v_mfma_f32_16x16x32_bf16 v[68:71], a[68:71], a[112:115], v[68:71]
    ds_read_b64_tr_b16 a[6:7], v6 offset:33792
    v_mfma_f32_16x16x32_bf16 v[60:63], a[68:71], a[108:111], v[60:63]
    v_mfma_f32_16x16x32_bf16 v[52:55], a[68:71], a[104:107], v[52:55]
    ds_read_b128 a[36:39], v13 offset:2048
    v_mfma_f32_16x16x32_bf16 v[44:47], a[68:71], a[100:103], v[44:47]
    v_mfma_f32_16x16x32_bf16 v[36:39], a[68:71], a[96:99], v[36:39]
    ds_read_b64_tr_b16 a[8:9], v7 offset:32768
    v_mfma_f32_16x16x32_bf16 v[96:99], a[72:75], a[96:99], v[96:99]
    buffer_load_dwordx4 v19, s[12:15], s24 offen offset:2048 sc1 lds
    v_mfma_f32_16x16x32_bf16 v[104:107], a[72:75], a[100:103], v[104:107]
    ds_read_b64_tr_b16 a[10:11], v7 offset:33792
    v_mfma_f32_16x16x32_bf16 v[112:115], a[72:75], a[104:107], v[112:115]
    v_mfma_f32_16x16x32_bf16 v[120:123], a[72:75], a[108:111], v[120:123]
    ds_read_b128 a[40:43], v13 offset:4096
    v_mfma_f32_16x16x32_bf16 v[128:131], a[72:75], a[112:115], v[128:131]
    v_mfma_f32_16x16x32_bf16 v[136:139], a[72:75], a[116:119], v[136:139]
    ds_read_b64_tr_b16 a[12:13], v8 offset:32768
    v_mfma_f32_16x16x32_bf16 v[144:147], a[72:75], a[120:123], v[144:147]
    buffer_load_dwordx4 v20, s[12:15], s24 offen offset:3072 sc1 lds
    v_mfma_f32_16x16x32_bf16 v[152:155], a[72:75], a[124:127], v[152:155]
    ds_read_b64_tr_b16 a[14:15], v8 offset:33792
    v_mfma_f32_16x16x32_bf16 v[156:159], a[76:79], a[124:127], v[156:159]
    s_add_u32 s24, s24, 262144
    v_mfma_f32_16x16x32_bf16 v[148:151], a[76:79], a[120:123], v[148:151]
    ds_read_b128 a[44:47], v13 offset:6144
    v_mfma_f32_16x16x32_bf16 v[140:143], a[76:79], a[116:119], v[140:143]
    s_mov_b32 m0, s26
    v_mfma_f32_16x16x32_bf16 v[132:135], a[76:79], a[112:115], v[132:135]
    ds_read_b64_tr_b16 a[16:17], v9 offset:32768
    v_mfma_f32_16x16x32_bf16 v[124:127], a[76:79], a[108:111], v[124:127]
    buffer_load_dwordx4 v21, s[8:11], s25 offen offset:0 sc1 lds
    v_mfma_f32_16x16x32_bf16 v[116:119], a[76:79], a[104:107], v[116:119]
    ds_read_b64_tr_b16 a[18:19], v9 offset:33792
    v_mfma_f32_16x16x32_bf16 v[108:111], a[76:79], a[100:103], v[108:111]
    v_mfma_f32_16x16x32_bf16 v[100:103], a[76:79], a[96:99], v[100:103]
    ds_read_b128 a[48:51], v13 offset:8192
    v_mfma_f32_16x16x32_bf16 v[160:163], a[80:83], a[96:99], v[160:163]
    v_mfma_f32_16x16x32_bf16 v[168:171], a[80:83], a[100:103], v[168:171]
    ds_read_b64_tr_b16 a[20:21], v10 offset:32768
    v_mfma_f32_16x16x32_bf16 v[176:179], a[80:83], a[104:107], v[176:179]
    buffer_load_dwordx4 v22, s[8:11], s25 offen offset:1024 sc1 lds
    v_mfma_f32_16x16x32_bf16 v[184:187], a[80:83], a[108:111], v[184:187]
    ds_read_b64_tr_b16 a[22:23], v10 offset:33792
    v_mfma_f32_16x16x32_bf16 v[192:195], a[80:83], a[112:115], v[192:195]
    v_mfma_f32_16x16x32_bf16 v[200:203], a[80:83], a[116:119], v[200:203]
    ds_read_b128 a[52:55], v13 offset:10240
    v_mfma_f32_16x16x32_bf16 v[208:211], a[80:83], a[120:123], v[208:211]
    v_mfma_f32_16x16x32_bf16 v[216:219], a[80:83], a[124:127], v[216:219]
    ds_read_b64_tr_b16 a[24:25], v11 offset:32768
    v_mfma_f32_16x16x32_bf16 v[220:223], a[84:87], a[124:127], v[220:223]
    buffer_load_dwordx4 v23, s[8:11], s25 offen offset:2048 sc1 lds
    v_mfma_f32_16x16x32_bf16 v[212:215], a[84:87], a[120:123], v[212:215]
    ds_read_b64_tr_b16 a[26:27], v11 offset:33792
    v_mfma_f32_16x16x32_bf16 v[204:207], a[84:87], a[116:119], v[204:207]
    v_mfma_f32_16x16x32_bf16 v[196:199], a[84:87], a[112:115], v[196:199]
    ds_read_b128 a[56:59], v13 offset:12288
    v_mfma_f32_16x16x32_bf16 v[188:191], a[84:87], a[108:111], v[188:191]
    v_mfma_f32_16x16x32_bf16 v[180:183], a[84:87], a[104:107], v[180:183]
    ds_read_b64_tr_b16 a[28:29], v12 offset:32768
    v_mfma_f32_16x16x32_bf16 v[172:175], a[84:87], a[100:103], v[172:175]
    buffer_load_dwordx4 v24, s[8:11], s25 offen offset:3072 sc1 lds
    v_mfma_f32_16x16x32_bf16 v[164:167], a[84:87], a[96:99], v[164:167]
    ds_read_b64_tr_b16 a[30:31], v12 offset:33792
    v_mfma_f32_16x16x32_bf16 v[224:227], a[88:91], a[96:99], v[224:227]
    v_mfma_f32_16x16x32_bf16 v[232:235], a[88:91], a[100:103], v[232:235]
    ds_read_b128 a[60:63], v13 offset:14336
    v_mfma_f32_16x16x32_bf16 v[240:243], a[88:91], a[104:107], v[240:243]
    v_mfma_f32_16x16x32_bf16 v[248:251], a[88:91], a[108:111], v[248:251]
    v_mfma_f32_16x16x32_bf16 a[224:227], a[88:91], a[112:115], a[224:227]
    v_mfma_f32_16x16x32_bf16 a[232:235], a[88:91], a[116:119], a[232:235]
    v_mfma_f32_16x16x32_bf16 a[240:243], a[88:91], a[120:123], a[240:243]
    v_mfma_f32_16x16x32_bf16 a[248:251], a[88:91], a[124:127], a[248:251]
    v_mfma_f32_16x16x32_bf16 a[252:255], a[92:95], a[124:127], a[252:255]
    v_mfma_f32_16x16x32_bf16 a[244:247], a[92:95], a[120:123], a[244:247]
    buffer_load_dword a202, v4, s[68:71], s74 offen
    v_mfma_f32_16x16x32_bf16 a[236:239], a[92:95], a[116:119], a[236:239]
    s_add_u32 s74, s74, s80
    v_mfma_f32_16x16x32_bf16 a[228:231], a[92:95], a[112:115], a[228:231]
    v_mfma_f32_16x16x32_bf16 v[252:255], a[92:95], a[108:111], v[252:255]
    v_mfma_f32_16x16x32_bf16 v[244:247], a[92:95], a[104:107], v[244:247]
    v_mfma_f32_16x16x32_bf16 v[236:239], a[92:95], a[100:103], v[236:239]
    v_mfma_f32_16x16x32_bf16 v[228:231], a[92:95], a[96:99], v[228:231]
    s_waitcnt vmcnt(18)
    s_waitcnt lgkmcnt(0)
    s_barrier
    v_mfma_f32_16x16x32_bf16 v[32:35], a[0:3], a[32:35], v[32:35]
    v_mfma_f32_16x16x32_bf16 v[40:43], a[0:3], a[36:39], v[40:43]
    v_mfma_f32_16x16x32_bf16 v[48:51], a[0:3], a[40:43], v[48:51]
    s_add_u32 m0, s30, 32768
    v_mfma_f32_16x16x32_bf16 v[56:59], a[0:3], a[44:47], v[56:59]
    ds_read_b64_tr_b16 a[64:65], v5 offset:49152
    v_mfma_f32_16x16x32_bf16 v[64:67], a[0:3], a[48:51], v[64:67]
    buffer_load_dwordx4 v17, s[12:15], s24 offen offset:0 sc1 lds
    v_mfma_f32_16x16x32_bf16 v[72:75], a[0:3], a[52:55], v[72:75]
    ds_read_b64_tr_b16 a[66:67], v5 offset:50176
    v_mfma_f32_16x16x32_bf16 v[80:83], a[0:3], a[56:59], v[80:83]
    v_mfma_f32_16x16x32_bf16 v[88:91], a[0:3], a[60:63], v[88:91]
    ds_read_b128 a[96:99], v14 offset:0
    v_mfma_f32_16x16x32_bf16 v[92:95], a[4:7], a[60:63], v[92:95]
    v_mfma_f32_16x16x32_bf16 v[84:87], a[4:7], a[56:59], v[84:87]
    ds_read_b64_tr_b16 a[68:69], v6 offset:49152
    v_mfma_f32_16x16x32_bf16 v[76:79], a[4:7], a[52:55], v[76:79]
    buffer_load_dwordx4 v18, s[12:15], s24 offen offset:1024 sc1 lds
    v_mfma_f32_16x16x32_bf16 v[68:71], a[4:7], a[48:51], v[68:71]
    ds_read_b64_tr_b16 a[70:71], v6 offset:50176
    v_mfma_f32_16x16x32_bf16 v[60:63], a[4:7], a[44:47], v[60:63]
    v_mfma_f32_16x16x32_bf16 v[52:55], a[4:7], a[40:43], v[52:55]
    ds_read_b128 a[100:103], v14 offset:2048
    v_mfma_f32_16x16x32_bf16 v[44:47], a[4:7], a[36:39], v[44:47]
    v_mfma_f32_16x16x32_bf16 v[36:39], a[4:7], a[32:35], v[36:39]
    ds_read_b64_tr_b16 a[72:73], v7 offset:49152
    v_mfma_f32_16x16x32_bf16 v[96:99], a[8:11], a[32:35], v[96:99]
    buffer_load_dwordx4 v19, s[12:15], s24 offen offset:2048 sc1 lds
    v_mfma_f32_16x16x32_bf16 v[104:107], a[8:11], a[36:39], v[104:107]
    ds_read_b64_tr_b16 a[74:75], v7 offset:50176
    v_mfma_f32_16x16x32_bf16 v[112:115], a[8:11], a[40:43], v[112:115]
    v_mfma_f32_16x16x32_bf16 v[120:123], a[8:11], a[44:47], v[120:123]
    ds_read_b128 a[104:107], v14 offset:4096
    v_mfma_f32_16x16x32_bf16 v[128:131], a[8:11], a[48:51], v[128:131]
    v_mfma_f32_16x16x32_bf16 v[136:139], a[8:11], a[52:55], v[136:139]
    ds_read_b64_tr_b16 a[76:77], v8 offset:49152
    v_mfma_f32_16x16x32_bf16 v[144:147], a[8:11], a[56:59], v[144:147]
    buffer_load_dwordx4 v20, s[12:15], s24 offen offset:3072 sc1 lds
    v_mfma_f32_16x16x32_bf16 v[152:155], a[8:11], a[60:63], v[152:155]
    ds_read_b64_tr_b16 a[78:79], v8 offset:50176
    v_mfma_f32_16x16x32_bf16 v[156:159], a[12:15], a[60:63], v[156:159]
    s_add_u32 s24, s24, 262144
    s_add_u32 s31, s25, 65536
    v_mfma_f32_16x16x32_bf16 v[148:151], a[12:15], a[56:59], v[148:151]
    ds_read_b128 a[108:111], v14 offset:6144
    v_mfma_f32_16x16x32_bf16 v[140:143], a[12:15], a[52:55], v[140:143]
    s_add_u32 m0, s26, 4096
    v_mfma_f32_16x16x32_bf16 v[132:135], a[12:15], a[48:51], v[132:135]
    ds_read_b64_tr_b16 a[80:81], v9 offset:49152
    v_mfma_f32_16x16x32_bf16 v[124:127], a[12:15], a[44:47], v[124:127]
    buffer_load_dwordx4 v21, s[8:11], s31 offen offset:0 sc1 lds
    v_mfma_f32_16x16x32_bf16 v[116:119], a[12:15], a[40:43], v[116:119]
    ds_read_b64_tr_b16 a[82:83], v9 offset:50176
    v_mfma_f32_16x16x32_bf16 v[108:111], a[12:15], a[36:39], v[108:111]
    v_mfma_f32_16x16x32_bf16 v[100:103], a[12:15], a[32:35], v[100:103]
    ds_read_b128 a[112:115], v14 offset:8192
    v_mfma_f32_16x16x32_bf16 v[160:163], a[16:19], a[32:35], v[160:163]
    v_mfma_f32_16x16x32_bf16 v[168:171], a[16:19], a[36:39], v[168:171]
    ds_read_b64_tr_b16 a[84:85], v10 offset:49152
    v_mfma_f32_16x16x32_bf16 v[176:179], a[16:19], a[40:43], v[176:179]
    buffer_load_dwordx4 v22, s[8:11], s31 offen offset:1024 sc1 lds
    v_mfma_f32_16x16x32_bf16 v[184:187], a[16:19], a[44:47], v[184:187]
    ds_read_b64_tr_b16 a[86:87], v10 offset:50176
    v_mfma_f32_16x16x32_bf16 v[192:195], a[16:19], a[48:51], v[192:195]
    v_mfma_f32_16x16x32_bf16 v[200:203], a[16:19], a[52:55], v[200:203]
    ds_read_b128 a[116:119], v14 offset:10240
    v_mfma_f32_16x16x32_bf16 v[208:211], a[16:19], a[56:59], v[208:211]
    v_mfma_f32_16x16x32_bf16 v[216:219], a[16:19], a[60:63], v[216:219]
    ds_read_b64_tr_b16 a[88:89], v11 offset:49152
    v_mfma_f32_16x16x32_bf16 v[220:223], a[20:23], a[60:63], v[220:223]
    buffer_load_dwordx4 v23, s[8:11], s31 offen offset:2048 sc1 lds
    v_mfma_f32_16x16x32_bf16 v[212:215], a[20:23], a[56:59], v[212:215]
    ds_read_b64_tr_b16 a[90:91], v11 offset:50176
    v_mfma_f32_16x16x32_bf16 v[204:207], a[20:23], a[52:55], v[204:207]
    v_mfma_f32_16x16x32_bf16 v[196:199], a[20:23], a[48:51], v[196:199]
    ds_read_b128 a[120:123], v14 offset:12288
    v_mfma_f32_16x16x32_bf16 v[188:191], a[20:23], a[44:47], v[188:191]
    v_mfma_f32_16x16x32_bf16 v[180:183], a[20:23], a[40:43], v[180:183]
    ds_read_b64_tr_b16 a[92:93], v12 offset:49152
    v_mfma_f32_16x16x32_bf16 v[172:175], a[20:23], a[36:39], v[172:175]
    buffer_load_dwordx4 v24, s[8:11], s31 offen offset:3072 sc1 lds
    v_mfma_f32_16x16x32_bf16 v[164:167], a[20:23], a[32:35], v[164:167]
    ds_read_b64_tr_b16 a[94:95], v12 offset:50176
    v_mfma_f32_16x16x32_bf16 v[224:227], a[24:27], a[32:35], v[224:227]
    v_mfma_f32_16x16x32_bf16 v[232:235], a[24:27], a[36:39], v[232:235]
    ds_read_b128 a[124:127], v14 offset:14336
    v_mfma_f32_16x16x32_bf16 v[240:243], a[24:27], a[40:43], v[240:243]
    s_add_u32 s25, s25, 128
    s_add_u32 s29, s29, 1
    v_mfma_f32_16x16x32_bf16 v[248:251], a[24:27], a[44:47], v[248:251]
    v_mfma_f32_16x16x32_bf16 a[224:227], a[24:27], a[48:51], a[224:227]
    s_cmp_ge_u32 s29, 16
    s_cselect_b32 s25, 1073741824, s25
    v_mfma_f32_16x16x32_bf16 a[232:235], a[24:27], a[52:55], a[232:235]
    v_mfma_f32_16x16x32_bf16 a[240:243], a[24:27], a[56:59], a[240:243]
    s_add_u32 s26, s26, 32768
    s_cmp_eq_u32 s26, s65
    v_mfma_f32_16x16x32_bf16 a[248:251], a[24:27], a[60:63], a[248:251]
    s_cselect_b32 s26, s64, s26
    v_mfma_f32_16x16x32_bf16 a[252:255], a[28:31], a[60:63], a[252:255]
    v_mfma_f32_16x16x32_bf16 a[244:247], a[28:31], a[56:59], a[244:247]
    buffer_load_dword a203, v4, s[68:71], s74 offen
    v_mfma_f32_16x16x32_bf16 a[236:239], a[28:31], a[52:55], a[236:239]
    s_add_u32 s74, s74, s80
    v_mfma_f32_16x16x32_bf16 a[228:231], a[28:31], a[48:51], a[228:231]
    v_mfma_f32_16x16x32_bf16 v[252:255], a[28:31], a[44:47], v[252:255]
    v_mfma_f32_16x16x32_bf16 v[244:247], a[28:31], a[40:43], v[244:247]
    v_mfma_f32_16x16x32_bf16 v[236:239], a[28:31], a[36:39], v[236:239]
    v_mfma_f32_16x16x32_bf16 v[228:231], a[28:31], a[32:35], v[228:231]
    s_waitcnt vmcnt(19)
    s_waitcnt lgkmcnt(0)
    s_barrier
    v_mfma_f32_16x16x32_bf16 v[32:35], a[64:67], a[96:99], v[32:35]
    s_add_u32 s27, s27, 32768
    s_cmp_eq_u32 s27, 98304
    v_mfma_f32_16x16x32_bf16 v[40:43], a[64:67], a[100:103], v[40:43]
    s_cselect_b32 s27, 0, s27
    v_add_u32 v13, s27, v15
    v_mfma_f32_16x16x32_bf16 v[48:51], a[64:67], a[104:107], v[48:51]
    v_add_u32 v14, s27, v16
    s_add_u32 m0, s30, 49152
    v_mfma_f32_16x16x32_bf16 v[56:59], a[64:67], a[108:111], v[56:59]
    ds_read_b64_tr_b16 a[0:1], v5 offset:0
    v_mfma_f32_16x16x32_bf16 v[64:67], a[64:67], a[112:115], v[64:67]
    buffer_load_dwordx4 v17, s[12:15], s24 offen offset:0 sc1 lds
    v_mfma_f32_16x16x32_bf16 v[72:75], a[64:67], a[116:119], v[72:75]
    ds_read_b64_tr_b16 a[2:3], v5 offset:1024
    v_mfma_f32_16x16x32_bf16 v[80:83], a[64:67], a[120:123], v[80:83]
    v_mfma_f32_16x16x32_bf16 v[88:91], a[64:67], a[124:127], v[88:91]
    ds_read_b128 a[32:35], v13 offset:0
    v_mfma_f32_16x16x32_bf16 v[92:95], a[68:71], a[124:127], v[92:95]
    v_mfma_f32_16x16x32_bf16 v[84:87], a[68:71], a[120:123], v[84:87]
    ds_read_b64_tr_b16 a[4:5], v6 offset:0
    v_mfma_f32_16x16x32_bf16 v[76:79], a[68:71], a[116:119], v[76:79]
    buffer_load_dwordx4 v18, s[12:15], s24 offen offset:1024 sc1 lds
    v_mfma_f32_16x16x32_bf16 v[68:71], a[68:71], a[112:115], v[68:71]
    ds_read_b64_tr_b16 a[6:7], v6 offset:1024
    v_mfma_f32_16x16x32_bf16 v[60:63], a[68:71], a[108:111], v[60:63]
    v_mfma_f32_16x16x32_bf16 v[52:55], a[68:71], a[104:107], v[52:55]
    ds_read_b128 a[36:39], v13 offset:2048
    v_mfma_f32_16x16x32_bf16 v[44:47], a[68:71], a[100:103], v[44:47]
    v_mfma_f32_16x16x32_bf16 v[36:39], a[68:71], a[96:99], v[36:39]
    ds_read_b64_tr_b16 a[8:9], v7 offset:0
    v_mfma_f32_16x16x32_bf16 v[96:99], a[72:75], a[96:99], v[96:99]
    buffer_load_dwordx4 v19, s[12:15], s24 offen offset:2048 sc1 lds
    v_mfma_f32_16x16x32_bf16 v[104:107], a[72:75], a[100:103], v[104:107]
    ds_read_b64_tr_b16 a[10:11], v7 offset:1024
    v_mfma_f32_16x16x32_bf16 v[112:115], a[72:75], a[104:107], v[112:115]
    v_mfma_f32_16x16x32_bf16 v[120:123], a[72:75], a[108:111], v[120:123]
    ds_read_b128 a[40:43], v13 offset:4096
    v_mfma_f32_16x16x32_bf16 v[128:131], a[72:75], a[112:115], v[128:131]
    v_mfma_f32_16x16x32_bf16 v[136:139], a[72:75], a[116:119], v[136:139]
    ds_read_b64_tr_b16 a[12:13], v8 offset:0
    v_mfma_f32_16x16x32_bf16 v[144:147], a[72:75], a[120:123], v[144:147]
    buffer_load_dwordx4 v20, s[12:15], s24 offen offset:3072 sc1 lds
    v_mfma_f32_16x16x32_bf16 v[152:155], a[72:75], a[124:127], v[152:155]
    ds_read_b64_tr_b16 a[14:15], v8 offset:1024
    v_mfma_f32_16x16x32_bf16 v[156:159], a[76:79], a[124:127], v[156:159]
    s_add_u32 s24, s24, 262144
    v_mfma_f32_16x16x32_bf16 v[148:151], a[76:79], a[120:123], v[148:151]
    ds_read_b128 a[44:47], v13 offset:6144
    v_mfma_f32_16x16x32_bf16 v[140:143], a[76:79], a[116:119], v[140:143]
    s_mov_b32 m0, s26
    v_mfma_f32_16x16x32_bf16 v[132:135], a[76:79], a[112:115], v[132:135]
    ds_read_b64_tr_b16 a[16:17], v9 offset:0
    v_mfma_f32_16x16x32_bf16 v[124:127], a[76:79], a[108:111], v[124:127]
    buffer_load_dwordx4 v21, s[8:11], s25 offen offset:0 sc1 lds
    v_mfma_f32_16x16x32_bf16 v[116:119], a[76:79], a[104:107], v[116:119]
    ds_read_b64_tr_b16 a[18:19], v9 offset:1024
    v_mfma_f32_16x16x32_bf16 v[108:111], a[76:79], a[100:103], v[108:111]
    v_mfma_f32_16x16x32_bf16 v[100:103], a[76:79], a[96:99], v[100:103]
    ds_read_b128 a[48:51], v13 offset:8192
    v_mfma_f32_16x16x32_bf16 v[160:163], a[80:83], a[96:99], v[160:163]
    v_mfma_f32_16x16x32_bf16 v[168:171], a[80:83], a[100:103], v[168:171]
    ds_read_b64_tr_b16 a[20:21], v10 offset:0
    v_mfma_f32_16x16x32_bf16 v[176:179], a[80:83], a[104:107], v[176:179]
    buffer_load_dwordx4 v22, s[8:11], s25 offen offset:1024 sc1 lds
    v_mfma_f32_16x16x32_bf16 v[184:187], a[80:83], a[108:111], v[184:187]
    ds_read_b64_tr_b16 a[22:23], v10 offset:1024
    v_mfma_f32_16x16x32_bf16 v[192:195], a[80:83], a[112:115], v[192:195]
    v_mfma_f32_16x16x32_bf16 v[200:203], a[80:83], a[116:119], v[200:203]
    ds_read_b128 a[52:55], v13 offset:10240
    v_mfma_f32_16x16x32_bf16 v[208:211], a[80:83], a[120:123], v[208:211]
    v_mfma_f32_16x16x32_bf16 v[216:219], a[80:83], a[124:127], v[216:219]
    ds_read_b64_tr_b16 a[24:25], v11 offset:0
    v_mfma_f32_16x16x32_bf16 v[220:223], a[84:87], a[124:127], v[220:223]
    buffer_load_dwordx4 v23, s[8:11], s25 offen offset:2048 sc1 lds
    v_mfma_f32_16x16x32_bf16 v[212:215], a[84:87], a[120:123], v[212:215]
    ds_read_b64_tr_b16 a[26:27], v11 offset:1024
    v_mfma_f32_16x16x32_bf16 v[204:207], a[84:87], a[116:119], v[204:207]
    v_mfma_f32_16x16x32_bf16 v[196:199], a[84:87], a[112:115], v[196:199]
    ds_read_b128 a[56:59], v13 offset:12288
    v_mfma_f32_16x16x32_bf16 v[188:191], a[84:87], a[108:111], v[188:191]
    v_mfma_f32_16x16x32_bf16 v[180:183], a[84:87], a[104:107], v[180:183]
    ds_read_b64_tr_b16 a[28:29], v12 offset:0
    v_mfma_f32_16x16x32_bf16 v[172:175], a[84:87], a[100:103], v[172:175]
    buffer_load_dwordx4 v24, s[8:11], s25 offen offset:3072 sc1 lds
    v_mfma_f32_16x16x32_bf16 v[164:167], a[84:87], a[96:99], v[164:167]
    ds_read_b64_tr_b16 a[30:31], v12 offset:1024
    v_mfma_f32_16x16x32_bf16 v[224:227], a[88:91], a[96:99], v[224:227]
    v_mfma_f32_16x16x32_bf16 v[232:235], a[88:91], a[100:103], v[232:235]
    ds_read_b128 a[60:63], v13 offset:14336
    v_mfma_f32_16x16x32_bf16 v[240:243], a[88:91], a[104:107], v[240:243]
    v_mfma_f32_16x16x32_bf16 v[248:251], a[88:91], a[108:111], v[248:251]
    v_mfma_f32_16x16x32_bf16 a[224:227], a[88:91], a[112:115], a[224:227]
    v_mfma_f32_16x16x32_bf16 a[232:235], a[88:91], a[116:119], a[232:235]
    v_mfma_f32_16x16x32_bf16 a[240:243], a[88:91], a[120:123], a[240:243]
    v_mfma_f32_16x16x32_bf16 a[248:251], a[88:91], a[124:127], a[248:251]
    v_mfma_f32_16x16x32_bf16 a[252:255], a[92:95], a[124:127], a[252:255]
    v_mfma_f32_16x16x32_bf16 a[244:247], a[92:95], a[120:123], a[244:247]
    buffer_load_dword a204, v4, s[68:71], s74 offen
    v_mfma_f32_16x16x32_bf16 a[236:239], a[92:95], a[116:119], a[236:239]
    s_add_u32 s74, s74, s80
    v_mfma_f32_16x16x32_bf16 a[228:231], a[92:95], a[112:115], a[228:231]
    s_add_u32 s28, s28, 1
    s_cmp_ge_u32 s28, s83
    v_mfma_f32_16x16x32_bf16 v[252:255], a[92:95], a[108:111], v[252:255]
    s_cselect_b32 s80, s81, 0
    s_cselect_b32 s70, s82, 0
    v_mfma_f32_16x16x32_bf16 v[244:247], a[92:95], a[104:107], v[244:247]
    s_cmp_lt_u32 s28, 7
    v_mfma_f32_16x16x32_bf16 v[236:239], a[92:95], a[100:103], v[236:239]
    v_mfma_f32_16x16x32_bf16 v[228:231], a[92:95], a[96:99], v[228:231]
pj_kloop:
    s_cmp_eq_u32 s20, 0
    s_cbranch_scc0 sig_2
    s_cmp_eq_u32 s28, s76
    s_cbranch_scc0 sig_2
    v_mov_b32 v2, 1
    v_mov_b32 v3, 0
    s_mov_b64 exec, 1
    buffer_atomic_add v2, v3, s[60:63], 0 offen sc1
    s_mov_b64 exec, -1
sig_2:
    s_waitcnt vmcnt(19)
    s_waitcnt lgkmcnt(0)
    s_barrier
    v_mfma_f32_16x16x32_bf16 v[32:35], a[0:3], a[32:35], v[32:35]
    v_mfma_f32_16x16x32_bf16 v[40:43], a[0:3], a[36:39], v[40:43]
    v_mfma_f32_16x16x32_bf16 v[48:51], a[0:3], a[40:43], v[48:51]
    s_add_u32 m0, s30, 0
    v_mfma_f32_16x16x32_bf16 v[56:59], a[0:3], a[44:47], v[56:59]
    ds_read_b64_tr_b16 a[64:65], v5 offset:16384
    v_mfma_f32_16x16x32_bf16 v[64:67], a[0:3], a[48:51], v[64:67]
    buffer_load_dwordx4 v17, s[12:15], s24 offen offset:0 sc1 lds
    v_mfma_f32_16x16x32_bf16 v[72:75], a[0:3], a[52:55], v[72:75]
    ds_read_b64_tr_b16 a[66:67], v5 offset:17408
    v_mfma_f32_16x16x32_bf16 v[80:83], a[0:3], a[56:59], v[80:83]
    v_mfma_f32_16x16x32_bf16 v[88:91], a[0:3], a[60:63], v[88:91]
    ds_read_b128 a[96:99], v14 offset:0
    v_mfma_f32_16x16x32_bf16 v[92:95], a[4:7], a[60:63], v[92:95]
    v_mfma_f32_16x16x32_bf16 v[84:87], a[4:7], a[56:59], v[84:87]
    ds_read_b64_tr_b16 a[68:69], v6 offset:16384
    v_mfma_f32_16x16x32_bf16 v[76:79], a[4:7], a[52:55], v[76:79]
    buffer_load_dwordx4 v18, s[12:15], s24 offen offset:1024 sc1 lds
    v_mfma_f32_16x16x32_bf16 v[68:71], a[4:7], a[48:51], v[68:71]
    ds_read_b64_tr_b16 a[70:71], v6 offset:17408
    v_mfma_f32_16x16x32_bf16 v[60:63], a[4:7], a[44:47], v[60:63]
    v_mfma_f32_16x16x32_bf16 v[52:55], a[4:7], a[40:43], v[52:55]
    ds_read_b128 a[100:103], v14 offset:2048
    v_mfma_f32_16x16x32_bf16 v[44:47], a[4:7], a[36:39], v[44:47]
    v_mfma_f32_16x16x32_bf16 v[36:39], a[4:7], a[32:35], v[36:39]
    ds_read_b64_tr_b16 a[72:73], v7 offset:16384
    v_mfma_f32_16x16x32_bf16 v[96:99], a[8:11], a[32:35], v[96:99]
    buffer_load_dwordx4 v19, s[12:15], s24 offen offset:2048 sc1 lds
    v_mfma_f32_16x16x32_bf16 v[104:107], a[8:11], a[36:39], v[104:107]
    ds_read_b64_tr_b16 a[74:75], v7 offset:17408
    v_mfma_f32_16x16x32_bf16 v[112:115], a[8:11], a[40:43], v[112:115]
    v_mfma_f32_16x16x32_bf16 v[120:123], a[8:11], a[44:47], v[120:123]
    ds_read_b128 a[104:107], v14 offset:4096
    v_mfma_f32_16x16x32_bf16 v[128:131], a[8:11], a[48:51], v[128:131]
    v_mfma_f32_16x16x32_bf16 v[136:139], a[8:11], a[52:55], v[136:139]
    ds_read_b64_tr_b16 a[76:77], v8 offset:16384
    v_mfma_f32_16x16x32_bf16 v[144:147], a[8:11], a[56:59], v[144:147]
    buffer_load_dwordx4 v20, s[12:15], s24 offen offset:3072 sc1 lds
    v_mfma_f32_16x16x32_bf16 v[152:155], a[8:11], a[60:63], v[152:155]
    ds_read_b64_tr_b16 a[78:79], v8 offset:17408
    v_mfma_f32_16x16x32_bf16 v[156:159], a[12:15], a[60:63], v[156:159]
    s_add_u32 s24, s24, 262144
    s_add_u32 s31, s25, 65536
    v_mfma_f32_16x16x32_bf16 v[148:151], a[12:15], a[56:59], v[148:151]
    ds_read_b128 a[108:111], v14 offset:6144
    v_mfma_f32_16x16x32_bf16 v[140:143], a[12:15], a[52:55], v[140:143]
    s_add_u32 m0, s26, 4096
    v_mfma_f32_16x16x32_bf16 v[132:135], a[12:15], a[48:51], v[132:135]
    ds_read_b64_tr_b16 a[80:81], v9 offset:16384
    v_mfma_f32_16x16x32_bf16 v[124:127], a[12:15], a[44:47], v[124:127]
    buffer_load_dwordx4 v21, s[8:11], s31 offen offset:0 sc1 lds
    v_mfma_f32_16x16x32_bf16 v[116:119], a[12:15], a[40:43], v[116:119]
    ds_read_b64_tr_b16 a[82:83], v9 offset:17408
    v_mfma_f32_16x16x32_bf16 v[108:111], a[12:15], a[36:39], v[108:111]
    v_mfma_f32_16x16x32_bf16 v[100:103], a[12:15], a[32:35], v[100:103]
    ds_read_b128 a[112:115], v14 offset:8192
    v_mfma_f32_16x16x32_bf16 v[160:163], a[16:19], a[32:35], v[160:163]
    v_mfma_f32_16x16x32_bf16 v[168:171], a[16:19], a[36:39], v[168:171]
    ds_read_b64_tr_b16 a[84:85], v10 offset:16384
    v_mfma_f32_16x16x32_bf16 v[176:179], a[16:19], a[40:43], v[176:179]
    buffer_load_dwordx4 v22, s[8:11], s31 offen offset:1024 sc1 lds
    v_mfma_f32_16x16x32_bf16 v[184:187], a[16:19], a[44:47], v[184:187]
    ds_read_b64_tr_b16 a[86:87], v10 offset:17408
    v_mfma_f32_16x16x32_bf16 v[192:195], a[16:19], a[48:51], v[192:195]
    v_mfma_f32_16x16x32_bf16 v[200:203], a[16:19], a[52:55], v[200:203]
    ds_read_b128 a[116:119], v14 offset:10240
    v_mfma_f32_16x16x32_bf16 v[208:211], a[16:19], a[56:59], v[208:211]
    v_mfma_f32_16x16x32_bf16 v[216:219], a[16:19], a[60:63], v[216:219]
    ds_read_b64_tr_b16 a[88:89], v11 offset:16384
    v_mfma_f32_16x16x32_bf16 v[220:223], a[20:23], a[60:63], v[220:223]
    buffer_load_dwordx4 v23, s[8:11], s31 offen offset:2048 sc1 lds
    v_mfma_f32_16x16x32_bf16 v[212:215], a[20:23], a[56:59], v[212:215]
    ds_read_b64_tr_b16 a[90:91], v11 offset:17408
    v_mfma_f32_16x16x32_bf16 v[204:207], a[20:23], a[52:55], v[204:207]
    v_mfma_f32_16x16x32_bf16 v[196:199], a[20:23], a[48:51], v[196:199]
    ds_read_b128 a[120:123], v14 offset:12288
    v_mfma_f32_16x16x32_bf16 v[188:191], a[20:23], a[44:47], v[188:191]
    v_mfma_f32_16x16x32_bf16 v[180:183], a[20:23], a[40:43], v[180:183]
    ds_read_b64_tr_b16 a[92:93], v12 offset:16384
    v_mfma_f32_16x16x32_bf16 v[172:175], a[20:23], a[36:39], v[172:175]
    buffer_load_dwordx4 v24, s[8:11], s31 offen offset:3072 sc1 lds
    v_mfma_f32_16x16x32_bf16 v[164:167], a[20:23], a[32:35], v[164:167]
    ds_read_b64_tr_b16 a[94:95], v12 offset:17408
    v_mfma_f32_16x16x32_bf16 v[224:227], a[24:27], a[32:35], v[224:227]
    v_mfma_f32_16x16x32_bf16 v[232:235], a[24:27], a[36:39], v[232:235]
    ds_read_b128 a[124:127], v14 offset:14336
    v_mfma_f32_16x16x32_bf16 v[240:243], a[24:27], a[40:43], v[240:243]
    s_add_u32 s25, s25, 128
    s_add_u32 s29, s29, 1
    v_mfma_f32_16x16x32_bf16 v[248:251], a[24:27], a[44:47], v[248:251]
    v_mfma_f32_16x16x32_bf16 a[224:227], a[24:27], a[48:51], a[224:227]
    s_cmp_ge_u32 s29, 16
    s_cselect_b32 s25, 1073741824, s25
    v_mfma_f32_16x16x32_bf16 a[232:235], a[24:27], a[52:55], a[232:235]
    v_mfma_f32_16x16x32_bf16 a[240:243], a[24:27], a[56:59], a[240:243]
    s_add_u32 s26, s26, 32768
    s_cmp_eq_u32 s26, s65
    v_mfma_f32_16x16x32_bf16 a[248:251], a[24:27], a[60:63], a[248:251]
    s_cselect_b32 s26, s64, s26
    v_mfma_f32_16x16x32_bf16 a[252:255], a[28:31], a[60:63], a[252:255]
    v_mfma_f32_16x16x32_bf16 a[244:247], a[28:31], a[56:59], a[244:247]
    buffer_load_dword a201, v4, s[68:71], s74 offen
    v_mfma_f32_16x16x32_bf16 a[236:239], a[28:31], a[52:55], a[236:239]
    s_add_u32 s74, s74, s80
    v_mfma_f32_16x16x32_bf16 a[228:231], a[28:31], a[48:51], a[228:231]
    v_mfma_f32_16x16x32_bf16 v[252:255], a[28:31], a[44:47], v[252:255]
    v_mfma_f32_16x16x32_bf16 v[244:247], a[28:31], a[40:43], v[244:247]
    v_mfma_f32_16x16x32_bf16 v[236:239], a[28:31], a[36:39], v[236:239]
    v_mfma_f32_16x16x32_bf16 v[228:231], a[28:31], a[32:35], v[228:231]
    s_waitcnt vmcnt(19)
    s_waitcnt lgkmcnt(0)
    s_barrier
    v_mfma_f32_16x16x32_bf16 v[32:35], a[64:67], a[96:99], v[32:35]
    s_add_u32 s27, s27, 32768
    s_cmp_eq_u32 s27, 98304
    v_mfma_f32_16x16x32_bf16 v[40:43], a[64:67], a[100:103], v[40:43]
    s_cselect_b32 s27, 0, s27
    v_add_u32 v13, s27, v15
    v_mfma_f32_16x16x32_bf16 v[48:51], a[64:67], a[104:107], v[48:51]
    v_add_u32 v14, s27, v16
    s_add_u32 m0, s30, 16384
    v_mfma_f32_16x16x32_bf16 v[56:59], a[64:67], a[108:111], v[56:59]
    ds_read_b64_tr_b16 a[0:1], v5 offset:32768
    v_mfma_f32_16x16x32_bf16 v[64:67], a[64:67], a[112:115], v[64:67]
    buffer_load_dwordx4 v17, s[12:15], s24 offen offset:0 sc1 lds
    v_mfma_f32_16x16x32_bf16 v[72:75], a[64:67], a[116:119], v[72:75]
    ds_read_b64_tr_b16 a[2:3], v5 offset:33792
    v_mfma_f32_16x16x32_bf16 v[80:83], a[64:67], a[120:123], v[80:83]
    v_mfma_f32_16x16x32_bf16 v[88:91], a[64:67], a[124:127], v[88:91]
    ds_read_b128 a[32:35], v13 offset:0
    v_mfma_f32_16x16x32_bf16 v[92:95], a[68:71], a[124:127], v[92:95]
    v_mfma_f32_16x16x32_bf16 v[84:87], a[68:71], a[120:123], v[84:87]
    ds_read_b64_tr_b16 a[4:5], v6 offset:32768
    v_mfma_f32_16x16x32_bf16 v[76:79], a[68:71], a[116:119], v[76:79]
    buffer_load_dwordx4 v18, s[12:15], s24 offen offset:1024 sc1 lds
    v_mfma_f32_16x16x32_bf16 v[68:71], a[68:71], a[112:115], v[68:71]
    ds_read_b64_tr_b16 a[6:7], v6 offset:33792
    v_mfma_f32_16x16x32_bf16 v[60:63], a[68:71], a[108:111], v[60:63]
    v_mfma_f32_16x16x32_bf16 v[52:55], a[68:71], a[104:107], v[52:55]
    ds_read_b128 a[36:39], v13 offset:2048
    v_mfma_f32_16x16x32_bf16 v[44:47], a[68:71], a[100:103], v[44:47]
    v_mfma_f32_16x16x32_bf16 v[36:39], a[68:71], a[96:99], v[36:39]
    ds_read_b64_tr_b16 a[8:9], v7 offset:32768
    v_mfma_f32_16x16x32_bf16 v[96:99], a[72:75], a[96:99], v[96:99]
    buffer_load_dwordx4 v19, s[12:15], s24 offen offset:2048 sc1 lds
    v_mfma_f32_16x16x32_bf16 v[104:107], a[72:75], a[100:103], v[104:107]
    ds_read_b64_tr_b16 a[10:11], v7 offset:33792
    v_mfma_f32_16x16x32_bf16 v[112:115], a[72:75], a[104:107], v[112:115]
    v_mfma_f32_16x16x32_bf16 v[120:123], a[72:75], a[108:111], v[120:123]
    ds_read_b128 a[40:43], v13 offset:4096
    v_mfma_f32_16x16x32_bf16 v[128:131], a[72:75], a[112:115], v[128:131]
    v_mfma_f32_16x16x32_bf16 v[136:139], a[72:75], a[116:119], v[136:139]
    ds_read_b64_tr_b16 a[12:13], v8 offset:32768
    v_mfma_f32_16x16x32_bf16 v[144:147], a[72:75], a[120:123], v[144:147]
    buffer_load_dwordx4 v20, s[12:15], s24 offen offset:3072 sc1 lds
    v_mfma_f32_16x16x32_bf16 v[152:155], a[72:75], a[124:127], v[152:155]
    ds_read_b64_tr_b16 a[14:15], v8 offset:33792
    v_mfma_f32_16x16x32_bf16 v[156:159], a[76:79], a[124:127], v[156:159]
    s_add_u32 s24, s24, 262144
    v_mfma_f32_16x16x32_bf16 v[148:151], a[76:79], a[120:123], v[148:151]
    ds_read_b128 a[44:47], v13 offset:6144
    v_mfma_f32_16x16x32_bf16 v[140:143], a[76:79], a[116:119], v[140:143]
    s_mov_b32 m0, s26
    v_mfma_f32_16x16x32_bf16 v[132:135], a[76:79], a[112:115], v[132:135]
    ds_read_b64_tr_b16 a[16:17], v9 offset:32768
    v_mfma_f32_16x16x32_bf16 v[124:127], a[76:79], a[108:111], v[124:127]
    buffer_load_dwordx4 v21, s[8:11], s25 offen offset:0 sc1 lds
    v_mfma_f32_16x16x32_bf16 v[116:119], a[76:79], a[104:107], v[116:119]
    ds_read_b64_tr_b16 a[18:19], v9 offset:33792
    v_mfma_f32_16x16x32_bf16 v[108:111], a[76:79], a[100:103], v[108:111]
    v_mfma_f32_16x16x32_bf16 v[100:103], a[76:79], a[96:99], v[100:103]
    ds_read_b128 a[48:51], v13 offset:8192
    v_mfma_f32_16x16x32_bf16 v[160:163], a[80:83], a[96:99], v[160:163]
    v_mfma_f32_16x16x32_bf16 v[168:171], a[80:83], a[100:103], v[168:171]
    ds_read_b64_tr_b16 a[20:21], v10 offset:32768
    v_mfma_f32_16x16x32_bf16 v[176:179], a[80:83], a[104:107], v[176:179]
    buffer_load_dwordx4 v22, s[8:11], s25 offen offset:1024 sc1 lds
    v_mfma_f32_16x16x32_bf16 v[184:187], a[80:83], a[108:111], v[184:187]
    ds_read_b64_tr_b16 a[22:23], v10 offset:33792
    v_mfma_f32_16x16x32_bf16 v[192:195], a[80:83], a[112:115], v[192:195]
    v_mfma_f32_16x16x32_bf16 v[200:203], a[80:83], a[116:119], v[200:203]
    ds_read_b128 a[52:55], v13 offset:10240
    v_mfma_f32_16x16x32_bf16 v[208:211], a[80:83], a[120:123], v[208:211]
    v_mfma_f32_16x16x32_bf16 v[216:219], a[80:83], a[124:127], v[216:219]
    ds_read_b64_tr_b16 a[24:25], v11 offset:32768
    v_mfma_f32_16x16x32_bf16 v[220:223], a[84:87], a[124:127], v[220:223]
    buffer_load_dwordx4 v23, s[8:11], s25 offen offset:2048 sc1 lds
    v_mfma_f32_16x16x32_bf16 v[212:215], a[84:87], a[120:123], v[212:215]
    ds_read_b64_tr_b16 a[26:27], v11 offset:33792
    v_mfma_f32_16x16x32_bf16 v[204:207], a[84:87], a[116:119], v[204:207]
    v_mfma_f32_16x16x32_bf16 v[196:199], a[84:87], a[112:115], v[196:199]
    ds_read_b128 a[56:59], v13 offset:12288
    v_mfma_f32_16x16x32_bf16 v[188:191], a[84:87], a[108:111], v[188:191]
    v_mfma_f32_16x16x32_bf16 v[180:183], a[84:87], a[104:107], v[180:183]
    ds_read_b64_tr_b16 a[28:29], v12 offset:32768
    v_mfma_f32_16x16x32_bf16 v[172:175], a[84:87], a[100:103], v[172:175]
    buffer_load_dwordx4 v24, s[8:11], s25 offen offset:3072 sc1 lds
    v_mfma_f32_16x16x32_bf16 v[164:167], a[84:87], a[96:99], v[164:167]
    ds_read_b64_tr_b16 a[30:31], v12 offset:33792
    v_mfma_f32_16x16x32_bf16 v[224:227], a[88:91], a[96:99], v[224:227]
    v_mfma_f32_16x16x32_bf16 v[232:235], a[88:91], a[100:103], v[232:235]
    ds_read_b128 a[60:63], v13 offset:14336
    v_mfma_f32_16x16x32_bf16 v[240:243], a[88:91], a[104:107], v[240:243]
    v_mfma_f32_16x16x32_bf16 v[248:251], a[88:91], a[108:111], v[248:251]
    v_mfma_f32_16x16x32_bf16 a[224:227], a[88:91], a[112:115], a[224:227]
    v_mfma_f32_16x16x32_bf16 a[232:235], a[88:91], a[116:119], a[232:235]
    v_mfma_f32_16x16x32_bf16 a[240:243], a[88:91], a[120:123], a[240:243]
    v_mfma_f32_16x16x32_bf16 a[248:251], a[88:91], a[124:127], a[248:251]
    v_mfma_f32_16x16x32_bf16 a[252:255], a[92:95], a[124:127], a[252:255]
    v_mfma_f32_16x16x32_bf16 a[244:247], a[92:95], a[120:123], a[244:247]
    buffer_load_dword a202, v4, s[68:71], s74 offen
    v_mfma_f32_16x16x32_bf16 a[236:239], a[92:95], a[116:119], a[236:239]
    s_add_u32 s74, s74, s80
    v_mfma_f32_16x16x32_bf16 a[228:231], a[92:95], a[112:115], a[228:231]
    v_mfma_f32_16x16x32_bf16 v[252:255], a[92:95], a[108:111], v[252:255]
    v_mfma_f32_16x16x32_bf16 v[244:247], a[92:95], a[104:107], v[244:247]
    v_mfma_f32_16x16x32_bf16 v[236:239], a[92:95], a[100:103], v[236:239]
    v_mfma_f32_16x16x32_bf16 v[228:231], a[92:95], a[96:99], v[228:231]
    s_waitcnt vmcnt(19)
    s_waitcnt lgkmcnt(0)
    s_barrier
    v_mfma_f32_16x16x32_bf16 v[32:35], a[0:3], a[32:35], v[32:35]
    v_mfma_f32_16x16x32_bf16 v[40:43], a[0:3], a[36:39], v[40:43]
    v_mfma_f32_16x16x32_bf16 v[48:51], a[0:3], a[40:43], v[48:51]
    s_add_u32 m0, s30, 32768
    v_mfma_f32_16x16x32_bf16 v[56:59], a[0:3], a[44:47], v[56:59]
    ds_read_b64_tr_b16 a[64:65], v5 offset:49152
    v_mfma_f32_16x16x32_bf16 v[64:67], a[0:3], a[48:51], v[64:67]
    buffer_load_dwordx4 v17, s[12:15], s24 offen offset:0 sc1 lds
    v_mfma_f32_16x16x32_bf16 v[72:75], a[0:3], a[52:55], v[72:75]
    ds_read_b64_tr_b16 a[66:67], v5 offset:50176
    v_mfma_f32_16x16x32_bf16 v[80:83], a[0:3], a[56:59], v[80:83]
    v_mfma_f32_16x16x32_bf16 v[88:91], a[0:3], a[60:63], v[88:91]
    ds_read_b128 a[96:99], v14 offset:0
    v_mfma_f32_16x16x32_bf16 v[92:95], a[4:7], a[60:63], v[92:95]
    v_mfma_f32_16x16x32_bf16 v[84:87], a[4:7], a[56:59], v[84:87]
    ds_read_b64_tr_b16 a[68:69], v6 offset:49152
    v_mfma_f32_16x16x32_bf16 v[76:79], a[4:7], a[52:55], v[76:79]
    buffer_load_dwordx4 v18, s[12:15], s24 offen offset:1024 sc1 lds
    v_mfma_f32_16x16x32_bf16 v[68:71], a[4:7], a[48:51], v[68:71]
    ds_read_b64_tr_b16 a[70:71], v6 offset:50176
    v_mfma_f32_16x16x32_bf16 v[60:63], a[4:7], a[44:47], v[60:63]
    v_mfma_f32_16x16x32_bf16 v[52:55], a[4:7], a[40:43], v[52:55]
    ds_read_b128 a[100:103], v14 offset:2048
    v_mfma_f32_16x16x32_bf16 v[44:47], a[4:7], a[36:39], v[44:47]
    v_mfma_f32_16x16x32_bf16 v[36:39], a[4:7], a[32:35], v[36:39]
    ds_read_b64_tr_b16 a[72:73], v7 offset:49152
    v_mfma_f32_16x16x32_bf16 v[96:99], a[8:11], a[32:35], v[96:99]
    buffer_load_dwordx4 v19, s[12:15], s24 offen offset:2048 sc1 lds
    v_mfma_f32_16x16x32_bf16 v[104:107], a[8:11], a[36:39], v[104:107]
    ds_read_b64_tr_b16 a[74:75], v7 offset:50176
    v_mfma_f32_16x16x32_bf16 v[112:115], a[8:11], a[40:43], v[112:115]
    v_mfma_f32_16x16x32_bf16 v[120:123], a[8:11], a[44:47], v[120:123]
    ds_read_b128 a[104:107], v14 offset:4096
    v_mfma_f32_16x16x32_bf16 v[128:131], a[8:11], a[48:51], v[128:131]
    v_mfma_f32_16x16x32_bf16 v[136:139], a[8:11], a[52:55], v[136:139]
    ds_read_b64_tr_b16 a[76:77], v8 offset:49152
    v_mfma_f32_16x16x32_bf16 v[144:147], a[8:11], a[56:59], v[144:147]
    buffer_load_dwordx4 v20, s[12:15], s24 offen offset:3072 sc1 lds
    v_mfma_f32_16x16x32_bf16 v[152:155], a[8:11], a[60:63], v[152:155]
    ds_read_b64_tr_b16 a[78:79], v8 offset:50176
    v_mfma_f32_16x16x32_bf16 v[156:159], a[12:15], a[60:63], v[156:159]
    s_add_u32 s24, s24, 262144
    s_add_u32 s31, s25, 65536
    v_mfma_f32_16x16x32_bf16 v[148:151], a[12:15], a[56:59], v[148:151]
    ds_read_b128 a[108:111], v14 offset:6144
    v_mfma_f32_16x16x32_bf16 v[140:143], a[12:15], a[52:55], v[140:143]
    s_add_u32 m0, s26, 4096
    v_mfma_f32_16x16x32_bf16 v[132:135], a[12:15], a[48:51], v[132:135]
    ds_read_b64_tr_b16 a[80:81], v9 offset:49152
    v_mfma_f32_16x16x32_bf16 v[124:127], a[12:15], a[44:47], v[124:127]
    buffer_load_dwordx4 v21, s[8:11], s31 offen offset:0 sc1 lds
    v_mfma_f32_16x16x32_bf16 v[116:119], a[12:15], a[40:43], v[116:119]
    ds_read_b64_tr_b16 a[82:83], v9 offset:50176
    v_mfma_f32_16x16x32_bf16 v[108:111], a[12:15], a[36:39], v[108:111]
    v_mfma_f32_16x16x32_bf16 v[100:103], a[12:15], a[32:35], v[100:103]
    ds_read_b128 a[112:115], v14 offset:8192
    v_mfma_f32_16x16x32_bf16 v[160:163], a[16:19], a[32:35], v[160:163]
    v_mfma_f32_16x16x32_bf16 v[168:171], a[16:19], a[36:39], v[168:171]
    ds_read_b64_tr_b16 a[84:85], v10 offset:49152
    v_mfma_f32_16x16x32_bf16 v[176:179], a[16:19], a[40:43], v[176:179]
    buffer_load_dwordx4 v22, s[8:11], s31 offen offset:1024 sc1 lds
    v_mfma_f32_16x16x32_bf16 v[184:187], a[16:19], a[44:47], v[184:187]
    ds_read_b64_tr_b16 a[86:87], v10 offset:50176
    v_mfma_f32_16x16x32_bf16 v[192:195], a[16:19], a[48:51], v[192:195]
    v_mfma_f32_16x16x32_bf16 v[200:203], a[16:19], a[52:55], v[200:203]
    ds_read_b128 a[116:119], v14 offset:10240
    v_mfma_f32_16x16x32_bf16 v[208:211], a[16:19], a[56:59], v[208:211]
    v_mfma_f32_16x16x32_bf16 v[216:219], a[16:19], a[60:63], v[216:219]
    ds_read_b64_tr_b16 a[88:89], v11 offset:49152
    v_mfma_f32_16x16x32_bf16 v[220:223], a[20:23], a[60:63], v[220:223]
    buffer_load_dwordx4 v23, s[8:11], s31 offen offset:2048 sc1 lds
    v_mfma_f32_16x16x32_bf16 v[212:215], a[20:23], a[56:59], v[212:215]
    ds_read_b64_tr_b16 a[90:91], v11 offset:50176
    v_mfma_f32_16x16x32_bf16 v[204:207], a[20:23], a[52:55], v[204:207]
    v_mfma_f32_16x16x32_bf16 v[196:199], a[20:23], a[48:51], v[196:199]
    ds_read_b128 a[120:123], v14 offset:12288
    v_mfma_f32_16x16x32_bf16 v[188:191], a[20:23], a[44:47], v[188:191]
    v_mfma_f32_16x16x32_bf16 v[180:183], a[20:23], a[40:43], v[180:183]
    ds_read_b64_tr_b16 a[92:93], v12 offset:49152
    v_mfma_f32_16x16x32_bf16 v[172:175], a[20:23], a[36:39], v[172:175]
    buffer_load_dwordx4 v24, s[8:11], s31 offen offset:3072 sc1 lds
    v_mfma_f32_16x16x32_bf16 v[164:167], a[20:23], a[32:35], v[164:167]
    ds_read_b64_tr_b16 a[94:95], v12 offset:50176
    v_mfma_f32_16x16x32_bf16 v[224:227], a[24:27], a[32:35], v[224:227]
    v_mfma_f32_16x16x32_bf16 v[232:235], a[24:27], a[36:39], v[232:235]
    ds_read_b128 a[124:127], v14 offset:14336
    v_mfma_f32_16x16x32_bf16 v[240:243], a[24:27], a[40:43], v[240:243]
    s_add_u32 s25, s25, 128
    s_add_u32 s29, s29, 1
    v_mfma_f32_16x16x32_bf16 v[248:251], a[24:27], a[44:47], v[248:251]
    v_mfma_f32_16x16x32_bf16 a[224:227], a[24:27], a[48:51], a[224:227]
    s_cmp_ge_u32 s29, 16
    s_cselect_b32 s25, 1073741824, s25
    v_mfma_f32_16x16x32_bf16 a[232:235], a[24:27], a[52:55], a[232:235]
    v_mfma_f32_16x16x32_bf16 a[240:243], a[24:27], a[56:59], a[240:243]
    s_add_u32 s26, s26, 32768
    s_cmp_eq_u32 s26, s65
    v_mfma_f32_16x16x32_bf16 a[248:251], a[24:27], a[60:63], a[248:251]
    s_cselect_b32 s26, s64, s26
    v_mfma_f32_16x16x32_bf16 a[252:255], a[28:31], a[60:63], a[252:255]
    v_mfma_f32_16x16x32_bf16 a[244:247], a[28:31], a[56:59], a[244:247]
    buffer_load_dword a203, v4, s[68:71], s74 offen
    v_mfma_f32_16x16x32_bf16 a[236:239], a[28:31], a[52:55], a[236:239]
    s_add_u32 s74, s74, s80
    v_mfma_f32_16x16x32_bf16 a[228:231], a[28:31], a[48:51], a[228:231]
    v_mfma_f32_16x16x32_bf16 v[252:255], a[28:31], a[44:47], v[252:255]
    v_mfma_f32_16x16x32_bf16 v[244:247], a[28:31], a[40:43], v[244:247]
    v_mfma_f32_16x16x32_bf16 v[236:239], a[28:31], a[36:39], v[236:239]
    v_mfma_f32_16x16x32_bf16 v[228:231], a[28:31], a[32:35], v[228:231]
    s_waitcnt vmcnt(19)
    s_waitcnt lgkmcnt(0)
    s_barrier
    v_mfma_f32_16x16x32_bf16 v[32:35], a[64:67], a[96:99], v[32:35]
    s_add_u32 s27, s27, 32768
    s_cmp_eq_u32 s27, 98304
    v_mfma_f32_16x16x32_bf16 v[40:43], a[64:67], a[100:103], v[40:43]
    s_cselect_b32 s27, 0, s27
    v_add_u32 v13, s27, v15
    v_mfma_f32_16x16x32_bf16 v[48:51], a[64:67], a[104:107], v[48:51]
    v_add_u32 v14, s27, v16
    s_add_u32 m0, s30, 49152
    v_mfma_f32_16x16x32_bf16 v[56:59], a[64:67], a[108:111], v[56:59]
    ds_read_b64_tr_b16 a[0:1], v5 offset:0
    v_mfma_f32_16x16x32_bf16 v[64:67], a[64:67], a[112:115], v[64:67]
    buffer_load_dwordx4 v17, s[12:15], s24 offen offset:0 sc1 lds
    v_mfma_f32_16x16x32_bf16 v[72:75], a[64:67], a[116:119], v[72:75]
    ds_read_b64_tr_b16 a[2:3], v5 offset:1024
    v_mfma_f32_16x16x32_bf16 v[80:83], a[64:67], a[120:123], v[80:83]
    v_mfma_f32_16x16x32_bf16 v[88:91], a[64:67], a[124:127], v[88:91]
    ds_read_b128 a[32:35], v13 offset:0
    v_mfma_f32_16x16x32_bf16 v[92:95], a[68:71], a[124:127], v[92:95]
    v_mfma_f32_16x16x32_bf16 v[84:87], a[68:71], a[120:123], v[84:87]
    ds_read_b64_tr_b16 a[4:5], v6 offset:0
    v_mfma_f32_16x16x32_bf16 v[76:79], a[68:71], a[116:119], v[76:79]
    buffer_load_dwordx4 v18, s[12:15], s24 offen offset:1024 sc1 lds
    v_mfma_f32_16x16x32_bf16 v[68:71], a[68:71], a[112:115], v[68:71]
    ds_read_b64_tr_b16 a[6:7], v6 offset:1024
    v_mfma_f32_16x16x32_bf16 v[60:63], a[68:71], a[108:111], v[60:63]
    v_mfma_f32_16x16x32_bf16 v[52:55], a[68:71], a[104:107], v[52:55]
    ds_read_b128 a[36:39], v13 offset:2048
    v_mfma_f32_16x16x32_bf16 v[44:47], a[68:71], a[100:103], v[44:47]
    v_mfma_f32_16x16x32_bf16 v[36:39], a[68:71], a[96:99], v[36:39]
    ds_read_b64_tr_b16 a[8:9], v7 offset:0
    v_mfma_f32_16x16x32_bf16 v[96:99], a[72:75], a[96:99], v[96:99]
    buffer_load_dwordx4 v19, s[12:15], s24 offen offset:2048 sc1 lds
    v_mfma_f32_16x16x32_bf16 v[104:107], a[72:75], a[100:103], v[104:107]
    ds_read_b64_tr_b16 a[10:11], v7 offset:1024
    v_mfma_f32_16x16x32_bf16 v[112:115], a[72:75], a[104:107], v[112:115]
    v_mfma_f32_16x16x32_bf16 v[120:123], a[72:75], a[108:111], v[120:123]
    ds_read_b128 a[40:43], v13 offset:4096
    v_mfma_f32_16x16x32_bf16 v[128:131], a[72:75], a[112:115], v[128:131]
    v_mfma_f32_16x16x32_bf16 v[136:139], a[72:75], a[116:119], v[136:139]
    ds_read_b64_tr_b16 a[12:13], v8 offset:0
    v_mfma_f32_16x16x32_bf16 v[144:147], a[72:75], a[120:123], v[144:147]
    buffer_load_dwordx4 v20, s[12:15], s24 offen offset:3072 sc1 lds
    v_mfma_f32_16x16x32_bf16 v[152:155], a[72:75], a[124:127], v[152:155]
    ds_read_b64_tr_b16 a[14:15], v8 offset:1024
    v_mfma_f32_16x16x32_bf16 v[156:159], a[76:79], a[124:127], v[156:159]
    s_add_u32 s24, s24, 262144
    v_mfma_f32_16x16x32_bf16 v[148:151], a[76:79], a[120:123], v[148:151]
    ds_read_b128 a[44:47], v13 offset:6144
    v_mfma_f32_16x16x32_bf16 v[140:143], a[76:79], a[116:119], v[140:143]
    s_mov_b32 m0, s26
    v_mfma_f32_16x16x32_bf16 v[132:135], a[76:79], a[112:115], v[132:135]
    ds_read_b64_tr_b16 a[16:17], v9 offset:0
    v_mfma_f32_16x16x32_bf16 v[124:127], a[76:79], a[108:111], v[124:127]
    buffer_load_dwordx4 v21, s[8:11], s25 offen offset:0 sc1 lds
    v_mfma_f32_16x16x32_bf16 v[116:119], a[76:79], a[104:107], v[116:119]
    ds_read_b64_tr_b16 a[18:19], v9 offset:1024
    v_mfma_f32_16x16x32_bf16 v[108:111], a[76:79], a[100:103], v[108:111]
    v_mfma_f32_16x16x32_bf16 v[100:103], a[76:79], a[96:99], v[100:103]
    ds_read_b128 a[48:51], v13 offset:8192
    v_mfma_f32_16x16x32_bf16 v[160:163], a[80:83], a[96:99], v[160:163]
    v_mfma_f32_16x16x32_bf16 v[168:171], a[80:83], a[100:103], v[168:171]
    ds_read_b64_tr_b16 a[20:21], v10 offset:0
    v_mfma_f32_16x16x32_bf16 v[176:179], a[80:83], a[104:107], v[176:179]
    buffer_load_dwordx4 v22, s[8:11], s25 offen offset:1024 sc1 lds
    v_mfma_f32_16x16x32_bf16 v[184:187], a[80:83], a[108:111], v[184:187]
    ds_read_b64_tr_b16 a[22:23], v10 offset:1024
    v_mfma_f32_16x16x32_bf16 v[192:195], a[80:83], a[112:115], v[192:195]
    v_mfma_f32_16x16x32_bf16 v[200:203], a[80:83], a[116:119], v[200:203]
    ds_read_b128 a[52:55], v13 offset:10240
    v_mfma_f32_16x16x32_bf16 v[208:211], a[80:83], a[120:123], v[208:211]
    v_mfma_f32_16x16x32_bf16 v[216:219], a[80:83], a[124:127], v[216:219]
    ds_read_b64_tr_b16 a[24:25], v11 offset:0
    v_mfma_f32_16x16x32_bf16 v[220:223], a[84:87], a[124:127], v[220:223]
    buffer_load_dwordx4 v23, s[8:11], s25 offen offset:2048 sc1 lds
    v_mfma_f32_16x16x32_bf16 v[212:215], a[84:87], a[120:123], v[212:215]
    ds_read_b64_tr_b16 a[26:27], v11 offset:1024
    v_mfma_f32_16x16x32_bf16 v[204:207], a[84:87], a[116:119], v[204:207]
    v_mfma_f32_16x16x32_bf16 v[196:199], a[84:87], a[112:115], v[196:199]
    ds_read_b128 a[56:59], v13 offset:12288
    v_mfma_f32_16x16x32_bf16 v[188:191], a[84:87], a[108:111], v[188:191]
    v_mfma_f32_16x16x32_bf16 v[180:183], a[84:87], a[104:107], v[180:183]
    ds_read_b64_tr_b16 a[28:29], v12 offset:0
    v_mfma_f32_16x16x32_bf16 v[172:175], a[84:87], a[100:103], v[172:175]
    buffer_load_dwordx4 v24, s[8:11], s25 offen offset:3072 sc1 lds
    v_mfma_f32_16x16x32_bf16 v[164:167], a[84:87], a[96:99], v[164:167]
    ds_read_b64_tr_b16 a[30:31], v12 offset:1024
    v_mfma_f32_16x16x32_bf16 v[224:227], a[88:91], a[96:99], v[224:227]
    v_mfma_f32_16x16x32_bf16 v[232:235], a[88:91], a[100:103], v[232:235]
    ds_read_b128 a[60:63], v13 offset:14336
    v_mfma_f32_16x16x32_bf16 v[240:243], a[88:91], a[104:107], v[240:243]
    v_mfma_f32_16x16x32_bf16 v[248:251], a[88:91], a[108:111], v[248:251]
    v_mfma_f32_16x16x32_bf16 a[224:227], a[88:91], a[112:115], a[224:227]
    v_mfma_f32_16x16x32_bf16 a[232:235], a[88:91], a[116:119], a[232:235]
    v_mfma_f32_16x16x32_bf16 a[240:243], a[88:91], a[120:123], a[240:243]
    v_mfma_f32_16x16x32_bf16 a[248:251], a[88:91], a[124:127], a[248:251]
    v_mfma_f32_16x16x32_bf16 a[252:255], a[92:95], a[124:127], a[252:255]
    v_mfma_f32_16x16x32_bf16 a[244:247], a[92:95], a[120:123], a[244:247]
    buffer_load_dword a204, v4, s[68:71], s74 offen
    v_mfma_f32_16x16x32_bf16 a[236:239], a[92:95], a[116:119], a[236:239]
    s_add_u32 s74, s74, s80
    v_mfma_f32_16x16x32_bf16 a[228:231], a[92:95], a[112:115], a[228:231]
    s_add_u32 s28, s28, 1
    s_cmp_ge_u32 s28, s83
    v_mfma_f32_16x16x32_bf16 v[252:255], a[92:95], a[108:111], v[252:255]
    s_cselect_b32 s80, s81, 0
    s_cselect_b32 s70, s82, 0
    v_mfma_f32_16x16x32_bf16 v[244:247], a[92:95], a[104:107], v[244:247]
    s_cmp_lt_u32 s28, 7
    v_mfma_f32_16x16x32_bf16 v[236:239], a[92:95], a[100:103], v[236:239]
    v_mfma_f32_16x16x32_bf16 v[228:231], a[92:95], a[96:99], v[228:231]
    s_cbranch_scc1 pj_kloop
pj_kloop_end:
    s_mov_b32 s12, s36
    s_mov_b32 s13, s37
    s_mov_b32 s14, 3670016
    s_mov_b32 s15, 0x20000
    s_mov_b32 s8, s32
    s_mov_b32 s9, s33
    s_mov_b32 s10, 1835008
    s_mov_b32 s11, 0x20000
    s_mov_b32 s24, s66
    s_lshl_b32 s25, s22, 2
    s_add_u32 s25, s25, s20
    s_mul_i32 s25, s25, 28672
    s_waitcnt vmcnt(19)
    s_waitcnt lgkmcnt(0)
    s_barrier
    v_mfma_f32_16x16x32_bf16 v[32:35], a[0:3], a[32:35], v[32:35]
    v_lshrrev_b32 v2, 3, v1
    v_mfma_f32_16x16x32_bf16 v[40:43], a[0:3], a[36:39], v[40:43]
    v_mfma_f32_16x16x32_bf16 v[48:51], a[0:3], a[40:43], v[48:51]
    s_add_u32 m0, s30, 0
    v_and_b32 v3, 6, v2
    v_mfma_f32_16x16x32_bf16 v[56:59], a[0:3], a[44:47], v[56:59]
    ds_read_b64_tr_b16 a[64:65], v5 offset:16384
    v_mfma_f32_16x16x32_bf16 v[64:67], a[0:3], a[48:51], v[64:67]
    buffer_load_dwordx4 v17, s[12:15], s24 offen offset:0 sc1 lds
    v_and_b32 v4, 7, v1
    v_mfma_f32_16x16x32_bf16 v[72:75], a[0:3], a[52:55], v[72:75]
    ds_read_b64_tr_b16 a[66:67], v5 offset:17408
    v_mfma_f32_16x16x32_bf16 v[80:83], a[0:3], a[56:59], v[80:83]
    v_mfma_f32_16x16x32_bf16 v[88:91], a[0:3], a[60:63], v[88:91]
    ds_read_b128 a[96:99], v14 offset:0
    v_xor_b32 v3, v3, v4
    v_mfma_f32_16x16x32_bf16 v[92:95], a[4:7], a[60:63], v[92:95]
    v_mfma_f32_16x16x32_bf16 v[84:87], a[4:7], a[56:59], v[84:87]
    ds_read_b64_tr_b16 a[68:69], v6 offset:16384
    v_lshlrev_b32 v3, 4, v3
    v_mfma_f32_16x16x32_bf16 v[76:79], a[4:7], a[52:55], v[76:79]
    buffer_load_dwordx4 v18, s[12:15], s24 offen offset:1024 sc1 lds
    v_mfma_f32_16x16x32_bf16 v[68:71], a[4:7], a[48:51], v[68:71]
    ds_read_b64_tr_b16 a[70:71], v6 offset:17408
    v_mfma_f32_16x16x32_bf16 v[60:63], a[4:7], a[44:47], v[60:63]
    v_mul_u32_u24 v2, 896, v2
    v_mfma_f32_16x16x32_bf16 v[52:55], a[4:7], a[40:43], v[52:55]
    ds_read_b128 a[100:103], v14 offset:2048
    v_mfma_f32_16x16x32_bf16 v[44:47], a[4:7], a[36:39], v[44:47]
    v_add_u32 v21, v2, v3
    v_mfma_f32_16x16x32_bf16 v[36:39], a[4:7], a[32:35], v[36:39]
    ds_read_b64_tr_b16 a[72:73], v7 offset:16384
    v_mfma_f32_16x16x32_bf16 v[96:99], a[8:11], a[32:35], v[96:99]
    buffer_load_dwordx4 v19, s[12:15], s24 offen offset:2048 sc1 lds
    v_add_u32 v22, 6144, v21
    v_mfma_f32_16x16x32_bf16 v[104:107], a[8:11], a[36:39], v[104:107]
    ds_read_b64_tr_b16 a[74:75], v7 offset:17408
    v_mfma_f32_16x16x32_bf16 v[112:115], a[8:11], a[40:43], v[112:115]
    v_mfma_f32_16x16x32_bf16 v[120:123], a[8:11], a[44:47], v[120:123]
    ds_read_b128 a[104:107], v14 offset:4096
    v_add_u32 v23, 12288, v21
    v_mfma_f32_16x16x32_bf16 v[128:131], a[8:11], a[48:51], v[128:131]
    v_mfma_f32_16x16x32_bf16 v[136:139], a[8:11], a[52:55], v[136:139]
    ds_read_b64_tr_b16 a[76:77], v8 offset:16384
    v_add_u32 v24, 18432, v21
    v_mfma_f32_16x16x32_bf16 v[144:147], a[8:11], a[56:59], v[144:147]
    buffer_load_dwordx4 v20, s[12:15], s24 offen offset:3072 sc1 lds
    v_mfma_f32_16x16x32_bf16 v[152:155], a[8:11], a[60:63], v[152:155]
    ds_read_b64_tr_b16 a[78:79], v8 offset:17408
    v_mfma_f32_16x16x32_bf16 v[156:159], a[12:15], a[60:63], v[156:159]
    s_add_u32 s24, s24, 262144
    v_mfma_f32_16x16x32_bf16 v[148:151], a[12:15], a[56:59], v[148:151]
    ds_read_b128 a[108:111], v14 offset:6144
    v_mfma_f32_16x16x32_bf16 v[140:143], a[12:15], a[52:55], v[140:143]
    s_getpc_b64 s[96:97]
pc_3:
    s_add_u32 s96, s96, pj_kvdone-pc_3
    s_addc_u32 s97, s97, 0
    v_mfma_f32_16x16x32_bf16 v[132:135], a[12:15], a[48:51], v[132:135]
    ds_read_b64_tr_b16 a[80:81], v9 offset:16384
    v_mfma_f32_16x16x32_bf16 v[124:127], a[12:15], a[44:47], v[124:127]
    v_mfma_f32_16x16x32_bf16 v[116:119], a[12:15], a[40:43], v[116:119]
    ds_read_b64_tr_b16 a[82:83], v9 offset:17408
    s_lshr_b32 s98, s2, 3
    v_mfma_f32_16x16x32_bf16 v[108:111], a[12:15], a[36:39], v[108:111]
    v_mfma_f32_16x16x32_bf16 v[100:103], a[12:15], a[32:35], v[100:103]
    ds_read_b128 a[112:115], v14 offset:8192
    v_mfma_f32_16x16x32_bf16 v[160:163], a[16:19], a[32:35], v[160:163]
    v_mfma_f32_16x16x32_bf16 v[168:171], a[16:19], a[36:39], v[168:171]
    ds_read_b64_tr_b16 a[84:85], v10 offset:16384
    s_lshl_b32 s98, s98, 8
    v_mfma_f32_16x16x32_bf16 v[176:179], a[16:19], a[40:43], v[176:179]
    v_mfma_f32_16x16x32_bf16 v[184:187], a[16:19], a[44:47], v[184:187]
    ds_read_b64_tr_b16 a[86:87], v10 offset:17408
    v_mfma_f32_16x16x32_bf16 v[192:195], a[16:19], a[48:51], v[192:195]
    v_mfma_f32_16x16x32_bf16 v[200:203], a[16:19], a[52:55], v[200:203]
    ds_read_b128 a[116:119], v14 offset:10240
    v_add_u32 v2, s98, v0
    v_mfma_f32_16x16x32_bf16 v[208:211], a[16:19], a[56:59], v[208:211]
    v_mfma_f32_16x16x32_bf16 v[216:219], a[16:19], a[60:63], v[216:219]
    ds_read_b64_tr_b16 a[88:89], v11 offset:16384
    v_mfma_f32_16x16x32_bf16 v[220:223], a[20:23], a[60:63], v[220:223]
    v_and_b32 v2, 0x1ff, v2
    v_mfma_f32_16x16x32_bf16 v[212:215], a[20:23], a[56:59], v[212:215]
    ds_read_b64_tr_b16 a[90:91], v11 offset:17408
    v_mfma_f32_16x16x32_bf16 v[204:207], a[20:23], a[52:55], v[204:207]
    v_mfma_f32_16x16x32_bf16 v[196:199], a[20:23], a[48:51], v[196:199]
    ds_read_b128 a[120:123], v14 offset:12288
    v_mfma_f32_16x16x32_bf16 v[188:191], a[20:23], a[44:47], v[188:191]
    v_lshlrev_b32 v2, 7, v2
    v_mfma_f32_16x16x32_bf16 v[180:183], a[20:23], a[40:43], v[180:183]
    ds_read_b64_tr_b16 a[92:93], v12 offset:16384
    v_mfma_f32_16x16x32_bf16 v[172:175], a[20:23], a[36:39], v[172:175]
    v_mfma_f32_16x16x32_bf16 v[164:167], a[20:23], a[32:35], v[164:167]
    ds_read_b64_tr_b16 a[94:95], v12 offset:17408
    v_mfma_f32_16x16x32_bf16 v[224:227], a[24:27], a[32:35], v[224:227]
    v_min_u32 v2, kernel_last-pj_kvdone-4, v2
    v_mfma_f32_16x16x32_bf16 v[232:235], a[24:27], a[36:39], v[232:235]
    ds_read_b128 a[124:127], v14 offset:14336
    v_mfma_f32_16x16x32_bf16 v[240:243], a[24:27], a[40:43], v[240:243]
    v_mfma_f32_16x16x32_bf16 v[248:251], a[24:27], a[44:47], v[248:251]
    v_mov_b32 v3, s97
    v_mfma_f32_16x16x32_bf16 a[224:227], a[24:27], a[48:51], a[224:227]
    v_mfma_f32_16x16x32_bf16 a[232:235], a[24:27], a[52:55], a[232:235]
    v_mfma_f32_16x16x32_bf16 a[240:243], a[24:27], a[56:59], a[240:243]
    v_mfma_f32_16x16x32_bf16 a[248:251], a[24:27], a[60:63], a[248:251]
    v_add_co_u32 v2, vcc, s96, v2
    s_nop 1
    v_addc_co_u32 v3, vcc, 0, v3, vcc
    v_mfma_f32_16x16x32_bf16 a[252:255], a[28:31], a[60:63], a[252:255]
    v_mfma_f32_16x16x32_bf16 a[244:247], a[28:31], a[56:59], a[244:247]
    v_mfma_f32_16x16x32_bf16 a[236:239], a[28:31], a[52:55], a[236:239]
    v_mfma_f32_16x16x32_bf16 a[228:231], a[28:31], a[48:51], a[228:231]
    global_load_dword a206, v[2:3], off
    v_mfma_f32_16x16x32_bf16 v[252:255], a[28:31], a[44:47], v[252:255]
    v_mfma_f32_16x16x32_bf16 v[244:247], a[28:31], a[40:43], v[244:247]
    v_mfma_f32_16x16x32_bf16 v[236:239], a[28:31], a[36:39], v[236:239]
    v_mfma_f32_16x16x32_bf16 v[228:231], a[28:31], a[32:35], v[228:231]
    s_waitcnt vmcnt(15)
    s_waitcnt lgkmcnt(0)
    s_barrier
    v_mfma_f32_16x16x32_bf16 v[32:35], a[64:67], a[96:99], v[32:35]
    s_add_u32 s27, s27, 32768
    s_cmp_eq_u32 s27, 98304
    v_mfma_f32_16x16x32_bf16 v[40:43], a[64:67], a[100:103], v[40:43]
    s_cselect_b32 s27, 0, s27
    v_add_u32 v13, s27, v15
    v_mfma_f32_16x16x32_bf16 v[48:51], a[64:67], a[104:107], v[48:51]
    v_add_u32 v14, s27, v16
    s_add_u32 m0, s30, 16384
    v_mfma_f32_16x16x32_bf16 v[56:59], a[64:67], a[108:111], v[56:59]
    ds_read_b64_tr_b16 a[0:1], v5 offset:32768
    v_mfma_f32_16x16x32_bf16 v[64:67], a[64:67], a[112:115], v[64:67]
    buffer_load_dwordx4 v17, s[12:15], s24 offen offset:0 sc1 lds
    v_mfma_f32_16x16x32_bf16 v[72:75], a[64:67], a[116:119], v[72:75]
    ds_read_b64_tr_b16 a[2:3], v5 offset:33792
    v_mfma_f32_16x16x32_bf16 v[80:83], a[64:67], a[120:123], v[80:83]
    v_mfma_f32_16x16x32_bf16 v[88:91], a[64:67], a[124:127], v[88:91]
    ds_read_b128 a[32:35], v13 offset:0
    v_mfma_f32_16x16x32_bf16 v[92:95], a[68:71], a[124:127], v[92:95]
    v_mfma_f32_16x16x32_bf16 v[84:87], a[68:71], a[120:123], v[84:87]
    ds_read_b64_tr_b16 a[4:5], v6 offset:32768
    v_mfma_f32_16x16x32_bf16 v[76:79], a[68:71], a[116:119], v[76:79]
    buffer_load_dwordx4 v18, s[12:15], s24 offen offset:1024 sc1 lds
    v_mfma_f32_16x16x32_bf16 v[68:71], a[68:71], a[112:115], v[68:71]
    ds_read_b64_tr_b16 a[6:7], v6 offset:33792
    v_mfma_f32_16x16x32_bf16 v[60:63], a[68:71], a[108:111], v[60:63]
    v_mfma_f32_16x16x32_bf16 v[52:55], a[68:71], a[104:107], v[52:55]
    ds_read_b128 a[36:39], v13 offset:2048
    v_mfma_f32_16x16x32_bf16 v[44:47], a[68:71], a[100:103], v[44:47]
    v_mfma_f32_16x16x32_bf16 v[36:39], a[68:71], a[96:99], v[36:39]
    ds_read_b64_tr_b16 a[8:9], v7 offset:32768
    v_mfma_f32_16x16x32_bf16 v[96:99], a[72:75], a[96:99], v[96:99]
    buffer_load_dwordx4 v19, s[12:15], s24 offen offset:2048 sc1 lds
    v_mfma_f32_16x16x32_bf16 v[104:107], a[72:75], a[100:103], v[104:107]
    ds_read_b64_tr_b16 a[10:11], v7 offset:33792
    v_mfma_f32_16x16x32_bf16 v[112:115], a[72:75], a[104:107], v[112:115]
    v_mfma_f32_16x16x32_bf16 v[120:123], a[72:75], a[108:111], v[120:123]
    ds_read_b128 a[40:43], v13 offset:4096
    v_mfma_f32_16x16x32_bf16 v[128:131], a[72:75], a[112:115], v[128:131]
    v_mfma_f32_16x16x32_bf16 v[136:139], a[72:75], a[116:119], v[136:139]
    ds_read_b64_tr_b16 a[12:13], v8 offset:32768
    v_mfma_f32_16x16x32_bf16 v[144:147], a[72:75], a[120:123], v[144:147]
    buffer_load_dwordx4 v20, s[12:15], s24 offen offset:3072 sc1 lds
    v_mfma_f32_16x16x32_bf16 v[152:155], a[72:75], a[124:127], v[152:155]
    ds_read_b64_tr_b16 a[14:15], v8 offset:33792
    v_mfma_f32_16x16x32_bf16 v[156:159], a[76:79], a[124:127], v[156:159]
    s_add_u32 s24, s24, 262144
    v_mfma_f32_16x16x32_bf16 v[148:151], a[76:79], a[120:123], v[148:151]
    ds_read_b128 a[44:47], v13 offset:6144
    v_mfma_f32_16x16x32_bf16 v[140:143], a[76:79], a[116:119], v[140:143]
    s_add_u32 m0, s75, 32768
    v_mfma_f32_16x16x32_bf16 v[132:135], a[76:79], a[112:115], v[132:135]
    ds_read_b64_tr_b16 a[16:17], v9 offset:32768
    buffer_load_dwordx4 v21, s[8:11], s25 offen offset:0 sc1 lds
    v_mfma_f32_16x16x32_bf16 v[124:127], a[76:79], a[108:111], v[124:127]
    v_mfma_f32_16x16x32_bf16 v[116:119], a[76:79], a[104:107], v[116:119]
    ds_read_b64_tr_b16 a[18:19], v9 offset:33792
    v_mfma_f32_16x16x32_bf16 v[108:111], a[76:79], a[100:103], v[108:111]
    v_mfma_f32_16x16x32_bf16 v[100:103], a[76:79], a[96:99], v[100:103]
    ds_read_b128 a[48:51], v13 offset:8192
    buffer_load_dwordx4 v22, s[8:11], s25 offen offset:1024 sc1 lds
    v_mfma_f32_16x16x32_bf16 v[160:163], a[80:83], a[96:99], v[160:163]
    v_mfma_f32_16x16x32_bf16 v[168:171], a[80:83], a[100:103], v[168:171]
    ds_read_b64_tr_b16 a[20:21], v10 offset:32768
    v_mfma_f32_16x16x32_bf16 v[176:179], a[80:83], a[104:107], v[176:179]
    v_mfma_f32_16x16x32_bf16 v[184:187], a[80:83], a[108:111], v[184:187]
    ds_read_b64_tr_b16 a[22:23], v10 offset:33792
    buffer_load_dwordx4 v23, s[8:11], s25 offen offset:2048 sc1 lds
    v_mfma_f32_16x16x32_bf16 v[192:195], a[80:83], a[112:115], v[192:195]
    v_mfma_f32_16x16x32_bf16 v[200:203], a[80:83], a[116:119], v[200:203]
    ds_read_b128 a[52:55], v13 offset:10240
    v_mfma_f32_16x16x32_bf16 v[208:211], a[80:83], a[120:123], v[208:211]
    v_mfma_f32_16x16x32_bf16 v[216:219], a[80:83], a[124:127], v[216:219]
    ds_read_b64_tr_b16 a[24:25], v11 offset:32768
    buffer_load_dwordx4 v24, s[8:11], s25 offen offset:3072 sc1 lds
    v_mfma_f32_16x16x32_bf16 v[220:223], a[84:87], a[124:127], v[220:223]
    v_mfma_f32_16x16x32_bf16 v[212:215], a[84:87], a[120:123], v[212:215]
    ds_read_b64_tr_b16 a[26:27], v11 offset:33792
    v_mfma_f32_16x16x32_bf16 v[204:207], a[84:87], a[116:119], v[204:207]
    v_mfma_f32_16x16x32_bf16 v[196:199], a[84:87], a[112:115], v[196:199]
    ds_read_b128 a[56:59], v13 offset:12288
    s_add_u32 s25, s25, 128
    v_mfma_f32_16x16x32_bf16 v[188:191], a[84:87], a[108:111], v[188:191]
    s_add_u32 m0, s75, 49152
    v_mfma_f32_16x16x32_bf16 v[180:183], a[84:87], a[104:107], v[180:183]
    ds_read_b64_tr_b16 a[28:29], v12 offset:32768
    buffer_load_dwordx4 v21, s[8:11], s25 offen offset:0 sc1 lds
    v_mfma_f32_16x16x32_bf16 v[172:175], a[84:87], a[100:103], v[172:175]
    v_mfma_f32_16x16x32_bf16 v[164:167], a[84:87], a[96:99], v[164:167]
    ds_read_b64_tr_b16 a[30:31], v12 offset:33792
    v_mfma_f32_16x16x32_bf16 v[224:227], a[88:91], a[96:99], v[224:227]
    v_mfma_f32_16x16x32_bf16 v[232:235], a[88:91], a[100:103], v[232:235]
    ds_read_b128 a[60:63], v13 offset:14336
    buffer_load_dwordx4 v22, s[8:11], s25 offen offset:1024 sc1 lds
    v_mfma_f32_16x16x32_bf16 v[240:243], a[88:91], a[104:107], v[240:243]
    v_mfma_f32_16x16x32_bf16 v[248:251], a[88:91], a[108:111], v[248:251]
    v_mfma_f32_16x16x32_bf16 a[224:227], a[88:91], a[112:115], a[224:227]
    v_mfma_f32_16x16x32_bf16 a[232:235], a[88:91], a[116:119], a[232:235]
    buffer_load_dwordx4 v23, s[8:11], s25 offen offset:2048 sc1 lds
    v_mfma_f32_16x16x32_bf16 a[240:243], a[88:91], a[120:123], a[240:243]
    v_mfma_f32_16x16x32_bf16 a[248:251], a[88:91], a[124:127], a[248:251]
    v_mfma_f32_16x16x32_bf16 a[252:255], a[92:95], a[124:127], a[252:255]
    v_mfma_f32_16x16x32_bf16 a[244:247], a[92:95], a[120:123], a[244:247]
    buffer_load_dwordx4 v24, s[8:11], s25 offen offset:3072 sc1 lds
    v_mfma_f32_16x16x32_bf16 a[236:239], a[92:95], a[116:119], a[236:239]
    v_mfma_f32_16x16x32_bf16 a[228:231], a[92:95], a[112:115], a[228:231]
    v_mfma_f32_16x16x32_bf16 v[252:255], a[92:95], a[108:111], v[252:255]
    v_mfma_f32_16x16x32_bf16 v[244:247], a[92:95], a[104:107], v[244:247]
    s_add_u32 s25, s25, 128
    v_mfma_f32_16x16x32_bf16 v[236:239], a[92:95], a[100:103], v[236:239]
    v_mfma_f32_16x16x32_bf16 v[228:231], a[92:95], a[96:99], v[228:231]
    s_waitcnt vmcnt(18)
    s_waitcnt lgkmcnt(0)
    s_barrier
    v_mfma_f32_16x16x32_bf16 v[32:35], a[0:3], a[32:35], v[32:35]
    v_mfma_f32_16x16x32_bf16 v[40:43], a[0:3], a[36:39], v[40:43]
    v_mfma_f32_16x16x32_bf16 v[48:51], a[0:3], a[40:43], v[48:51]
    s_add_u32 m0, s30, 32768
    v_mfma_f32_16x16x32_bf16 v[56:59], a[0:3], a[44:47], v[56:59]
    ds_read_b64_tr_b16 a[64:65], v5 offset:49152
    v_mfma_f32_16x16x32_bf16 v[64:67], a[0:3], a[48:51], v[64:67]
    buffer_load_dwordx4 v17, s[12:15], s24 offen offset:0 sc1 lds
    v_mfma_f32_16x16x32_bf16 v[72:75], a[0:3], a[52:55], v[72:75]
    ds_read_b64_tr_b16 a[66:67], v5 offset:50176
    v_mfma_f32_16x16x32_bf16 v[80:83], a[0:3], a[56:59], v[80:83]
    v_mfma_f32_16x16x32_bf16 v[88:91], a[0:3], a[60:63], v[88:91]
    ds_read_b128 a[96:99], v14 offset:0
    v_mfma_f32_16x16x32_bf16 v[92:95], a[4:7], a[60:63], v[92:95]
    v_mfma_f32_16x16x32_bf16 v[84:87], a[4:7], a[56:59], v[84:87]
    ds_read_b64_tr_b16 a[68:69], v6 offset:49152
    v_mfma_f32_16x16x32_bf16 v[76:79], a[4:7], a[52:55], v[76:79]
    buffer_load_dwordx4 v18, s[12:15], s24 offen offset:1024 sc1 lds
    v_mfma_f32_16x16x32_bf16 v[68:71], a[4:7], a[48:51], v[68:71]
    ds_read_b64_tr_b16 a[70:71], v6 offset:50176
    v_mfma_f32_16x16x32_bf16 v[60:63], a[4:7], a[44:47], v[60:63]
    v_mfma_f32_16x16x32_bf16 v[52:55], a[4:7], a[40:43], v[52:55]
    ds_read_b128 a[100:103], v14 offset:2048
    v_mfma_f32_16x16x32_bf16 v[44:47], a[4:7], a[36:39], v[44:47]
    v_mfma_f32_16x16x32_bf16 v[36:39], a[4:7], a[32:35], v[36:39]
    ds_read_b64_tr_b16 a[72:73], v7 offset:49152
    v_mfma_f32_16x16x32_bf16 v[96:99], a[8:11], a[32:35], v[96:99]
    buffer_load_dwordx4 v19, s[12:15], s24 offen offset:2048 sc1 lds
    v_mfma_f32_16x16x32_bf16 v[104:107], a[8:11], a[36:39], v[104:107]
    ds_read_b64_tr_b16 a[74:75], v7 offset:50176
    v_mfma_f32_16x16x32_bf16 v[112:115], a[8:11], a[40:43], v[112:115]
    v_mfma_f32_16x16x32_bf16 v[120:123], a[8:11], a[44:47], v[120:123]
    ds_read_b128 a[104:107], v14 offset:4096
    v_mfma_f32_16x16x32_bf16 v[128:131], a[8:11], a[48:51], v[128:131]
    v_mfma_f32_16x16x32_bf16 v[136:139], a[8:11], a[52:55], v[136:139]
    ds_read_b64_tr_b16 a[76:77], v8 offset:49152
    v_mfma_f32_16x16x32_bf16 v[144:147], a[8:11], a[56:59], v[144:147]
    buffer_load_dwordx4 v20, s[12:15], s24 offen offset:3072 sc1 lds
    v_mfma_f32_16x16x32_bf16 v[152:155], a[8:11], a[60:63], v[152:155]
    ds_read_b64_tr_b16 a[78:79], v8 offset:50176
    v_mfma_f32_16x16x32_bf16 v[156:159], a[12:15], a[60:63], v[156:159]
    s_add_u32 s24, s24, 262144
    v_mfma_f32_16x16x32_bf16 v[148:151], a[12:15], a[56:59], v[148:151]
    ds_read_b128 a[108:111], v14 offset:6144
    v_mfma_f32_16x16x32_bf16 v[140:143], a[12:15], a[52:55], v[140:143]
    s_add_u32 m0, s75, 0
    v_mfma_f32_16x16x32_bf16 v[132:135], a[12:15], a[48:51], v[132:135]
    ds_read_b64_tr_b16 a[80:81], v9 offset:49152
    buffer_load_dwordx4 v21, s[8:11], s25 offen offset:0 sc1 lds
    v_mfma_f32_16x16x32_bf16 v[124:127], a[12:15], a[44:47], v[124:127]
    v_mfma_f32_16x16x32_bf16 v[116:119], a[12:15], a[40:43], v[116:119]
    ds_read_b64_tr_b16 a[82:83], v9 offset:50176
    v_mfma_f32_16x16x32_bf16 v[108:111], a[12:15], a[36:39], v[108:111]
    v_mfma_f32_16x16x32_bf16 v[100:103], a[12:15], a[32:35], v[100:103]
    ds_read_b128 a[112:115], v14 offset:8192
    buffer_load_dwordx4 v22, s[8:11], s25 offen offset:1024 sc1 lds
    v_mfma_f32_16x16x32_bf16 v[160:163], a[16:19], a[32:35], v[160:163]
    v_mfma_f32_16x16x32_bf16 v[168:171], a[16:19], a[36:39], v[168:171]
    ds_read_b64_tr_b16 a[84:85], v10 offset:49152
    v_mfma_f32_16x16x32_bf16 v[176:179], a[16:19], a[40:43], v[176:179]
    v_mfma_f32_16x16x32_bf16 v[184:187], a[16:19], a[44:47], v[184:187]
    ds_read_b64_tr_b16 a[86:87], v10 offset:50176
    buffer_load_dwordx4 v23, s[8:11], s25 offen offset:2048 sc1 lds
    v_mfma_f32_16x16x32_bf16 v[192:195], a[16:19], a[48:51], v[192:195]
    v_mfma_f32_16x16x32_bf16 v[200:203], a[16:19], a[52:55], v[200:203]
    ds_read_b128 a[116:119], v14 offset:10240
    v_mfma_f32_16x16x32_bf16 v[208:211], a[16:19], a[56:59], v[208:211]
    v_mfma_f32_16x16x32_bf16 v[216:219], a[16:19], a[60:63], v[216:219]
    ds_read_b64_tr_b16 a[88:89], v11 offset:49152
    buffer_load_dwordx4 v24, s[8:11], s25 offen offset:3072 sc1 lds
    v_mfma_f32_16x16x32_bf16 v[220:223], a[20:23], a[60:63], v[220:223]
    v_mfma_f32_16x16x32_bf16 v[212:215], a[20:23], a[56:59], v[212:215]
    ds_read_b64_tr_b16 a[90:91], v11 offset:50176
    v_mfma_f32_16x16x32_bf16 v[204:207], a[20:23], a[52:55], v[204:207]
    v_mfma_f32_16x16x32_bf16 v[196:199], a[20:23], a[48:51], v[196:199]
    ds_read_b128 a[120:123], v14 offset:12288
    s_add_u32 s25, s25, 128
    v_mfma_f32_16x16x32_bf16 v[188:191], a[20:23], a[44:47], v[188:191]
    s_add_u32 m0, s75, 16384
    v_mfma_f32_16x16x32_bf16 v[180:183], a[20:23], a[40:43], v[180:183]
    ds_read_b64_tr_b16 a[92:93], v12 offset:49152
    buffer_load_dwordx4 v21, s[8:11], s25 offen offset:0 sc1 lds
    v_mfma_f32_16x16x32_bf16 v[172:175], a[20:23], a[36:39], v[172:175]
    v_mfma_f32_16x16x32_bf16 v[164:167], a[20:23], a[32:35], v[164:167]
    ds_read_b64_tr_b16 a[94:95], v12 offset:50176
    v_mfma_f32_16x16x32_bf16 v[224:227], a[24:27], a[32:35], v[224:227]
    v_mfma_f32_16x16x32_bf16 v[232:235], a[24:27], a[36:39], v[232:235]
    ds_read_b128 a[124:127], v14 offset:14336
    buffer_load_dwordx4 v22, s[8:11], s25 offen offset:1024 sc1 lds
    v_mfma_f32_16x16x32_bf16 v[240:243], a[24:27], a[40:43], v[240:243]
    v_mfma_f32_16x16x32_bf16 v[248:251], a[24:27], a[44:47], v[248:251]
    v_mfma_f32_16x16x32_bf16 a[224:227], a[24:27], a[48:51], a[224:227]
    v_mfma_f32_16x16x32_bf16 a[232:235], a[24:27], a[52:55], a[232:235]
    buffer_load_dwordx4 v23, s[8:11], s25 offen offset:2048 sc1 lds
    v_mfma_f32_16x16x32_bf16 a[240:243], a[24:27], a[56:59], a[240:243]
    v_mfma_f32_16x16x32_bf16 a[248:251], a[24:27], a[60:63], a[248:251]
    v_mfma_f32_16x16x32_bf16 a[252:255], a[28:31], a[60:63], a[252:255]
    v_mfma_f32_16x16x32_bf16 a[244:247], a[28:31], a[56:59], a[244:247]
    buffer_load_dwordx4 v24, s[8:11], s25 offen offset:3072 sc1 lds
    v_mfma_f32_16x16x32_bf16 a[236:239], a[28:31], a[52:55], a[236:239]
    v_mfma_f32_16x16x32_bf16 a[228:231], a[28:31], a[48:51], a[228:231]
    v_mfma_f32_16x16x32_bf16 v[252:255], a[28:31], a[44:47], v[252:255]
    v_mfma_f32_16x16x32_bf16 v[244:247], a[28:31], a[40:43], v[244:247]
    s_add_u32 s25, s25, 128
    v_mfma_f32_16x16x32_bf16 v[236:239], a[28:31], a[36:39], v[236:239]
    v_mfma_f32_16x16x32_bf16 v[228:231], a[28:31], a[32:35], v[228:231]
    s_waitcnt lgkmcnt(0)
    s_barrier
    v_mfma_f32_16x16x32_bf16 v[32:35], a[64:67], a[96:99], v[32:35]
    s_waitcnt vmcnt(16)
    v_subrev_u32 v5, s67, v5
    v_mfma_f32_16x16x32_bf16 v[40:43], a[64:67], a[100:103], v[40:43]
    v_mfma_f32_16x16x32_bf16 v[48:51], a[64:67], a[104:107], v[48:51]
    s_add_u32 m0, s30, 49152
    ds_read_b128 a[128:131], v30 offset:32768
    v_mfma_f32_16x16x32_bf16 v[56:59], a[64:67], a[108:111], v[56:59]
    v_subrev_u32 v6, s67, v6
    v_mfma_f32_16x16x32_bf16 v[64:67], a[64:67], a[112:115], v[64:67]
    buffer_load_dwordx4 v17, s[12:15], s24 offen offset:0 sc1 lds
    ds_read_b128 a[132:135], v30 offset:34816
    v_mfma_f32_16x16x32_bf16 v[72:75], a[64:67], a[116:119], v[72:75]
    v_subrev_u32 v7, s67, v7
    v_mfma_f32_16x16x32_bf16 v[80:83], a[64:67], a[120:123], v[80:83]
    ds_read_b128 a[136:139], v31 offset:32768
    v_mfma_f32_16x16x32_bf16 v[88:91], a[64:67], a[124:127], v[88:91]
    v_subrev_u32 v8, s67, v8
    v_mfma_f32_16x16x32_bf16 v[92:95], a[68:71], a[124:127], v[92:95]
    ds_read_b128 a[140:143], v31 offset:34816
    v_mfma_f32_16x16x32_bf16 v[84:87], a[68:71], a[120:123], v[84:87]
    v_mfma_f32_16x16x32_bf16 v[76:79], a[68:71], a[116:119], v[76:79]
    buffer_load_dwordx4 v18, s[12:15], s24 offen offset:1024 sc1 lds
    s_waitcnt vmcnt(14)
    v_mfma_f32_16x16x32_bf16 v[68:71], a[68:71], a[112:115], v[68:71]
    v_subrev_u32 v9, s67, v9
    v_mfma_f32_16x16x32_bf16 v[60:63], a[68:71], a[108:111], v[60:63]
    ds_read_b128 a[144:147], v30 offset:49152
    v_subrev_u32 v10, s67, v10
    v_mfma_f32_16x16x32_bf16 v[52:55], a[68:71], a[104:107], v[52:55]
    v_mfma_f32_16x16x32_bf16 v[44:47], a[68:71], a[100:103], v[44:47]
    ds_read_b128 a[148:151], v30 offset:51200
    v_mfma_f32_16x16x32_bf16 v[36:39], a[68:71], a[96:99], v[36:39]
    v_subrev_u32 v11, s67, v11
    v_mfma_f32_16x16x32_bf16 v[96:99], a[72:75], a[96:99], v[96:99]
    buffer_load_dwordx4 v19, s[12:15], s24 offen offset:2048 sc1 lds
    ds_read_b128 a[152:155], v31 offset:49152
    v_mfma_f32_16x16x32_bf16 v[104:107], a[72:75], a[100:103], v[104:107]
    v_subrev_u32 v12, s67, v12
    v_mfma_f32_16x16x32_bf16 v[112:115], a[72:75], a[104:107], v[112:115]
    ds_read_b128 a[156:159], v31 offset:51200
    v_mfma_f32_16x16x32_bf16 v[120:123], a[72:75], a[108:111], v[120:123]
    v_mfma_f32_16x16x32_bf16 v[128:131], a[72:75], a[112:115], v[128:131]
    s_waitcnt lgkmcnt(0)
    v_cvt_pk_bf16_f32 v32, v32, v33
    v_mfma_f32_16x16x32_bf16 v[136:139], a[72:75], a[116:119], v[136:139]
    v_cvt_pk_bf16_f32 v33, v34, v35
    v_cvt_pk_bf16_f32 v34, v36, v37
    v_mfma_f32_16x16x32_bf16 v[144:147], a[72:75], a[120:123], v[144:147]
    buffer_load_dwordx4 v20, s[12:15], s24 offen offset:3072 sc1 lds
    v_cvt_pk_bf16_f32 v35, v38, v39
    v_mfma_f32_16x16x32_bf16 v[152:155], a[72:75], a[124:127], v[152:155]
    v_cvt_pk_bf16_f32 v40, v40, v41
    v_cvt_pk_bf16_f32 v41, v42, v43
    v_mfma_f32_16x16x32_bf16 v[156:159], a[76:79], a[124:127], v[156:159]
    s_add_u32 s24, s24, 262144
    v_cvt_pk_bf16_f32 v42, v44, v45
    v_mfma_f32_16x16x32_bf16 v[148:151], a[76:79], a[120:123], v[148:151]
    v_cvt_pk_bf16_f32 v43, v46, v47
    v_cvt_pk_bf16_f32 v48, v48, v49
    v_mfma_f32_16x16x32_bf16 v[140:143], a[76:79], a[116:119], v[140:143]
    s_add_u32 m0, s75, 32768
    v_cvt_pk_bf16_f32 v49, v50, v51
    v_mfma_f32_16x16x32_bf16 v[132:135], a[76:79], a[112:115], v[132:135]
    buffer_load_dwordx4 v21, s[8:11], s25 offen offset:0 sc1 lds
    v_cvt_pk_bf16_f32 v50, v52, v53
    v_mfma_f32_16x16x32_bf16 v[124:127], a[76:79], a[108:111], v[124:127]
    v_cvt_pk_bf16_f32 v51, v54, v55
    v_cvt_pk_bf16_f32 v56, v56, v57
    v_mfma_f32_16x16x32_bf16 v[116:119], a[76:79], a[104:107], v[116:119]
    v_cvt_pk_bf16_f32 v57, v58, v59
    v_cvt_pk_bf16_f32 v58, v60, v61
    v_mfma_f32_16x16x32_bf16 v[108:111], a[76:79], a[100:103], v[108:111]
    v_cvt_pk_bf16_f32 v59, v62, v63
    v_cvt_pk_bf16_f32 v64, v64, v65
    v_mfma_f32_16x16x32_bf16 v[100:103], a[76:79], a[96:99], v[100:103]
    buffer_load_dwordx4 v22, s[8:11], s25 offen offset:1024 sc1 lds
    v_cvt_pk_bf16_f32 v65, v66, v67
    v_mfma_f32_16x16x32_bf16 v[160:163], a[80:83], a[96:99], v[160:163]
    v_cvt_pk_bf16_f32 v66, v68, v69
    v_cvt_pk_bf16_f32 v67, v70, v71
    v_mfma_f32_16x16x32_bf16 v[168:171], a[80:83], a[100:103], v[168:171]
    v_cvt_pk_bf16_f32 v72, v72, v73
    v_cvt_pk_bf16_f32 v73, v74, v75
    v_mfma_f32_16x16x32_bf16 v[176:179], a[80:83], a[104:107], v[176:179]
    v_cvt_pk_bf16_f32 v74, v76, v77
    v_cvt_pk_bf16_f32 v75, v78, v79
    v_mfma_f32_16x16x32_bf16 v[184:187], a[80:83], a[108:111], v[184:187]
    buffer_load_dwordx4 v23, s[8:11], s25 offen offset:2048 sc1 lds
    v_cvt_pk_bf16_f32 v80, v80, v81
    v_cvt_pk_bf16_f32 v81, v82, v83
    v_cvt_pk_bf16_f32 v82, v84, v85
    v_cvt_pk_bf16_f32 v83, v86, v87
    v_cvt_pk_bf16_f32 v88, v88, v89
    v_cvt_pk_bf16_f32 v89, v90, v91
    v_cvt_pk_bf16_f32 v90, v92, v93
    v_cvt_pk_bf16_f32 v91, v94, v95
    v_mfma_f32_16x16x32_bf16 v[192:195], a[80:83], a[112:115], v[192:195]
    v_cvt_pk_bf16_f32 v96, v96, v97
    v_cvt_pk_bf16_f32 v97, v98, v99
    v_mfma_f32_16x16x32_bf16 v[200:203], a[80:83], a[116:119], v[200:203]
    v_cvt_pk_bf16_f32 v98, v100, v101
    v_cvt_pk_bf16_f32 v99, v102, v103
    v_mfma_f32_16x16x32_bf16 v[208:211], a[80:83], a[120:123], v[208:211]
    v_cvt_pk_bf16_f32 v104, v104, v105
    v_cvt_pk_bf16_f32 v105, v106, v107
    v_mfma_f32_16x16x32_bf16 v[216:219], a[80:83], a[124:127], v[216:219]
    buffer_load_dwordx4 v24, s[8:11], s25 offen offset:3072 sc1 lds
    v_cvt_pk_bf16_f32 v106, v108, v109
    v_mfma_f32_16x16x32_bf16 v[220:223], a[84:87], a[124:127], v[220:223]
    v_cvt_pk_bf16_f32 v107, v110, v111
    v_cvt_pk_bf16_f32 v112, v112, v113
    v_mfma_f32_16x16x32_bf16 v[212:215], a[84:87], a[120:123], v[212:215]
    v_cvt_pk_bf16_f32 v113, v114, v115
    v_cvt_pk_bf16_f32 v114, v116, v117
    v_mfma_f32_16x16x32_bf16 v[204:207], a[84:87], a[116:119], v[204:207]
    v_cvt_pk_bf16_f32 v115, v118, v119
    v_cvt_pk_bf16_f32 v120, v120, v121
    v_mfma_f32_16x16x32_bf16 v[196:199], a[84:87], a[112:115], v[196:199]
    s_add_u32 s25, s25, 128
    v_cvt_pk_bf16_f32 v121, v122, v123
    v_mfma_f32_16x16x32_bf16 v[188:191], a[84:87], a[108:111], v[188:191]
    s_add_u32 m0, s75, 49152
    v_cvt_pk_bf16_f32 v122, v124, v125
    v_mfma_f32_16x16x32_bf16 v[180:183], a[84:87], a[104:107], v[180:183]
    buffer_load_dwordx4 v21, s[8:11], s25 offen offset:0 sc1 lds
    v_cvt_pk_bf16_f32 v123, v126, v127
    v_mfma_f32_16x16x32_bf16 v[172:175], a[84:87], a[100:103], v[172:175]
    v_cvt_pk_bf16_f32 v128, v128, v129
    v_cvt_pk_bf16_f32 v129, v130, v131
    v_mfma_f32_16x16x32_bf16 v[164:167], a[84:87], a[96:99], v[164:167]
    v_cvt_pk_bf16_f32 v130, v132, v133
    v_cvt_pk_bf16_f32 v131, v134, v135
    v_mfma_f32_16x16x32_bf16 v[224:227], a[88:91], a[96:99], v[224:227]
    v_cvt_pk_bf16_f32 v136, v136, v137
    v_cvt_pk_bf16_f32 v137, v138, v139
    v_mfma_f32_16x16x32_bf16 v[232:235], a[88:91], a[100:103], v[232:235]
    buffer_load_dwordx4 v22, s[8:11], s25 offen offset:1024 sc1 lds
    v_cvt_pk_bf16_f32 v138, v140, v141
    v_mfma_f32_16x16x32_bf16 v[240:243], a[88:91], a[104:107], v[240:243]
    v_cvt_pk_bf16_f32 v139, v142, v143
    v_cvt_pk_bf16_f32 v144, v144, v145
    v_mfma_f32_16x16x32_bf16 v[248:251], a[88:91], a[108:111], v[248:251]
    v_cvt_pk_bf16_f32 v145, v146, v147
    v_cvt_pk_bf16_f32 v146, v148, v149
    v_cvt_pk_bf16_f32 v147, v150, v151
    v_cvt_pk_bf16_f32 v152, v152, v153
    v_cvt_pk_bf16_f32 v153, v154, v155
    v_cvt_pk_bf16_f32 v154, v156, v157
    v_cvt_pk_bf16_f32 v155, v158, v159
    v_mfma_f32_16x16x32_bf16 a[224:227], a[88:91], a[112:115], a[224:227]
    v_cvt_pk_bf16_f32 v160, v160, v161
    v_cvt_pk_bf16_f32 v161, v162, v163
    v_mfma_f32_16x16x32_bf16 a[232:235], a[88:91], a[116:119], a[232:235]
    buffer_load_dwordx4 v23, s[8:11], s25 offen offset:2048 sc1 lds
    v_cvt_pk_bf16_f32 v162, v164, v165
    v_mfma_f32_16x16x32_bf16 a[240:243], a[88:91], a[120:123], a[240:243]
    v_cvt_pk_bf16_f32 v163, v166, v167
    v_cvt_pk_bf16_f32 v168, v168, v169
    v_mfma_f32_16x16x32_bf16 a[248:251], a[88:91], a[124:127], a[248:251]
    v_cvt_pk_bf16_f32 v169, v170, v171
    v_cvt_pk_bf16_f32 v170, v172, v173
    v_mfma_f32_16x16x32_bf16 a[252:255], a[92:95], a[124:127], a[252:255]
    v_cvt_pk_bf16_f32 v171, v174, v175
    v_cvt_pk_bf16_f32 v176, v176, v177
    v_mfma_f32_16x16x32_bf16 a[244:247], a[92:95], a[120:123], a[244:247]
    buffer_load_dwordx4 v24, s[8:11], s25 offen offset:3072 sc1 lds
    v_cvt_pk_bf16_f32 v177, v178, v179
    v_mfma_f32_16x16x32_bf16 a[236:239], a[92:95], a[116:119], a[236:239]
    v_cvt_pk_bf16_f32 v178, v180, v181
    v_cvt_pk_bf16_f32 v179, v182, v183
    v_mfma_f32_16x16x32_bf16 a[228:231], a[92:95], a[112:115], a[228:231]
    v_cvt_pk_bf16_f32 v184, v184, v185
    v_cvt_pk_bf16_f32 v185, v186, v187
    v_mfma_f32_16x16x32_bf16 v[252:255], a[92:95], a[108:111], v[252:255]
    v_cvt_pk_bf16_f32 v186, v188, v189
    v_cvt_pk_bf16_f32 v187, v190, v191
    v_mfma_f32_16x16x32_bf16 v[244:247], a[92:95], a[104:107], v[244:247]
    s_add_u32 s25, s25, 128
    v_cvt_pk_bf16_f32 v192, v192, v193
    v_mfma_f32_16x16x32_bf16 v[236:239], a[92:95], a[100:103], v[236:239]
    v_cvt_pk_bf16_f32 v193, v194, v195
    v_cvt_pk_bf16_f32 v194, v196, v197
    v_mfma_f32_16x16x32_bf16 v[228:231], a[92:95], a[96:99], v[228:231]
    v_cvt_pk_bf16_f32 v195, v198, v199
    v_cvt_pk_bf16_f32 v200, v200, v201
    v_cvt_pk_bf16_f32 v201, v202, v203
    v_cvt_pk_bf16_f32 v202, v204, v205
    v_cvt_pk_bf16_f32 v203, v206, v207
    v_cvt_pk_bf16_f32 v208, v208, v209
    v_cvt_pk_bf16_f32 v209, v210, v211
    v_cvt_pk_bf16_f32 v210, v212, v213
    v_cvt_pk_bf16_f32 v211, v214, v215
    v_cvt_pk_bf16_f32 v216, v216, v217
    v_cvt_pk_bf16_f32 v217, v218, v219
    v_cvt_pk_bf16_f32 v218, v220, v221
    v_cvt_pk_bf16_f32 v219, v222, v223
    s_lshr_b32 s3, s20, 1
    s_lshl_b32 s3, s3, 17
    s_and_b32 s29, s20, 1
    s_lshl_b32 s29, s29, 12
    s_add_u32 s3, s3, s29
    s_lshl_b32 s29, s21, 21
    s_add_u32 s3, s3, s29
    s_and_b32 s29, s22, 7
    s_lshl_b32 s29, s29, 18
    s_add_u32 s64, s3, s29
    s_mov_b32 s65, 1024
    s_mov_b32 s26, 8192
    s_mov_b32 s27, 24576
    s_barrier
    ds_read_b64_tr_b16 a[0:1], v5 offset:0
    ds_read_b64_tr_b16 a[2:3], v5 offset:1024
    ds_read_b64_tr_b16 a[4:5], v6 offset:0
    ds_read_b64_tr_b16 a[6:7], v6 offset:1024
    ds_read_b64_tr_b16 a[8:9], v7 offset:0
    ds_read_b64_tr_b16 a[10:11], v7 offset:1024
    ds_read_b64_tr_b16 a[12:13], v8 offset:0
    ds_read_b64_tr_b16 a[14:15], v8 offset:1024
    v_cvt_pk_bf16_f32 v224, v224, v225
    v_cvt_pk_bf16_f32 v225, v226, v227
    v_cvt_pk_bf16_f32 v226, v228, v229
    v_cvt_pk_bf16_f32 v227, v230, v231
    v_cvt_pk_bf16_f32 v232, v232, v233
    v_cvt_pk_bf16_f32 v233, v234, v235
    v_cvt_pk_bf16_f32 v234, v236, v237
    v_cvt_pk_bf16_f32 v235, v238, v239
    v_cvt_pk_bf16_f32 v240, v240, v241
    v_cvt_pk_bf16_f32 v241, v242, v243
    v_cvt_pk_bf16_f32 v242, v244, v245
    v_cvt_pk_bf16_f32 v243, v246, v247
    v_cvt_pk_bf16_f32 v248, v248, v249
    v_cvt_pk_bf16_f32 v249, v250, v251
    v_cvt_pk_bf16_f32 v250, v252, v253
    v_cvt_pk_bf16_f32 v251, v254, v255
    v_accvgpr_read_b32 v196, a224
    v_accvgpr_read_b32 v197, a225
    v_accvgpr_read_b32 v198, a226
    v_accvgpr_read_b32 v199, a227
    v_accvgpr_read_b32 v204, a228
    v_accvgpr_read_b32 v205, a229
    v_accvgpr_read_b32 v206, a230
    v_accvgpr_read_b32 v207, a231
    v_cvt_pk_bf16_f32 v196, v196, v197
    v_cvt_pk_bf16_f32 v197, v198, v199
    v_cvt_pk_bf16_f32 v198, v204, v205
    v_cvt_pk_bf16_f32 v199, v206, v207
    v_accvgpr_read_b32 v212, a232
    v_accvgpr_read_b32 v213, a233
    v_accvgpr_read_b32 v214, a234
    v_accvgpr_read_b32 v215, a235
    v_accvgpr_read_b32 v220, a236
    v_accvgpr_read_b32 v221, a237
    v_accvgpr_read_b32 v222, a238
    v_accvgpr_read_b32 v223, a239
    v_cvt_pk_bf16_f32 v212, v212, v213
    v_cvt_pk_bf16_f32 v213, v214, v215
    v_cvt_pk_bf16_f32 v214, v220, v221
    v_cvt_pk_bf16_f32 v215, v222, v223
    v_accvgpr_read_b32 v228, a240
    v_accvgpr_read_b32 v229, a241
    v_accvgpr_read_b32 v230, a242
    v_accvgpr_read_b32 v231, a243
    v_accvgpr_read_b32 v236, a244
    v_accvgpr_read_b32 v237, a245
    v_accvgpr_read_b32 v238, a246
    v_accvgpr_read_b32 v239, a247
    v_cvt_pk_bf16_f32 v228, v228, v229
    v_cvt_pk_bf16_f32 v229, v230, v231
    v_cvt_pk_bf16_f32 v230, v236, v237
    v_cvt_pk_bf16_f32 v231, v238, v239
    v_accvgpr_read_b32 v244, a248
    v_accvgpr_read_b32 v245, a249
    v_accvgpr_read_b32 v246, a250
    v_accvgpr_read_b32 v247, a251
    v_accvgpr_read_b32 v252, a252
    v_accvgpr_read_b32 v253, a253
    v_accvgpr_read_b32 v254, a254
    v_accvgpr_read_b32 v255, a255
    v_cvt_pk_bf16_f32 v244, v244, v245
    v_cvt_pk_bf16_f32 v245, v246, v247
    v_cvt_pk_bf16_f32 v246, v252, v253
    v_cvt_pk_bf16_f32 v247, v254, v255
    s_add_u32 s3, s64, 68608
    buffer_store_dwordx4 v[196:199], v25, s[4:7], s3 offen sc1
    s_add_u32 s3, s64, 76800
    buffer_store_dwordx4 v[212:215], v25, s[4:7], s3 offen sc1
    s_add_u32 s3, s64, 101376
    buffer_store_dwordx4 v[228:231], v25, s[4:7], s3 offen sc1
    s_add_u32 s3, s64, 109568
    buffer_store_dwordx4 v[244:247], v25, s[4:7], s3 offen sc1
    s_branch pj_kvdone
pj_vloop0:
    s_waitcnt vmcnt(8)
    s_waitcnt lgkmcnt(0)
    s_barrier
    v_mfma_f32_16x16x32_bf16 v[32:35], a[32:35], a[0:3], 0
    s_add_u32 m0, s30, 49152
    v_mfma_f32_16x16x32_bf16 v[40:43], a[32:35], a[4:7], 0
    v_mfma_f32_16x16x32_bf16 v[48:51], a[32:35], a[8:11], 0
    buffer_load_dwordx4 v17, s[12:15], s24 offen offset:0 sc1 lds
    v_mfma_f32_16x16x32_bf16 v[56:59], a[32:35], a[12:15], 0
    ds_read_b64_tr_b16 a[64:65], v5 offset:16384
    v_mfma_f32_16x16x32_bf16 v[64:67], a[32:35], a[16:19], 0
    buffer_load_dwordx4 v18, s[12:15], s24 offen offset:1024 sc1 lds
    v_mfma_f32_16x16x32_bf16 v[72:75], a[32:35], a[20:23], 0
    ds_read_b64_tr_b16 a[66:67], v5 offset:17408
    v_mfma_f32_16x16x32_bf16 v[80:83], a[32:35], a[24:27], 0
    buffer_load_dwordx4 v19, s[12:15], s24 offen offset:2048 sc1 lds
    v_mfma_f32_16x16x32_bf16 v[88:91], a[32:35], a[28:31], 0
    ds_read_b128 a[96:99], v14 offset:0
    v_mfma_f32_16x16x32_bf16 v[92:95], a[36:39], a[28:31], 0
    buffer_load_dwordx4 v20, s[12:15], s24 offen offset:3072 sc1 lds
    v_mfma_f32_16x16x32_bf16 v[84:87], a[36:39], a[24:27], 0
    ds_read_b64_tr_b16 a[68:69], v6 offset:16384
    v_mfma_f32_16x16x32_bf16 v[76:79], a[36:39], a[20:23], 0
    s_add_u32 s24, s24, 262144
    v_mfma_f32_16x16x32_bf16 v[68:71], a[36:39], a[16:19], 0
    ds_read_b64_tr_b16 a[70:71], v6 offset:17408
    v_mfma_f32_16x16x32_bf16 v[60:63], a[36:39], a[12:15], 0
    s_mov_b32 m0, s26
    v_mfma_f32_16x16x32_bf16 v[52:55], a[36:39], a[8:11], 0
    ds_read_b128 a[100:103], v14 offset:2048
    v_mfma_f32_16x16x32_bf16 v[44:47], a[36:39], a[4:7], 0
    buffer_load_dwordx4 v21, s[8:11], s25 offen offset:0 sc1 lds
    v_mfma_f32_16x16x32_bf16 v[36:39], a[36:39], a[0:3], 0
    ds_read_b64_tr_b16 a[72:73], v7 offset:16384
    v_mfma_f32_16x16x32_bf16 v[96:99], a[40:43], a[0:3], 0
    v_mfma_f32_16x16x32_bf16 v[104:107], a[40:43], a[4:7], 0
    ds_read_b64_tr_b16 a[74:75], v7 offset:17408
    buffer_load_dwordx4 v22, s[8:11], s25 offen offset:1024 sc1 lds
    v_mfma_f32_16x16x32_bf16 v[112:115], a[40:43], a[8:11], 0
    v_mfma_f32_16x16x32_bf16 v[120:123], a[40:43], a[12:15], 0
    ds_read_b128 a[104:107], v14 offset:4096
    buffer_load_dwordx4 v23, s[8:11], s25 offen offset:2048 sc1 lds
    v_mfma_f32_16x16x32_bf16 v[128:131], a[40:43], a[16:19], 0
    v_mfma_f32_16x16x32_bf16 v[136:139], a[40:43], a[20:23], 0
    ds_read_b64_tr_b16 a[76:77], v8 offset:16384
    buffer_load_dwordx4 v24, s[8:11], s25 offen offset:3072 sc1 lds
    v_mfma_f32_16x16x32_bf16 v[144:147], a[40:43], a[24:27], 0
    v_mfma_f32_16x16x32_bf16 v[152:155], a[40:43], a[28:31], 0
    ds_read_b64_tr_b16 a[78:79], v8 offset:17408
    s_mov_b32 m0, s30
    v_mfma_f32_16x16x32_bf16 v[156:159], a[44:47], a[28:31], 0
    v_mfma_f32_16x16x32_bf16 v[148:151], a[44:47], a[24:27], 0
    ds_read_b128 a[108:111], v14 offset:6144
    buffer_load_dwordx4 v17, s[12:15], s24 offen offset:0 sc1 lds
    v_mfma_f32_16x16x32_bf16 v[140:143], a[44:47], a[20:23], 0
    v_mfma_f32_16x16x32_bf16 v[132:135], a[44:47], a[16:19], 0
    ds_read_b64_tr_b16 a[80:81], v9 offset:16384
    buffer_load_dwordx4 v18, s[12:15], s24 offen offset:1024 sc1 lds
    v_mfma_f32_16x16x32_bf16 v[124:127], a[44:47], a[12:15], 0
    v_mfma_f32_16x16x32_bf16 v[116:119], a[44:47], a[8:11], 0
    ds_read_b64_tr_b16 a[82:83], v9 offset:17408
    buffer_load_dwordx4 v19, s[12:15], s24 offen offset:2048 sc1 lds
    v_mfma_f32_16x16x32_bf16 v[108:111], a[44:47], a[4:7], 0
    v_mfma_f32_16x16x32_bf16 v[100:103], a[44:47], a[0:3], 0
    ds_read_b128 a[112:115], v14 offset:8192
    buffer_load_dwordx4 v20, s[12:15], s24 offen offset:3072 sc1 lds
    v_mfma_f32_16x16x32_bf16 v[160:163], a[48:51], a[0:3], 0
    v_mfma_f32_16x16x32_bf16 v[168:171], a[48:51], a[4:7], 0
    ds_read_b64_tr_b16 a[84:85], v10 offset:16384
    v_mfma_f32_16x16x32_bf16 v[176:179], a[48:51], a[8:11], 0
    s_add_u32 s24, s24, 262144
    v_mfma_f32_16x16x32_bf16 v[184:187], a[48:51], a[12:15], 0
    ds_read_b64_tr_b16 a[86:87], v10 offset:17408
    v_mfma_f32_16x16x32_bf16 v[192:195], a[48:51], a[16:19], 0
    s_add_u32 s31, s25, 65536
    v_mfma_f32_16x16x32_bf16 v[200:203], a[48:51], a[20:23], 0
    ds_read_b128 a[116:119], v14 offset:10240
    v_mfma_f32_16x16x32_bf16 v[208:211], a[48:51], a[24:27], 0
    s_add_u32 m0, s26, 4096
    v_mfma_f32_16x16x32_bf16 v[216:219], a[48:51], a[28:31], 0
    ds_read_b64_tr_b16 a[88:89], v11 offset:16384
    v_mfma_f32_16x16x32_bf16 v[220:223], a[52:55], a[28:31], 0
    buffer_load_dwordx4 v21, s[8:11], s31 offen offset:0 sc1 lds
    v_mfma_f32_16x16x32_bf16 v[212:215], a[52:55], a[24:27], 0
    ds_read_b64_tr_b16 a[90:91], v11 offset:17408
    v_mfma_f32_16x16x32_bf16 v[204:207], a[52:55], a[20:23], 0
    buffer_load_dwordx4 v22, s[8:11], s31 offen offset:1024 sc1 lds
    v_mfma_f32_16x16x32_bf16 v[196:199], a[52:55], a[16:19], 0
    ds_read_b128 a[120:123], v14 offset:12288
    v_mfma_f32_16x16x32_bf16 v[188:191], a[52:55], a[12:15], 0
    buffer_load_dwordx4 v23, s[8:11], s31 offen offset:2048 sc1 lds
    v_mfma_f32_16x16x32_bf16 v[180:183], a[52:55], a[8:11], 0
    ds_read_b64_tr_b16 a[92:93], v12 offset:16384
    v_mfma_f32_16x16x32_bf16 v[172:175], a[52:55], a[4:7], 0
    buffer_load_dwordx4 v24, s[8:11], s31 offen offset:3072 sc1 lds
    v_mfma_f32_16x16x32_bf16 v[164:167], a[52:55], a[0:3], 0
    ds_read_b64_tr_b16 a[94:95], v12 offset:17408
    v_mfma_f32_16x16x32_bf16 v[224:227], a[56:59], a[0:3], 0
    v_mfma_f32_16x16x32_bf16 v[232:235], a[56:59], a[4:7], 0
    ds_read_b128 a[124:127], v14 offset:14336
    v_mfma_f32_16x16x32_bf16 v[240:243], a[56:59], a[8:11], 0
    s_add_u32 s25, s25, 128
    s_add_u32 s29, s29, 1
    v_mfma_f32_16x16x32_bf16 v[248:251], a[56:59], a[12:15], 0
    v_mfma_f32_16x16x32_bf16 a[224:227], a[56:59], a[16:19], 0
    s_cmp_ge_u32 s29, 16
    s_cselect_b32 s25, 1073741824, s25
    v_mfma_f32_16x16x32_bf16 a[232:235], a[56:59], a[20:23], 0
    v_mfma_f32_16x16x32_bf16 a[240:243], a[56:59], a[24:27], 0
    s_add_u32 s26, s26, 32768
    s_cmp_eq_u32 s26, s65
    v_mfma_f32_16x16x32_bf16 a[248:251], a[56:59], a[28:31], 0
    s_cselect_b32 s26, s64, s26
    v_mfma_f32_16x16x32_bf16 a[252:255], a[60:63], a[28:31], 0
    v_mfma_f32_16x16x32_bf16 a[244:247], a[60:63], a[24:27], 0
    buffer_load_dword a201, v4, s[68:71], s74 offen
    v_mfma_f32_16x16x32_bf16 a[236:239], a[60:63], a[20:23], 0
    s_add_u32 s74, s74, s80
    v_mfma_f32_16x16x32_bf16 a[228:231], a[60:63], a[16:19], 0
    v_mfma_f32_16x16x32_bf16 v[252:255], a[60:63], a[12:15], 0
    v_mfma_f32_16x16x32_bf16 v[244:247], a[60:63], a[8:11], 0
    v_mfma_f32_16x16x32_bf16 v[236:239], a[60:63], a[4:7], 0
    v_mfma_f32_16x16x32_bf16 v[228:231], a[60:63], a[0:3], 0
    s_waitcnt vmcnt(17)
    s_waitcnt lgkmcnt(0)
    s_barrier
    v_mfma_f32_16x16x32_bf16 v[32:35], a[96:99], a[64:67], v[32:35]
    s_add_u32 s27, s27, 32768
    s_cmp_eq_u32 s27, 98304
    v_mfma_f32_16x16x32_bf16 v[40:43], a[96:99], a[68:71], v[40:43]
    s_cselect_b32 s27, 0, s27
    v_add_u32 v13, s27, v15
    v_mfma_f32_16x16x32_bf16 v[48:51], a[96:99], a[72:75], v[48:51]
    v_add_u32 v14, s27, v16
    s_add_u32 m0, s30, 16384
    v_mfma_f32_16x16x32_bf16 v[56:59], a[96:99], a[76:79], v[56:59]
    ds_read_b64_tr_b16 a[0:1], v5 offset:32768
    v_mfma_f32_16x16x32_bf16 v[64:67], a[96:99], a[80:83], v[64:67]
    buffer_load_dwordx4 v17, s[12:15], s24 offen offset:0 sc1 lds
    v_mfma_f32_16x16x32_bf16 v[72:75], a[96:99], a[84:87], v[72:75]
    ds_read_b64_tr_b16 a[2:3], v5 offset:33792
    v_mfma_f32_16x16x32_bf16 v[80:83], a[96:99], a[88:91], v[80:83]
    v_mfma_f32_16x16x32_bf16 v[88:91], a[96:99], a[92:95], v[88:91]
    ds_read_b128 a[32:35], v13 offset:0
    v_mfma_f32_16x16x32_bf16 v[92:95], a[100:103], a[92:95], v[92:95]
    v_mfma_f32_16x16x32_bf16 v[84:87], a[100:103], a[88:91], v[84:87]
    ds_read_b64_tr_b16 a[4:5], v6 offset:32768
    v_mfma_f32_16x16x32_bf16 v[76:79], a[100:103], a[84:87], v[76:79]
    buffer_load_dwordx4 v18, s[12:15], s24 offen offset:1024 sc1 lds
    v_mfma_f32_16x16x32_bf16 v[68:71], a[100:103], a[80:83], v[68:71]
    ds_read_b64_tr_b16 a[6:7], v6 offset:33792
    v_mfma_f32_16x16x32_bf16 v[60:63], a[100:103], a[76:79], v[60:63]
    v_mfma_f32_16x16x32_bf16 v[52:55], a[100:103], a[72:75], v[52:55]
    ds_read_b128 a[36:39], v13 offset:2048
    v_mfma_f32_16x16x32_bf16 v[44:47], a[100:103], a[68:71], v[44:47]
    v_mfma_f32_16x16x32_bf16 v[36:39], a[100:103], a[64:67], v[36:39]
    ds_read_b64_tr_b16 a[8:9], v7 offset:32768
    v_mfma_f32_16x16x32_bf16 v[96:99], a[104:107], a[64:67], v[96:99]
    buffer_load_dwordx4 v19, s[12:15], s24 offen offset:2048 sc1 lds
    v_mfma_f32_16x16x32_bf16 v[104:107], a[104:107], a[68:71], v[104:107]
    ds_read_b64_tr_b16 a[10:11], v7 offset:33792
    v_mfma_f32_16x16x32_bf16 v[112:115], a[104:107], a[72:75], v[112:115]
    v_mfma_f32_16x16x32_bf16 v[120:123], a[104:107], a[76:79], v[120:123]
    ds_read_b128 a[40:43], v13 offset:4096
    v_mfma_f32_16x16x32_bf16 v[128:131], a[104:107], a[80:83], v[128:131]
    v_mfma_f32_16x16x32_bf16 v[136:139], a[104:107], a[84:87], v[136:139]
    ds_read_b64_tr_b16 a[12:13], v8 offset:32768
    v_mfma_f32_16x16x32_bf16 v[144:147], a[104:107], a[88:91], v[144:147]
    buffer_load_dwordx4 v20, s[12:15], s24 offen offset:3072 sc1 lds
    v_mfma_f32_16x16x32_bf16 v[152:155], a[104:107], a[92:95], v[152:155]
    ds_read_b64_tr_b16 a[14:15], v8 offset:33792
    v_mfma_f32_16x16x32_bf16 v[156:159], a[108:111], a[92:95], v[156:159]
    s_add_u32 s24, s24, 262144
    v_mfma_f32_16x16x32_bf16 v[148:151], a[108:111], a[88:91], v[148:151]
    ds_read_b128 a[44:47], v13 offset:6144
    v_mfma_f32_16x16x32_bf16 v[140:143], a[108:111], a[84:87], v[140:143]
    s_mov_b32 m0, s26
    v_mfma_f32_16x16x32_bf16 v[132:135], a[108:111], a[80:83], v[132:135]
    ds_read_b64_tr_b16 a[16:17], v9 offset:32768
    v_mfma_f32_16x16x32_bf16 v[124:127], a[108:111], a[76:79], v[124:127]
    buffer_load_dwordx4 v21, s[8:11], s25 offen offset:0 sc1 lds
    v_mfma_f32_16x16x32_bf16 v[116:119], a[108:111], a[72:75], v[116:119]
    ds_read_b64_tr_b16 a[18:19], v9 offset:33792
    v_mfma_f32_16x16x32_bf16 v[108:111], a[108:111], a[68:71], v[108:111]
    v_mfma_f32_16x16x32_bf16 v[100:103], a[108:111], a[64:67], v[100:103]
    ds_read_b128 a[48:51], v13 offset:8192
    v_mfma_f32_16x16x32_bf16 v[160:163], a[112:115], a[64:67], v[160:163]
    v_mfma_f32_16x16x32_bf16 v[168:171], a[112:115], a[68:71], v[168:171]
    ds_read_b64_tr_b16 a[20:21], v10 offset:32768
    v_mfma_f32_16x16x32_bf16 v[176:179], a[112:115], a[72:75], v[176:179]
    buffer_load_dwordx4 v22, s[8:11], s25 offen offset:1024 sc1 lds
    v_mfma_f32_16x16x32_bf16 v[184:187], a[112:115], a[76:79], v[184:187]
    ds_read_b64_tr_b16 a[22:23], v10 offset:33792
    v_mfma_f32_16x16x32_bf16 v[192:195], a[112:115], a[80:83], v[192:195]
    v_mfma_f32_16x16x32_bf16 v[200:203], a[112:115], a[84:87], v[200:203]
    ds_read_b128 a[52:55], v13 offset:10240
    v_mfma_f32_16x16x32_bf16 v[208:211], a[112:115], a[88:91], v[208:211]
    v_mfma_f32_16x16x32_bf16 v[216:219], a[112:115], a[92:95], v[216:219]
    ds_read_b64_tr_b16 a[24:25], v11 offset:32768
    v_mfma_f32_16x16x32_bf16 v[220:223], a[116:119], a[92:95], v[220:223]
    buffer_load_dwordx4 v23, s[8:11], s25 offen offset:2048 sc1 lds
    v_mfma_f32_16x16x32_bf16 v[212:215], a[116:119], a[88:91], v[212:215]
    ds_read_b64_tr_b16 a[26:27], v11 offset:33792
    v_mfma_f32_16x16x32_bf16 v[204:207], a[116:119], a[84:87], v[204:207]
    v_mfma_f32_16x16x32_bf16 v[196:199], a[116:119], a[80:83], v[196:199]
    ds_read_b128 a[56:59], v13 offset:12288
    v_mfma_f32_16x16x32_bf16 v[188:191], a[116:119], a[76:79], v[188:191]
    v_mfma_f32_16x16x32_bf16 v[180:183], a[116:119], a[72:75], v[180:183]
    ds_read_b64_tr_b16 a[28:29], v12 offset:32768
    v_mfma_f32_16x16x32_bf16 v[172:175], a[116:119], a[68:71], v[172:175]
    buffer_load_dwordx4 v24, s[8:11], s25 offen offset:3072 sc1 lds
    v_mfma_f32_16x16x32_bf16 v[164:167], a[116:119], a[64:67], v[164:167]
    ds_read_b64_tr_b16 a[30:31], v12 offset:33792
    v_mfma_f32_16x16x32_bf16 v[224:227], a[120:123], a[64:67], v[224:227]
    v_mfma_f32_16x16x32_bf16 v[232:235], a[120:123], a[68:71], v[232:235]
    ds_read_b128 a[60:63], v13 offset:14336
    v_mfma_f32_16x16x32_bf16 v[240:243], a[120:123], a[72:75], v[240:243]
    v_mfma_f32_16x16x32_bf16 v[248:251], a[120:123], a[76:79], v[248:251]
    v_mfma_f32_16x16x32_bf16 a[224:227], a[120:123], a[80:83], a[224:227]
    v_mfma_f32_16x16x32_bf16 a[232:235], a[120:123], a[84:87], a[232:235]
    v_mfma_f32_16x16x32_bf16 a[240:243], a[120:123], a[88:91], a[240:243]
    v_mfma_f32_16x16x32_bf16 a[248:251], a[120:123], a[92:95], a[248:251]
    v_mfma_f32_16x16x32_bf16 a[252:255], a[124:127], a[92:95], a[252:255]
    v_mfma_f32_16x16x32_bf16 a[244:247], a[124:127], a[88:91], a[244:247]
    buffer_load_dword a202, v4, s[68:71], s74 offen
    v_mfma_f32_16x16x32_bf16 a[236:239], a[124:127], a[84:87], a[236:239]
    s_add_u32 s74, s74, s80
    v_mfma_f32_16x16x32_bf16 a[228:231], a[124:127], a[80:83], a[228:231]
    v_mfma_f32_16x16x32_bf16 v[252:255], a[124:127], a[76:79], v[252:255]
    v_mfma_f32_16x16x32_bf16 v[244:247], a[124:127], a[72:75], v[244:247]
    v_mfma_f32_16x16x32_bf16 v[236:239], a[124:127], a[68:71], v[236:239]
    v_mfma_f32_16x16x32_bf16 v[228:231], a[124:127], a[64:67], v[228:231]
    s_waitcnt vmcnt(18)
    s_waitcnt lgkmcnt(0)
    s_barrier
    v_mfma_f32_16x16x32_bf16 v[32:35], a[32:35], a[0:3], v[32:35]
    v_mfma_f32_16x16x32_bf16 v[40:43], a[32:35], a[4:7], v[40:43]
    v_mfma_f32_16x16x32_bf16 v[48:51], a[32:35], a[8:11], v[48:51]
    s_add_u32 m0, s30, 32768
    v_mfma_f32_16x16x32_bf16 v[56:59], a[32:35], a[12:15], v[56:59]
    ds_read_b64_tr_b16 a[64:65], v5 offset:49152
    v_mfma_f32_16x16x32_bf16 v[64:67], a[32:35], a[16:19], v[64:67]
    buffer_load_dwordx4 v17, s[12:15], s24 offen offset:0 sc1 lds
    v_mfma_f32_16x16x32_bf16 v[72:75], a[32:35], a[20:23], v[72:75]
    ds_read_b64_tr_b16 a[66:67], v5 offset:50176
    v_mfma_f32_16x16x32_bf16 v[80:83], a[32:35], a[24:27], v[80:83]
    v_mfma_f32_16x16x32_bf16 v[88:91], a[32:35], a[28:31], v[88:91]
    ds_read_b128 a[96:99], v14 offset:0
    v_mfma_f32_16x16x32_bf16 v[92:95], a[36:39], a[28:31], v[92:95]
    v_mfma_f32_16x16x32_bf16 v[84:87], a[36:39], a[24:27], v[84:87]
    ds_read_b64_tr_b16 a[68:69], v6 offset:49152
    v_mfma_f32_16x16x32_bf16 v[76:79], a[36:39], a[20:23], v[76:79]
    buffer_load_dwordx4 v18, s[12:15], s24 offen offset:1024 sc1 lds
    v_mfma_f32_16x16x32_bf16 v[68:71], a[36:39], a[16:19], v[68:71]
    ds_read_b64_tr_b16 a[70:71], v6 offset:50176
    v_mfma_f32_16x16x32_bf16 v[60:63], a[36:39], a[12:15], v[60:63]
    v_mfma_f32_16x16x32_bf16 v[52:55], a[36:39], a[8:11], v[52:55]
    ds_read_b128 a[100:103], v14 offset:2048
    v_mfma_f32_16x16x32_bf16 v[44:47], a[36:39], a[4:7], v[44:47]
    v_mfma_f32_16x16x32_bf16 v[36:39], a[36:39], a[0:3], v[36:39]
    ds_read_b64_tr_b16 a[72:73], v7 offset:49152
    v_mfma_f32_16x16x32_bf16 v[96:99], a[40:43], a[0:3], v[96:99]
    buffer_load_dwordx4 v19, s[12:15], s24 offen offset:2048 sc1 lds
    v_mfma_f32_16x16x32_bf16 v[104:107], a[40:43], a[4:7], v[104:107]
    ds_read_b64_tr_b16 a[74:75], v7 offset:50176
    v_mfma_f32_16x16x32_bf16 v[112:115], a[40:43], a[8:11], v[112:115]
    v_mfma_f32_16x16x32_bf16 v[120:123], a[40:43], a[12:15], v[120:123]
    ds_read_b128 a[104:107], v14 offset:4096
    v_mfma_f32_16x16x32_bf16 v[128:131], a[40:43], a[16:19], v[128:131]
    v_mfma_f32_16x16x32_bf16 v[136:139], a[40:43], a[20:23], v[136:139]
    ds_read_b64_tr_b16 a[76:77], v8 offset:49152
    v_mfma_f32_16x16x32_bf16 v[144:147], a[40:43], a[24:27], v[144:147]
    buffer_load_dwordx4 v20, s[12:15], s24 offen offset:3072 sc1 lds
    v_mfma_f32_16x16x32_bf16 v[152:155], a[40:43], a[28:31], v[152:155]
    ds_read_b64_tr_b16 a[78:79], v8 offset:50176
    v_mfma_f32_16x16x32_bf16 v[156:159], a[44:47], a[28:31], v[156:159]
    s_add_u32 s24, s24, 262144
    s_add_u32 s31, s25, 65536
    v_mfma_f32_16x16x32_bf16 v[148:151], a[44:47], a[24:27], v[148:151]
    ds_read_b128 a[108:111], v14 offset:6144
    v_mfma_f32_16x16x32_bf16 v[140:143], a[44:47], a[20:23], v[140:143]
    s_add_u32 m0, s26, 4096
    v_mfma_f32_16x16x32_bf16 v[132:135], a[44:47], a[16:19], v[132:135]
    ds_read_b64_tr_b16 a[80:81], v9 offset:49152
    v_mfma_f32_16x16x32_bf16 v[124:127], a[44:47], a[12:15], v[124:127]
    buffer_load_dwordx4 v21, s[8:11], s31 offen offset:0 sc1 lds
    v_mfma_f32_16x16x32_bf16 v[116:119], a[44:47], a[8:11], v[116:119]
    ds_read_b64_tr_b16 a[82:83], v9 offset:50176
    v_mfma_f32_16x16x32_bf16 v[108:111], a[44:47], a[4:7], v[108:111]
    v_mfma_f32_16x16x32_bf16 v[100:103], a[44:47], a[0:3], v[100:103]
    ds_read_b128 a[112:115], v14 offset:8192
    v_mfma_f32_16x16x32_bf16 v[160:163], a[48:51], a[0:3], v[160:163]
    v_mfma_f32_16x16x32_bf16 v[168:171], a[48:51], a[4:7], v[168:171]
    ds_read_b64_tr_b16 a[84:85], v10 offset:49152
    v_mfma_f32_16x16x32_bf16 v[176:179], a[48:51], a[8:11], v[176:179]
    buffer_load_dwordx4 v22, s[8:11], s31 offen offset:1024 sc1 lds
    v_mfma_f32_16x16x32_bf16 v[184:187], a[48:51], a[12:15], v[184:187]
    ds_read_b64_tr_b16 a[86:87], v10 offset:50176
    v_mfma_f32_16x16x32_bf16 v[192:195], a[48:51], a[16:19], v[192:195]
    v_mfma_f32_16x16x32_bf16 v[200:203], a[48:51], a[20:23], v[200:203]
    ds_read_b128 a[116:119], v14 offset:10240
    v_mfma_f32_16x16x32_bf16 v[208:211], a[48:51], a[24:27], v[208:211]
    v_mfma_f32_16x16x32_bf16 v[216:219], a[48:51], a[28:31], v[216:219]
    ds_read_b64_tr_b16 a[88:89], v11 offset:49152
    v_mfma_f32_16x16x32_bf16 v[220:223], a[52:55], a[28:31], v[220:223]
    buffer_load_dwordx4 v23, s[8:11], s31 offen offset:2048 sc1 lds
    v_mfma_f32_16x16x32_bf16 v[212:215], a[52:55], a[24:27], v[212:215]
    ds_read_b64_tr_b16 a[90:91], v11 offset:50176
    v_mfma_f32_16x16x32_bf16 v[204:207], a[52:55], a[20:23], v[204:207]
    v_mfma_f32_16x16x32_bf16 v[196:199], a[52:55], a[16:19], v[196:199]
    ds_read_b128 a[120:123], v14 offset:12288
    v_mfma_f32_16x16x32_bf16 v[188:191], a[52:55], a[12:15], v[188:191]
    v_mfma_f32_16x16x32_bf16 v[180:183], a[52:55], a[8:11], v[180:183]
    ds_read_b64_tr_b16 a[92:93], v12 offset:49152
    v_mfma_f32_16x16x32_bf16 v[172:175], a[52:55], a[4:7], v[172:175]
    buffer_load_dwordx4 v24, s[8:11], s31 offen offset:3072 sc1 lds
    v_mfma_f32_16x16x32_bf16 v[164:167], a[52:55], a[0:3], v[164:167]
    ds_read_b64_tr_b16 a[94:95], v12 offset:50176
    v_mfma_f32_16x16x32_bf16 v[224:227], a[56:59], a[0:3], v[224:227]
    v_mfma_f32_16x16x32_bf16 v[232:235], a[56:59], a[4:7], v[232:235]
    ds_read_b128 a[124:127], v14 offset:14336
    v_mfma_f32_16x16x32_bf16 v[240:243], a[56:59], a[8:11], v[240:243]
    s_add_u32 s25, s25, 128
    s_add_u32 s29, s29, 1
    v_mfma_f32_16x16x32_bf16 v[248:251], a[56:59], a[12:15], v[248:251]
    v_mfma_f32_16x16x32_bf16 a[224:227], a[56:59], a[16:19], a[224:227]
    s_cmp_ge_u32 s29, 16
    s_cselect_b32 s25, 1073741824, s25
    v_mfma_f32_16x16x32_bf16 a[232:235], a[56:59], a[20:23], a[232:235]
    v_mfma_f32_16x16x32_bf16 a[240:243], a[56:59], a[24:27], a[240:243]
    s_add_u32 s26, s26, 32768
    s_cmp_eq_u32 s26, s65
    v_mfma_f32_16x16x32_bf16 a[248:251], a[56:59], a[28:31], a[248:251]
    s_cselect_b32 s26, s64, s26
    v_mfma_f32_16x16x32_bf16 a[252:255], a[60:63], a[28:31], a[252:255]
    v_mfma_f32_16x16x32_bf16 a[244:247], a[60:63], a[24:27], a[244:247]
    buffer_load_dword a203, v4, s[68:71], s74 offen
    v_mfma_f32_16x16x32_bf16 a[236:239], a[60:63], a[20:23], a[236:239]
    s_add_u32 s74, s74, s80
    v_mfma_f32_16x16x32_bf16 a[228:231], a[60:63], a[16:19], a[228:231]
    v_mfma_f32_16x16x32_bf16 v[252:255], a[60:63], a[12:15], v[252:255]
    v_mfma_f32_16x16x32_bf16 v[244:247], a[60:63], a[8:11], v[244:247]
    v_mfma_f32_16x16x32_bf16 v[236:239], a[60:63], a[4:7], v[236:239]
    v_mfma_f32_16x16x32_bf16 v[228:231], a[60:63], a[0:3], v[228:231]
    s_waitcnt vmcnt(19)
    s_waitcnt lgkmcnt(0)
    s_barrier
    v_mfma_f32_16x16x32_bf16 v[32:35], a[96:99], a[64:67], v[32:35]
    s_add_u32 s27, s27, 32768
    s_cmp_eq_u32 s27, 98304
    v_mfma_f32_16x16x32_bf16 v[40:43], a[96:99], a[68:71], v[40:43]
    s_cselect_b32 s27, 0, s27
    v_add_u32 v13, s27, v15
    v_mfma_f32_16x16x32_bf16 v[48:51], a[96:99], a[72:75], v[48:51]
    v_add_u32 v14, s27, v16
    s_add_u32 m0, s30, 49152
    v_mfma_f32_16x16x32_bf16 v[56:59], a[96:99], a[76:79], v[56:59]
    ds_read_b64_tr_b16 a[0:1], v5 offset:0
    v_mfma_f32_16x16x32_bf16 v[64:67], a[96:99], a[80:83], v[64:67]
    buffer_load_dwordx4 v17, s[12:15], s24 offen offset:0 sc1 lds
    v_mfma_f32_16x16x32_bf16 v[72:75], a[96:99], a[84:87], v[72:75]
    ds_read_b64_tr_b16 a[2:3], v5 offset:1024
    v_mfma_f32_16x16x32_bf16 v[80:83], a[96:99], a[88:91], v[80:83]
    v_mfma_f32_16x16x32_bf16 v[88:91], a[96:99], a[92:95], v[88:91]
    ds_read_b128 a[32:35], v13 offset:0
    v_mfma_f32_16x16x32_bf16 v[92:95], a[100:103], a[92:95], v[92:95]
    v_mfma_f32_16x16x32_bf16 v[84:87], a[100:103], a[88:91], v[84:87]
    ds_read_b64_tr_b16 a[4:5], v6 offset:0
    v_mfma_f32_16x16x32_bf16 v[76:79], a[100:103], a[84:87], v[76:79]
    buffer_load_dwordx4 v18, s[12:15], s24 offen offset:1024 sc1 lds
    v_mfma_f32_16x16x32_bf16 v[68:71], a[100:103], a[80:83], v[68:71]
    ds_read_b64_tr_b16 a[6:7], v6 offset:1024
    v_mfma_f32_16x16x32_bf16 v[60:63], a[100:103], a[76:79], v[60:63]
    v_mfma_f32_16x16x32_bf16 v[52:55], a[100:103], a[72:75], v[52:55]
    ds_read_b128 a[36:39], v13 offset:2048
    v_mfma_f32_16x16x32_bf16 v[44:47], a[100:103], a[68:71], v[44:47]
    v_mfma_f32_16x16x32_bf16 v[36:39], a[100:103], a[64:67], v[36:39]
    ds_read_b64_tr_b16 a[8:9], v7 offset:0
    v_mfma_f32_16x16x32_bf16 v[96:99], a[104:107], a[64:67], v[96:99]
    buffer_load_dwordx4 v19, s[12:15], s24 offen offset:2048 sc1 lds
    v_mfma_f32_16x16x32_bf16 v[104:107], a[104:107], a[68:71], v[104:107]
    ds_read_b64_tr_b16 a[10:11], v7 offset:1024
    v_mfma_f32_16x16x32_bf16 v[112:115], a[104:107], a[72:75], v[112:115]
    v_mfma_f32_16x16x32_bf16 v[120:123], a[104:107], a[76:79], v[120:123]
    ds_read_b128 a[40:43], v13 offset:4096
    v_mfma_f32_16x16x32_bf16 v[128:131], a[104:107], a[80:83], v[128:131]
    v_mfma_f32_16x16x32_bf16 v[136:139], a[104:107], a[84:87], v[136:139]
    ds_read_b64_tr_b16 a[12:13], v8 offset:0
    v_mfma_f32_16x16x32_bf16 v[144:147], a[104:107], a[88:91], v[144:147]
    buffer_load_dwordx4 v20, s[12:15], s24 offen offset:3072 sc1 lds
    v_mfma_f32_16x16x32_bf16 v[152:155], a[104:107], a[92:95], v[152:155]
    ds_read_b64_tr_b16 a[14:15], v8 offset:1024
    v_mfma_f32_16x16x32_bf16 v[156:159], a[108:111], a[92:95], v[156:159]
    s_add_u32 s24, s24, 262144
    v_mfma_f32_16x16x32_bf16 v[148:151], a[108:111], a[88:91], v[148:151]
    ds_read_b128 a[44:47], v13 offset:6144
    v_mfma_f32_16x16x32_bf16 v[140:143], a[108:111], a[84:87], v[140:143]
    s_mov_b32 m0, s26
    v_mfma_f32_16x16x32_bf16 v[132:135], a[108:111], a[80:83], v[132:135]
    ds_read_b64_tr_b16 a[16:17], v9 offset:0
    v_mfma_f32_16x16x32_bf16 v[124:127], a[108:111], a[76:79], v[124:127]
    buffer_load_dwordx4 v21, s[8:11], s25 offen offset:0 sc1 lds
    v_mfma_f32_16x16x32_bf16 v[116:119], a[108:111], a[72:75], v[116:119]
    ds_read_b64_tr_b16 a[18:19], v9 offset:1024
    v_mfma_f32_16x16x32_bf16 v[108:111], a[108:111], a[68:71], v[108:111]
    v_mfma_f32_16x16x32_bf16 v[100:103], a[108:111], a[64:67], v[100:103]
    ds_read_b128 a[48:51], v13 offset:8192
    v_mfma_f32_16x16x32_bf16 v[160:163], a[112:115], a[64:67], v[160:163]
    v_mfma_f32_16x16x32_bf16 v[168:171], a[112:115], a[68:71], v[168:171]
    ds_read_b64_tr_b16 a[20:21], v10 offset:0
    v_mfma_f32_16x16x32_bf16 v[176:179], a[112:115], a[72:75], v[176:179]
    buffer_load_dwordx4 v22, s[8:11], s25 offen offset:1024 sc1 lds
    v_mfma_f32_16x16x32_bf16 v[184:187], a[112:115], a[76:79], v[184:187]
    ds_read_b64_tr_b16 a[22:23], v10 offset:1024
    v_mfma_f32_16x16x32_bf16 v[192:195], a[112:115], a[80:83], v[192:195]
    v_mfma_f32_16x16x32_bf16 v[200:203], a[112:115], a[84:87], v[200:203]
    ds_read_b128 a[52:55], v13 offset:10240
    v_mfma_f32_16x16x32_bf16 v[208:211], a[112:115], a[88:91], v[208:211]
    v_mfma_f32_16x16x32_bf16 v[216:219], a[112:115], a[92:95], v[216:219]
    ds_read_b64_tr_b16 a[24:25], v11 offset:0
    v_mfma_f32_16x16x32_bf16 v[220:223], a[116:119], a[92:95], v[220:223]
    buffer_load_dwordx4 v23, s[8:11], s25 offen offset:2048 sc1 lds
    v_mfma_f32_16x16x32_bf16 v[212:215], a[116:119], a[88:91], v[212:215]
    ds_read_b64_tr_b16 a[26:27], v11 offset:1024
    v_mfma_f32_16x16x32_bf16 v[204:207], a[116:119], a[84:87], v[204:207]
    v_mfma_f32_16x16x32_bf16 v[196:199], a[116:119], a[80:83], v[196:199]
    ds_read_b128 a[56:59], v13 offset:12288
    v_mfma_f32_16x16x32_bf16 v[188:191], a[116:119], a[76:79], v[188:191]
    v_mfma_f32_16x16x32_bf16 v[180:183], a[116:119], a[72:75], v[180:183]
    ds_read_b64_tr_b16 a[28:29], v12 offset:0
    v_mfma_f32_16x16x32_bf16 v[172:175], a[116:119], a[68:71], v[172:175]
    buffer_load_dwordx4 v24, s[8:11], s25 offen offset:3072 sc1 lds
    v_mfma_f32_16x16x32_bf16 v[164:167], a[116:119], a[64:67], v[164:167]
    ds_read_b64_tr_b16 a[30:31], v12 offset:1024
    v_mfma_f32_16x16x32_bf16 v[224:227], a[120:123], a[64:67], v[224:227]
    v_mfma_f32_16x16x32_bf16 v[232:235], a[120:123], a[68:71], v[232:235]
    ds_read_b128 a[60:63], v13 offset:14336
    v_mfma_f32_16x16x32_bf16 v[240:243], a[120:123], a[72:75], v[240:243]
    v_mfma_f32_16x16x32_bf16 v[248:251], a[120:123], a[76:79], v[248:251]
    v_mfma_f32_16x16x32_bf16 a[224:227], a[120:123], a[80:83], a[224:227]
    v_mfma_f32_16x16x32_bf16 a[232:235], a[120:123], a[84:87], a[232:235]
    v_mfma_f32_16x16x32_bf16 a[240:243], a[120:123], a[88:91], a[240:243]
    v_mfma_f32_16x16x32_bf16 a[248:251], a[120:123], a[92:95], a[248:251]
    v_mfma_f32_16x16x32_bf16 a[252:255], a[124:127], a[92:95], a[252:255]
    v_mfma_f32_16x16x32_bf16 a[244:247], a[124:127], a[88:91], a[244:247]
    buffer_load_dword a204, v4, s[68:71], s74 offen
    v_mfma_f32_16x16x32_bf16 a[236:239], a[124:127], a[84:87], a[236:239]
    s_add_u32 s74, s74, s80
    v_mfma_f32_16x16x32_bf16 a[228:231], a[124:127], a[80:83], a[228:231]
    s_add_u32 s28, s28, 1
    s_cmp_ge_u32 s28, s83
    v_mfma_f32_16x16x32_bf16 v[252:255], a[124:127], a[76:79], v[252:255]
    s_cselect_b32 s80, s81, 0
    s_cselect_b32 s70, s82, 0
    v_mfma_f32_16x16x32_bf16 v[244:247], a[124:127], a[72:75], v[244:247]
    s_cmp_lt_u32 s28, 7
    v_mfma_f32_16x16x32_bf16 v[236:239], a[124:127], a[68:71], v[236:239]
    v_mfma_f32_16x16x32_bf16 v[228:231], a[124:127], a[64:67], v[228:231]
pj_vloop:
    s_cmp_eq_u32 s20, 0
    s_cbranch_scc0 sig_4
    s_cmp_eq_u32 s28, s76
    s_cbranch_scc0 sig_4
    v_mov_b32 v2, 1
    v_mov_b32 v3, 0
    s_mov_b64 exec, 1
    buffer_atomic_add v2, v3, s[60:63], 0 offen sc1
    s_mov_b64 exec, -1
sig_4:
    s_waitcnt vmcnt(19)
    s_waitcnt lgkmcnt(0)
    s_barrier
    v_mfma_f32_16x16x32_bf16 v[32:35], a[32:35], a[0:3], v[32:35]
    v_mfma_f32_16x16x32_bf16 v[40:43], a[32:35], a[4:7], v[40:43]
    v_mfma_f32_16x16x32_bf16 v[48:51], a[32:35], a[8:11], v[48:51]
    s_add_u32 m0, s30, 0
    v_mfma_f32_16x16x32_bf16 v[56:59], a[32:35], a[12:15], v[56:59]
    ds_read_b64_tr_b16 a[64:65], v5 offset:16384
    v_mfma_f32_16x16x32_bf16 v[64:67], a[32:35], a[16:19], v[64:67]
    buffer_load_dwordx4 v17, s[12:15], s24 offen offset:0 sc1 lds
    v_mfma_f32_16x16x32_bf16 v[72:75], a[32:35], a[20:23], v[72:75]
    ds_read_b64_tr_b16 a[66:67], v5 offset:17408
    v_mfma_f32_16x16x32_bf16 v[80:83], a[32:35], a[24:27], v[80:83]
    v_mfma_f32_16x16x32_bf16 v[88:91], a[32:35], a[28:31], v[88:91]
    ds_read_b128 a[96:99], v14 offset:0
    v_mfma_f32_16x16x32_bf16 v[92:95], a[36:39], a[28:31], v[92:95]
    v_mfma_f32_16x16x32_bf16 v[84:87], a[36:39], a[24:27], v[84:87]
    ds_read_b64_tr_b16 a[68:69], v6 offset:16384
    v_mfma_f32_16x16x32_bf16 v[76:79], a[36:39], a[20:23], v[76:79]
    buffer_load_dwordx4 v18, s[12:15], s24 offen offset:1024 sc1 lds
    v_mfma_f32_16x16x32_bf16 v[68:71], a[36:39], a[16:19], v[68:71]
    ds_read_b64_tr_b16 a[70:71], v6 offset:17408
    v_mfma_f32_16x16x32_bf16 v[60:63], a[36:39], a[12:15], v[60:63]
    v_mfma_f32_16x16x32_bf16 v[52:55], a[36:39], a[8:11], v[52:55]
    ds_read_b128 a[100:103], v14 offset:2048
    v_mfma_f32_16x16x32_bf16 v[44:47], a[36:39], a[4:7], v[44:47]
    v_mfma_f32_16x16x32_bf16 v[36:39], a[36:39], a[0:3], v[36:39]
    ds_read_b64_tr_b16 a[72:73], v7 offset:16384
    v_mfma_f32_16x16x32_bf16 v[96:99], a[40:43], a[0:3], v[96:99]
    buffer_load_dwordx4 v19, s[12:15], s24 offen offset:2048 sc1 lds
    v_mfma_f32_16x16x32_bf16 v[104:107], a[40:43], a[4:7], v[104:107]
    ds_read_b64_tr_b16 a[74:75], v7 offset:17408
    v_mfma_f32_16x16x32_bf16 v[112:115], a[40:43], a[8:11], v[112:115]
    v_mfma_f32_16x16x32_bf16 v[120:123], a[40:43], a[12:15], v[120:123]
    ds_read_b128 a[104:107], v14 offset:4096
    v_mfma_f32_16x16x32_bf16 v[128:131], a[40:43], a[16:19], v[128:131]
    v_mfma_f32_16x16x32_bf16 v[136:139], a[40:43], a[20:23], v[136:139]
    ds_read_b64_tr_b16 a[76:77], v8 offset:16384
    v_mfma_f32_16x16x32_bf16 v[144:147], a[40:43], a[24:27], v[144:147]
    buffer_load_dwordx4 v20, s[12:15], s24 offen offset:3072 sc1 lds
    v_mfma_f32_16x16x32_bf16 v[152:155], a[40:43], a[28:31], v[152:155]
    ds_read_b64_tr_b16 a[78:79], v8 offset:17408
    v_mfma_f32_16x16x32_bf16 v[156:159], a[44:47], a[28:31], v[156:159]
    s_add_u32 s24, s24, 262144
    s_add_u32 s31, s25, 65536
    v_mfma_f32_16x16x32_bf16 v[148:151], a[44:47], a[24:27], v[148:151]
    ds_read_b128 a[108:111], v14 offset:6144
    v_mfma_f32_16x16x32_bf16 v[140:143], a[44:47], a[20:23], v[140:143]
    s_add_u32 m0, s26, 4096
    v_mfma_f32_16x16x32_bf16 v[132:135], a[44:47], a[16:19], v[132:135]
    ds_read_b64_tr_b16 a[80:81], v9 offset:16384
    v_mfma_f32_16x16x32_bf16 v[124:127], a[44:47], a[12:15], v[124:127]
    buffer_load_dwordx4 v21, s[8:11], s31 offen offset:0 sc1 lds
    v_mfma_f32_16x16x32_bf16 v[116:119], a[44:47], a[8:11], v[116:119]
    ds_read_b64_tr_b16 a[82:83], v9 offset:17408
    v_mfma_f32_16x16x32_bf16 v[108:111], a[44:47], a[4:7], v[108:111]
    v_mfma_f32_16x16x32_bf16 v[100:103], a[44:47], a[0:3], v[100:103]
    ds_read_b128 a[112:115], v14 offset:8192
    v_mfma_f32_16x16x32_bf16 v[160:163], a[48:51], a[0:3], v[160:163]
    v_mfma_f32_16x16x32_bf16 v[168:171], a[48:51], a[4:7], v[168:171]
    ds_read_b64_tr_b16 a[84:85], v10 offset:16384
    v_mfma_f32_16x16x32_bf16 v[176:179], a[48:51], a[8:11], v[176:179]
    buffer_load_dwordx4 v22, s[8:11], s31 offen offset:1024 sc1 lds
    v_mfma_f32_16x16x32_bf16 v[184:187], a[48:51], a[12:15], v[184:187]
    ds_read_b64_tr_b16 a[86:87], v10 offset:17408
    v_mfma_f32_16x16x32_bf16 v[192:195], a[48:51], a[16:19], v[192:195]
    v_mfma_f32_16x16x32_bf16 v[200:203], a[48:51], a[20:23], v[200:203]
    ds_read_b128 a[116:119], v14 offset:10240
    v_mfma_f32_16x16x32_bf16 v[208:211], a[48:51], a[24:27], v[208:211]
    v_mfma_f32_16x16x32_bf16 v[216:219], a[48:51], a[28:31], v[216:219]
    ds_read_b64_tr_b16 a[88:89], v11 offset:16384
    v_mfma_f32_16x16x32_bf16 v[220:223], a[52:55], a[28:31], v[220:223]
    buffer_load_dwordx4 v23, s[8:11], s31 offen offset:2048 sc1 lds
    v_mfma_f32_16x16x32_bf16 v[212:215], a[52:55], a[24:27], v[212:215]
    ds_read_b64_tr_b16 a[90:91], v11 offset:17408
    v_mfma_f32_16x16x32_bf16 v[204:207], a[52:55], a[20:23], v[204:207]
    v_mfma_f32_16x16x32_bf16 v[196:199], a[52:55], a[16:19], v[196:199]
    ds_read_b128 a[120:123], v14 offset:12288
    v_mfma_f32_16x16x32_bf16 v[188:191], a[52:55], a[12:15], v[188:191]
    v_mfma_f32_16x16x32_bf16 v[180:183], a[52:55], a[8:11], v[180:183]
    ds_read_b64_tr_b16 a[92:93], v12 offset:16384
    v_mfma_f32_16x16x32_bf16 v[172:175], a[52:55], a[4:7], v[172:175]
    buffer_load_dwordx4 v24, s[8:11], s31 offen offset:3072 sc1 lds
    v_mfma_f32_16x16x32_bf16 v[164:167], a[52:55], a[0:3], v[164:167]
    ds_read_b64_tr_b16 a[94:95], v12 offset:17408
    v_mfma_f32_16x16x32_bf16 v[224:227], a[56:59], a[0:3], v[224:227]
    v_mfma_f32_16x16x32_bf16 v[232:235], a[56:59], a[4:7], v[232:235]
    ds_read_b128 a[124:127], v14 offset:14336
    v_mfma_f32_16x16x32_bf16 v[240:243], a[56:59], a[8:11], v[240:243]
    s_add_u32 s25, s25, 128
    s_add_u32 s29, s29, 1
    v_mfma_f32_16x16x32_bf16 v[248:251], a[56:59], a[12:15], v[248:251]
    v_mfma_f32_16x16x32_bf16 a[224:227], a[56:59], a[16:19], a[224:227]
    s_cmp_ge_u32 s29, 16
    s_cselect_b32 s25, 1073741824, s25
    v_mfma_f32_16x16x32_bf16 a[232:235], a[56:59], a[20:23], a[232:235]
    v_mfma_f32_16x16x32_bf16 a[240:243], a[56:59], a[24:27], a[240:243]
    s_add_u32 s26, s26, 32768
    s_cmp_eq_u32 s26, s65
    v_mfma_f32_16x16x32_bf16 a[248:251], a[56:59], a[28:31], a[248:251]
    s_cselect_b32 s26, s64, s26
    v_mfma_f32_16x16x32_bf16 a[252:255], a[60:63], a[28:31], a[252:255]
    v_mfma_f32_16x16x32_bf16 a[244:247], a[60:63], a[24:27], a[244:247]
    buffer_load_dword a201, v4, s[68:71], s74 offen
    v_mfma_f32_16x16x32_bf16 a[236:239], a[60:63], a[20:23], a[236:239]
    s_add_u32 s74, s74, s80
    v_mfma_f32_16x16x32_bf16 a[228:231], a[60:63], a[16:19], a[228:231]
    v_mfma_f32_16x16x32_bf16 v[252:255], a[60:63], a[12:15], v[252:255]
    v_mfma_f32_16x16x32_bf16 v[244:247], a[60:63], a[8:11], v[244:247]
    v_mfma_f32_16x16x32_bf16 v[236:239], a[60:63], a[4:7], v[236:239]
    v_mfma_f32_16x16x32_bf16 v[228:231], a[60:63], a[0:3], v[228:231]
    s_waitcnt vmcnt(19)
    s_waitcnt lgkmcnt(0)
    s_barrier
    v_mfma_f32_16x16x32_bf16 v[32:35], a[96:99], a[64:67], v[32:35]
    s_add_u32 s27, s27, 32768
    s_cmp_eq_u32 s27, 98304
    v_mfma_f32_16x16x32_bf16 v[40:43], a[96:99], a[68:71], v[40:43]
    s_cselect_b32 s27, 0, s27
    v_add_u32 v13, s27, v15
    v_mfma_f32_16x16x32_bf16 v[48:51], a[96:99], a[72:75], v[48:51]
    v_add_u32 v14, s27, v16
    s_add_u32 m0, s30, 16384
    v_mfma_f32_16x16x32_bf16 v[56:59], a[96:99], a[76:79], v[56:59]
    ds_read_b64_tr_b16 a[0:1], v5 offset:32768
    v_mfma_f32_16x16x32_bf16 v[64:67], a[96:99], a[80:83], v[64:67]
    buffer_load_dwordx4 v17, s[12:15], s24 offen offset:0 sc1 lds
    v_mfma_f32_16x16x32_bf16 v[72:75], a[96:99], a[84:87], v[72:75]
    ds_read_b64_tr_b16 a[2:3], v5 offset:33792
    v_mfma_f32_16x16x32_bf16 v[80:83], a[96:99], a[88:91], v[80:83]
    v_mfma_f32_16x16x32_bf16 v[88:91], a[96:99], a[92:95], v[88:91]
    ds_read_b128 a[32:35], v13 offset:0
    v_mfma_f32_16x16x32_bf16 v[92:95], a[100:103], a[92:95], v[92:95]
    v_mfma_f32_16x16x32_bf16 v[84:87], a[100:103], a[88:91], v[84:87]
    ds_read_b64_tr_b16 a[4:5], v6 offset:32768
    v_mfma_f32_16x16x32_bf16 v[76:79], a[100:103], a[84:87], v[76:79]
    buffer_load_dwordx4 v18, s[12:15], s24 offen offset:1024 sc1 lds
    v_mfma_f32_16x16x32_bf16 v[68:71], a[100:103], a[80:83], v[68:71]
    ds_read_b64_tr_b16 a[6:7], v6 offset:33792
    v_mfma_f32_16x16x32_bf16 v[60:63], a[100:103], a[76:79], v[60:63]
    v_mfma_f32_16x16x32_bf16 v[52:55], a[100:103], a[72:75], v[52:55]
    ds_read_b128 a[36:39], v13 offset:2048
    v_mfma_f32_16x16x32_bf16 v[44:47], a[100:103], a[68:71], v[44:47]
    v_mfma_f32_16x16x32_bf16 v[36:39], a[100:103], a[64:67], v[36:39]
    ds_read_b64_tr_b16 a[8:9], v7 offset:32768
    v_mfma_f32_16x16x32_bf16 v[96:99], a[104:107], a[64:67], v[96:99]
    buffer_load_dwordx4 v19, s[12:15], s24 offen offset:2048 sc1 lds
    v_mfma_f32_16x16x32_bf16 v[104:107], a[104:107], a[68:71], v[104:107]
    ds_read_b64_tr_b16 a[10:11], v7 offset:33792
    v_mfma_f32_16x16x32_bf16 v[112:115], a[104:107], a[72:75], v[112:115]
    v_mfma_f32_16x16x32_bf16 v[120:123], a[104:107], a[76:79], v[120:123]
    ds_read_b128 a[40:43], v13 offset:4096
    v_mfma_f32_16x16x32_bf16 v[128:131], a[104:107], a[80:83], v[128:131]
    v_mfma_f32_16x16x32_bf16 v[136:139], a[104:107], a[84:87], v[136:139]
    ds_read_b64_tr_b16 a[12:13], v8 offset:32768
    v_mfma_f32_16x16x32_bf16 v[144:147], a[104:107], a[88:91], v[144:147]
    buffer_load_dwordx4 v20, s[12:15], s24 offen offset:3072 sc1 lds
    v_mfma_f32_16x16x32_bf16 v[152:155], a[104:107], a[92:95], v[152:155]
    ds_read_b64_tr_b16 a[14:15], v8 offset:33792
    v_mfma_f32_16x16x32_bf16 v[156:159], a[108:111], a[92:95], v[156:159]
    s_add_u32 s24, s24, 262144
    v_mfma_f32_16x16x32_bf16 v[148:151], a[108:111], a[88:91], v[148:151]
    ds_read_b128 a[44:47], v13 offset:6144
    v_mfma_f32_16x16x32_bf16 v[140:143], a[108:111], a[84:87], v[140:143]
    s_mov_b32 m0, s26
    v_mfma_f32_16x16x32_bf16 v[132:135], a[108:111], a[80:83], v[132:135]
    ds_read_b64_tr_b16 a[16:17], v9 offset:32768
    v_mfma_f32_16x16x32_bf16 v[124:127], a[108:111], a[76:79], v[124:127]
    buffer_load_dwordx4 v21, s[8:11], s25 offen offset:0 sc1 lds
    v_mfma_f32_16x16x32_bf16 v[116:119], a[108:111], a[72:75], v[116:119]
    ds_read_b64_tr_b16 a[18:19], v9 offset:33792
    v_mfma_f32_16x16x32_bf16 v[108:111], a[108:111], a[68:71], v[108:111]
    v_mfma_f32_16x16x32_bf16 v[100:103], a[108:111], a[64:67], v[100:103]
    ds_read_b128 a[48:51], v13 offset:8192
    v_mfma_f32_16x16x32_bf16 v[160:163], a[112:115], a[64:67], v[160:163]
    v_mfma_f32_16x16x32_bf16 v[168:171], a[112:115], a[68:71], v[168:171]
    ds_read_b64_tr_b16 a[20:21], v10 offset:32768
    v_mfma_f32_16x16x32_bf16 v[176:179], a[112:115], a[72:75], v[176:179]
    buffer_load_dwordx4 v22, s[8:11], s25 offen offset:1024 sc1 lds
    v_mfma_f32_16x16x32_bf16 v[184:187], a[112:115], a[76:79], v[184:187]
    ds_read_b64_tr_b16 a[22:23], v10 offset:33792
    v_mfma_f32_16x16x32_bf16 v[192:195], a[112:115], a[80:83], v[192:195]
    v_mfma_f32_16x16x32_bf16 v[200:203], a[112:115], a[84:87], v[200:203]
    ds_read_b128 a[52:55], v13 offset:10240
    v_mfma_f32_16x16x32_bf16 v[208:211], a[112:115], a[88:91], v[208:211]
    v_mfma_f32_16x16x32_bf16 v[216:219], a[112:115], a[92:95], v[216:219]
    ds_read_b64_tr_b16 a[24:25], v11 offset:32768
    v_mfma_f32_16x16x32_bf16 v[220:223], a[116:119], a[92:95], v[220:223]
    buffer_load_dwordx4 v23, s[8:11], s25 offen offset:2048 sc1 lds
    v_mfma_f32_16x16x32_bf16 v[212:215], a[116:119], a[88:91], v[212:215]
    ds_read_b64_tr_b16 a[26:27], v11 offset:33792
    v_mfma_f32_16x16x32_bf16 v[204:207], a[116:119], a[84:87], v[204:207]
    v_mfma_f32_16x16x32_bf16 v[196:199], a[116:119], a[80:83], v[196:199]
    ds_read_b128 a[56:59], v13 offset:12288
    v_mfma_f32_16x16x32_bf16 v[188:191], a[116:119], a[76:79], v[188:191]
    v_mfma_f32_16x16x32_bf16 v[180:183], a[116:119], a[72:75], v[180:183]
    ds_read_b64_tr_b16 a[28:29], v12 offset:32768
    v_mfma_f32_16x16x32_bf16 v[172:175], a[116:119], a[68:71], v[172:175]
    buffer_load_dwordx4 v24, s[8:11], s25 offen offset:3072 sc1 lds
    v_mfma_f32_16x16x32_bf16 v[164:167], a[116:119], a[64:67], v[164:167]
    ds_read_b64_tr_b16 a[30:31], v12 offset:33792
    v_mfma_f32_16x16x32_bf16 v[224:227], a[120:123], a[64:67], v[224:227]
    v_mfma_f32_16x16x32_bf16 v[232:235], a[120:123], a[68:71], v[232:235]
    ds_read_b128 a[60:63], v13 offset:14336
    v_mfma_f32_16x16x32_bf16 v[240:243], a[120:123], a[72:75], v[240:243]
    v_mfma_f32_16x16x32_bf16 v[248:251], a[120:123], a[76:79], v[248:251]
    v_mfma_f32_16x16x32_bf16 a[224:227], a[120:123], a[80:83], a[224:227]
    v_mfma_f32_16x16x32_bf16 a[232:235], a[120:123], a[84:87], a[232:235]
    v_mfma_f32_16x16x32_bf16 a[240:243], a[120:123], a[88:91], a[240:243]
    v_mfma_f32_16x16x32_bf16 a[248:251], a[120:123], a[92:95], a[248:251]
    v_mfma_f32_16x16x32_bf16 a[252:255], a[124:127], a[92:95], a[252:255]
    v_mfma_f32_16x16x32_bf16 a[244:247], a[124:127], a[88:91], a[244:247]
    buffer_load_dword a202, v4, s[68:71], s74 offen
    v_mfma_f32_16x16x32_bf16 a[236:239], a[124:127], a[84:87], a[236:239]
    s_add_u32 s74, s74, s80
    v_mfma_f32_16x16x32_bf16 a[228:231], a[124:127], a[80:83], a[228:231]
    v_mfma_f32_16x16x32_bf16 v[252:255], a[124:127], a[76:79], v[252:255]
    v_mfma_f32_16x16x32_bf16 v[244:247], a[124:127], a[72:75], v[244:247]
    v_mfma_f32_16x16x32_bf16 v[236:239], a[124:127], a[68:71], v[236:239]
    v_mfma_f32_16x16x32_bf16 v[228:231], a[124:127], a[64:67], v[228:231]
    s_waitcnt vmcnt(19)
    s_waitcnt lgkmcnt(0)
    s_barrier
    v_mfma_f32_16x16x32_bf16 v[32:35], a[32:35], a[0:3], v[32:35]
    v_mfma_f32_16x16x32_bf16 v[40:43], a[32:35], a[4:7], v[40:43]
    v_mfma_f32_16x16x32_bf16 v[48:51], a[32:35], a[8:11], v[48:51]
    s_add_u32 m0, s30, 32768
    v_mfma_f32_16x16x32_bf16 v[56:59], a[32:35], a[12:15], v[56:59]
    ds_read_b64_tr_b16 a[64:65], v5 offset:49152
    v_mfma_f32_16x16x32_bf16 v[64:67], a[32:35], a[16:19], v[64:67]
    buffer_load_dwordx4 v17, s[12:15], s24 offen offset:0 sc1 lds
    v_mfma_f32_16x16x32_bf16 v[72:75], a[32:35], a[20:23], v[72:75]
    ds_read_b64_tr_b16 a[66:67], v5 offset:50176
    v_mfma_f32_16x16x32_bf16 v[80:83], a[32:35], a[24:27], v[80:83]
    v_mfma_f32_16x16x32_bf16 v[88:91], a[32:35], a[28:31], v[88:91]
    ds_read_b128 a[96:99], v14 offset:0
    v_mfma_f32_16x16x32_bf16 v[92:95], a[36:39], a[28:31], v[92:95]
    v_mfma_f32_16x16x32_bf16 v[84:87], a[36:39], a[24:27], v[84:87]
    ds_read_b64_tr_b16 a[68:69], v6 offset:49152
    v_mfma_f32_16x16x32_bf16 v[76:79], a[36:39], a[20:23], v[76:79]
    buffer_load_dwordx4 v18, s[12:15], s24 offen offset:1024 sc1 lds
    v_mfma_f32_16x16x32_bf16 v[68:71], a[36:39], a[16:19], v[68:71]
    ds_read_b64_tr_b16 a[70:71], v6 offset:50176
    v_mfma_f32_16x16x32_bf16 v[60:63], a[36:39], a[12:15], v[60:63]
    v_mfma_f32_16x16x32_bf16 v[52:55], a[36:39], a[8:11], v[52:55]
    ds_read_b128 a[100:103], v14 offset:2048
    v_mfma_f32_16x16x32_bf16 v[44:47], a[36:39], a[4:7], v[44:47]
    v_mfma_f32_16x16x32_bf16 v[36:39], a[36:39], a[0:3], v[36:39]
    ds_read_b64_tr_b16 a[72:73], v7 offset:49152
    v_mfma_f32_16x16x32_bf16 v[96:99], a[40:43], a[0:3], v[96:99]
    buffer_load_dwordx4 v19, s[12:15], s24 offen offset:2048 sc1 lds
    v_mfma_f32_16x16x32_bf16 v[104:107], a[40:43], a[4:7], v[104:107]
    ds_read_b64_tr_b16 a[74:75], v7 offset:50176
    v_mfma_f32_16x16x32_bf16 v[112:115], a[40:43], a[8:11], v[112:115]
    v_mfma_f32_16x16x32_bf16 v[120:123], a[40:43], a[12:15], v[120:123]
    ds_read_b128 a[104:107], v14 offset:4096
    v_mfma_f32_16x16x32_bf16 v[128:131], a[40:43], a[16:19], v[128:131]
    v_mfma_f32_16x16x32_bf16 v[136:139], a[40:43], a[20:23], v[136:139]
    ds_read_b64_tr_b16 a[76:77], v8 offset:49152
    v_mfma_f32_16x16x32_bf16 v[144:147], a[40:43], a[24:27], v[144:147]
    buffer_load_dwordx4 v20, s[12:15], s24 offen offset:3072 sc1 lds
    v_mfma_f32_16x16x32_bf16 v[152:155], a[40:43], a[28:31], v[152:155]
    ds_read_b64_tr_b16 a[78:79], v8 offset:50176
    v_mfma_f32_16x16x32_bf16 v[156:159], a[44:47], a[28:31], v[156:159]
    s_add_u32 s24, s24, 262144
    s_add_u32 s31, s25, 65536
    v_mfma_f32_16x16x32_bf16 v[148:151], a[44:47], a[24:27], v[148:151]
    ds_read_b128 a[108:111], v14 offset:6144
    v_mfma_f32_16x16x32_bf16 v[140:143], a[44:47], a[20:23], v[140:143]
    s_add_u32 m0, s26, 4096
    v_mfma_f32_16x16x32_bf16 v[132:135], a[44:47], a[16:19], v[132:135]
    ds_read_b64_tr_b16 a[80:81], v9 offset:49152
    v_mfma_f32_16x16x32_bf16 v[124:127], a[44:47], a[12:15], v[124:127]
    buffer_load_dwordx4 v21, s[8:11], s31 offen offset:0 sc1 lds
    v_mfma_f32_16x16x32_bf16 v[116:119], a[44:47], a[8:11], v[116:119]
    ds_read_b64_tr_b16 a[82:83], v9 offset:50176
    v_mfma_f32_16x16x32_bf16 v[108:111], a[44:47], a[4:7], v[108:111]
    v_mfma_f32_16x16x32_bf16 v[100:103], a[44:47], a[0:3], v[100:103]
    ds_read_b128 a[112:115], v14 offset:8192
    v_mfma_f32_16x16x32_bf16 v[160:163], a[48:51], a[0:3], v[160:163]
    v_mfma_f32_16x16x32_bf16 v[168:171], a[48:51], a[4:7], v[168:171]
    ds_read_b64_tr_b16 a[84:85], v10 offset:49152
    v_mfma_f32_16x16x32_bf16 v[176:179], a[48:51], a[8:11], v[176:179]
    buffer_load_dwordx4 v22, s[8:11], s31 offen offset:1024 sc1 lds
    v_mfma_f32_16x16x32_bf16 v[184:187], a[48:51], a[12:15], v[184:187]
    ds_read_b64_tr_b16 a[86:87], v10 offset:50176
    v_mfma_f32_16x16x32_bf16 v[192:195], a[48:51], a[16:19], v[192:195]
    v_mfma_f32_16x16x32_bf16 v[200:203], a[48:51], a[20:23], v[200:203]
    ds_read_b128 a[116:119], v14 offset:10240
    v_mfma_f32_16x16x32_bf16 v[208:211], a[48:51], a[24:27], v[208:211]
    v_mfma_f32_16x16x32_bf16 v[216:219], a[48:51], a[28:31], v[216:219]
    ds_read_b64_tr_b16 a[88:89], v11 offset:49152
    v_mfma_f32_16x16x32_bf16 v[220:223], a[52:55], a[28:31], v[220:223]
    buffer_load_dwordx4 v23, s[8:11], s31 offen offset:2048 sc1 lds
    v_mfma_f32_16x16x32_bf16 v[212:215], a[52:55], a[24:27], v[212:215]
    ds_read_b64_tr_b16 a[90:91], v11 offset:50176
    v_mfma_f32_16x16x32_bf16 v[204:207], a[52:55], a[20:23], v[204:207]
    v_mfma_f32_16x16x32_bf16 v[196:199], a[52:55], a[16:19], v[196:199]
    ds_read_b128 a[120:123], v14 offset:12288
    v_mfma_f32_16x16x32_bf16 v[188:191], a[52:55], a[12:15], v[188:191]
    v_mfma_f32_16x16x32_bf16 v[180:183], a[52:55], a[8:11], v[180:183]
    ds_read_b64_tr_b16 a[92:93], v12 offset:49152
    v_mfma_f32_16x16x32_bf16 v[172:175], a[52:55], a[4:7], v[172:175]
    buffer_load_dwordx4 v24, s[8:11], s31 offen offset:3072 sc1 lds
    v_mfma_f32_16x16x32_bf16 v[164:167], a[52:55], a[0:3], v[164:167]
    ds_read_b64_tr_b16 a[94:95], v12 offset:50176
    v_mfma_f32_16x16x32_bf16 v[224:227], a[56:59], a[0:3], v[224:227]
    v_mfma_f32_16x16x32_bf16 v[232:235], a[56:59], a[4:7], v[232:235]
    ds_read_b128 a[124:127], v14 offset:14336
    v_mfma_f32_16x16x32_bf16 v[240:243], a[56:59], a[8:11], v[240:243]
    s_add_u32 s25, s25, 128
    s_add_u32 s29, s29, 1
    v_mfma_f32_16x16x32_bf16 v[248:251], a[56:59], a[12:15], v[248:251]
    v_mfma_f32_16x16x32_bf16 a[224:227], a[56:59], a[16:19], a[224:227]
    s_cmp_ge_u32 s29, 16
    s_cselect_b32 s25, 1073741824, s25
    v_mfma_f32_16x16x32_bf16 a[232:235], a[56:59], a[20:23], a[232:235]
    v_mfma_f32_16x16x32_bf16 a[240:243], a[56:59], a[24:27], a[240:243]
    s_add_u32 s26, s26, 32768
    s_cmp_eq_u32 s26, s65
    v_mfma_f32_16x16x32_bf16 a[248:251], a[56:59], a[28:31], a[248:251]
    s_cselect_b32 s26, s64, s26
    v_mfma_f32_16x16x32_bf16 a[252:255], a[60:63], a[28:31], a[252:255]
    v_mfma_f32_16x16x32_bf16 a[244:247], a[60:63], a[24:27], a[244:247]
    buffer_load_dword a203, v4, s[68:71], s74 offen
    v_mfma_f32_16x16x32_bf16 a[236:239], a[60:63], a[20:23], a[236:239]
    s_add_u32 s74, s74, s80
    v_mfma_f32_16x16x32_bf16 a[228:231], a[60:63], a[16:19], a[228:231]
    v_mfma_f32_16x16x32_bf16 v[252:255], a[60:63], a[12:15], v[252:255]
    v_mfma_f32_16x16x32_bf16 v[244:247], a[60:63], a[8:11], v[244:247]
    v_mfma_f32_16x16x32_bf16 v[236:239], a[60:63], a[4:7], v[236:239]
    v_mfma_f32_16x16x32_bf16 v[228:231], a[60:63], a[0:3], v[228:231]
    s_waitcnt vmcnt(19)
    s_waitcnt lgkmcnt(0)
    s_barrier
    v_mfma_f32_16x16x32_bf16 v[32:35], a[96:99], a[64:67], v[32:35]
    s_add_u32 s27, s27, 32768
    s_cmp_eq_u32 s27, 98304
    v_mfma_f32_16x16x32_bf16 v[40:43], a[96:99], a[68:71], v[40:43]
    s_cselect_b32 s27, 0, s27
    v_add_u32 v13, s27, v15
    v_mfma_f32_16x16x32_bf16 v[48:51], a[96:99], a[72:75], v[48:51]
    v_add_u32 v14, s27, v16
    s_add_u32 m0, s30, 49152
    v_mfma_f32_16x16x32_bf16 v[56:59], a[96:99], a[76:79], v[56:59]
    ds_read_b64_tr_b16 a[0:1], v5 offset:0
    v_mfma_f32_16x16x32_bf16 v[64:67], a[96:99], a[80:83], v[64:67]
    buffer_load_dwordx4 v17, s[12:15], s24 offen offset:0 sc1 lds
    v_mfma_f32_16x16x32_bf16 v[72:75], a[96:99], a[84:87], v[72:75]
    ds_read_b64_tr_b16 a[2:3], v5 offset:1024
    v_mfma_f32_16x16x32_bf16 v[80:83], a[96:99], a[88:91], v[80:83]
    v_mfma_f32_16x16x32_bf16 v[88:91], a[96:99], a[92:95], v[88:91]
    ds_read_b128 a[32:35], v13 offset:0
    v_mfma_f32_16x16x32_bf16 v[92:95], a[100:103], a[92:95], v[92:95]
    v_mfma_f32_16x16x32_bf16 v[84:87], a[100:103], a[88:91], v[84:87]
    ds_read_b64_tr_b16 a[4:5], v6 offset:0
    v_mfma_f32_16x16x32_bf16 v[76:79], a[100:103], a[84:87], v[76:79]
    buffer_load_dwordx4 v18, s[12:15], s24 offen offset:1024 sc1 lds
    v_mfma_f32_16x16x32_bf16 v[68:71], a[100:103], a[80:83], v[68:71]
    ds_read_b64_tr_b16 a[6:7], v6 offset:1024
    v_mfma_f32_16x16x32_bf16 v[60:63], a[100:103], a[76:79], v[60:63]
    v_mfma_f32_16x16x32_bf16 v[52:55], a[100:103], a[72:75], v[52:55]
    ds_read_b128 a[36:39], v13 offset:2048
    v_mfma_f32_16x16x32_bf16 v[44:47], a[100:103], a[68:71], v[44:47]
    v_mfma_f32_16x16x32_bf16 v[36:39], a[100:103], a[64:67], v[36:39]
    ds_read_b64_tr_b16 a[8:9], v7 offset:0
    v_mfma_f32_16x16x32_bf16 v[96:99], a[104:107], a[64:67], v[96:99]
    buffer_load_dwordx4 v19, s[12:15], s24 offen offset:2048 sc1 lds
    v_mfma_f32_16x16x32_bf16 v[104:107], a[104:107], a[68:71], v[104:107]
    ds_read_b64_tr_b16 a[10:11], v7 offset:1024
    v_mfma_f32_16x16x32_bf16 v[112:115], a[104:107], a[72:75], v[112:115]
    v_mfma_f32_16x16x32_bf16 v[120:123], a[104:107], a[76:79], v[120:123]
    ds_read_b128 a[40:43], v13 offset:4096
    v_mfma_f32_16x16x32_bf16 v[128:131], a[104:107], a[80:83], v[128:131]
    v_mfma_f32_16x16x32_bf16 v[136:139], a[104:107], a[84:87], v[136:139]
    ds_read_b64_tr_b16 a[12:13], v8 offset:0
    v_mfma_f32_16x16x32_bf16 v[144:147], a[104:107], a[88:91], v[144:147]
    buffer_load_dwordx4 v20, s[12:15], s24 offen offset:3072 sc1 lds
    v_mfma_f32_16x16x32_bf16 v[152:155], a[104:107], a[92:95], v[152:155]
    ds_read_b64_tr_b16 a[14:15], v8 offset:1024
    v_mfma_f32_16x16x32_bf16 v[156:159], a[108:111], a[92:95], v[156:159]
    s_add_u32 s24, s24, 262144
    v_mfma_f32_16x16x32_bf16 v[148:151], a[108:111], a[88:91], v[148:151]
    ds_read_b128 a[44:47], v13 offset:6144
    v_mfma_f32_16x16x32_bf16 v[140:143], a[108:111], a[84:87], v[140:143]
    s_mov_b32 m0, s26
    v_mfma_f32_16x16x32_bf16 v[132:135], a[108:111], a[80:83], v[132:135]
    ds_read_b64_tr_b16 a[16:17], v9 offset:0
    v_mfma_f32_16x16x32_bf16 v[124:127], a[108:111], a[76:79], v[124:127]
    buffer_load_dwordx4 v21, s[8:11], s25 offen offset:0 sc1 lds
    v_mfma_f32_16x16x32_bf16 v[116:119], a[108:111], a[72:75], v[116:119]
    ds_read_b64_tr_b16 a[18:19], v9 offset:1024
    v_mfma_f32_16x16x32_bf16 v[108:111], a[108:111], a[68:71], v[108:111]
    v_mfma_f32_16x16x32_bf16 v[100:103], a[108:111], a[64:67], v[100:103]
    ds_read_b128 a[48:51], v13 offset:8192
    v_mfma_f32_16x16x32_bf16 v[160:163], a[112:115], a[64:67], v[160:163]
    v_mfma_f32_16x16x32_bf16 v[168:171], a[112:115], a[68:71], v[168:171]
    ds_read_b64_tr_b16 a[20:21], v10 offset:0
    v_mfma_f32_16x16x32_bf16 v[176:179], a[112:115], a[72:75], v[176:179]
    buffer_load_dwordx4 v22, s[8:11], s25 offen offset:1024 sc1 lds
    v_mfma_f32_16x16x32_bf16 v[184:187], a[112:115], a[76:79], v[184:187]
    ds_read_b64_tr_b16 a[22:23], v10 offset:1024
    v_mfma_f32_16x16x32_bf16 v[192:195], a[112:115], a[80:83], v[192:195]
    v_mfma_f32_16x16x32_bf16 v[200:203], a[112:115], a[84:87], v[200:203]
    ds_read_b128 a[52:55], v13 offset:10240
    v_mfma_f32_16x16x32_bf16 v[208:211], a[112:115], a[88:91], v[208:211]
    v_mfma_f32_16x16x32_bf16 v[216:219], a[112:115], a[92:95], v[216:219]
    ds_read_b64_tr_b16 a[24:25], v11 offset:0
    v_mfma_f32_16x16x32_bf16 v[220:223], a[116:119], a[92:95], v[220:223]
    buffer_load_dwordx4 v23, s[8:11], s25 offen offset:2048 sc1 lds
    v_mfma_f32_16x16x32_bf16 v[212:215], a[116:119], a[88:91], v[212:215]
    ds_read_b64_tr_b16 a[26:27], v11 offset:1024
    v_mfma_f32_16x16x32_bf16 v[204:207], a[116:119], a[84:87], v[204:207]
    v_mfma_f32_16x16x32_bf16 v[196:199], a[116:119], a[80:83], v[196:199]
    ds_read_b128 a[56:59], v13 offset:12288
    v_mfma_f32_16x16x32_bf16 v[188:191], a[116:119], a[76:79], v[188:191]
    v_mfma_f32_16x16x32_bf16 v[180:183], a[116:119], a[72:75], v[180:183]
    ds_read_b64_tr_b16 a[28:29], v12 offset:0
    v_mfma_f32_16x16x32_bf16 v[172:175], a[116:119], a[68:71], v[172:175]
    buffer_load_dwordx4 v24, s[8:11], s25 offen offset:3072 sc1 lds
    v_mfma_f32_16x16x32_bf16 v[164:167], a[116:119], a[64:67], v[164:167]
    ds_read_b64_tr_b16 a[30:31], v12 offset:1024
    v_mfma_f32_16x16x32_bf16 v[224:227], a[120:123], a[64:67], v[224:227]
    v_mfma_f32_16x16x32_bf16 v[232:235], a[120:123], a[68:71], v[232:235]
    ds_read_b128 a[60:63], v13 offset:14336
    v_mfma_f32_16x16x32_bf16 v[240:243], a[120:123], a[72:75], v[240:243]
    v_mfma_f32_16x16x32_bf16 v[248:251], a[120:123], a[76:79], v[248:251]
    v_mfma_f32_16x16x32_bf16 a[224:227], a[120:123], a[80:83], a[224:227]
    v_mfma_f32_16x16x32_bf16 a[232:235], a[120:123], a[84:87], a[232:235]
    v_mfma_f32_16x16x32_bf16 a[240:243], a[120:123], a[88:91], a[240:243]
    v_mfma_f32_16x16x32_bf16 a[248:251], a[120:123], a[92:95], a[248:251]
    v_mfma_f32_16x16x32_bf16 a[252:255], a[124:127], a[92:95], a[252:255]
    v_mfma_f32_16x16x32_bf16 a[244:247], a[124:127], a[88:91], a[244:247]
    buffer_load_dword a204, v4, s[68:71], s74 offen
    v_mfma_f32_16x16x32_bf16 a[236:239], a[124:127], a[84:87], a[236:239]
    s_add_u32 s74, s74, s80
    v_mfma_f32_16x16x32_bf16 a[228:231], a[124:127], a[80:83], a[228:231]
    s_add_u32 s28, s28, 1
    s_cmp_ge_u32 s28, s83
    v_mfma_f32_16x16x32_bf16 v[252:255], a[124:127], a[76:79], v[252:255]
    s_cselect_b32 s80, s81, 0
    s_cselect_b32 s70, s82, 0
    v_mfma_f32_16x16x32_bf16 v[244:247], a[124:127], a[72:75], v[244:247]
    s_cmp_lt_u32 s28, 7
    v_mfma_f32_16x16x32_bf16 v[236:239], a[124:127], a[68:71], v[236:239]
    v_mfma_f32_16x16x32_bf16 v[228:231], a[124:127], a[64:67], v[228:231]
    s_cbranch_scc1 pj_vloop
pj_vloop_end:
    s_mov_b32 s12, s36
    s_mov_b32 s13, s37
    s_mov_b32 s14, 3670016
    s_mov_b32 s15, 0x20000
    s_mov_b32 s8, s32
    s_mov_b32 s9, s33
    s_mov_b32 s10, 1835008
    s_mov_b32 s11, 0x20000
    s_mov_b32 s24, s66
    s_lshl_b32 s25, s22, 2
    s_add_u32 s25, s25, s20
    s_mul_i32 s25, s25, 28672
    s_waitcnt vmcnt(19)
    s_waitcnt lgkmcnt(0)
    s_barrier
    v_mfma_f32_16x16x32_bf16 v[32:35], a[32:35], a[0:3], v[32:35]
    v_lshrrev_b32 v2, 3, v1
    v_mfma_f32_16x16x32_bf16 v[40:43], a[32:35], a[4:7], v[40:43]
    v_mfma_f32_16x16x32_bf16 v[48:51], a[32:35], a[8:11], v[48:51]
    s_add_u32 m0, s30, 0
    v_and_b32 v3, 6, v2
    v_mfma_f32_16x16x32_bf16 v[56:59], a[32:35], a[12:15], v[56:59]
    ds_read_b64_tr_b16 a[64:65], v5 offset:16384
    v_mfma_f32_16x16x32_bf16 v[64:67], a[32:35], a[16:19], v[64:67]
    buffer_load_dwordx4 v17, s[12:15], s24 offen offset:0 sc1 lds
    v_and_b32 v4, 7, v1
    v_mfma_f32_16x16x32_bf16 v[72:75], a[32:35], a[20:23], v[72:75]
    ds_read_b64_tr_b16 a[66:67], v5 offset:17408
    v_mfma_f32_16x16x32_bf16 v[80:83], a[32:35], a[24:27], v[80:83]
    v_mfma_f32_16x16x32_bf16 v[88:91], a[32:35], a[28:31], v[88:91]
    ds_read_b128 a[96:99], v14 offset:0
    v_xor_b32 v3, v3, v4
    v_mfma_f32_16x16x32_bf16 v[92:95], a[36:39], a[28:31], v[92:95]
    v_mfma_f32_16x16x32_bf16 v[84:87], a[36:39], a[24:27], v[84:87]
    ds_read_b64_tr_b16 a[68:69], v6 offset:16384
    v_lshlrev_b32 v3, 4, v3
    v_mfma_f32_16x16x32_bf16 v[76:79], a[36:39], a[20:23], v[76:79]
    buffer_load_dwordx4 v18, s[12:15], s24 offen offset:1024 sc1 lds
    v_mfma_f32_16x16x32_bf16 v[68:71], a[36:39], a[16:19], v[68:71]
    ds_read_b64_tr_b16 a[70:71], v6 offset:17408
    v_mfma_f32_16x16x32_bf16 v[60:63], a[36:39], a[12:15], v[60:63]
    v_mul_u32_u24 v2, 896, v2
    v_mfma_f32_16x16x32_bf16 v[52:55], a[36:39], a[8:11], v[52:55]
    ds_read_b128 a[100:103], v14 offset:2048
    v_mfma_f32_16x16x32_bf16 v[44:47], a[36:39], a[4:7], v[44:47]
    v_add_u32 v21, v2, v3
    v_mfma_f32_16x16x32_bf16 v[36:39], a[36:39], a[0:3], v[36:39]
    ds_read_b64_tr_b16 a[72:73], v7 offset:16384
    v_mfma_f32_16x16x32_bf16 v[96:99], a[40:43], a[0:3], v[96:99]
    buffer_load_dwordx4 v19, s[12:15], s24 offen offset:2048 sc1 lds
    v_add_u32 v22, 6144, v21
    v_mfma_f32_16x16x32_bf16 v[104:107], a[40:43], a[4:7], v[104:107]
    ds_read_b64_tr_b16 a[74:75], v7 offset:17408
    v_mfma_f32_16x16x32_bf16 v[112:115], a[40:43], a[8:11], v[112:115]
    v_mfma_f32_16x16x32_bf16 v[120:123], a[40:43], a[12:15], v[120:123]
    ds_read_b128 a[104:107], v14 offset:4096
    v_add_u32 v23, 12288, v21
    v_mfma_f32_16x16x32_bf16 v[128:131], a[40:43], a[16:19], v[128:131]
    v_mfma_f32_16x16x32_bf16 v[136:139], a[40:43], a[20:23], v[136:139]
    ds_read_b64_tr_b16 a[76:77], v8 offset:16384
    v_add_u32 v24, 18432, v21
    v_mfma_f32_16x16x32_bf16 v[144:147], a[40:43], a[24:27], v[144:147]
    buffer_load_dwordx4 v20, s[12:15], s24 offen offset:3072 sc1 lds
    v_mfma_f32_16x16x32_bf16 v[152:155], a[40:43], a[28:31], v[152:155]
    ds_read_b64_tr_b16 a[78:79], v8 offset:17408
    v_mfma_f32_16x16x32_bf16 v[156:159], a[44:47], a[28:31], v[156:159]
    s_add_u32 s24, s24, 262144
    v_mfma_f32_16x16x32_bf16 v[148:151], a[44:47], a[24:27], v[148:151]
    ds_read_b128 a[108:111], v14 offset:6144
    v_mfma_f32_16x16x32_bf16 v[140:143], a[44:47], a[20:23], v[140:143]
    s_getpc_b64 s[96:97]
pc_5:
    s_add_u32 s96, s96, pj_kvdone-pc_5
    s_addc_u32 s97, s97, 0
    v_mfma_f32_16x16x32_bf16 v[132:135], a[44:47], a[16:19], v[132:135]
    ds_read_b64_tr_b16 a[80:81], v9 offset:16384
    v_mfma_f32_16x16x32_bf16 v[124:127], a[44:47], a[12:15], v[124:127]
    v_mfma_f32_16x16x32_bf16 v[116:119], a[44:47], a[8:11], v[116:119]
    ds_read_b64_tr_b16 a[82:83], v9 offset:17408
    s_lshr_b32 s98, s2, 3
    v_mfma_f32_16x16x32_bf16 v[108:111], a[44:47], a[4:7], v[108:111]
    v_mfma_f32_16x16x32_bf16 v[100:103], a[44:47], a[0:3], v[100:103]
    ds_read_b128 a[112:115], v14 offset:8192
    v_mfma_f32_16x16x32_bf16 v[160:163], a[48:51], a[0:3], v[160:163]
    v_mfma_f32_16x16x32_bf16 v[168:171], a[48:51], a[4:7], v[168:171]
    ds_read_b64_tr_b16 a[84:85], v10 offset:16384
    s_lshl_b32 s98, s98, 8
    v_mfma_f32_16x16x32_bf16 v[176:179], a[48:51], a[8:11], v[176:179]
    v_mfma_f32_16x16x32_bf16 v[184:187], a[48:51], a[12:15], v[184:187]
    ds_read_b64_tr_b16 a[86:87], v10 offset:17408
    v_mfma_f32_16x16x32_bf16 v[192:195], a[48:51], a[16:19], v[192:195]
    v_mfma_f32_16x16x32_bf16 v[200:203], a[48:51], a[20:23], v[200:203]
    ds_read_b128 a[116:119], v14 offset:10240
    v_add_u32 v2, s98, v0
    v_mfma_f32_16x16x32_bf16 v[208:211], a[48:51], a[24:27], v[208:211]
    v_mfma_f32_16x16x32_bf16 v[216:219], a[48:51], a[28:31], v[216:219]
    ds_read_b64_tr_b16 a[88:89], v11 offset:16384
    v_mfma_f32_16x16x32_bf16 v[220:223], a[52:55], a[28:31], v[220:223]
    v_and_b32 v2, 0x1ff, v2
    v_mfma_f32_16x16x32_bf16 v[212:215], a[52:55], a[24:27], v[212:215]
    ds_read_b64_tr_b16 a[90:91], v11 offset:17408
    v_mfma_f32_16x16x32_bf16 v[204:207], a[52:55], a[20:23], v[204:207]
    v_mfma_f32_16x16x32_bf16 v[196:199], a[52:55], a[16:19], v[196:199]
    ds_read_b128 a[120:123], v14 offset:12288
    v_mfma_f32_16x16x32_bf16 v[188:191], a[52:55], a[12:15], v[188:191]
    v_lshlrev_b32 v2, 7, v2
    v_mfma_f32_16x16x32_bf16 v[180:183], a[52:55], a[8:11], v[180:183]
    ds_read_b64_tr_b16 a[92:93], v12 offset:16384
    v_mfma_f32_16x16x32_bf16 v[172:175], a[52:55], a[4:7], v[172:175]
    v_mfma_f32_16x16x32_bf16 v[164:167], a[52:55], a[0:3], v[164:167]
    ds_read_b64_tr_b16 a[94:95], v12 offset:17408
    v_mfma_f32_16x16x32_bf16 v[224:227], a[56:59], a[0:3], v[224:227]
    v_min_u32 v2, kernel_last-pj_kvdone-4, v2
    v_mfma_f32_16x16x32_bf16 v[232:235], a[56:59], a[4:7], v[232:235]
    ds_read_b128 a[124:127], v14 offset:14336
    v_mfma_f32_16x16x32_bf16 v[240:243], a[56:59], a[8:11], v[240:243]
    v_mfma_f32_16x16x32_bf16 v[248:251], a[56:59], a[12:15], v[248:251]
    v_mov_b32 v3, s97
    v_mfma_f32_16x16x32_bf16 a[224:227], a[56:59], a[16:19], a[224:227]
    v_mfma_f32_16x16x32_bf16 a[232:235], a[56:59], a[20:23], a[232:235]
    v_mfma_f32_16x16x32_bf16 a[240:243], a[56:59], a[24:27], a[240:243]
    v_mfma_f32_16x16x32_bf16 a[248:251], a[56:59], a[28:31], a[248:251]
    v_add_co_u32 v2, vcc, s96, v2
    s_nop 1
    v_addc_co_u32 v3, vcc, 0, v3, vcc
    v_mfma_f32_16x16x32_bf16 a[252:255], a[60:63], a[28:31], a[252:255]
    v_mfma_f32_16x16x32_bf16 a[244:247], a[60:63], a[24:27], a[244:247]
    v_mfma_f32_16x16x32_bf16 a[236:239], a[60:63], a[20:23], a[236:239]
    v_mfma_f32_16x16x32_bf16 a[228:231], a[60:63], a[16:19], a[228:231]
    global_load_dword a206, v[2:3], off
    v_mfma_f32_16x16x32_bf16 v[252:255], a[60:63], a[12:15], v[252:255]
    v_mfma_f32_16x16x32_bf16 v[244:247], a[60:63], a[8:11], v[244:247]
    v_mfma_f32_16x16x32_bf16 v[236:239], a[60:63], a[4:7], v[236:239]
    v_mfma_f32_16x16x32_bf16 v[228:231], a[60:63], a[0:3], v[228:231]
    s_waitcnt vmcnt(15)
    s_waitcnt lgkmcnt(0)
    s_barrier
    v_mfma_f32_16x16x32_bf16 v[32:35], a[96:99], a[64:67], v[32:35]
    s_add_u32 s27, s27, 32768
    s_cmp_eq_u32 s27, 98304
    v_mfma_f32_16x16x32_bf16 v[40:43], a[96:99], a[68:71], v[40:43]
    s_cselect_b32 s27, 0, s27
    v_add_u32 v13, s27, v15
    v_mfma_f32_16x16x32_bf16 v[48:51], a[96:99], a[72:75], v[48:51]
    v_add_u32 v14, s27, v16
    s_add_u32 m0, s30, 16384
    v_mfma_f32_16x16x32_bf16 v[56:59], a[96:99], a[76:79], v[56:59]
    ds_read_b64_tr_b16 a[0:1], v5 offset:32768
    v_mfma_f32_16x16x32_bf16 v[64:67], a[96:99], a[80:83], v[64:67]
    buffer_load_dwordx4 v17, s[12:15], s24 offen offset:0 sc1 lds
    v_mfma_f32_16x16x32_bf16 v[72:75], a[96:99], a[84:87], v[72:75]
    ds_read_b64_tr_b16 a[2:3], v5 offset:33792
    v_mfma_f32_16x16x32_bf16 v[80:83], a[96:99], a[88:91], v[80:83]
    v_mfma_f32_16x16x32_bf16 v[88:91], a[96:99], a[92:95], v[88:91]
    ds_read_b128 a[32:35], v13 offset:0
    v_mfma_f32_16x16x32_bf16 v[92:95], a[100:103], a[92:95], v[92:95]
    v_mfma_f32_16x16x32_bf16 v[84:87], a[100:103], a[88:91], v[84:87]
    ds_read_b64_tr_b16 a[4:5], v6 offset:32768
    v_mfma_f32_16x16x32_bf16 v[76:79], a[100:103], a[84:87], v[76:79]
    buffer_load_dwordx4 v18, s[12:15], s24 offen offset:1024 sc1 lds
    v_mfma_f32_16x16x32_bf16 v[68:71], a[100:103], a[80:83], v[68:71]
    ds_read_b64_tr_b16 a[6:7], v6 offset:33792
    v_mfma_f32_16x16x32_bf16 v[60:63], a[100:103], a[76:79], v[60:63]
    v_mfma_f32_16x16x32_bf16 v[52:55], a[100:103], a[72:75], v[52:55]
    ds_read_b128 a[36:39], v13 offset:2048
    v_mfma_f32_16x16x32_bf16 v[44:47], a[100:103], a[68:71], v[44:47]
    v_mfma_f32_16x16x32_bf16 v[36:39], a[100:103], a[64:67], v[36:39]
    ds_read_b64_tr_b16 a[8:9], v7 offset:32768
    v_mfma_f32_16x16x32_bf16 v[96:99], a[104:107], a[64:67], v[96:99]
    buffer_load_dwordx4 v19, s[12:15], s24 offen offset:2048 sc1 lds
    v_mfma_f32_16x16x32_bf16 v[104:107], a[104:107], a[68:71], v[104:107]
    ds_read_b64_tr_b16 a[10:11], v7 offset:33792
    v_mfma_f32_16x16x32_bf16 v[112:115], a[104:107], a[72:75], v[112:115]
    v_mfma_f32_16x16x32_bf16 v[120:123], a[104:107], a[76:79], v[120:123]
    ds_read_b128 a[40:43], v13 offset:4096
    v_mfma_f32_16x16x32_bf16 v[128:131], a[104:107], a[80:83], v[128:131]
    v_mfma_f32_16x16x32_bf16 v[136:139], a[104:107], a[84:87], v[136:139]
    ds_read_b64_tr_b16 a[12:13], v8 offset:32768
    v_mfma_f32_16x16x32_bf16 v[144:147], a[104:107], a[88:91], v[144:147]
    buffer_load_dwordx4 v20, s[12:15], s24 offen offset:3072 sc1 lds
    v_mfma_f32_16x16x32_bf16 v[152:155], a[104:107], a[92:95], v[152:155]
    ds_read_b64_tr_b16 a[14:15], v8 offset:33792
    v_mfma_f32_16x16x32_bf16 v[156:159], a[108:111], a[92:95], v[156:159]
    s_add_u32 s24, s24, 262144
    v_mfma_f32_16x16x32_bf16 v[148:151], a[108:111], a[88:91], v[148:151]
    ds_read_b128 a[44:47], v13 offset:6144
    v_mfma_f32_16x16x32_bf16 v[140:143], a[108:111], a[84:87], v[140:143]
    s_add_u32 m0, s75, 32768
    v_mfma_f32_16x16x32_bf16 v[132:135], a[108:111], a[80:83], v[132:135]
    ds_read_b64_tr_b16 a[16:17], v9 offset:32768
    buffer_load_dwordx4 v21, s[8:11], s25 offen offset:0 sc1 lds
    v_mfma_f32_16x16x32_bf16 v[124:127], a[108:111], a[76:79], v[124:127]
    v_mfma_f32_16x16x32_bf16 v[116:119], a[108:111], a[72:75], v[116:119]
    ds_read_b64_tr_b16 a[18:19], v9 offset:33792
    v_mfma_f32_16x16x32_bf16 v[108:111], a[108:111], a[68:71], v[108:111]
    v_mfma_f32_16x16x32_bf16 v[100:103], a[108:111], a[64:67], v[100:103]
    ds_read_b128 a[48:51], v13 offset:8192
    buffer_load_dwordx4 v22, s[8:11], s25 offen offset:1024 sc1 lds
    v_mfma_f32_16x16x32_bf16 v[160:163], a[112:115], a[64:67], v[160:163]
    v_mfma_f32_16x16x32_bf16 v[168:171], a[112:115], a[68:71], v[168:171]
    ds_read_b64_tr_b16 a[20:21], v10 offset:32768
    v_mfma_f32_16x16x32_bf16 v[176:179], a[112:115], a[72:75], v[176:179]
    v_mfma_f32_16x16x32_bf16 v[184:187], a[112:115], a[76:79], v[184:187]
    ds_read_b64_tr_b16 a[22:23], v10 offset:33792
    buffer_load_dwordx4 v23, s[8:11], s25 offen offset:2048 sc1 lds
    v_mfma_f32_16x16x32_bf16 v[192:195], a[112:115], a[80:83], v[192:195]
    v_mfma_f32_16x16x32_bf16 v[200:203], a[112:115], a[84:87], v[200:203]
    ds_read_b128 a[52:55], v13 offset:10240
    v_mfma_f32_16x16x32_bf16 v[208:211], a[112:115], a[88:91], v[208:211]
    v_mfma_f32_16x16x32_bf16 v[216:219], a[112:115], a[92:95], v[216:219]
    ds_read_b64_tr_b16 a[24:25], v11 offset:32768
    buffer_load_dwordx4 v24, s[8:11], s25 offen offset:3072 sc1 lds
    v_mfma_f32_16x16x32_bf16 v[220:223], a[116:119], a[92:95], v[220:223]
    v_mfma_f32_16x16x32_bf16 v[212:215], a[116:119], a[88:91], v[212:215]
    ds_read_b64_tr_b16 a[26:27], v11 offset:33792
    v_mfma_f32_16x16x32_bf16 v[204:207], a[116:119], a[84:87], v[204:207]
    v_mfma_f32_16x16x32_bf16 v[196:199], a[116:119], a[80:83], v[196:199]
    ds_read_b128 a[56:59], v13 offset:12288
    s_add_u32 s25, s25, 128
    v_mfma_f32_16x16x32_bf16 v[188:191], a[116:119], a[76:79], v[188:191]
    s_add_u32 m0, s75, 49152
    v_mfma_f32_16x16x32_bf16 v[180:183], a[116:119], a[72:75], v[180:183]
    ds_read_b64_tr_b16 a[28:29], v12 offset:32768
    buffer_load_dwordx4 v21, s[8:11], s25 offen offset:0 sc1 lds
    v_mfma_f32_16x16x32_bf16 v[172:175], a[116:119], a[68:71], v[172:175]
    v_mfma_f32_16x16x32_bf16 v[164:167], a[116:119], a[64:67], v[164:167]
    ds_read_b64_tr_b16 a[30:31], v12 offset:33792
    v_mfma_f32_16x16x32_bf16 v[224:227], a[120:123], a[64:67], v[224:227]
    v_mfma_f32_16x16x32_bf16 v[232:235], a[120:123], a[68:71], v[232:235]
    ds_read_b128 a[60:63], v13 offset:14336
    buffer_load_dwordx4 v22, s[8:11], s25 offen offset:1024 sc1 lds
    v_mfma_f32_16x16x32_bf16 v[240:243], a[120:123], a[72:75], v[240:243]
    v_mfma_f32_16x16x32_bf16 v[248:251], a[120:123], a[76:79], v[248:251]
    v_mfma_f32_16x16x32_bf16 a[224:227], a[120:123], a[80:83], a[224:227]
    v_mfma_f32_16x16x32_bf16 a[232:235], a[120:123], a[84:87], a[232:235]
    buffer_load_dwordx4 v23, s[8:11], s25 offen offset:2048 sc1 lds
    v_mfma_f32_16x16x32_bf16 a[240:243], a[120:123], a[88:91], a[240:243]
    v_mfma_f32_16x16x32_bf16 a[248:251], a[120:123], a[92:95], a[248:251]
    v_mfma_f32_16x16x32_bf16 a[252:255], a[124:127], a[92:95], a[252:255]
    v_mfma_f32_16x16x32_bf16 a[244:247], a[124:127], a[88:91], a[244:247]
    buffer_load_dwordx4 v24, s[8:11], s25 offen offset:3072 sc1 lds
    v_mfma_f32_16x16x32_bf16 a[236:239], a[124:127], a[84:87], a[236:239]
    v_mfma_f32_16x16x32_bf16 a[228:231], a[124:127], a[80:83], a[228:231]
    v_mfma_f32_16x16x32_bf16 v[252:255], a[124:127], a[76:79], v[252:255]
    v_mfma_f32_16x16x32_bf16 v[244:247], a[124:127], a[72:75], v[244:247]
    s_add_u32 s25, s25, 128
    v_mfma_f32_16x16x32_bf16 v[236:239], a[124:127], a[68:71], v[236:239]
    v_mfma_f32_16x16x32_bf16 v[228:231], a[124:127], a[64:67], v[228:231]
    s_waitcnt vmcnt(18)
    s_waitcnt lgkmcnt(0)
    s_barrier
    v_mfma_f32_16x16x32_bf16 v[32:35], a[32:35], a[0:3], v[32:35]
    v_mfma_f32_16x16x32_bf16 v[40:43], a[32:35], a[4:7], v[40:43]
    v_mfma_f32_16x16x32_bf16 v[48:51], a[32:35], a[8:11], v[48:51]
    s_add_u32 m0, s30, 32768
    v_mfma_f32_16x16x32_bf16 v[56:59], a[32:35], a[12:15], v[56:59]
    ds_read_b64_tr_b16 a[64:65], v5 offset:49152
    v_mfma_f32_16x16x32_bf16 v[64:67], a[32:35], a[16:19], v[64:67]
    buffer_load_dwordx4 v17, s[12:15], s24 offen offset:0 sc1 lds
    v_mfma_f32_16x16x32_bf16 v[72:75], a[32:35], a[20:23], v[72:75]
    ds_read_b64_tr_b16 a[66:67], v5 offset:50176
    v_mfma_f32_16x16x32_bf16 v[80:83], a[32:35], a[24:27], v[80:83]
    v_mfma_f32_16x16x32_bf16 v[88:91], a[32:35], a[28:31], v[88:91]
    ds_read_b128 a[96:99], v14 offset:0
    v_mfma_f32_16x16x32_bf16 v[92:95], a[36:39], a[28:31], v[92:95]
    v_mfma_f32_16x16x32_bf16 v[84:87], a[36:39], a[24:27], v[84:87]
    ds_read_b64_tr_b16 a[68:69], v6 offset:49152
    v_mfma_f32_16x16x32_bf16 v[76:79], a[36:39], a[20:23], v[76:79]
    buffer_load_dwordx4 v18, s[12:15], s24 offen offset:1024 sc1 lds
    v_mfma_f32_16x16x32_bf16 v[68:71], a[36:39], a[16:19], v[68:71]
    ds_read_b64_tr_b16 a[70:71], v6 offset:50176
    v_mfma_f32_16x16x32_bf16 v[60:63], a[36:39], a[12:15], v[60:63]
    v_mfma_f32_16x16x32_bf16 v[52:55], a[36:39], a[8:11], v[52:55]
    ds_read_b128 a[100:103], v14 offset:2048
    v_mfma_f32_16x16x32_bf16 v[44:47], a[36:39], a[4:7], v[44:47]
    v_mfma_f32_16x16x32_bf16 v[36:39], a[36:39], a[0:3], v[36:39]
    ds_read_b64_tr_b16 a[72:73], v7 offset:49152
    v_mfma_f32_16x16x32_bf16 v[96:99], a[40:43], a[0:3], v[96:99]
    buffer_load_dwordx4 v19, s[12:15], s24 offen offset:2048 sc1 lds
    v_mfma_f32_16x16x32_bf16 v[104:107], a[40:43], a[4:7], v[104:107]
    ds_read_b64_tr_b16 a[74:75], v7 offset:50176
    v_mfma_f32_16x16x32_bf16 v[112:115], a[40:43], a[8:11], v[112:115]
    v_mfma_f32_16x16x32_bf16 v[120:123], a[40:43], a[12:15], v[120:123]
    ds_read_b128 a[104:107], v14 offset:4096
    v_mfma_f32_16x16x32_bf16 v[128:131], a[40:43], a[16:19], v[128:131]
    v_mfma_f32_16x16x32_bf16 v[136:139], a[40:43], a[20:23], v[136:139]
    ds_read_b64_tr_b16 a[76:77], v8 offset:49152
    v_mfma_f32_16x16x32_bf16 v[144:147], a[40:43], a[24:27], v[144:147]
    buffer_load_dwordx4 v20, s[12:15], s24 offen offset:3072 sc1 lds
    v_mfma_f32_16x16x32_bf16 v[152:155], a[40:43], a[28:31], v[152:155]
    ds_read_b64_tr_b16 a[78:79], v8 offset:50176
    v_mfma_f32_16x16x32_bf16 v[156:159], a[44:47], a[28:31], v[156:159]
    s_add_u32 s24, s24, 262144
    v_mfma_f32_16x16x32_bf16 v[148:151], a[44:47], a[24:27], v[148:151]
    ds_read_b128 a[108:111], v14 offset:6144
    v_mfma_f32_16x16x32_bf16 v[140:143], a[44:47], a[20:23], v[140:143]
    s_add_u32 m0, s75, 0
    v_mfma_f32_16x16x32_bf16 v[132:135], a[44:47], a[16:19], v[132:135]
    ds_read_b64_tr_b16 a[80:81], v9 offset:49152
    buffer_load_dwordx4 v21, s[8:11], s25 offen offset:0 sc1 lds
    v_mfma_f32_16x16x32_bf16 v[124:127], a[44:47], a[12:15], v[124:127]
    v_mfma_f32_16x16x32_bf16 v[116:119], a[44:47], a[8:11], v[116:119]
    ds_read_b64_tr_b16 a[82:83], v9 offset:50176
    v_mfma_f32_16x16x32_bf16 v[108:111], a[44:47], a[4:7], v[108:111]
    v_mfma_f32_16x16x32_bf16 v[100:103], a[44:47], a[0:3], v[100:103]
    ds_read_b128 a[112:115], v14 offset:8192
    buffer_load_dwordx4 v22, s[8:11], s25 offen offset:1024 sc1 lds
    v_mfma_f32_16x16x32_bf16 v[160:163], a[48:51], a[0:3], v[160:163]
    v_mfma_f32_16x16x32_bf16 v[168:171], a[48:51], a[4:7], v[168:171]
    ds_read_b64_tr_b16 a[84:85], v10 offset:49152
    v_mfma_f32_16x16x32_bf16 v[176:179], a[48:51], a[8:11], v[176:179]
    v_mfma_f32_16x16x32_bf16 v[184:187], a[48:51], a[12:15], v[184:187]
    ds_read_b64_tr_b16 a[86:87], v10 offset:50176
    buffer_load_dwordx4 v23, s[8:11], s25 offen offset:2048 sc1 lds
    v_mfma_f32_16x16x32_bf16 v[192:195], a[48:51], a[16:19], v[192:195]
    v_mfma_f32_16x16x32_bf16 v[200:203], a[48:51], a[20:23], v[200:203]
    ds_read_b128 a[116:119], v14 offset:10240
    v_mfma_f32_16x16x32_bf16 v[208:211], a[48:51], a[24:27], v[208:211]
    v_mfma_f32_16x16x32_bf16 v[216:219], a[48:51], a[28:31], v[216:219]
    ds_read_b64_tr_b16 a[88:89], v11 offset:49152
    buffer_load_dwordx4 v24, s[8:11], s25 offen offset:3072 sc1 lds
    v_mfma_f32_16x16x32_bf16 v[220:223], a[52:55], a[28:31], v[220:223]
    v_mfma_f32_16x16x32_bf16 v[212:215], a[52:55], a[24:27], v[212:215]
    ds_read_b64_tr_b16 a[90:91], v11 offset:50176
    v_mfma_f32_16x16x32_bf16 v[204:207], a[52:55], a[20:23], v[204:207]
    v_mfma_f32_16x16x32_bf16 v[196:199], a[52:55], a[16:19], v[196:199]
    ds_read_b128 a[120:123], v14 offset:12288
    s_add_u32 s25, s25, 128
    v_mfma_f32_16x16x32_bf16 v[188:191], a[52:55], a[12:15], v[188:191]
    s_add_u32 m0, s75, 16384
    v_mfma_f32_16x16x32_bf16 v[180:183], a[52:55], a[8:11], v[180:183]
    ds_read_b64_tr_b16 a[92:93], v12 offset:49152
    buffer_load_dwordx4 v21, s[8:11], s25 offen offset:0 sc1 lds
    v_mfma_f32_16x16x32_bf16 v[172:175], a[52:55], a[4:7], v[172:175]
    v_mfma_f32_16x16x32_bf16 v[164:167], a[52:55], a[0:3], v[164:167]
    ds_read_b64_tr_b16 a[94:95], v12 offset:50176
    v_mfma_f32_16x16x32_bf16 v[224:227], a[56:59], a[0:3], v[224:227]
    v_mfma_f32_16x16x32_bf16 v[232:235], a[56:59], a[4:7], v[232:235]
    ds_read_b128 a[124:127], v14 offset:14336
    buffer_load_dwordx4 v22, s[8:11], s25 offen offset:1024 sc1 lds
    v_mfma_f32_16x16x32_bf16 v[240:243], a[56:59], a[8:11], v[240:243]
    v_mfma_f32_16x16x32_bf16 v[248:251], a[56:59], a[12:15], v[248:251]
    v_mfma_f32_16x16x32_bf16 a[224:227], a[56:59], a[16:19], a[224:227]
    v_mfma_f32_16x16x32_bf16 a[232:235], a[56:59], a[20:23], a[232:235]
    buffer_load_dwordx4 v23, s[8:11], s25 offen offset:2048 sc1 lds
    v_mfma_f32_16x16x32_bf16 a[240:243], a[56:59], a[24:27], a[240:243]
    v_mfma_f32_16x16x32_bf16 a[248:251], a[56:59], a[28:31], a[248:251]
    v_mfma_f32_16x16x32_bf16 a[252:255], a[60:63], a[28:31], a[252:255]
    v_mfma_f32_16x16x32_bf16 a[244:247], a[60:63], a[24:27], a[244:247]
    buffer_load_dwordx4 v24, s[8:11], s25 offen offset:3072 sc1 lds
    v_mfma_f32_16x16x32_bf16 a[236:239], a[60:63], a[20:23], a[236:239]
    v_mfma_f32_16x16x32_bf16 a[228:231], a[60:63], a[16:19], a[228:231]
    v_mfma_f32_16x16x32_bf16 v[252:255], a[60:63], a[12:15], v[252:255]
    v_mfma_f32_16x16x32_bf16 v[244:247], a[60:63], a[8:11], v[244:247]
    s_add_u32 s25, s25, 128
    v_mfma_f32_16x16x32_bf16 v[236:239], a[60:63], a[4:7], v[236:239]
    v_mfma_f32_16x16x32_bf16 v[228:231], a[60:63], a[0:3], v[228:231]
    s_waitcnt lgkmcnt(0)
    s_barrier
    v_mfma_f32_16x16x32_bf16 v[32:35], a[96:99], a[64:67], v[32:35]
    s_waitcnt vmcnt(16)
    v_subrev_u32 v5, s67, v5
    v_mfma_f32_16x16x32_bf16 v[40:43], a[96:99], a[68:71], v[40:43]
    v_mfma_f32_16x16x32_bf16 v[48:51], a[96:99], a[72:75], v[48:51]
    s_add_u32 m0, s30, 49152
    ds_read_b128 a[128:131], v30 offset:32768
    v_mfma_f32_16x16x32_bf16 v[56:59], a[96:99], a[76:79], v[56:59]
    v_subrev_u32 v6, s67, v6
    v_mfma_f32_16x16x32_bf16 v[64:67], a[96:99], a[80:83], v[64:67]
    buffer_load_dwordx4 v17, s[12:15], s24 offen offset:0 sc1 lds
    ds_read_b128 a[132:135], v30 offset:34816
    v_mfma_f32_16x16x32_bf16 v[72:75], a[96:99], a[84:87], v[72:75]
    v_subrev_u32 v7, s67, v7
    v_mfma_f32_16x16x32_bf16 v[80:83], a[96:99], a[88:91], v[80:83]
    ds_read_b128 a[136:139], v31 offset:32768
    v_mfma_f32_16x16x32_bf16 v[88:91], a[96:99], a[92:95], v[88:91]
    v_subrev_u32 v8, s67, v8
    v_mfma_f32_16x16x32_bf16 v[92:95], a[100:103], a[92:95], v[92:95]
    ds_read_b128 a[140:143], v31 offset:34816
    v_mfma_f32_16x16x32_bf16 v[84:87], a[100:103], a[88:91], v[84:87]
    v_mfma_f32_16x16x32_bf16 v[76:79], a[100:103], a[84:87], v[76:79]
    buffer_load_dwordx4 v18, s[12:15], s24 offen offset:1024 sc1 lds
    s_waitcnt vmcnt(14)
    v_mfma_f32_16x16x32_bf16 v[68:71], a[100:103], a[80:83], v[68:71]
    v_subrev_u32 v9, s67, v9
    v_mfma_f32_16x16x32_bf16 v[60:63], a[100:103], a[76:79], v[60:63]
    ds_read_b128 a[144:147], v30 offset:49152
    v_subrev_u32 v10, s67, v10
    v_mfma_f32_16x16x32_bf16 v[52:55], a[100:103], a[72:75], v[52:55]
    v_mfma_f32_16x16x32_bf16 v[44:47], a[100:103], a[68:71], v[44:47]
    ds_read_b128 a[148:151], v30 offset:51200
    v_mfma_f32_16x16x32_bf16 v[36:39], a[100:103], a[64:67], v[36:39]
    v_subrev_u32 v11, s67, v11
    v_mfma_f32_16x16x32_bf16 v[96:99], a[104:107], a[64:67], v[96:99]
    buffer_load_dwordx4 v19, s[12:15], s24 offen offset:2048 sc1 lds
    ds_read_b128 a[152:155], v31 offset:49152
    v_mfma_f32_16x16x32_bf16 v[104:107], a[104:107], a[68:71], v[104:107]
    v_subrev_u32 v12, s67, v12
    v_mfma_f32_16x16x32_bf16 v[112:115], a[104:107], a[72:75], v[112:115]
    ds_read_b128 a[156:159], v31 offset:51200
    v_mfma_f32_16x16x32_bf16 v[120:123], a[104:107], a[76:79], v[120:123]
    v_mfma_f32_16x16x32_bf16 v[128:131], a[104:107], a[80:83], v[128:131]
    s_waitcnt lgkmcnt(0)
    v_cvt_pk_bf16_f32 v32, v32, v33
    v_mfma_f32_16x16x32_bf16 v[136:139], a[104:107], a[84:87], v[136:139]
    v_cvt_pk_bf16_f32 v33, v34, v35
    v_cvt_pk_bf16_f32 v34, v36, v37
    v_mfma_f32_16x16x32_bf16 v[144:147], a[104:107], a[88:91], v[144:147]
    buffer_load_dwordx4 v20, s[12:15], s24 offen offset:3072 sc1 lds
    v_cvt_pk_bf16_f32 v35, v38, v39
    v_mfma_f32_16x16x32_bf16 v[152:155], a[104:107], a[92:95], v[152:155]
    v_cvt_pk_bf16_f32 v40, v40, v41
    v_cvt_pk_bf16_f32 v41, v42, v43
    v_mfma_f32_16x16x32_bf16 v[156:159], a[108:111], a[92:95], v[156:159]
    s_add_u32 s24, s24, 262144
    v_cvt_pk_bf16_f32 v42, v44, v45
    v_mfma_f32_16x16x32_bf16 v[148:151], a[108:111], a[88:91], v[148:151]
    v_cvt_pk_bf16_f32 v43, v46, v47
    v_cvt_pk_bf16_f32 v48, v48, v49
    v_mfma_f32_16x16x32_bf16 v[140:143], a[108:111], a[84:87], v[140:143]
    s_add_u32 m0, s75, 32768
    v_cvt_pk_bf16_f32 v49, v50, v51
    v_mfma_f32_16x16x32_bf16 v[132:135], a[108:111], a[80:83], v[132:135]
    buffer_load_dwordx4 v21, s[8:11], s25 offen offset:0 sc1 lds
    v_cvt_pk_bf16_f32 v50, v52, v53
    v_mfma_f32_16x16x32_bf16 v[124:127], a[108:111], a[76:79], v[124:127]
    v_cvt_pk_bf16_f32 v51, v54, v55
    v_cvt_pk_bf16_f32 v56, v56, v57
    v_mfma_f32_16x16x32_bf16 v[116:119], a[108:111], a[72:75], v[116:119]
    v_cvt_pk_bf16_f32 v57, v58, v59
    v_cvt_pk_bf16_f32 v58, v60, v61
    v_mfma_f32_16x16x32_bf16 v[108:111], a[108:111], a[68:71], v[108:111]
    v_cvt_pk_bf16_f32 v59, v62, v63
    v_cvt_pk_bf16_f32 v64, v64, v65
    v_mfma_f32_16x16x32_bf16 v[100:103], a[108:111], a[64:67], v[100:103]
    buffer_load_dwordx4 v22, s[8:11], s25 offen offset:1024 sc1 lds
    v_cvt_pk_bf16_f32 v65, v66, v67
    v_mfma_f32_16x16x32_bf16 v[160:163], a[112:115], a[64:67], v[160:163]
    v_cvt_pk_bf16_f32 v66, v68, v69
    v_cvt_pk_bf16_f32 v67, v70, v71
    v_mfma_f32_16x16x32_bf16 v[168:171], a[112:115], a[68:71], v[168:171]
    v_cvt_pk_bf16_f32 v72, v72, v73
    v_cvt_pk_bf16_f32 v73, v74, v75
    v_mfma_f32_16x16x32_bf16 v[176:179], a[112:115], a[72:75], v[176:179]
    v_cvt_pk_bf16_f32 v74, v76, v77
    v_cvt_pk_bf16_f32 v75, v78, v79
    v_mfma_f32_16x16x32_bf16 v[184:187], a[112:115], a[76:79], v[184:187]
    buffer_load_dwordx4 v23, s[8:11], s25 offen offset:2048 sc1 lds
    v_cvt_pk_bf16_f32 v80, v80, v81
    v_cvt_pk_bf16_f32 v81, v82, v83
    v_cvt_pk_bf16_f32 v82, v84, v85
    v_cvt_pk_bf16_f32 v83, v86, v87
    v_cvt_pk_bf16_f32 v88, v88, v89
    v_cvt_pk_bf16_f32 v89, v90, v91
    v_cvt_pk_bf16_f32 v90, v92, v93
    v_cvt_pk_bf16_f32 v91, v94, v95
    v_mfma_f32_16x16x32_bf16 v[192:195], a[112:115], a[80:83], v[192:195]
    v_cvt_pk_bf16_f32 v96, v96, v97
    v_cvt_pk_bf16_f32 v97, v98, v99
    v_mfma_f32_16x16x32_bf16 v[200:203], a[112:115], a[84:87], v[200:203]
    v_cvt_pk_bf16_f32 v98, v100, v101
    v_cvt_pk_bf16_f32 v99, v102, v103
    v_mfma_f32_16x16x32_bf16 v[208:211], a[112:115], a[88:91], v[208:211]
    v_cvt_pk_bf16_f32 v104, v104, v105
    v_cvt_pk_bf16_f32 v105, v106, v107
    v_mfma_f32_16x16x32_bf16 v[216:219], a[112:115], a[92:95], v[216:219]
    buffer_load_dwordx4 v24, s[8:11], s25 offen offset:3072 sc1 lds
    v_cvt_pk_bf16_f32 v106, v108, v109
    v_mfma_f32_16x16x32_bf16 v[220:223], a[116:119], a[92:95], v[220:223]
    v_cvt_pk_bf16_f32 v107, v110, v111
    v_cvt_pk_bf16_f32 v112, v112, v113
    v_mfma_f32_16x16x32_bf16 v[212:215], a[116:119], a[88:91], v[212:215]
    v_cvt_pk_bf16_f32 v113, v114, v115
    v_cvt_pk_bf16_f32 v114, v116, v117
    v_mfma_f32_16x16x32_bf16 v[204:207], a[116:119], a[84:87], v[204:207]
    v_cvt_pk_bf16_f32 v115, v118, v119
    v_cvt_pk_bf16_f32 v120, v120, v121
    v_mfma_f32_16x16x32_bf16 v[196:199], a[116:119], a[80:83], v[196:199]
    s_add_u32 s25, s25, 128
    v_cvt_pk_bf16_f32 v121, v122, v123
    v_mfma_f32_16x16x32_bf16 v[188:191], a[116:119], a[76:79], v[188:191]
    s_add_u32 m0, s75, 49152
    v_cvt_pk_bf16_f32 v122, v124, v125
    v_mfma_f32_16x16x32_bf16 v[180:183], a[116:119], a[72:75], v[180:183]
    buffer_load_dwordx4 v21, s[8:11], s25 offen offset:0 sc1 lds
    v_cvt_pk_bf16_f32 v123, v126, v127
    v_mfma_f32_16x16x32_bf16 v[172:175], a[116:119], a[68:71], v[172:175]
    v_cvt_pk_bf16_f32 v128, v128, v129
    v_cvt_pk_bf16_f32 v129, v130, v131
    v_mfma_f32_16x16x32_bf16 v[164:167], a[116:119], a[64:67], v[164:167]
    v_cvt_pk_bf16_f32 v130, v132, v133
    v_cvt_pk_bf16_f32 v131, v134, v135
    v_mfma_f32_16x16x32_bf16 v[224:227], a[120:123], a[64:67], v[224:227]
    v_cvt_pk_bf16_f32 v136, v136, v137
    v_cvt_pk_bf16_f32 v137, v138, v139
    v_mfma_f32_16x16x32_bf16 v[232:235], a[120:123], a[68:71], v[232:235]
    buffer_load_dwordx4 v22, s[8:11], s25 offen offset:1024 sc1 lds
    v_cvt_pk_bf16_f32 v138, v140, v141
    v_mfma_f32_16x16x32_bf16 v[240:243], a[120:123], a[72:75], v[240:243]
    v_cvt_pk_bf16_f32 v139, v142, v143
    v_cvt_pk_bf16_f32 v144, v144, v145
    v_mfma_f32_16x16x32_bf16 v[248:251], a[120:123], a[76:79], v[248:251]
    v_cvt_pk_bf16_f32 v145, v146, v147
    v_cvt_pk_bf16_f32 v146, v148, v149
    v_cvt_pk_bf16_f32 v147, v150, v151
    v_cvt_pk_bf16_f32 v152, v152, v153
    v_cvt_pk_bf16_f32 v153, v154, v155
    v_cvt_pk_bf16_f32 v154, v156, v157
    v_cvt_pk_bf16_f32 v155, v158, v159
    v_mfma_f32_16x16x32_bf16 a[224:227], a[120:123], a[80:83], a[224:227]
    v_cvt_pk_bf16_f32 v160, v160, v161
    v_cvt_pk_bf16_f32 v161, v162, v163
    v_mfma_f32_16x16x32_bf16 a[232:235], a[120:123], a[84:87], a[232:235]
    buffer_load_dwordx4 v23, s[8:11], s25 offen offset:2048 sc1 lds
    v_cvt_pk_bf16_f32 v162, v164, v165
    v_mfma_f32_16x16x32_bf16 a[240:243], a[120:123], a[88:91], a[240:243]
    v_cvt_pk_bf16_f32 v163, v166, v167
    v_cvt_pk_bf16_f32 v168, v168, v169
    v_mfma_f32_16x16x32_bf16 a[248:251], a[120:123], a[92:95], a[248:251]
    v_cvt_pk_bf16_f32 v169, v170, v171
    v_cvt_pk_bf16_f32 v170, v172, v173
    v_mfma_f32_16x16x32_bf16 a[252:255], a[124:127], a[92:95], a[252:255]
    v_cvt_pk_bf16_f32 v171, v174, v175
    v_cvt_pk_bf16_f32 v176, v176, v177
    v_mfma_f32_16x16x32_bf16 a[244:247], a[124:127], a[88:91], a[244:247]
    buffer_load_dwordx4 v24, s[8:11], s25 offen offset:3072 sc1 lds
    v_cvt_pk_bf16_f32 v177, v178, v179
    v_mfma_f32_16x16x32_bf16 a[236:239], a[124:127], a[84:87], a[236:239]
    v_cvt_pk_bf16_f32 v178, v180, v181
    v_cvt_pk_bf16_f32 v179, v182, v183
    v_mfma_f32_16x16x32_bf16 a[228:231], a[124:127], a[80:83], a[228:231]
    v_cvt_pk_bf16_f32 v184, v184, v185
    v_cvt_pk_bf16_f32 v185, v186, v187
    v_mfma_f32_16x16x32_bf16 v[252:255], a[124:127], a[76:79], v[252:255]
    v_cvt_pk_bf16_f32 v186, v188, v189
    v_cvt_pk_bf16_f32 v187, v190, v191
    v_mfma_f32_16x16x32_bf16 v[244:247], a[124:127], a[72:75], v[244:247]
    s_add_u32 s25, s25, 128
    v_cvt_pk_bf16_f32 v192, v192, v193
    v_mfma_f32_16x16x32_bf16 v[236:239], a[124:127], a[68:71], v[236:239]
    v_cvt_pk_bf16_f32 v193, v194, v195
    v_cvt_pk_bf16_f32 v194, v196, v197
    v_mfma_f32_16x16x32_bf16 v[228:231], a[124:127], a[64:67], v[228:231]
    v_cvt_pk_bf16_f32 v195, v198, v199
    v_cvt_pk_bf16_f32 v200, v200, v201
    v_cvt_pk_bf16_f32 v201, v202, v203
    v_cvt_pk_bf16_f32 v202, v204, v205
    v_cvt_pk_bf16_f32 v203, v206, v207
    v_cvt_pk_bf16_f32 v208, v208, v209
    v_cvt_pk_bf16_f32 v209, v210, v211
    v_cvt_pk_bf16_f32 v210, v212, v213
    v_cvt_pk_bf16_f32 v211, v214, v215
    v_cvt_pk_bf16_f32 v216, v216, v217
    v_cvt_pk_bf16_f32 v217, v218, v219
    v_cvt_pk_bf16_f32 v218, v220, v221
    v_cvt_pk_bf16_f32 v219, v222, v223
    s_lshr_b32 s3, s20, 1
    s_lshl_b32 s3, s3, 17
    s_and_b32 s29, s20, 1
    s_lshl_b32 s29, s29, 13
    s_add_u32 s29, s29, 16384
    s_add_u32 s3, s3, s29
    s_lshl_b32 s29, s21, 21
    s_add_u32 s3, s3, s29
    s_and_b32 s29, s22, 7
    s_lshl_b32 s29, s29, 18
    s_add_u32 s64, s3, s29
    s_mov_b32 s65, 32768
    s_mov_b32 s26, 1024
    s_mov_b32 s27, 1024
    s_barrier
    ds_read_b64_tr_b16 a[0:1], v5 offset:0
    ds_read_b64_tr_b16 a[2:3], v5 offset:1024
    ds_read_b64_tr_b16 a[4:5], v6 offset:0
    ds_read_b64_tr_b16 a[6:7], v6 offset:1024
    ds_read_b64_tr_b16 a[8:9], v7 offset:0
    ds_read_b64_tr_b16 a[10:11], v7 offset:1024
    ds_read_b64_tr_b16 a[12:13], v8 offset:0
    ds_read_b64_tr_b16 a[14:15], v8 offset:1024
    v_cvt_pk_bf16_f32 v224, v224, v225
    v_cvt_pk_bf16_f32 v225, v226, v227
    v_cvt_pk_bf16_f32 v226, v228, v229
    v_cvt_pk_bf16_f32 v227, v230, v231
    v_cvt_pk_bf16_f32 v232, v232, v233
    v_cvt_pk_bf16_f32 v233, v234, v235
    v_cvt_pk_bf16_f32 v234, v236, v237
    v_cvt_pk_bf16_f32 v235, v238, v239
    v_cvt_pk_bf16_f32 v240, v240, v241
    v_cvt_pk_bf16_f32 v241, v242, v243
    v_cvt_pk_bf16_f32 v242, v244, v245
    v_cvt_pk_bf16_f32 v243, v246, v247
    v_cvt_pk_bf16_f32 v248, v248, v249
    v_cvt_pk_bf16_f32 v249, v250, v251
    v_cvt_pk_bf16_f32 v250, v252, v253
    v_cvt_pk_bf16_f32 v251, v254, v255
    v_accvgpr_read_b32 v196, a224
    v_accvgpr_read_b32 v197, a225
    v_accvgpr_read_b32 v198, a226
    v_accvgpr_read_b32 v199, a227
    v_accvgpr_read_b32 v204, a228
    v_accvgpr_read_b32 v205, a229
    v_accvgpr_read_b32 v206, a230
    v_accvgpr_read_b32 v207, a231
    v_cvt_pk_bf16_f32 v196, v196, v197
    v_cvt_pk_bf16_f32 v197, v198, v199
    v_cvt_pk_bf16_f32 v198, v204, v205
    v_cvt_pk_bf16_f32 v199, v206, v207
    v_accvgpr_read_b32 v212, a232
    v_accvgpr_read_b32 v213, a233
    v_accvgpr_read_b32 v214, a234
    v_accvgpr_read_b32 v215, a235
    v_accvgpr_read_b32 v220, a236
    v_accvgpr_read_b32 v221, a237
    v_accvgpr_read_b32 v222, a238
    v_accvgpr_read_b32 v223, a239
    v_cvt_pk_bf16_f32 v212, v212, v213
    v_cvt_pk_bf16_f32 v213, v214, v215
    v_cvt_pk_bf16_f32 v214, v220, v221
    v_cvt_pk_bf16_f32 v215, v222, v223
    v_accvgpr_read_b32 v228, a240
    v_accvgpr_read_b32 v229, a241
    v_accvgpr_read_b32 v230, a242
    v_accvgpr_read_b32 v231, a243
    v_accvgpr_read_b32 v236, a244
    v_accvgpr_read_b32 v237, a245
    v_accvgpr_read_b32 v238, a246
    v_accvgpr_read_b32 v239, a247
    v_cvt_pk_bf16_f32 v228, v228, v229
    v_cvt_pk_bf16_f32 v229, v230, v231
    v_cvt_pk_bf16_f32 v230, v236, v237
    v_cvt_pk_bf16_f32 v231, v238, v239
    v_accvgpr_read_b32 v244, a248
    v_accvgpr_read_b32 v245, a249
    v_accvgpr_read_b32 v246, a250
    v_accvgpr_read_b32 v247, a251
    v_accvgpr_read_b32 v252, a252
    v_accvgpr_read_b32 v253, a253
    v_accvgpr_read_b32 v254, a254
    v_accvgpr_read_b32 v255, a255
    v_cvt_pk_bf16_f32 v244, v244, v245
    v_cvt_pk_bf16_f32 v245, v246, v247
    v_cvt_pk_bf16_f32 v246, v252, v253
    v_cvt_pk_bf16_f32 v247, v254, v255
    s_add_u32 s3, s64, 102400
    buffer_store_dwordx4 v[196:199], v25, s[4:7], s3 offen sc1
    s_add_u32 s3, s64, 103424
    buffer_store_dwordx4 v[212:215], v25, s[4:7], s3 offen sc1
    s_add_u32 s3, s64, 104448
    buffer_store_dwordx4 v[228:231], v25, s[4:7], s3 offen sc1
    s_add_u32 s3, s64, 105472
    buffer_store_dwordx4 v[244:247], v25, s[4:7], s3 offen sc1
pj_kvdone:
    s_cmp_lt_u32 s20, 2
    s_cselect_b32 s16, s46, s48
    s_cselect_b32 s17, s47, s49
    s_mov_b32 s18, 1605632
    s_mov_b32 s19, 0x20000
    s_bitcmp1_b32 s2, 0
    s_cselect_b32 s3, 6, 8
    s_cselect_b32 s29, 256, 0
    s_lshl_b32 s3, s3, 4
    s_and_b32 s78, s21, 1
    s_xor_b32 s79, s78, 1
    s_mul_i32 s78, s78, s3
    s_mul_i32 s79, s79, s3
    s_lshr_b32 s3, s21, 2
    s_mul_i32 s3, s3, 448
    s_add_u32 s3, s3, s29
    s_add_u32 s78, s78, s3
    s_add_u32 s79, s79, s3
    s_and_b32 s3, s20, 1
    s_mul_i32 s31, s3, 57344
    s_lshl_b32 s29, s78, 1
    s_add_u32 s31, s31, s29
    s_lshl_b32 s72, s21, 7
    s_add_u32 s72, s72, 100663296
    s_sub_u32 s3, 15, s22
    s_min_u32 s3, s3, s22
    s_lshl_b32 s29, s21, 3
    s_add_u32 s3, s3, s29
    s_lshl_b32 s3, s3, 7
    s_add_u32 s73, s3, 100671488
    s_waitcnt lgkmcnt(4)
    v_mfma_f32_16x16x32_bf16 v[36:39], a[0:3], a[128:131], 0
    ds_read_b64_tr_b16 a[16:17], v9 offset:0
    s_add_u32 m0, s30, 65536
    v_mfma_f32_16x16x32_bf16 v[44:47], a[0:3], a[132:135], 0
    ds_read_b64_tr_b16 a[18:19], v9 offset:1024
    v_mfma_f32_16x16x32_bf16 v[60:63], a[4:7], a[132:135], 0
    ds_read_b64_tr_b16 a[20:21], v10 offset:0
    buffer_load_dwordx4 v17, s[12:15], s24 offen offset:0 sc1 lds
    v_mfma_f32_16x16x32_bf16 v[52:55], a[4:7], a[128:131], 0
    ds_read_b64_tr_b16 a[22:23], v10 offset:1024
    s_waitcnt vmcnt(21)
    s_waitcnt lgkmcnt(4)
    v_mfma_f32_16x16x32_bf16 v[68:71], a[8:11], a[128:131], 0
    ds_read_b64_tr_b16 a[24:25], v11 offset:0
    ds_read_b128 a[160:163], v30 offset:0
    v_mfma_f32_16x16x32_bf16 v[76:79], a[8:11], a[132:135], 0
    ds_read_b64_tr_b16 a[26:27], v11 offset:1024
    buffer_load_dwordx4 v18, s[12:15], s24 offen offset:1024 sc1 lds
    v_mfma_f32_16x16x32_bf16 v[92:95], a[12:15], a[132:135], 0
    ds_read_b64_tr_b16 a[28:29], v12 offset:0
    ds_read_b128 a[164:167], v30 offset:2048
    v_mfma_f32_16x16x32_bf16 v[84:87], a[12:15], a[128:131], 0
    ds_read_b64_tr_b16 a[30:31], v12 offset:1024
    s_waitcnt lgkmcnt(6)
    v_mfma_f32_16x16x32_bf16 v[100:103], a[16:19], a[128:131], 0
    ds_read_b64_tr_b16 a[0:1], v5 offset:8192
    buffer_load_dwordx4 v19, s[12:15], s24 offen offset:2048 sc1 lds
    v_mfma_f32_16x16x32_bf16 v[108:111], a[16:19], a[132:135], 0
    ds_read_b64_tr_b16 a[2:3], v5 offset:9216
    ds_read_b128 a[168:171], v31 offset:0
    v_mfma_f32_16x16x32_bf16 v[124:127], a[20:23], a[132:135], 0
    ds_read_b64_tr_b16 a[4:5], v6 offset:8192
    ds_read_b128 a[172:175], v31 offset:2048
    v_mfma_f32_16x16x32_bf16 v[116:119], a[20:23], a[128:131], 0
    ds_read_b64_tr_b16 a[6:7], v6 offset:9216
    s_waitcnt lgkmcnt(6)
    v_mfma_f32_16x16x32_bf16 v[132:135], a[24:27], a[128:131], 0
    ds_read_b64_tr_b16 a[8:9], v7 offset:8192
    buffer_load_dwordx4 v20, s[12:15], s24 offen offset:3072 sc1 lds
    v_mfma_f32_16x16x32_bf16 v[140:143], a[24:27], a[132:135], 0
    ds_read_b64_tr_b16 a[10:11], v7 offset:9216
    s_waitcnt vmcnt(20)
    v_mfma_f32_16x16x32_bf16 v[156:159], a[28:31], a[132:135], 0
    ds_read_b64_tr_b16 a[12:13], v8 offset:8192
    s_add_u32 s24, s24, 262144
    v_mfma_f32_16x16x32_bf16 v[148:151], a[28:31], a[128:131], 0
    ds_read_b64_tr_b16 a[14:15], v8 offset:9216
    ds_read_b128 a[176:179], v30 offset:16384
    s_waitcnt lgkmcnt(5)
    v_mfma_f32_16x16x32_bf16 v[164:167], a[0:3], a[128:131], 0
    ds_read_b64_tr_b16 a[16:17], v9 offset:8192
    ds_read_b128 a[180:183], v30 offset:18432
    v_mfma_f32_16x16x32_bf16 v[172:175], a[0:3], a[132:135], 0
    ds_read_b64_tr_b16 a[18:19], v9 offset:9216
    s_add_u32 m0, s30, 81920
    v_mfma_f32_16x16x32_bf16 v[188:191], a[4:7], a[132:135], 0
    ds_read_b64_tr_b16 a[20:21], v10 offset:8192
    ds_read_b128 a[184:187], v31 offset:16384
    v_mfma_f32_16x16x32_bf16 v[180:183], a[4:7], a[128:131], 0
    ds_read_b64_tr_b16 a[22:23], v10 offset:9216
    s_waitcnt lgkmcnt(7)
    v_mfma_f32_16x16x32_bf16 v[196:199], a[8:11], a[128:131], 0
    ds_read_b64_tr_b16 a[24:25], v11 offset:8192
    buffer_load_dwordx4 v17, s[12:15], s24 offen offset:0 sc1 lds
    v_mfma_f32_16x16x32_bf16 v[204:207], a[8:11], a[132:135], 0
    ds_read_b64_tr_b16 a[26:27], v11 offset:9216
    ds_read_b128 a[188:191], v31 offset:18432
    v_mfma_f32_16x16x32_bf16 v[220:223], a[12:15], a[132:135], 0
    ds_read_b64_tr_b16 a[28:29], v12 offset:8192
    buffer_load_dwordx4 v18, s[12:15], s24 offen offset:1024 sc1 lds
    v_mfma_f32_16x16x32_bf16 v[212:215], a[12:15], a[128:131], 0
    ds_read_b64_tr_b16 a[30:31], v12 offset:9216
    s_waitcnt lgkmcnt(5)
    v_mfma_f32_16x16x32_bf16 v[228:231], a[16:19], a[128:131], 0
    ds_read_b64_tr_b16 a[0:1], v5 offset:16384
    v_mfma_f32_16x16x32_bf16 v[236:239], a[16:19], a[132:135], 0
    ds_read_b64_tr_b16 a[2:3], v5 offset:17408
    buffer_load_dwordx4 v19, s[12:15], s24 offen offset:2048 sc1 lds
    v_mfma_f32_16x16x32_bf16 v[252:255], a[20:23], a[132:135], 0
    ds_read_b64_tr_b16 a[4:5], v6 offset:16384
    v_mfma_f32_16x16x32_bf16 v[244:247], a[20:23], a[128:131], 0
    ds_read_b64_tr_b16 a[6:7], v6 offset:17408
    s_waitcnt lgkmcnt(4)
    v_mfma_f32_16x16x32_bf16 a[224:227], a[24:27], a[128:131], 0
    ds_read_b64_tr_b16 a[8:9], v7 offset:16384
    buffer_load_dwordx4 v20, s[12:15], s24 offen offset:3072 sc1 lds
    v_mfma_f32_16x16x32_bf16 a[228:231], a[24:27], a[132:135], 0
    ds_read_b64_tr_b16 a[10:11], v7 offset:17408
    v_mfma_f32_16x16x32_bf16 a[236:239], a[28:31], a[132:135], 0
    ds_read_b64_tr_b16 a[12:13], v8 offset:16384
    v_mfma_f32_16x16x32_bf16 a[232:235], a[28:31], a[128:131], 0
    ds_read_b64_tr_b16 a[14:15], v8 offset:17408
    s_waitcnt lgkmcnt(4)
    v_mfma_f32_16x16x32_bf16 v[36:39], a[0:3], a[136:139], v[36:39]
    ds_read_b64_tr_b16 a[16:17], v9 offset:16384
    s_add_u32 s24, s24, 262144
    v_mfma_f32_16x16x32_bf16 v[44:47], a[0:3], a[140:143], v[44:47]
    ds_read_b64_tr_b16 a[18:19], v9 offset:17408
    v_mfma_f32_16x16x32_bf16 v[60:63], a[4:7], a[140:143], v[60:63]
    ds_read_b64_tr_b16 a[20:21], v10 offset:16384
    v_mfma_f32_16x16x32_bf16 v[52:55], a[4:7], a[136:139], v[52:55]
    ds_read_b64_tr_b16 a[22:23], v10 offset:17408
    s_waitcnt lgkmcnt(6)
    s_waitcnt lgkmcnt(4)
    v_mfma_f32_16x16x32_bf16 v[68:71], a[8:11], a[136:139], v[68:71]
    ds_read_b64_tr_b16 a[24:25], v11 offset:16384
    s_add_u32 s77, s64, 0
    v_mfma_f32_16x16x32_bf16 v[76:79], a[8:11], a[140:143], v[76:79]
    ds_read_b64_tr_b16 a[26:27], v11 offset:17408
    s_add_u32 m0, s75, 16384
    v_mfma_f32_16x16x32_bf16 v[92:95], a[12:15], a[140:143], v[92:95]
    ds_read_b64_tr_b16 a[28:29], v12 offset:16384
    v_mfma_f32_16x16x32_bf16 v[84:87], a[12:15], a[136:139], v[84:87]
    ds_read_b64_tr_b16 a[30:31], v12 offset:17408
    s_waitcnt lgkmcnt(4)
    v_mfma_f32_16x16x32_bf16 v[100:103], a[16:19], a[136:139], v[100:103]
    ds_read_b64_tr_b16 a[0:1], v5 offset:24576
    buffer_store_dwordx4 v[32:35], v25, s[4:7], s77 offen sc1
    v_mfma_f32_16x16x32_bf16 v[108:111], a[16:19], a[140:143], v[108:111]
    ds_read_b64_tr_b16 a[2:3], v5 offset:25600
    buffer_load_dwordx4 v21, s[8:11], s25 offen offset:0 sc1 lds
    v_mfma_f32_16x16x32_bf16 v[124:127], a[20:23], a[140:143], v[124:127]
    ds_read_b64_tr_b16 a[4:5], v6 offset:24576
    v_mfma_f32_16x16x32_bf16 v[116:119], a[20:23], a[136:139], v[116:119]
    ds_read_b64_tr_b16 a[6:7], v6 offset:25600
    buffer_load_dwordx4 v22, s[8:11], s25 offen offset:1024 sc1 lds
    s_waitcnt lgkmcnt(4)
    v_mfma_f32_16x16x32_bf16 v[132:135], a[24:27], a[136:139], v[132:135]
    ds_read_b64_tr_b16 a[8:9], v7 offset:24576
    s_add_u32 s77, s77, s26
    v_mfma_f32_16x16x32_bf16 v[140:143], a[24:27], a[140:143], v[140:143]
    ds_read_b64_tr_b16 a[10:11], v7 offset:25600
    v_mfma_f32_16x16x32_bf16 v[156:159], a[28:31], a[140:143], v[156:159]
    ds_read_b64_tr_b16 a[12:13], v8 offset:24576
    buffer_store_dwordx4 v[40:43], v25, s[4:7], s77 offen sc1
    v_mfma_f32_16x16x32_bf16 v[148:151], a[28:31], a[136:139], v[148:151]
    ds_read_b64_tr_b16 a[14:15], v8 offset:25600
    buffer_load_dwordx4 v23, s[8:11], s25 offen offset:2048 sc1 lds
    s_waitcnt lgkmcnt(4)
    v_mfma_f32_16x16x32_bf16 v[164:167], a[0:3], a[136:139], v[164:167]
    ds_read_b64_tr_b16 a[16:17], v9 offset:24576
    v_mfma_f32_16x16x32_bf16 v[172:175], a[0:3], a[140:143], v[172:175]
    ds_read_b64_tr_b16 a[18:19], v9 offset:25600
    buffer_load_dwordx4 v24, s[8:11], s25 offen offset:3072 sc1 lds
    v_mfma_f32_16x16x32_bf16 v[188:191], a[4:7], a[140:143], v[188:191]
    ds_read_b64_tr_b16 a[20:21], v10 offset:24576
    s_add_u32 s77, s77, s27
    v_mfma_f32_16x16x32_bf16 v[180:183], a[4:7], a[136:139], v[180:183]
    ds_read_b64_tr_b16 a[22:23], v10 offset:25600
    s_waitcnt lgkmcnt(4)
    v_mfma_f32_16x16x32_bf16 v[196:199], a[8:11], a[136:139], v[196:199]
    ds_read_b64_tr_b16 a[24:25], v11 offset:24576
    s_add_u32 s25, s25, 128
    v_mfma_f32_16x16x32_bf16 v[204:207], a[8:11], a[140:143], v[204:207]
    ds_read_b64_tr_b16 a[26:27], v11 offset:25600
    buffer_store_dwordx4 v[48:51], v25, s[4:7], s77 offen sc1
    v_mfma_f32_16x16x32_bf16 v[220:223], a[12:15], a[140:143], v[220:223]
    ds_read_b64_tr_b16 a[28:29], v12 offset:24576
    v_mfma_f32_16x16x32_bf16 v[212:215], a[12:15], a[136:139], v[212:215]
    ds_read_b64_tr_b16 a[30:31], v12 offset:25600
    s_waitcnt vmcnt(27)
    s_barrier
    s_waitcnt lgkmcnt(4)
    v_mfma_f32_16x16x32_bf16 v[228:231], a[16:19], a[136:139], v[228:231]
    ds_read_b64_tr_b16 a[0:1], v5 offset:32768
    v_mfma_f32_16x16x32_bf16 v[236:239], a[16:19], a[140:143], v[236:239]
    ds_read_b64_tr_b16 a[2:3], v5 offset:33792
    s_add_u32 s77, s77, s26
    v_mfma_f32_16x16x32_bf16 v[252:255], a[20:23], a[140:143], v[252:255]
    ds_read_b64_tr_b16 a[4:5], v6 offset:32768
    v_mfma_f32_16x16x32_bf16 v[244:247], a[20:23], a[136:139], v[244:247]
    ds_read_b64_tr_b16 a[6:7], v6 offset:33792
    s_waitcnt lgkmcnt(4)
    v_mfma_f32_16x16x32_bf16 a[224:227], a[24:27], a[136:139], a[224:227]
    ds_read_b64_tr_b16 a[8:9], v7 offset:32768
    buffer_store_dwordx4 v[56:59], v25, s[4:7], s77 offen sc1
    v_mfma_f32_16x16x32_bf16 a[228:231], a[24:27], a[140:143], a[228:231]
    ds_read_b64_tr_b16 a[10:11], v7 offset:33792
    v_mfma_f32_16x16x32_bf16 a[236:239], a[28:31], a[140:143], a[236:239]
    ds_read_b64_tr_b16 a[12:13], v8 offset:32768
    v_mfma_f32_16x16x32_bf16 a[232:235], a[28:31], a[136:139], a[232:235]
    ds_read_b64_tr_b16 a[14:15], v8 offset:33792
    s_waitcnt lgkmcnt(4)
    v_mfma_f32_16x16x32_bf16 v[36:39], a[0:3], a[144:147], v[36:39]
    ds_read_b64_tr_b16 a[16:17], v9 offset:32768
    s_add_u32 m0, s30, 98304
    v_mfma_f32_16x16x32_bf16 v[44:47], a[0:3], a[148:151], v[44:47]
    ds_read_b64_tr_b16 a[18:19], v9 offset:33792
    v_add_u32 v13, 0x10000, v5
    v_mfma_f32_16x16x32_bf16 v[60:63], a[4:7], a[148:151], v[60:63]
    ds_read_b64_tr_b16 a[20:21], v10 offset:32768
    buffer_load_dwordx4 v17, s[12:15], s24 offen offset:0 sc1 lds
    v_mfma_f32_16x16x32_bf16 v[52:55], a[4:7], a[144:147], v[52:55]
    ds_read_b64_tr_b16 a[22:23], v10 offset:33792
    v_add_u32 v14, 0x10000, v6
    s_waitcnt lgkmcnt(4)
    v_mfma_f32_16x16x32_bf16 v[68:71], a[8:11], a[144:147], v[68:71]
    ds_read_b64_tr_b16 a[24:25], v11 offset:32768
    v_mfma_f32_16x16x32_bf16 v[76:79], a[8:11], a[148:151], v[76:79]
    ds_read_b64_tr_b16 a[26:27], v11 offset:33792
    buffer_load_dwordx4 v18, s[12:15], s24 offen offset:1024 sc1 lds
    v_mfma_f32_16x16x32_bf16 v[92:95], a[12:15], a[148:151], v[92:95]
    ds_read_b64_tr_b16 a[28:29], v12 offset:32768
    v_mfma_f32_16x16x32_bf16 v[84:87], a[12:15], a[144:147], v[84:87]
    ds_read_b64_tr_b16 a[30:31], v12 offset:33792
    v_add_u32 v15, 0x10000, v7
    s_waitcnt lgkmcnt(4)
    v_mfma_f32_16x16x32_bf16 v[100:103], a[16:19], a[144:147], v[100:103]
    ds_read_b64_tr_b16 a[0:1], v5 offset:40960
    buffer_load_dwordx4 v19, s[12:15], s24 offen offset:2048 sc1 lds
    v_mfma_f32_16x16x32_bf16 v[108:111], a[16:19], a[148:151], v[108:111]
    ds_read_b64_tr_b16 a[2:3], v5 offset:41984
    v_mfma_f32_16x16x32_bf16 v[124:127], a[20:23], a[148:151], v[124:127]
    ds_read_b64_tr_b16 a[4:5], v6 offset:40960
    v_mfma_f32_16x16x32_bf16 v[116:119], a[20:23], a[144:147], v[116:119]
    ds_read_b64_tr_b16 a[6:7], v6 offset:41984
    v_add_u32 v16, 0x10000, v8
    s_waitcnt lgkmcnt(4)
    v_mfma_f32_16x16x32_bf16 v[132:135], a[24:27], a[144:147], v[132:135]
    ds_read_b64_tr_b16 a[8:9], v7 offset:40960
    buffer_load_dwordx4 v20, s[12:15], s24 offen offset:3072 sc1 lds
    v_mfma_f32_16x16x32_bf16 v[140:143], a[24:27], a[148:151], v[140:143]
    ds_read_b64_tr_b16 a[10:11], v7 offset:41984
    v_mfma_f32_16x16x32_bf16 v[156:159], a[28:31], a[148:151], v[156:159]
    ds_read_b64_tr_b16 a[12:13], v8 offset:40960
    s_add_u32 s24, s24, 262144
    v_mfma_f32_16x16x32_bf16 v[148:151], a[28:31], a[144:147], v[148:151]
    ds_read_b64_tr_b16 a[14:15], v8 offset:41984
    v_add_u32 v21, 0x10000, v9
    s_waitcnt lgkmcnt(4)
    v_mfma_f32_16x16x32_bf16 v[164:167], a[0:3], a[144:147], v[164:167]
    ds_read_b64_tr_b16 a[16:17], v9 offset:40960
    v_mfma_f32_16x16x32_bf16 v[172:175], a[0:3], a[148:151], v[172:175]
    ds_read_b64_tr_b16 a[18:19], v9 offset:41984
    s_add_u32 m0, s30, 0
    v_mfma_f32_16x16x32_bf16 v[188:191], a[4:7], a[148:151], v[188:191]
    ds_read_b64_tr_b16 a[20:21], v10 offset:40960
    v_mfma_f32_16x16x32_bf16 v[180:183], a[4:7], a[144:147], v[180:183]
    ds_read_b64_tr_b16 a[22:23], v10 offset:41984
    v_add_u32 v22, 0x10000, v10
    s_waitcnt lgkmcnt(4)
    v_mfma_f32_16x16x32_bf16 v[196:199], a[8:11], a[144:147], v[196:199]
    ds_read_b64_tr_b16 a[24:25], v11 offset:40960
    buffer_load_dwordx4 v17, s[12:15], s24 offen offset:0 sc1 lds
    v_mfma_f32_16x16x32_bf16 v[204:207], a[8:11], a[148:151], v[204:207]
    ds_read_b64_tr_b16 a[26:27], v11 offset:41984
    v_mfma_f32_16x16x32_bf16 v[220:223], a[12:15], a[148:151], v[220:223]
    ds_read_b64_tr_b16 a[28:29], v12 offset:40960
    buffer_load_dwordx4 v18, s[12:15], s24 offen offset:1024 sc1 lds
    v_mfma_f32_16x16x32_bf16 v[212:215], a[12:15], a[144:147], v[212:215]
    ds_read_b64_tr_b16 a[30:31], v12 offset:41984
    v_add_u32 v23, 0x10000, v11
    s_waitcnt lgkmcnt(4)
    v_mfma_f32_16x16x32_bf16 v[228:231], a[16:19], a[144:147], v[228:231]
    ds_read_b64_tr_b16 a[0:1], v5 offset:49152
    v_mfma_f32_16x16x32_bf16 v[236:239], a[16:19], a[148:151], v[236:239]
    ds_read_b64_tr_b16 a[2:3], v5 offset:50176
    buffer_load_dwordx4 v19, s[12:15], s24 offen offset:2048 sc1 lds
    v_mfma_f32_16x16x32_bf16 v[252:255], a[20:23], a[148:151], v[252:255]
    ds_read_b64_tr_b16 a[4:5], v6 offset:49152
    v_mfma_f32_16x16x32_bf16 v[244:247], a[20:23], a[144:147], v[244:247]
    ds_read_b64_tr_b16 a[6:7], v6 offset:50176
    v_add_u32 v24, 0x10000, v12
    s_waitcnt lgkmcnt(4)
    v_mfma_f32_16x16x32_bf16 a[224:227], a[24:27], a[144:147], a[224:227]
    ds_read_b64_tr_b16 a[8:9], v7 offset:49152
    buffer_load_dwordx4 v20, s[12:15], s24 offen offset:3072 sc1 lds
    v_mfma_f32_16x16x32_bf16 a[228:231], a[24:27], a[148:151], a[228:231]
    ds_read_b64_tr_b16 a[10:11], v7 offset:50176
    v_mfma_f32_16x16x32_bf16 a[236:239], a[28:31], a[148:151], a[236:239]
    ds_read_b64_tr_b16 a[12:13], v8 offset:49152
    s_waitcnt vmcnt(32)
    v_mfma_f32_16x16x32_bf16 a[232:235], a[28:31], a[144:147], a[232:235]
    ds_read_b64_tr_b16 a[14:15], v8 offset:50176
    s_waitcnt lgkmcnt(4)
    v_mfma_f32_16x16x32_bf16 v[36:39], a[0:3], a[152:155], v[36:39]
    ds_read_b64_tr_b16 a[16:17], v9 offset:49152
    s_add_u32 s24, s24, 262144
    v_mfma_f32_16x16x32_bf16 v[44:47], a[0:3], a[156:159], v[44:47]
    ds_read_b64_tr_b16 a[18:19], v9 offset:50176
    ds_read_b128 a[192:195], v30 offset:32768
    v_mfma_f32_16x16x32_bf16 v[60:63], a[4:7], a[156:159], v[60:63]
    ds_read_b64_tr_b16 a[20:21], v10 offset:49152
    v_mfma_f32_16x16x32_bf16 v[52:55], a[4:7], a[152:155], v[52:55]
    ds_read_b64_tr_b16 a[22:23], v10 offset:50176
    ds_read_b128 a[196:199], v30 offset:34816
    s_waitcnt lgkmcnt(6)
    v_mfma_f32_16x16x32_bf16 v[68:71], a[8:11], a[152:155], v[68:71]
    ds_read_b64_tr_b16 a[24:25], v11 offset:49152
    s_add_u32 s77, s77, s27
    v_mfma_f32_16x16x32_bf16 v[76:79], a[8:11], a[156:159], v[76:79]
    ds_read_b64_tr_b16 a[26:27], v11 offset:50176
    ds_read_b128 a[200:203], v31 offset:32768
    v_mfma_f32_16x16x32_bf16 v[92:95], a[12:15], a[156:159], v[92:95]
    ds_read_b64_tr_b16 a[28:29], v12 offset:49152
    v_mfma_f32_16x16x32_bf16 v[84:87], a[12:15], a[152:155], v[84:87]
    ds_read_b64_tr_b16 a[30:31], v12 offset:50176
    s_waitcnt lgkmcnt(6)
    v_mfma_f32_16x16x32_bf16 v[100:103], a[16:19], a[152:155], v[100:103]
    ds_read_b64_tr_b16 a[0:1], v5 offset:57344
    buffer_store_dwordx4 v[64:67], v25, s[4:7], s77 offen sc1
    v_mfma_f32_16x16x32_bf16 v[108:111], a[16:19], a[156:159], v[108:111]
    ds_read_b64_tr_b16 a[2:3], v5 offset:58368
    ds_read_b128 a[204:207], v31 offset:34816
    v_mfma_f32_16x16x32_bf16 v[124:127], a[20:23], a[156:159], v[124:127]
    ds_read_b64_tr_b16 a[4:5], v6 offset:57344
    s_waitcnt vmcnt(29)
    v_mfma_f32_16x16x32_bf16 v[116:119], a[20:23], a[152:155], v[116:119]
    ds_read_b64_tr_b16 a[6:7], v6 offset:58368
    s_waitcnt lgkmcnt(5)
    v_mfma_f32_16x16x32_bf16 v[132:135], a[24:27], a[152:155], v[132:135]
    ds_read_b64_tr_b16 a[8:9], v7 offset:57344
    s_add_u32 s77, s77, s26
    v_mfma_f32_16x16x32_bf16 v[140:143], a[24:27], a[156:159], v[140:143]
    ds_read_b64_tr_b16 a[10:11], v7 offset:58368
    ds_read_b128 a[208:211], v30 offset:49152
    v_mfma_f32_16x16x32_bf16 v[156:159], a[28:31], a[156:159], v[156:159]
    ds_read_b64_tr_b16 a[12:13], v8 offset:57344
    buffer_store_dwordx4 v[72:75], v25, s[4:7], s77 offen sc1
    v_mfma_f32_16x16x32_bf16 v[148:151], a[28:31], a[152:155], v[148:151]
    ds_read_b64_tr_b16 a[14:15], v8 offset:58368
    ds_read_b128 a[212:215], v30 offset:51200
    s_waitcnt lgkmcnt(6)
    v_mfma_f32_16x16x32_bf16 v[164:167], a[0:3], a[152:155], v[164:167]
    ds_read_b64_tr_b16 a[16:17], v9 offset:57344
    v_mfma_f32_16x16x32_bf16 v[172:175], a[0:3], a[156:159], v[172:175]
    ds_read_b64_tr_b16 a[18:19], v9 offset:58368
    v_mfma_f32_16x16x32_bf16 v[188:191], a[4:7], a[156:159], v[188:191]
    ds_read_b64_tr_b16 a[20:21], v10 offset:57344
    s_add_u32 s77, s77, s27
    v_mfma_f32_16x16x32_bf16 v[180:183], a[4:7], a[152:155], v[180:183]
    ds_read_b64_tr_b16 a[22:23], v10 offset:58368
    ds_read_b128 a[216:219], v31 offset:49152
    s_waitcnt lgkmcnt(6)
    v_mfma_f32_16x16x32_bf16 v[196:199], a[8:11], a[152:155], v[196:199]
    ds_read_b64_tr_b16 a[24:25], v11 offset:57344
    ds_read_b128 a[220:223], v31 offset:51200
    v_mfma_f32_16x16x32_bf16 v[204:207], a[8:11], a[156:159], v[204:207]
    ds_read_b64_tr_b16 a[26:27], v11 offset:58368
    buffer_store_dwordx4 v[80:83], v25, s[4:7], s77 offen sc1
    v_mfma_f32_16x16x32_bf16 v[220:223], a[12:15], a[156:159], v[220:223]
    ds_read_b64_tr_b16 a[28:29], v12 offset:57344
    v_mfma_f32_16x16x32_bf16 v[212:215], a[12:15], a[152:155], v[212:215]
    ds_read_b64_tr_b16 a[30:31], v12 offset:58368
    s_waitcnt vmcnt(19)
    s_barrier
    s_waitcnt lgkmcnt(6)
    v_mfma_f32_16x16x32_bf16 v[228:231], a[16:19], a[152:155], v[228:231]
    ds_read_b64_tr_b16 a[0:1], v13 offset:0
    v_mfma_f32_16x16x32_bf16 v[236:239], a[16:19], a[156:159], v[236:239]
    ds_read_b64_tr_b16 a[2:3], v13 offset:1024
    s_add_u32 s77, s77, s26
    v_mfma_f32_16x16x32_bf16 v[252:255], a[20:23], a[156:159], v[252:255]
    ds_read_b64_tr_b16 a[4:5], v14 offset:0
    v_mfma_f32_16x16x32_bf16 v[244:247], a[20:23], a[152:155], v[244:247]
    ds_read_b64_tr_b16 a[6:7], v14 offset:1024
    s_waitcnt lgkmcnt(4)
    v_mfma_f32_16x16x32_bf16 a[224:227], a[24:27], a[152:155], a[224:227]
    ds_read_b64_tr_b16 a[8:9], v15 offset:0
    buffer_store_dwordx4 v[88:91], v25, s[4:7], s77 offen sc1
    v_mfma_f32_16x16x32_bf16 a[228:231], a[24:27], a[156:159], a[228:231]
    ds_read_b64_tr_b16 a[10:11], v15 offset:1024
    v_mfma_f32_16x16x32_bf16 a[236:239], a[28:31], a[156:159], a[236:239]
    ds_read_b64_tr_b16 a[12:13], v16 offset:0
    v_mfma_f32_16x16x32_bf16 a[232:235], a[28:31], a[152:155], a[232:235]
    ds_read_b64_tr_b16 a[14:15], v16 offset:1024
    s_waitcnt lgkmcnt(4)
    v_mfma_f32_16x16x32_bf16 v[36:39], a[0:3], a[160:163], v[36:39]
    ds_read_b64_tr_b16 a[16:17], v21 offset:0
    s_add_u32 m0, s30, 16384
    v_mfma_f32_16x16x32_bf16 v[44:47], a[0:3], a[164:167], v[44:47]
    ds_read_b64_tr_b16 a[18:19], v21 offset:1024
    v_mfma_f32_16x16x32_bf16 v[60:63], a[4:7], a[164:167], v[60:63]
    ds_read_b64_tr_b16 a[20:21], v22 offset:0
    buffer_load_dwordx4 v17, s[12:15], s24 offen offset:0 sc1 lds
    v_mfma_f32_16x16x32_bf16 v[52:55], a[4:7], a[160:163], v[52:55]
    ds_read_b64_tr_b16 a[22:23], v22 offset:1024
    s_waitcnt lgkmcnt(4)
    v_mfma_f32_16x16x32_bf16 v[68:71], a[8:11], a[160:163], v[68:71]
    ds_read_b64_tr_b16 a[24:25], v23 offset:0
    v_mfma_f32_16x16x32_bf16 v[76:79], a[8:11], a[164:167], v[76:79]
    ds_read_b64_tr_b16 a[26:27], v23 offset:1024
    buffer_load_dwordx4 v18, s[12:15], s24 offen offset:1024 sc1 lds
    v_mfma_f32_16x16x32_bf16 v[92:95], a[12:15], a[164:167], v[92:95]
    ds_read_b64_tr_b16 a[28:29], v24 offset:0
    v_mfma_f32_16x16x32_bf16 v[84:87], a[12:15], a[160:163], v[84:87]
    ds_read_b64_tr_b16 a[30:31], v24 offset:1024
    s_waitcnt lgkmcnt(4)
    v_mfma_f32_16x16x32_bf16 v[100:103], a[16:19], a[160:163], v[100:103]
    ds_read_b64_tr_b16 a[0:1], v13 offset:8192
    buffer_load_dwordx4 v19, s[12:15], s24 offen offset:2048 sc1 lds
    v_mfma_f32_16x16x32_bf16 v[108:111], a[16:19], a[164:167], v[108:111]
    ds_read_b64_tr_b16 a[2:3], v13 offset:9216
    v_mfma_f32_16x16x32_bf16 v[124:127], a[20:23], a[164:167], v[124:127]
    ds_read_b64_tr_b16 a[4:5], v14 offset:8192
    v_mfma_f32_16x16x32_bf16 v[116:119], a[20:23], a[160:163], v[116:119]
    ds_read_b64_tr_b16 a[6:7], v14 offset:9216
    s_waitcnt lgkmcnt(4)
    v_mfma_f32_16x16x32_bf16 v[132:135], a[24:27], a[160:163], v[132:135]
    ds_read_b64_tr_b16 a[8:9], v15 offset:8192
    buffer_load_dwordx4 v20, s[12:15], s24 offen offset:3072 sc1 lds
    v_mfma_f32_16x16x32_bf16 v[140:143], a[24:27], a[164:167], v[140:143]
    ds_read_b64_tr_b16 a[10:11], v15 offset:9216
    v_mfma_f32_16x16x32_bf16 v[156:159], a[28:31], a[164:167], v[156:159]
    ds_read_b64_tr_b16 a[12:13], v16 offset:8192
    s_add_u32 s24, s24, 262144
    v_mfma_f32_16x16x32_bf16 v[148:151], a[28:31], a[160:163], v[148:151]
    ds_read_b64_tr_b16 a[14:15], v16 offset:9216
    s_waitcnt lgkmcnt(4)
    v_mfma_f32_16x16x32_bf16 v[164:167], a[0:3], a[160:163], v[164:167]
    ds_read_b64_tr_b16 a[16:17], v21 offset:8192
    v_mfma_f32_16x16x32_bf16 v[172:175], a[0:3], a[164:167], v[172:175]
    ds_read_b64_tr_b16 a[18:19], v21 offset:9216
    s_add_u32 m0, s30, 32768
    v_mfma_f32_16x16x32_bf16 v[188:191], a[4:7], a[164:167], v[188:191]
    ds_read_b64_tr_b16 a[20:21], v22 offset:8192
    v_mfma_f32_16x16x32_bf16 v[180:183], a[4:7], a[160:163], v[180:183]
    ds_read_b64_tr_b16 a[22:23], v22 offset:9216
    s_waitcnt lgkmcnt(4)
    v_mfma_f32_16x16x32_bf16 v[196:199], a[8:11], a[160:163], v[196:199]
    ds_read_b64_tr_b16 a[24:25], v23 offset:8192
    buffer_load_dwordx4 v17, s[12:15], s24 offen offset:0 sc1 lds
    v_mfma_f32_16x16x32_bf16 v[204:207], a[8:11], a[164:167], v[204:207]
    ds_read_b64_tr_b16 a[26:27], v23 offset:9216
    v_mfma_f32_16x16x32_bf16 v[220:223], a[12:15], a[164:167], v[220:223]
    ds_read_b64_tr_b16 a[28:29], v24 offset:8192
    buffer_load_dwordx4 v18, s[12:15], s24 offen offset:1024 sc1 lds
    v_mfma_f32_16x16x32_bf16 v[212:215], a[12:15], a[160:163], v[212:215]
    ds_read_b64_tr_b16 a[30:31], v24 offset:9216
    s_waitcnt lgkmcnt(4)
    v_mfma_f32_16x16x32_bf16 v[228:231], a[16:19], a[160:163], v[228:231]
    ds_read_b64_tr_b16 a[0:1], v13 offset:16384
    v_mfma_f32_16x16x32_bf16 v[236:239], a[16:19], a[164:167], v[236:239]
    ds_read_b64_tr_b16 a[2:3], v13 offset:17408
    buffer_load_dwordx4 v19, s[12:15], s24 offen offset:2048 sc1 lds
    v_mfma_f32_16x16x32_bf16 v[252:255], a[20:23], a[164:167], v[252:255]
    ds_read_b64_tr_b16 a[4:5], v14 offset:16384
    v_mfma_f32_16x16x32_bf16 v[244:247], a[20:23], a[160:163], v[244:247]
    ds_read_b64_tr_b16 a[6:7], v14 offset:17408
    s_waitcnt lgkmcnt(4)
    v_mfma_f32_16x16x32_bf16 a[224:227], a[24:27], a[160:163], a[224:227]
    ds_read_b64_tr_b16 a[8:9], v15 offset:16384
    buffer_load_dwordx4 v20, s[12:15], s24 offen offset:3072 sc1 lds
    v_mfma_f32_16x16x32_bf16 a[228:231], a[24:27], a[164:167], a[228:231]
    ds_read_b64_tr_b16 a[10:11], v15 offset:17408
    v_mfma_f32_16x16x32_bf16 a[236:239], a[28:31], a[164:167], a[236:239]
    ds_read_b64_tr_b16 a[12:13], v16 offset:16384
    s_waitcnt vmcnt(22)
    v_mfma_f32_16x16x32_bf16 a[232:235], a[28:31], a[160:163], a[232:235]
    ds_read_b64_tr_b16 a[14:15], v16 offset:17408
    s_waitcnt lgkmcnt(4)
    v_mfma_f32_16x16x32_bf16 v[36:39], a[0:3], a[168:171], v[36:39]
    ds_read_b64_tr_b16 a[16:17], v21 offset:16384
    s_add_u32 s24, s24, 262144
    v_mfma_f32_16x16x32_bf16 v[44:47], a[0:3], a[172:175], v[44:47]
    ds_read_b64_tr_b16 a[18:19], v21 offset:17408
    v_mfma_f32_16x16x32_bf16 v[60:63], a[4:7], a[172:175], v[60:63]
    ds_read_b64_tr_b16 a[20:21], v22 offset:16384
    v_mfma_f32_16x16x32_bf16 v[52:55], a[4:7], a[168:171], v[52:55]
    ds_read_b64_tr_b16 a[22:23], v22 offset:17408
    ds_read_b128 a[64:67], v30 offset:16384
    s_waitcnt lgkmcnt(5)
    v_mfma_f32_16x16x32_bf16 v[68:71], a[8:11], a[168:171], v[68:71]
    ds_read_b64_tr_b16 a[24:25], v23 offset:16384
    s_add_u32 s64, s64, s65
    s_add_u32 s77, s64, 0
    v_mfma_f32_16x16x32_bf16 v[76:79], a[8:11], a[172:175], v[76:79]
    ds_read_b64_tr_b16 a[26:27], v23 offset:17408
    v_mfma_f32_16x16x32_bf16 v[92:95], a[12:15], a[172:175], v[92:95]
    ds_read_b64_tr_b16 a[28:29], v24 offset:16384
    v_mfma_f32_16x16x32_bf16 v[84:87], a[12:15], a[168:171], v[84:87]
    ds_read_b64_tr_b16 a[30:31], v24 offset:17408
    s_waitcnt lgkmcnt(5)
    v_mfma_f32_16x16x32_bf16 v[100:103], a[16:19], a[168:171], v[100:103]
    ds_read_b64_tr_b16 a[0:1], v13 offset:24576
    buffer_store_dwordx4 v[96:99], v25, s[4:7], s77 offen sc1
    v_mfma_f32_16x16x32_bf16 v[108:111], a[16:19], a[172:175], v[108:111]
    ds_read_b64_tr_b16 a[2:3], v13 offset:25600
    ds_read_b128 a[68:71], v30 offset:18432
    v_mfma_f32_16x16x32_bf16 v[124:127], a[20:23], a[172:175], v[124:127]
    ds_read_b64_tr_b16 a[4:5], v14 offset:24576
    v_mfma_f32_16x16x32_bf16 v[116:119], a[20:23], a[168:171], v[116:119]
    ds_read_b64_tr_b16 a[6:7], v14 offset:25600
    s_waitcnt lgkmcnt(5)
    v_mfma_f32_16x16x32_bf16 v[132:135], a[24:27], a[168:171], v[132:135]
    ds_read_b64_tr_b16 a[8:9], v15 offset:24576
    s_add_u32 s77, s77, s26
    v_mfma_f32_16x16x32_bf16 v[140:143], a[24:27], a[172:175], v[140:143]
    ds_read_b64_tr_b16 a[10:11], v15 offset:25600
    ds_read_b128 a[72:75], v31 offset:16384
    v_mfma_f32_16x16x32_bf16 v[156:159], a[28:31], a[172:175], v[156:159]
    ds_read_b64_tr_b16 a[12:13], v16 offset:24576
    buffer_store_dwordx4 v[104:107], v25, s[4:7], s77 offen sc1
    v_mfma_f32_16x16x32_bf16 v[148:151], a[28:31], a[168:171], v[148:151]
    ds_read_b64_tr_b16 a[14:15], v16 offset:25600
    s_waitcnt lgkmcnt(5)
    v_mfma_f32_16x16x32_bf16 v[164:167], a[0:3], a[168:171], v[164:167]
    ds_read_b64_tr_b16 a[16:17], v21 offset:24576
    v_mfma_f32_16x16x32_bf16 v[172:175], a[0:3], a[172:175], v[172:175]
    ds_read_b64_tr_b16 a[18:19], v21 offset:25600
    v_mfma_f32_16x16x32_bf16 v[188:191], a[4:7], a[172:175], v[188:191]
    ds_read_b64_tr_b16 a[20:21], v22 offset:24576
    s_add_u32 s77, s77, s27
    v_mfma_f32_16x16x32_bf16 v[180:183], a[4:7], a[168:171], v[180:183]
    ds_read_b64_tr_b16 a[22:23], v22 offset:25600
    ds_read_b128 a[76:79], v31 offset:18432
    s_waitcnt lgkmcnt(5)
    v_mfma_f32_16x16x32_bf16 v[196:199], a[8:11], a[168:171], v[196:199]
    ds_read_b64_tr_b16 a[24:25], v23 offset:24576
    v_mfma_f32_16x16x32_bf16 v[204:207], a[8:11], a[172:175], v[204:207]
    ds_read_b64_tr_b16 a[26:27], v23 offset:25600
    buffer_store_dwordx4 v[112:115], v25, s[4:7], s77 offen sc1
    v_mfma_f32_16x16x32_bf16 v[220:223], a[12:15], a[172:175], v[220:223]
    ds_read_b64_tr_b16 a[28:29], v24 offset:24576
    v_mfma_f32_16x16x32_bf16 v[212:215], a[12:15], a[168:171], v[212:215]
    ds_read_b64_tr_b16 a[30:31], v24 offset:25600
    s_waitcnt vmcnt(15)
    s_barrier
    s_waitcnt lgkmcnt(5)
    v_mfma_f32_16x16x32_bf16 v[228:231], a[16:19], a[168:171], v[228:231]
    ds_read_b64_tr_b16 a[0:1], v13 offset:32768
    v_mfma_f32_16x16x32_bf16 v[236:239], a[16:19], a[172:175], v[236:239]
    ds_read_b64_tr_b16 a[2:3], v13 offset:33792
    s_add_u32 s77, s77, s26
    v_mfma_f32_16x16x32_bf16 v[252:255], a[20:23], a[172:175], v[252:255]
    ds_read_b64_tr_b16 a[4:5], v14 offset:32768
    v_mfma_f32_16x16x32_bf16 v[244:247], a[20:23], a[168:171], v[244:247]
    ds_read_b64_tr_b16 a[6:7], v14 offset:33792
    s_waitcnt lgkmcnt(4)
    v_mfma_f32_16x16x32_bf16 a[224:227], a[24:27], a[168:171], a[224:227]
    ds_read_b64_tr_b16 a[8:9], v15 offset:32768
    buffer_store_dwordx4 v[120:123], v25, s[4:7], s77 offen sc1
    v_mfma_f32_16x16x32_bf16 a[228:231], a[24:27], a[172:175], a[228:231]
    ds_read_b64_tr_b16 a[10:11], v15 offset:33792
    v_mfma_f32_16x16x32_bf16 a[236:239], a[28:31], a[172:175], a[236:239]
    ds_read_b64_tr_b16 a[12:13], v16 offset:32768
    v_mfma_f32_16x16x32_bf16 a[232:235], a[28:31], a[168:171], a[232:235]
    ds_read_b64_tr_b16 a[14:15], v16 offset:33792
    s_waitcnt lgkmcnt(4)
    v_mfma_f32_16x16x32_bf16 v[36:39], a[0:3], a[176:179], v[36:39]
    ds_read_b64_tr_b16 a[16:17], v21 offset:32768
    s_add_u32 m0, s30, 49152
    v_mfma_f32_16x16x32_bf16 v[44:47], a[0:3], a[180:183], v[44:47]
    ds_read_b64_tr_b16 a[18:19], v21 offset:33792
    s_lshl_b32 s32, s20, 12
    v_mfma_f32_16x16x32_bf16 v[60:63], a[4:7], a[180:183], v[60:63]
    ds_read_b64_tr_b16 a[20:21], v22 offset:32768
    buffer_load_dwordx4 v17, s[12:15], s24 offen offset:0 sc1 lds
    v_mfma_f32_16x16x32_bf16 v[52:55], a[4:7], a[176:179], v[52:55]
    ds_read_b64_tr_b16 a[22:23], v22 offset:33792
    s_waitcnt lgkmcnt(4)
    v_mfma_f32_16x16x32_bf16 v[68:71], a[8:11], a[176:179], v[68:71]
    ds_read_b64_tr_b16 a[24:25], v23 offset:32768
    s_xor_b32 s41, s21, 1
    v_mfma_f32_16x16x32_bf16 v[76:79], a[8:11], a[180:183], v[76:79]
    ds_read_b64_tr_b16 a[26:27], v23 offset:33792
    buffer_load_dwordx4 v18, s[12:15], s24 offen offset:1024 sc1 lds
    v_mfma_f32_16x16x32_bf16 v[92:95], a[12:15], a[180:183], v[92:95]
    ds_read_b64_tr_b16 a[28:29], v24 offset:32768
    v_mfma_f32_16x16x32_bf16 v[84:87], a[12:15], a[176:179], v[84:87]
    ds_read_b64_tr_b16 a[30:31], v24 offset:33792
    s_waitcnt lgkmcnt(4)
    v_mfma_f32_16x16x32_bf16 v[100:103], a[16:19], a[176:179], v[100:103]
    ds_read_b64_tr_b16 a[0:1], v13 offset:40960
    buffer_load_dwordx4 v19, s[12:15], s24 offen offset:2048 sc1 lds
    v_mfma_f32_16x16x32_bf16 v[108:111], a[16:19], a[180:183], v[108:111]
    ds_read_b64_tr_b16 a[2:3], v13 offset:41984
    s_lshl_b32 s48, s21, 4
    v_mfma_f32_16x16x32_bf16 v[124:127], a[20:23], a[180:183], v[124:127]
    ds_read_b64_tr_b16 a[4:5], v14 offset:40960
    s_add_u32 s48, s48, s22
    v_mfma_f32_16x16x32_bf16 v[116:119], a[20:23], a[176:179], v[116:119]
    ds_read_b64_tr_b16 a[6:7], v14 offset:41984
    s_waitcnt lgkmcnt(4)
    v_mfma_f32_16x16x32_bf16 v[132:135], a[24:27], a[176:179], v[132:135]
    ds_read_b64_tr_b16 a[8:9], v15 offset:40960
    buffer_load_dwordx4 v20, s[12:15], s24 offen offset:3072 sc1 lds
    v_mfma_f32_16x16x32_bf16 v[140:143], a[24:27], a[180:183], v[140:143]
    ds_read_b64_tr_b16 a[10:11], v15 offset:41984
    s_lshl_b32 s48, s48, 7
    v_mfma_f32_16x16x32_bf16 v[156:159], a[28:31], a[180:183], v[156:159]
    ds_read_b64_tr_b16 a[12:13], v16 offset:40960
    s_add_u32 s24, s24, 262144
    v_mfma_f32_16x16x32_bf16 v[148:151], a[28:31], a[176:179], v[148:151]
    ds_read_b64_tr_b16 a[14:15], v16 offset:41984
    s_waitcnt lgkmcnt(4)
    v_mfma_f32_16x16x32_bf16 v[164:167], a[0:3], a[176:179], v[164:167]
    ds_read_b64_tr_b16 a[16:17], v21 offset:40960
    s_add_u32 s33, s48, 100687872
    v_mfma_f32_16x16x32_bf16 v[172:175], a[0:3], a[180:183], v[172:175]
    ds_read_b64_tr_b16 a[18:19], v21 offset:41984
    s_add_u32 m0, s30, 65536
    v_mfma_f32_16x16x32_bf16 v[188:191], a[4:7], a[180:183], v[188:191]
    ds_read_b64_tr_b16 a[20:21], v22 offset:40960
    v_mfma_f32_16x16x32_bf16 v[180:183], a[4:7], a[176:179], v[180:183]
    ds_read_b64_tr_b16 a[22:23], v22 offset:41984
    s_waitcnt lgkmcnt(4)
    v_mfma_f32_16x16x32_bf16 v[196:199], a[8:11], a[176:179], v[196:199]
    ds_read_b64_tr_b16 a[24:25], v23 offset:40960
    buffer_load_dwordx4 v17, s[12:15], s24 offen offset:0 sc1 lds
    v_mfma_f32_16x16x32_bf16 v[204:207], a[8:11], a[180:183], v[204:207]
    ds_read_b64_tr_b16 a[26:27], v23 offset:41984
    s_lshl_b32 s48, s41, 4
    v_mfma_f32_16x16x32_bf16 v[220:223], a[12:15], a[180:183], v[220:223]
    ds_read_b64_tr_b16 a[28:29], v24 offset:40960
    buffer_load_dwordx4 v18, s[12:15], s24 offen offset:1024 sc1 lds
    v_mfma_f32_16x16x32_bf16 v[212:215], a[12:15], a[176:179], v[212:215]
    ds_read_b64_tr_b16 a[30:31], v24 offset:41984
    s_waitcnt lgkmcnt(4)
    v_mfma_f32_16x16x32_bf16 v[228:231], a[16:19], a[176:179], v[228:231]
    ds_read_b64_tr_b16 a[0:1], v5 offset:0
    s_add_u32 s48, s48, s22
    v_mfma_f32_16x16x32_bf16 v[236:239], a[16:19], a[180:183], v[236:239]
    ds_read_b64_tr_b16 a[2:3], v5 offset:1024
    buffer_load_dwordx4 v19, s[12:15], s24 offen offset:2048 sc1 lds
    v_mfma_f32_16x16x32_bf16 v[252:255], a[20:23], a[180:183], v[252:255]
    ds_read_b64_tr_b16 a[4:5], v6 offset:0
    s_lshl_b32 s49, s48, 7
    v_mfma_f32_16x16x32_bf16 v[244:247], a[20:23], a[176:179], v[244:247]
    ds_read_b64_tr_b16 a[6:7], v6 offset:1024
    s_waitcnt lgkmcnt(4)
    v_mfma_f32_16x16x32_bf16 a[224:227], a[24:27], a[176:179], a[224:227]
    ds_read_b64_tr_b16 a[8:9], v7 offset:0
    buffer_load_dwordx4 v20, s[12:15], s24 offen offset:3072 sc1 lds
    v_mfma_f32_16x16x32_bf16 a[228:231], a[24:27], a[180:183], a[228:231]
    ds_read_b64_tr_b16 a[10:11], v7 offset:1024
    s_add_u32 s34, s49, 100687872
    v_mfma_f32_16x16x32_bf16 a[236:239], a[28:31], a[180:183], a[236:239]
    ds_read_b64_tr_b16 a[12:13], v8 offset:0
    v_mfma_f32_16x16x32_bf16 a[232:235], a[28:31], a[176:179], a[232:235]
    ds_read_b64_tr_b16 a[14:15], v8 offset:1024
    s_waitcnt lgkmcnt(4)
    v_mfma_f32_16x16x32_bf16 v[36:39], a[0:3], a[184:187], v[36:39]
    ds_read_b64_tr_b16 a[16:17], v9 offset:0
    s_add_u32 s24, s24, 262144
    v_mfma_f32_16x16x32_bf16 v[44:47], a[0:3], a[188:191], v[44:47]
    ds_read_b64_tr_b16 a[18:19], v9 offset:1024
    s_lshl_b32 s48, s48, 2
    v_mfma_f32_16x16x32_bf16 v[60:63], a[4:7], a[188:191], v[60:63]
    ds_read_b64_tr_b16 a[20:21], v10 offset:0
    s_add_u32 s48, s48, s20
    v_mfma_f32_16x16x32_bf16 v[52:55], a[4:7], a[184:187], v[52:55]
    ds_read_b64_tr_b16 a[22:23], v10 offset:1024
    s_waitcnt lgkmcnt(4)
    v_mfma_f32_16x16x32_bf16 v[68:71], a[8:11], a[184:187], v[68:71]
    ds_read_b64_tr_b16 a[24:25], v11 offset:0
    s_add_u32 s77, s77, s27
    v_mfma_f32_16x16x32_bf16 v[76:79], a[8:11], a[188:191], v[76:79]
    ds_read_b64_tr_b16 a[26:27], v11 offset:1024
    s_lshl_b32 s49, s48, 13
    v_mfma_f32_16x16x32_bf16 v[92:95], a[12:15], a[188:191], v[92:95]
    ds_read_b64_tr_b16 a[28:29], v12 offset:0
    v_mfma_f32_16x16x32_bf16 v[84:87], a[12:15], a[184:187], v[84:87]
    ds_read_b64_tr_b16 a[30:31], v12 offset:1024
    s_waitcnt lgkmcnt(4)
    v_mfma_f32_16x16x32_bf16 v[100:103], a[16:19], a[184:187], v[100:103]
    ds_read_b64_tr_b16 a[0:1], v5 offset:8192
    buffer_store_dwordx4 v[128:131], v25, s[4:7], s77 offen sc1
    v_mfma_f32_16x16x32_bf16 v[108:111], a[16:19], a[188:191], v[108:111]
    ds_read_b64_tr_b16 a[2:3], v5 offset:9216
    s_add_u32 s35, s49, 50331648
    v_mfma_f32_16x16x32_bf16 v[124:127], a[20:23], a[188:191], v[124:127]
    ds_read_b64_tr_b16 a[4:5], v6 offset:8192
    v_mfma_f32_16x16x32_bf16 v[116:119], a[20:23], a[184:187], v[116:119]
    ds_read_b64_tr_b16 a[6:7], v6 offset:9216
    s_waitcnt lgkmcnt(4)
    v_mfma_f32_16x16x32_bf16 v[132:135], a[24:27], a[184:187], v[132:135]
    ds_read_b64_tr_b16 a[8:9], v7 offset:8192
    s_add_u32 s77, s77, s26
    v_mfma_f32_16x16x32_bf16 v[140:143], a[24:27], a[188:191], v[140:143]
    ds_read_b64_tr_b16 a[10:11], v7 offset:9216
    s_lshl_b32 s49, s48, 14
    v_mfma_f32_16x16x32_bf16 v[156:159], a[28:31], a[188:191], v[156:159]
    ds_read_b64_tr_b16 a[12:13], v8 offset:8192
    buffer_store_dwordx4 v[136:139], v25, s[4:7], s77 offen sc1
    v_mfma_f32_16x16x32_bf16 v[148:151], a[28:31], a[184:187], v[148:151]
    ds_read_b64_tr_b16 a[14:15], v8 offset:9216
    s_waitcnt lgkmcnt(4)
    v_mfma_f32_16x16x32_bf16 v[164:167], a[0:3], a[184:187], v[164:167]
    ds_read_b64_tr_b16 a[16:17], v9 offset:8192
    s_add_u32 s36, s49, 58720256
    v_mfma_f32_16x16x32_bf16 v[172:175], a[0:3], a[188:191], v[172:175]
    ds_read_b64_tr_b16 a[18:19], v9 offset:9216
    s_and_b32 s48, s21, 1
    v_mfma_f32_16x16x32_bf16 v[188:191], a[4:7], a[188:191], v[188:191]
    ds_read_b64_tr_b16 a[20:21], v10 offset:8192
    s_add_u32 s77, s77, s27
    v_mfma_f32_16x16x32_bf16 v[180:183], a[4:7], a[184:187], v[180:183]
    ds_read_b64_tr_b16 a[22:23], v10 offset:9216
    s_waitcnt lgkmcnt(4)
    v_mfma_f32_16x16x32_bf16 v[196:199], a[8:11], a[184:187], v[196:199]
    ds_read_b64_tr_b16 a[24:25], v11 offset:8192
    s_mul_i32 s48, s48, 448
    v_mfma_f32_16x16x32_bf16 v[204:207], a[8:11], a[188:191], v[204:207]
    ds_read_b64_tr_b16 a[26:27], v11 offset:9216
    buffer_store_dwordx4 v[144:147], v25, s[4:7], s77 offen sc1
    v_mfma_f32_16x16x32_bf16 v[220:223], a[12:15], a[188:191], v[220:223]
    ds_read_b64_tr_b16 a[28:29], v12 offset:8192
    v_mfma_f32_16x16x32_bf16 v[212:215], a[12:15], a[184:187], v[212:215]
    ds_read_b64_tr_b16 a[30:31], v12 offset:9216
    s_waitcnt vmcnt(15)
    s_barrier
    s_waitcnt lgkmcnt(4)
    v_mfma_f32_16x16x32_bf16 v[228:231], a[16:19], a[184:187], v[228:231]
    ds_read_b64_tr_b16 a[0:1], v5 offset:16384
    v_mfma_f32_16x16x32_bf16 v[236:239], a[16:19], a[188:191], v[236:239]
    ds_read_b64_tr_b16 a[2:3], v5 offset:17408
    s_add_u32 s77, s77, s26
    v_mfma_f32_16x16x32_bf16 v[252:255], a[20:23], a[188:191], v[252:255]
    ds_read_b64_tr_b16 a[4:5], v6 offset:16384
    v_mfma_f32_16x16x32_bf16 v[244:247], a[20:23], a[184:187], v[244:247]
    ds_read_b64_tr_b16 a[6:7], v6 offset:17408
    s_waitcnt lgkmcnt(4)
    v_mfma_f32_16x16x32_bf16 a[224:227], a[24:27], a[184:187], a[224:227]
    ds_read_b64_tr_b16 a[8:9], v7 offset:16384
    buffer_store_dwordx4 v[152:155], v25, s[4:7], s77 offen sc1
    v_mfma_f32_16x16x32_bf16 a[228:231], a[24:27], a[188:191], a[228:231]
    ds_read_b64_tr_b16 a[10:11], v7 offset:17408
    v_mfma_f32_16x16x32_bf16 a[236:239], a[28:31], a[188:191], a[236:239]
    ds_read_b64_tr_b16 a[12:13], v8 offset:16384
    v_mfma_f32_16x16x32_bf16 a[232:235], a[28:31], a[184:187], a[232:235]
    ds_read_b64_tr_b16 a[14:15], v8 offset:17408
    s_waitcnt lgkmcnt(4)
    v_mfma_f32_16x16x32_bf16 v[36:39], a[0:3], a[192:195], v[36:39]
    ds_read_b64_tr_b16 a[16:17], v9 offset:16384
    s_add_u32 m0, s30, 81920
    v_mfma_f32_16x16x32_bf16 v[44:47], a[0:3], a[196:199], v[44:47]
    ds_read_b64_tr_b16 a[18:19], v9 offset:17408
    s_mul_i32 s49, s20, 7168
    v_mfma_f32_16x16x32_bf16 v[60:63], a[4:7], a[196:199], v[60:63]
    ds_read_b64_tr_b16 a[20:21], v10 offset:16384
    buffer_load_dwordx4 v17, s[12:15], s24 offen offset:0 sc1 lds
    v_mfma_f32_16x16x32_bf16 v[52:55], a[4:7], a[192:195], v[52:55]
    ds_read_b64_tr_b16 a[22:23], v10 offset:17408
    s_waitcnt lgkmcnt(4)
    v_mfma_f32_16x16x32_bf16 v[68:71], a[8:11], a[192:195], v[68:71]
    ds_read_b64_tr_b16 a[24:25], v11 offset:16384
    s_add_u32 s48, s48, s49
    v_mfma_f32_16x16x32_bf16 v[76:79], a[8:11], a[196:199], v[76:79]
    ds_read_b64_tr_b16 a[26:27], v11 offset:17408
    buffer_load_dwordx4 v18, s[12:15], s24 offen offset:1024 sc1 lds
    v_mfma_f32_16x16x32_bf16 v[92:95], a[12:15], a[196:199], v[92:95]
    ds_read_b64_tr_b16 a[28:29], v12 offset:16384
    v_mfma_f32_16x16x32_bf16 v[84:87], a[12:15], a[192:195], v[84:87]
    ds_read_b64_tr_b16 a[30:31], v12 offset:17408
    s_waitcnt lgkmcnt(4)
    v_mfma_f32_16x16x32_bf16 v[100:103], a[16:19], a[192:195], v[100:103]
    ds_read_b64_tr_b16 a[0:1], v5 offset:24576
    buffer_load_dwordx4 v19, s[12:15], s24 offen offset:2048 sc1 lds
    v_mfma_f32_16x16x32_bf16 v[108:111], a[16:19], a[196:199], v[108:111]
    ds_read_b64_tr_b16 a[2:3], v5 offset:25600
    s_mul_i32 s49, s21, 229376
    v_mfma_f32_16x16x32_bf16 v[124:127], a[20:23], a[196:199], v[124:127]
    ds_read_b64_tr_b16 a[4:5], v6 offset:24576
    s_add_u32 s46, s48, s49
    v_mfma_f32_16x16x32_bf16 v[116:119], a[20:23], a[192:195], v[116:119]
    ds_read_b64_tr_b16 a[6:7], v6 offset:25600
    s_waitcnt lgkmcnt(4)
    v_mfma_f32_16x16x32_bf16 v[132:135], a[24:27], a[192:195], v[132:135]
    ds_read_b64_tr_b16 a[8:9], v7 offset:24576
    buffer_load_dwordx4 v20, s[12:15], s24 offen offset:3072 sc1 lds
    v_mfma_f32_16x16x32_bf16 v[140:143], a[24:27], a[196:199], v[140:143]
    ds_read_b64_tr_b16 a[10:11], v7 offset:25600
    s_mul_i32 s49, s41, 229376
    v_mfma_f32_16x16x32_bf16 v[156:159], a[28:31], a[196:199], v[156:159]
    ds_read_b64_tr_b16 a[12:13], v8 offset:24576
    s_add_u32 s24, s24, 262144
    v_mfma_f32_16x16x32_bf16 v[148:151], a[28:31], a[192:195], v[148:151]
    ds_read_b64_tr_b16 a[14:15], v8 offset:25600
    s_waitcnt lgkmcnt(4)
    v_mfma_f32_16x16x32_bf16 v[164:167], a[0:3], a[192:195], v[164:167]
    ds_read_b64_tr_b16 a[16:17], v9 offset:24576
    s_add_u32 s47, s48, s49
    v_mfma_f32_16x16x32_bf16 v[172:175], a[0:3], a[196:199], v[172:175]
    ds_read_b64_tr_b16 a[18:19], v9 offset:25600
    s_add_u32 m0, s30, 98304
    v_mfma_f32_16x16x32_bf16 v[188:191], a[4:7], a[196:199], v[188:191]
    ds_read_b64_tr_b16 a[20:21], v10 offset:24576
    v_mfma_f32_16x16x32_bf16 v[180:183], a[4:7], a[192:195], v[180:183]
    ds_read_b64_tr_b16 a[22:23], v10 offset:25600
    s_waitcnt lgkmcnt(4)
    v_mfma_f32_16x16x32_bf16 v[196:199], a[8:11], a[192:195], v[196:199]
    ds_read_b64_tr_b16 a[24:25], v11 offset:24576
    buffer_load_dwordx4 v17, s[12:15], s24 offen offset:0 sc1 lds
    v_mfma_f32_16x16x32_bf16 v[204:207], a[8:11], a[196:199], v[204:207]
    ds_read_b64_tr_b16 a[26:27], v11 offset:25600
    s_mul_i32 s49, s78, 896
    v_mfma_f32_16x16x32_bf16 v[220:223], a[12:15], a[196:199], v[220:223]
    ds_read_b64_tr_b16 a[28:29], v12 offset:24576
    buffer_load_dwordx4 v18, s[12:15], s24 offen offset:1024 sc1 lds
    v_mfma_f32_16x16x32_bf16 v[212:215], a[12:15], a[192:195], v[212:215]
    ds_read_b64_tr_b16 a[30:31], v12 offset:25600
    s_waitcnt lgkmcnt(4)
    v_mfma_f32_16x16x32_bf16 v[228:231], a[16:19], a[192:195], v[228:231]
    ds_read_b64_tr_b16 a[0:1], v5 offset:32768
    s_add_u32 s44, s48, s49
    v_mfma_f32_16x16x32_bf16 v[236:239], a[16:19], a[196:199], v[236:239]
    ds_read_b64_tr_b16 a[2:3], v5 offset:33792
    buffer_load_dwordx4 v19, s[12:15], s24 offen offset:2048 sc1 lds
    v_mfma_f32_16x16x32_bf16 v[252:255], a[20:23], a[196:199], v[252:255]
    ds_read_b64_tr_b16 a[4:5], v6 offset:32768
    s_mul_i32 s49, s79, 896
    v_mfma_f32_16x16x32_bf16 v[244:247], a[20:23], a[192:195], v[244:247]
    ds_read_b64_tr_b16 a[6:7], v6 offset:33792
    s_waitcnt lgkmcnt(4)
    v_mfma_f32_16x16x32_bf16 a[224:227], a[24:27], a[192:195], a[224:227]
    ds_read_b64_tr_b16 a[8:9], v7 offset:32768
    buffer_load_dwordx4 v20, s[12:15], s24 offen offset:3072 sc1 lds
    v_mfma_f32_16x16x32_bf16 a[228:231], a[24:27], a[196:199], a[228:231]
    ds_read_b64_tr_b16 a[10:11], v7 offset:33792
    s_add_u32 s45, s48, s49
    v_mfma_f32_16x16x32_bf16 a[236:239], a[28:31], a[196:199], a[236:239]
    ds_read_b64_tr_b16 a[12:13], v8 offset:32768
    v_mfma_f32_16x16x32_bf16 a[232:235], a[28:31], a[192:195], a[232:235]
    ds_read_b64_tr_b16 a[14:15], v8 offset:33792
    s_waitcnt lgkmcnt(4)
    v_mfma_f32_16x16x32_bf16 v[36:39], a[0:3], a[200:203], v[36:39]
    ds_read_b64_tr_b16 a[16:17], v9 offset:32768
    s_add_u32 s24, s24, 262144
    v_mfma_f32_16x16x32_bf16 v[44:47], a[0:3], a[204:207], v[44:47]
    ds_read_b64_tr_b16 a[18:19], v9 offset:33792
    s_and_b32 s48, s21, 1
    v_mfma_f32_16x16x32_bf16 v[60:63], a[4:7], a[204:207], v[60:63]
    ds_read_b64_tr_b16 a[20:21], v10 offset:32768
    s_lshl_b32 s49, s22, 1
    v_mfma_f32_16x16x32_bf16 v[52:55], a[4:7], a[200:203], v[52:55]
    ds_read_b64_tr_b16 a[22:23], v10 offset:33792
    s_waitcnt lgkmcnt(4)
    v_mfma_f32_16x16x32_bf16 v[68:71], a[8:11], a[200:203], v[68:71]
    ds_read_b64_tr_b16 a[24:25], v11 offset:32768
    s_add_u32 s64, s64, s65
    s_add_u32 s77, s64, 0
    v_mfma_f32_16x16x32_bf16 v[76:79], a[8:11], a[204:207], v[76:79]
    ds_read_b64_tr_b16 a[26:27], v11 offset:33792
    s_add_u32 s48, s48, s49
    v_mfma_f32_16x16x32_bf16 v[92:95], a[12:15], a[204:207], v[92:95]
    ds_read_b64_tr_b16 a[28:29], v12 offset:32768
    v_mfma_f32_16x16x32_bf16 v[84:87], a[12:15], a[200:203], v[84:87]
    ds_read_b64_tr_b16 a[30:31], v12 offset:33792
    s_waitcnt lgkmcnt(4)
    v_mfma_f32_16x16x32_bf16 v[100:103], a[16:19], a[200:203], v[100:103]
    ds_read_b64_tr_b16 a[0:1], v5 offset:40960
    buffer_store_dwordx4 v[160:163], v25, s[4:7], s77 offen sc1
    v_mfma_f32_16x16x32_bf16 v[108:111], a[16:19], a[204:207], v[108:111]
    ds_read_b64_tr_b16 a[2:3], v5 offset:41984
    s_lshl_b32 s49, s48, 7
    v_mfma_f32_16x16x32_bf16 v[124:127], a[20:23], a[204:207], v[124:127]
    ds_read_b64_tr_b16 a[4:5], v6 offset:40960
    v_mfma_f32_16x16x32_bf16 v[116:119], a[20:23], a[200:203], v[116:119]
    ds_read_b64_tr_b16 a[6:7], v6 offset:41984
    s_waitcnt lgkmcnt(4)
    v_mfma_f32_16x16x32_bf16 v[132:135], a[24:27], a[200:203], v[132:135]
    ds_read_b64_tr_b16 a[8:9], v7 offset:40960
    s_add_u32 s77, s77, s26
    v_mfma_f32_16x16x32_bf16 v[140:143], a[24:27], a[204:207], v[140:143]
    ds_read_b64_tr_b16 a[10:11], v7 offset:41984
    s_add_u32 s39, s49, 100665344
    v_mfma_f32_16x16x32_bf16 v[156:159], a[28:31], a[204:207], v[156:159]
    ds_read_b64_tr_b16 a[12:13], v8 offset:40960
    buffer_store_dwordx4 v[168:171], v25, s[4:7], s77 offen sc1
    v_mfma_f32_16x16x32_bf16 v[148:151], a[28:31], a[200:203], v[148:151]
    ds_read_b64_tr_b16 a[14:15], v8 offset:41984
    s_waitcnt lgkmcnt(4)
    v_mfma_f32_16x16x32_bf16 v[164:167], a[0:3], a[200:203], v[164:167]
    ds_read_b64_tr_b16 a[16:17], v9 offset:40960
    s_mul_i32 s48, s48, 458752
    v_mfma_f32_16x16x32_bf16 v[172:175], a[0:3], a[204:207], v[172:175]
    ds_read_b64_tr_b16 a[18:19], v9 offset:41984
    s_add_u32 s48, s48, 109051904
    v_mfma_f32_16x16x32_bf16 v[188:191], a[4:7], a[204:207], v[188:191]
    ds_read_b64_tr_b16 a[20:21], v10 offset:40960
    s_add_u32 s77, s77, s27
    v_mfma_f32_16x16x32_bf16 v[180:183], a[4:7], a[200:203], v[180:183]
    ds_read_b64_tr_b16 a[22:23], v10 offset:41984
    s_waitcnt lgkmcnt(4)
    v_mfma_f32_16x16x32_bf16 v[196:199], a[8:11], a[200:203], v[196:199]
    ds_read_b64_tr_b16 a[24:25], v11 offset:40960
    s_lshr_b32 s41, s21, 1
    v_mfma_f32_16x16x32_bf16 v[204:207], a[8:11], a[204:207], v[204:207]
    ds_read_b64_tr_b16 a[26:27], v11 offset:41984
    buffer_store_dwordx4 v[176:179], v25, s[4:7], s77 offen sc1
    v_mfma_f32_16x16x32_bf16 v[220:223], a[12:15], a[204:207], v[220:223]
    ds_read_b64_tr_b16 a[28:29], v12 offset:40960
    v_mfma_f32_16x16x32_bf16 v[212:215], a[12:15], a[200:203], v[212:215]
    ds_read_b64_tr_b16 a[30:31], v12 offset:41984
    s_waitcnt vmcnt(15)
    s_barrier
    s_waitcnt lgkmcnt(4)
    v_mfma_f32_16x16x32_bf16 v[228:231], a[16:19], a[200:203], v[228:231]
    ds_read_b64_tr_b16 a[0:1], v5 offset:49152
    v_mfma_f32_16x16x32_bf16 v[236:239], a[16:19], a[204:207], v[236:239]
    ds_read_b64_tr_b16 a[2:3], v5 offset:50176
    s_add_u32 s77, s77, s26
    v_mfma_f32_16x16x32_bf16 v[252:255], a[20:23], a[204:207], v[252:255]
    ds_read_b64_tr_b16 a[4:5], v6 offset:49152
    v_mfma_f32_16x16x32_bf16 v[244:247], a[20:23], a[200:203], v[244:247]
    ds_read_b64_tr_b16 a[6:7], v6 offset:50176
    s_waitcnt lgkmcnt(4)
    v_mfma_f32_16x16x32_bf16 a[224:227], a[24:27], a[200:203], a[224:227]
    ds_read_b64_tr_b16 a[8:9], v7 offset:49152
    buffer_store_dwordx4 v[184:187], v25, s[4:7], s77 offen sc1
    v_mfma_f32_16x16x32_bf16 a[228:231], a[24:27], a[204:207], a[228:231]
    ds_read_b64_tr_b16 a[10:11], v7 offset:50176
    v_mfma_f32_16x16x32_bf16 a[236:239], a[28:31], a[204:207], a[236:239]
    ds_read_b64_tr_b16 a[12:13], v8 offset:49152
    v_mfma_f32_16x16x32_bf16 a[232:235], a[28:31], a[200:203], a[232:235]
    ds_read_b64_tr_b16 a[14:15], v8 offset:50176
    s_waitcnt lgkmcnt(4)
    v_mfma_f32_16x16x32_bf16 v[36:39], a[0:3], a[208:211], v[36:39]
    ds_read_b64_tr_b16 a[16:17], v9 offset:49152
    s_add_u32 m0, s30, 0
    v_mfma_f32_16x16x32_bf16 v[44:47], a[0:3], a[212:215], v[44:47]
    ds_read_b64_tr_b16 a[18:19], v9 offset:50176
    s_mul_i32 s49, s41, 7168
    v_mfma_f32_16x16x32_bf16 v[60:63], a[4:7], a[212:215], v[60:63]
    ds_read_b64_tr_b16 a[20:21], v10 offset:49152
    buffer_load_dwordx4 v26, s[16:19], s31 offen offset:0 sc1 lds
    v_mfma_f32_16x16x32_bf16 v[52:55], a[4:7], a[208:211], v[52:55]
    ds_read_b64_tr_b16 a[22:23], v10 offset:50176
    s_waitcnt lgkmcnt(4)
    v_mfma_f32_16x16x32_bf16 v[68:71], a[8:11], a[208:211], v[68:71]
    ds_read_b64_tr_b16 a[24:25], v11 offset:49152
    s_add_u32 s37, s48, s49
    v_mfma_f32_16x16x32_bf16 v[76:79], a[8:11], a[212:215], v[76:79]
    ds_read_b64_tr_b16 a[26:27], v11 offset:50176
    buffer_load_dwordx4 v27, s[16:19], s31 offen offset:1024 sc1 lds
    v_mfma_f32_16x16x32_bf16 v[92:95], a[12:15], a[212:215], v[92:95]
    ds_read_b64_tr_b16 a[28:29], v12 offset:49152
    v_mfma_f32_16x16x32_bf16 v[84:87], a[12:15], a[208:211], v[84:87]
    ds_read_b64_tr_b16 a[30:31], v12 offset:50176
    s_waitcnt lgkmcnt(4)
    v_mfma_f32_16x16x32_bf16 v[100:103], a[16:19], a[208:211], v[100:103]
    ds_read_b64_tr_b16 a[0:1], v5 offset:57344
    buffer_load_dwordx4 v28, s[16:19], s31 offen offset:2048 sc1 lds
    v_mfma_f32_16x16x32_bf16 v[108:111], a[16:19], a[212:215], v[108:111]
    ds_read_b64_tr_b16 a[2:3], v5 offset:58368
    s_mul_i32 s49, s20, 114688
    v_mfma_f32_16x16x32_bf16 v[124:127], a[20:23], a[212:215], v[124:127]
    ds_read_b64_tr_b16 a[4:5], v6 offset:57344
    s_add_u32 s37, s37, s49
    v_mfma_f32_16x16x32_bf16 v[116:119], a[20:23], a[208:211], v[116:119]
    ds_read_b64_tr_b16 a[6:7], v6 offset:58368
    s_waitcnt lgkmcnt(4)
    v_mfma_f32_16x16x32_bf16 v[132:135], a[24:27], a[208:211], v[132:135]
    ds_read_b64_tr_b16 a[8:9], v7 offset:57344
    buffer_load_dwordx4 v29, s[16:19], s31 offen offset:3072 sc1 lds
    v_mfma_f32_16x16x32_bf16 v[140:143], a[24:27], a[212:215], v[140:143]
    ds_read_b64_tr_b16 a[10:11], v7 offset:58368
    s_mul_i32 s49, s41, 57344
    v_mfma_f32_16x16x32_bf16 v[156:159], a[28:31], a[212:215], v[156:159]
    ds_read_b64_tr_b16 a[12:13], v8 offset:57344
    s_add_u32 s31, s31, 114688
    v_mfma_f32_16x16x32_bf16 v[148:151], a[28:31], a[208:211], v[148:151]
    ds_read_b64_tr_b16 a[14:15], v8 offset:58368
    s_waitcnt lgkmcnt(4)
    v_mfma_f32_16x16x32_bf16 v[164:167], a[0:3], a[208:211], v[164:167]
    ds_read_b64_tr_b16 a[16:17], v9 offset:57344
    s_add_u32 s48, s48, s49
    v_mfma_f32_16x16x32_bf16 v[172:175], a[0:3], a[212:215], v[172:175]
    ds_read_b64_tr_b16 a[18:19], v9 offset:58368
    s_add_u32 m0, s30, 16384
    v_mfma_f32_16x16x32_bf16 v[188:191], a[4:7], a[212:215], v[188:191]
    ds_read_b64_tr_b16 a[20:21], v10 offset:57344
    v_mfma_f32_16x16x32_bf16 v[180:183], a[4:7], a[208:211], v[180:183]
    ds_read_b64_tr_b16 a[22:23], v10 offset:58368
    s_waitcnt lgkmcnt(4)
    v_mfma_f32_16x16x32_bf16 v[196:199], a[8:11], a[208:211], v[196:199]
    ds_read_b64_tr_b16 a[24:25], v11 offset:57344
    buffer_load_dwordx4 v26, s[16:19], s31 offen offset:0 sc1 lds
    v_mfma_f32_16x16x32_bf16 v[204:207], a[8:11], a[212:215], v[204:207]
    ds_read_b64_tr_b16 a[26:27], v11 offset:58368
    s_lshl_b32 s49, s20, 11
    v_mfma_f32_16x16x32_bf16 v[220:223], a[12:15], a[212:215], v[220:223]
    ds_read_b64_tr_b16 a[28:29], v12 offset:57344
    buffer_load_dwordx4 v27, s[16:19], s31 offen offset:1024 sc1 lds
    v_mfma_f32_16x16x32_bf16 v[212:215], a[12:15], a[208:211], v[212:215]
    ds_read_b64_tr_b16 a[30:31], v12 offset:58368
    s_waitcnt lgkmcnt(4)
    v_mfma_f32_16x16x32_bf16 v[228:231], a[16:19], a[208:211], v[228:231]
    ds_read_b64_tr_b16 a[0:1], v13 offset:0
    s_add_u32 s38, s48, s49
    v_mfma_f32_16x16x32_bf16 v[236:239], a[16:19], a[212:215], v[236:239]
    ds_read_b64_tr_b16 a[2:3], v13 offset:1024
    buffer_load_dwordx4 v28, s[16:19], s31 offen offset:2048 sc1 lds
    v_mfma_f32_16x16x32_bf16 v[252:255], a[20:23], a[212:215], v[252:255]
    ds_read_b64_tr_b16 a[4:5], v14 offset:0
    s_lshl_b32 s48, s22, 3
    v_mfma_f32_16x16x32_bf16 v[244:247], a[20:23], a[208:211], v[244:247]
    ds_read_b64_tr_b16 a[6:7], v14 offset:1024
    s_waitcnt lgkmcnt(4)
    v_mfma_f32_16x16x32_bf16 a[224:227], a[24:27], a[208:211], a[224:227]
    ds_read_b64_tr_b16 a[8:9], v15 offset:0
    buffer_load_dwordx4 v29, s[16:19], s31 offen offset:3072 sc1 lds
    v_mfma_f32_16x16x32_bf16 a[228:231], a[24:27], a[212:215], a[228:231]
    ds_read_b64_tr_b16 a[10:11], v15 offset:1024
    s_add_u32 s48, s48, s41
    v_mfma_f32_16x16x32_bf16 a[236:239], a[28:31], a[212:215], a[236:239]
    ds_read_b64_tr_b16 a[12:13], v16 offset:0
    v_mfma_f32_16x16x32_bf16 a[232:235], a[28:31], a[208:211], a[232:235]
    ds_read_b64_tr_b16 a[14:15], v16 offset:1024
    s_waitcnt lgkmcnt(4)
    v_mfma_f32_16x16x32_bf16 v[36:39], a[0:3], a[216:219], v[36:39]
    ds_read_b64_tr_b16 a[16:17], v21 offset:0
    s_add_u32 s31, s31, 114688
    v_mfma_f32_16x16x32_bf16 v[44:47], a[0:3], a[220:223], v[44:47]
    ds_read_b64_tr_b16 a[18:19], v21 offset:1024
    s_mul_i32 s48, s48, 14336
    v_mfma_f32_16x16x32_bf16 v[60:63], a[4:7], a[220:223], v[60:63]
    ds_read_b64_tr_b16 a[20:21], v22 offset:0
    s_and_b32 s49, s21, 1
    v_mfma_f32_16x16x32_bf16 v[52:55], a[4:7], a[216:219], v[52:55]
    ds_read_b64_tr_b16 a[22:23], v22 offset:1024
    s_waitcnt lgkmcnt(4)
    v_mfma_f32_16x16x32_bf16 v[68:71], a[8:11], a[216:219], v[68:71]
    ds_read_b64_tr_b16 a[24:25], v23 offset:0
    s_add_u32 s77, s77, s27
    v_mfma_f32_16x16x32_bf16 v[76:79], a[8:11], a[220:223], v[76:79]
    ds_read_b64_tr_b16 a[26:27], v23 offset:1024
    s_mul_i32 s49, s49, 448
    v_mfma_f32_16x16x32_bf16 v[92:95], a[12:15], a[220:223], v[92:95]
    ds_read_b64_tr_b16 a[28:29], v24 offset:0
    v_mfma_f32_16x16x32_bf16 v[84:87], a[12:15], a[216:219], v[84:87]
    ds_read_b64_tr_b16 a[30:31], v24 offset:1024
    s_waitcnt lgkmcnt(4)
    v_mfma_f32_16x16x32_bf16 v[100:103], a[16:19], a[216:219], v[100:103]
    ds_read_b64_tr_b16 a[0:1], v13 offset:8192
    buffer_store_dwordx4 v[192:195], v25, s[4:7], s77 offen sc1
    v_mfma_f32_16x16x32_bf16 v[108:111], a[16:19], a[220:223], v[108:111]
    ds_read_b64_tr_b16 a[2:3], v13 offset:9216
    s_add_u32 s48, s48, s49
    v_mfma_f32_16x16x32_bf16 v[124:127], a[20:23], a[220:223], v[124:127]
    ds_read_b64_tr_b16 a[4:5], v14 offset:8192
    v_mfma_f32_16x16x32_bf16 v[116:119], a[20:23], a[216:219], v[116:119]
    ds_read_b64_tr_b16 a[6:7], v14 offset:9216
    s_waitcnt lgkmcnt(4)
    v_mfma_f32_16x16x32_bf16 v[132:135], a[24:27], a[216:219], v[132:135]
    ds_read_b64_tr_b16 a[8:9], v15 offset:8192
    s_add_u32 s77, s77, s26
    v_mfma_f32_16x16x32_bf16 v[140:143], a[24:27], a[220:223], v[140:143]
    ds_read_b64_tr_b16 a[10:11], v15 offset:9216
    s_lshl_b32 s49, s20, 7
    v_mfma_f32_16x16x32_bf16 v[156:159], a[28:31], a[220:223], v[156:159]
    ds_read_b64_tr_b16 a[12:13], v16 offset:8192
    buffer_store_dwordx4 v[200:203], v25, s[4:7], s77 offen sc1
    v_mfma_f32_16x16x32_bf16 v[148:151], a[28:31], a[216:219], v[148:151]
    ds_read_b64_tr_b16 a[14:15], v16 offset:9216
    s_waitcnt lgkmcnt(4)
    v_mfma_f32_16x16x32_bf16 v[164:167], a[0:3], a[216:219], v[164:167]
    ds_read_b64_tr_b16 a[16:17], v21 offset:8192
    s_add_u32 s40, s48, s49
    v_mfma_f32_16x16x32_bf16 v[172:175], a[0:3], a[220:223], v[172:175]
    ds_read_b64_tr_b16 a[18:19], v21 offset:9216
    s_add_u32 s52, s35, 6144
    v_mfma_f32_16x16x32_bf16 v[188:191], a[4:7], a[220:223], v[188:191]
    ds_read_b64_tr_b16 a[20:21], v22 offset:8192
    s_add_u32 s77, s77, s27
    v_mfma_f32_16x16x32_bf16 v[180:183], a[4:7], a[216:219], v[180:183]
    ds_read_b64_tr_b16 a[22:23], v22 offset:9216
    s_waitcnt lgkmcnt(4)
    v_mfma_f32_16x16x32_bf16 v[196:199], a[8:11], a[216:219], v[196:199]
    ds_read_b64_tr_b16 a[24:25], v23 offset:8192
    s_bitcmp1_b32 s2, 0
    s_cselect_b32 s52, 1073741824, s52
    v_mfma_f32_16x16x32_bf16 v[204:207], a[8:11], a[220:223], v[204:207]
    ds_read_b64_tr_b16 a[26:27], v23 offset:9216
    buffer_store_dwordx4 v[208:211], v25, s[4:7], s77 offen sc1
    v_mfma_f32_16x16x32_bf16 v[220:223], a[12:15], a[220:223], v[220:223]
    ds_read_b64_tr_b16 a[28:29], v24 offset:8192
    v_mfma_f32_16x16x32_bf16 v[212:215], a[12:15], a[216:219], v[212:215]
    ds_read_b64_tr_b16 a[30:31], v24 offset:9216
    s_waitcnt vmcnt(15)
    s_barrier
    s_waitcnt lgkmcnt(4)
    v_mfma_f32_16x16x32_bf16 v[228:231], a[16:19], a[216:219], v[228:231]
    ds_read_b64_tr_b16 a[0:1], v13 offset:16384
    v_mfma_f32_16x16x32_bf16 v[236:239], a[16:19], a[220:223], v[236:239]
    ds_read_b64_tr_b16 a[2:3], v13 offset:17408
    s_add_u32 s77, s77, s26
    v_mfma_f32_16x16x32_bf16 v[252:255], a[20:23], a[220:223], v[252:255]
    ds_read_b64_tr_b16 a[4:5], v14 offset:16384
    v_mfma_f32_16x16x32_bf16 v[244:247], a[20:23], a[216:219], v[244:247]
    ds_read_b64_tr_b16 a[6:7], v14 offset:17408
    s_waitcnt lgkmcnt(4)
    v_mfma_f32_16x16x32_bf16 a[224:227], a[24:27], a[216:219], a[224:227]
    ds_read_b64_tr_b16 a[8:9], v15 offset:16384
    buffer_store_dwordx4 v[216:219], v25, s[4:7], s77 offen sc1
    v_mfma_f32_16x16x32_bf16 a[228:231], a[24:27], a[220:223], a[228:231]
    ds_read_b64_tr_b16 a[10:11], v15 offset:17408
    v_mfma_f32_16x16x32_bf16 a[236:239], a[28:31], a[220:223], a[236:239]
    ds_read_b64_tr_b16 a[12:13], v16 offset:16384
    v_mfma_f32_16x16x32_bf16 a[232:235], a[28:31], a[216:219], a[232:235]
    ds_read_b64_tr_b16 a[14:15], v16 offset:17408
    s_waitcnt lgkmcnt(4)
    v_mfma_f32_16x16x32_bf16 v[36:39], a[0:3], a[64:67], v[36:39]
    ds_read_b64_tr_b16 a[16:17], v21 offset:16384
    s_add_u32 m0, s30, 32768
    v_mfma_f32_16x16x32_bf16 v[44:47], a[0:3], a[68:71], v[44:47]
    ds_read_b64_tr_b16 a[18:19], v21 offset:17408
    v_mfma_f32_16x16x32_bf16 v[60:63], a[4:7], a[68:71], v[60:63]
    ds_read_b64_tr_b16 a[20:21], v22 offset:16384
    buffer_load_dwordx4 v26, s[16:19], s31 offen offset:0 sc1 lds
    v_mfma_f32_16x16x32_bf16 v[52:55], a[4:7], a[64:67], v[52:55]
    ds_read_b64_tr_b16 a[22:23], v22 offset:17408
    s_mov_b32 s68, 0x3db8aa3b
    s_waitcnt lgkmcnt(4)
    v_mfma_f32_16x16x32_bf16 v[68:71], a[8:11], a[64:67], v[68:71]
    ds_read_b64_tr_b16 a[24:25], v23 offset:16384
    v_mfma_f32_16x16x32_bf16 v[76:79], a[8:11], a[68:71], v[76:79]
    ds_read_b64_tr_b16 a[26:27], v23 offset:17408
    buffer_load_dwordx4 v27, s[16:19], s31 offen offset:1024 sc1 lds
    v_mfma_f32_16x16x32_bf16 v[92:95], a[12:15], a[68:71], v[92:95]
    ds_read_b64_tr_b16 a[28:29], v24 offset:16384
    s_mov_b32 s69, 0x3db8aa3b
    v_mfma_f32_16x16x32_bf16 v[84:87], a[12:15], a[64:67], v[84:87]
    ds_read_b64_tr_b16 a[30:31], v24 offset:17408
    s_waitcnt lgkmcnt(4)
    v_mfma_f32_16x16x32_bf16 v[100:103], a[16:19], a[64:67], v[100:103]
    ds_read_b64_tr_b16 a[0:1], v13 offset:24576
    buffer_load_dwordx4 v28, s[16:19], s31 offen offset:2048 sc1 lds
    v_mfma_f32_16x16x32_bf16 v[108:111], a[16:19], a[68:71], v[108:111]
    ds_read_b64_tr_b16 a[2:3], v13 offset:25600
    v_mfma_f32_16x16x32_bf16 v[124:127], a[20:23], a[68:71], v[124:127]
    ds_read_b64_tr_b16 a[4:5], v14 offset:24576
    s_lshl_b32 s70, s21, 4
    v_mfma_f32_16x16x32_bf16 v[116:119], a[20:23], a[64:67], v[116:119]
    ds_read_b64_tr_b16 a[6:7], v14 offset:25600
    s_waitcnt lgkmcnt(4)
    v_mfma_f32_16x16x32_bf16 v[132:135], a[24:27], a[64:67], v[132:135]
    ds_read_b64_tr_b16 a[8:9], v15 offset:24576
    buffer_load_dwordx4 v29, s[16:19], s31 offen offset:3072 sc1 lds
    v_mfma_f32_16x16x32_bf16 v[140:143], a[24:27], a[68:71], v[140:143]
    ds_read_b64_tr_b16 a[10:11], v15 offset:25600
    v_mfma_f32_16x16x32_bf16 v[156:159], a[28:31], a[68:71], v[156:159]
    ds_read_b64_tr_b16 a[12:13], v16 offset:24576
    s_add_u32 s31, s31, 114688
    v_mfma_f32_16x16x32_bf16 v[148:151], a[28:31], a[64:67], v[148:151]
    ds_read_b64_tr_b16 a[14:15], v16 offset:25600
    s_add_u32 s70, s70, s22
    s_waitcnt lgkmcnt(4)
    v_mfma_f32_16x16x32_bf16 v[164:167], a[0:3], a[64:67], v[164:167]
    ds_read_b64_tr_b16 a[16:17], v21 offset:24576
    v_mfma_f32_16x16x32_bf16 v[172:175], a[0:3], a[68:71], v[172:175]
    ds_read_b64_tr_b16 a[18:19], v21 offset:25600
    s_add_u32 m0, s30, 49152
    v_mfma_f32_16x16x32_bf16 v[188:191], a[4:7], a[68:71], v[188:191]
    ds_read_b64_tr_b16 a[20:21], v22 offset:24576
    v_mfma_f32_16x16x32_bf16 v[180:183], a[4:7], a[64:67], v[180:183]
    ds_read_b64_tr_b16 a[22:23], v22 offset:25600
    s_lshl_b32 s70, s70, 2
    s_waitcnt lgkmcnt(4)
    v_mfma_f32_16x16x32_bf16 v[196:199], a[8:11], a[64:67], v[196:199]
    ds_read_b64_tr_b16 a[24:25], v23 offset:24576
    buffer_load_dwordx4 v26, s[16:19], s31 offen offset:0 sc1 lds
    v_mfma_f32_16x16x32_bf16 v[204:207], a[8:11], a[68:71], v[204:207]
    ds_read_b64_tr_b16 a[26:27], v23 offset:25600
    v_mfma_f32_16x16x32_bf16 v[220:223], a[12:15], a[68:71], v[220:223]
    ds_read_b64_tr_b16 a[28:29], v24 offset:24576
    buffer_load_dwordx4 v27, s[16:19], s31 offen offset:1024 sc1 lds
    v_mfma_f32_16x16x32_bf16 v[212:215], a[12:15], a[64:67], v[212:215]
    ds_read_b64_tr_b16 a[30:31], v24 offset:25600
    s_add_u32 s70, s70, s20
    s_waitcnt lgkmcnt(4)
    v_mfma_f32_16x16x32_bf16 v[228:231], a[16:19], a[64:67], v[228:231]
    ds_read_b64_tr_b16 a[0:1], v13 offset:32768
    v_mfma_f32_16x16x32_bf16 v[236:239], a[16:19], a[68:71], v[236:239]
    ds_read_b64_tr_b16 a[2:3], v13 offset:33792
    buffer_load_dwordx4 v28, s[16:19], s31 offen offset:2048 sc1 lds
    v_mfma_f32_16x16x32_bf16 v[252:255], a[20:23], a[68:71], v[252:255]
    ds_read_b64_tr_b16 a[4:5], v14 offset:32768
    v_mfma_f32_16x16x32_bf16 v[244:247], a[20:23], a[64:67], v[244:247]
    ds_read_b64_tr_b16 a[6:7], v14 offset:33792
    s_waitcnt lgkmcnt(4)
    v_mfma_f32_16x16x32_bf16 a[224:227], a[24:27], a[64:67], a[224:227]
    ds_read_b64_tr_b16 a[8:9], v15 offset:32768
    buffer_load_dwordx4 v29, s[16:19], s31 offen offset:3072 sc1 lds
    v_mfma_f32_16x16x32_bf16 a[228:231], a[24:27], a[68:71], a[228:231]
    ds_read_b64_tr_b16 a[10:11], v15 offset:33792
    s_lshl_b32 s70, s70, 14
    v_mfma_f32_16x16x32_bf16 a[236:239], a[28:31], a[68:71], a[236:239]
    ds_read_b64_tr_b16 a[12:13], v16 offset:32768
    v_mfma_f32_16x16x32_bf16 a[232:235], a[28:31], a[64:67], a[232:235]
    ds_read_b64_tr_b16 a[14:15], v16 offset:33792
    s_waitcnt lgkmcnt(4)
    v_mfma_f32_16x16x32_bf16 v[36:39], a[0:3], a[72:75], v[36:39]
    ds_read_b64_tr_b16 a[16:17], v21 offset:32768
    s_add_u32 s31, s31, 114688
    v_mfma_f32_16x16x32_bf16 v[44:47], a[0:3], a[76:79], v[44:47]
    ds_read_b64_tr_b16 a[18:19], v21 offset:33792
    s_add_u32 s70, s70, 33554432
    v_mfma_f32_16x16x32_bf16 v[60:63], a[4:7], a[76:79], v[60:63]
    ds_read_b64_tr_b16 a[20:21], v22 offset:32768
    v_mfma_f32_16x16x32_bf16 v[52:55], a[4:7], a[72:75], v[52:55]
    ds_read_b64_tr_b16 a[22:23], v22 offset:33792
    s_waitcnt lgkmcnt(4)
    v_mfma_f32_16x16x32_bf16 v[68:71], a[8:11], a[72:75], v[68:71]
    ds_read_b64_tr_b16 a[24:25], v23 offset:32768
    s_add_u32 s64, s64, s65
    s_add_u32 s77, s64, 0
    v_mfma_f32_16x16x32_bf16 v[76:79], a[8:11], a[76:79], v[76:79]
    ds_read_b64_tr_b16 a[26:27], v23 offset:33792
    s_cmp_ge_u32 s22, 8
    s_cselect_b32 s70, s70, 1073741824
    v_mfma_f32_16x16x32_bf16 v[92:95], a[12:15], a[76:79], v[92:95]
    ds_read_b64_tr_b16 a[28:29], v24 offset:32768
    v_mfma_f32_16x16x32_bf16 v[84:87], a[12:15], a[72:75], v[84:87]
    ds_read_b64_tr_b16 a[30:31], v24 offset:33792
    s_waitcnt lgkmcnt(4)
    v_mfma_f32_16x16x32_bf16 v[100:103], a[16:19], a[72:75], v[100:103]
    ds_read_b64_tr_b16 a[0:1], v13 offset:40960
    buffer_store_dwordx4 v[224:227], v25, s[4:7], s77 offen sc1
    v_mfma_f32_16x16x32_bf16 v[108:111], a[16:19], a[76:79], v[108:111]
    ds_read_b64_tr_b16 a[2:3], v13 offset:41984
    v_mfma_f32_16x16x32_bf16 v[124:127], a[20:23], a[76:79], v[124:127]
    ds_read_b64_tr_b16 a[4:5], v14 offset:40960
    v_mfma_f32_16x16x32_bf16 v[116:119], a[20:23], a[72:75], v[116:119]
    ds_read_b64_tr_b16 a[6:7], v14 offset:41984
    s_waitcnt lgkmcnt(4)
    v_mfma_f32_16x16x32_bf16 v[132:135], a[24:27], a[72:75], v[132:135]
    ds_read_b64_tr_b16 a[8:9], v15 offset:40960
    s_add_u32 s77, s77, s26
    v_mfma_f32_16x16x32_bf16 v[140:143], a[24:27], a[76:79], v[140:143]
    ds_read_b64_tr_b16 a[10:11], v15 offset:41984
    v_mfma_f32_16x16x32_bf16 v[156:159], a[28:31], a[76:79], v[156:159]
    ds_read_b64_tr_b16 a[12:13], v16 offset:40960
    buffer_store_dwordx4 v[232:235], v25, s[4:7], s77 offen sc1
    v_mfma_f32_16x16x32_bf16 v[148:151], a[28:31], a[72:75], v[148:151]
    ds_read_b64_tr_b16 a[14:15], v16 offset:41984
    s_waitcnt lgkmcnt(4)
    v_mfma_f32_16x16x32_bf16 v[164:167], a[0:3], a[72:75], v[164:167]
    ds_read_b64_tr_b16 a[16:17], v21 offset:40960
    v_mfma_f32_16x16x32_bf16 v[172:175], a[0:3], a[76:79], v[172:175]
    ds_read_b64_tr_b16 a[18:19], v21 offset:41984
    v_mfma_f32_16x16x32_bf16 v[188:191], a[4:7], a[76:79], v[188:191]
    ds_read_b64_tr_b16 a[20:21], v22 offset:40960
    s_add_u32 s77, s77, s27
    v_mfma_f32_16x16x32_bf16 v[180:183], a[4:7], a[72:75], v[180:183]
    ds_read_b64_tr_b16 a[22:23], v22 offset:41984
    s_waitcnt lgkmcnt(4)
    v_mfma_f32_16x16x32_bf16 v[196:199], a[8:11], a[72:75], v[196:199]
    ds_read_b64_tr_b16 a[24:25], v23 offset:40960
    v_mfma_f32_16x16x32_bf16 v[204:207], a[8:11], a[76:79], v[204:207]
    ds_read_b64_tr_b16 a[26:27], v23 offset:41984
    buffer_store_dwordx4 v[240:243], v25, s[4:7], s77 offen sc1
    v_mfma_f32_16x16x32_bf16 v[220:223], a[12:15], a[76:79], v[220:223]
    ds_read_b64_tr_b16 a[28:29], v24 offset:40960
    v_mfma_f32_16x16x32_bf16 v[212:215], a[12:15], a[72:75], v[212:215]
    ds_read_b64_tr_b16 a[30:31], v24 offset:41984
    s_waitcnt vmcnt(15)
    s_barrier
    s_waitcnt lgkmcnt(4)
    v_mfma_f32_16x16x32_bf16 v[228:231], a[16:19], a[72:75], v[228:231]
    ds_read_b64_tr_b16 a[0:1], v5 offset:0
    v_mfma_f32_16x16x32_bf16 v[236:239], a[16:19], a[76:79], v[236:239]
    ds_read_b64_tr_b16 a[2:3], v5 offset:1024
    s_add_u32 s77, s77, s26
    v_mfma_f32_16x16x32_bf16 v[252:255], a[20:23], a[76:79], v[252:255]
    ds_read_b64_tr_b16 a[4:5], v6 offset:0
    v_mfma_f32_16x16x32_bf16 v[244:247], a[20:23], a[72:75], v[244:247]
    ds_read_b64_tr_b16 a[6:7], v6 offset:1024
    s_waitcnt lgkmcnt(4)
    v_mfma_f32_16x16x32_bf16 a[224:227], a[24:27], a[72:75], a[224:227]
    ds_read_b64_tr_b16 a[8:9], v7 offset:0
    buffer_store_dwordx4 v[248:251], v25, s[4:7], s77 offen sc1
    v_mfma_f32_16x16x32_bf16 a[228:231], a[24:27], a[76:79], a[228:231]
    ds_read_b64_tr_b16 a[10:11], v7 offset:1024
    v_mfma_f32_16x16x32_bf16 a[236:239], a[28:31], a[76:79], a[236:239]
    ds_read_b64_tr_b16 a[12:13], v8 offset:0
    v_mfma_f32_16x16x32_bf16 a[232:235], a[28:31], a[72:75], a[232:235]
    ds_read_b64_tr_b16 a[14:15], v8 offset:1024
    s_bitcmp1_b32 s2, 0
    s_cbranch_scc1 qf_odd
    s_waitcnt lgkmcnt(4)
    v_mfma_f32_16x16x32_bf16 v[32:35], a[0:3], a[128:131], 0
    ds_read_b64_tr_b16 a[16:17], v9 offset:0
    s_add_u32 m0, s30, 65536
    v_mfma_f32_16x16x32_bf16 v[40:43], a[0:3], a[132:135], 0
    ds_read_b64_tr_b16 a[18:19], v9 offset:1024
    v_mfma_f32_16x16x32_bf16 v[56:59], a[4:7], a[132:135], 0
    ds_read_b64_tr_b16 a[20:21], v10 offset:0
    buffer_load_dwordx4 v26, s[16:19], s31 offen offset:0 sc1 lds
    v_mfma_f32_16x16x32_bf16 v[48:51], a[4:7], a[128:131], 0
    ds_read_b64_tr_b16 a[22:23], v10 offset:1024
    s_waitcnt lgkmcnt(4)
    v_mfma_f32_16x16x32_bf16 v[64:67], a[8:11], a[128:131], 0
    ds_read_b64_tr_b16 a[24:25], v11 offset:0
    v_mfma_f32_16x16x32_bf16 v[72:75], a[8:11], a[132:135], 0
    ds_read_b64_tr_b16 a[26:27], v11 offset:1024
    buffer_load_dwordx4 v27, s[16:19], s31 offen offset:1024 sc1 lds
    v_mul_f32 v36, s68, v36
    v_mfma_f32_16x16x32_bf16 v[88:91], a[12:15], a[132:135], 0
    ds_read_b64_tr_b16 a[28:29], v12 offset:0
    v_mul_f32 v37, s68, v37
    v_mul_f32 v38, s68, v38
    v_mfma_f32_16x16x32_bf16 v[80:83], a[12:15], a[128:131], 0
    ds_read_b64_tr_b16 a[30:31], v12 offset:1024
    v_mul_f32 v39, s68, v39
    s_waitcnt lgkmcnt(4)
    v_mfma_f32_16x16x32_bf16 v[96:99], a[16:19], a[128:131], 0
    ds_read_b64_tr_b16 a[0:1], v5 offset:8192
    buffer_load_dwordx4 v28, s[16:19], s31 offen offset:2048 sc1 lds
    v_mul_f32 v52, s68, v52
    v_mfma_f32_16x16x32_bf16 v[104:107], a[16:19], a[132:135], 0
    ds_read_b64_tr_b16 a[2:3], v5 offset:9216
    v_mul_f32 v53, s68, v53
    v_mfma_f32_16x16x32_bf16 v[120:123], a[20:23], a[132:135], 0
    ds_read_b64_tr_b16 a[4:5], v6 offset:8192
    v_mul_f32 v54, s68, v54
    v_mfma_f32_16x16x32_bf16 v[112:115], a[20:23], a[128:131], 0
    ds_read_b64_tr_b16 a[6:7], v6 offset:9216
    v_mul_f32 v55, s68, v55
    s_waitcnt lgkmcnt(4)
    v_mfma_f32_16x16x32_bf16 v[128:131], a[24:27], a[128:131], 0
    ds_read_b64_tr_b16 a[8:9], v7 offset:8192
    buffer_load_dwordx4 v29, s[16:19], s31 offen offset:3072 sc1 lds
    v_cvt_pk_bf16_f32 v36, v36, v37
    v_mfma_f32_16x16x32_bf16 v[136:139], a[24:27], a[132:135], 0
    ds_read_b64_tr_b16 a[10:11], v7 offset:9216
    v_cvt_pk_bf16_f32 v37, v38, v39
    v_cvt_pk_bf16_f32 v38, v52, v53
    v_mfma_f32_16x16x32_bf16 v[152:155], a[28:31], a[132:135], 0
    ds_read_b64_tr_b16 a[12:13], v8 offset:8192
    s_add_u32 s31, s31, 114688
    v_cvt_pk_bf16_f32 v39, v54, v55
    v_mfma_f32_16x16x32_bf16 v[144:147], a[28:31], a[128:131], 0
    ds_read_b64_tr_b16 a[14:15], v8 offset:9216
    s_add_u32 s3, s70, 0
    s_waitcnt lgkmcnt(4)
    v_mfma_f32_16x16x32_bf16 v[160:163], a[0:3], a[128:131], 0
    ds_read_b64_tr_b16 a[16:17], v9 offset:8192
    buffer_store_dwordx4 v[36:39], v25, s[4:7], s3 offen offset:0 sc1
    v_mfma_f32_16x16x32_bf16 v[168:171], a[0:3], a[132:135], 0
    ds_read_b64_tr_b16 a[18:19], v9 offset:9216
    s_add_u32 m0, s30, 81920
    v_mul_f32 v68, s68, v68
    v_mfma_f32_16x16x32_bf16 v[184:187], a[4:7], a[132:135], 0
    ds_read_b64_tr_b16 a[20:21], v10 offset:8192
    v_mul_f32 v69, s68, v69
    v_mfma_f32_16x16x32_bf16 v[176:179], a[4:7], a[128:131], 0
    ds_read_b64_tr_b16 a[22:23], v10 offset:9216
    v_mul_f32 v70, s68, v70
    v_mul_f32 v71, s68, v71
    s_waitcnt lgkmcnt(4)
    v_mfma_f32_16x16x32_bf16 v[192:195], a[8:11], a[128:131], 0
    ds_read_b64_tr_b16 a[24:25], v11 offset:8192
    buffer_load_dwordx4 v26, s[16:19], s31 offen offset:0 sc1 lds
    v_mul_f32 v84, s68, v84
    v_mfma_f32_16x16x32_bf16 v[200:203], a[8:11], a[132:135], 0
    ds_read_b64_tr_b16 a[26:27], v11 offset:9216
    v_mul_f32 v85, s68, v85
    v_mfma_f32_16x16x32_bf16 v[216:219], a[12:15], a[132:135], 0
    ds_read_b64_tr_b16 a[28:29], v12 offset:8192
    buffer_load_dwordx4 v27, s[16:19], s31 offen offset:1024 sc1 lds
    v_mul_f32 v86, s68, v86
    v_mfma_f32_16x16x32_bf16 v[208:211], a[12:15], a[128:131], 0
    ds_read_b64_tr_b16 a[30:31], v12 offset:9216
    v_mul_f32 v87, s68, v87
    s_waitcnt lgkmcnt(4)
    v_mfma_f32_16x16x32_bf16 v[224:227], a[16:19], a[128:131], 0
    ds_read_b64_tr_b16 a[0:1], v5 offset:16384
    v_cvt_pk_bf16_f32 v68, v68, v69
    v_mfma_f32_16x16x32_bf16 v[232:235], a[16:19], a[132:135], 0
    ds_read_b64_tr_b16 a[2:3], v5 offset:17408
    buffer_load_dwordx4 v28, s[16:19], s31 offen offset:2048 sc1 lds
    v_cvt_pk_bf16_f32 v69, v70, v71
    v_mfma_f32_16x16x32_bf16 v[248:251], a[20:23], a[132:135], 0
    ds_read_b64_tr_b16 a[4:5], v6 offset:16384
    v_cvt_pk_bf16_f32 v70, v84, v85
    v_mfma_f32_16x16x32_bf16 v[240:243], a[20:23], a[128:131], 0
    ds_read_b64_tr_b16 a[6:7], v6 offset:17408
    v_cvt_pk_bf16_f32 v71, v86, v87
    buffer_store_dwordx4 v[68:71], v25, s[4:7], s3 offen offset:1024 sc1
    s_waitcnt lgkmcnt(4)
    v_mfma_f32_16x16x32_bf16 a[240:243], a[24:27], a[128:131], 0
    ds_read_b64_tr_b16 a[8:9], v7 offset:16384
    buffer_load_dwordx4 v29, s[16:19], s31 offen offset:3072 sc1 lds
    v_mul_f32 v100, s68, v100
    v_mfma_f32_16x16x32_bf16 a[244:247], a[24:27], a[132:135], 0
    ds_read_b64_tr_b16 a[10:11], v7 offset:17408
    v_mul_f32 v101, s68, v101
    v_mfma_f32_16x16x32_bf16 a[252:255], a[28:31], a[132:135], 0
    ds_read_b64_tr_b16 a[12:13], v8 offset:16384
    buffer_load_dword v31, off, s[60:63], 0 sc1
    v_mul_f32 v102, s68, v102
    v_mfma_f32_16x16x32_bf16 a[248:251], a[28:31], a[128:131], 0
    ds_read_b64_tr_b16 a[14:15], v8 offset:17408
    v_mul_f32 v103, s68, v103
    s_waitcnt lgkmcnt(4)
    v_mfma_f32_16x16x32_bf16 v[32:35], a[0:3], a[136:139], v[32:35]
    ds_read_b64_tr_b16 a[16:17], v9 offset:16384
    s_add_u32 s31, s31, 114688
    v_mul_f32 v116, s68, v116
    v_mfma_f32_16x16x32_bf16 v[40:43], a[0:3], a[140:143], v[40:43]
    ds_read_b64_tr_b16 a[18:19], v9 offset:17408
    v_mul_f32 v117, s68, v117
    v_mfma_f32_16x16x32_bf16 v[56:59], a[4:7], a[140:143], v[56:59]
    ds_read_b64_tr_b16 a[20:21], v10 offset:16384
    v_mul_f32 v118, s68, v118
    v_mul_f32 v119, s68, v119
    v_mfma_f32_16x16x32_bf16 v[48:51], a[4:7], a[136:139], v[48:51]
    ds_read_b64_tr_b16 a[22:23], v10 offset:17408
    v_cvt_pk_bf16_f32 v100, v100, v101
    s_waitcnt lgkmcnt(4)
    v_mfma_f32_16x16x32_bf16 v[64:67], a[8:11], a[136:139], v[64:67]
    ds_read_b64_tr_b16 a[24:25], v11 offset:16384
    v_cvt_pk_bf16_f32 v101, v102, v103
    v_mfma_f32_16x16x32_bf16 v[72:75], a[8:11], a[140:143], v[72:75]
    ds_read_b64_tr_b16 a[26:27], v11 offset:17408
    v_cvt_pk_bf16_f32 v102, v116, v117
    v_mfma_f32_16x16x32_bf16 v[88:91], a[12:15], a[140:143], v[88:91]
    ds_read_b64_tr_b16 a[28:29], v12 offset:16384
    v_cvt_pk_bf16_f32 v103, v118, v119
    v_mfma_f32_16x16x32_bf16 v[80:83], a[12:15], a[136:139], v[80:83]
    ds_read_b64_tr_b16 a[30:31], v12 offset:17408
    buffer_store_dwordx4 v[100:103], v25, s[4:7], s3 offen offset:2048 sc1
    s_waitcnt lgkmcnt(4)
    v_mfma_f32_16x16x32_bf16 v[96:99], a[16:19], a[136:139], v[96:99]
    ds_read_b64_tr_b16 a[0:1], v5 offset:24576
    v_mul_f32 v132, s68, v132
    v_mfma_f32_16x16x32_bf16 v[104:107], a[16:19], a[140:143], v[104:107]
    ds_read_b64_tr_b16 a[2:3], v5 offset:25600
    v_mul_f32 v133, s68, v133
    v_mul_f32 v134, s68, v134
    v_mfma_f32_16x16x32_bf16 v[120:123], a[20:23], a[140:143], v[120:123]
    ds_read_b64_tr_b16 a[4:5], v6 offset:24576
    v_mul_f32 v135, s68, v135
    v_mfma_f32_16x16x32_bf16 v[112:115], a[20:23], a[136:139], v[112:115]
    ds_read_b64_tr_b16 a[6:7], v6 offset:25600
    v_mul_f32 v148, s68, v148
    s_waitcnt lgkmcnt(4)
    v_mfma_f32_16x16x32_bf16 v[128:131], a[24:27], a[136:139], v[128:131]
    ds_read_b64_tr_b16 a[8:9], v7 offset:24576
    v_mul_f32 v149, s68, v149
    v_mfma_f32_16x16x32_bf16 v[136:139], a[24:27], a[140:143], v[136:139]
    ds_read_b64_tr_b16 a[10:11], v7 offset:25600
    v_mul_f32 v150, s68, v150
    v_mfma_f32_16x16x32_bf16 v[152:155], a[28:31], a[140:143], v[152:155]
    ds_read_b64_tr_b16 a[12:13], v8 offset:24576
    v_mul_f32 v151, s68, v151
    v_mfma_f32_16x16x32_bf16 v[144:147], a[28:31], a[136:139], v[144:147]
    ds_read_b64_tr_b16 a[14:15], v8 offset:25600
    v_cvt_pk_bf16_f32 v132, v132, v133
    s_waitcnt lgkmcnt(4)
    v_mfma_f32_16x16x32_bf16 v[160:163], a[0:3], a[136:139], v[160:163]
    ds_read_b64_tr_b16 a[16:17], v9 offset:24576
    v_cvt_pk_bf16_f32 v133, v134, v135
    v_mfma_f32_16x16x32_bf16 v[168:171], a[0:3], a[140:143], v[168:171]
    ds_read_b64_tr_b16 a[18:19], v9 offset:25600
    v_cvt_pk_bf16_f32 v134, v148, v149
    v_cvt_pk_bf16_f32 v135, v150, v151
    v_mfma_f32_16x16x32_bf16 v[184:187], a[4:7], a[140:143], v[184:187]
    ds_read_b64_tr_b16 a[20:21], v10 offset:24576
    buffer_store_dwordx4 v[132:135], v25, s[4:7], s3 offen offset:3072 sc1
    v_mfma_f32_16x16x32_bf16 v[176:179], a[4:7], a[136:139], v[176:179]
    ds_read_b64_tr_b16 a[22:23], v10 offset:25600
    v_mul_f32 v164, s68, v164
    s_waitcnt lgkmcnt(4)
    v_mfma_f32_16x16x32_bf16 v[192:195], a[8:11], a[136:139], v[192:195]
    ds_read_b64_tr_b16 a[24:25], v11 offset:24576
    v_mul_f32 v165, s68, v165
    v_mfma_f32_16x16x32_bf16 v[200:203], a[8:11], a[140:143], v[200:203]
    ds_read_b64_tr_b16 a[26:27], v11 offset:25600
    v_mul_f32 v166, s68, v166
    v_mfma_f32_16x16x32_bf16 v[216:219], a[12:15], a[140:143], v[216:219]
    ds_read_b64_tr_b16 a[28:29], v12 offset:24576
    v_mul_f32 v167, s68, v167
    v_mfma_f32_16x16x32_bf16 v[208:211], a[12:15], a[136:139], v[208:211]
    ds_read_b64_tr_b16 a[30:31], v12 offset:25600
    s_waitcnt vmcnt(17)
    s_barrier
    s_waitcnt lgkmcnt(4)
    v_mfma_f32_16x16x32_bf16 v[224:227], a[16:19], a[136:139], v[224:227]
    ds_read_b64_tr_b16 a[0:1], v5 offset:32768
    v_mul_f32 v180, s68, v180
    v_mul_f32 v181, s68, v181
    v_mfma_f32_16x16x32_bf16 v[232:235], a[16:19], a[140:143], v[232:235]
    ds_read_b64_tr_b16 a[2:3], v5 offset:33792
    v_mul_f32 v182, s68, v182
    v_mul_f32 v183, s68, v183
    v_mfma_f32_16x16x32_bf16 v[248:251], a[20:23], a[140:143], v[248:251]
    ds_read_b64_tr_b16 a[4:5], v6 offset:32768
    v_cvt_pk_bf16_f32 v164, v164, v165
    v_mfma_f32_16x16x32_bf16 v[240:243], a[20:23], a[136:139], v[240:243]
    ds_read_b64_tr_b16 a[6:7], v6 offset:33792
    v_cvt_pk_bf16_f32 v165, v166, v167
    s_waitcnt lgkmcnt(4)
    v_mfma_f32_16x16x32_bf16 a[240:243], a[24:27], a[136:139], a[240:243]
    ds_read_b64_tr_b16 a[8:9], v7 offset:32768
    v_cvt_pk_bf16_f32 v166, v180, v181
    v_mfma_f32_16x16x32_bf16 a[244:247], a[24:27], a[140:143], a[244:247]
    ds_read_b64_tr_b16 a[10:11], v7 offset:33792
    v_cvt_pk_bf16_f32 v167, v182, v183
    v_mfma_f32_16x16x32_bf16 a[252:255], a[28:31], a[140:143], a[252:255]
    ds_read_b64_tr_b16 a[12:13], v8 offset:32768
    s_add_u32 s3, s70, 4096
    v_mfma_f32_16x16x32_bf16 a[248:251], a[28:31], a[136:139], a[248:251]
    ds_read_b64_tr_b16 a[14:15], v8 offset:33792
    buffer_store_dwordx4 v[164:167], v25, s[4:7], s3 offen offset:0 sc1
    s_waitcnt lgkmcnt(4)
    v_mfma_f32_16x16x32_bf16 v[32:35], a[0:3], a[144:147], v[32:35]
    ds_read_b64_tr_b16 a[16:17], v9 offset:32768
    s_add_u32 m0, s30, 98304
    v_mul_f32 v196, s68, v196
    v_mfma_f32_16x16x32_bf16 v[40:43], a[0:3], a[148:151], v[40:43]
    ds_read_b64_tr_b16 a[18:19], v9 offset:33792
    v_mul_f32 v197, s68, v197
    v_mul_f32 v198, s68, v198
    v_mfma_f32_16x16x32_bf16 v[56:59], a[4:7], a[148:151], v[56:59]
    ds_read_b64_tr_b16 a[20:21], v10 offset:32768
    buffer_load_dwordx4 v26, s[16:19], s31 offen offset:0 sc1 lds
    v_mul_f32 v199, s68, v199
    v_mfma_f32_16x16x32_bf16 v[48:51], a[4:7], a[144:147], v[48:51]
    ds_read_b64_tr_b16 a[22:23], v10 offset:33792
    v_mul_f32 v212, s68, v212
    v_mul_f32 v213, s68, v213
    s_waitcnt lgkmcnt(4)
    v_mfma_f32_16x16x32_bf16 v[64:67], a[8:11], a[144:147], v[64:67]
    ds_read_b64_tr_b16 a[24:25], v11 offset:32768
    v_mul_f32 v214, s68, v214
    v_mfma_f32_16x16x32_bf16 v[72:75], a[8:11], a[148:151], v[72:75]
    ds_read_b64_tr_b16 a[26:27], v11 offset:33792
    buffer_load_dwordx4 v27, s[16:19], s31 offen offset:1024 sc1 lds
    v_mul_f32 v215, s68, v215
    v_mfma_f32_16x16x32_bf16 v[88:91], a[12:15], a[148:151], v[88:91]
    ds_read_b64_tr_b16 a[28:29], v12 offset:32768
    v_cvt_pk_bf16_f32 v196, v196, v197
    v_cvt_pk_bf16_f32 v197, v198, v199
    v_mfma_f32_16x16x32_bf16 v[80:83], a[12:15], a[144:147], v[80:83]
    ds_read_b64_tr_b16 a[30:31], v12 offset:33792
    v_cvt_pk_bf16_f32 v198, v212, v213
    s_waitcnt lgkmcnt(4)
    v_mfma_f32_16x16x32_bf16 v[96:99], a[16:19], a[144:147], v[96:99]
    ds_read_b64_tr_b16 a[0:1], v5 offset:40960
    buffer_load_dwordx4 v28, s[16:19], s31 offen offset:2048 sc1 lds
    v_cvt_pk_bf16_f32 v199, v214, v215
    v_mfma_f32_16x16x32_bf16 v[104:107], a[16:19], a[148:151], v[104:107]
    ds_read_b64_tr_b16 a[2:3], v5 offset:41984
    buffer_store_dwordx4 v[196:199], v25, s[4:7], s3 offen offset:1024 sc1
    v_mul_f32 v228, s68, v228
    v_mfma_f32_16x16x32_bf16 v[120:123], a[20:23], a[148:151], v[120:123]
    ds_read_b64_tr_b16 a[4:5], v6 offset:40960
    v_mul_f32 v229, s68, v229
    v_mfma_f32_16x16x32_bf16 v[112:115], a[20:23], a[144:147], v[112:115]
    ds_read_b64_tr_b16 a[6:7], v6 offset:41984
    v_mul_f32 v230, s68, v230
    v_mul_f32 v231, s68, v231
    s_waitcnt lgkmcnt(4)
    v_mfma_f32_16x16x32_bf16 v[128:131], a[24:27], a[144:147], v[128:131]
    ds_read_b64_tr_b16 a[8:9], v7 offset:40960
    buffer_load_dwordx4 v29, s[16:19], s31 offen offset:3072 sc1 lds
    v_mul_f32 v244, s68, v244
    v_mfma_f32_16x16x32_bf16 v[136:139], a[24:27], a[148:151], v[136:139]
    ds_read_b64_tr_b16 a[10:11], v7 offset:41984
    v_mul_f32 v245, s68, v245
    v_mul_f32 v246, s68, v246
    v_mfma_f32_16x16x32_bf16 v[152:155], a[28:31], a[148:151], v[152:155]
    ds_read_b64_tr_b16 a[12:13], v8 offset:40960
    s_add_u32 s31, s31, 114688
    v_mul_f32 v247, s68, v247
    v_mfma_f32_16x16x32_bf16 v[144:147], a[28:31], a[144:147], v[144:147]
    ds_read_b64_tr_b16 a[14:15], v8 offset:41984
    v_cvt_pk_bf16_f32 v228, v228, v229
    s_waitcnt lgkmcnt(4)
    v_mfma_f32_16x16x32_bf16 v[160:163], a[0:3], a[144:147], v[160:163]
    ds_read_b64_tr_b16 a[16:17], v9 offset:40960
    v_cvt_pk_bf16_f32 v229, v230, v231
    v_cvt_pk_bf16_f32 v230, v244, v245
    v_mfma_f32_16x16x32_bf16 v[168:171], a[0:3], a[148:151], v[168:171]
    ds_read_b64_tr_b16 a[18:19], v9 offset:41984
    s_add_u32 m0, s30, 0
    v_cvt_pk_bf16_f32 v231, v246, v247
    v_mfma_f32_16x16x32_bf16 v[184:187], a[4:7], a[148:151], v[184:187]
    ds_read_b64_tr_b16 a[20:21], v10 offset:40960
    buffer_store_dwordx4 v[228:231], v25, s[4:7], s3 offen offset:2048 sc1
    v_mfma_f32_16x16x32_bf16 v[176:179], a[4:7], a[144:147], v[176:179]
    ds_read_b64_tr_b16 a[22:23], v10 offset:41984
    v_accvgpr_read_b32 v52, a224
    v_accvgpr_read_b32 v53, a225
    s_waitcnt lgkmcnt(4)
    v_mfma_f32_16x16x32_bf16 v[192:195], a[8:11], a[144:147], v[192:195]
    ds_read_b64_tr_b16 a[24:25], v11 offset:40960
    buffer_load_dwordx4 v26, s[16:19], s31 offen offset:0 sc1 lds
    v_accvgpr_read_b32 v54, a226
    v_mfma_f32_16x16x32_bf16 v[200:203], a[8:11], a[148:151], v[200:203]
    ds_read_b64_tr_b16 a[26:27], v11 offset:41984
    v_accvgpr_read_b32 v55, a227
    v_mfma_f32_16x16x32_bf16 v[216:219], a[12:15], a[148:151], v[216:219]
    ds_read_b64_tr_b16 a[28:29], v12 offset:40960
    buffer_load_dwordx4 v27, s[16:19], s31 offen offset:1024 sc1 lds
    v_mul_f32 v52, s68, v52
    v_mfma_f32_16x16x32_bf16 v[208:211], a[12:15], a[144:147], v[208:211]
    ds_read_b64_tr_b16 a[30:31], v12 offset:41984
    v_mul_f32 v53, s68, v53
    v_mul_f32 v54, s68, v54
    s_waitcnt lgkmcnt(4)
    v_mfma_f32_16x16x32_bf16 v[224:227], a[16:19], a[144:147], v[224:227]
    ds_read_b64_tr_b16 a[0:1], v5 offset:49152
    v_mul_f32 v55, s68, v55
    v_mfma_f32_16x16x32_bf16 v[232:235], a[16:19], a[148:151], v[232:235]
    ds_read_b64_tr_b16 a[2:3], v5 offset:50176
    buffer_load_dwordx4 v28, s[16:19], s31 offen offset:2048 sc1 lds
    v_accvgpr_read_b32 v84, a232
    v_mfma_f32_16x16x32_bf16 v[248:251], a[20:23], a[148:151], v[248:251]
    ds_read_b64_tr_b16 a[4:5], v6 offset:49152
    v_accvgpr_read_b32 v85, a233
    v_accvgpr_read_b32 v86, a234
    v_mfma_f32_16x16x32_bf16 v[240:243], a[20:23], a[144:147], v[240:243]
    ds_read_b64_tr_b16 a[6:7], v6 offset:50176
    v_accvgpr_read_b32 v87, a235
    v_mul_f32 v84, s68, v84
    s_waitcnt lgkmcnt(4)
    v_mfma_f32_16x16x32_bf16 a[240:243], a[24:27], a[144:147], a[240:243]
    ds_read_b64_tr_b16 a[8:9], v7 offset:49152
    buffer_load_dwordx4 v29, s[16:19], s31 offen offset:3072 sc1 lds
    v_mul_f32 v85, s68, v85
    v_mfma_f32_16x16x32_bf16 a[244:247], a[24:27], a[148:151], a[244:247]
    ds_read_b64_tr_b16 a[10:11], v7 offset:50176
    v_mul_f32 v86, s68, v86
    v_mfma_f32_16x16x32_bf16 a[252:255], a[28:31], a[148:151], a[252:255]
    ds_read_b64_tr_b16 a[12:13], v8 offset:49152
    v_mul_f32 v87, s68, v87
    v_cvt_pk_bf16_f32 v52, v52, v53
    v_mfma_f32_16x16x32_bf16 a[248:251], a[28:31], a[144:147], a[248:251]
    ds_read_b64_tr_b16 a[14:15], v8 offset:50176
    v_cvt_pk_bf16_f32 v53, v54, v55
    s_waitcnt lgkmcnt(4)
    v_mfma_f32_16x16x32_bf16 v[32:35], a[0:3], a[152:155], v[32:35]
    ds_read_b64_tr_b16 a[16:17], v9 offset:49152
    s_add_u32 s31, s31, 114688
    v_cvt_pk_bf16_f32 v54, v84, v85
    v_mfma_f32_16x16x32_bf16 v[40:43], a[0:3], a[156:159], v[40:43]
    ds_read_b64_tr_b16 a[18:19], v9 offset:50176
    v_cvt_pk_bf16_f32 v55, v86, v87
    buffer_store_dwordx4 v[52:55], v25, s[4:7], s3 offen offset:3072 sc1
    v_mfma_f32_16x16x32_bf16 v[56:59], a[4:7], a[156:159], v[56:59]
    ds_read_b64_tr_b16 a[20:21], v10 offset:49152
    v_mul_f32 v44, s68, v44
    v_mfma_f32_16x16x32_bf16 v[48:51], a[4:7], a[152:155], v[48:51]
    ds_read_b64_tr_b16 a[22:23], v10 offset:50176
    v_mul_f32 v45, s68, v45
    s_waitcnt lgkmcnt(4)
    v_mfma_f32_16x16x32_bf16 v[64:67], a[8:11], a[152:155], v[64:67]
    ds_read_b64_tr_b16 a[24:25], v11 offset:49152
    v_mul_f32 v46, s68, v46
    v_mul_f32 v47, s68, v47
    v_mfma_f32_16x16x32_bf16 v[72:75], a[8:11], a[156:159], v[72:75]
    ds_read_b64_tr_b16 a[26:27], v11 offset:50176
    v_mul_f32 v60, s68, v60
    v_mfma_f32_16x16x32_bf16 v[88:91], a[12:15], a[156:159], v[88:91]
    ds_read_b64_tr_b16 a[28:29], v12 offset:49152
    v_mul_f32 v61, s68, v61
    v_mul_f32 v62, s68, v62
    v_mfma_f32_16x16x32_bf16 v[80:83], a[12:15], a[152:155], v[80:83]
    ds_read_b64_tr_b16 a[30:31], v12 offset:50176
    v_mul_f32 v63, s68, v63
    s_waitcnt lgkmcnt(4)
    v_mfma_f32_16x16x32_bf16 v[96:99], a[16:19], a[152:155], v[96:99]
    ds_read_b64_tr_b16 a[0:1], v5 offset:57344
    v_cvt_pk_bf16_f32 v44, v44, v45
    v_mfma_f32_16x16x32_bf16 v[104:107], a[16:19], a[156:159], v[104:107]
    ds_read_b64_tr_b16 a[2:3], v5 offset:58368
    v_cvt_pk_bf16_f32 v45, v46, v47
    v_cvt_pk_bf16_f32 v46, v60, v61
    v_mfma_f32_16x16x32_bf16 v[120:123], a[20:23], a[156:159], v[120:123]
    ds_read_b64_tr_b16 a[4:5], v6 offset:57344
    v_cvt_pk_bf16_f32 v47, v62, v63
    v_mfma_f32_16x16x32_bf16 v[112:115], a[20:23], a[152:155], v[112:115]
    ds_read_b64_tr_b16 a[6:7], v6 offset:58368
    s_add_u32 s3, s70, 8192
    s_waitcnt lgkmcnt(4)
    v_mfma_f32_16x16x32_bf16 v[128:131], a[24:27], a[152:155], v[128:131]
    ds_read_b64_tr_b16 a[8:9], v7 offset:57344
    buffer_store_dwordx4 v[44:47], v25, s[4:7], s3 offen offset:0 sc1
    v_mul_f32 v76, s68, v76
    v_mfma_f32_16x16x32_bf16 v[136:139], a[24:27], a[156:159], v[136:139]
    ds_read_b64_tr_b16 a[10:11], v7 offset:58368
    v_mul_f32 v77, s68, v77
    v_mfma_f32_16x16x32_bf16 v[152:155], a[28:31], a[156:159], v[152:155]
    ds_read_b64_tr_b16 a[12:13], v8 offset:57344
    v_mul_f32 v78, s68, v78
    v_mfma_f32_16x16x32_bf16 v[144:147], a[28:31], a[152:155], v[144:147]
    ds_read_b64_tr_b16 a[14:15], v8 offset:58368
    v_mul_f32 v79, s68, v79
    v_mul_f32 v92, s68, v92
    s_waitcnt lgkmcnt(4)
    v_mfma_f32_16x16x32_bf16 v[160:163], a[0:3], a[152:155], v[160:163]
    ds_read_b64_tr_b16 a[16:17], v9 offset:57344
    v_mul_f32 v93, s68, v93
    v_mfma_f32_16x16x32_bf16 v[168:171], a[0:3], a[156:159], v[168:171]
    ds_read_b64_tr_b16 a[18:19], v9 offset:58368
    v_mul_f32 v94, s68, v94
    v_mfma_f32_16x16x32_bf16 v[184:187], a[4:7], a[156:159], v[184:187]
    ds_read_b64_tr_b16 a[20:21], v10 offset:57344
    v_mul_f32 v95, s68, v95
    v_cvt_pk_bf16_f32 v76, v76, v77
    v_mfma_f32_16x16x32_bf16 v[176:179], a[4:7], a[152:155], v[176:179]
    ds_read_b64_tr_b16 a[22:23], v10 offset:58368
    v_cvt_pk_bf16_f32 v77, v78, v79
    s_waitcnt lgkmcnt(4)
    v_mfma_f32_16x16x32_bf16 v[192:195], a[8:11], a[152:155], v[192:195]
    ds_read_b64_tr_b16 a[24:25], v11 offset:57344
    v_cvt_pk_bf16_f32 v78, v92, v93
    v_cvt_pk_bf16_f32 v79, v94, v95
    v_mfma_f32_16x16x32_bf16 v[200:203], a[8:11], a[156:159], v[200:203]
    ds_read_b64_tr_b16 a[26:27], v11 offset:58368
    buffer_store_dwordx4 v[76:79], v25, s[4:7], s3 offen offset:1024 sc1
    v_mfma_f32_16x16x32_bf16 v[216:219], a[12:15], a[156:159], v[216:219]
    ds_read_b64_tr_b16 a[28:29], v12 offset:57344
    v_mul_f32 v108, s68, v108
    v_mfma_f32_16x16x32_bf16 v[208:211], a[12:15], a[152:155], v[208:211]
    ds_read_b64_tr_b16 a[30:31], v12 offset:58368
    s_waitcnt vmcnt(17)
    s_barrier
    s_waitcnt lgkmcnt(4)
    v_mfma_f32_16x16x32_bf16 v[224:227], a[16:19], a[152:155], v[224:227]
    ds_read_b64_tr_b16 a[0:1], v13 offset:0
    v_mul_f32 v109, s68, v109
    v_mul_f32 v110, s68, v110
    v_mfma_f32_16x16x32_bf16 v[232:235], a[16:19], a[156:159], v[232:235]
    ds_read_b64_tr_b16 a[2:3], v13 offset:1024
    v_mul_f32 v111, s68, v111
    v_mul_f32 v124, s68, v124
    v_mfma_f32_16x16x32_bf16 v[248:251], a[20:23], a[156:159], v[248:251]
    ds_read_b64_tr_b16 a[4:5], v14 offset:0
    v_mul_f32 v125, s68, v125
    v_mul_f32 v126, s68, v126
    v_mfma_f32_16x16x32_bf16 v[240:243], a[20:23], a[152:155], v[240:243]
    ds_read_b64_tr_b16 a[6:7], v14 offset:1024
    v_mul_f32 v127, s68, v127
    s_waitcnt lgkmcnt(4)
    v_mfma_f32_16x16x32_bf16 a[240:243], a[24:27], a[152:155], a[240:243]
    ds_read_b64_tr_b16 a[8:9], v15 offset:0
    v_cvt_pk_bf16_f32 v108, v108, v109
    v_mfma_f32_16x16x32_bf16 a[244:247], a[24:27], a[156:159], a[244:247]
    ds_read_b64_tr_b16 a[10:11], v15 offset:1024
    v_cvt_pk_bf16_f32 v109, v110, v111
    v_cvt_pk_bf16_f32 v110, v124, v125
    v_mfma_f32_16x16x32_bf16 a[252:255], a[28:31], a[156:159], a[252:255]
    ds_read_b64_tr_b16 a[12:13], v16 offset:0
    v_cvt_pk_bf16_f32 v111, v126, v127
    v_mfma_f32_16x16x32_bf16 a[248:251], a[28:31], a[152:155], a[248:251]
    ds_read_b64_tr_b16 a[14:15], v16 offset:1024
    buffer_store_dwordx4 v[108:111], v25, s[4:7], s3 offen offset:2048 sc1
    s_mov_b32 s98, 0
spin_6:
    s_waitcnt vmcnt(17)
    v_readfirstlane_b32 s99, v31
    s_nop 0
    s_cmp_ge_u32 s99, 256
    s_cbranch_scc1 ok_7
    s_add_u32 s98, s98, 1
    s_cmp_gt_u32 s98, 0x80000
    s_cbranch_scc1 ok_7
    s_sleep 8
    buffer_load_dword v31, off, s[60:63], 0 sc1
    s_waitcnt vmcnt(0)
    s_branch spin_6
ok_7:
    s_cmp_eq_u32 s20, 0
    s_cbranch_scc0 sig_8
    v_mov_b32 v2, 1
    v_mov_b32 v3, 0
    s_mov_b64 exec, 1
    buffer_atomic_add v2, v3, s[4:7], s72 offen sc1
    s_mov_b64 exec, -1
sig_8:
    s_waitcnt lgkmcnt(4)
    v_mfma_f32_16x16x32_bf16 v[32:35], a[0:3], a[160:163], v[32:35]
    ds_read_b64_tr_b16 a[16:17], v21 offset:0
    s_add_u32 m0, s30, 16384
    v_mul_f32 v140, s68, v140
    v_mfma_f32_16x16x32_bf16 v[40:43], a[0:3], a[164:167], v[40:43]
    ds_read_b64_tr_b16 a[18:19], v21 offset:1024
    v_mul_f32 v141, s68, v141
    v_mul_f32 v142, s68, v142
    v_mfma_f32_16x16x32_bf16 v[56:59], a[4:7], a[164:167], v[56:59]
    ds_read_b64_tr_b16 a[20:21], v22 offset:0
    buffer_load_dwordx4 v26, s[16:19], s31 offen offset:0 sc1 lds
    v_mul_f32 v143, s68, v143
    v_mfma_f32_16x16x32_bf16 v[48:51], a[4:7], a[160:163], v[48:51]
    ds_read_b64_tr_b16 a[22:23], v22 offset:1024
    v_mul_f32 v156, s68, v156
    s_waitcnt lgkmcnt(4)
    v_mfma_f32_16x16x32_bf16 v[64:67], a[8:11], a[160:163], v[64:67]
    ds_read_b64_tr_b16 a[24:25], v23 offset:0
    v_mul_f32 v157, s68, v157
    v_mfma_f32_16x16x32_bf16 v[72:75], a[8:11], a[164:167], v[72:75]
    ds_read_b64_tr_b16 a[26:27], v23 offset:1024
    buffer_load_dwordx4 v27, s[16:19], s31 offen offset:1024 sc1 lds
    v_mul_f32 v158, s68, v158
    v_mfma_f32_16x16x32_bf16 v[88:91], a[12:15], a[164:167], v[88:91]
    ds_read_b64_tr_b16 a[28:29], v24 offset:0
    v_mul_f32 v159, s68, v159
    v_cvt_pk_bf16_f32 v140, v140, v141
    v_mfma_f32_16x16x32_bf16 v[80:83], a[12:15], a[160:163], v[80:83]
    ds_read_b64_tr_b16 a[30:31], v24 offset:1024
    v_cvt_pk_bf16_f32 v141, v142, v143
    s_waitcnt lgkmcnt(4)
    v_mfma_f32_16x16x32_bf16 v[96:99], a[16:19], a[160:163], v[96:99]
    ds_read_b64_tr_b16 a[0:1], v13 offset:8192
    buffer_load_dwordx4 v28, s[16:19], s31 offen offset:2048 sc1 lds
    v_cvt_pk_bf16_f32 v142, v156, v157
    v_mfma_f32_16x16x32_bf16 v[104:107], a[16:19], a[164:167], v[104:107]
    ds_read_b64_tr_b16 a[2:3], v13 offset:9216
    v_cvt_pk_bf16_f32 v143, v158, v159
    v_mfma_f32_16x16x32_bf16 v[120:123], a[20:23], a[164:167], v[120:123]
    ds_read_b64_tr_b16 a[4:5], v14 offset:8192
    buffer_store_dwordx4 v[140:143], v25, s[4:7], s3 offen offset:3072 sc1
    v_mfma_f32_16x16x32_bf16 v[112:115], a[20:23], a[160:163], v[112:115]
    ds_read_b64_tr_b16 a[6:7], v14 offset:9216
    v_mul_f32 v172, s68, v172
    s_waitcnt lgkmcnt(4)
    v_mfma_f32_16x16x32_bf16 v[128:131], a[24:27], a[160:163], v[128:131]
    ds_read_b64_tr_b16 a[8:9], v15 offset:8192
    buffer_load_dwordx4 v29, s[16:19], s31 offen offset:3072 sc1 lds
    v_mul_f32 v173, s68, v173
    v_mfma_f32_16x16x32_bf16 v[136:139], a[24:27], a[164:167], v[136:139]
    ds_read_b64_tr_b16 a[10:11], v15 offset:9216
    v_mul_f32 v174, s68, v174
    v_mul_f32 v175, s68, v175
    v_mfma_f32_16x16x32_bf16 v[152:155], a[28:31], a[164:167], v[152:155]
    ds_read_b64_tr_b16 a[12:13], v16 offset:8192
    s_add_u32 s31, s31, 114688
    v_mul_f32 v188, s68, v188
    v_mfma_f32_16x16x32_bf16 v[144:147], a[28:31], a[160:163], v[144:147]
    ds_read_b64_tr_b16 a[14:15], v16 offset:9216
    v_mul_f32 v189, s68, v189
    s_waitcnt lgkmcnt(4)
    v_mfma_f32_16x16x32_bf16 v[160:163], a[0:3], a[160:163], v[160:163]
    ds_read_b64_tr_b16 a[16:17], v21 offset:8192
    v_mul_f32 v190, s68, v190
    v_mfma_f32_16x16x32_bf16 v[168:171], a[0:3], a[164:167], v[168:171]
    ds_read_b64_tr_b16 a[18:19], v21 offset:9216
    s_add_u32 m0, s30, 32768
    v_mul_f32 v191, s68, v191
    v_mfma_f32_16x16x32_bf16 v[184:187], a[4:7], a[164:167], v[184:187]
    ds_read_b64_tr_b16 a[20:21], v22 offset:8192
    v_cvt_pk_bf16_f32 v172, v172, v173
    v_mfma_f32_16x16x32_bf16 v[176:179], a[4:7], a[160:163], v[176:179]
    ds_read_b64_tr_b16 a[22:23], v22 offset:9216
    v_cvt_pk_bf16_f32 v173, v174, v175
    v_cvt_pk_bf16_f32 v174, v188, v189
    s_waitcnt lgkmcnt(4)
    v_mfma_f32_16x16x32_bf16 v[192:195], a[8:11], a[160:163], v[192:195]
    ds_read_b64_tr_b16 a[24:25], v23 offset:8192
    buffer_load_dwordx4 v26, s[16:19], s31 offen offset:0 sc1 lds
    v_cvt_pk_bf16_f32 v175, v190, v191
    v_mfma_f32_16x16x32_bf16 v[200:203], a[8:11], a[164:167], v[200:203]
    ds_read_b64_tr_b16 a[26:27], v23 offset:9216
    s_add_u32 s3, s70, 12288
    v_mfma_f32_16x16x32_bf16 v[216:219], a[12:15], a[164:167], v[216:219]
    ds_read_b64_tr_b16 a[28:29], v24 offset:8192
    buffer_load_dwordx4 v27, s[16:19], s31 offen offset:1024 sc1 lds
    buffer_store_dwordx4 v[172:175], v25, s[4:7], s3 offen offset:0 sc1
    v_mfma_f32_16x16x32_bf16 v[208:211], a[12:15], a[160:163], v[208:211]
    ds_read_b64_tr_b16 a[30:31], v24 offset:9216
    v_mul_f32 v204, s68, v204
    s_waitcnt lgkmcnt(4)
    v_mfma_f32_16x16x32_bf16 v[224:227], a[16:19], a[160:163], v[224:227]
    ds_read_b64_tr_b16 a[0:1], v13 offset:16384
    v_mul_f32 v205, s68, v205
    v_mfma_f32_16x16x32_bf16 v[232:235], a[16:19], a[164:167], v[232:235]
    ds_read_b64_tr_b16 a[2:3], v13 offset:17408
    buffer_load_dwordx4 v28, s[16:19], s31 offen offset:2048 sc1 lds
    v_mul_f32 v206, s68, v206
    v_mfma_f32_16x16x32_bf16 v[248:251], a[20:23], a[164:167], v[248:251]
    ds_read_b64_tr_b16 a[4:5], v14 offset:16384
    v_mul_f32 v207, s68, v207
    v_mul_f32 v220, s68, v220
    v_mfma_f32_16x16x32_bf16 v[240:243], a[20:23], a[160:163], v[240:243]
    ds_read_b64_tr_b16 a[6:7], v14 offset:17408
    v_mul_f32 v221, s68, v221
    s_waitcnt lgkmcnt(4)
    v_mfma_f32_16x16x32_bf16 a[240:243], a[24:27], a[160:163], a[240:243]
    ds_read_b64_tr_b16 a[8:9], v15 offset:16384
    buffer_load_dwordx4 v29, s[16:19], s31 offen offset:3072 sc1 lds
    v_mul_f32 v222, s68, v222
    v_mfma_f32_16x16x32_bf16 a[244:247], a[24:27], a[164:167], a[244:247]
    ds_read_b64_tr_b16 a[10:11], v15 offset:17408
    v_mul_f32 v223, s68, v223
    v_mfma_f32_16x16x32_bf16 a[252:255], a[28:31], a[164:167], a[252:255]
    ds_read_b64_tr_b16 a[12:13], v16 offset:16384
    v_cvt_pk_bf16_f32 v204, v204, v205
    v_mfma_f32_16x16x32_bf16 a[248:251], a[28:31], a[160:163], a[248:251]
    ds_read_b64_tr_b16 a[14:15], v16 offset:17408
    v_cvt_pk_bf16_f32 v205, v206, v207
    s_waitcnt lgkmcnt(4)
    v_mfma_f32_16x16x32_bf16 v[32:35], a[0:3], a[168:171], v[32:35]
    ds_read_b64_tr_b16 a[16:17], v21 offset:16384
    s_add_u32 s31, s31, 114688
    v_cvt_pk_bf16_f32 v206, v220, v221
    v_mfma_f32_16x16x32_bf16 v[40:43], a[0:3], a[172:175], v[40:43]
    ds_read_b64_tr_b16 a[18:19], v21 offset:17408
    v_cvt_pk_bf16_f32 v207, v222, v223
    buffer_store_dwordx4 v[204:207], v25, s[4:7], s3 offen offset:1024 sc1
    v_mfma_f32_16x16x32_bf16 v[56:59], a[4:7], a[172:175], v[56:59]
    ds_read_b64_tr_b16 a[20:21], v22 offset:16384
    v_mul_f32 v236, s68, v236
    v_mfma_f32_16x16x32_bf16 v[48:51], a[4:7], a[168:171], v[48:51]
    ds_read_b64_tr_b16 a[22:23], v22 offset:17408
    v_mul_f32 v237, s68, v237
    s_waitcnt lgkmcnt(4)
    v_mfma_f32_16x16x32_bf16 v[64:67], a[8:11], a[168:171], v[64:67]
    ds_read_b64_tr_b16 a[24:25], v23 offset:16384
    v_mul_f32 v238, s68, v238
    v_mfma_f32_16x16x32_bf16 v[72:75], a[8:11], a[172:175], v[72:75]
    ds_read_b64_tr_b16 a[26:27], v23 offset:17408
    v_mul_f32 v239, s68, v239
    v_mfma_f32_16x16x32_bf16 v[88:91], a[12:15], a[172:175], v[88:91]
    ds_read_b64_tr_b16 a[28:29], v24 offset:16384
    v_mul_f32 v252, s68, v252
    v_mul_f32 v253, s68, v253
    v_mfma_f32_16x16x32_bf16 v[80:83], a[12:15], a[168:171], v[80:83]
    ds_read_b64_tr_b16 a[30:31], v24 offset:17408
    v_mul_f32 v254, s68, v254
    s_waitcnt lgkmcnt(4)
    v_mfma_f32_16x16x32_bf16 v[96:99], a[16:19], a[168:171], v[96:99]
    ds_read_b64_tr_b16 a[0:1], v13 offset:24576
    v_mul_f32 v255, s68, v255
    v_mfma_f32_16x16x32_bf16 v[104:107], a[16:19], a[172:175], v[104:107]
    ds_read_b64_tr_b16 a[2:3], v13 offset:25600
    v_cvt_pk_bf16_f32 v236, v236, v237
    v_mfma_f32_16x16x32_bf16 v[120:123], a[20:23], a[172:175], v[120:123]
    ds_read_b64_tr_b16 a[4:5], v14 offset:24576
    v_cvt_pk_bf16_f32 v237, v238, v239
    v_mfma_f32_16x16x32_bf16 v[112:115], a[20:23], a[168:171], v[112:115]
    ds_read_b64_tr_b16 a[6:7], v14 offset:25600
    v_cvt_pk_bf16_f32 v238, v252, v253
    s_waitcnt lgkmcnt(4)
    v_mfma_f32_16x16x32_bf16 v[128:131], a[24:27], a[168:171], v[128:131]
    ds_read_b64_tr_b16 a[8:9], v15 offset:24576
    v_cvt_pk_bf16_f32 v239, v254, v255
    buffer_store_dwordx4 v[236:239], v25, s[4:7], s3 offen offset:2048 sc1
    v_mfma_f32_16x16x32_bf16 v[136:139], a[24:27], a[172:175], v[136:139]
    ds_read_b64_tr_b16 a[10:11], v15 offset:25600
    v_accvgpr_read_b32 v60, a228
    v_mfma_f32_16x16x32_bf16 v[152:155], a[28:31], a[172:175], v[152:155]
    ds_read_b64_tr_b16 a[12:13], v16 offset:24576
    v_accvgpr_read_b32 v61, a229
    v_mfma_f32_16x16x32_bf16 v[144:147], a[28:31], a[168:171], v[144:147]
    ds_read_b64_tr_b16 a[14:15], v16 offset:25600
    v_accvgpr_read_b32 v62, a230
    s_waitcnt lgkmcnt(4)
    v_mfma_f32_16x16x32_bf16 v[160:163], a[0:3], a[168:171], v[160:163]
    ds_read_b64_tr_b16 a[16:17], v21 offset:24576
    v_accvgpr_read_b32 v63, a231
    v_mfma_f32_16x16x32_bf16 v[168:171], a[0:3], a[172:175], v[168:171]
    ds_read_b64_tr_b16 a[18:19], v21 offset:25600
    v_mul_f32 v60, s68, v60
    v_mfma_f32_16x16x32_bf16 v[184:187], a[4:7], a[172:175], v[184:187]
    ds_read_b64_tr_b16 a[20:21], v22 offset:24576
    v_mul_f32 v61, s68, v61
    v_mfma_f32_16x16x32_bf16 v[176:179], a[4:7], a[168:171], v[176:179]
    ds_read_b64_tr_b16 a[22:23], v22 offset:25600
    v_mul_f32 v62, s68, v62
    v_mul_f32 v63, s68, v63
    s_waitcnt lgkmcnt(4)
    v_mfma_f32_16x16x32_bf16 v[192:195], a[8:11], a[168:171], v[192:195]
    ds_read_b64_tr_b16 a[24:25], v23 offset:24576
    v_accvgpr_read_b32 v92, a236
    v_mfma_f32_16x16x32_bf16 v[200:203], a[8:11], a[172:175], v[200:203]
    ds_read_b64_tr_b16 a[26:27], v23 offset:25600
    v_accvgpr_read_b32 v93, a237
    v_mfma_f32_16x16x32_bf16 v[216:219], a[12:15], a[172:175], v[216:219]
    ds_read_b64_tr_b16 a[28:29], v24 offset:24576
    v_accvgpr_read_b32 v94, a238
    s_lshl_b32 s28, s20, 12
    v_add_u32 v30, s28, v25
    s_add_u32 s28, s28, 98304
    s_sub_u32 s97, 15, s22
    s_max_u32 s97, s97, s22
    s_lshl_b32 s97, s97, 2
    s_sub_u32 s8, s97, 30
    s_cmp_lt_i32 s8, 4
    s_cselect_b32 s8, 0, s8
    v_mfma_f32_16x16x32_bf16 v[208:211], a[12:15], a[168:171], v[208:211]
    ds_read_b64_tr_b16 a[30:31], v24 offset:25600
    s_waitcnt vmcnt(16)
    s_barrier
    s_waitcnt lgkmcnt(4)
    v_mfma_f32_16x16x32_bf16 v[224:227], a[16:19], a[168:171], v[224:227]
    ds_read_b64_tr_b16 a[0:1], v13 offset:32768
    v_accvgpr_read_b32 v95, a239
    v_mul_f32 v92, s68, v92
    v_mfma_f32_16x16x32_bf16 v[232:235], a[16:19], a[172:175], v[232:235]
    ds_read_b64_tr_b16 a[2:3], v13 offset:33792
    v_mul_f32 v93, s68, v93
    v_mul_f32 v94, s68, v94
    v_mfma_f32_16x16x32_bf16 v[248:251], a[20:23], a[172:175], v[248:251]
    ds_read_b64_tr_b16 a[4:5], v14 offset:32768
    v_mul_f32 v95, s68, v95
    v_mfma_f32_16x16x32_bf16 v[240:243], a[20:23], a[168:171], v[240:243]
    ds_read_b64_tr_b16 a[6:7], v14 offset:33792
    v_cvt_pk_bf16_f32 v60, v60, v61
    s_waitcnt lgkmcnt(4)
    v_mfma_f32_16x16x32_bf16 a[240:243], a[24:27], a[168:171], a[240:243]
    ds_read_b64_tr_b16 a[8:9], v15 offset:32768
    v_cvt_pk_bf16_f32 v61, v62, v63
    v_mfma_f32_16x16x32_bf16 a[244:247], a[24:27], a[172:175], a[244:247]
    ds_read_b64_tr_b16 a[10:11], v15 offset:33792
    v_cvt_pk_bf16_f32 v62, v92, v93
    v_mfma_f32_16x16x32_bf16 a[252:255], a[28:31], a[172:175], a[252:255]
    ds_read_b64_tr_b16 a[12:13], v16 offset:32768
    v_cvt_pk_bf16_f32 v63, v94, v95
    v_mfma_f32_16x16x32_bf16 a[248:251], a[28:31], a[168:171], a[248:251]
    ds_read_b64_tr_b16 a[14:15], v16 offset:33792
    buffer_store_dwordx4 v[60:63], v25, s[4:7], s3 offen offset:3072 sc1
    s_waitcnt lgkmcnt(4)
    v_mfma_f32_16x16x32_bf16 v[32:35], a[0:3], a[176:179], v[32:35]
    ds_read_b64_tr_b16 a[16:17], v21 offset:32768
    s_add_u32 m0, s30, 49152
    v_mfma_f32_16x16x32_bf16 v[40:43], a[0:3], a[180:183], v[40:43]
    ds_read_b64_tr_b16 a[18:19], v21 offset:33792
    v_accvgpr_write_b32 a32, v36
    v_mfma_f32_16x16x32_bf16 v[56:59], a[4:7], a[180:183], v[56:59]
    ds_read_b64_tr_b16 a[20:21], v22 offset:32768
    buffer_load_dwordx4 v26, s[16:19], s31 offen offset:0 sc1 lds
    v_mfma_f32_16x16x32_bf16 v[48:51], a[4:7], a[176:179], v[48:51]
    ds_read_b64_tr_b16 a[22:23], v22 offset:33792
    s_waitcnt lgkmcnt(4)
    v_mfma_f32_16x16x32_bf16 v[64:67], a[8:11], a[176:179], v[64:67]
    ds_read_b64_tr_b16 a[24:25], v23 offset:32768
    v_accvgpr_write_b32 a33, v37
    v_mfma_f32_16x16x32_bf16 v[72:75], a[8:11], a[180:183], v[72:75]
    ds_read_b64_tr_b16 a[26:27], v23 offset:33792
    buffer_load_dwordx4 v27, s[16:19], s31 offen offset:1024 sc1 lds
    v_mfma_f32_16x16x32_bf16 v[88:91], a[12:15], a[180:183], v[88:91]
    ds_read_b64_tr_b16 a[28:29], v24 offset:32768
    v_accvgpr_write_b32 a34, v38
    v_mfma_f32_16x16x32_bf16 v[80:83], a[12:15], a[176:179], v[80:83]
    ds_read_b64_tr_b16 a[30:31], v24 offset:33792
    s_waitcnt lgkmcnt(4)
    v_mfma_f32_16x16x32_bf16 v[96:99], a[16:19], a[176:179], v[96:99]
    ds_read_b64_tr_b16 a[0:1], v13 offset:40960
    buffer_load_dwordx4 v28, s[16:19], s31 offen offset:2048 sc1 lds
    v_mfma_f32_16x16x32_bf16 v[104:107], a[16:19], a[180:183], v[104:107]
    ds_read_b64_tr_b16 a[2:3], v13 offset:41984
    v_accvgpr_write_b32 a35, v39
    v_mfma_f32_16x16x32_bf16 v[120:123], a[20:23], a[180:183], v[120:123]
    ds_read_b64_tr_b16 a[4:5], v14 offset:40960
    v_and_b32 v2, 15, v1
    v_mfma_f32_16x16x32_bf16 v[112:115], a[20:23], a[176:179], v[112:115]
    ds_read_b64_tr_b16 a[6:7], v14 offset:41984
    s_waitcnt lgkmcnt(4)
    v_mfma_f32_16x16x32_bf16 v[128:131], a[24:27], a[176:179], v[128:131]
    ds_read_b64_tr_b16 a[8:9], v15 offset:40960
    buffer_load_dwordx4 v29, s[16:19], s31 offen offset:3072 sc1 lds
    v_mfma_f32_16x16x32_bf16 v[136:139], a[24:27], a[180:183], v[136:139]
    ds_read_b64_tr_b16 a[10:11], v15 offset:41984
    v_accvgpr_write_b32 a36, v68
    v_mfma_f32_16x16x32_bf16 v[152:155], a[28:31], a[180:183], v[152:155]
    ds_read_b64_tr_b16 a[12:13], v16 offset:40960
    s_add_u32 s31, s31, 114688
    v_mfma_f32_16x16x32_bf16 v[144:147], a[28:31], a[176:179], v[144:147]
    ds_read_b64_tr_b16 a[14:15], v16 offset:41984
    s_waitcnt lgkmcnt(4)
    v_mfma_f32_16x16x32_bf16 v[160:163], a[0:3], a[176:179], v[160:163]
    ds_read_b64_tr_b16 a[16:17], v21 offset:40960
    v_accvgpr_write_b32 a37, v69
    v_mfma_f32_16x16x32_bf16 v[168:171], a[0:3], a[180:183], v[168:171]
    ds_read_b64_tr_b16 a[18:19], v21 offset:41984
    s_add_u32 m0, s30, 65536
    v_mfma_f32_16x16x32_bf16 v[184:187], a[4:7], a[180:183], v[184:187]
    ds_read_b64_tr_b16 a[20:21], v22 offset:40960
    v_accvgpr_write_b32 a38, v70
    v_mfma_f32_16x16x32_bf16 v[176:179], a[4:7], a[176:179], v[176:179]
    ds_read_b64_tr_b16 a[22:23], v22 offset:41984
    s_waitcnt lgkmcnt(4)
    v_mfma_f32_16x16x32_bf16 v[192:195], a[8:11], a[176:179], v[192:195]
    ds_read_b64_tr_b16 a[24:25], v23 offset:40960
    buffer_load_dwordx4 v26, s[16:19], s31 offen offset:0 sc1 lds
    v_mfma_f32_16x16x32_bf16 v[200:203], a[8:11], a[180:183], v[200:203]
    ds_read_b64_tr_b16 a[26:27], v23 offset:41984
    v_accvgpr_write_b32 a39, v71
    v_mfma_f32_16x16x32_bf16 v[216:219], a[12:15], a[180:183], v[216:219]
    ds_read_b64_tr_b16 a[28:29], v24 offset:40960
    buffer_load_dwordx4 v27, s[16:19], s31 offen offset:1024 sc1 lds
    v_mfma_f32_16x16x32_bf16 v[208:211], a[12:15], a[176:179], v[208:211]
    ds_read_b64_tr_b16 a[30:31], v24 offset:41984
    s_waitcnt lgkmcnt(4)
    v_mfma_f32_16x16x32_bf16 v[224:227], a[16:19], a[176:179], v[224:227]
    ds_read_b64_tr_b16 a[0:1], v5 offset:0
    v_accvgpr_write_b32 a40, v100
    v_mfma_f32_16x16x32_bf16 v[232:235], a[16:19], a[180:183], v[232:235]
    ds_read_b64_tr_b16 a[2:3], v5 offset:1024
    buffer_load_dwordx4 v28, s[16:19], s31 offen offset:2048 sc1 lds
    v_mfma_f32_16x16x32_bf16 v[248:251], a[20:23], a[180:183], v[248:251]
    ds_read_b64_tr_b16 a[4:5], v6 offset:0
    v_accvgpr_write_b32 a41, v101
    v_mfma_f32_16x16x32_bf16 v[240:243], a[20:23], a[176:179], v[240:243]
    ds_read_b64_tr_b16 a[6:7], v6 offset:1024
    s_waitcnt lgkmcnt(4)
    v_mfma_f32_16x16x32_bf16 a[240:243], a[24:27], a[176:179], a[240:243]
    ds_read_b64_tr_b16 a[8:9], v7 offset:0
    buffer_load_dwordx4 v29, s[16:19], s31 offen offset:3072 sc1 lds
    v_mfma_f32_16x16x32_bf16 a[244:247], a[24:27], a[180:183], a[244:247]
    ds_read_b64_tr_b16 a[10:11], v7 offset:1024
    v_accvgpr_write_b32 a42, v102
    v_mfma_f32_16x16x32_bf16 a[252:255], a[28:31], a[180:183], a[252:255]
    ds_read_b64_tr_b16 a[12:13], v8 offset:0
    v_lshlrev_b32 v2, 2, v2
    v_mfma_f32_16x16x32_bf16 a[248:251], a[28:31], a[176:179], a[248:251]
    ds_read_b64_tr_b16 a[14:15], v8 offset:1024
    s_waitcnt lgkmcnt(4)
    v_mfma_f32_16x16x32_bf16 v[32:35], a[0:3], a[184:187], v[32:35]
    ds_read_b64_tr_b16 a[16:17], v9 offset:0
    s_add_u32 s31, s31, 114688
    v_mfma_f32_16x16x32_bf16 v[40:43], a[0:3], a[188:191], v[40:43]
    ds_read_b64_tr_b16 a[18:19], v9 offset:1024
    v_accvgpr_write_b32 a43, v103
    v_mfma_f32_16x16x32_bf16 v[56:59], a[4:7], a[188:191], v[56:59]
    ds_read_b64_tr_b16 a[20:21], v10 offset:0
    v_accvgpr_write_b32 a44, v132
    v_mfma_f32_16x16x32_bf16 v[48:51], a[4:7], a[184:187], v[48:51]
    ds_read_b64_tr_b16 a[22:23], v10 offset:1024
    s_waitcnt lgkmcnt(4)
    v_mfma_f32_16x16x32_bf16 v[64:67], a[8:11], a[184:187], v[64:67]
    ds_read_b64_tr_b16 a[24:25], v11 offset:0
    s_lshl_b32 s97, s22, 2
    v_mfma_f32_16x16x32_bf16 v[72:75], a[8:11], a[188:191], v[72:75]
    ds_read_b64_tr_b16 a[26:27], v11 offset:1024
    v_accvgpr_write_b32 a45, v133
    v_mfma_f32_16x16x32_bf16 v[88:91], a[12:15], a[188:191], v[88:91]
    ds_read_b64_tr_b16 a[28:29], v12 offset:0
    s_add_u32 s97, s97, s20
    v_mfma_f32_16x16x32_bf16 v[80:83], a[12:15], a[184:187], v[80:83]
    ds_read_b64_tr_b16 a[30:31], v12 offset:1024
    s_waitcnt lgkmcnt(4)
    v_mfma_f32_16x16x32_bf16 v[96:99], a[16:19], a[184:187], v[96:99]
    ds_read_b64_tr_b16 a[0:1], v5 offset:8192
    v_accvgpr_write_b32 a46, v134
    v_mfma_f32_16x16x32_bf16 v[104:107], a[16:19], a[188:191], v[104:107]
    ds_read_b64_tr_b16 a[2:3], v5 offset:9216
    s_lshl_b32 s97, s97, 7
    v_mfma_f32_16x16x32_bf16 v[120:123], a[20:23], a[188:191], v[120:123]
    ds_read_b64_tr_b16 a[4:5], v6 offset:8192
    s_add_u32 s97, s97, 75497472
    v_mfma_f32_16x16x32_bf16 v[112:115], a[20:23], a[184:187], v[112:115]
    ds_read_b64_tr_b16 a[6:7], v6 offset:9216
    s_waitcnt lgkmcnt(4)
    v_mfma_f32_16x16x32_bf16 v[128:131], a[24:27], a[184:187], v[128:131]
    ds_read_b64_tr_b16 a[8:9], v7 offset:8192
    v_accvgpr_write_b32 a47, v135
    v_mfma_f32_16x16x32_bf16 v[136:139], a[24:27], a[188:191], v[136:139]
    ds_read_b64_tr_b16 a[10:11], v7 offset:9216
    buffer_load_dword a228, v2, s[4:7], s97 offen offset:0 sc1
    v_mfma_f32_16x16x32_bf16 v[152:155], a[28:31], a[188:191], v[152:155]
    ds_read_b64_tr_b16 a[12:13], v8 offset:8192
    v_accvgpr_write_b32 a48, v164
    v_mfma_f32_16x16x32_bf16 v[144:147], a[28:31], a[184:187], v[144:147]
    ds_read_b64_tr_b16 a[14:15], v8 offset:9216
    s_waitcnt lgkmcnt(4)
    v_mfma_f32_16x16x32_bf16 v[160:163], a[0:3], a[184:187], v[160:163]
    ds_read_b64_tr_b16 a[16:17], v9 offset:8192
    buffer_load_dword a229, v2, s[4:7], s97 offen offset:64 sc1
    v_mfma_f32_16x16x32_bf16 v[168:171], a[0:3], a[188:191], v[168:171]
    ds_read_b64_tr_b16 a[18:19], v9 offset:9216
    v_accvgpr_write_b32 a49, v165
    v_mfma_f32_16x16x32_bf16 v[184:187], a[4:7], a[188:191], v[184:187]
    ds_read_b64_tr_b16 a[20:21], v10 offset:8192
    v_mfma_f32_16x16x32_bf16 v[176:179], a[4:7], a[184:187], v[176:179]
    ds_read_b64_tr_b16 a[22:23], v10 offset:9216
    s_waitcnt lgkmcnt(4)
    v_mfma_f32_16x16x32_bf16 v[192:195], a[8:11], a[184:187], v[192:195]
    ds_read_b64_tr_b16 a[24:25], v11 offset:8192
    v_accvgpr_write_b32 a50, v166
    v_mfma_f32_16x16x32_bf16 v[200:203], a[8:11], a[188:191], v[200:203]
    ds_read_b64_tr_b16 a[26:27], v11 offset:9216
    v_mfma_f32_16x16x32_bf16 v[216:219], a[12:15], a[188:191], v[216:219]
    ds_read_b64_tr_b16 a[28:29], v12 offset:8192
    v_mfma_f32_16x16x32_bf16 v[208:211], a[12:15], a[184:187], v[208:211]
    ds_read_b64_tr_b16 a[30:31], v12 offset:9216
    s_waitcnt vmcnt(10)
    s_barrier
    s_waitcnt lgkmcnt(4)
    v_mfma_f32_16x16x32_bf16 v[224:227], a[16:19], a[184:187], v[224:227]
    ds_read_b64_tr_b16 a[0:1], v5 offset:16384
    v_accvgpr_write_b32 a51, v167
    v_mfma_f32_16x16x32_bf16 v[232:235], a[16:19], a[188:191], v[232:235]
    ds_read_b64_tr_b16 a[2:3], v5 offset:17408
    v_mfma_f32_16x16x32_bf16 v[248:251], a[20:23], a[188:191], v[248:251]
    ds_read_b64_tr_b16 a[4:5], v6 offset:16384
    v_accvgpr_write_b32 a52, v196
    v_mfma_f32_16x16x32_bf16 v[240:243], a[20:23], a[184:187], v[240:243]
    ds_read_b64_tr_b16 a[6:7], v6 offset:17408
    s_waitcnt lgkmcnt(4)
    v_mfma_f32_16x16x32_bf16 a[240:243], a[24:27], a[184:187], a[240:243]
    ds_read_b64_tr_b16 a[8:9], v7 offset:16384
    v_mfma_f32_16x16x32_bf16 a[244:247], a[24:27], a[188:191], a[244:247]
    ds_read_b64_tr_b16 a[10:11], v7 offset:17408
    v_accvgpr_write_b32 a53, v197
    v_mfma_f32_16x16x32_bf16 a[252:255], a[28:31], a[188:191], a[252:255]
    ds_read_b64_tr_b16 a[12:13], v8 offset:16384
    v_mfma_f32_16x16x32_bf16 a[248:251], a[28:31], a[184:187], a[248:251]
    ds_read_b64_tr_b16 a[14:15], v8 offset:17408
    s_cmp_eq_u32 s20, 0
    s_cbranch_scc0 sig_9
    s_cmp_ge_u32 s22, 8
    s_cbranch_scc0 sig_9
    v_mov_b32 v2, 1
    v_mov_b32 v3, 0
    s_mov_b64 exec, 1
    buffer_atomic_add v2, v3, s[4:7], s73 offen sc1
    s_mov_b64 exec, -1
sig_9:
    s_waitcnt lgkmcnt(4)
    v_mfma_f32_16x16x32_bf16 v[32:35], a[0:3], a[192:195], v[32:35]
    ds_read_b64_tr_b16 a[16:17], v9 offset:16384
    s_add_u32 m0, s30, 81920
    v_mfma_f32_16x16x32_bf16 v[40:43], a[0:3], a[196:199], v[40:43]
    ds_read_b64_tr_b16 a[18:19], v9 offset:17408
    v_accvgpr_write_b32 a54, v198
    v_mfma_f32_16x16x32_bf16 v[56:59], a[4:7], a[196:199], v[56:59]
    ds_read_b64_tr_b16 a[20:21], v10 offset:16384
    buffer_load_dwordx4 v26, s[16:19], s31 offen offset:0 sc1 lds
    v_mfma_f32_16x16x32_bf16 v[48:51], a[4:7], a[192:195], v[48:51]
    ds_read_b64_tr_b16 a[22:23], v10 offset:17408
    s_waitcnt lgkmcnt(4)
    v_mfma_f32_16x16x32_bf16 v[64:67], a[8:11], a[192:195], v[64:67]
    ds_read_b64_tr_b16 a[24:25], v11 offset:16384
    v_accvgpr_write_b32 a55, v199
    v_mfma_f32_16x16x32_bf16 v[72:75], a[8:11], a[196:199], v[72:75]
    ds_read_b64_tr_b16 a[26:27], v11 offset:17408
    buffer_load_dwordx4 v27, s[16:19], s31 offen offset:1024 sc1 lds
    v_mfma_f32_16x16x32_bf16 v[88:91], a[12:15], a[196:199], v[88:91]
    ds_read_b64_tr_b16 a[28:29], v12 offset:16384
    v_accvgpr_write_b32 a56, v228
    v_mfma_f32_16x16x32_bf16 v[80:83], a[12:15], a[192:195], v[80:83]
    ds_read_b64_tr_b16 a[30:31], v12 offset:17408
    s_waitcnt lgkmcnt(4)
    v_mfma_f32_16x16x32_bf16 v[96:99], a[16:19], a[192:195], v[96:99]
    ds_read_b64_tr_b16 a[0:1], v5 offset:24576
    buffer_load_dwordx4 v28, s[16:19], s31 offen offset:2048 sc1 lds
    v_mfma_f32_16x16x32_bf16 v[104:107], a[16:19], a[196:199], v[104:107]
    ds_read_b64_tr_b16 a[2:3], v5 offset:25600
    v_accvgpr_write_b32 a57, v229
    v_mfma_f32_16x16x32_bf16 v[120:123], a[20:23], a[196:199], v[120:123]
    ds_read_b64_tr_b16 a[4:5], v6 offset:24576
    s_getpc_b64 s[96:97]
pc_10:
    s_add_u32 s96, s96, qf_done-pc_10
    s_addc_u32 s97, s97, 0
    v_mfma_f32_16x16x32_bf16 v[112:115], a[20:23], a[192:195], v[112:115]
    ds_read_b64_tr_b16 a[6:7], v6 offset:25600
    s_waitcnt lgkmcnt(4)
    v_mfma_f32_16x16x32_bf16 v[128:131], a[24:27], a[192:195], v[128:131]
    ds_read_b64_tr_b16 a[8:9], v7 offset:24576
    buffer_load_dwordx4 v29, s[16:19], s31 offen offset:3072 sc1 lds
    v_mfma_f32_16x16x32_bf16 v[136:139], a[24:27], a[196:199], v[136:139]
    ds_read_b64_tr_b16 a[10:11], v7 offset:25600
    v_accvgpr_write_b32 a58, v230
    v_mfma_f32_16x16x32_bf16 v[152:155], a[28:31], a[196:199], v[152:155]
    ds_read_b64_tr_b16 a[12:13], v8 offset:24576
    s_add_u32 s31, s31, 114688
    v_mfma_f32_16x16x32_bf16 v[144:147], a[28:31], a[192:195], v[144:147]
    ds_read_b64_tr_b16 a[14:15], v8 offset:25600
    s_waitcnt lgkmcnt(4)
    v_mfma_f32_16x16x32_bf16 v[160:163], a[0:3], a[192:195], v[160:163]
    ds_read_b64_tr_b16 a[16:17], v9 offset:24576
    v_accvgpr_write_b32 a59, v231
    v_mfma_f32_16x16x32_bf16 v[168:171], a[0:3], a[196:199], v[168:171]
    ds_read_b64_tr_b16 a[18:19], v9 offset:25600
    s_add_u32 m0, s30, 98304
    v_mfma_f32_16x16x32_bf16 v[184:187], a[4:7], a[196:199], v[184:187]
    ds_read_b64_tr_b16 a[20:21], v10 offset:24576
    v_accvgpr_write_b32 a60, v52
    v_mfma_f32_16x16x32_bf16 v[176:179], a[4:7], a[192:195], v[176:179]
    ds_read_b64_tr_b16 a[22:23], v10 offset:25600
    s_waitcnt lgkmcnt(4)
    v_mfma_f32_16x16x32_bf16 v[192:195], a[8:11], a[192:195], v[192:195]
    ds_read_b64_tr_b16 a[24:25], v11 offset:24576
    buffer_load_dwordx4 v26, s[16:19], s31 offen offset:0 sc1 lds
    v_mfma_f32_16x16x32_bf16 v[200:203], a[8:11], a[196:199], v[200:203]
    ds_read_b64_tr_b16 a[26:27], v11 offset:25600
    v_accvgpr_write_b32 a61, v53
    v_mfma_f32_16x16x32_bf16 v[216:219], a[12:15], a[196:199], v[216:219]
    ds_read_b64_tr_b16 a[28:29], v12 offset:24576
    buffer_load_dwordx4 v27, s[16:19], s31 offen offset:1024 sc1 lds
    v_mfma_f32_16x16x32_bf16 v[208:211], a[12:15], a[192:195], v[208:211]
    ds_read_b64_tr_b16 a[30:31], v12 offset:25600
    s_waitcnt lgkmcnt(4)
    v_mfma_f32_16x16x32_bf16 v[224:227], a[16:19], a[192:195], v[224:227]
    ds_read_b64_tr_b16 a[0:1], v5 offset:32768
    v_accvgpr_write_b32 a62, v54
    v_mfma_f32_16x16x32_bf16 v[232:235], a[16:19], a[196:199], v[232:235]
    ds_read_b64_tr_b16 a[2:3], v5 offset:33792
    buffer_load_dwordx4 v28, s[16:19], s31 offen offset:2048 sc1 lds
    v_mfma_f32_16x16x32_bf16 v[248:251], a[20:23], a[196:199], v[248:251]
    ds_read_b64_tr_b16 a[4:5], v6 offset:32768
    v_accvgpr_write_b32 a63, v55
    v_mfma_f32_16x16x32_bf16 v[240:243], a[20:23], a[192:195], v[240:243]
    ds_read_b64_tr_b16 a[6:7], v6 offset:33792
    s_waitcnt lgkmcnt(4)
    v_mfma_f32_16x16x32_bf16 a[240:243], a[24:27], a[192:195], a[240:243]
    ds_read_b64_tr_b16 a[8:9], v7 offset:32768
    buffer_load_dwordx4 v29, s[16:19], s31 offen offset:3072 sc1 lds
    v_mfma_f32_16x16x32_bf16 a[244:247], a[24:27], a[196:199], a[244:247]
    ds_read_b64_tr_b16 a[10:11], v7 offset:33792
    v_accvgpr_write_b32 a80, v44
    v_mfma_f32_16x16x32_bf16 a[252:255], a[28:31], a[196:199], a[252:255]
    ds_read_b64_tr_b16 a[12:13], v8 offset:32768
    s_lshr_b32 s98, s2, 3
    v_mfma_f32_16x16x32_bf16 a[248:251], a[28:31], a[192:195], a[248:251]
    ds_read_b64_tr_b16 a[14:15], v8 offset:33792
    s_waitcnt lgkmcnt(4)
    v_mfma_f32_16x16x32_bf16 v[32:35], a[0:3], a[200:203], v[32:35]
    ds_read_b64_tr_b16 a[16:17], v9 offset:32768
    s_add_u32 s31, s31, 114688
    v_mfma_f32_16x16x32_bf16 v[40:43], a[0:3], a[204:207], v[40:43]
    ds_read_b64_tr_b16 a[18:19], v9 offset:33792
    v_accvgpr_write_b32 a81, v45
    v_mfma_f32_16x16x32_bf16 v[56:59], a[4:7], a[204:207], v[56:59]
    ds_read_b64_tr_b16 a[20:21], v10 offset:32768
    v_accvgpr_write_b32 a82, v46
    v_mfma_f32_16x16x32_bf16 v[48:51], a[4:7], a[200:203], v[48:51]
    ds_read_b64_tr_b16 a[22:23], v10 offset:33792
    s_waitcnt lgkmcnt(4)
    v_mfma_f32_16x16x32_bf16 v[64:67], a[8:11], a[200:203], v[64:67]
    ds_read_b64_tr_b16 a[24:25], v11 offset:32768
    s_lshl_b32 s98, s98, 8
    v_mfma_f32_16x16x32_bf16 v[72:75], a[8:11], a[204:207], v[72:75]
    ds_read_b64_tr_b16 a[26:27], v11 offset:33792
    v_accvgpr_write_b32 a83, v47
    v_mfma_f32_16x16x32_bf16 v[88:91], a[12:15], a[204:207], v[88:91]
    ds_read_b64_tr_b16 a[28:29], v12 offset:32768
    v_add_u32 v2, s98, v0
    v_mfma_f32_16x16x32_bf16 v[80:83], a[12:15], a[200:203], v[80:83]
    ds_read_b64_tr_b16 a[30:31], v12 offset:33792
    s_waitcnt lgkmcnt(4)
    v_mfma_f32_16x16x32_bf16 v[96:99], a[16:19], a[200:203], v[96:99]
    ds_read_b64_tr_b16 a[0:1], v5 offset:40960
    v_accvgpr_write_b32 a84, v76
    v_mfma_f32_16x16x32_bf16 v[104:107], a[16:19], a[204:207], v[104:107]
    ds_read_b64_tr_b16 a[2:3], v5 offset:41984
    v_and_b32 v2, 0x1ff, v2
    v_mfma_f32_16x16x32_bf16 v[120:123], a[20:23], a[204:207], v[120:123]
    ds_read_b64_tr_b16 a[4:5], v6 offset:40960
    v_lshlrev_b32 v2, 7, v2
    v_mfma_f32_16x16x32_bf16 v[112:115], a[20:23], a[200:203], v[112:115]
    ds_read_b64_tr_b16 a[6:7], v6 offset:41984
    s_waitcnt lgkmcnt(4)
    v_mfma_f32_16x16x32_bf16 v[128:131], a[24:27], a[200:203], v[128:131]
    ds_read_b64_tr_b16 a[8:9], v7 offset:40960
    v_accvgpr_write_b32 a85, v77
    v_mfma_f32_16x16x32_bf16 v[136:139], a[24:27], a[204:207], v[136:139]
    ds_read_b64_tr_b16 a[10:11], v7 offset:41984
    v_min_u32 v2, kernel_last-qf_done-4, v2
    v_mfma_f32_16x16x32_bf16 v[152:155], a[28:31], a[204:207], v[152:155]
    ds_read_b64_tr_b16 a[12:13], v8 offset:40960
    v_accvgpr_write_b32 a86, v78
    v_mfma_f32_16x16x32_bf16 v[144:147], a[28:31], a[200:203], v[144:147]
    ds_read_b64_tr_b16 a[14:15], v8 offset:41984
    s_waitcnt lgkmcnt(4)
    v_mfma_f32_16x16x32_bf16 v[160:163], a[0:3], a[200:203], v[160:163]
    ds_read_b64_tr_b16 a[16:17], v9 offset:40960
    v_mov_b32 v3, s97
    v_mfma_f32_16x16x32_bf16 v[168:171], a[0:3], a[204:207], v[168:171]
    ds_read_b64_tr_b16 a[18:19], v9 offset:41984
    v_accvgpr_write_b32 a87, v79
    v_mfma_f32_16x16x32_bf16 v[184:187], a[4:7], a[204:207], v[184:187]
    ds_read_b64_tr_b16 a[20:21], v10 offset:40960
    v_add_co_u32 v2, vcc, s96, v2
    s_nop 1
    v_addc_co_u32 v3, vcc, 0, v3, vcc
    v_mfma_f32_16x16x32_bf16 v[176:179], a[4:7], a[200:203], v[176:179]
    ds_read_b64_tr_b16 a[22:23], v10 offset:41984
    s_waitcnt lgkmcnt(4)
    v_mfma_f32_16x16x32_bf16 v[192:195], a[8:11], a[200:203], v[192:195]
    ds_read_b64_tr_b16 a[24:25], v11 offset:40960
    v_accvgpr_write_b32 a88, v108
    v_mfma_f32_16x16x32_bf16 v[200:203], a[8:11], a[204:207], v[200:203]
    ds_read_b64_tr_b16 a[26:27], v11 offset:41984
    global_load_dword a230, v[2:3], off
    v_mfma_f32_16x16x32_bf16 v[216:219], a[12:15], a[204:207], v[216:219]
    ds_read_b64_tr_b16 a[28:29], v12 offset:40960
    v_mfma_f32_16x16x32_bf16 v[208:211], a[12:15], a[200:203], v[208:211]
    ds_read_b64_tr_b16 a[30:31], v12 offset:41984
    s_waitcnt vmcnt(11)
    s_barrier
    s_waitcnt lgkmcnt(4)
    v_mfma_f32_16x16x32_bf16 v[224:227], a[16:19], a[200:203], v[224:227]
    ds_read_b64_tr_b16 a[0:1], v5 offset:49152
    v_accvgpr_write_b32 a89, v109
    v_mfma_f32_16x16x32_bf16 v[232:235], a[16:19], a[204:207], v[232:235]
    ds_read_b64_tr_b16 a[2:3], v5 offset:50176
    v_mfma_f32_16x16x32_bf16 v[248:251], a[20:23], a[204:207], v[248:251]
    ds_read_b64_tr_b16 a[4:5], v6 offset:49152
    v_accvgpr_write_b32 a90, v110
    v_mfma_f32_16x16x32_bf16 v[240:243], a[20:23], a[200:203], v[240:243]
    ds_read_b64_tr_b16 a[6:7], v6 offset:50176
    s_waitcnt lgkmcnt(4)
    v_mfma_f32_16x16x32_bf16 a[240:243], a[24:27], a[200:203], a[240:243]
    ds_read_b64_tr_b16 a[8:9], v7 offset:49152
    v_mfma_f32_16x16x32_bf16 a[244:247], a[24:27], a[204:207], a[244:247]
    ds_read_b64_tr_b16 a[10:11], v7 offset:50176
    v_accvgpr_write_b32 a91, v111
    v_mfma_f32_16x16x32_bf16 a[252:255], a[28:31], a[204:207], a[252:255]
    ds_read_b64_tr_b16 a[12:13], v8 offset:49152
    v_mfma_f32_16x16x32_bf16 a[248:251], a[28:31], a[200:203], a[248:251]
    ds_read_b64_tr_b16 a[14:15], v8 offset:50176
    s_waitcnt lgkmcnt(4)
    v_mfma_f32_16x16x32_bf16 v[32:35], a[0:3], a[208:211], v[32:35]
    ds_read_b64_tr_b16 a[16:17], v9 offset:49152
    v_accvgpr_write_b32 a92, v140
    v_mfma_f32_16x16x32_bf16 v[40:43], a[0:3], a[212:215], v[40:43]
    ds_read_b64_tr_b16 a[18:19], v9 offset:50176
    buffer_load_dword v31, off, s[4:7], s72 sc1
    v_mfma_f32_16x16x32_bf16 v[56:59], a[4:7], a[212:215], v[56:59]
    ds_read_b64_tr_b16 a[20:21], v10 offset:49152
    v_mfma_f32_16x16x32_bf16 v[48:51], a[4:7], a[208:211], v[48:51]
    ds_read_b64_tr_b16 a[22:23], v10 offset:50176
    s_waitcnt lgkmcnt(4)
    v_mfma_f32_16x16x32_bf16 v[64:67], a[8:11], a[208:211], v[64:67]
    ds_read_b64_tr_b16 a[24:25], v11 offset:49152
    v_accvgpr_write_b32 a93, v141
    v_mfma_f32_16x16x32_bf16 v[72:75], a[8:11], a[212:215], v[72:75]
    ds_read_b64_tr_b16 a[26:27], v11 offset:50176
    s_lshl_b32 s97, s21, 21
    v_mfma_f32_16x16x32_bf16 v[88:91], a[12:15], a[212:215], v[88:91]
    ds_read_b64_tr_b16 a[28:29], v12 offset:49152
    v_accvgpr_write_b32 a94, v142
    v_mfma_f32_16x16x32_bf16 v[80:83], a[12:15], a[208:211], v[80:83]
    ds_read_b64_tr_b16 a[30:31], v12 offset:50176
    s_waitcnt lgkmcnt(4)
    v_mfma_f32_16x16x32_bf16 v[96:99], a[16:19], a[208:211], v[96:99]
    ds_read_b64_tr_b16 a[0:1], v5 offset:57344
    s_add_u32 s97, s97, 0
    v_mfma_f32_16x16x32_bf16 v[104:107], a[16:19], a[212:215], v[104:107]
    ds_read_b64_tr_b16 a[2:3], v5 offset:58368
    v_accvgpr_write_b32 a95, v143
    v_mfma_f32_16x16x32_bf16 v[120:123], a[20:23], a[212:215], v[120:123]
    ds_read_b64_tr_b16 a[4:5], v6 offset:57344
    s_lshl_b32 s98, s8, 15
    v_mfma_f32_16x16x32_bf16 v[112:115], a[20:23], a[208:211], v[112:115]
    ds_read_b64_tr_b16 a[6:7], v6 offset:58368
    s_waitcnt lgkmcnt(4)
    v_mfma_f32_16x16x32_bf16 v[128:131], a[24:27], a[208:211], v[128:131]
    ds_read_b64_tr_b16 a[8:9], v7 offset:57344
    v_accvgpr_write_b32 a96, v172
    v_mfma_f32_16x16x32_bf16 v[136:139], a[24:27], a[212:215], v[136:139]
    ds_read_b64_tr_b16 a[10:11], v7 offset:58368
    s_add_u32 s98, s98, s97
    v_mfma_f32_16x16x32_bf16 v[152:155], a[28:31], a[212:215], v[152:155]
    ds_read_b64_tr_b16 a[12:13], v8 offset:57344
    s_add_u32 s99, s22, 1
    v_mfma_f32_16x16x32_bf16 v[144:147], a[28:31], a[208:211], v[144:147]
    ds_read_b64_tr_b16 a[14:15], v8 offset:58368
    s_waitcnt lgkmcnt(4)
    v_mfma_f32_16x16x32_bf16 v[160:163], a[0:3], a[208:211], v[160:163]
    ds_read_b64_tr_b16 a[16:17], v9 offset:57344
    v_accvgpr_write_b32 a97, v173
    v_mfma_f32_16x16x32_bf16 v[168:171], a[0:3], a[212:215], v[168:171]
    ds_read_b64_tr_b16 a[18:19], v9 offset:58368
    s_lshl_b32 s99, s99, 17
    v_mfma_f32_16x16x32_bf16 v[184:187], a[4:7], a[212:215], v[184:187]
    ds_read_b64_tr_b16 a[20:21], v10 offset:57344
    s_add_u32 s99, s99, s97
    v_mfma_f32_16x16x32_bf16 v[176:179], a[4:7], a[208:211], v[176:179]
    ds_read_b64_tr_b16 a[22:23], v10 offset:58368
    s_waitcnt lgkmcnt(4)
    v_mfma_f32_16x16x32_bf16 v[192:195], a[8:11], a[208:211], v[192:195]
    ds_read_b64_tr_b16 a[24:25], v11 offset:57344
    v_accvgpr_write_b32 a98, v174
    v_mfma_f32_16x16x32_bf16 v[200:203], a[8:11], a[212:215], v[200:203]
    ds_read_b64_tr_b16 a[26:27], v11 offset:58368
    s_cmp_ge_u32 s22, 8
    s_cselect_b32 s24, s98, s97
    s_cselect_b32 s13, 0, s8
    v_mfma_f32_16x16x32_bf16 v[216:219], a[12:15], a[212:215], v[216:219]
    ds_read_b64_tr_b16 a[28:29], v12 offset:57344
    v_accvgpr_write_b32 a99, v175
    v_mfma_f32_16x16x32_bf16 v[208:211], a[12:15], a[208:211], v[208:211]
    ds_read_b64_tr_b16 a[30:31], v12 offset:58368
    s_waitcnt lgkmcnt(4)
    v_mfma_f32_16x16x32_bf16 v[224:227], a[16:19], a[208:211], v[224:227]
    ds_read_b64_tr_b16 a[0:1], v13 offset:0
    s_cmp_eq_u32 s13, 0
    s_cselect_b32 s25, s99, s98
    s_cselect_b32 s26, 1073741824, s97
    v_mfma_f32_16x16x32_bf16 v[232:235], a[16:19], a[212:215], v[232:235]
    ds_read_b64_tr_b16 a[2:3], v13 offset:1024
    v_accvgpr_write_b32 a100, v204
    v_mfma_f32_16x16x32_bf16 v[248:251], a[20:23], a[212:215], v[248:251]
    ds_read_b64_tr_b16 a[4:5], v14 offset:0
    s_mov_b32 s27, s99
    v_mfma_f32_16x16x32_bf16 v[240:243], a[20:23], a[208:211], v[240:243]
    ds_read_b64_tr_b16 a[6:7], v14 offset:1024
    s_waitcnt lgkmcnt(4)
    v_mfma_f32_16x16x32_bf16 a[240:243], a[24:27], a[208:211], a[240:243]
    ds_read_b64_tr_b16 a[8:9], v15 offset:0
    v_accvgpr_write_b32 a101, v205
    v_mfma_f32_16x16x32_bf16 a[244:247], a[24:27], a[212:215], a[244:247]
    ds_read_b64_tr_b16 a[10:11], v15 offset:1024
    s_mov_b32 s84, s24
    v_mfma_f32_16x16x32_bf16 a[252:255], a[28:31], a[212:215], a[252:255]
    ds_read_b64_tr_b16 a[12:13], v16 offset:0
    s_add_u32 s24, s24, 32768
    v_mfma_f32_16x16x32_bf16 a[248:251], a[28:31], a[208:211], a[248:251]
    ds_read_b64_tr_b16 a[14:15], v16 offset:1024
    s_waitcnt lgkmcnt(4)
    v_mfma_f32_16x16x32_bf16 v[32:35], a[0:3], a[216:219], v[32:35]
    ds_read_b64_tr_b16 a[16:17], v21 offset:0
    v_accvgpr_write_b32 a102, v206
    v_mfma_f32_16x16x32_bf16 v[40:43], a[0:3], a[220:223], v[40:43]
    ds_read_b64_tr_b16 a[18:19], v21 offset:1024
    s_cmp_eq_u32 s24, s25
    s_cselect_b32 s24, s26, s24
    s_cselect_b32 s25, s27, s25
    s_cselect_b32 s26, 1073741824, s26
    v_mfma_f32_16x16x32_bf16 v[56:59], a[4:7], a[220:223], v[56:59]
    ds_read_b64_tr_b16 a[20:21], v22 offset:0
    s_mov_b32 s85, s24
    v_mfma_f32_16x16x32_bf16 v[48:51], a[4:7], a[216:219], v[48:51]
    ds_read_b64_tr_b16 a[22:23], v22 offset:1024
    s_waitcnt lgkmcnt(4)
    v_mfma_f32_16x16x32_bf16 v[64:67], a[8:11], a[216:219], v[64:67]
    ds_read_b64_tr_b16 a[24:25], v23 offset:0
    v_accvgpr_write_b32 a103, v207
    v_mfma_f32_16x16x32_bf16 v[72:75], a[8:11], a[220:223], v[72:75]
    ds_read_b64_tr_b16 a[26:27], v23 offset:1024
    s_add_u32 s24, s24, 32768
    v_mfma_f32_16x16x32_bf16 v[88:91], a[12:15], a[220:223], v[88:91]
    ds_read_b64_tr_b16 a[28:29], v24 offset:0
    v_accvgpr_write_b32 a104, v236
    v_mfma_f32_16x16x32_bf16 v[80:83], a[12:15], a[216:219], v[80:83]
    ds_read_b64_tr_b16 a[30:31], v24 offset:1024
    s_waitcnt lgkmcnt(4)
    v_mfma_f32_16x16x32_bf16 v[96:99], a[16:19], a[216:219], v[96:99]
    ds_read_b64_tr_b16 a[0:1], v13 offset:8192
    s_cmp_eq_u32 s24, s25
    s_cselect_b32 s24, s26, s24
    s_cselect_b32 s25, s27, s25
    s_cselect_b32 s26, 1073741824, s26
    v_mfma_f32_16x16x32_bf16 v[104:107], a[16:19], a[220:223], v[104:107]
    ds_read_b64_tr_b16 a[2:3], v13 offset:9216
    v_accvgpr_write_b32 a105, v237
    v_mfma_f32_16x16x32_bf16 v[120:123], a[20:23], a[220:223], v[120:123]
    ds_read_b64_tr_b16 a[4:5], v14 offset:8192
    s_mov_b32 s86, s24
    v_mfma_f32_16x16x32_bf16 v[112:115], a[20:23], a[216:219], v[112:115]
    ds_read_b64_tr_b16 a[6:7], v14 offset:9216
    s_waitcnt lgkmcnt(4)
    v_mfma_f32_16x16x32_bf16 v[128:131], a[24:27], a[216:219], v[128:131]
    ds_read_b64_tr_b16 a[8:9], v15 offset:8192
    v_accvgpr_write_b32 a106, v238
    v_mfma_f32_16x16x32_bf16 v[136:139], a[24:27], a[220:223], v[136:139]
    ds_read_b64_tr_b16 a[10:11], v15 offset:9216
    s_add_u32 s24, s24, 32768
    v_mfma_f32_16x16x32_bf16 v[152:155], a[28:31], a[220:223], v[152:155]
    ds_read_b64_tr_b16 a[12:13], v16 offset:8192
    s_cmp_eq_u32 s24, s25
    s_cselect_b32 s24, s26, s24
    s_cselect_b32 s25, s27, s25
    s_cselect_b32 s26, 1073741824, s26
    v_mfma_f32_16x16x32_bf16 v[144:147], a[28:31], a[216:219], v[144:147]
    ds_read_b64_tr_b16 a[14:15], v16 offset:9216
    s_waitcnt lgkmcnt(4)
    v_mfma_f32_16x16x32_bf16 v[160:163], a[0:3], a[216:219], v[160:163]
    ds_read_b64_tr_b16 a[16:17], v21 offset:8192
    v_accvgpr_write_b32 a107, v239
    v_mfma_f32_16x16x32_bf16 v[168:171], a[0:3], a[220:223], v[168:171]
    ds_read_b64_tr_b16 a[18:19], v21 offset:9216
    s_mov_b32 s87, s24
    v_mfma_f32_16x16x32_bf16 v[184:187], a[4:7], a[220:223], v[184:187]
    ds_read_b64_tr_b16 a[20:21], v22 offset:8192
    s_add_u32 s24, s24, 32768
    v_mfma_f32_16x16x32_bf16 v[176:179], a[4:7], a[216:219], v[176:179]
    ds_read_b64_tr_b16 a[22:23], v22 offset:9216
    s_waitcnt lgkmcnt(4)
    v_mfma_f32_16x16x32_bf16 v[192:195], a[8:11], a[216:219], v[192:195]
    ds_read_b64_tr_b16 a[24:25], v23 offset:8192
    v_accvgpr_write_b32 a108, v60
    v_mfma_f32_16x16x32_bf16 v[200:203], a[8:11], a[220:223], v[200:203]
    ds_read_b64_tr_b16 a[26:27], v23 offset:9216
    s_cmp_eq_u32 s24, s25
    s_cselect_b32 s24, s26, s24
    s_cselect_b32 s25, s27, s25
    s_cselect_b32 s26, 1073741824, s26
    v_mfma_f32_16x16x32_bf16 v[216:219], a[12:15], a[220:223], v[216:219]
    ds_read_b64_tr_b16 a[28:29], v24 offset:8192
    v_accvgpr_write_b32 a109, v61
    v_mfma_f32_16x16x32_bf16 v[208:211], a[12:15], a[216:219], v[208:211]
    ds_read_b64_tr_b16 a[30:31], v24 offset:9216
    s_waitcnt vmcnt(2)
    s_barrier
    s_waitcnt lgkmcnt(4)
    v_mfma_f32_16x16x32_bf16 v[224:227], a[16:19], a[216:219], v[224:227]
    ds_read_b64_tr_b16 a[0:1], v13 offset:16384
    v_mfma_f32_16x16x32_bf16 v[232:235], a[16:19], a[220:223], v[232:235]
    ds_read_b64_tr_b16 a[2:3], v13 offset:17408
    v_accvgpr_write_b32 a110, v62
    v_mfma_f32_16x16x32_bf16 v[248:251], a[20:23], a[220:223], v[248:251]
    ds_read_b64_tr_b16 a[4:5], v14 offset:16384
    v_mfma_f32_16x16x32_bf16 v[240:243], a[20:23], a[216:219], v[240:243]
    ds_read_b64_tr_b16 a[6:7], v14 offset:17408
    s_waitcnt lgkmcnt(4)
    v_mfma_f32_16x16x32_bf16 a[240:243], a[24:27], a[216:219], a[240:243]
    ds_read_b64_tr_b16 a[8:9], v15 offset:16384
    v_accvgpr_write_b32 a111, v63
    v_mfma_f32_16x16x32_bf16 a[244:247], a[24:27], a[220:223], a[244:247]
    ds_read_b64_tr_b16 a[10:11], v15 offset:17408
    v_mfma_f32_16x16x32_bf16 a[252:255], a[28:31], a[220:223], a[252:255]
    ds_read_b64_tr_b16 a[12:13], v16 offset:16384
    v_mfma_f32_16x16x32_bf16 a[248:251], a[28:31], a[216:219], a[248:251]
    ds_read_b64_tr_b16 a[14:15], v16 offset:17408
    s_mov_b32 s98, 0
spin_11:
    s_waitcnt vmcnt(0)
    v_readfirstlane_b32 s99, v31
    s_nop 0
    s_cmp_ge_u32 s99, 16
    s_cbranch_scc1 ok_12
    s_add_u32 s98, s98, 1
    s_cmp_gt_u32 s98, 0x80000
    s_cbranch_scc1 ok_12
    s_sleep 8
    buffer_load_dword v31, off, s[4:7], s72 sc1
    s_waitcnt vmcnt(0)
    s_branch spin_11
ok_12:
    s_waitcnt lgkmcnt(4)
    v_mfma_f32_16x16x32_bf16 v[32:35], a[0:3], a[64:67], v[32:35]
    ds_read_b64_tr_b16 a[16:17], v21 offset:16384
    v_mfma_f32_16x16x32_bf16 v[40:43], a[0:3], a[68:71], v[40:43]
    ds_read_b64_tr_b16 a[18:19], v21 offset:17408
    s_add_u32 m0, s28, 32768
    v_mfma_f32_16x16x32_bf16 v[56:59], a[4:7], a[68:71], v[56:59]
    ds_read_b64_tr_b16 a[20:21], v22 offset:16384
    buffer_load_dwordx4 v30, s[4:7], s84 offen offset:0 sc1 lds
    v_mfma_f32_16x16x32_bf16 v[48:51], a[4:7], a[64:67], v[48:51]
    ds_read_b64_tr_b16 a[22:23], v22 offset:17408
    s_waitcnt lgkmcnt(4)
    v_mfma_f32_16x16x32_bf16 v[64:67], a[8:11], a[64:67], v[64:67]
    ds_read_b64_tr_b16 a[24:25], v23 offset:16384
    buffer_load_dwordx4 v30, s[4:7], s84 offen offset:1024 sc1 lds
    v_mfma_f32_16x16x32_bf16 v[72:75], a[8:11], a[68:71], v[72:75]
    ds_read_b64_tr_b16 a[26:27], v23 offset:17408
    buffer_load_dwordx4 v30, s[4:7], s84 offen offset:2048 sc1 lds
    v_mfma_f32_16x16x32_bf16 v[88:91], a[12:15], a[68:71], v[88:91]
    ds_read_b64_tr_b16 a[28:29], v24 offset:16384
    buffer_load_dwordx4 v30, s[4:7], s84 offen offset:3072 sc1 lds
    v_mfma_f32_16x16x32_bf16 v[80:83], a[12:15], a[64:67], v[80:83]
    ds_read_b64_tr_b16 a[30:31], v24 offset:17408
    s_waitcnt lgkmcnt(4)
    v_mfma_f32_16x16x32_bf16 v[96:99], a[16:19], a[64:67], v[96:99]
    ds_read_b64_tr_b16 a[0:1], v13 offset:24576
    s_sub_u32 m0, s28, 65536
    v_mfma_f32_16x16x32_bf16 v[104:107], a[16:19], a[68:71], v[104:107]
    ds_read_b64_tr_b16 a[2:3], v13 offset:25600
    buffer_load_dword v31, off, s[4:7], s73 sc1
    v_mfma_f32_16x16x32_bf16 v[120:123], a[20:23], a[68:71], v[120:123]
    ds_read_b64_tr_b16 a[4:5], v14 offset:24576
    s_mov_b32 s3, s85
    v_mfma_f32_16x16x32_bf16 v[112:115], a[20:23], a[64:67], v[112:115]
    ds_read_b64_tr_b16 a[6:7], v14 offset:25600
    s_waitcnt lgkmcnt(4)
    v_mfma_f32_16x16x32_bf16 v[128:131], a[24:27], a[64:67], v[128:131]
    ds_read_b64_tr_b16 a[8:9], v15 offset:24576
    buffer_load_dwordx4 v30, s[4:7], s3 offen offset:0 sc1 lds
    v_mfma_f32_16x16x32_bf16 v[136:139], a[24:27], a[68:71], v[136:139]
    ds_read_b64_tr_b16 a[10:11], v15 offset:25600
    buffer_load_dwordx4 v30, s[4:7], s3 offen offset:1024 sc1 lds
    v_mfma_f32_16x16x32_bf16 v[152:155], a[28:31], a[68:71], v[152:155]
    ds_read_b64_tr_b16 a[12:13], v16 offset:24576
    buffer_load_dwordx4 v30, s[4:7], s3 offen offset:2048 sc1 lds
    v_mfma_f32_16x16x32_bf16 v[144:147], a[28:31], a[64:67], v[144:147]
    ds_read_b64_tr_b16 a[14:15], v16 offset:25600
    s_waitcnt lgkmcnt(4)
    v_mfma_f32_16x16x32_bf16 v[160:163], a[0:3], a[64:67], v[160:163]
    ds_read_b64_tr_b16 a[16:17], v21 offset:24576
    buffer_load_dwordx4 v30, s[4:7], s3 offen offset:3072 sc1 lds
    v_mfma_f32_16x16x32_bf16 v[168:171], a[0:3], a[68:71], v[168:171]
    ds_read_b64_tr_b16 a[18:19], v21 offset:25600
    s_add_u32 m0, s28, 49152
    v_mfma_f32_16x16x32_bf16 v[184:187], a[4:7], a[68:71], v[184:187]
    ds_read_b64_tr_b16 a[20:21], v22 offset:24576
    s_add_u32 s3, s84, 16384
    v_mfma_f32_16x16x32_bf16 v[176:179], a[4:7], a[64:67], v[176:179]
    ds_read_b64_tr_b16 a[22:23], v22 offset:25600
    s_waitcnt lgkmcnt(4)
    v_mfma_f32_16x16x32_bf16 v[192:195], a[8:11], a[64:67], v[192:195]
    ds_read_b64_tr_b16 a[24:25], v23 offset:24576
    buffer_load_dwordx4 v30, s[4:7], s3 offen offset:0 sc1 lds
    v_mfma_f32_16x16x32_bf16 v[200:203], a[8:11], a[68:71], v[200:203]
    ds_read_b64_tr_b16 a[26:27], v23 offset:25600
    buffer_load_dwordx4 v30, s[4:7], s3 offen offset:1024 sc1 lds
    v_mfma_f32_16x16x32_bf16 v[216:219], a[12:15], a[68:71], v[216:219]
    ds_read_b64_tr_b16 a[28:29], v24 offset:24576
    buffer_load_dwordx4 v30, s[4:7], s3 offen offset:2048 sc1 lds
    v_mfma_f32_16x16x32_bf16 v[208:211], a[12:15], a[64:67], v[208:211]
    ds_read_b64_tr_b16 a[30:31], v24 offset:25600
    s_waitcnt lgkmcnt(4)
    v_mfma_f32_16x16x32_bf16 v[224:227], a[16:19], a[64:67], v[224:227]
    ds_read_b64_tr_b16 a[0:1], v13 offset:32768
    buffer_load_dwordx4 v30, s[4:7], s3 offen offset:3072 sc1 lds
    v_mfma_f32_16x16x32_bf16 v[232:235], a[16:19], a[68:71], v[232:235]
    ds_read_b64_tr_b16 a[2:3], v13 offset:33792
    v_lshrrev_b32 v2, 4, v1
    v_mfma_f32_16x16x32_bf16 v[248:251], a[20:23], a[68:71], v[248:251]
    ds_read_b64_tr_b16 a[4:5], v14 offset:32768
    v_bfe_u32 v3, v1, 2, 2
    v_mfma_f32_16x16x32_bf16 v[240:243], a[20:23], a[64:67], v[240:243]
    ds_read_b64_tr_b16 a[6:7], v14 offset:33792
    s_waitcnt lgkmcnt(4)
    v_mfma_f32_16x16x32_bf16 a[240:243], a[24:27], a[64:67], a[240:243]
    ds_read_b64_tr_b16 a[8:9], v15 offset:32768
    v_lshl_add_u32 v4, v2, 2, v3
    v_mfma_f32_16x16x32_bf16 a[244:247], a[24:27], a[68:71], a[244:247]
    ds_read_b64_tr_b16 a[10:11], v15 offset:33792
    v_and_b32 v3, 7, v4
    v_mfma_f32_16x16x32_bf16 a[252:255], a[28:31], a[68:71], a[252:255]
    ds_read_b64_tr_b16 a[12:13], v16 offset:32768
    v_lshlrev_b32 v4, 9, v4
    v_mfma_f32_16x16x32_bf16 a[248:251], a[28:31], a[64:67], a[248:251]
    ds_read_b64_tr_b16 a[14:15], v16 offset:33792
    s_waitcnt lgkmcnt(4)
    v_mfma_f32_16x16x32_bf16 v[32:35], a[0:3], a[72:75], v[32:35]
    ds_read_b64_tr_b16 a[16:17], v21 offset:32768
    v_and_b32 v2, 3, v1
    v_mfma_f32_16x16x32_bf16 v[40:43], a[0:3], a[76:79], v[40:43]
    ds_read_b64_tr_b16 a[18:19], v21 offset:33792
    v_lshl_or_b32 v4, v2, 3, v4
    v_mfma_f32_16x16x32_bf16 v[56:59], a[4:7], a[76:79], v[56:59]
    ds_read_b64_tr_b16 a[20:21], v22 offset:32768
    v_xor_b32 v2, 0, v3
    v_mfma_f32_16x16x32_bf16 v[48:51], a[4:7], a[72:75], v[48:51]
    ds_read_b64_tr_b16 a[22:23], v22 offset:33792
    s_waitcnt lgkmcnt(4)
    v_mfma_f32_16x16x32_bf16 v[64:67], a[8:11], a[72:75], v[64:67]
    ds_read_b64_tr_b16 a[24:25], v23 offset:32768
    v_lshl_add_u32 v17, v2, 5, v4
    v_mfma_f32_16x16x32_bf16 v[72:75], a[8:11], a[76:79], v[72:75]
    ds_read_b64_tr_b16 a[26:27], v23 offset:33792
    v_xor_b32 v2, 1, v3
    v_mfma_f32_16x16x32_bf16 v[88:91], a[12:15], a[76:79], v[88:91]
    ds_read_b64_tr_b16 a[28:29], v24 offset:32768
    v_lshl_add_u32 v18, v2, 5, v4
    v_mfma_f32_16x16x32_bf16 v[80:83], a[12:15], a[72:75], v[80:83]
    ds_read_b64_tr_b16 a[30:31], v24 offset:33792
    s_waitcnt lgkmcnt(4)
    v_mfma_f32_16x16x32_bf16 v[96:99], a[16:19], a[72:75], v[96:99]
    ds_read_b64_tr_b16 a[0:1], v13 offset:40960
    v_xor_b32 v2, 2, v3
    v_mfma_f32_16x16x32_bf16 v[104:107], a[16:19], a[76:79], v[104:107]
    ds_read_b64_tr_b16 a[2:3], v13 offset:41984
    v_lshl_add_u32 v19, v2, 5, v4
    v_mfma_f32_16x16x32_bf16 v[120:123], a[20:23], a[76:79], v[120:123]
    ds_read_b64_tr_b16 a[4:5], v14 offset:40960
    v_xor_b32 v2, 3, v3
    v_mfma_f32_16x16x32_bf16 v[112:115], a[20:23], a[72:75], v[112:115]
    ds_read_b64_tr_b16 a[6:7], v14 offset:41984
    s_waitcnt lgkmcnt(4)
    v_mfma_f32_16x16x32_bf16 v[128:131], a[24:27], a[72:75], v[128:131]
    ds_read_b64_tr_b16 a[8:9], v15 offset:40960
    v_lshl_add_u32 v20, v2, 5, v4
    v_mfma_f32_16x16x32_bf16 v[136:139], a[24:27], a[76:79], v[136:139]
    ds_read_b64_tr_b16 a[10:11], v15 offset:41984
    v_xor_b32 v2, 4, v3
    v_mfma_f32_16x16x32_bf16 v[152:155], a[28:31], a[76:79], v[152:155]
    ds_read_b64_tr_b16 a[12:13], v16 offset:40960
    v_lshl_add_u32 v26, v2, 5, v4
    v_mfma_f32_16x16x32_bf16 v[144:147], a[28:31], a[72:75], v[144:147]
    ds_read_b64_tr_b16 a[14:15], v16 offset:41984
    s_waitcnt lgkmcnt(4)
    v_mfma_f32_16x16x32_bf16 v[160:163], a[0:3], a[72:75], v[160:163]
    ds_read_b64_tr_b16 a[16:17], v21 offset:40960
    v_xor_b32 v2, 5, v3
    v_mfma_f32_16x16x32_bf16 v[168:171], a[0:3], a[76:79], v[168:171]
    ds_read_b64_tr_b16 a[18:19], v21 offset:41984
    v_lshl_add_u32 v27, v2, 5, v4
    v_mfma_f32_16x16x32_bf16 v[184:187], a[4:7], a[76:79], v[184:187]
    ds_read_b64_tr_b16 a[20:21], v22 offset:40960
    v_xor_b32 v2, 6, v3
    v_mfma_f32_16x16x32_bf16 v[176:179], a[4:7], a[72:75], v[176:179]
    ds_read_b64_tr_b16 a[22:23], v22 offset:41984
    s_waitcnt lgkmcnt(4)
    v_mfma_f32_16x16x32_bf16 v[192:195], a[8:11], a[72:75], v[192:195]
    ds_read_b64_tr_b16 a[24:25], v23 offset:40960
    v_lshl_add_u32 v28, v2, 5, v4
    v_mfma_f32_16x16x32_bf16 v[200:203], a[8:11], a[76:79], v[200:203]
    ds_read_b64_tr_b16 a[26:27], v23 offset:41984
    v_xor_b32 v2, 7, v3
    v_mfma_f32_16x16x32_bf16 v[216:219], a[12:15], a[76:79], v[216:219]
    ds_read_b64_tr_b16 a[28:29], v24 offset:40960
    v_lshl_add_u32 v29, v2, 5, v4
    s_mov_b32 s16, s50
    s_mov_b32 s17, s51
    s_mov_b32 s18, 1605632
    s_mov_b32 s19, 0x20000
    v_mfma_f32_16x16x32_bf16 v[208:211], a[12:15], a[72:75], v[208:211]
    ds_read_b64_tr_b16 a[30:31], v24 offset:41984
    s_waitcnt lgkmcnt(4)
    v_mfma_f32_16x16x32_bf16 v[224:227], a[16:19], a[72:75], v[224:227]
    v_mfma_f32_16x16x32_bf16 v[232:235], a[16:19], a[76:79], v[232:235]
    v_mfma_f32_16x16x32_bf16 v[248:251], a[20:23], a[76:79], v[248:251]
    v_mfma_f32_16x16x32_bf16 v[240:243], a[20:23], a[72:75], v[240:243]
    s_waitcnt lgkmcnt(0)
    v_mfma_f32_16x16x32_bf16 a[240:243], a[24:27], a[72:75], a[240:243]
    v_mfma_f32_16x16x32_bf16 a[244:247], a[24:27], a[76:79], a[244:247]
    v_mfma_f32_16x16x32_bf16 a[252:255], a[28:31], a[76:79], a[252:255]
    v_mfma_f32_16x16x32_bf16 a[248:251], a[28:31], a[72:75], a[248:251]
    s_cmp_eq_u32 s13, 0
    s_cbranch_scc1 as8_noq
    s_lshl_b32 s3, s21, 4
    s_sub_u32 s74, 15, s22
    s_add_u32 s3, s3, s74
    s_lshl_b32 s3, s3, 2
    s_add_u32 s3, s3, s20
    s_lshl_b32 s3, s3, 14
    s_add_u32 s74, s3, 33554432
    s_mov_b32 s98, 0
spin_13:
    s_waitcnt vmcnt(8)
    v_readfirstlane_b32 s99, v31
    s_nop 0
    s_cmp_ge_u32 s99, 1
    s_cbranch_scc1 ok_14
    s_add_u32 s98, s98, 1
    s_cmp_gt_u32 s98, 0x80000
    s_cbranch_scc1 ok_14
    s_sleep 8
    buffer_load_dword v31, off, s[4:7], s73 sc1
    s_waitcnt vmcnt(0)
    s_branch spin_13
ok_14:
    s_add_u32 s3, s74, 0
    buffer_load_dwordx4 a[128:131], v25, s[4:7], s3 offen offset:0 sc1
    buffer_load_dwordx4 a[132:135], v25, s[4:7], s3 offen offset:1024 sc1
    buffer_load_dwordx4 a[136:139], v25, s[4:7], s3 offen offset:2048 sc1
    buffer_load_dwordx4 a[140:143], v25, s[4:7], s3 offen offset:3072 sc1
    s_add_u32 s3, s74, 4096
    buffer_load_dwordx4 a[144:147], v25, s[4:7], s3 offen offset:0 sc1
    buffer_load_dwordx4 a[148:151], v25, s[4:7], s3 offen offset:1024 sc1
    buffer_load_dwordx4 a[152:155], v25, s[4:7], s3 offen offset:2048 sc1
    buffer_load_dwordx4 a[156:159], v25, s[4:7], s3 offen offset:3072 sc1
    s_add_u32 s3, s74, 8192
    buffer_load_dwordx4 a[160:163], v25, s[4:7], s3 offen offset:0 sc1
    buffer_load_dwordx4 a[164:167], v25, s[4:7], s3 offen offset:1024 sc1
    buffer_load_dwordx4 a[168:171], v25, s[4:7], s3 offen offset:2048 sc1
    buffer_load_dwordx4 a[172:175], v25, s[4:7], s3 offen offset:3072 sc1
    s_add_u32 s3, s74, 12288
    buffer_load_dwordx4 a[176:179], v25, s[4:7], s3 offen offset:0 sc1
    buffer_load_dwordx4 a[180:183], v25, s[4:7], s3 offen offset:1024 sc1
    buffer_load_dwordx4 a[184:187], v25, s[4:7], s3 offen offset:2048 sc1
    buffer_load_dwordx4 a[188:191], v25, s[4:7], s3 offen offset:3072 sc1
as8_noq:
    s_lshl_b32 s3, s21, 4
    s_add_u32 s3, s3, s22
    s_lshl_b32 s3, s3, 2
    s_add_u32 s3, s3, s20
    s_lshl_b32 s3, s3, 13
    s_add_u32 s23, s3, 50331648
    s_mov_b32 s68, 0xbfb8aa3b
    s_mov_b32 s69, s68
    v_accvgpr_read_b32 v14, a228
    v_accvgpr_read_b32 v15, a229
    v_sub_f32 v12, 1.0, v14
    v_max_f32 v12, 0x0da24260, v12
    v_rcp_f32 v12, v12
    v_sub_f32 v13, 1.0, v15
    v_max_f32 v13, 0x0da24260, v13
    v_rcp_f32 v13, v13
    v_pk_mul_f32 v[36:37], v[32:33], s[68:69]
    v_pk_mul_f32 v[38:39], v[34:35], s[68:69]
    v_pk_mul_f32 v[52:53], v[48:49], s[68:69]
    v_pk_mul_f32 v[54:55], v[50:51], s[68:69]
    v_exp_f32 v36, v36
    v_exp_f32 v37, v37
    v_exp_f32 v38, v38
    v_exp_f32 v39, v39
    v_exp_f32 v52, v52
    v_exp_f32 v53, v53
    v_exp_f32 v54, v54
    v_exp_f32 v55, v55
    v_pk_mul_f32 v[32:33], v[32:33], v[160:161]
    v_pk_mul_f32 v[34:35], v[34:35], v[162:163]
    v_pk_mul_f32 v[48:49], v[48:49], v[176:177]
    v_pk_mul_f32 v[50:51], v[50:51], v[178:179]
    v_pk_fma_f32 v[36:37], v[36:37], v[12:13], v[12:13] op_sel_hi:[1,0,0]
    v_pk_fma_f32 v[38:39], v[38:39], v[12:13], v[12:13] op_sel_hi:[1,0,0]
    v_pk_fma_f32 v[52:53], v[52:53], v[12:13], v[12:13] op_sel_hi:[1,0,0]
    v_pk_fma_f32 v[54:55], v[54:55], v[12:13], v[12:13] op_sel_hi:[1,0,0]
    v_rcp_f32 v36, v36
    v_rcp_f32 v37, v37
    v_rcp_f32 v38, v38
    v_rcp_f32 v39, v39
    v_rcp_f32 v52, v52
    v_rcp_f32 v53, v53
    v_rcp_f32 v54, v54
    v_rcp_f32 v55, v55
    v_pk_mul_f32 v[32:33], v[32:33], v[36:37]
    v_pk_mul_f32 v[34:35], v[34:35], v[38:39]
    v_pk_mul_f32 v[48:49], v[48:49], v[52:53]
    v_pk_mul_f32 v[50:51], v[50:51], v[54:55]
    v_cvt_pk_bf16_f32 v32, v32, v33
    v_cvt_pk_bf16_f32 v33, v34, v35
    v_cvt_pk_bf16_f32 v34, v48, v49
    v_cvt_pk_bf16_f32 v35, v50, v51
    buffer_store_dwordx4 v[32:35], v25, s[4:7], s23 offen offset:0 sc1
    v_accvgpr_write_b32 a196, v32
    v_accvgpr_write_b32 a197, v33
    v_accvgpr_write_b32 a198, v34
    v_accvgpr_write_b32 a199, v35
    v_pk_mul_f32 v[44:45], v[40:41], s[68:69]
    v_pk_mul_f32 v[46:47], v[42:43], s[68:69]
    v_pk_mul_f32 v[60:61], v[56:57], s[68:69]
    v_pk_mul_f32 v[62:63], v[58:59], s[68:69]
    v_exp_f32 v44, v44
    v_exp_f32 v45, v45
    v_exp_f32 v46, v46
    v_exp_f32 v47, v47
    v_exp_f32 v60, v60
    v_exp_f32 v61, v61
    v_exp_f32 v62, v62
    v_exp_f32 v63, v63
    v_pk_mul_f32 v[40:41], v[40:41], v[168:169]
    v_pk_mul_f32 v[42:43], v[42:43], v[170:171]
    v_pk_mul_f32 v[56:57], v[56:57], v[184:185]
    v_pk_mul_f32 v[58:59], v[58:59], v[186:187]
    v_pk_fma_f32 v[44:45], v[44:45], v[12:13], v[12:13] op_sel:[0,1,1] op_sel_hi:[1,1,1]
    v_pk_fma_f32 v[46:47], v[46:47], v[12:13], v[12:13] op_sel:[0,1,1] op_sel_hi:[1,1,1]
    v_pk_fma_f32 v[60:61], v[60:61], v[12:13], v[12:13] op_sel:[0,1,1] op_sel_hi:[1,1,1]
    v_pk_fma_f32 v[62:63], v[62:63], v[12:13], v[12:13] op_sel:[0,1,1] op_sel_hi:[1,1,1]
    v_rcp_f32 v44, v44
    v_rcp_f32 v45, v45
    v_rcp_f32 v46, v46
    v_rcp_f32 v47, v47
    v_rcp_f32 v60, v60
    v_rcp_f32 v61, v61
    v_rcp_f32 v62, v62
    v_rcp_f32 v63, v63
    v_pk_mul_f32 v[40:41], v[40:41], v[44:45]
    v_pk_mul_f32 v[42:43], v[42:43], v[46:47]
    v_pk_mul_f32 v[56:57], v[56:57], v[60:61]
    v_pk_mul_f32 v[58:59], v[58:59], v[62:63]
    v_cvt_pk_bf16_f32 v40, v40, v41
    v_cvt_pk_bf16_f32 v41, v42, v43
    v_cvt_pk_bf16_f32 v42, v56, v57
    v_cvt_pk_bf16_f32 v43, v58, v59
    buffer_store_dwordx4 v[40:43], v25, s[4:7], s23 offen offset:1024 sc1
    v_accvgpr_write_b32 a200, v40
    v_accvgpr_write_b32 a201, v41
    v_accvgpr_write_b32 a202, v42
    v_accvgpr_write_b32 a203, v43
    v_pk_mul_f32 v[68:69], v[64:65], s[68:69]
    v_pk_mul_f32 v[70:71], v[66:67], s[68:69]
    v_pk_mul_f32 v[84:85], v[80:81], s[68:69]
    v_pk_mul_f32 v[86:87], v[82:83], s[68:69]
    v_exp_f32 v68, v68
    v_exp_f32 v69, v69
    v_exp_f32 v70, v70
    v_exp_f32 v71, v71
    v_exp_f32 v84, v84
    v_exp_f32 v85, v85
    v_exp_f32 v86, v86
    v_exp_f32 v87, v87
    v_pk_mul_f32 v[64:65], v[64:65], v[192:193]
    v_pk_mul_f32 v[66:67], v[66:67], v[194:195]
    v_pk_mul_f32 v[80:81], v[80:81], v[208:209]
    v_pk_mul_f32 v[82:83], v[82:83], v[210:211]
    v_pk_fma_f32 v[68:69], v[68:69], v[12:13], v[12:13] op_sel_hi:[1,0,0]
    v_pk_fma_f32 v[70:71], v[70:71], v[12:13], v[12:13] op_sel_hi:[1,0,0]
    v_pk_fma_f32 v[84:85], v[84:85], v[12:13], v[12:13] op_sel_hi:[1,0,0]
    v_pk_fma_f32 v[86:87], v[86:87], v[12:13], v[12:13] op_sel_hi:[1,0,0]
    v_rcp_f32 v68, v68
    v_rcp_f32 v69, v69
    v_rcp_f32 v70, v70
    v_rcp_f32 v71, v71
    v_rcp_f32 v84, v84
    v_rcp_f32 v85, v85
    v_rcp_f32 v86, v86
    v_rcp_f32 v87, v87
    v_pk_mul_f32 v[64:65], v[64:65], v[68:69]
    v_pk_mul_f32 v[66:67], v[66:67], v[70:71]
    v_pk_mul_f32 v[80:81], v[80:81], v[84:85]
    v_pk_mul_f32 v[82:83], v[82:83], v[86:87]
    v_cvt_pk_bf16_f32 v64, v64, v65
    v_cvt_pk_bf16_f32 v65, v66, v67
    v_cvt_pk_bf16_f32 v66, v80, v81
    v_cvt_pk_bf16_f32 v67, v82, v83
    buffer_store_dwordx4 v[64:67], v25, s[4:7], s23 offen offset:2048 sc1
    v_accvgpr_write_b32 a204, v64
    v_accvgpr_write_b32 a205, v65
    v_accvgpr_write_b32 a206, v66
    v_accvgpr_write_b32 a207, v67
    v_pk_mul_f32 v[76:77], v[72:73], s[68:69]
    v_pk_mul_f32 v[78:79], v[74:75], s[68:69]
    v_pk_mul_f32 v[92:93], v[88:89], s[68:69]
    v_pk_mul_f32 v[94:95], v[90:91], s[68:69]
    v_exp_f32 v76, v76
    v_exp_f32 v77, v77
    v_exp_f32 v78, v78
    v_exp_f32 v79, v79
    v_exp_f32 v92, v92
    v_exp_f32 v93, v93
    v_exp_f32 v94, v94
    v_exp_f32 v95, v95
    v_pk_mul_f32 v[72:73], v[72:73], v[200:201]
    v_pk_mul_f32 v[74:75], v[74:75], v[202:203]
    v_pk_mul_f32 v[88:89], v[88:89], v[216:217]
    v_pk_mul_f32 v[90:91], v[90:91], v[218:219]
    v_pk_fma_f32 v[76:77], v[76:77], v[12:13], v[12:13] op_sel:[0,1,1] op_sel_hi:[1,1,1]
    v_pk_fma_f32 v[78:79], v[78:79], v[12:13], v[12:13] op_sel:[0,1,1] op_sel_hi:[1,1,1]
    v_pk_fma_f32 v[92:93], v[92:93], v[12:13], v[12:13] op_sel:[0,1,1] op_sel_hi:[1,1,1]
    v_pk_fma_f32 v[94:95], v[94:95], v[12:13], v[12:13] op_sel:[0,1,1] op_sel_hi:[1,1,1]
    v_rcp_f32 v76, v76
    v_rcp_f32 v77, v77
    v_rcp_f32 v78, v78
    v_rcp_f32 v79, v79
    v_rcp_f32 v92, v92
    v_rcp_f32 v93, v93
    v_rcp_f32 v94, v94
    v_rcp_f32 v95, v95
    v_pk_mul_f32 v[72:73], v[72:73], v[76:77]
    v_pk_mul_f32 v[74:75], v[74:75], v[78:79]
    v_pk_mul_f32 v[88:89], v[88:89], v[92:93]
    v_pk_mul_f32 v[90:91], v[90:91], v[94:95]
    v_cvt_pk_bf16_f32 v72, v72, v73
    v_cvt_pk_bf16_f32 v73, v74, v75
    v_cvt_pk_bf16_f32 v74, v88, v89
    v_cvt_pk_bf16_f32 v75, v90, v91
    buffer_store_dwordx4 v[72:75], v25, s[4:7], s23 offen offset:3072 sc1
    v_accvgpr_write_b32 a208, v72
    v_accvgpr_write_b32 a209, v73
    v_accvgpr_write_b32 a210, v74
    v_accvgpr_write_b32 a211, v75
    s_add_u32 s23, s23, 4096
    v_pk_mul_f32 v[100:101], v[96:97], s[68:69]
    v_pk_mul_f32 v[102:103], v[98:99], s[68:69]
    v_pk_mul_f32 v[116:117], v[112:113], s[68:69]
    v_pk_mul_f32 v[118:119], v[114:115], s[68:69]
    v_exp_f32 v100, v100
    v_exp_f32 v101, v101
    v_exp_f32 v102, v102
    v_exp_f32 v103, v103
    v_exp_f32 v116, v116
    v_exp_f32 v117, v117
    v_exp_f32 v118, v118
    v_exp_f32 v119, v119
    v_pk_mul_f32 v[96:97], v[96:97], v[224:225]
    v_pk_mul_f32 v[98:99], v[98:99], v[226:227]
    v_pk_mul_f32 v[112:113], v[112:113], v[240:241]
    v_pk_mul_f32 v[114:115], v[114:115], v[242:243]
    v_pk_fma_f32 v[100:101], v[100:101], v[12:13], v[12:13] op_sel_hi:[1,0,0]
    v_pk_fma_f32 v[102:103], v[102:103], v[12:13], v[12:13] op_sel_hi:[1,0,0]
    v_pk_fma_f32 v[116:117], v[116:117], v[12:13], v[12:13] op_sel_hi:[1,0,0]
    v_pk_fma_f32 v[118:119], v[118:119], v[12:13], v[12:13] op_sel_hi:[1,0,0]
    v_rcp_f32 v100, v100
    v_rcp_f32 v101, v101
    v_rcp_f32 v102, v102
    v_rcp_f32 v103, v103
    v_rcp_f32 v116, v116
    v_rcp_f32 v117, v117
    v_rcp_f32 v118, v118
    v_rcp_f32 v119, v119
    v_pk_mul_f32 v[96:97], v[96:97], v[100:101]
    v_pk_mul_f32 v[98:99], v[98:99], v[102:103]
    v_pk_mul_f32 v[112:113], v[112:113], v[116:117]
    v_pk_mul_f32 v[114:115], v[114:115], v[118:119]
    v_cvt_pk_bf16_f32 v96, v96, v97
    v_cvt_pk_bf16_f32 v97, v98, v99
    v_cvt_pk_bf16_f32 v98, v112, v113
    v_cvt_pk_bf16_f32 v99, v114, v115
    buffer_store_dwordx4 v[96:99], v25, s[4:7], s23 offen offset:0 sc1
    v_accvgpr_write_b32 a212, v96
    v_accvgpr_write_b32 a213, v97
    v_accvgpr_write_b32 a214, v98
    v_accvgpr_write_b32 a215, v99
    v_pk_mul_f32 v[108:109], v[104:105], s[68:69]
    v_pk_mul_f32 v[110:111], v[106:107], s[68:69]
    v_pk_mul_f32 v[124:125], v[120:121], s[68:69]
    v_pk_mul_f32 v[126:127], v[122:123], s[68:69]
    v_exp_f32 v108, v108
    v_exp_f32 v109, v109
    v_exp_f32 v110, v110
    v_exp_f32 v111, v111
    v_exp_f32 v124, v124
    v_exp_f32 v125, v125
    v_exp_f32 v126, v126
    v_exp_f32 v127, v127
    v_pk_mul_f32 v[104:105], v[104:105], v[232:233]
    v_pk_mul_f32 v[106:107], v[106:107], v[234:235]
    v_pk_mul_f32 v[120:121], v[120:121], v[248:249]
    v_pk_mul_f32 v[122:123], v[122:123], v[250:251]
    v_pk_fma_f32 v[108:109], v[108:109], v[12:13], v[12:13] op_sel:[0,1,1] op_sel_hi:[1,1,1]
    v_pk_fma_f32 v[110:111], v[110:111], v[12:13], v[12:13] op_sel:[0,1,1] op_sel_hi:[1,1,1]
    v_pk_fma_f32 v[124:125], v[124:125], v[12:13], v[12:13] op_sel:[0,1,1] op_sel_hi:[1,1,1]
    v_pk_fma_f32 v[126:127], v[126:127], v[12:13], v[12:13] op_sel:[0,1,1] op_sel_hi:[1,1,1]
    v_rcp_f32 v108, v108
    v_rcp_f32 v109, v109
    v_rcp_f32 v110, v110
    v_rcp_f32 v111, v111
    v_rcp_f32 v124, v124
    v_rcp_f32 v125, v125
    v_rcp_f32 v126, v126
    v_rcp_f32 v127, v127
    v_pk_mul_f32 v[104:105], v[104:105], v[108:109]
    v_pk_mul_f32 v[106:107], v[106:107], v[110:111]
    v_pk_mul_f32 v[120:121], v[120:121], v[124:125]
    v_pk_mul_f32 v[122:123], v[122:123], v[126:127]
    v_cvt_pk_bf16_f32 v104, v104, v105
    v_cvt_pk_bf16_f32 v105, v106, v107
    v_cvt_pk_bf16_f32 v106, v120, v121
    v_cvt_pk_bf16_f32 v107, v122, v123
    buffer_store_dwordx4 v[104:107], v25, s[4:7], s23 offen offset:1024 sc1
    v_accvgpr_write_b32 a216, v104
    v_accvgpr_write_b32 a217, v105
    v_accvgpr_write_b32 a218, v106
    v_accvgpr_write_b32 a219, v107
    v_accvgpr_read_b32 v100, a240
    v_accvgpr_read_b32 v101, a241
    v_accvgpr_read_b32 v102, a242
    v_accvgpr_read_b32 v103, a243
    v_accvgpr_read_b32 v108, a248
    v_accvgpr_read_b32 v109, a249
    v_accvgpr_read_b32 v110, a250
    v_accvgpr_read_b32 v111, a251
    v_pk_mul_f32 v[132:133], v[128:129], s[68:69]
    v_pk_mul_f32 v[134:135], v[130:131], s[68:69]
    v_pk_mul_f32 v[148:149], v[144:145], s[68:69]
    v_pk_mul_f32 v[150:151], v[146:147], s[68:69]
    v_exp_f32 v132, v132
    v_exp_f32 v133, v133
    v_exp_f32 v134, v134
    v_exp_f32 v135, v135
    v_exp_f32 v148, v148
    v_exp_f32 v149, v149
    v_exp_f32 v150, v150
    v_exp_f32 v151, v151
    v_pk_mul_f32 v[128:129], v[128:129], v[100:101]
    v_pk_mul_f32 v[130:131], v[130:131], v[102:103]
    v_pk_mul_f32 v[144:145], v[144:145], v[108:109]
    v_pk_mul_f32 v[146:147], v[146:147], v[110:111]
    v_pk_fma_f32 v[132:133], v[132:133], v[12:13], v[12:13] op_sel_hi:[1,0,0]
    v_pk_fma_f32 v[134:135], v[134:135], v[12:13], v[12:13] op_sel_hi:[1,0,0]
    v_pk_fma_f32 v[148:149], v[148:149], v[12:13], v[12:13] op_sel_hi:[1,0,0]
    v_pk_fma_f32 v[150:151], v[150:151], v[12:13], v[12:13] op_sel_hi:[1,0,0]
    v_rcp_f32 v132, v132
    v_rcp_f32 v133, v133
    v_rcp_f32 v134, v134
    v_rcp_f32 v135, v135
    v_rcp_f32 v148, v148
    v_rcp_f32 v149, v149
    v_rcp_f32 v150, v150
    v_rcp_f32 v151, v151
    v_pk_mul_f32 v[128:129], v[128:129], v[132:133]
    v_pk_mul_f32 v[130:131], v[130:131], v[134:135]
    v_pk_mul_f32 v[144:145], v[144:145], v[148:149]
    v_pk_mul_f32 v[146:147], v[146:147], v[150:151]
    v_cvt_pk_bf16_f32 v128, v128, v129
    v_cvt_pk_bf16_f32 v129, v130, v131
    v_cvt_pk_bf16_f32 v130, v144, v145
    v_cvt_pk_bf16_f32 v131, v146, v147
    buffer_store_dwordx4 v[128:131], v25, s[4:7], s23 offen offset:2048 sc1
    v_accvgpr_write_b32 a220, v128
    v_accvgpr_write_b32 a221, v129
    v_accvgpr_write_b32 a222, v130
    v_accvgpr_write_b32 a223, v131
    v_accvgpr_read_b32 v100, a244
    v_accvgpr_read_b32 v101, a245
    v_accvgpr_read_b32 v102, a246
    v_accvgpr_read_b32 v103, a247
    v_accvgpr_read_b32 v108, a252
    v_accvgpr_read_b32 v109, a253
    v_accvgpr_read_b32 v110, a254
    v_accvgpr_read_b32 v111, a255
    v_pk_mul_f32 v[140:141], v[136:137], s[68:69]
    v_pk_mul_f32 v[142:143], v[138:139], s[68:69]
    v_pk_mul_f32 v[156:157], v[152:153], s[68:69]
    v_pk_mul_f32 v[158:159], v[154:155], s[68:69]
    v_exp_f32 v140, v140
    v_exp_f32 v141, v141
    v_exp_f32 v142, v142
    v_exp_f32 v143, v143
    v_exp_f32 v156, v156
    v_exp_f32 v157, v157
    v_exp_f32 v158, v158
    v_exp_f32 v159, v159
    v_pk_mul_f32 v[136:137], v[136:137], v[100:101]
    v_pk_mul_f32 v[138:139], v[138:139], v[102:103]
    v_pk_mul_f32 v[152:153], v[152:153], v[108:109]
    v_pk_mul_f32 v[154:155], v[154:155], v[110:111]
    v_pk_fma_f32 v[140:141], v[140:141], v[12:13], v[12:13] op_sel:[0,1,1] op_sel_hi:[1,1,1]
    v_pk_fma_f32 v[142:143], v[142:143], v[12:13], v[12:13] op_sel:[0,1,1] op_sel_hi:[1,1,1]
    v_pk_fma_f32 v[156:157], v[156:157], v[12:13], v[12:13] op_sel:[0,1,1] op_sel_hi:[1,1,1]
    v_pk_fma_f32 v[158:159], v[158:159], v[12:13], v[12:13] op_sel:[0,1,1] op_sel_hi:[1,1,1]
    v_rcp_f32 v140, v140
    v_rcp_f32 v141, v141
    v_rcp_f32 v142, v142
    v_rcp_f32 v143, v143
    v_rcp_f32 v156, v156
    v_rcp_f32 v157, v157
    v_rcp_f32 v158, v158
    v_rcp_f32 v159, v159
    v_pk_mul_f32 v[136:137], v[136:137], v[140:141]
    v_pk_mul_f32 v[138:139], v[138:139], v[142:143]
    v_pk_mul_f32 v[152:153], v[152:153], v[156:157]
    v_pk_mul_f32 v[154:155], v[154:155], v[158:159]
    v_cvt_pk_bf16_f32 v136, v136, v137
    v_cvt_pk_bf16_f32 v137, v138, v139
    v_cvt_pk_bf16_f32 v138, v152, v153
    v_cvt_pk_bf16_f32 v139, v154, v155
    buffer_store_dwordx4 v[136:139], v25, s[4:7], s23 offen offset:3072 sc1
    v_accvgpr_write_b32 a224, v136
    v_accvgpr_write_b32 a225, v137
    v_accvgpr_write_b32 a226, v138
    v_accvgpr_write_b32 a227, v139
    s_branch qf_done
qf_odd:
    s_waitcnt lgkmcnt(4)
    v_mfma_f32_16x16x32_bf16 v[32:35], a[0:3], a[128:131], 0
    ds_read_b64_tr_b16 a[16:17], v9 offset:0
    s_add_u32 m0, s30, 65536
    v_mfma_f32_16x16x32_bf16 v[40:43], a[0:3], a[132:135], 0
    ds_read_b64_tr_b16 a[18:19], v9 offset:1024
    v_mfma_f32_16x16x32_bf16 v[56:59], a[4:7], a[132:135], 0
    ds_read_b64_tr_b16 a[20:21], v10 offset:0
    buffer_load_dwordx4 v26, s[16:19], s31 offen offset:0 sc1 lds
    v_mfma_f32_16x16x32_bf16 v[48:51], a[4:7], a[128:131], 0
    ds_read_b64_tr_b16 a[22:23], v10 offset:1024
    s_waitcnt lgkmcnt(4)
    v_mfma_f32_16x16x32_bf16 v[64:67], a[8:11], a[128:131], 0
    ds_read_b64_tr_b16 a[24:25], v5 offset:8192
    buffer_load_dwordx4 v27, s[16:19], s31 offen offset:1024 sc1 lds
    v_mfma_f32_16x16x32_bf16 v[72:75], a[8:11], a[132:135], 0
    ds_read_b64_tr_b16 a[26:27], v5 offset:9216
    v_mul_f32 v36, s68, v36
    v_mul_f32 v37, s68, v37
    v_mfma_f32_16x16x32_bf16 v[88:91], a[12:15], a[132:135], 0
    ds_read_b64_tr_b16 a[28:29], v6 offset:8192
    buffer_load_dwordx4 v28, s[16:19], s31 offen offset:2048 sc1 lds
    v_mul_f32 v38, s68, v38
    v_mfma_f32_16x16x32_bf16 v[80:83], a[12:15], a[128:131], 0
    ds_read_b64_tr_b16 a[30:31], v6 offset:9216
    v_mul_f32 v39, s68, v39
    v_mul_f32 v52, s68, v52
    s_waitcnt lgkmcnt(4)
    v_mfma_f32_16x16x32_bf16 v[96:99], a[16:19], a[128:131], 0
    ds_read_b64_tr_b16 a[0:1], v7 offset:8192
    buffer_load_dwordx4 v29, s[16:19], s31 offen offset:3072 sc1 lds
    v_mul_f32 v53, s68, v53
    v_mfma_f32_16x16x32_bf16 v[104:107], a[16:19], a[132:135], 0
    ds_read_b64_tr_b16 a[2:3], v7 offset:9216
    v_mul_f32 v54, s68, v54
    v_mul_f32 v55, s68, v55
    v_mfma_f32_16x16x32_bf16 v[120:123], a[20:23], a[132:135], 0
    ds_read_b64_tr_b16 a[4:5], v8 offset:8192
    s_add_u32 s31, s31, 114688
    v_cvt_pk_bf16_f32 v36, v36, v37
    v_mfma_f32_16x16x32_bf16 v[112:115], a[20:23], a[128:131], 0
    ds_read_b64_tr_b16 a[6:7], v8 offset:9216
    v_cvt_pk_bf16_f32 v37, v38, v39
    v_cvt_pk_bf16_f32 v38, v52, v53
    s_waitcnt lgkmcnt(4)
    v_mfma_f32_16x16x32_bf16 v[160:163], a[24:27], a[128:131], 0
    ds_read_b64_tr_b16 a[8:9], v9 offset:8192
    v_cvt_pk_bf16_f32 v39, v54, v55
    s_add_u32 s3, s70, 0
    v_mfma_f32_16x16x32_bf16 v[168:171], a[24:27], a[132:135], 0
    ds_read_b64_tr_b16 a[10:11], v9 offset:9216
    s_add_u32 m0, s30, 81920
    buffer_store_dwordx4 v[36:39], v25, s[4:7], s3 offen offset:0 sc1
    v_mfma_f32_16x16x32_bf16 v[184:187], a[28:31], a[132:135], 0
    ds_read_b64_tr_b16 a[12:13], v10 offset:8192
    v_mul_f32 v68, s68, v68
    v_mul_f32 v69, s68, v69
    v_mfma_f32_16x16x32_bf16 v[176:179], a[28:31], a[128:131], 0
    ds_read_b64_tr_b16 a[14:15], v10 offset:9216
    v_mul_f32 v70, s68, v70
    v_mul_f32 v71, s68, v71
    s_waitcnt lgkmcnt(4)
    v_mfma_f32_16x16x32_bf16 v[192:195], a[0:3], a[128:131], 0
    ds_read_b64_tr_b16 a[16:17], v5 offset:16384
    buffer_load_dwordx4 v26, s[16:19], s31 offen offset:0 sc1 lds
    v_mul_f32 v84, s68, v84
    v_mfma_f32_16x16x32_bf16 v[200:203], a[0:3], a[132:135], 0
    ds_read_b64_tr_b16 a[18:19], v5 offset:17408
    buffer_load_dwordx4 v27, s[16:19], s31 offen offset:1024 sc1 lds
    v_mul_f32 v85, s68, v85
    v_mfma_f32_16x16x32_bf16 v[216:219], a[4:7], a[132:135], 0
    ds_read_b64_tr_b16 a[20:21], v6 offset:16384
    v_mul_f32 v86, s68, v86
    v_mul_f32 v87, s68, v87
    v_mfma_f32_16x16x32_bf16 v[208:211], a[4:7], a[128:131], 0
    ds_read_b64_tr_b16 a[22:23], v6 offset:17408
    v_cvt_pk_bf16_f32 v68, v68, v69
    v_cvt_pk_bf16_f32 v69, v70, v71
    s_waitcnt lgkmcnt(4)
    v_mfma_f32_16x16x32_bf16 v[224:227], a[8:11], a[128:131], 0
    ds_read_b64_tr_b16 a[24:25], v7 offset:16384
    buffer_load_dwordx4 v28, s[16:19], s31 offen offset:2048 sc1 lds
    v_cvt_pk_bf16_f32 v70, v84, v85
    v_mfma_f32_16x16x32_bf16 v[232:235], a[8:11], a[132:135], 0
    ds_read_b64_tr_b16 a[26:27], v7 offset:17408
    buffer_load_dwordx4 v29, s[16:19], s31 offen offset:3072 sc1 lds
    v_cvt_pk_bf16_f32 v71, v86, v87
    v_mfma_f32_16x16x32_bf16 v[248:251], a[12:15], a[132:135], 0
    ds_read_b64_tr_b16 a[28:29], v8 offset:16384
    buffer_store_dwordx4 v[68:71], v25, s[4:7], s3 offen offset:1024 sc1
    v_mul_f32 v100, s68, v100
    v_mfma_f32_16x16x32_bf16 v[240:243], a[12:15], a[128:131], 0
    ds_read_b64_tr_b16 a[30:31], v8 offset:17408
    v_mul_f32 v101, s68, v101
    v_mul_f32 v102, s68, v102
    s_waitcnt lgkmcnt(4)
    v_mfma_f32_16x16x32_bf16 v[32:35], a[16:19], a[136:139], v[32:35]
    ds_read_b64_tr_b16 a[0:1], v9 offset:16384
    s_add_u32 s31, s31, 114688
    v_mul_f32 v103, s68, v103
    v_mfma_f32_16x16x32_bf16 v[40:43], a[16:19], a[140:143], v[40:43]
    ds_read_b64_tr_b16 a[2:3], v9 offset:17408
    v_mul_f32 v116, s68, v116
    v_mul_f32 v117, s68, v117
    v_mfma_f32_16x16x32_bf16 v[56:59], a[20:23], a[140:143], v[56:59]
    ds_read_b64_tr_b16 a[4:5], v10 offset:16384
    v_mul_f32 v118, s68, v118
    v_mul_f32 v119, s68, v119
    v_mfma_f32_16x16x32_bf16 v[48:51], a[20:23], a[136:139], v[48:51]
    ds_read_b64_tr_b16 a[6:7], v10 offset:17408
    v_cvt_pk_bf16_f32 v100, v100, v101
    s_waitcnt lgkmcnt(4)
    v_mfma_f32_16x16x32_bf16 v[64:67], a[24:27], a[136:139], v[64:67]
    ds_read_b64_tr_b16 a[8:9], v5 offset:24576
    v_cvt_pk_bf16_f32 v101, v102, v103
    v_cvt_pk_bf16_f32 v102, v116, v117
    v_mfma_f32_16x16x32_bf16 v[72:75], a[24:27], a[140:143], v[72:75]
    ds_read_b64_tr_b16 a[10:11], v5 offset:25600
    v_cvt_pk_bf16_f32 v103, v118, v119
    v_mfma_f32_16x16x32_bf16 v[88:91], a[28:31], a[140:143], v[88:91]
    ds_read_b64_tr_b16 a[12:13], v6 offset:24576
    buffer_load_dword v31, off, s[60:63], 0 sc1
    buffer_store_dwordx4 v[100:103], v25, s[4:7], s3 offen offset:2048 sc1
    v_mfma_f32_16x16x32_bf16 v[80:83], a[28:31], a[136:139], v[80:83]
    ds_read_b64_tr_b16 a[14:15], v6 offset:25600
    v_mul_f32 v132, s68, v132
    v_mul_f32 v133, s68, v133
    s_waitcnt lgkmcnt(4)
    v_mfma_f32_16x16x32_bf16 v[96:99], a[0:3], a[136:139], v[96:99]
    ds_read_b64_tr_b16 a[16:17], v7 offset:24576
    v_mul_f32 v134, s68, v134
    v_mul_f32 v135, s68, v135
    v_mfma_f32_16x16x32_bf16 v[104:107], a[0:3], a[140:143], v[104:107]
    ds_read_b64_tr_b16 a[18:19], v7 offset:25600
    v_mul_f32 v148, s68, v148
    v_mul_f32 v149, s68, v149
    v_mfma_f32_16x16x32_bf16 v[120:123], a[4:7], a[140:143], v[120:123]
    ds_read_b64_tr_b16 a[20:21], v8 offset:24576
    v_mul_f32 v150, s68, v150
    v_mfma_f32_16x16x32_bf16 v[112:115], a[4:7], a[136:139], v[112:115]
    ds_read_b64_tr_b16 a[22:23], v8 offset:25600
    v_mul_f32 v151, s68, v151
    v_cvt_pk_bf16_f32 v132, v132, v133
    s_waitcnt lgkmcnt(4)
    v_mfma_f32_16x16x32_bf16 v[160:163], a[8:11], a[136:139], v[160:163]
    ds_read_b64_tr_b16 a[24:25], v9 offset:24576
    v_cvt_pk_bf16_f32 v133, v134, v135
    v_mfma_f32_16x16x32_bf16 v[168:171], a[8:11], a[140:143], v[168:171]
    ds_read_b64_tr_b16 a[26:27], v9 offset:25600
    v_cvt_pk_bf16_f32 v134, v148, v149
    v_cvt_pk_bf16_f32 v135, v150, v151
    v_mfma_f32_16x16x32_bf16 v[184:187], a[12:15], a[140:143], v[184:187]
    ds_read_b64_tr_b16 a[28:29], v10 offset:24576
    buffer_store_dwordx4 v[132:135], v25, s[4:7], s3 offen offset:3072 sc1
    v_mfma_f32_16x16x32_bf16 v[176:179], a[12:15], a[136:139], v[176:179]
    ds_read_b64_tr_b16 a[30:31], v10 offset:25600
    s_waitcnt vmcnt(17)
    s_barrier
    s_waitcnt lgkmcnt(4)
    v_mfma_f32_16x16x32_bf16 v[192:195], a[16:19], a[136:139], v[192:195]
    ds_read_b64_tr_b16 a[0:1], v5 offset:32768
    v_mul_f32 v164, s68, v164
    v_mul_f32 v165, s68, v165
    v_mfma_f32_16x16x32_bf16 v[200:203], a[16:19], a[140:143], v[200:203]
    ds_read_b64_tr_b16 a[2:3], v5 offset:33792
    v_mul_f32 v166, s68, v166
    v_mul_f32 v167, s68, v167
    v_mfma_f32_16x16x32_bf16 v[216:219], a[20:23], a[140:143], v[216:219]
    ds_read_b64_tr_b16 a[4:5], v6 offset:32768
    v_mul_f32 v180, s68, v180
    v_mul_f32 v181, s68, v181
    v_mfma_f32_16x16x32_bf16 v[208:211], a[20:23], a[136:139], v[208:211]
    ds_read_b64_tr_b16 a[6:7], v6 offset:33792
    v_mul_f32 v182, s68, v182
    v_mul_f32 v183, s68, v183
    s_waitcnt lgkmcnt(4)
    v_mfma_f32_16x16x32_bf16 v[224:227], a[24:27], a[136:139], v[224:227]
    ds_read_b64_tr_b16 a[8:9], v7 offset:32768
    v_cvt_pk_bf16_f32 v164, v164, v165
    v_cvt_pk_bf16_f32 v165, v166, v167
    v_mfma_f32_16x16x32_bf16 v[232:235], a[24:27], a[140:143], v[232:235]
    ds_read_b64_tr_b16 a[10:11], v7 offset:33792
    v_cvt_pk_bf16_f32 v166, v180, v181
    v_mfma_f32_16x16x32_bf16 v[248:251], a[28:31], a[140:143], v[248:251]
    ds_read_b64_tr_b16 a[12:13], v8 offset:32768
    v_cvt_pk_bf16_f32 v167, v182, v183
    s_add_u32 s3, s70, 4096
    v_mfma_f32_16x16x32_bf16 v[240:243], a[28:31], a[136:139], v[240:243]
    ds_read_b64_tr_b16 a[14:15], v8 offset:33792
    buffer_store_dwordx4 v[164:167], v25, s[4:7], s3 offen offset:0 sc1
    s_waitcnt lgkmcnt(4)
    v_mfma_f32_16x16x32_bf16 v[32:35], a[0:3], a[144:147], v[32:35]
    ds_read_b64_tr_b16 a[16:17], v9 offset:32768
    s_add_u32 m0, s30, 98304
    v_mul_f32 v196, s68, v196
    v_mfma_f32_16x16x32_bf16 v[40:43], a[0:3], a[148:151], v[40:43]
    ds_read_b64_tr_b16 a[18:19], v9 offset:33792
    v_mul_f32 v197, s68, v197
    v_mul_f32 v198, s68, v198
    v_mfma_f32_16x16x32_bf16 v[56:59], a[4:7], a[148:151], v[56:59]
    ds_read_b64_tr_b16 a[20:21], v10 offset:32768
    buffer_load_dwordx4 v26, s[16:19], s31 offen offset:0 sc1 lds
    v_mul_f32 v199, s68, v199
    v_mfma_f32_16x16x32_bf16 v[48:51], a[4:7], a[144:147], v[48:51]
    ds_read_b64_tr_b16 a[22:23], v10 offset:33792
    v_mul_f32 v212, s68, v212
    v_mul_f32 v213, s68, v213
    s_waitcnt lgkmcnt(4)
    v_mfma_f32_16x16x32_bf16 v[64:67], a[8:11], a[144:147], v[64:67]
    ds_read_b64_tr_b16 a[24:25], v5 offset:40960
    buffer_load_dwordx4 v27, s[16:19], s31 offen offset:1024 sc1 lds
    v_mul_f32 v214, s68, v214
    v_mfma_f32_16x16x32_bf16 v[72:75], a[8:11], a[148:151], v[72:75]
    ds_read_b64_tr_b16 a[26:27], v5 offset:41984
    v_mul_f32 v215, s68, v215
    v_cvt_pk_bf16_f32 v196, v196, v197
    v_mfma_f32_16x16x32_bf16 v[88:91], a[12:15], a[148:151], v[88:91]
    ds_read_b64_tr_b16 a[28:29], v6 offset:40960
    buffer_load_dwordx4 v28, s[16:19], s31 offen offset:2048 sc1 lds
    v_cvt_pk_bf16_f32 v197, v198, v199
    v_mfma_f32_16x16x32_bf16 v[80:83], a[12:15], a[144:147], v[80:83]
    ds_read_b64_tr_b16 a[30:31], v6 offset:41984
    v_cvt_pk_bf16_f32 v198, v212, v213
    v_cvt_pk_bf16_f32 v199, v214, v215
    s_waitcnt lgkmcnt(4)
    v_mfma_f32_16x16x32_bf16 v[96:99], a[16:19], a[144:147], v[96:99]
    ds_read_b64_tr_b16 a[0:1], v7 offset:40960
    buffer_load_dwordx4 v29, s[16:19], s31 offen offset:3072 sc1 lds
    buffer_store_dwordx4 v[196:199], v25, s[4:7], s3 offen offset:1024 sc1
    v_mfma_f32_16x16x32_bf16 v[104:107], a[16:19], a[148:151], v[104:107]
    ds_read_b64_tr_b16 a[2:3], v7 offset:41984
    v_mul_f32 v228, s68, v228
    v_mul_f32 v229, s68, v229
    v_mfma_f32_16x16x32_bf16 v[120:123], a[20:23], a[148:151], v[120:123]
    ds_read_b64_tr_b16 a[4:5], v8 offset:40960
    s_add_u32 s31, s31, 114688
    v_mul_f32 v230, s68, v230
    v_mfma_f32_16x16x32_bf16 v[112:115], a[20:23], a[144:147], v[112:115]
    ds_read_b64_tr_b16 a[6:7], v8 offset:41984
    v_mul_f32 v231, s68, v231
    v_mul_f32 v244, s68, v244
    s_waitcnt lgkmcnt(4)
    v_mfma_f32_16x16x32_bf16 v[160:163], a[24:27], a[144:147], v[160:163]
    ds_read_b64_tr_b16 a[8:9], v9 offset:40960
    v_mul_f32 v245, s68, v245
    v_mul_f32 v246, s68, v246
    v_mfma_f32_16x16x32_bf16 v[168:171], a[24:27], a[148:151], v[168:171]
    ds_read_b64_tr_b16 a[10:11], v9 offset:41984
    s_add_u32 m0, s30, 0
    v_mul_f32 v247, s68, v247
    v_mfma_f32_16x16x32_bf16 v[184:187], a[28:31], a[148:151], v[184:187]
    ds_read_b64_tr_b16 a[12:13], v10 offset:40960
    v_cvt_pk_bf16_f32 v228, v228, v229
    v_cvt_pk_bf16_f32 v229, v230, v231
    v_mfma_f32_16x16x32_bf16 v[176:179], a[28:31], a[144:147], v[176:179]
    ds_read_b64_tr_b16 a[14:15], v10 offset:41984
    v_cvt_pk_bf16_f32 v230, v244, v245
    v_cvt_pk_bf16_f32 v231, v246, v247
    s_waitcnt lgkmcnt(4)
    v_mfma_f32_16x16x32_bf16 v[192:195], a[0:3], a[144:147], v[192:195]
    ds_read_b64_tr_b16 a[16:17], v5 offset:49152
    buffer_load_dwordx4 v26, s[16:19], s31 offen offset:0 sc1 lds
    buffer_store_dwordx4 v[228:231], v25, s[4:7], s3 offen offset:2048 sc1
    v_mfma_f32_16x16x32_bf16 v[200:203], a[0:3], a[148:151], v[200:203]
    ds_read_b64_tr_b16 a[18:19], v5 offset:50176
    buffer_load_dwordx4 v27, s[16:19], s31 offen offset:1024 sc1 lds
    v_accvgpr_read_b32 v52, a224
    v_mfma_f32_16x16x32_bf16 v[216:219], a[4:7], a[148:151], v[216:219]
    ds_read_b64_tr_b16 a[20:21], v6 offset:49152
    v_accvgpr_read_b32 v53, a225
    v_accvgpr_read_b32 v54, a226
    v_mfma_f32_16x16x32_bf16 v[208:211], a[4:7], a[144:147], v[208:211]
    ds_read_b64_tr_b16 a[22:23], v6 offset:50176
    v_accvgpr_read_b32 v55, a227
    v_mul_f32 v52, s68, v52
    s_waitcnt lgkmcnt(4)
    v_mfma_f32_16x16x32_bf16 v[224:227], a[8:11], a[144:147], v[224:227]
    ds_read_b64_tr_b16 a[24:25], v7 offset:49152
    buffer_load_dwordx4 v28, s[16:19], s31 offen offset:2048 sc1 lds
    v_mul_f32 v53, s68, v53
    v_mfma_f32_16x16x32_bf16 v[232:235], a[8:11], a[148:151], v[232:235]
    ds_read_b64_tr_b16 a[26:27], v7 offset:50176
    buffer_load_dwordx4 v29, s[16:19], s31 offen offset:3072 sc1 lds
    v_mul_f32 v54, s68, v54
    v_mfma_f32_16x16x32_bf16 v[248:251], a[12:15], a[148:151], v[248:251]
    ds_read_b64_tr_b16 a[28:29], v8 offset:49152
    v_mul_f32 v55, s68, v55
    v_accvgpr_read_b32 v84, a232
    v_mfma_f32_16x16x32_bf16 v[240:243], a[12:15], a[144:147], v[240:243]
    ds_read_b64_tr_b16 a[30:31], v8 offset:50176
    v_accvgpr_read_b32 v85, a233
    v_accvgpr_read_b32 v86, a234
    s_waitcnt lgkmcnt(4)
    v_mfma_f32_16x16x32_bf16 v[32:35], a[16:19], a[152:155], v[32:35]
    ds_read_b64_tr_b16 a[0:1], v9 offset:49152
    s_add_u32 s31, s31, 114688
    v_accvgpr_read_b32 v87, a235
    v_mfma_f32_16x16x32_bf16 v[40:43], a[16:19], a[156:159], v[40:43]
    ds_read_b64_tr_b16 a[2:3], v9 offset:50176
    v_mul_f32 v84, s68, v84
    v_mul_f32 v85, s68, v85
    v_mfma_f32_16x16x32_bf16 v[56:59], a[20:23], a[156:159], v[56:59]
    ds_read_b64_tr_b16 a[4:5], v10 offset:49152
    v_mul_f32 v86, s68, v86
    v_mul_f32 v87, s68, v87
    v_mfma_f32_16x16x32_bf16 v[48:51], a[20:23], a[152:155], v[48:51]
    ds_read_b64_tr_b16 a[6:7], v10 offset:50176
    v_cvt_pk_bf16_f32 v52, v52, v53
    v_cvt_pk_bf16_f32 v53, v54, v55
    s_waitcnt lgkmcnt(4)
    v_mfma_f32_16x16x32_bf16 v[64:67], a[24:27], a[152:155], v[64:67]
    ds_read_b64_tr_b16 a[8:9], v5 offset:57344
    v_cvt_pk_bf16_f32 v54, v84, v85
    v_cvt_pk_bf16_f32 v55, v86, v87
    v_mfma_f32_16x16x32_bf16 v[72:75], a[24:27], a[156:159], v[72:75]
    ds_read_b64_tr_b16 a[10:11], v5 offset:58368
    buffer_store_dwordx4 v[52:55], v25, s[4:7], s3 offen offset:3072 sc1
    v_mul_f32 v44, s68, v44
    v_mfma_f32_16x16x32_bf16 v[88:91], a[28:31], a[156:159], v[88:91]
    ds_read_b64_tr_b16 a[12:13], v6 offset:57344
    v_mul_f32 v45, s68, v45
    v_mul_f32 v46, s68, v46
    v_mfma_f32_16x16x32_bf16 v[80:83], a[28:31], a[152:155], v[80:83]
    ds_read_b64_tr_b16 a[14:15], v6 offset:58368
    v_mul_f32 v47, s68, v47
    v_mul_f32 v60, s68, v60
    s_waitcnt lgkmcnt(4)
    v_mfma_f32_16x16x32_bf16 v[96:99], a[0:3], a[152:155], v[96:99]
    ds_read_b64_tr_b16 a[16:17], v7 offset:57344
    v_mul_f32 v61, s68, v61
    v_mul_f32 v62, s68, v62
    v_mfma_f32_16x16x32_bf16 v[104:107], a[0:3], a[156:159], v[104:107]
    ds_read_b64_tr_b16 a[18:19], v7 offset:58368
    v_mul_f32 v63, s68, v63
    v_cvt_pk_bf16_f32 v44, v44, v45
    v_mfma_f32_16x16x32_bf16 v[120:123], a[4:7], a[156:159], v[120:123]
    ds_read_b64_tr_b16 a[20:21], v8 offset:57344
    v_cvt_pk_bf16_f32 v45, v46, v47
    v_cvt_pk_bf16_f32 v46, v60, v61
    v_mfma_f32_16x16x32_bf16 v[112:115], a[4:7], a[152:155], v[112:115]
    ds_read_b64_tr_b16 a[22:23], v8 offset:58368
    v_cvt_pk_bf16_f32 v47, v62, v63
    s_add_u32 s3, s70, 8192
    s_waitcnt lgkmcnt(4)
    v_mfma_f32_16x16x32_bf16 v[160:163], a[8:11], a[152:155], v[160:163]
    ds_read_b64_tr_b16 a[24:25], v9 offset:57344
    buffer_store_dwordx4 v[44:47], v25, s[4:7], s3 offen offset:0 sc1
    v_mul_f32 v76, s68, v76
    v_mfma_f32_16x16x32_bf16 v[168:171], a[8:11], a[156:159], v[168:171]
    ds_read_b64_tr_b16 a[26:27], v9 offset:58368
    v_mul_f32 v77, s68, v77
    v_mul_f32 v78, s68, v78
    v_mfma_f32_16x16x32_bf16 v[184:187], a[12:15], a[156:159], v[184:187]
    ds_read_b64_tr_b16 a[28:29], v10 offset:57344
    v_mul_f32 v79, s68, v79
    v_mul_f32 v92, s68, v92
    v_mfma_f32_16x16x32_bf16 v[176:179], a[12:15], a[152:155], v[176:179]
    ds_read_b64_tr_b16 a[30:31], v10 offset:58368
    s_waitcnt vmcnt(17)
    s_barrier
    s_waitcnt lgkmcnt(4)
    v_mfma_f32_16x16x32_bf16 v[192:195], a[16:19], a[152:155], v[192:195]
    ds_read_b64_tr_b16 a[0:1], v13 offset:0
    v_mul_f32 v93, s68, v93
    v_mul_f32 v94, s68, v94
    v_mfma_f32_16x16x32_bf16 v[200:203], a[16:19], a[156:159], v[200:203]
    ds_read_b64_tr_b16 a[2:3], v13 offset:1024
    v_mul_f32 v95, s68, v95
    v_cvt_pk_bf16_f32 v76, v76, v77
    v_mfma_f32_16x16x32_bf16 v[216:219], a[20:23], a[156:159], v[216:219]
    ds_read_b64_tr_b16 a[4:5], v14 offset:0
    v_cvt_pk_bf16_f32 v77, v78, v79
    v_cvt_pk_bf16_f32 v78, v92, v93
    v_mfma_f32_16x16x32_bf16 v[208:211], a[20:23], a[152:155], v[208:211]
    ds_read_b64_tr_b16 a[6:7], v14 offset:1024
    v_cvt_pk_bf16_f32 v79, v94, v95
    buffer_store_dwordx4 v[76:79], v25, s[4:7], s3 offen offset:1024 sc1
    s_waitcnt lgkmcnt(4)
    v_mfma_f32_16x16x32_bf16 v[224:227], a[24:27], a[152:155], v[224:227]
    ds_read_b64_tr_b16 a[8:9], v15 offset:0
    v_mul_f32 v108, s68, v108
    v_mul_f32 v109, s68, v109
    v_mfma_f32_16x16x32_bf16 v[232:235], a[24:27], a[156:159], v[232:235]
    ds_read_b64_tr_b16 a[10:11], v15 offset:1024
    v_mul_f32 v110, s68, v110
    v_mul_f32 v111, s68, v111
    v_mfma_f32_16x16x32_bf16 v[248:251], a[28:31], a[156:159], v[248:251]
    ds_read_b64_tr_b16 a[12:13], v16 offset:0
    v_mul_f32 v124, s68, v124
    v_mul_f32 v125, s68, v125
    v_mfma_f32_16x16x32_bf16 v[240:243], a[28:31], a[152:155], v[240:243]
    ds_read_b64_tr_b16 a[14:15], v16 offset:1024
    v_mul_f32 v126, s68, v126
    v_mul_f32 v127, s68, v127
    v_cvt_pk_bf16_f32 v108, v108, v109
    v_cvt_pk_bf16_f32 v109, v110, v111
    v_cvt_pk_bf16_f32 v110, v124, v125
    v_cvt_pk_bf16_f32 v111, v126, v127
    buffer_store_dwordx4 v[108:111], v25, s[4:7], s3 offen offset:2048 sc1
    s_mov_b32 s98, 0
spin_15:
    s_waitcnt vmcnt(17)
    v_readfirstlane_b32 s99, v31
    s_nop 0
    s_cmp_ge_u32 s99, 256
    s_cbranch_scc1 ok_16
    s_add_u32 s98, s98, 1
    s_cmp_gt_u32 s98, 0x80000
    s_cbranch_scc1 ok_16
    s_sleep 8
    buffer_load_dword v31, off, s[60:63], 0 sc1
    s_waitcnt vmcnt(0)
    s_branch spin_15
ok_16:
    s_cmp_eq_u32 s20, 0
    s_cbranch_scc0 sig_17
    v_mov_b32 v2, 1
    v_mov_b32 v3, 0
    s_mov_b64 exec, 1
    buffer_atomic_add v2, v3, s[4:7], s72 offen sc1
    s_mov_b64 exec, -1
sig_17:
    s_waitcnt lgkmcnt(4)
    v_mfma_f32_16x16x32_bf16 v[32:35], a[0:3], a[160:163], v[32:35]
    ds_read_b64_tr_b16 a[16:17], v21 offset:0
    s_add_u32 m0, s30, 16384
    v_mul_f32 v140, s68, v140
    v_mfma_f32_16x16x32_bf16 v[40:43], a[0:3], a[164:167], v[40:43]
    ds_read_b64_tr_b16 a[18:19], v21 offset:1024
    v_mul_f32 v141, s68, v141
    v_mul_f32 v142, s68, v142
    v_mfma_f32_16x16x32_bf16 v[56:59], a[4:7], a[164:167], v[56:59]
    ds_read_b64_tr_b16 a[20:21], v22 offset:0
    buffer_load_dwordx4 v26, s[16:19], s31 offen offset:0 sc1 lds
    v_mul_f32 v143, s68, v143
    v_mfma_f32_16x16x32_bf16 v[48:51], a[4:7], a[160:163], v[48:51]
    ds_read_b64_tr_b16 a[22:23], v22 offset:1024
    v_mul_f32 v156, s68, v156
    v_mul_f32 v157, s68, v157
    s_waitcnt lgkmcnt(4)
    v_mfma_f32_16x16x32_bf16 v[64:67], a[8:11], a[160:163], v[64:67]
    ds_read_b64_tr_b16 a[24:25], v13 offset:8192
    buffer_load_dwordx4 v27, s[16:19], s31 offen offset:1024 sc1 lds
    v_mul_f32 v158, s68, v158
    v_mfma_f32_16x16x32_bf16 v[72:75], a[8:11], a[164:167], v[72:75]
    ds_read_b64_tr_b16 a[26:27], v13 offset:9216
    v_mul_f32 v159, s68, v159
    v_cvt_pk_bf16_f32 v140, v140, v141
    v_mfma_f32_16x16x32_bf16 v[88:91], a[12:15], a[164:167], v[88:91]
    ds_read_b64_tr_b16 a[28:29], v14 offset:8192
    buffer_load_dwordx4 v28, s[16:19], s31 offen offset:2048 sc1 lds
    v_cvt_pk_bf16_f32 v141, v142, v143
    v_mfma_f32_16x16x32_bf16 v[80:83], a[12:15], a[160:163], v[80:83]
    ds_read_b64_tr_b16 a[30:31], v14 offset:9216
    v_cvt_pk_bf16_f32 v142, v156, v157
    v_cvt_pk_bf16_f32 v143, v158, v159
    s_waitcnt lgkmcnt(4)
    v_mfma_f32_16x16x32_bf16 v[96:99], a[16:19], a[160:163], v[96:99]
    ds_read_b64_tr_b16 a[0:1], v15 offset:8192
    buffer_load_dwordx4 v29, s[16:19], s31 offen offset:3072 sc1 lds
    buffer_store_dwordx4 v[140:143], v25, s[4:7], s3 offen offset:3072 sc1
    v_mfma_f32_16x16x32_bf16 v[104:107], a[16:19], a[164:167], v[104:107]
    ds_read_b64_tr_b16 a[2:3], v15 offset:9216
    v_mul_f32 v172, s68, v172
    v_mul_f32 v173, s68, v173
    v_mfma_f32_16x16x32_bf16 v[120:123], a[20:23], a[164:167], v[120:123]
    ds_read_b64_tr_b16 a[4:5], v16 offset:8192
    s_add_u32 s31, s31, 114688
    v_mul_f32 v174, s68, v174
    v_mfma_f32_16x16x32_bf16 v[112:115], a[20:23], a[160:163], v[112:115]
    ds_read_b64_tr_b16 a[6:7], v16 offset:9216
    v_mul_f32 v175, s68, v175
    v_mul_f32 v188, s68, v188
    s_waitcnt lgkmcnt(4)
    v_mfma_f32_16x16x32_bf16 v[160:163], a[24:27], a[160:163], v[160:163]
    ds_read_b64_tr_b16 a[8:9], v21 offset:8192
    v_mul_f32 v189, s68, v189
    v_mul_f32 v190, s68, v190
    v_mfma_f32_16x16x32_bf16 v[168:171], a[24:27], a[164:167], v[168:171]
    ds_read_b64_tr_b16 a[10:11], v21 offset:9216
    s_add_u32 m0, s30, 32768
    v_mul_f32 v191, s68, v191
    v_mfma_f32_16x16x32_bf16 v[184:187], a[28:31], a[164:167], v[184:187]
    ds_read_b64_tr_b16 a[12:13], v22 offset:8192
    v_cvt_pk_bf16_f32 v172, v172, v173
    v_cvt_pk_bf16_f32 v173, v174, v175
    v_mfma_f32_16x16x32_bf16 v[176:179], a[28:31], a[160:163], v[176:179]
    ds_read_b64_tr_b16 a[14:15], v22 offset:9216
    v_cvt_pk_bf16_f32 v174, v188, v189
    v_cvt_pk_bf16_f32 v175, v190, v191
    s_waitcnt lgkmcnt(4)
    v_mfma_f32_16x16x32_bf16 v[192:195], a[0:3], a[160:163], v[192:195]
    ds_read_b64_tr_b16 a[16:17], v13 offset:16384
    buffer_load_dwordx4 v26, s[16:19], s31 offen offset:0 sc1 lds
    s_add_u32 s3, s70, 12288
    v_mfma_f32_16x16x32_bf16 v[200:203], a[0:3], a[164:167], v[200:203]
    ds_read_b64_tr_b16 a[18:19], v13 offset:17408
    buffer_load_dwordx4 v27, s[16:19], s31 offen offset:1024 sc1 lds
    buffer_store_dwordx4 v[172:175], v25, s[4:7], s3 offen offset:0 sc1
    v_mfma_f32_16x16x32_bf16 v[216:219], a[4:7], a[164:167], v[216:219]
    ds_read_b64_tr_b16 a[20:21], v14 offset:16384
    v_mul_f32 v204, s68, v204
    v_mul_f32 v205, s68, v205
    v_mfma_f32_16x16x32_bf16 v[208:211], a[4:7], a[160:163], v[208:211]
    ds_read_b64_tr_b16 a[22:23], v14 offset:17408
    v_mul_f32 v206, s68, v206
    v_mul_f32 v207, s68, v207
    s_waitcnt lgkmcnt(4)
    v_mfma_f32_16x16x32_bf16 v[224:227], a[8:11], a[160:163], v[224:227]
    ds_read_b64_tr_b16 a[24:25], v15 offset:16384
    buffer_load_dwordx4 v28, s[16:19], s31 offen offset:2048 sc1 lds
    v_mul_f32 v220, s68, v220
    v_mfma_f32_16x16x32_bf16 v[232:235], a[8:11], a[164:167], v[232:235]
    ds_read_b64_tr_b16 a[26:27], v15 offset:17408
    buffer_load_dwordx4 v29, s[16:19], s31 offen offset:3072 sc1 lds
    v_mul_f32 v221, s68, v221
    v_mfma_f32_16x16x32_bf16 v[248:251], a[12:15], a[164:167], v[248:251]
    ds_read_b64_tr_b16 a[28:29], v16 offset:16384
    v_mul_f32 v222, s68, v222
    v_mul_f32 v223, s68, v223
    v_mfma_f32_16x16x32_bf16 v[240:243], a[12:15], a[160:163], v[240:243]
    ds_read_b64_tr_b16 a[30:31], v16 offset:17408
    v_cvt_pk_bf16_f32 v204, v204, v205
    v_cvt_pk_bf16_f32 v205, v206, v207
    s_waitcnt lgkmcnt(4)
    v_mfma_f32_16x16x32_bf16 v[32:35], a[16:19], a[168:171], v[32:35]
    ds_read_b64_tr_b16 a[0:1], v21 offset:16384
    s_add_u32 s31, s31, 114688
    v_cvt_pk_bf16_f32 v206, v220, v221
    v_mfma_f32_16x16x32_bf16 v[40:43], a[16:19], a[172:175], v[40:43]
    ds_read_b64_tr_b16 a[2:3], v21 offset:17408
    v_cvt_pk_bf16_f32 v207, v222, v223
    buffer_store_dwordx4 v[204:207], v25, s[4:7], s3 offen offset:1024 sc1
    v_mfma_f32_16x16x32_bf16 v[56:59], a[20:23], a[172:175], v[56:59]
    ds_read_b64_tr_b16 a[4:5], v22 offset:16384
    v_mul_f32 v236, s68, v236
    v_mul_f32 v237, s68, v237
    v_mfma_f32_16x16x32_bf16 v[48:51], a[20:23], a[168:171], v[48:51]
    ds_read_b64_tr_b16 a[6:7], v22 offset:17408
    v_mul_f32 v238, s68, v238
    v_mul_f32 v239, s68, v239
    s_waitcnt lgkmcnt(4)
    v_mfma_f32_16x16x32_bf16 v[64:67], a[24:27], a[168:171], v[64:67]
    ds_read_b64_tr_b16 a[8:9], v13 offset:24576
    v_mul_f32 v252, s68, v252
    v_mfma_f32_16x16x32_bf16 v[72:75], a[24:27], a[172:175], v[72:75]
    ds_read_b64_tr_b16 a[10:11], v13 offset:25600
    v_mul_f32 v253, s68, v253
    v_mul_f32 v254, s68, v254
    v_mfma_f32_16x16x32_bf16 v[88:91], a[28:31], a[172:175], v[88:91]
    ds_read_b64_tr_b16 a[12:13], v14 offset:24576
    v_mul_f32 v255, s68, v255
    v_mfma_f32_16x16x32_bf16 v[80:83], a[28:31], a[168:171], v[80:83]
    ds_read_b64_tr_b16 a[14:15], v14 offset:25600
    v_cvt_pk_bf16_f32 v236, v236, v237
    v_cvt_pk_bf16_f32 v237, v238, v239
    s_waitcnt lgkmcnt(4)
    v_mfma_f32_16x16x32_bf16 v[96:99], a[0:3], a[168:171], v[96:99]
    ds_read_b64_tr_b16 a[16:17], v15 offset:24576
    v_cvt_pk_bf16_f32 v238, v252, v253
    v_mfma_f32_16x16x32_bf16 v[104:107], a[0:3], a[172:175], v[104:107]
    ds_read_b64_tr_b16 a[18:19], v15 offset:25600
    v_cvt_pk_bf16_f32 v239, v254, v255
    buffer_store_dwordx4 v[236:239], v25, s[4:7], s3 offen offset:2048 sc1
    v_mfma_f32_16x16x32_bf16 v[120:123], a[4:7], a[172:175], v[120:123]
    ds_read_b64_tr_b16 a[20:21], v16 offset:24576
    v_accvgpr_read_b32 v60, a228
    v_mfma_f32_16x16x32_bf16 v[112:115], a[4:7], a[168:171], v[112:115]
    ds_read_b64_tr_b16 a[22:23], v16 offset:25600
    v_accvgpr_read_b32 v61, a229
    v_accvgpr_read_b32 v62, a230
    s_waitcnt lgkmcnt(4)
    v_mfma_f32_16x16x32_bf16 v[160:163], a[8:11], a[168:171], v[160:163]
    ds_read_b64_tr_b16 a[24:25], v21 offset:24576
    v_accvgpr_read_b32 v63, a231
    v_mul_f32 v60, s68, v60
    v_mfma_f32_16x16x32_bf16 v[168:171], a[8:11], a[172:175], v[168:171]
    ds_read_b64_tr_b16 a[26:27], v21 offset:25600
    v_mul_f32 v61, s68, v61
    v_mfma_f32_16x16x32_bf16 v[184:187], a[12:15], a[172:175], v[184:187]
    ds_read_b64_tr_b16 a[28:29], v22 offset:24576
    v_mul_f32 v62, s68, v62
    v_mul_f32 v63, s68, v63
    s_lshl_b32 s28, s20, 12
    v_add_u32 v30, s28, v25
    s_add_u32 s28, s28, 98304
    s_sub_u32 s97, 15, s22
    s_max_u32 s97, s97, s22
    s_lshl_b32 s97, s97, 2
    s_sub_u32 s8, s97, 30
    s_cmp_lt_i32 s8, 4
    s_cselect_b32 s8, 0, s8
    v_mfma_f32_16x16x32_bf16 v[176:179], a[12:15], a[168:171], v[176:179]
    ds_read_b64_tr_b16 a[30:31], v22 offset:25600
    s_waitcnt vmcnt(16)
    s_barrier
    s_waitcnt lgkmcnt(4)
    v_mfma_f32_16x16x32_bf16 v[192:195], a[16:19], a[168:171], v[192:195]
    ds_read_b64_tr_b16 a[0:1], v13 offset:32768
    v_accvgpr_read_b32 v92, a236
    v_accvgpr_read_b32 v93, a237
    v_mfma_f32_16x16x32_bf16 v[200:203], a[16:19], a[172:175], v[200:203]
    ds_read_b64_tr_b16 a[2:3], v13 offset:33792
    v_accvgpr_read_b32 v94, a238
    v_accvgpr_read_b32 v95, a239
    v_mfma_f32_16x16x32_bf16 v[216:219], a[20:23], a[172:175], v[216:219]
    ds_read_b64_tr_b16 a[4:5], v14 offset:32768
    v_mul_f32 v92, s68, v92
    v_mul_f32 v93, s68, v93
    v_mfma_f32_16x16x32_bf16 v[208:211], a[20:23], a[168:171], v[208:211]
    ds_read_b64_tr_b16 a[6:7], v14 offset:33792
    v_mul_f32 v94, s68, v94
    s_waitcnt lgkmcnt(4)
    v_mfma_f32_16x16x32_bf16 v[224:227], a[24:27], a[168:171], v[224:227]
    ds_read_b64_tr_b16 a[8:9], v15 offset:32768
    v_mul_f32 v95, s68, v95
    v_cvt_pk_bf16_f32 v60, v60, v61
    v_mfma_f32_16x16x32_bf16 v[232:235], a[24:27], a[172:175], v[232:235]
    ds_read_b64_tr_b16 a[10:11], v15 offset:33792
    v_cvt_pk_bf16_f32 v61, v62, v63
    v_mfma_f32_16x16x32_bf16 v[248:251], a[28:31], a[172:175], v[248:251]
    ds_read_b64_tr_b16 a[12:13], v16 offset:32768
    v_cvt_pk_bf16_f32 v62, v92, v93
    v_cvt_pk_bf16_f32 v63, v94, v95
    v_mfma_f32_16x16x32_bf16 v[240:243], a[28:31], a[168:171], v[240:243]
    ds_read_b64_tr_b16 a[14:15], v16 offset:33792
    buffer_store_dwordx4 v[60:63], v25, s[4:7], s3 offen offset:3072 sc1
    s_waitcnt lgkmcnt(4)
    v_mfma_f32_16x16x32_bf16 v[32:35], a[0:3], a[176:179], v[32:35]
    ds_read_b64_tr_b16 a[16:17], v21 offset:32768
    s_add_u32 m0, s30, 49152
    v_mfma_f32_16x16x32_bf16 v[40:43], a[0:3], a[180:183], v[40:43]
    ds_read_b64_tr_b16 a[18:19], v21 offset:33792
    v_accvgpr_write_b32 a32, v36
    v_mfma_f32_16x16x32_bf16 v[56:59], a[4:7], a[180:183], v[56:59]
    ds_read_b64_tr_b16 a[20:21], v22 offset:32768
    buffer_load_dwordx4 v26, s[16:19], s31 offen offset:0 sc1 lds
    v_mfma_f32_16x16x32_bf16 v[48:51], a[4:7], a[176:179], v[48:51]
    ds_read_b64_tr_b16 a[22:23], v22 offset:33792
    s_waitcnt lgkmcnt(4)
    v_mfma_f32_16x16x32_bf16 v[64:67], a[8:11], a[176:179], v[64:67]
    ds_read_b64_tr_b16 a[24:25], v13 offset:40960
    buffer_load_dwordx4 v27, s[16:19], s31 offen offset:1024 sc1 lds
    v_mfma_f32_16x16x32_bf16 v[72:75], a[8:11], a[180:183], v[72:75]
    ds_read_b64_tr_b16 a[26:27], v13 offset:41984
    v_accvgpr_write_b32 a33, v37
    v_mfma_f32_16x16x32_bf16 v[88:91], a[12:15], a[180:183], v[88:91]
    ds_read_b64_tr_b16 a[28:29], v14 offset:40960
    buffer_load_dwordx4 v28, s[16:19], s31 offen offset:2048 sc1 lds
    v_mfma_f32_16x16x32_bf16 v[80:83], a[12:15], a[176:179], v[80:83]
    ds_read_b64_tr_b16 a[30:31], v14 offset:41984
    s_waitcnt lgkmcnt(4)
    v_mfma_f32_16x16x32_bf16 v[96:99], a[16:19], a[176:179], v[96:99]
    ds_read_b64_tr_b16 a[0:1], v15 offset:40960
    buffer_load_dwordx4 v29, s[16:19], s31 offen offset:3072 sc1 lds
    v_mfma_f32_16x16x32_bf16 v[104:107], a[16:19], a[180:183], v[104:107]
    ds_read_b64_tr_b16 a[2:3], v15 offset:41984
    v_accvgpr_write_b32 a34, v38
    v_mfma_f32_16x16x32_bf16 v[120:123], a[20:23], a[180:183], v[120:123]
    ds_read_b64_tr_b16 a[4:5], v16 offset:40960
    s_add_u32 s31, s31, 114688
    v_mfma_f32_16x16x32_bf16 v[112:115], a[20:23], a[176:179], v[112:115]
    ds_read_b64_tr_b16 a[6:7], v16 offset:41984
    s_waitcnt lgkmcnt(4)
    v_mfma_f32_16x16x32_bf16 v[160:163], a[24:27], a[176:179], v[160:163]
    ds_read_b64_tr_b16 a[8:9], v21 offset:40960
    v_accvgpr_write_b32 a35, v39
    v_mfma_f32_16x16x32_bf16 v[168:171], a[24:27], a[180:183], v[168:171]
    ds_read_b64_tr_b16 a[10:11], v21 offset:41984
    s_add_u32 m0, s30, 65536
    v_mfma_f32_16x16x32_bf16 v[184:187], a[28:31], a[180:183], v[184:187]
    ds_read_b64_tr_b16 a[12:13], v22 offset:40960
    v_accvgpr_write_b32 a36, v68
    v_mfma_f32_16x16x32_bf16 v[176:179], a[28:31], a[176:179], v[176:179]
    ds_read_b64_tr_b16 a[14:15], v22 offset:41984
    s_waitcnt lgkmcnt(4)
    v_mfma_f32_16x16x32_bf16 v[192:195], a[0:3], a[176:179], v[192:195]
    ds_read_b64_tr_b16 a[16:17], v5 offset:0
    buffer_load_dwordx4 v26, s[16:19], s31 offen offset:0 sc1 lds
    v_mfma_f32_16x16x32_bf16 v[200:203], a[0:3], a[180:183], v[200:203]
    ds_read_b64_tr_b16 a[18:19], v5 offset:1024
    buffer_load_dwordx4 v27, s[16:19], s31 offen offset:1024 sc1 lds
    v_mfma_f32_16x16x32_bf16 v[216:219], a[4:7], a[180:183], v[216:219]
    ds_read_b64_tr_b16 a[20:21], v6 offset:0
    v_accvgpr_write_b32 a37, v69
    v_mfma_f32_16x16x32_bf16 v[208:211], a[4:7], a[176:179], v[208:211]
    ds_read_b64_tr_b16 a[22:23], v6 offset:1024
    s_waitcnt lgkmcnt(4)
    v_mfma_f32_16x16x32_bf16 v[224:227], a[8:11], a[176:179], v[224:227]
    ds_read_b64_tr_b16 a[24:25], v7 offset:0
    buffer_load_dwordx4 v28, s[16:19], s31 offen offset:2048 sc1 lds
    v_mfma_f32_16x16x32_bf16 v[232:235], a[8:11], a[180:183], v[232:235]
    ds_read_b64_tr_b16 a[26:27], v7 offset:1024
    buffer_load_dwordx4 v29, s[16:19], s31 offen offset:3072 sc1 lds
    v_mfma_f32_16x16x32_bf16 v[248:251], a[12:15], a[180:183], v[248:251]
    ds_read_b64_tr_b16 a[28:29], v8 offset:0
    v_accvgpr_write_b32 a38, v70
    v_mfma_f32_16x16x32_bf16 v[240:243], a[12:15], a[176:179], v[240:243]
    ds_read_b64_tr_b16 a[30:31], v8 offset:1024
    s_waitcnt lgkmcnt(4)
    v_mfma_f32_16x16x32_bf16 v[32:35], a[16:19], a[184:187], v[32:35]
    ds_read_b64_tr_b16 a[0:1], v9 offset:0
    s_add_u32 s31, s31, 114688
    v_mfma_f32_16x16x32_bf16 v[40:43], a[16:19], a[188:191], v[40:43]
    ds_read_b64_tr_b16 a[2:3], v9 offset:1024
    v_accvgpr_write_b32 a39, v71
    v_mfma_f32_16x16x32_bf16 v[56:59], a[20:23], a[188:191], v[56:59]
    ds_read_b64_tr_b16 a[4:5], v10 offset:0
    v_accvgpr_write_b32 a40, v100
    v_mfma_f32_16x16x32_bf16 v[48:51], a[20:23], a[184:187], v[48:51]
    ds_read_b64_tr_b16 a[6:7], v10 offset:1024
    s_waitcnt lgkmcnt(4)
    v_mfma_f32_16x16x32_bf16 v[64:67], a[24:27], a[184:187], v[64:67]
    ds_read_b64_tr_b16 a[8:9], v5 offset:8192
    v_accvgpr_write_b32 a41, v101
    v_mfma_f32_16x16x32_bf16 v[72:75], a[24:27], a[188:191], v[72:75]
    ds_read_b64_tr_b16 a[10:11], v5 offset:9216
    v_accvgpr_write_b32 a42, v102
    v_mfma_f32_16x16x32_bf16 v[88:91], a[28:31], a[188:191], v[88:91]
    ds_read_b64_tr_b16 a[12:13], v6 offset:8192
    v_accvgpr_write_b32 a43, v103
    v_mfma_f32_16x16x32_bf16 v[80:83], a[28:31], a[184:187], v[80:83]
    ds_read_b64_tr_b16 a[14:15], v6 offset:9216
    s_waitcnt lgkmcnt(4)
    v_mfma_f32_16x16x32_bf16 v[96:99], a[0:3], a[184:187], v[96:99]
    ds_read_b64_tr_b16 a[16:17], v7 offset:8192
    v_accvgpr_write_b32 a44, v132
    v_mfma_f32_16x16x32_bf16 v[104:107], a[0:3], a[188:191], v[104:107]
    ds_read_b64_tr_b16 a[18:19], v7 offset:9216
    v_accvgpr_write_b32 a45, v133
    v_mfma_f32_16x16x32_bf16 v[120:123], a[4:7], a[188:191], v[120:123]
    ds_read_b64_tr_b16 a[20:21], v8 offset:8192
    v_accvgpr_write_b32 a46, v134
    v_mfma_f32_16x16x32_bf16 v[112:115], a[4:7], a[184:187], v[112:115]
    ds_read_b64_tr_b16 a[22:23], v8 offset:9216
    s_waitcnt lgkmcnt(4)
    v_mfma_f32_16x16x32_bf16 v[160:163], a[8:11], a[184:187], v[160:163]
    ds_read_b64_tr_b16 a[24:25], v9 offset:8192
    v_accvgpr_write_b32 a47, v135
    v_mfma_f32_16x16x32_bf16 v[168:171], a[8:11], a[188:191], v[168:171]
    ds_read_b64_tr_b16 a[26:27], v9 offset:9216
    v_accvgpr_write_b32 a48, v164
    v_mfma_f32_16x16x32_bf16 v[184:187], a[12:15], a[188:191], v[184:187]
    ds_read_b64_tr_b16 a[28:29], v10 offset:8192
    v_accvgpr_write_b32 a49, v165
    v_and_b32 v2, 15, v1
    v_lshlrev_b32 v2, 2, v2
    s_lshl_b32 s97, s22, 2
    s_add_u32 s97, s97, s20
    s_lshl_b32 s97, s97, 7
    s_add_u32 s97, s97, 75497472
    buffer_load_dword a228, v2, s[4:7], s97 offen offset:0 sc1
    buffer_load_dword a229, v2, s[4:7], s97 offen offset:64 sc1
    v_mfma_f32_16x16x32_bf16 v[176:179], a[12:15], a[184:187], v[176:179]
    ds_read_b64_tr_b16 a[30:31], v10 offset:9216
    s_waitcnt vmcnt(10)
    s_barrier
    s_waitcnt lgkmcnt(4)
    v_mfma_f32_16x16x32_bf16 v[192:195], a[16:19], a[184:187], v[192:195]
    ds_read_b64_tr_b16 a[0:1], v5 offset:16384
    v_accvgpr_write_b32 a50, v166
    v_mfma_f32_16x16x32_bf16 v[200:203], a[16:19], a[188:191], v[200:203]
    ds_read_b64_tr_b16 a[2:3], v5 offset:17408
    v_accvgpr_write_b32 a51, v167
    v_mfma_f32_16x16x32_bf16 v[216:219], a[20:23], a[188:191], v[216:219]
    ds_read_b64_tr_b16 a[4:5], v6 offset:16384
    v_mfma_f32_16x16x32_bf16 v[208:211], a[20:23], a[184:187], v[208:211]
    ds_read_b64_tr_b16 a[6:7], v6 offset:17408
    s_waitcnt lgkmcnt(4)
    v_mfma_f32_16x16x32_bf16 v[224:227], a[24:27], a[184:187], v[224:227]
    ds_read_b64_tr_b16 a[8:9], v7 offset:16384
    v_accvgpr_write_b32 a52, v196
    v_mfma_f32_16x16x32_bf16 v[232:235], a[24:27], a[188:191], v[232:235]
    ds_read_b64_tr_b16 a[10:11], v7 offset:17408
    v_accvgpr_write_b32 a53, v197
    v_mfma_f32_16x16x32_bf16 v[248:251], a[28:31], a[188:191], v[248:251]
    ds_read_b64_tr_b16 a[12:13], v8 offset:16384
    v_mfma_f32_16x16x32_bf16 v[240:243], a[28:31], a[184:187], v[240:243]
    ds_read_b64_tr_b16 a[14:15], v8 offset:17408
    s_cmp_eq_u32 s20, 0
    s_cbranch_scc0 sig_18
    s_cmp_ge_u32 s22, 8
    s_cbranch_scc0 sig_18
    v_mov_b32 v2, 1
    v_mov_b32 v3, 0
    s_mov_b64 exec, 1
    buffer_atomic_add v2, v3, s[4:7], s73 offen sc1
    s_mov_b64 exec, -1
sig_18:
    s_waitcnt lgkmcnt(4)
    v_mfma_f32_16x16x32_bf16 v[32:35], a[0:3], a[192:195], v[32:35]
    ds_read_b64_tr_b16 a[16:17], v9 offset:16384
    s_add_u32 m0, s30, 81920
    v_mfma_f32_16x16x32_bf16 v[40:43], a[0:3], a[196:199], v[40:43]
    ds_read_b64_tr_b16 a[18:19], v9 offset:17408
    v_accvgpr_write_b32 a54, v198
    v_mfma_f32_16x16x32_bf16 v[56:59], a[4:7], a[196:199], v[56:59]
    ds_read_b64_tr_b16 a[20:21], v10 offset:16384
    buffer_load_dwordx4 v26, s[16:19], s31 offen offset:0 sc1 lds
    v_mfma_f32_16x16x32_bf16 v[48:51], a[4:7], a[192:195], v[48:51]
    ds_read_b64_tr_b16 a[22:23], v10 offset:17408
    s_waitcnt lgkmcnt(4)
    v_mfma_f32_16x16x32_bf16 v[64:67], a[8:11], a[192:195], v[64:67]
    ds_read_b64_tr_b16 a[24:25], v5 offset:24576
    buffer_load_dwordx4 v27, s[16:19], s31 offen offset:1024 sc1 lds
    v_mfma_f32_16x16x32_bf16 v[72:75], a[8:11], a[196:199], v[72:75]
    ds_read_b64_tr_b16 a[26:27], v5 offset:25600
    v_accvgpr_write_b32 a55, v199
    v_mfma_f32_16x16x32_bf16 v[88:91], a[12:15], a[196:199], v[88:91]
    ds_read_b64_tr_b16 a[28:29], v6 offset:24576
    buffer_load_dwordx4 v28, s[16:19], s31 offen offset:2048 sc1 lds
    v_mfma_f32_16x16x32_bf16 v[80:83], a[12:15], a[192:195], v[80:83]
    ds_read_b64_tr_b16 a[30:31], v6 offset:25600
    s_waitcnt lgkmcnt(4)
    v_mfma_f32_16x16x32_bf16 v[96:99], a[16:19], a[192:195], v[96:99]
    ds_read_b64_tr_b16 a[0:1], v7 offset:24576
    buffer_load_dwordx4 v29, s[16:19], s31 offen offset:3072 sc1 lds
    v_mfma_f32_16x16x32_bf16 v[104:107], a[16:19], a[196:199], v[104:107]
    ds_read_b64_tr_b16 a[2:3], v7 offset:25600
    v_accvgpr_write_b32 a56, v228
    v_mfma_f32_16x16x32_bf16 v[120:123], a[20:23], a[196:199], v[120:123]
    ds_read_b64_tr_b16 a[4:5], v8 offset:24576
    s_add_u32 s31, s31, 114688
    v_mfma_f32_16x16x32_bf16 v[112:115], a[20:23], a[192:195], v[112:115]
    ds_read_b64_tr_b16 a[6:7], v8 offset:25600
    s_waitcnt lgkmcnt(4)
    v_mfma_f32_16x16x32_bf16 v[160:163], a[24:27], a[192:195], v[160:163]
    ds_read_b64_tr_b16 a[8:9], v9 offset:24576
    v_accvgpr_write_b32 a57, v229
    v_mfma_f32_16x16x32_bf16 v[168:171], a[24:27], a[196:199], v[168:171]
    ds_read_b64_tr_b16 a[10:11], v9 offset:25600
    s_add_u32 m0, s30, 98304
    v_mfma_f32_16x16x32_bf16 v[184:187], a[28:31], a[196:199], v[184:187]
    ds_read_b64_tr_b16 a[12:13], v10 offset:24576
    v_accvgpr_write_b32 a58, v230
    v_mfma_f32_16x16x32_bf16 v[176:179], a[28:31], a[192:195], v[176:179]
    ds_read_b64_tr_b16 a[14:15], v10 offset:25600
    s_waitcnt lgkmcnt(4)
    v_mfma_f32_16x16x32_bf16 v[192:195], a[0:3], a[192:195], v[192:195]
    ds_read_b64_tr_b16 a[16:17], v5 offset:32768
    buffer_load_dwordx4 v26, s[16:19], s31 offen offset:0 sc1 lds
    v_mfma_f32_16x16x32_bf16 v[200:203], a[0:3], a[196:199], v[200:203]
    ds_read_b64_tr_b16 a[18:19], v5 offset:33792
    buffer_load_dwordx4 v27, s[16:19], s31 offen offset:1024 sc1 lds
    v_mfma_f32_16x16x32_bf16 v[216:219], a[4:7], a[196:199], v[216:219]
    ds_read_b64_tr_b16 a[20:21], v6 offset:32768
    v_accvgpr_write_b32 a59, v231
    v_mfma_f32_16x16x32_bf16 v[208:211], a[4:7], a[192:195], v[208:211]
    ds_read_b64_tr_b16 a[22:23], v6 offset:33792
    s_waitcnt lgkmcnt(4)
    v_mfma_f32_16x16x32_bf16 v[224:227], a[8:11], a[192:195], v[224:227]
    ds_read_b64_tr_b16 a[24:25], v7 offset:32768
    buffer_load_dwordx4 v28, s[16:19], s31 offen offset:2048 sc1 lds
    v_mfma_f32_16x16x32_bf16 v[232:235], a[8:11], a[196:199], v[232:235]
    ds_read_b64_tr_b16 a[26:27], v7 offset:33792
    buffer_load_dwordx4 v29, s[16:19], s31 offen offset:3072 sc1 lds
    v_mfma_f32_16x16x32_bf16 v[248:251], a[12:15], a[196:199], v[248:251]
    ds_read_b64_tr_b16 a[28:29], v8 offset:32768
    v_accvgpr_write_b32 a60, v52
    v_mfma_f32_16x16x32_bf16 v[240:243], a[12:15], a[192:195], v[240:243]
    ds_read_b64_tr_b16 a[30:31], v8 offset:33792
    s_waitcnt lgkmcnt(4)
    v_mfma_f32_16x16x32_bf16 v[32:35], a[16:19], a[200:203], v[32:35]
    ds_read_b64_tr_b16 a[0:1], v9 offset:32768
    s_add_u32 s31, s31, 114688
    v_mfma_f32_16x16x32_bf16 v[40:43], a[16:19], a[204:207], v[40:43]
    ds_read_b64_tr_b16 a[2:3], v9 offset:33792
    v_accvgpr_write_b32 a61, v53
    v_mfma_f32_16x16x32_bf16 v[56:59], a[20:23], a[204:207], v[56:59]
    ds_read_b64_tr_b16 a[4:5], v10 offset:32768
    v_accvgpr_write_b32 a62, v54
    v_mfma_f32_16x16x32_bf16 v[48:51], a[20:23], a[200:203], v[48:51]
    ds_read_b64_tr_b16 a[6:7], v10 offset:33792
    s_waitcnt lgkmcnt(4)
    v_mfma_f32_16x16x32_bf16 v[64:67], a[24:27], a[200:203], v[64:67]
    ds_read_b64_tr_b16 a[8:9], v5 offset:40960
    v_accvgpr_write_b32 a63, v55
    v_mfma_f32_16x16x32_bf16 v[72:75], a[24:27], a[204:207], v[72:75]
    ds_read_b64_tr_b16 a[10:11], v5 offset:41984
    v_accvgpr_write_b32 a80, v44
    v_mfma_f32_16x16x32_bf16 v[88:91], a[28:31], a[204:207], v[88:91]
    ds_read_b64_tr_b16 a[12:13], v6 offset:40960
    v_accvgpr_write_b32 a81, v45
    v_mfma_f32_16x16x32_bf16 v[80:83], a[28:31], a[200:203], v[80:83]
    ds_read_b64_tr_b16 a[14:15], v6 offset:41984
    s_waitcnt lgkmcnt(4)
    v_mfma_f32_16x16x32_bf16 v[96:99], a[0:3], a[200:203], v[96:99]
    ds_read_b64_tr_b16 a[16:17], v7 offset:40960
    v_accvgpr_write_b32 a82, v46
    v_mfma_f32_16x16x32_bf16 v[104:107], a[0:3], a[204:207], v[104:107]
    ds_read_b64_tr_b16 a[18:19], v7 offset:41984
    v_accvgpr_write_b32 a83, v47
    v_mfma_f32_16x16x32_bf16 v[120:123], a[4:7], a[204:207], v[120:123]
    ds_read_b64_tr_b16 a[20:21], v8 offset:40960
    v_accvgpr_write_b32 a84, v76
    v_mfma_f32_16x16x32_bf16 v[112:115], a[4:7], a[200:203], v[112:115]
    ds_read_b64_tr_b16 a[22:23], v8 offset:41984
    s_waitcnt lgkmcnt(4)
    v_mfma_f32_16x16x32_bf16 v[160:163], a[8:11], a[200:203], v[160:163]
    ds_read_b64_tr_b16 a[24:25], v9 offset:40960
    v_accvgpr_write_b32 a85, v77
    v_mfma_f32_16x16x32_bf16 v[168:171], a[8:11], a[204:207], v[168:171]
    ds_read_b64_tr_b16 a[26:27], v9 offset:41984
    v_accvgpr_write_b32 a86, v78
    v_mfma_f32_16x16x32_bf16 v[184:187], a[12:15], a[204:207], v[184:187]
    ds_read_b64_tr_b16 a[28:29], v10 offset:40960
    v_accvgpr_write_b32 a87, v79
    s_getpc_b64 s[96:97]
pc_19:
    s_add_u32 s96, s96, qf_done-pc_19
    s_addc_u32 s97, s97, 0
    s_lshr_b32 s98, s2, 3
    s_lshl_b32 s98, s98, 8
    v_add_u32 v2, s98, v0
    v_and_b32 v2, 0x1ff, v2
    v_lshlrev_b32 v2, 7, v2
    v_min_u32 v2, kernel_last-qf_done-4, v2
    v_mov_b32 v3, s97
    v_add_co_u32 v2, vcc, s96, v2
    s_nop 1
    v_addc_co_u32 v3, vcc, 0, v3, vcc
    global_load_dword a230, v[2:3], off
    v_mfma_f32_16x16x32_bf16 v[176:179], a[12:15], a[200:203], v[176:179]
    ds_read_b64_tr_b16 a[30:31], v10 offset:41984
    s_waitcnt vmcnt(11)
    s_barrier
    s_waitcnt lgkmcnt(4)
    v_mfma_f32_16x16x32_bf16 v[192:195], a[16:19], a[200:203], v[192:195]
    ds_read_b64_tr_b16 a[0:1], v5 offset:49152
    v_accvgpr_write_b32 a88, v108
    v_mfma_f32_16x16x32_bf16 v[200:203], a[16:19], a[204:207], v[200:203]
    ds_read_b64_tr_b16 a[2:3], v5 offset:50176
    v_accvgpr_write_b32 a89, v109
    v_mfma_f32_16x16x32_bf16 v[216:219], a[20:23], a[204:207], v[216:219]
    ds_read_b64_tr_b16 a[4:5], v6 offset:49152
    v_mfma_f32_16x16x32_bf16 v[208:211], a[20:23], a[200:203], v[208:211]
    ds_read_b64_tr_b16 a[6:7], v6 offset:50176
    s_waitcnt lgkmcnt(4)
    v_mfma_f32_16x16x32_bf16 v[224:227], a[24:27], a[200:203], v[224:227]
    ds_read_b64_tr_b16 a[8:9], v7 offset:49152
    v_accvgpr_write_b32 a90, v110
    v_mfma_f32_16x16x32_bf16 v[232:235], a[24:27], a[204:207], v[232:235]
    ds_read_b64_tr_b16 a[10:11], v7 offset:50176
    v_accvgpr_write_b32 a91, v111
    v_mfma_f32_16x16x32_bf16 v[248:251], a[28:31], a[204:207], v[248:251]
    ds_read_b64_tr_b16 a[12:13], v8 offset:49152
    v_mfma_f32_16x16x32_bf16 v[240:243], a[28:31], a[200:203], v[240:243]
    ds_read_b64_tr_b16 a[14:15], v8 offset:50176
    s_waitcnt lgkmcnt(4)
    v_mfma_f32_16x16x32_bf16 v[32:35], a[0:3], a[208:211], v[32:35]
    ds_read_b64_tr_b16 a[16:17], v9 offset:49152
    v_accvgpr_write_b32 a92, v140
    v_mfma_f32_16x16x32_bf16 v[40:43], a[0:3], a[212:215], v[40:43]
    ds_read_b64_tr_b16 a[18:19], v9 offset:50176
    buffer_load_dword v31, off, s[4:7], s72 sc1
    v_mfma_f32_16x16x32_bf16 v[56:59], a[4:7], a[212:215], v[56:59]
    ds_read_b64_tr_b16 a[20:21], v10 offset:49152
    v_accvgpr_write_b32 a93, v141
    v_mfma_f32_16x16x32_bf16 v[48:51], a[4:7], a[208:211], v[48:51]
    ds_read_b64_tr_b16 a[22:23], v10 offset:50176
    s_waitcnt lgkmcnt(4)
    v_mfma_f32_16x16x32_bf16 v[64:67], a[8:11], a[208:211], v[64:67]
    ds_read_b64_tr_b16 a[24:25], v5 offset:57344
    v_accvgpr_write_b32 a94, v142
    v_mfma_f32_16x16x32_bf16 v[72:75], a[8:11], a[212:215], v[72:75]
    ds_read_b64_tr_b16 a[26:27], v5 offset:58368
    s_lshl_b32 s97, s21, 21
    v_mfma_f32_16x16x32_bf16 v[88:91], a[12:15], a[212:215], v[88:91]
    ds_read_b64_tr_b16 a[28:29], v6 offset:57344
    s_add_u32 s97, s97, 0
    v_mfma_f32_16x16x32_bf16 v[80:83], a[12:15], a[208:211], v[80:83]
    ds_read_b64_tr_b16 a[30:31], v6 offset:58368
    s_waitcnt lgkmcnt(4)
    v_mfma_f32_16x16x32_bf16 v[96:99], a[16:19], a[208:211], v[96:99]
    ds_read_b64_tr_b16 a[0:1], v7 offset:57344
    v_accvgpr_write_b32 a95, v143
    v_mfma_f32_16x16x32_bf16 v[104:107], a[16:19], a[212:215], v[104:107]
    ds_read_b64_tr_b16 a[2:3], v7 offset:58368
    v_accvgpr_write_b32 a96, v172
    v_mfma_f32_16x16x32_bf16 v[120:123], a[20:23], a[212:215], v[120:123]
    ds_read_b64_tr_b16 a[4:5], v8 offset:57344
    s_lshl_b32 s98, s8, 15
    v_mfma_f32_16x16x32_bf16 v[112:115], a[20:23], a[208:211], v[112:115]
    ds_read_b64_tr_b16 a[6:7], v8 offset:58368
    s_waitcnt lgkmcnt(4)
    v_mfma_f32_16x16x32_bf16 v[160:163], a[24:27], a[208:211], v[160:163]
    ds_read_b64_tr_b16 a[8:9], v9 offset:57344
    v_accvgpr_write_b32 a97, v173
    v_mfma_f32_16x16x32_bf16 v[168:171], a[24:27], a[212:215], v[168:171]
    ds_read_b64_tr_b16 a[10:11], v9 offset:58368
    s_add_u32 s98, s98, s97
    v_mfma_f32_16x16x32_bf16 v[184:187], a[28:31], a[212:215], v[184:187]
    ds_read_b64_tr_b16 a[12:13], v10 offset:57344
    v_accvgpr_write_b32 a98, v174
    v_mfma_f32_16x16x32_bf16 v[176:179], a[28:31], a[208:211], v[176:179]
    ds_read_b64_tr_b16 a[14:15], v10 offset:58368
    s_waitcnt lgkmcnt(4)
    v_mfma_f32_16x16x32_bf16 v[192:195], a[0:3], a[208:211], v[192:195]
    ds_read_b64_tr_b16 a[16:17], v13 offset:0
    v_accvgpr_write_b32 a99, v175
    v_mfma_f32_16x16x32_bf16 v[200:203], a[0:3], a[212:215], v[200:203]
    ds_read_b64_tr_b16 a[18:19], v13 offset:1024
    s_add_u32 s99, s22, 1
    v_mfma_f32_16x16x32_bf16 v[216:219], a[4:7], a[212:215], v[216:219]
    ds_read_b64_tr_b16 a[20:21], v14 offset:0
    s_lshl_b32 s99, s99, 17
    v_mfma_f32_16x16x32_bf16 v[208:211], a[4:7], a[208:211], v[208:211]
    ds_read_b64_tr_b16 a[22:23], v14 offset:1024
    s_waitcnt lgkmcnt(4)
    v_mfma_f32_16x16x32_bf16 v[224:227], a[8:11], a[208:211], v[224:227]
    ds_read_b64_tr_b16 a[24:25], v15 offset:0
    v_accvgpr_write_b32 a100, v204
    v_mfma_f32_16x16x32_bf16 v[232:235], a[8:11], a[212:215], v[232:235]
    ds_read_b64_tr_b16 a[26:27], v15 offset:1024
    v_accvgpr_write_b32 a101, v205
    v_mfma_f32_16x16x32_bf16 v[248:251], a[12:15], a[212:215], v[248:251]
    ds_read_b64_tr_b16 a[28:29], v16 offset:0
    s_add_u32 s99, s99, s97
    v_mfma_f32_16x16x32_bf16 v[240:243], a[12:15], a[208:211], v[240:243]
    ds_read_b64_tr_b16 a[30:31], v16 offset:1024
    s_waitcnt lgkmcnt(4)
    v_mfma_f32_16x16x32_bf16 v[32:35], a[16:19], a[216:219], v[32:35]
    ds_read_b64_tr_b16 a[0:1], v21 offset:0
    v_accvgpr_write_b32 a102, v206
    v_mfma_f32_16x16x32_bf16 v[40:43], a[16:19], a[220:223], v[40:43]
    ds_read_b64_tr_b16 a[2:3], v21 offset:1024
    s_cmp_ge_u32 s22, 8
    s_cselect_b32 s24, s98, s97
    s_cselect_b32 s13, 0, s8
    v_mfma_f32_16x16x32_bf16 v[56:59], a[20:23], a[220:223], v[56:59]
    ds_read_b64_tr_b16 a[4:5], v22 offset:0
    v_accvgpr_write_b32 a103, v207
    v_mfma_f32_16x16x32_bf16 v[48:51], a[20:23], a[216:219], v[48:51]
    ds_read_b64_tr_b16 a[6:7], v22 offset:1024
    s_waitcnt lgkmcnt(4)
    v_mfma_f32_16x16x32_bf16 v[64:67], a[24:27], a[216:219], v[64:67]
    ds_read_b64_tr_b16 a[8:9], v13 offset:8192
    v_accvgpr_write_b32 a104, v236
    v_mfma_f32_16x16x32_bf16 v[72:75], a[24:27], a[220:223], v[72:75]
    ds_read_b64_tr_b16 a[10:11], v13 offset:9216
    s_cmp_eq_u32 s13, 0
    s_cselect_b32 s25, s99, s98
    s_cselect_b32 s26, 1073741824, s97
    v_mfma_f32_16x16x32_bf16 v[88:91], a[28:31], a[220:223], v[88:91]
    ds_read_b64_tr_b16 a[12:13], v14 offset:8192
    s_mov_b32 s27, s99
    v_mfma_f32_16x16x32_bf16 v[80:83], a[28:31], a[216:219], v[80:83]
    ds_read_b64_tr_b16 a[14:15], v14 offset:9216
    s_waitcnt lgkmcnt(4)
    v_mfma_f32_16x16x32_bf16 v[96:99], a[0:3], a[216:219], v[96:99]
    ds_read_b64_tr_b16 a[16:17], v15 offset:8192
    v_accvgpr_write_b32 a105, v237
    v_mfma_f32_16x16x32_bf16 v[104:107], a[0:3], a[220:223], v[104:107]
    ds_read_b64_tr_b16 a[18:19], v15 offset:9216
    v_accvgpr_write_b32 a106, v238
    v_mfma_f32_16x16x32_bf16 v[120:123], a[4:7], a[220:223], v[120:123]
    ds_read_b64_tr_b16 a[20:21], v16 offset:8192
    s_mov_b32 s84, s24
    v_mfma_f32_16x16x32_bf16 v[112:115], a[4:7], a[216:219], v[112:115]
    ds_read_b64_tr_b16 a[22:23], v16 offset:9216
    s_waitcnt lgkmcnt(4)
    v_mfma_f32_16x16x32_bf16 v[160:163], a[8:11], a[216:219], v[160:163]
    ds_read_b64_tr_b16 a[24:25], v21 offset:8192
    v_accvgpr_write_b32 a107, v239
    v_mfma_f32_16x16x32_bf16 v[168:171], a[8:11], a[220:223], v[168:171]
    ds_read_b64_tr_b16 a[26:27], v21 offset:9216
    s_add_u32 s24, s24, 32768
    v_mfma_f32_16x16x32_bf16 v[184:187], a[12:15], a[220:223], v[184:187]
    ds_read_b64_tr_b16 a[28:29], v22 offset:8192
    v_accvgpr_write_b32 a108, v60
    s_cmp_eq_u32 s24, s25
    s_cselect_b32 s24, s26, s24
    s_cselect_b32 s25, s27, s25
    s_cselect_b32 s26, 1073741824, s26
    s_mov_b32 s85, s24
    s_add_u32 s24, s24, 32768
    s_cmp_eq_u32 s24, s25
    s_cselect_b32 s24, s26, s24
    s_cselect_b32 s25, s27, s25
    s_cselect_b32 s26, 1073741824, s26
    s_mov_b32 s86, s24
    s_add_u32 s24, s24, 32768
    s_cmp_eq_u32 s24, s25
    s_cselect_b32 s24, s26, s24
    s_cselect_b32 s25, s27, s25
    s_cselect_b32 s26, 1073741824, s26
    s_mov_b32 s87, s24
    s_add_u32 s24, s24, 32768
    s_cmp_eq_u32 s24, s25
    s_cselect_b32 s24, s26, s24
    s_cselect_b32 s25, s27, s25
    s_cselect_b32 s26, 1073741824, s26
    v_mfma_f32_16x16x32_bf16 v[176:179], a[12:15], a[216:219], v[176:179]
    ds_read_b64_tr_b16 a[30:31], v22 offset:9216
    s_waitcnt vmcnt(2)
    s_barrier
    s_waitcnt lgkmcnt(4)
    v_mfma_f32_16x16x32_bf16 v[192:195], a[16:19], a[216:219], v[192:195]
    ds_read_b64_tr_b16 a[0:1], v13 offset:16384
    v_accvgpr_write_b32 a109, v61
    v_mfma_f32_16x16x32_bf16 v[200:203], a[16:19], a[220:223], v[200:203]
    ds_read_b64_tr_b16 a[2:3], v13 offset:17408
    v_mfma_f32_16x16x32_bf16 v[216:219], a[20:23], a[220:223], v[216:219]
    ds_read_b64_tr_b16 a[4:5], v14 offset:16384
    v_mfma_f32_16x16x32_bf16 v[208:211], a[20:23], a[216:219], v[208:211]
    ds_read_b64_tr_b16 a[6:7], v14 offset:17408
    s_waitcnt lgkmcnt(4)
    v_mfma_f32_16x16x32_bf16 v[224:227], a[24:27], a[216:219], v[224:227]
    ds_read_b64_tr_b16 a[8:9], v15 offset:16384
    v_accvgpr_write_b32 a110, v62
    v_mfma_f32_16x16x32_bf16 v[232:235], a[24:27], a[220:223], v[232:235]
    ds_read_b64_tr_b16 a[10:11], v15 offset:17408
    v_accvgpr_write_b32 a111, v63
    v_mfma_f32_16x16x32_bf16 v[248:251], a[28:31], a[220:223], v[248:251]
    ds_read_b64_tr_b16 a[12:13], v16 offset:16384
    v_mfma_f32_16x16x32_bf16 v[240:243], a[28:31], a[216:219], v[240:243]
    ds_read_b64_tr_b16 a[14:15], v16 offset:17408
    s_mov_b32 s98, 0
spin_20:
    s_waitcnt vmcnt(0)
    v_readfirstlane_b32 s99, v31
    s_nop 0
    s_cmp_ge_u32 s99, 16
    s_cbranch_scc1 ok_21
    s_add_u32 s98, s98, 1
    s_cmp_gt_u32 s98, 0x80000
    s_cbranch_scc1 ok_21
    s_sleep 8
    buffer_load_dword v31, off, s[4:7], s72 sc1
    s_waitcnt vmcnt(0)
    s_branch spin_20
ok_21:
    s_waitcnt lgkmcnt(4)
    v_mfma_f32_16x16x32_bf16 v[32:35], a[0:3], a[64:67], v[32:35]
    ds_read_b64_tr_b16 a[16:17], v21 offset:16384
    v_mfma_f32_16x16x32_bf16 v[40:43], a[0:3], a[68:71], v[40:43]
    ds_read_b64_tr_b16 a[18:19], v21 offset:17408
    s_add_u32 m0, s28, 32768
    v_mfma_f32_16x16x32_bf16 v[56:59], a[4:7], a[68:71], v[56:59]
    ds_read_b64_tr_b16 a[20:21], v22 offset:16384
    buffer_load_dwordx4 v30, s[4:7], s84 offen offset:0 sc1 lds
    v_mfma_f32_16x16x32_bf16 v[48:51], a[4:7], a[64:67], v[48:51]
    ds_read_b64_tr_b16 a[22:23], v22 offset:17408
    s_waitcnt lgkmcnt(4)
    v_mfma_f32_16x16x32_bf16 v[64:67], a[8:11], a[64:67], v[64:67]
    ds_read_b64_tr_b16 a[24:25], v13 offset:24576
    buffer_load_dwordx4 v30, s[4:7], s84 offen offset:1024 sc1 lds
    v_mfma_f32_16x16x32_bf16 v[72:75], a[8:11], a[68:71], v[72:75]
    ds_read_b64_tr_b16 a[26:27], v13 offset:25600
    buffer_load_dwordx4 v30, s[4:7], s84 offen offset:2048 sc1 lds
    v_mfma_f32_16x16x32_bf16 v[88:91], a[12:15], a[68:71], v[88:91]
    ds_read_b64_tr_b16 a[28:29], v14 offset:24576
    buffer_load_dwordx4 v30, s[4:7], s84 offen offset:3072 sc1 lds
    v_mfma_f32_16x16x32_bf16 v[80:83], a[12:15], a[64:67], v[80:83]
    ds_read_b64_tr_b16 a[30:31], v14 offset:25600
    s_waitcnt lgkmcnt(4)
    v_mfma_f32_16x16x32_bf16 v[96:99], a[16:19], a[64:67], v[96:99]
    ds_read_b64_tr_b16 a[0:1], v15 offset:24576
    s_sub_u32 m0, s28, 65536
    v_mfma_f32_16x16x32_bf16 v[104:107], a[16:19], a[68:71], v[104:107]
    ds_read_b64_tr_b16 a[2:3], v15 offset:25600
    buffer_load_dword v31, off, s[4:7], s73 sc1
    v_mfma_f32_16x16x32_bf16 v[120:123], a[20:23], a[68:71], v[120:123]
    ds_read_b64_tr_b16 a[4:5], v16 offset:24576
    s_mov_b32 s3, s85
    v_mfma_f32_16x16x32_bf16 v[112:115], a[20:23], a[64:67], v[112:115]
    ds_read_b64_tr_b16 a[6:7], v16 offset:25600
    s_waitcnt lgkmcnt(4)
    v_mfma_f32_16x16x32_bf16 v[160:163], a[24:27], a[64:67], v[160:163]
    ds_read_b64_tr_b16 a[8:9], v21 offset:24576
    buffer_load_dwordx4 v30, s[4:7], s3 offen offset:0 sc1 lds
    v_mfma_f32_16x16x32_bf16 v[168:171], a[24:27], a[68:71], v[168:171]
    ds_read_b64_tr_b16 a[10:11], v21 offset:25600
    buffer_load_dwordx4 v30, s[4:7], s3 offen offset:1024 sc1 lds
    v_mfma_f32_16x16x32_bf16 v[184:187], a[28:31], a[68:71], v[184:187]
    ds_read_b64_tr_b16 a[12:13], v22 offset:24576
    buffer_load_dwordx4 v30, s[4:7], s3 offen offset:2048 sc1 lds
    v_mfma_f32_16x16x32_bf16 v[176:179], a[28:31], a[64:67], v[176:179]
    ds_read_b64_tr_b16 a[14:15], v22 offset:25600
    s_waitcnt lgkmcnt(4)
    v_mfma_f32_16x16x32_bf16 v[192:195], a[0:3], a[64:67], v[192:195]
    ds_read_b64_tr_b16 a[16:17], v13 offset:32768
    buffer_load_dwordx4 v30, s[4:7], s3 offen offset:3072 sc1 lds
    v_mfma_f32_16x16x32_bf16 v[200:203], a[0:3], a[68:71], v[200:203]
    ds_read_b64_tr_b16 a[18:19], v13 offset:33792
    s_add_u32 m0, s28, 49152
    v_mfma_f32_16x16x32_bf16 v[216:219], a[4:7], a[68:71], v[216:219]
    ds_read_b64_tr_b16 a[20:21], v14 offset:32768
    s_add_u32 s3, s84, 16384
    v_mfma_f32_16x16x32_bf16 v[208:211], a[4:7], a[64:67], v[208:211]
    ds_read_b64_tr_b16 a[22:23], v14 offset:33792
    s_waitcnt lgkmcnt(4)
    v_mfma_f32_16x16x32_bf16 v[224:227], a[8:11], a[64:67], v[224:227]
    ds_read_b64_tr_b16 a[24:25], v15 offset:32768
    buffer_load_dwordx4 v30, s[4:7], s3 offen offset:0 sc1 lds
    v_mfma_f32_16x16x32_bf16 v[232:235], a[8:11], a[68:71], v[232:235]
    ds_read_b64_tr_b16 a[26:27], v15 offset:33792
    buffer_load_dwordx4 v30, s[4:7], s3 offen offset:1024 sc1 lds
    v_mfma_f32_16x16x32_bf16 v[248:251], a[12:15], a[68:71], v[248:251]
    ds_read_b64_tr_b16 a[28:29], v16 offset:32768
    buffer_load_dwordx4 v30, s[4:7], s3 offen offset:2048 sc1 lds
    v_mfma_f32_16x16x32_bf16 v[240:243], a[12:15], a[64:67], v[240:243]
    ds_read_b64_tr_b16 a[30:31], v16 offset:33792
    s_waitcnt lgkmcnt(4)
    v_mfma_f32_16x16x32_bf16 v[32:35], a[16:19], a[72:75], v[32:35]
    ds_read_b64_tr_b16 a[0:1], v21 offset:32768
    buffer_load_dwordx4 v30, s[4:7], s3 offen offset:3072 sc1 lds
    v_mfma_f32_16x16x32_bf16 v[40:43], a[16:19], a[76:79], v[40:43]
    ds_read_b64_tr_b16 a[2:3], v21 offset:33792
    v_lshrrev_b32 v2, 4, v1
    v_mfma_f32_16x16x32_bf16 v[56:59], a[20:23], a[76:79], v[56:59]
    ds_read_b64_tr_b16 a[4:5], v22 offset:32768
    v_bfe_u32 v3, v1, 2, 2
    v_mfma_f32_16x16x32_bf16 v[48:51], a[20:23], a[72:75], v[48:51]
    ds_read_b64_tr_b16 a[6:7], v22 offset:33792
    s_waitcnt lgkmcnt(4)
    v_mfma_f32_16x16x32_bf16 v[64:67], a[24:27], a[72:75], v[64:67]
    ds_read_b64_tr_b16 a[8:9], v13 offset:40960
    v_lshl_add_u32 v4, v2, 2, v3
    v_mfma_f32_16x16x32_bf16 v[72:75], a[24:27], a[76:79], v[72:75]
    ds_read_b64_tr_b16 a[10:11], v13 offset:41984
    v_and_b32 v3, 7, v4
    v_mfma_f32_16x16x32_bf16 v[88:91], a[28:31], a[76:79], v[88:91]
    ds_read_b64_tr_b16 a[12:13], v14 offset:40960
    v_lshlrev_b32 v4, 9, v4
    v_mfma_f32_16x16x32_bf16 v[80:83], a[28:31], a[72:75], v[80:83]
    ds_read_b64_tr_b16 a[14:15], v14 offset:41984
    s_waitcnt lgkmcnt(4)
    v_mfma_f32_16x16x32_bf16 v[96:99], a[0:3], a[72:75], v[96:99]
    ds_read_b64_tr_b16 a[16:17], v15 offset:40960
    v_and_b32 v2, 3, v1
    v_mfma_f32_16x16x32_bf16 v[104:107], a[0:3], a[76:79], v[104:107]
    ds_read_b64_tr_b16 a[18:19], v15 offset:41984
    v_lshl_or_b32 v4, v2, 3, v4
    v_mfma_f32_16x16x32_bf16 v[120:123], a[4:7], a[76:79], v[120:123]
    ds_read_b64_tr_b16 a[20:21], v16 offset:40960
    v_xor_b32 v2, 0, v3
    v_mfma_f32_16x16x32_bf16 v[112:115], a[4:7], a[72:75], v[112:115]
    ds_read_b64_tr_b16 a[22:23], v16 offset:41984
    s_waitcnt lgkmcnt(4)
    v_mfma_f32_16x16x32_bf16 v[160:163], a[8:11], a[72:75], v[160:163]
    ds_read_b64_tr_b16 a[24:25], v21 offset:40960
    v_lshl_add_u32 v17, v2, 5, v4
    v_mfma_f32_16x16x32_bf16 v[168:171], a[8:11], a[76:79], v[168:171]
    ds_read_b64_tr_b16 a[26:27], v21 offset:41984
    v_xor_b32 v2, 1, v3
    v_mfma_f32_16x16x32_bf16 v[184:187], a[12:15], a[76:79], v[184:187]
    ds_read_b64_tr_b16 a[28:29], v22 offset:40960
    v_lshl_add_u32 v18, v2, 5, v4
    v_xor_b32 v2, 2, v3
    v_lshl_add_u32 v19, v2, 5, v4
    v_xor_b32 v2, 3, v3
    v_lshl_add_u32 v20, v2, 5, v4
    v_xor_b32 v2, 4, v3
    v_lshl_add_u32 v26, v2, 5, v4
    v_xor_b32 v2, 5, v3
    v_lshl_add_u32 v27, v2, 5, v4
    v_xor_b32 v2, 6, v3
    v_lshl_add_u32 v28, v2, 5, v4
    v_xor_b32 v2, 7, v3
    v_lshl_add_u32 v29, v2, 5, v4
    s_mov_b32 s16, s50
    s_mov_b32 s17, s51
    s_mov_b32 s18, 1605632
    s_mov_b32 s19, 0x20000
    v_mfma_f32_16x16x32_bf16 v[176:179], a[12:15], a[72:75], v[176:179]
    ds_read_b64_tr_b16 a[30:31], v22 offset:41984
    s_waitcnt lgkmcnt(4)
    v_mfma_f32_16x16x32_bf16 v[192:195], a[16:19], a[72:75], v[192:195]
    v_mfma_f32_16x16x32_bf16 v[200:203], a[16:19], a[76:79], v[200:203]
    v_mfma_f32_16x16x32_bf16 v[216:219], a[20:23], a[76:79], v[216:219]
    v_mfma_f32_16x16x32_bf16 v[208:211], a[20:23], a[72:75], v[208:211]
    s_waitcnt lgkmcnt(0)
    v_mfma_f32_16x16x32_bf16 v[224:227], a[24:27], a[72:75], v[224:227]
    v_mfma_f32_16x16x32_bf16 v[232:235], a[24:27], a[76:79], v[232:235]
    v_mfma_f32_16x16x32_bf16 v[248:251], a[28:31], a[76:79], v[248:251]
    v_mfma_f32_16x16x32_bf16 v[240:243], a[28:31], a[72:75], v[240:243]
    s_cmp_eq_u32 s13, 0
    s_cbranch_scc1 as6_noq
    s_lshl_b32 s3, s21, 4
    s_sub_u32 s74, 15, s22
    s_add_u32 s3, s3, s74
    s_lshl_b32 s3, s3, 2
    s_add_u32 s3, s3, s20
    s_lshl_b32 s3, s3, 14
    s_add_u32 s74, s3, 33554432
    s_mov_b32 s98, 0
spin_22:
    s_waitcnt vmcnt(8)
    v_readfirstlane_b32 s99, v31
    s_nop 0
    s_cmp_ge_u32 s99, 1
    s_cbranch_scc1 ok_23
    s_add_u32 s98, s98, 1
    s_cmp_gt_u32 s98, 0x80000
    s_cbranch_scc1 ok_23
    s_sleep 8
    buffer_load_dword v31, off, s[4:7], s73 sc1
    s_waitcnt vmcnt(0)
    s_branch spin_22
ok_23:
    s_add_u32 s3, s74, 0
    buffer_load_dwordx4 a[128:131], v25, s[4:7], s3 offen offset:0 sc1
    buffer_load_dwordx4 a[132:135], v25, s[4:7], s3 offen offset:1024 sc1
    buffer_load_dwordx4 a[136:139], v25, s[4:7], s3 offen offset:2048 sc1
    buffer_load_dwordx4 a[140:143], v25, s[4:7], s3 offen offset:3072 sc1
    s_add_u32 s3, s74, 4096
    buffer_load_dwordx4 a[144:147], v25, s[4:7], s3 offen offset:0 sc1
    buffer_load_dwordx4 a[148:151], v25, s[4:7], s3 offen offset:1024 sc1
    buffer_load_dwordx4 a[152:155], v25, s[4:7], s3 offen offset:2048 sc1
    buffer_load_dwordx4 a[156:159], v25, s[4:7], s3 offen offset:3072 sc1
    s_add_u32 s3, s74, 8192
    buffer_load_dwordx4 a[160:163], v25, s[4:7], s3 offen offset:0 sc1
    buffer_load_dwordx4 a[164:167], v25, s[4:7], s3 offen offset:1024 sc1
    buffer_load_dwordx4 a[168:171], v25, s[4:7], s3 offen offset:2048 sc1
    buffer_load_dwordx4 a[172:175], v25, s[4:7], s3 offen offset:3072 sc1
    s_add_u32 s3, s74, 12288
    buffer_load_dwordx4 a[176:179], v25, s[4:7], s3 offen offset:0 sc1
    buffer_load_dwordx4 a[180:183], v25, s[4:7], s3 offen offset:1024 sc1
    buffer_load_dwordx4 a[184:187], v25, s[4:7], s3 offen offset:2048 sc1
    buffer_load_dwordx4 a[188:191], v25, s[4:7], s3 offen offset:3072 sc1
as6_noq:
    s_lshl_b32 s3, s21, 4
    s_add_u32 s3, s3, s22
    s_lshl_b32 s3, s3, 2
    s_add_u32 s3, s3, s20
    s_lshl_b32 s3, s3, 13
    s_add_u32 s23, s3, 50331648
    s_mov_b32 s68, 0xbfb8aa3b
    s_mov_b32 s69, s68
    v_accvgpr_read_b32 v14, a228
    v_accvgpr_read_b32 v15, a229
    v_sub_f32 v12, 1.0, v14
    v_max_f32 v12, 0x0da24260, v12
    v_rcp_f32 v12, v12
    v_sub_f32 v13, 1.0, v15
    v_max_f32 v13, 0x0da24260, v13
    v_rcp_f32 v13, v13
    v_pk_mul_f32 v[36:37], v[32:33], s[68:69]
    v_pk_mul_f32 v[38:39], v[34:35], s[68:69]
    v_pk_mul_f32 v[52:53], v[48:49], s[68:69]
    v_pk_mul_f32 v[54:55], v[50:51], s[68:69]
    v_exp_f32 v36, v36
    v_exp_f32 v37, v37
    v_exp_f32 v38, v38
    v_exp_f32 v39, v39
    v_exp_f32 v52, v52
    v_exp_f32 v53, v53
    v_exp_f32 v54, v54
    v_exp_f32 v55, v55
    v_pk_mul_f32 v[32:33], v[32:33], v[160:161]
    v_pk_mul_f32 v[34:35], v[34:35], v[162:163]
    v_pk_mul_f32 v[48:49], v[48:49], v[176:177]
    v_pk_mul_f32 v[50:51], v[50:51], v[178:179]
    v_pk_fma_f32 v[36:37], v[36:37], v[12:13], v[12:13] op_sel_hi:[1,0,0]
    v_pk_fma_f32 v[38:39], v[38:39], v[12:13], v[12:13] op_sel_hi:[1,0,0]
    v_pk_fma_f32 v[52:53], v[52:53], v[12:13], v[12:13] op_sel_hi:[1,0,0]
    v_pk_fma_f32 v[54:55], v[54:55], v[12:13], v[12:13] op_sel_hi:[1,0,0]
    v_rcp_f32 v36, v36
    v_rcp_f32 v37, v37
    v_rcp_f32 v38, v38
    v_rcp_f32 v39, v39
    v_rcp_f32 v52, v52
    v_rcp_f32 v53, v53
    v_rcp_f32 v54, v54
    v_rcp_f32 v55, v55
    v_pk_mul_f32 v[32:33], v[32:33], v[36:37]
    v_pk_mul_f32 v[34:35], v[34:35], v[38:39]
    v_pk_mul_f32 v[48:49], v[48:49], v[52:53]
    v_pk_mul_f32 v[50:51], v[50:51], v[54:55]
    v_cvt_pk_bf16_f32 v32, v32, v33
    v_cvt_pk_bf16_f32 v33, v34, v35
    v_cvt_pk_bf16_f32 v34, v48, v49
    v_cvt_pk_bf16_f32 v35, v50, v51
    buffer_store_dwordx4 v[32:35], v25, s[4:7], s23 offen offset:0 sc1
    v_accvgpr_write_b32 a196, v32
    v_accvgpr_write_b32 a197, v33
    v_accvgpr_write_b32 a198, v34
    v_accvgpr_write_b32 a199, v35
    v_pk_mul_f32 v[44:45], v[40:41], s[68:69]
    v_pk_mul_f32 v[46:47], v[42:43], s[68:69]
    v_pk_mul_f32 v[60:61], v[56:57], s[68:69]
    v_pk_mul_f32 v[62:63], v[58:59], s[68:69]
    v_exp_f32 v44, v44
    v_exp_f32 v45, v45
    v_exp_f32 v46, v46
    v_exp_f32 v47, v47
    v_exp_f32 v60, v60
    v_exp_f32 v61, v61
    v_exp_f32 v62, v62
    v_exp_f32 v63, v63
    v_pk_mul_f32 v[40:41], v[40:41], v[168:169]
    v_pk_mul_f32 v[42:43], v[42:43], v[170:171]
    v_pk_mul_f32 v[56:57], v[56:57], v[184:185]
    v_pk_mul_f32 v[58:59], v[58:59], v[186:187]
    v_pk_fma_f32 v[44:45], v[44:45], v[12:13], v[12:13] op_sel:[0,1,1] op_sel_hi:[1,1,1]
    v_pk_fma_f32 v[46:47], v[46:47], v[12:13], v[12:13] op_sel:[0,1,1] op_sel_hi:[1,1,1]
    v_pk_fma_f32 v[60:61], v[60:61], v[12:13], v[12:13] op_sel:[0,1,1] op_sel_hi:[1,1,1]
    v_pk_fma_f32 v[62:63], v[62:63], v[12:13], v[12:13] op_sel:[0,1,1] op_sel_hi:[1,1,1]
    v_rcp_f32 v44, v44
    v_rcp_f32 v45, v45
    v_rcp_f32 v46, v46
    v_rcp_f32 v47, v47
    v_rcp_f32 v60, v60
    v_rcp_f32 v61, v61
    v_rcp_f32 v62, v62
    v_rcp_f32 v63, v63
    v_pk_mul_f32 v[40:41], v[40:41], v[44:45]
    v_pk_mul_f32 v[42:43], v[42:43], v[46:47]
    v_pk_mul_f32 v[56:57], v[56:57], v[60:61]
    v_pk_mul_f32 v[58:59], v[58:59], v[62:63]
    v_cvt_pk_bf16_f32 v40, v40, v41
    v_cvt_pk_bf16_f32 v41, v42, v43
    v_cvt_pk_bf16_f32 v42, v56, v57
    v_cvt_pk_bf16_f32 v43, v58, v59
    buffer_store_dwordx4 v[40:43], v25, s[4:7], s23 offen offset:1024 sc1
    v_accvgpr_write_b32 a200, v40
    v_accvgpr_write_b32 a201, v41
    v_accvgpr_write_b32 a202, v42
    v_accvgpr_write_b32 a203, v43
    v_pk_mul_f32 v[68:69], v[64:65], s[68:69]
    v_pk_mul_f32 v[70:71], v[66:67], s[68:69]
    v_pk_mul_f32 v[84:85], v[80:81], s[68:69]
    v_pk_mul_f32 v[86:87], v[82:83], s[68:69]
    v_exp_f32 v68, v68
    v_exp_f32 v69, v69
    v_exp_f32 v70, v70
    v_exp_f32 v71, v71
    v_exp_f32 v84, v84
    v_exp_f32 v85, v85
    v_exp_f32 v86, v86
    v_exp_f32 v87, v87
    v_pk_mul_f32 v[64:65], v[64:65], v[192:193]
    v_pk_mul_f32 v[66:67], v[66:67], v[194:195]
    v_pk_mul_f32 v[80:81], v[80:81], v[208:209]
    v_pk_mul_f32 v[82:83], v[82:83], v[210:211]
    v_pk_fma_f32 v[68:69], v[68:69], v[12:13], v[12:13] op_sel_hi:[1,0,0]
    v_pk_fma_f32 v[70:71], v[70:71], v[12:13], v[12:13] op_sel_hi:[1,0,0]
    v_pk_fma_f32 v[84:85], v[84:85], v[12:13], v[12:13] op_sel_hi:[1,0,0]
    v_pk_fma_f32 v[86:87], v[86:87], v[12:13], v[12:13] op_sel_hi:[1,0,0]
    v_rcp_f32 v68, v68
    v_rcp_f32 v69, v69
    v_rcp_f32 v70, v70
    v_rcp_f32 v71, v71
    v_rcp_f32 v84, v84
    v_rcp_f32 v85, v85
    v_rcp_f32 v86, v86
    v_rcp_f32 v87, v87
    v_pk_mul_f32 v[64:65], v[64:65], v[68:69]
    v_pk_mul_f32 v[66:67], v[66:67], v[70:71]
    v_pk_mul_f32 v[80:81], v[80:81], v[84:85]
    v_pk_mul_f32 v[82:83], v[82:83], v[86:87]
    v_cvt_pk_bf16_f32 v64, v64, v65
    v_cvt_pk_bf16_f32 v65, v66, v67
    v_cvt_pk_bf16_f32 v66, v80, v81
    v_cvt_pk_bf16_f32 v67, v82, v83
    buffer_store_dwordx4 v[64:67], v25, s[4:7], s23 offen offset:2048 sc1
    v_accvgpr_write_b32 a204, v64
    v_accvgpr_write_b32 a205, v65
    v_accvgpr_write_b32 a206, v66
    v_accvgpr_write_b32 a207, v67
    v_pk_mul_f32 v[76:77], v[72:73], s[68:69]
    v_pk_mul_f32 v[78:79], v[74:75], s[68:69]
    v_pk_mul_f32 v[92:93], v[88:89], s[68:69]
    v_pk_mul_f32 v[94:95], v[90:91], s[68:69]
    v_exp_f32 v76, v76
    v_exp_f32 v77, v77
    v_exp_f32 v78, v78
    v_exp_f32 v79, v79
    v_exp_f32 v92, v92
    v_exp_f32 v93, v93
    v_exp_f32 v94, v94
    v_exp_f32 v95, v95
    v_pk_mul_f32 v[72:73], v[72:73], v[200:201]
    v_pk_mul_f32 v[74:75], v[74:75], v[202:203]
    v_pk_mul_f32 v[88:89], v[88:89], v[216:217]
    v_pk_mul_f32 v[90:91], v[90:91], v[218:219]
    v_pk_fma_f32 v[76:77], v[76:77], v[12:13], v[12:13] op_sel:[0,1,1] op_sel_hi:[1,1,1]
    v_pk_fma_f32 v[78:79], v[78:79], v[12:13], v[12:13] op_sel:[0,1,1] op_sel_hi:[1,1,1]
    v_pk_fma_f32 v[92:93], v[92:93], v[12:13], v[12:13] op_sel:[0,1,1] op_sel_hi:[1,1,1]
    v_pk_fma_f32 v[94:95], v[94:95], v[12:13], v[12:13] op_sel:[0,1,1] op_sel_hi:[1,1,1]
    v_rcp_f32 v76, v76
    v_rcp_f32 v77, v77
    v_rcp_f32 v78, v78
    v_rcp_f32 v79, v79
    v_rcp_f32 v92, v92
    v_rcp_f32 v93, v93
    v_rcp_f32 v94, v94
    v_rcp_f32 v95, v95
    v_pk_mul_f32 v[72:73], v[72:73], v[76:77]
    v_pk_mul_f32 v[74:75], v[74:75], v[78:79]
    v_pk_mul_f32 v[88:89], v[88:89], v[92:93]
    v_pk_mul_f32 v[90:91], v[90:91], v[94:95]
    v_cvt_pk_bf16_f32 v72, v72, v73
    v_cvt_pk_bf16_f32 v73, v74, v75
    v_cvt_pk_bf16_f32 v74, v88, v89
    v_cvt_pk_bf16_f32 v75, v90, v91
    buffer_store_dwordx4 v[72:75], v25, s[4:7], s23 offen offset:3072 sc1
    v_accvgpr_write_b32 a208, v72
    v_accvgpr_write_b32 a209, v73
    v_accvgpr_write_b32 a210, v74
    v_accvgpr_write_b32 a211, v75
    s_add_u32 s23, s23, 4096
    v_pk_mul_f32 v[100:101], v[96:97], s[68:69]
    v_pk_mul_f32 v[102:103], v[98:99], s[68:69]
    v_pk_mul_f32 v[116:117], v[112:113], s[68:69]
    v_pk_mul_f32 v[118:119], v[114:115], s[68:69]
    v_exp_f32 v100, v100
    v_exp_f32 v101, v101
    v_exp_f32 v102, v102
    v_exp_f32 v103, v103
    v_exp_f32 v116, v116
    v_exp_f32 v117, v117
    v_exp_f32 v118, v118
    v_exp_f32 v119, v119
    v_pk_mul_f32 v[96:97], v[96:97], v[224:225]
    v_pk_mul_f32 v[98:99], v[98:99], v[226:227]
    v_pk_mul_f32 v[112:113], v[112:113], v[240:241]
    v_pk_mul_f32 v[114:115], v[114:115], v[242:243]
    v_pk_fma_f32 v[100:101], v[100:101], v[12:13], v[12:13] op_sel_hi:[1,0,0]
    v_pk_fma_f32 v[102:103], v[102:103], v[12:13], v[12:13] op_sel_hi:[1,0,0]
    v_pk_fma_f32 v[116:117], v[116:117], v[12:13], v[12:13] op_sel_hi:[1,0,0]
    v_pk_fma_f32 v[118:119], v[118:119], v[12:13], v[12:13] op_sel_hi:[1,0,0]
    v_rcp_f32 v100, v100
    v_rcp_f32 v101, v101
    v_rcp_f32 v102, v102
    v_rcp_f32 v103, v103
    v_rcp_f32 v116, v116
    v_rcp_f32 v117, v117
    v_rcp_f32 v118, v118
    v_rcp_f32 v119, v119
    v_pk_mul_f32 v[96:97], v[96:97], v[100:101]
    v_pk_mul_f32 v[98:99], v[98:99], v[102:103]
    v_pk_mul_f32 v[112:113], v[112:113], v[116:117]
    v_pk_mul_f32 v[114:115], v[114:115], v[118:119]
    v_cvt_pk_bf16_f32 v96, v96, v97
    v_cvt_pk_bf16_f32 v97, v98, v99
    v_cvt_pk_bf16_f32 v98, v112, v113
    v_cvt_pk_bf16_f32 v99, v114, v115
    buffer_store_dwordx4 v[96:99], v25, s[4:7], s23 offen offset:0 sc1
    v_accvgpr_write_b32 a212, v96
    v_accvgpr_write_b32 a213, v97
    v_accvgpr_write_b32 a214, v98
    v_accvgpr_write_b32 a215, v99
    v_pk_mul_f32 v[108:109], v[104:105], s[68:69]
    v_pk_mul_f32 v[110:111], v[106:107], s[68:69]
    v_pk_mul_f32 v[124:125], v[120:121], s[68:69]
    v_pk_mul_f32 v[126:127], v[122:123], s[68:69]
    v_exp_f32 v108, v108
    v_exp_f32 v109, v109
    v_exp_f32 v110, v110
    v_exp_f32 v111, v111
    v_exp_f32 v124, v124
    v_exp_f32 v125, v125
    v_exp_f32 v126, v126
    v_exp_f32 v127, v127
    v_pk_mul_f32 v[104:105], v[104:105], v[232:233]
    v_pk_mul_f32 v[106:107], v[106:107], v[234:235]
    v_pk_mul_f32 v[120:121], v[120:121], v[248:249]
    v_pk_mul_f32 v[122:123], v[122:123], v[250:251]
    v_pk_fma_f32 v[108:109], v[108:109], v[12:13], v[12:13] op_sel:[0,1,1] op_sel_hi:[1,1,1]
    v_pk_fma_f32 v[110:111], v[110:111], v[12:13], v[12:13] op_sel:[0,1,1] op_sel_hi:[1,1,1]
    v_pk_fma_f32 v[124:125], v[124:125], v[12:13], v[12:13] op_sel:[0,1,1] op_sel_hi:[1,1,1]
    v_pk_fma_f32 v[126:127], v[126:127], v[12:13], v[12:13] op_sel:[0,1,1] op_sel_hi:[1,1,1]
    v_rcp_f32 v108, v108
    v_rcp_f32 v109, v109
    v_rcp_f32 v110, v110
    v_rcp_f32 v111, v111
    v_rcp_f32 v124, v124
    v_rcp_f32 v125, v125
    v_rcp_f32 v126, v126
    v_rcp_f32 v127, v127
    v_pk_mul_f32 v[104:105], v[104:105], v[108:109]
    v_pk_mul_f32 v[106:107], v[106:107], v[110:111]
    v_pk_mul_f32 v[120:121], v[120:121], v[124:125]
    v_pk_mul_f32 v[122:123], v[122:123], v[126:127]
    v_cvt_pk_bf16_f32 v104, v104, v105
    v_cvt_pk_bf16_f32 v105, v106, v107
    v_cvt_pk_bf16_f32 v106, v120, v121
    v_cvt_pk_bf16_f32 v107, v122, v123
    buffer_store_dwordx4 v[104:107], v25, s[4:7], s23 offen offset:1024 sc1
    v_accvgpr_write_b32 a216, v104
    v_accvgpr_write_b32 a217, v105
    v_accvgpr_write_b32 a218, v106
    v_accvgpr_write_b32 a219, v107
qf_done:
    v_lshrrev_b32 v2, 5, v1
    v_bfe_u32 v3, v1, 1, 4
    v_and_b32 v4, 1, v1
    v_lshlrev_b32 v4, 4, v4
    v_mov_b32 v5, 1073741824
    v_xor_b32 v8, v3, v2
    v_lshl_or_b32 v13, v8, 5, v4
    v_mul_u32_u24 v16, 896, v2
    v_add_u32 v13, v13, v16
    v_cmp_gt_u32 vcc, 14, v8
    s_nop 1
    v_cndmask_b32 v21, v5, v13, vcc
    v_add_u32 v2, 2, v2
    v_xor_b32 v8, v3, v2
    v_lshl_or_b32 v13, v8, 5, v4
    v_mul_u32_u24 v16, 896, v2
    v_add_u32 v13, v13, v16
    v_subrev_u32 v13, 1024, v13
    v_cmp_gt_u32 vcc, 14, v8
    s_nop 1
    v_cndmask_b32 v22, v5, v13, vcc
    v_add_u32 v2, 2, v2
    v_xor_b32 v8, v3, v2
    v_lshl_or_b32 v13, v8, 5, v4
    v_mul_u32_u24 v16, 896, v2
    v_add_u32 v13, v13, v16
    v_subrev_u32 v13, 2048, v13
    v_cmp_gt_u32 vcc, 14, v8
    s_nop 1
    v_cndmask_b32 v23, v5, v13, vcc
    v_add_u32 v2, 2, v2
    v_xor_b32 v8, v3, v2
    v_lshl_or_b32 v13, v8, 5, v4
    v_mul_u32_u24 v16, 896, v2
    v_add_u32 v13, v13, v16
    v_subrev_u32 v13, 3072, v13
    v_cmp_gt_u32 vcc, 14, v8
    s_nop 1
    v_cndmask_b32 v24, v5, v13, vcc
    v_add_u32 v2, 2, v2
    v_add_u32 v6, 98304, v25
    v_mov_b32 v7, v25
    s_add_u32 s14, s73, 4
    s_mov_b32 s65, 0x40004000
    v_mov_b32 v126, 0xf149f2ca
    v_mov_b32 v112, 0x3f803f80
    v_mov_b32 v113, 0x3f803f80
    v_mov_b32 v114, 0x3f803f80
    v_mov_b32 v115, 0x3f803f80
    s_lshl_b32 s3, s22, 2
    s_add_u32 s3, s3, s20
    s_lshl_b32 s3, s3, 5
    v_and_b32 v2, 15, v1
    v_lshrrev_b32 v3, 4, v1
    v_lshlrev_b32 v3, 2, v3
    v_sub_u32 v2, v2, v3
    v_add_u32 v9, s3, v2
    v_add_u32 v10, 16, v9
    s_sub_u32 s3, 15, s22
    s_min_u32 s3, s3, s22
    s_lshl_b32 s23, s21, 3
    s_add_u32 s3, s3, s23
    s_lshl_b32 s3, s3, 2
    s_add_u32 s3, s3, s20
    s_lshl_b32 s3, s3, 14
    s_add_u32 s11, s3, 83886080
    s_cmp_ge_u32 s22, 8
    s_cselect_b32 s10, s8, 0
    s_add_u32 s10, s10, 2
    s_waitcnt vmcnt(15)
    s_barrier
    s_cmp_eq_u32 s13, 0
    s_cbranch_scc1 at_own
    s_mov_b32 s30, 0
    s_sub_u32 s31, s8, 1
    s_mov_b32 s64, 2147483647
    s_mov_b32 s9, 2
    v_mov_b32 v32, 0
    v_mov_b32 v33, 0
    v_mov_b32 v34, 0
    v_mov_b32 v35, 0
    v_mov_b32 v36, 0
    v_mov_b32 v37, 0
    v_mov_b32 v38, 0
    v_mov_b32 v39, 0
    v_mov_b32 v40, 0
    v_mov_b32 v41, 0
    v_mov_b32 v42, 0
    v_mov_b32 v43, 0
    v_mov_b32 v44, 0
    v_mov_b32 v45, 0
    v_mov_b32 v46, 0
    v_mov_b32 v47, 0
    v_mov_b32 v116, 0
    v_mov_b32 v117, 0
    ds_read_b128 a[0:3], v6 offset:32768
    ds_read_b128 a[4:7], v6 offset:40960
    ds_read_b128 a[8:11], v6 offset:33792
    ds_read_b128 a[12:15], v6 offset:41984
    ds_read_b128 a[16:19], v6 offset:34816
    ds_read_b128 a[20:23], v6 offset:43008
    s_waitcnt vmcnt(23) lgkmcnt(5)
    v_mfma_f32_16x16x32_bf16 v[48:51], a[0:3], a[128:131], v[32:35]
    ds_read_b128 a[24:27], v6 offset:35840
    v_mov_b32 v104, 0
    s_waitcnt vmcnt(13)
    v_mfma_f32_16x16x32_bf16 v[52:55], a[0:3], a[160:163], v[36:39]
    s_sub_u32 m0, s28, 32768
    s_add_u32 s3, s86, 0
    s_waitcnt lgkmcnt(5)
    v_mfma_f32_16x16x32_bf16 v[60:63], a[4:7], a[160:163], v[44:47]
    ds_read_b128 a[28:31], v6 offset:44032
    v_mov_b32 v105, 0
    v_mfma_f32_16x16x32_bf16 v[56:59], a[4:7], a[128:131], v[40:43]
    buffer_load_dwordx4 v30, s[4:7], s3 offen offset:0 sc1 lds
    v_mov_b32 v106, 0
    s_waitcnt lgkmcnt(5)
    v_mfma_f32_16x16x32_bf16 v[48:51], a[8:11], a[132:135], v[48:51]
    ds_read_b128 a[0:3], v6 offset:36864
    v_mov_b32 v107, 0
    s_waitcnt vmcnt(13)
    v_mfma_f32_16x16x32_bf16 v[52:55], a[8:11], a[164:167], v[52:55]
    buffer_load_dwordx4 v30, s[4:7], s3 offen offset:1024 sc1 lds
    v_mov_b32 v108, 0
    s_waitcnt lgkmcnt(5)
    v_mfma_f32_16x16x32_bf16 v[60:63], a[12:15], a[164:167], v[60:63]
    ds_read_b128 a[4:7], v6 offset:45056
    v_mov_b32 v109, 0
    v_mfma_f32_16x16x32_bf16 v[56:59], a[12:15], a[132:135], v[56:59]
    buffer_load_dwordx4 v30, s[4:7], s3 offen offset:2048 sc1 lds
    v_mov_b32 v110, 0
    s_waitcnt lgkmcnt(5)
    v_mfma_f32_16x16x32_bf16 v[48:51], a[16:19], a[136:139], v[48:51]
    ds_read_b128 a[8:11], v6 offset:37888
    v_mov_b32 v111, 0
    s_waitcnt vmcnt(14)
    v_mfma_f32_16x16x32_bf16 v[52:55], a[16:19], a[168:171], v[52:55]
    buffer_load_dwordx4 v30, s[4:7], s3 offen offset:3072 sc1 lds
    v_mov_b32 v128, 0
    s_waitcnt lgkmcnt(5)
    v_mfma_f32_16x16x32_bf16 v[60:63], a[20:23], a[168:171], v[60:63]
    ds_read_b128 a[12:15], v6 offset:46080
    v_mov_b32 v129, 0
    v_mfma_f32_16x16x32_bf16 v[56:59], a[20:23], a[136:139], v[56:59]
    s_sub_u32 m0, s28, 49152
    s_add_u32 s3, s85, 16384
    s_waitcnt lgkmcnt(5)
    v_mfma_f32_16x16x32_bf16 v[48:51], a[24:27], a[140:143], v[48:51]
    ds_read_b128 a[16:19], v6 offset:38912
    v_mov_b32 v130, 0
    s_waitcnt vmcnt(14)
    v_mfma_f32_16x16x32_bf16 v[52:55], a[24:27], a[172:175], v[52:55]
    buffer_load_dwordx4 v30, s[4:7], s3 offen offset:0 sc1 lds
    v_mov_b32 v131, 0
    s_waitcnt lgkmcnt(5)
    v_mfma_f32_16x16x32_bf16 v[60:63], a[28:31], a[172:175], v[60:63]
    ds_read_b128 a[20:23], v6 offset:47104
    v_mov_b32 v132, 0
    v_mfma_f32_16x16x32_bf16 v[56:59], a[28:31], a[140:143], v[56:59]
    buffer_load_dwordx4 v30, s[4:7], s3 offen offset:1024 sc1 lds
    v_mov_b32 v133, 0
    s_waitcnt lgkmcnt(5)
    v_mfma_f32_16x16x32_bf16 v[48:51], a[0:3], a[144:147], v[48:51]
    ds_read_b128 a[24:27], v6 offset:39936
    v_mov_b32 v134, 0
    s_waitcnt vmcnt(15)
    v_mfma_f32_16x16x32_bf16 v[52:55], a[0:3], a[176:179], v[52:55]
    buffer_load_dwordx4 v30, s[4:7], s3 offen offset:2048 sc1 lds
    v_mov_b32 v135, 0
    s_waitcnt lgkmcnt(5)
    v_mfma_f32_16x16x32_bf16 v[60:63], a[4:7], a[176:179], v[60:63]
    ds_read_b128 a[28:31], v6 offset:48128
    v_mov_b32 v136, 0
    v_mfma_f32_16x16x32_bf16 v[56:59], a[4:7], a[144:147], v[56:59]
    buffer_load_dwordx4 v30, s[4:7], s3 offen offset:3072 sc1 lds
    v_mov_b32 v137, 0
    s_waitcnt lgkmcnt(5)
    v_mfma_f32_16x16x32_bf16 v[48:51], a[8:11], a[148:151], v[48:51]
    v_mov_b32 v138, 0
    v_mov_b32 v139, 0
    s_waitcnt vmcnt(16)
    v_mfma_f32_16x16x32_bf16 v[52:55], a[8:11], a[180:183], v[52:55]
    s_sub_u32 m0, s28, 0
    s_add_u32 s3, s87, 0
    s_waitcnt lgkmcnt(4)
    v_mfma_f32_16x16x32_bf16 v[60:63], a[12:15], a[180:183], v[60:63]
    v_mov_b32 v140, 0
    v_mov_b32 v141, 0
    v_mfma_f32_16x16x32_bf16 v[56:59], a[12:15], a[148:151], v[56:59]
    buffer_load_dwordx4 v30, s[4:7], s3 offen offset:0 sc1 lds
    v_mov_b32 v142, 0
    s_waitcnt lgkmcnt(3)
    v_mfma_f32_16x16x32_bf16 v[48:51], a[16:19], a[152:155], v[48:51]
    v_mov_b32 v143, 0
    v_mov_b32 v144, 0
    s_waitcnt vmcnt(16)
    v_mfma_f32_16x16x32_bf16 v[52:55], a[16:19], a[184:187], v[52:55]
    buffer_load_dwordx4 v30, s[4:7], s3 offen offset:1024 sc1 lds
    v_mov_b32 v145, 0
    s_waitcnt lgkmcnt(2)
    v_mfma_f32_16x16x32_bf16 v[60:63], a[20:23], a[184:187], v[60:63]
    v_mov_b32 v146, 0
    v_mov_b32 v147, 0
    v_mfma_f32_16x16x32_bf16 v[56:59], a[20:23], a[152:155], v[56:59]
    buffer_load_dwordx4 v30, s[4:7], s3 offen offset:2048 sc1 lds
    v_mov_b32 v148, 0
    s_waitcnt lgkmcnt(1)
    v_mfma_f32_16x16x32_bf16 v[48:51], a[24:27], a[156:159], v[48:51]
    v_mov_b32 v149, 0
    v_mov_b32 v150, 0
    s_waitcnt vmcnt(17)
    v_mfma_f32_16x16x32_bf16 v[52:55], a[24:27], a[188:191], v[52:55]
    buffer_load_dwordx4 v30, s[4:7], s3 offen offset:3072 sc1 lds
    v_mov_b32 v151, 0
    s_waitcnt lgkmcnt(0)
    v_mfma_f32_16x16x32_bf16 v[60:63], a[28:31], a[188:191], v[60:63]
    v_mov_b32 v152, 0
    v_mov_b32 v153, 0
    v_mfma_f32_16x16x32_bf16 v[56:59], a[28:31], a[156:159], v[56:59]
    v_mov_b32 v154, 0
    v_mov_b32 v155, 0
    v_mov_b32 v156, 0
    v_mov_b32 v157, 0
    v_mov_b32 v158, 0
    v_mov_b32 v159, 0
    s_add_u32 s29, s86, 16384
    s_mov_b32 s66, s87
    s_sub_u32 s67, s28, 16384
    s_sub_u32 s28, s28, 32768
    v_mov_b32 v160, 0
    v_mov_b32 v161, 0
    v_mov_b32 v162, 0
    v_mov_b32 v163, 0
    v_mov_b32 v164, 0
    v_mov_b32 v165, 0
    v_mov_b32 v166, 0
    v_mov_b32 v167, 0
    v_mov_b32 v168, 0
    v_mov_b32 v169, 0
    v_mov_b32 v170, 0
    v_mov_b32 v171, 0
    v_mov_b32 v172, 0
    v_mov_b32 v173, 0
    v_mov_b32 v174, 0
    v_mov_b32 v175, 0
    v_mov_b32 v176, 0
    v_mov_b32 v177, 0
    v_mov_b32 v178, 0
    v_mov_b32 v179, 0
    v_mov_b32 v180, 0
    v_mov_b32 v181, 0
    v_mov_b32 v182, 0
    v_mov_b32 v183, 0
    v_mov_b32 v184, 0
    v_mov_b32 v185, 0
    v_mov_b32 v186, 0
    v_mov_b32 v187, 0
    v_mov_b32 v188, 0
    v_mov_b32 v189, 0
    v_mov_b32 v190, 0
    v_mov_b32 v191, 0
    v_mov_b32 v192, 0
    v_mov_b32 v193, 0
    v_mov_b32 v194, 0
    v_mov_b32 v195, 0
    v_mov_b32 v196, 0
    v_mov_b32 v197, 0
    v_mov_b32 v198, 0
    v_mov_b32 v199, 0
    v_mov_b32 v200, 0
    v_mov_b32 v201, 0
    v_mov_b32 v202, 0
    v_mov_b32 v203, 0
    v_mov_b32 v204, 0
    v_mov_b32 v205, 0
    v_mov_b32 v206, 0
    v_mov_b32 v207, 0
    s_mov_b32 m0, s67
at_x_p_qk:
    s_barrier
    ds_read_b128 a[0:3], v7 offset:32768
    ds_read_b128 a[4:7], v7 offset:40960
    ds_read_b128 a[8:11], v7 offset:33792
    ds_read_b128 a[12:15], v7 offset:41984
    ds_read_b128 a[16:19], v7 offset:34816
    ds_read_b128 a[20:23], v7 offset:43008
    buffer_load_dwordx4 v30, s[4:7], s29 offen offset:0 sc1 lds
    v_max3_f32 v118, v48, v49, v50
    v_max3_f32 v119, v51, v56, v57
    v_max3_f32 v118, v118, v58, v59
    v_max_f32 v118, v118, v119
    v_mov_b32 v119, v118
    s_nop 1
    v_permlane32_swap_b32 v118, v119
    v_max_f32 v118, v118, v119
    v_mov_b32 v119, v118
    s_nop 1
    v_permlane16_swap_b32 v118, v119
    v_max_f32 v118, v118, v119
    v_add_f32 v118, 0x40e00000, v118
    v_ceil_f32 v118, v118
    buffer_load_dwordx4 v30, s[4:7], s29 offen offset:1024 sc1 lds
    v_sub_f32 v48, v48, v118
    v_sub_f32 v49, v49, v118
    v_sub_f32 v50, v50, v118
    v_sub_f32 v51, v51, v118
    v_sub_f32 v56, v56, v118
    v_sub_f32 v57, v57, v118
    v_sub_f32 v58, v58, v118
    v_sub_f32 v59, v59, v118
    v_sub_f32 v116, 0, v118
    v_mov_b32 v32, v116
    v_mov_b32 v33, v116
    v_mov_b32 v34, v116
    v_mov_b32 v35, v116
    v_mov_b32 v40, v116
    v_mov_b32 v41, v116
    v_mov_b32 v42, v116
    v_mov_b32 v43, v116
    buffer_load_dwordx4 v30, s[4:7], s29 offen offset:2048 sc1 lds
    v_max3_f32 v122, v52, v53, v54
    v_max3_f32 v123, v55, v60, v61
    v_max3_f32 v122, v122, v62, v63
    v_max_f32 v122, v122, v123
    v_mov_b32 v123, v122
    s_nop 1
    v_permlane32_swap_b32 v122, v123
    v_max_f32 v122, v122, v123
    v_mov_b32 v123, v122
    s_nop 1
    v_permlane16_swap_b32 v122, v123
    v_max_f32 v122, v122, v123
    v_add_f32 v122, 0x40e00000, v122
    v_ceil_f32 v122, v122
    buffer_load_dwordx4 v30, s[4:7], s29 offen offset:3072 sc1 lds
    v_sub_f32 v52, v52, v122
    v_sub_f32 v53, v53, v122
    v_sub_f32 v54, v54, v122
    v_sub_f32 v55, v55, v122
    v_sub_f32 v60, v60, v122
    v_sub_f32 v61, v61, v122
    v_sub_f32 v62, v62, v122
    v_sub_f32 v63, v63, v122
    v_sub_f32 v117, 0, v122
    v_mov_b32 v36, v117
    v_mov_b32 v37, v117
    v_mov_b32 v38, v117
    v_mov_b32 v39, v117
    v_mov_b32 v44, v117
    v_mov_b32 v45, v117
    v_mov_b32 v46, v117
    v_mov_b32 v47, v117
    s_add_u32 s67, s28, 49152
    s_add_u32 s28, s28, 32768
    s_and_b32 s28, s28, 0x1ffff
    s_add_u32 m0, s28, 32768
    v_exp_f32 v96, v48
    v_exp_f32 v97, v49
    v_exp_f32 v98, v50
    v_cvt_pk_bf16_f32 v80, v96, v97
    v_exp_f32 v99, v51
    v_exp_f32 v100, v56
    v_cvt_pk_bf16_f32 v81, v98, v99
    v_exp_f32 v101, v57
    v_exp_f32 v102, v58
    v_cvt_pk_bf16_f32 v82, v100, v101
    v_exp_f32 v103, v59
    s_nop 0
    v_cvt_pk_bf16_f32 v83, v102, v103
    v_mov_b32 v208, 0
    v_mov_b32 v209, 0
    v_mov_b32 v210, 0
    v_mov_b32 v211, 0
    v_mov_b32 v212, 0
    v_mov_b32 v213, 0
    v_mov_b32 v214, 0
    v_mov_b32 v215, 0
    v_mov_b32 v216, 0
    v_mov_b32 v217, 0
    v_mov_b32 v218, 0
    v_mov_b32 v219, 0
    v_mov_b32 v220, 0
    v_mov_b32 v221, 0
    v_mov_b32 v222, 0
    v_mov_b32 v223, 0
    v_mov_b32 v224, 0
    v_mov_b32 v225, 0
    v_mov_b32 v226, 0
    v_mov_b32 v227, 0
    v_mov_b32 v228, 0
    v_mov_b32 v229, 0
    v_mov_b32 v230, 0
    v_mov_b32 v231, 0
    v_mov_b32 v232, 0
    v_mov_b32 v233, 0
    v_mov_b32 v234, 0
    v_mov_b32 v235, 0
    v_mov_b32 v236, 0
    v_mov_b32 v237, 0
    v_mov_b32 v238, 0
    v_mov_b32 v239, 0
    v_mov_b32 v240, 0
    v_mov_b32 v241, 0
    v_mov_b32 v242, 0
    v_mov_b32 v243, 0
    v_mov_b32 v244, 0
    v_mov_b32 v245, 0
    v_mov_b32 v246, 0
    v_mov_b32 v247, 0
    v_mov_b32 v248, 0
    v_mov_b32 v249, 0
    v_mov_b32 v250, 0
    v_mov_b32 v251, 0
    v_mov_b32 v252, 0
    v_mov_b32 v253, 0
    v_mov_b32 v254, 0
    v_mov_b32 v255, 0
at_x_loop:
    s_waitcnt lgkmcnt(4)
    v_mfma_f32_16x16x32_bf16 v[64:67], a[0:3], a[128:131], v[32:35]
    ds_read_b128 a[24:27], v7 offset:35840
    ds_read_b128 a[28:31], v7 offset:44032
    v_mfma_f32_16x16x32_bf16 v[68:71], a[0:3], a[160:163], v[36:39]
    v_exp_f32 v96, v52
    v_mfma_f32_16x16x32_bf16 v[76:79], a[4:7], a[160:163], v[44:47]
    v_exp_f32 v97, v53
    v_mfma_f32_16x16x32_bf16 v[72:75], a[4:7], a[128:131], v[40:43]
    v_cvt_pk_bf16_f32 v84, v96, v97
    s_waitcnt lgkmcnt(4)
    v_mfma_f32_16x16x32_bf16 v[64:67], a[8:11], a[132:135], v[64:67]
    ds_read_b128 a[0:3], v7 offset:36864
    ds_read_b128 a[4:7], v7 offset:45056
    v_mfma_f32_16x16x32_bf16 v[68:71], a[8:11], a[164:167], v[68:71]
    v_exp_f32 v98, v54
    v_mfma_f32_16x16x32_bf16 v[76:79], a[12:15], a[164:167], v[76:79]
    buffer_load_dwordx4 v30, s[4:7], s24 offen offset:0 sc1 lds
    s_add_u32 s29, s66, 16384
    v_mfma_f32_16x16x32_bf16 v[72:75], a[12:15], a[132:135], v[72:75]
    s_mov_b32 s66, s24
    s_waitcnt lgkmcnt(4)
    v_mfma_f32_16x16x32_bf16 v[64:67], a[16:19], a[136:139], v[64:67]
    ds_read_b128 a[8:11], v7 offset:37888
    ds_read_b128 a[12:15], v7 offset:46080
    v_mfma_f32_16x16x32_bf16 v[68:71], a[16:19], a[168:171], v[68:71]
    v_exp_f32 v99, v55
    v_mfma_f32_16x16x32_bf16 v[76:79], a[20:23], a[168:171], v[76:79]
    v_exp_f32 v100, v60
    v_mfma_f32_16x16x32_bf16 v[72:75], a[20:23], a[136:139], v[72:75]
    v_cvt_pk_bf16_f32 v85, v98, v99
    s_waitcnt lgkmcnt(4)
    v_mfma_f32_16x16x32_bf16 v[64:67], a[24:27], a[140:143], v[64:67]
    ds_read_b128 a[16:19], v7 offset:38912
    ds_read_b128 a[20:23], v7 offset:47104
    v_mfma_f32_16x16x32_bf16 v[68:71], a[24:27], a[172:175], v[68:71]
    v_exp_f32 v101, v61
    v_mfma_f32_16x16x32_bf16 v[76:79], a[28:31], a[172:175], v[76:79]
    buffer_load_dwordx4 v30, s[4:7], s24 offen offset:1024 sc1 lds
    v_mfma_f32_16x16x32_bf16 v[72:75], a[28:31], a[140:143], v[72:75]
    v_cvt_pk_bf16_f32 v86, v100, v101
    s_waitcnt lgkmcnt(4)
    v_mfma_f32_16x16x32_bf16 v[64:67], a[0:3], a[144:147], v[64:67]
    ds_read_b128 a[24:27], v7 offset:39936
    ds_read_b128 a[28:31], v7 offset:48128
    v_mfma_f32_16x16x32_bf16 v[68:71], a[0:3], a[176:179], v[68:71]
    v_exp_f32 v102, v62
    v_mfma_f32_16x16x32_bf16 v[76:79], a[4:7], a[176:179], v[76:79]
    v_exp_f32 v103, v63
    v_mfma_f32_16x16x32_bf16 v[72:75], a[4:7], a[144:147], v[72:75]
    v_cvt_pk_bf16_f32 v87, v102, v103
    s_waitcnt lgkmcnt(4)
    v_mfma_f32_16x16x32_bf16 v[64:67], a[8:11], a[148:151], v[64:67]
    ds_read_b128 a[0:3], v6 offset:49152
    ds_read_b128 a[4:7], v6 offset:50176
    v_mfma_f32_16x16x32_bf16 v[68:71], a[8:11], a[180:183], v[68:71]
    v_or3_b32 v11, v80, v81, v82
    v_or3_b32 v11, v11, v83, v84
    v_mfma_f32_16x16x32_bf16 v[76:79], a[12:15], a[180:183], v[76:79]
    buffer_load_dwordx4 v30, s[4:7], s24 offen offset:2048 sc1 lds
    v_mfma_f32_16x16x32_bf16 v[72:75], a[12:15], a[148:151], v[72:75]
    v_or3_b32 v11, v11, v85, v86
    s_waitcnt lgkmcnt(4)
    v_mfma_f32_16x16x32_bf16 v[64:67], a[16:19], a[152:155], v[64:67]
    ds_read_b128 a[8:11], v6 offset:51200
    ds_read_b128 a[12:15], v6 offset:52224
    v_mfma_f32_16x16x32_bf16 v[68:71], a[16:19], a[184:187], v[68:71]
    v_bitop3_b32 v11, v11, v87, s65 bitop3:0xa8
    v_cmp_ne_u32 vcc, 0, v11
    v_mfma_f32_16x16x32_bf16 v[76:79], a[20:23], a[184:187], v[76:79]
    v_mfma_f32_16x16x32_bf16 v[72:75], a[20:23], a[152:155], v[72:75]
    s_cbranch_vccnz at_x_rs0
at_x_rs0_ret:
    s_waitcnt lgkmcnt(4)
    v_mfma_f32_16x16x32_bf16 v[64:67], a[24:27], a[156:159], v[64:67]
    ds_read_b128 a[16:19], v6 offset:53248
    ds_read_b128 a[20:23], v6 offset:54272
    v_mfma_f32_16x16x32_bf16 v[68:71], a[24:27], a[188:191], v[68:71]
    buffer_load_dwordx4 v30, s[4:7], s24 offen offset:3072 sc1 lds
    v_mfma_f32_16x16x32_bf16 v[76:79], a[28:31], a[188:191], v[76:79]
    s_add_u32 s24, s24, 32768
    s_mov_b32 m0, s67
    v_mfma_f32_16x16x32_bf16 v[72:75], a[28:31], a[156:159], v[72:75]
    s_waitcnt vmcnt(12)
    s_barrier
    v_mfma_f32_16x16x32_bf16 v[104:107], v[112:115], v[80:83], v[104:107]
    buffer_load_dwordx4 v30, s[4:7], s29 offen offset:0 sc1 lds
    v_mfma_f32_16x16x32_bf16 v[108:111], v[112:115], v[84:87], v[108:111]
    s_waitcnt lgkmcnt(4)
    v_mfma_f32_16x16x32_bf16 v[132:135], v[84:87], a[0:3], v[132:135]
    ds_read_b128 a[24:27], v6 offset:55296
    ds_read_b128 a[28:31], v6 offset:56320
    v_mfma_f32_16x16x32_bf16 v[128:131], v[80:83], a[0:3], v[128:131]
    v_exp_f32 v96, v64
    v_mfma_f32_16x16x32_bf16 v[136:139], v[80:83], a[4:7], v[136:139]
    v_exp_f32 v97, v65
    v_mfma_f32_16x16x32_bf16 v[140:143], v[84:87], a[4:7], v[140:143]
    v_cvt_pk_bf16_f32 v88, v96, v97
    s_waitcnt lgkmcnt(4)
    v_mfma_f32_16x16x32_bf16 v[148:151], v[84:87], a[8:11], v[148:151]
    ds_read_b128 a[0:3], v6 offset:57344
    ds_read_b128 a[4:7], v6 offset:58368
    v_mfma_f32_16x16x32_bf16 v[144:147], v[80:83], a[8:11], v[144:147]
    v_exp_f32 v98, v66
    v_mfma_f32_16x16x32_bf16 v[152:155], v[80:83], a[12:15], v[152:155]
    buffer_load_dwordx4 v30, s[4:7], s29 offen offset:1024 sc1 lds
    s_add_u32 s67, s28, 49152
    v_mfma_f32_16x16x32_bf16 v[156:159], v[84:87], a[12:15], v[156:159]
    s_add_u32 s28, s28, 32768
    s_waitcnt lgkmcnt(4)
    v_mfma_f32_16x16x32_bf16 v[164:167], v[84:87], a[16:19], v[164:167]
    ds_read_b128 a[8:11], v6 offset:59392
    ds_read_b128 a[12:15], v6 offset:60416
    v_mfma_f32_16x16x32_bf16 v[160:163], v[80:83], a[16:19], v[160:163]
    v_exp_f32 v99, v67
    v_mfma_f32_16x16x32_bf16 v[168:171], v[80:83], a[20:23], v[168:171]
    v_exp_f32 v100, v72
    v_mfma_f32_16x16x32_bf16 v[172:175], v[84:87], a[20:23], v[172:175]
    v_cvt_pk_bf16_f32 v89, v98, v99
    s_waitcnt lgkmcnt(4)
    v_mfma_f32_16x16x32_bf16 v[180:183], v[84:87], a[24:27], v[180:183]
    ds_read_b128 a[16:19], v6 offset:61440
    ds_read_b128 a[20:23], v6 offset:62464
    v_mfma_f32_16x16x32_bf16 v[176:179], v[80:83], a[24:27], v[176:179]
    v_exp_f32 v101, v73
    v_mfma_f32_16x16x32_bf16 v[184:187], v[80:83], a[28:31], v[184:187]
    buffer_load_dwordx4 v30, s[4:7], s29 offen offset:2048 sc1 lds
    s_and_b32 s28, s28, 0x1ffff
    v_mfma_f32_16x16x32_bf16 v[188:191], v[84:87], a[28:31], v[188:191]
    v_cvt_pk_bf16_f32 v90, v100, v101
    s_waitcnt lgkmcnt(4)
    v_mfma_f32_16x16x32_bf16 v[196:199], v[84:87], a[0:3], v[196:199]
    ds_read_b128 a[24:27], v6 offset:63488
    ds_read_b128 a[28:31], v6 offset:64512
    v_mfma_f32_16x16x32_bf16 v[192:195], v[80:83], a[0:3], v[192:195]
    v_exp_f32 v102, v74
    v_mfma_f32_16x16x32_bf16 v[200:203], v[80:83], a[4:7], v[200:203]
    v_xor_b32 v6, 0x10000, v6
    s_add_u32 s30, s30, 1
    v_mfma_f32_16x16x32_bf16 v[204:207], v[84:87], a[4:7], v[204:207]
    s_waitcnt lgkmcnt(4)
    v_mfma_f32_16x16x32_bf16 v[212:215], v[84:87], a[8:11], v[212:215]
    ds_read_b128 a[0:3], v6 offset:32768
    ds_read_b128 a[4:7], v6 offset:40960
    v_mfma_f32_16x16x32_bf16 v[208:211], v[80:83], a[8:11], v[208:211]
    v_exp_f32 v103, v75
    v_mfma_f32_16x16x32_bf16 v[216:219], v[80:83], a[12:15], v[216:219]
    buffer_load_dwordx4 v30, s[4:7], s29 offen offset:3072 sc1 lds
    v_mfma_f32_16x16x32_bf16 v[220:223], v[84:87], a[12:15], v[220:223]
    v_cvt_pk_bf16_f32 v91, v102, v103
    s_waitcnt lgkmcnt(4)
    v_mfma_f32_16x16x32_bf16 v[228:231], v[84:87], a[16:19], v[228:231]
    ds_read_b128 a[8:11], v6 offset:33792
    ds_read_b128 a[12:15], v6 offset:41984
    v_mfma_f32_16x16x32_bf16 v[224:227], v[80:83], a[16:19], v[224:227]
    s_cmp_eq_u32 s24, s25
    s_cselect_b32 s24, s26, s24
    v_mfma_f32_16x16x32_bf16 v[232:235], v[80:83], a[20:23], v[232:235]
    s_cselect_b32 s25, s27, s25
    s_cselect_b32 s26, 1073741824, s26
    v_mfma_f32_16x16x32_bf16 v[236:239], v[84:87], a[20:23], v[236:239]
    s_add_u32 m0, s28, 32768
    s_waitcnt lgkmcnt(4)
    v_mfma_f32_16x16x32_bf16 v[244:247], v[84:87], a[24:27], v[244:247]
    ds_read_b128 a[16:19], v6 offset:34816
    ds_read_b128 a[20:23], v6 offset:43008
    v_mfma_f32_16x16x32_bf16 v[240:243], v[80:83], a[24:27], v[240:243]
    s_cmp_ge_i32 s30, s9
    s_cbranch_scc1 at_x_ev1
at_x_ev1_ret:
    v_mfma_f32_16x16x32_bf16 v[248:251], v[80:83], a[28:31], v[248:251]
    s_cmp_eq_u32 s30, s31
    v_mfma_f32_16x16x32_bf16 v[252:255], v[84:87], a[28:31], v[252:255]
    s_cbranch_scc1 at_x_tail1
at_x_b1:
    s_waitcnt lgkmcnt(4)
    v_mfma_f32_16x16x32_bf16 v[48:51], a[0:3], a[128:131], v[32:35]
    ds_read_b128 a[24:27], v6 offset:35840
    ds_read_b128 a[28:31], v6 offset:44032
    v_mfma_f32_16x16x32_bf16 v[52:55], a[0:3], a[160:163], v[36:39]
    v_exp_f32 v96, v68
    v_mfma_f32_16x16x32_bf16 v[60:63], a[4:7], a[160:163], v[44:47]
    v_exp_f32 v97, v69
    v_mfma_f32_16x16x32_bf16 v[56:59], a[4:7], a[128:131], v[40:43]
    v_cvt_pk_bf16_f32 v92, v96, v97
    s_waitcnt lgkmcnt(4)
    v_mfma_f32_16x16x32_bf16 v[48:51], a[8:11], a[132:135], v[48:51]
    ds_read_b128 a[0:3], v6 offset:36864
    ds_read_b128 a[4:7], v6 offset:45056
    v_mfma_f32_16x16x32_bf16 v[52:55], a[8:11], a[164:167], v[52:55]
    v_exp_f32 v98, v70
    v_mfma_f32_16x16x32_bf16 v[60:63], a[12:15], a[164:167], v[60:63]
    buffer_load_dwordx4 v30, s[4:7], s24 offen offset:0 sc1 lds
    s_add_u32 s29, s66, 16384
    v_mfma_f32_16x16x32_bf16 v[56:59], a[12:15], a[132:135], v[56:59]
    s_mov_b32 s66, s24
    s_waitcnt lgkmcnt(4)
    v_mfma_f32_16x16x32_bf16 v[48:51], a[16:19], a[136:139], v[48:51]
    ds_read_b128 a[8:11], v6 offset:37888
    ds_read_b128 a[12:15], v6 offset:46080
    v_mfma_f32_16x16x32_bf16 v[52:55], a[16:19], a[168:171], v[52:55]
    v_exp_f32 v99, v71
    v_mfma_f32_16x16x32_bf16 v[60:63], a[20:23], a[168:171], v[60:63]
    v_exp_f32 v100, v76
    v_mfma_f32_16x16x32_bf16 v[56:59], a[20:23], a[136:139], v[56:59]
    v_cvt_pk_bf16_f32 v93, v98, v99
    s_waitcnt lgkmcnt(4)
    v_mfma_f32_16x16x32_bf16 v[48:51], a[24:27], a[140:143], v[48:51]
    ds_read_b128 a[16:19], v6 offset:38912
    ds_read_b128 a[20:23], v6 offset:47104
    v_mfma_f32_16x16x32_bf16 v[52:55], a[24:27], a[172:175], v[52:55]
    v_exp_f32 v101, v77
    v_mfma_f32_16x16x32_bf16 v[60:63], a[28:31], a[172:175], v[60:63]
    buffer_load_dwordx4 v30, s[4:7], s24 offen offset:1024 sc1 lds
    v_mfma_f32_16x16x32_bf16 v[56:59], a[28:31], a[140:143], v[56:59]
    v_cvt_pk_bf16_f32 v94, v100, v101
    s_waitcnt lgkmcnt(4)
    v_mfma_f32_16x16x32_bf16 v[48:51], a[0:3], a[144:147], v[48:51]
    ds_read_b128 a[24:27], v6 offset:39936
    ds_read_b128 a[28:31], v6 offset:48128
    v_mfma_f32_16x16x32_bf16 v[52:55], a[0:3], a[176:179], v[52:55]
    v_exp_f32 v102, v78
    v_mfma_f32_16x16x32_bf16 v[60:63], a[4:7], a[176:179], v[60:63]
    v_exp_f32 v103, v79
    v_mfma_f32_16x16x32_bf16 v[56:59], a[4:7], a[144:147], v[56:59]
    v_cvt_pk_bf16_f32 v95, v102, v103
    s_waitcnt lgkmcnt(4)
    v_mfma_f32_16x16x32_bf16 v[48:51], a[8:11], a[148:151], v[48:51]
    ds_read_b128 a[0:3], v7 offset:49152
    ds_read_b128 a[4:7], v7 offset:50176
    v_mfma_f32_16x16x32_bf16 v[52:55], a[8:11], a[180:183], v[52:55]
    v_or3_b32 v11, v88, v89, v90
    v_or3_b32 v11, v11, v91, v92
    v_mfma_f32_16x16x32_bf16 v[60:63], a[12:15], a[180:183], v[60:63]
    buffer_load_dwordx4 v30, s[4:7], s24 offen offset:2048 sc1 lds
    v_mfma_f32_16x16x32_bf16 v[56:59], a[12:15], a[148:151], v[56:59]
    v_or3_b32 v11, v11, v93, v94
    s_waitcnt lgkmcnt(4)
    v_mfma_f32_16x16x32_bf16 v[48:51], a[16:19], a[152:155], v[48:51]
    ds_read_b128 a[8:11], v7 offset:51200
    ds_read_b128 a[12:15], v7 offset:52224
    v_mfma_f32_16x16x32_bf16 v[52:55], a[16:19], a[184:187], v[52:55]
    v_bitop3_b32 v11, v11, v95, s65 bitop3:0xa8
    v_cmp_ne_u32 vcc, 0, v11
    v_mfma_f32_16x16x32_bf16 v[60:63], a[20:23], a[184:187], v[60:63]
    v_mfma_f32_16x16x32_bf16 v[56:59], a[20:23], a[152:155], v[56:59]
    s_cbranch_vccnz at_x_rs1
at_x_rs1_ret:
    s_waitcnt lgkmcnt(4)
    v_mfma_f32_16x16x32_bf16 v[48:51], a[24:27], a[156:159], v[48:51]
    ds_read_b128 a[16:19], v7 offset:53248
    ds_read_b128 a[20:23], v7 offset:54272
    v_mfma_f32_16x16x32_bf16 v[52:55], a[24:27], a[188:191], v[52:55]
    buffer_load_dwordx4 v30, s[4:7], s24 offen offset:3072 sc1 lds
    v_mfma_f32_16x16x32_bf16 v[60:63], a[28:31], a[188:191], v[60:63]
    s_add_u32 s24, s24, 32768
    s_mov_b32 m0, s67
    v_mfma_f32_16x16x32_bf16 v[56:59], a[28:31], a[156:159], v[56:59]
    s_waitcnt vmcnt(12)
    s_barrier
    v_mfma_f32_16x16x32_bf16 v[104:107], v[112:115], v[88:91], v[104:107]
    buffer_load_dwordx4 v30, s[4:7], s29 offen offset:0 sc1 lds
    v_mfma_f32_16x16x32_bf16 v[108:111], v[112:115], v[92:95], v[108:111]
    s_waitcnt lgkmcnt(4)
    v_mfma_f32_16x16x32_bf16 v[132:135], v[92:95], a[0:3], v[132:135]
    ds_read_b128 a[24:27], v7 offset:55296
    ds_read_b128 a[28:31], v7 offset:56320
    v_mfma_f32_16x16x32_bf16 v[128:131], v[88:91], a[0:3], v[128:131]
    v_exp_f32 v96, v48
    v_mfma_f32_16x16x32_bf16 v[136:139], v[88:91], a[4:7], v[136:139]
    v_exp_f32 v97, v49
    v_mfma_f32_16x16x32_bf16 v[140:143], v[92:95], a[4:7], v[140:143]
    v_cvt_pk_bf16_f32 v80, v96, v97
    s_waitcnt lgkmcnt(4)
    v_mfma_f32_16x16x32_bf16 v[148:151], v[92:95], a[8:11], v[148:151]
    ds_read_b128 a[0:3], v7 offset:57344
    ds_read_b128 a[4:7], v7 offset:58368
    v_mfma_f32_16x16x32_bf16 v[144:147], v[88:91], a[8:11], v[144:147]
    v_exp_f32 v98, v50
    v_mfma_f32_16x16x32_bf16 v[152:155], v[88:91], a[12:15], v[152:155]
    buffer_load_dwordx4 v30, s[4:7], s29 offen offset:1024 sc1 lds
    s_add_u32 s67, s28, 49152
    v_mfma_f32_16x16x32_bf16 v[156:159], v[92:95], a[12:15], v[156:159]
    s_add_u32 s28, s28, 32768
    s_waitcnt lgkmcnt(4)
    v_mfma_f32_16x16x32_bf16 v[164:167], v[92:95], a[16:19], v[164:167]
    ds_read_b128 a[8:11], v7 offset:59392
    ds_read_b128 a[12:15], v7 offset:60416
    v_mfma_f32_16x16x32_bf16 v[160:163], v[88:91], a[16:19], v[160:163]
    v_exp_f32 v99, v51
    v_mfma_f32_16x16x32_bf16 v[168:171], v[88:91], a[20:23], v[168:171]
    v_exp_f32 v100, v56
    v_mfma_f32_16x16x32_bf16 v[172:175], v[92:95], a[20:23], v[172:175]
    v_cvt_pk_bf16_f32 v81, v98, v99
    s_waitcnt lgkmcnt(4)
    v_mfma_f32_16x16x32_bf16 v[180:183], v[92:95], a[24:27], v[180:183]
    ds_read_b128 a[16:19], v7 offset:61440
    ds_read_b128 a[20:23], v7 offset:62464
    v_mfma_f32_16x16x32_bf16 v[176:179], v[88:91], a[24:27], v[176:179]
    v_exp_f32 v101, v57
    v_mfma_f32_16x16x32_bf16 v[184:187], v[88:91], a[28:31], v[184:187]
    buffer_load_dwordx4 v30, s[4:7], s29 offen offset:2048 sc1 lds
    s_and_b32 s28, s28, 0x1ffff
    v_mfma_f32_16x16x32_bf16 v[188:191], v[92:95], a[28:31], v[188:191]
    v_cvt_pk_bf16_f32 v82, v100, v101
    s_waitcnt lgkmcnt(4)
    v_mfma_f32_16x16x32_bf16 v[196:199], v[92:95], a[0:3], v[196:199]
    ds_read_b128 a[24:27], v7 offset:63488
    ds_read_b128 a[28:31], v7 offset:64512
    v_mfma_f32_16x16x32_bf16 v[192:195], v[88:91], a[0:3], v[192:195]
    v_exp_f32 v102, v58
    v_mfma_f32_16x16x32_bf16 v[200:203], v[88:91], a[4:7], v[200:203]
    v_xor_b32 v7, 0x10000, v7
    s_add_u32 s30, s30, 1
    v_mfma_f32_16x16x32_bf16 v[204:207], v[92:95], a[4:7], v[204:207]
    s_waitcnt lgkmcnt(4)
    v_mfma_f32_16x16x32_bf16 v[212:215], v[92:95], a[8:11], v[212:215]
    ds_read_b128 a[0:3], v7 offset:32768
    ds_read_b128 a[4:7], v7 offset:40960
    v_mfma_f32_16x16x32_bf16 v[208:211], v[88:91], a[8:11], v[208:211]
    v_exp_f32 v103, v59
    v_mfma_f32_16x16x32_bf16 v[216:219], v[88:91], a[12:15], v[216:219]
    buffer_load_dwordx4 v30, s[4:7], s29 offen offset:3072 sc1 lds
    v_mfma_f32_16x16x32_bf16 v[220:223], v[92:95], a[12:15], v[220:223]
    v_cvt_pk_bf16_f32 v83, v102, v103
    s_waitcnt lgkmcnt(4)
    v_mfma_f32_16x16x32_bf16 v[228:231], v[92:95], a[16:19], v[228:231]
    ds_read_b128 a[8:11], v7 offset:33792
    ds_read_b128 a[12:15], v7 offset:41984
    v_mfma_f32_16x16x32_bf16 v[224:227], v[88:91], a[16:19], v[224:227]
    s_cmp_eq_u32 s24, s25
    s_cselect_b32 s24, s26, s24
    v_mfma_f32_16x16x32_bf16 v[232:235], v[88:91], a[20:23], v[232:235]
    s_cselect_b32 s25, s27, s25
    s_cselect_b32 s26, 1073741824, s26
    v_mfma_f32_16x16x32_bf16 v[236:239], v[92:95], a[20:23], v[236:239]
    s_add_u32 m0, s28, 32768
    s_waitcnt lgkmcnt(4)
    v_mfma_f32_16x16x32_bf16 v[244:247], v[92:95], a[24:27], v[244:247]
    ds_read_b128 a[16:19], v7 offset:34816
    ds_read_b128 a[20:23], v7 offset:43008
    v_mfma_f32_16x16x32_bf16 v[240:243], v[88:91], a[24:27], v[240:243]
    s_cmp_ge_i32 s30, s9
    s_cbranch_scc1 at_x_ev0
at_x_ev0_ret:
    v_mfma_f32_16x16x32_bf16 v[248:251], v[88:91], a[28:31], v[248:251]
    s_cmp_lg_u32 s30, s31
    v_mfma_f32_16x16x32_bf16 v[252:255], v[92:95], a[28:31], v[252:255]
    s_cbranch_scc1 at_x_loop
    s_branch at_x_tail0
at_x_ev0:
    s_cmp_ge_i32 s30, s10
    s_cbranch_scc0 e_24
    s_cmp_eq_u32 s20, 0
    s_cbranch_scc0 sig_26
    v_mov_b32 v2, 1
    v_mov_b32 v3, 0
    s_mov_b64 exec, 1
    buffer_atomic_add v2, v3, s[4:7], s33 offen sc1
    s_mov_b64 exec, -1
sig_26:
    s_mov_b32 s10, 2147483647
    s_sub_u32 s9, s64, 1
e_24:
    s_branch at_x_ev0_ret
at_x_rs0:
    v_max3_f32 v118, v48, v49, v50
    v_max3_f32 v119, v51, v56, v57
    v_max3_f32 v118, v118, v58, v59
    v_max_f32 v118, v118, v119
    v_mov_b32 v119, v118
    s_nop 1
    v_permlane32_swap_b32 v118, v119
    v_max_f32 v118, v118, v119
    v_mov_b32 v119, v118
    s_nop 1
    v_permlane16_swap_b32 v118, v119
    v_max_f32 v118, v118, v119
    v_add_f32 v118, 0x40e00000, v118
    v_ceil_f32 v118, v118
    v_max_f32 v118, 0, v118
    v_exp_f32 v119, -v118
    v_sub_f32 v116, v116, v118
    v_sub_f32 v32, v32, v118
    v_sub_f32 v33, v33, v118
    v_sub_f32 v34, v34, v118
    v_sub_f32 v35, v35, v118
    v_sub_f32 v40, v40, v118
    v_sub_f32 v41, v41, v118
    v_sub_f32 v42, v42, v118
    v_sub_f32 v43, v43, v118
    v_sub_f32 v48, v48, v118
    v_sub_f32 v49, v49, v118
    v_sub_f32 v50, v50, v118
    v_sub_f32 v51, v51, v118
    v_sub_f32 v56, v56, v118
    v_sub_f32 v57, v57, v118
    v_sub_f32 v58, v58, v118
    v_sub_f32 v59, v59, v118
    v_sub_f32 v64, v64, v118
    v_sub_f32 v65, v65, v118
    v_sub_f32 v66, v66, v118
    v_sub_f32 v67, v67, v118
    v_sub_f32 v72, v72, v118
    v_sub_f32 v73, v73, v118
    v_sub_f32 v74, v74, v118
    v_sub_f32 v75, v75, v118
    v_mul_f32 v104, v104, v119
    v_mul_f32 v105, v105, v119
    v_mul_f32 v106, v106, v119
    v_mul_f32 v107, v107, v119
    v_lshrrev_b32 v120, 4, v1
    v_lshlrev_b32 v120, 4, v120
    ds_bpermute_b32 v96, v120, v119 offset:0
    ds_bpermute_b32 v97, v120, v119 offset:4
    ds_bpermute_b32 v98, v120, v119 offset:8
    ds_bpermute_b32 v99, v120, v119 offset:12
    s_waitcnt lgkmcnt(3)
    v_mul_f32 v128, v128, v96
    s_waitcnt lgkmcnt(2)
    v_mul_f32 v129, v129, v97
    s_waitcnt lgkmcnt(1)
    v_mul_f32 v130, v130, v98
    s_waitcnt lgkmcnt(0)
    v_mul_f32 v131, v131, v99
    v_mul_f32 v136, v136, v96
    v_mul_f32 v137, v137, v97
    v_mul_f32 v138, v138, v98
    v_mul_f32 v139, v139, v99
    v_mul_f32 v144, v144, v96
    v_mul_f32 v145, v145, v97
    v_mul_f32 v146, v146, v98
    v_mul_f32 v147, v147, v99
    v_mul_f32 v152, v152, v96
    v_mul_f32 v153, v153, v97
    v_mul_f32 v154, v154, v98
    v_mul_f32 v155, v155, v99
    v_mul_f32 v160, v160, v96
    v_mul_f32 v161, v161, v97
    v_mul_f32 v162, v162, v98
    v_mul_f32 v163, v163, v99
    v_mul_f32 v168, v168, v96
    v_mul_f32 v169, v169, v97
    v_mul_f32 v170, v170, v98
    v_mul_f32 v171, v171, v99
    v_mul_f32 v176, v176, v96
    v_mul_f32 v177, v177, v97
    v_mul_f32 v178, v178, v98
    v_mul_f32 v179, v179, v99
    v_mul_f32 v184, v184, v96
    v_mul_f32 v185, v185, v97
    v_mul_f32 v186, v186, v98
    v_mul_f32 v187, v187, v99
    v_mul_f32 v192, v192, v96
    v_mul_f32 v193, v193, v97
    v_mul_f32 v194, v194, v98
    v_mul_f32 v195, v195, v99
    v_mul_f32 v200, v200, v96
    v_mul_f32 v201, v201, v97
    v_mul_f32 v202, v202, v98
    v_mul_f32 v203, v203, v99
    v_mul_f32 v208, v208, v96
    v_mul_f32 v209, v209, v97
    v_mul_f32 v210, v210, v98
    v_mul_f32 v211, v211, v99
    v_mul_f32 v216, v216, v96
    v_mul_f32 v217, v217, v97
    v_mul_f32 v218, v218, v98
    v_mul_f32 v219, v219, v99
    v_mul_f32 v224, v224, v96
    v_mul_f32 v225, v225, v97
    v_mul_f32 v226, v226, v98
    v_mul_f32 v227, v227, v99
    v_mul_f32 v232, v232, v96
    v_mul_f32 v233, v233, v97
    v_mul_f32 v234, v234, v98
    v_mul_f32 v235, v235, v99
    v_mul_f32 v240, v240, v96
    v_mul_f32 v241, v241, v97
    v_mul_f32 v242, v242, v98
    v_mul_f32 v243, v243, v99
    v_mul_f32 v248, v248, v96
    v_mul_f32 v249, v249, v97
    v_mul_f32 v250, v250, v98
    v_mul_f32 v251, v251, v99
    v_exp_f32 v96, v48
    v_exp_f32 v97, v49
    v_exp_f32 v98, v50
    v_cvt_pk_bf16_f32 v80, v96, v97
    v_exp_f32 v99, v51
    v_exp_f32 v100, v56
    v_cvt_pk_bf16_f32 v81, v98, v99
    v_exp_f32 v101, v57
    v_exp_f32 v102, v58
    v_cvt_pk_bf16_f32 v82, v100, v101
    v_exp_f32 v103, v59
    s_nop 0
    v_cvt_pk_bf16_f32 v83, v102, v103
    v_max3_f32 v122, v52, v53, v54
    v_max3_f32 v123, v55, v60, v61
    v_max3_f32 v122, v122, v62, v63
    v_max_f32 v122, v122, v123
    v_mov_b32 v123, v122
    s_nop 1
    v_permlane32_swap_b32 v122, v123
    v_max_f32 v122, v122, v123
    v_mov_b32 v123, v122
    s_nop 1
    v_permlane16_swap_b32 v122, v123
    v_max_f32 v122, v122, v123
    v_add_f32 v122, 0x40e00000, v122
    v_ceil_f32 v122, v122
    v_max_f32 v122, 0, v122
    v_exp_f32 v123, -v122
    v_sub_f32 v117, v117, v122
    v_sub_f32 v36, v36, v122
    v_sub_f32 v37, v37, v122
    v_sub_f32 v38, v38, v122
    v_sub_f32 v39, v39, v122
    v_sub_f32 v44, v44, v122
    v_sub_f32 v45, v45, v122
    v_sub_f32 v46, v46, v122
    v_sub_f32 v47, v47, v122
    v_sub_f32 v52, v52, v122
    v_sub_f32 v53, v53, v122
    v_sub_f32 v54, v54, v122
    v_sub_f32 v55, v55, v122
    v_sub_f32 v60, v60, v122
    v_sub_f32 v61, v61, v122
    v_sub_f32 v62, v62, v122
    v_sub_f32 v63, v63, v122
    v_sub_f32 v68, v68, v122
    v_sub_f32 v69, v69, v122
    v_sub_f32 v70, v70, v122
    v_sub_f32 v71, v71, v122
    v_sub_f32 v76, v76, v122
    v_sub_f32 v77, v77, v122
    v_sub_f32 v78, v78, v122
    v_sub_f32 v79, v79, v122
    v_mul_f32 v108, v108, v123
    v_mul_f32 v109, v109, v123
    v_mul_f32 v110, v110, v123
    v_mul_f32 v111, v111, v123
    v_lshrrev_b32 v124, 4, v1
    v_lshlrev_b32 v124, 4, v124
    ds_bpermute_b32 v96, v124, v123 offset:0
    ds_bpermute_b32 v97, v124, v123 offset:4
    ds_bpermute_b32 v98, v124, v123 offset:8
    ds_bpermute_b32 v99, v124, v123 offset:12
    s_waitcnt lgkmcnt(3)
    v_mul_f32 v132, v132, v96
    s_waitcnt lgkmcnt(2)
    v_mul_f32 v133, v133, v97
    s_waitcnt lgkmcnt(1)
    v_mul_f32 v134, v134, v98
    s_waitcnt lgkmcnt(0)
    v_mul_f32 v135, v135, v99
    v_mul_f32 v140, v140, v96
    v_mul_f32 v141, v141, v97
    v_mul_f32 v142, v142, v98
    v_mul_f32 v143, v143, v99
    v_mul_f32 v148, v148, v96
    v_mul_f32 v149, v149, v97
    v_mul_f32 v150, v150, v98
    v_mul_f32 v151, v151, v99
    v_mul_f32 v156, v156, v96
    v_mul_f32 v157, v157, v97
    v_mul_f32 v158, v158, v98
    v_mul_f32 v159, v159, v99
    v_mul_f32 v164, v164, v96
    v_mul_f32 v165, v165, v97
    v_mul_f32 v166, v166, v98
    v_mul_f32 v167, v167, v99
    v_mul_f32 v172, v172, v96
    v_mul_f32 v173, v173, v97
    v_mul_f32 v174, v174, v98
    v_mul_f32 v175, v175, v99
    v_mul_f32 v180, v180, v96
    v_mul_f32 v181, v181, v97
    v_mul_f32 v182, v182, v98
    v_mul_f32 v183, v183, v99
    v_mul_f32 v188, v188, v96
    v_mul_f32 v189, v189, v97
    v_mul_f32 v190, v190, v98
    v_mul_f32 v191, v191, v99
    v_mul_f32 v196, v196, v96
    v_mul_f32 v197, v197, v97
    v_mul_f32 v198, v198, v98
    v_mul_f32 v199, v199, v99
    v_mul_f32 v204, v204, v96
    v_mul_f32 v205, v205, v97
    v_mul_f32 v206, v206, v98
    v_mul_f32 v207, v207, v99
    v_mul_f32 v212, v212, v96
    v_mul_f32 v213, v213, v97
    v_mul_f32 v214, v214, v98
    v_mul_f32 v215, v215, v99
    v_mul_f32 v220, v220, v96
    v_mul_f32 v221, v221, v97
    v_mul_f32 v222, v222, v98
    v_mul_f32 v223, v223, v99
    v_mul_f32 v228, v228, v96
    v_mul_f32 v229, v229, v97
    v_mul_f32 v230, v230, v98
    v_mul_f32 v231, v231, v99
    v_mul_f32 v236, v236, v96
    v_mul_f32 v237, v237, v97
    v_mul_f32 v238, v238, v98
    v_mul_f32 v239, v239, v99
    v_mul_f32 v244, v244, v96
    v_mul_f32 v245, v245, v97
    v_mul_f32 v246, v246, v98
    v_mul_f32 v247, v247, v99
    v_mul_f32 v252, v252, v96
    v_mul_f32 v253, v253, v97
    v_mul_f32 v254, v254, v98
    v_mul_f32 v255, v255, v99
    v_exp_f32 v96, v52
    v_exp_f32 v97, v53
    v_exp_f32 v98, v54
    v_cvt_pk_bf16_f32 v84, v96, v97
    v_exp_f32 v99, v55
    v_exp_f32 v100, v60
    v_cvt_pk_bf16_f32 v85, v98, v99
    v_exp_f32 v101, v61
    v_exp_f32 v102, v62
    v_cvt_pk_bf16_f32 v86, v100, v101
    v_exp_f32 v103, v63
    s_nop 0
    v_cvt_pk_bf16_f32 v87, v102, v103
    s_branch at_x_rs0_ret
at_x_rt0:
    v_max3_f32 v118, v48, v49, v50
    v_max3_f32 v119, v51, v56, v57
    v_max3_f32 v118, v118, v58, v59
    v_max_f32 v118, v118, v119
    v_mov_b32 v119, v118
    s_nop 1
    v_permlane32_swap_b32 v118, v119
    v_max_f32 v118, v118, v119
    v_mov_b32 v119, v118
    s_nop 1
    v_permlane16_swap_b32 v118, v119
    v_max_f32 v118, v118, v119
    v_add_f32 v118, 0x40e00000, v118
    v_ceil_f32 v118, v118
    v_max_f32 v118, 0, v118
    v_exp_f32 v119, -v118
    v_sub_f32 v116, v116, v118
    v_sub_f32 v32, v32, v118
    v_sub_f32 v33, v33, v118
    v_sub_f32 v34, v34, v118
    v_sub_f32 v35, v35, v118
    v_sub_f32 v40, v40, v118
    v_sub_f32 v41, v41, v118
    v_sub_f32 v42, v42, v118
    v_sub_f32 v43, v43, v118
    v_sub_f32 v48, v48, v118
    v_sub_f32 v49, v49, v118
    v_sub_f32 v50, v50, v118
    v_sub_f32 v51, v51, v118
    v_sub_f32 v56, v56, v118
    v_sub_f32 v57, v57, v118
    v_sub_f32 v58, v58, v118
    v_sub_f32 v59, v59, v118
    v_mul_f32 v104, v104, v119
    v_mul_f32 v105, v105, v119
    v_mul_f32 v106, v106, v119
    v_mul_f32 v107, v107, v119
    v_lshrrev_b32 v120, 4, v1
    v_lshlrev_b32 v120, 4, v120
    ds_bpermute_b32 v96, v120, v119 offset:0
    ds_bpermute_b32 v97, v120, v119 offset:4
    ds_bpermute_b32 v98, v120, v119 offset:8
    ds_bpermute_b32 v99, v120, v119 offset:12
    s_waitcnt lgkmcnt(3)
    v_mul_f32 v128, v128, v96
    s_waitcnt lgkmcnt(2)
    v_mul_f32 v129, v129, v97
    s_waitcnt lgkmcnt(1)
    v_mul_f32 v130, v130, v98
    s_waitcnt lgkmcnt(0)
    v_mul_f32 v131, v131, v99
    v_mul_f32 v136, v136, v96
    v_mul_f32 v137, v137, v97
    v_mul_f32 v138, v138, v98
    v_mul_f32 v139, v139, v99
    v_mul_f32 v144, v144, v96
    v_mul_f32 v145, v145, v97
    v_mul_f32 v146, v146, v98
    v_mul_f32 v147, v147, v99
    v_mul_f32 v152, v152, v96
    v_mul_f32 v153, v153, v97
    v_mul_f32 v154, v154, v98
    v_mul_f32 v155, v155, v99
    v_mul_f32 v160, v160, v96
    v_mul_f32 v161, v161, v97
    v_mul_f32 v162, v162, v98
    v_mul_f32 v163, v163, v99
    v_mul_f32 v168, v168, v96
    v_mul_f32 v169, v169, v97
    v_mul_f32 v170, v170, v98
    v_mul_f32 v171, v171, v99
    v_mul_f32 v176, v176, v96
    v_mul_f32 v177, v177, v97
    v_mul_f32 v178, v178, v98
    v_mul_f32 v179, v179, v99
    v_mul_f32 v184, v184, v96
    v_mul_f32 v185, v185, v97
    v_mul_f32 v186, v186, v98
    v_mul_f32 v187, v187, v99
    v_mul_f32 v192, v192, v96
    v_mul_f32 v193, v193, v97
    v_mul_f32 v194, v194, v98
    v_mul_f32 v195, v195, v99
    v_mul_f32 v200, v200, v96
    v_mul_f32 v201, v201, v97
    v_mul_f32 v202, v202, v98
    v_mul_f32 v203, v203, v99
    v_mul_f32 v208, v208, v96
    v_mul_f32 v209, v209, v97
    v_mul_f32 v210, v210, v98
    v_mul_f32 v211, v211, v99
    v_mul_f32 v216, v216, v96
    v_mul_f32 v217, v217, v97
    v_mul_f32 v218, v218, v98
    v_mul_f32 v219, v219, v99
    v_mul_f32 v224, v224, v96
    v_mul_f32 v225, v225, v97
    v_mul_f32 v226, v226, v98
    v_mul_f32 v227, v227, v99
    v_mul_f32 v232, v232, v96
    v_mul_f32 v233, v233, v97
    v_mul_f32 v234, v234, v98
    v_mul_f32 v235, v235, v99
    v_mul_f32 v240, v240, v96
    v_mul_f32 v241, v241, v97
    v_mul_f32 v242, v242, v98
    v_mul_f32 v243, v243, v99
    v_mul_f32 v248, v248, v96
    v_mul_f32 v249, v249, v97
    v_mul_f32 v250, v250, v98
    v_mul_f32 v251, v251, v99
    v_exp_f32 v96, v48
    v_exp_f32 v97, v49
    v_exp_f32 v98, v50
    v_cvt_pk_bf16_f32 v80, v96, v97
    v_exp_f32 v99, v51
    v_exp_f32 v100, v56
    v_cvt_pk_bf16_f32 v81, v98, v99
    v_exp_f32 v101, v57
    v_exp_f32 v102, v58
    v_cvt_pk_bf16_f32 v82, v100, v101
    v_exp_f32 v103, v59
    s_nop 0
    v_cvt_pk_bf16_f32 v83, v102, v103
    v_max3_f32 v122, v52, v53, v54
    v_max3_f32 v123, v55, v60, v61
    v_max3_f32 v122, v122, v62, v63
    v_max_f32 v122, v122, v123
    v_mov_b32 v123, v122
    s_nop 1
    v_permlane32_swap_b32 v122, v123
    v_max_f32 v122, v122, v123
    v_mov_b32 v123, v122
    s_nop 1
    v_permlane16_swap_b32 v122, v123
    v_max_f32 v122, v122, v123
    v_add_f32 v122, 0x40e00000, v122
    v_ceil_f32 v122, v122
    v_max_f32 v122, 0, v122
    v_exp_f32 v123, -v122
    v_sub_f32 v117, v117, v122
    v_sub_f32 v36, v36, v122
    v_sub_f32 v37, v37, v122
    v_sub_f32 v38, v38, v122
    v_sub_f32 v39, v39, v122
    v_sub_f32 v44, v44, v122
    v_sub_f32 v45, v45, v122
    v_sub_f32 v46, v46, v122
    v_sub_f32 v47, v47, v122
    v_sub_f32 v52, v52, v122
    v_sub_f32 v53, v53, v122
    v_sub_f32 v54, v54, v122
    v_sub_f32 v55, v55, v122
    v_sub_f32 v60, v60, v122
    v_sub_f32 v61, v61, v122
    v_sub_f32 v62, v62, v122
    v_sub_f32 v63, v63, v122
    v_mul_f32 v108, v108, v123
    v_mul_f32 v109, v109, v123
    v_mul_f32 v110, v110, v123
    v_mul_f32 v111, v111, v123
    v_lshrrev_b32 v124, 4, v1
    v_lshlrev_b32 v124, 4, v124
    ds_bpermute_b32 v96, v124, v123 offset:0
    ds_bpermute_b32 v97, v124, v123 offset:4
    ds_bpermute_b32 v98, v124, v123 offset:8
    ds_bpermute_b32 v99, v124, v123 offset:12
    s_waitcnt lgkmcnt(3)
    v_mul_f32 v132, v132, v96
    s_waitcnt lgkmcnt(2)
    v_mul_f32 v133, v133, v97
    s_waitcnt lgkmcnt(1)
    v_mul_f32 v134, v134, v98
    s_waitcnt lgkmcnt(0)
    v_mul_f32 v135, v135, v99
    v_mul_f32 v140, v140, v96
    v_mul_f32 v141, v141, v97
    v_mul_f32 v142, v142, v98
    v_mul_f32 v143, v143, v99
    v_mul_f32 v148, v148, v96
    v_mul_f32 v149, v149, v97
    v_mul_f32 v150, v150, v98
    v_mul_f32 v151, v151, v99
    v_mul_f32 v156, v156, v96
    v_mul_f32 v157, v157, v97
    v_mul_f32 v158, v158, v98
    v_mul_f32 v159, v159, v99
    v_mul_f32 v164, v164, v96
    v_mul_f32 v165, v165, v97
    v_mul_f32 v166, v166, v98
    v_mul_f32 v167, v167, v99
    v_mul_f32 v172, v172, v96
    v_mul_f32 v173, v173, v97
    v_mul_f32 v174, v174, v98
    v_mul_f32 v175, v175, v99
    v_mul_f32 v180, v180, v96
    v_mul_f32 v181, v181, v97
    v_mul_f32 v182, v182, v98
    v_mul_f32 v183, v183, v99
    v_mul_f32 v188, v188, v96
    v_mul_f32 v189, v189, v97
    v_mul_f32 v190, v190, v98
    v_mul_f32 v191, v191, v99
    v_mul_f32 v196, v196, v96
    v_mul_f32 v197, v197, v97
    v_mul_f32 v198, v198, v98
    v_mul_f32 v199, v199, v99
    v_mul_f32 v204, v204, v96
    v_mul_f32 v205, v205, v97
    v_mul_f32 v206, v206, v98
    v_mul_f32 v207, v207, v99
    v_mul_f32 v212, v212, v96
    v_mul_f32 v213, v213, v97
    v_mul_f32 v214, v214, v98
    v_mul_f32 v215, v215, v99
    v_mul_f32 v220, v220, v96
    v_mul_f32 v221, v221, v97
    v_mul_f32 v222, v222, v98
    v_mul_f32 v223, v223, v99
    v_mul_f32 v228, v228, v96
    v_mul_f32 v229, v229, v97
    v_mul_f32 v230, v230, v98
    v_mul_f32 v231, v231, v99
    v_mul_f32 v236, v236, v96
    v_mul_f32 v237, v237, v97
    v_mul_f32 v238, v238, v98
    v_mul_f32 v239, v239, v99
    v_mul_f32 v244, v244, v96
    v_mul_f32 v245, v245, v97
    v_mul_f32 v246, v246, v98
    v_mul_f32 v247, v247, v99
    v_mul_f32 v252, v252, v96
    v_mul_f32 v253, v253, v97
    v_mul_f32 v254, v254, v98
    v_mul_f32 v255, v255, v99
    v_exp_f32 v96, v52
    v_exp_f32 v97, v53
    v_exp_f32 v98, v54
    v_cvt_pk_bf16_f32 v84, v96, v97
    v_exp_f32 v99, v55
    v_exp_f32 v100, v60
    v_cvt_pk_bf16_f32 v85, v98, v99
    v_exp_f32 v101, v61
    v_exp_f32 v102, v62
    v_cvt_pk_bf16_f32 v86, v100, v101
    v_exp_f32 v103, v63
    s_nop 0
    v_cvt_pk_bf16_f32 v87, v102, v103
    s_branch at_x_rt0_ret
at_x_ev1:
    s_cmp_ge_i32 s30, s10
    s_cbranch_scc0 e_27
    s_cmp_eq_u32 s20, 0
    s_cbranch_scc0 sig_29
    v_mov_b32 v2, 1
    v_mov_b32 v3, 0
    s_mov_b64 exec, 1
    buffer_atomic_add v2, v3, s[4:7], s33 offen sc1
    s_mov_b64 exec, -1
sig_29:
    s_mov_b32 s10, 2147483647
    s_sub_u32 s9, s64, 1
e_27:
    s_branch at_x_ev1_ret
at_x_rs1:
    v_max3_f32 v118, v64, v65, v66
    v_max3_f32 v119, v67, v72, v73
    v_max3_f32 v118, v118, v74, v75
    v_max_f32 v118, v118, v119
    v_mov_b32 v119, v118
    s_nop 1
    v_permlane32_swap_b32 v118, v119
    v_max_f32 v118, v118, v119
    v_mov_b32 v119, v118
    s_nop 1
    v_permlane16_swap_b32 v118, v119
    v_max_f32 v118, v118, v119
    v_add_f32 v118, 0x40e00000, v118
    v_ceil_f32 v118, v118
    v_max_f32 v118, 0, v118
    v_exp_f32 v119, -v118
    v_sub_f32 v116, v116, v118
    v_sub_f32 v32, v32, v118
    v_sub_f32 v33, v33, v118
    v_sub_f32 v34, v34, v118
    v_sub_f32 v35, v35, v118
    v_sub_f32 v40, v40, v118
    v_sub_f32 v41, v41, v118
    v_sub_f32 v42, v42, v118
    v_sub_f32 v43, v43, v118
    v_sub_f32 v64, v64, v118
    v_sub_f32 v65, v65, v118
    v_sub_f32 v66, v66, v118
    v_sub_f32 v67, v67, v118
    v_sub_f32 v72, v72, v118
    v_sub_f32 v73, v73, v118
    v_sub_f32 v74, v74, v118
    v_sub_f32 v75, v75, v118
    v_sub_f32 v48, v48, v118
    v_sub_f32 v49, v49, v118
    v_sub_f32 v50, v50, v118
    v_sub_f32 v51, v51, v118
    v_sub_f32 v56, v56, v118
    v_sub_f32 v57, v57, v118
    v_sub_f32 v58, v58, v118
    v_sub_f32 v59, v59, v118
    v_mul_f32 v104, v104, v119
    v_mul_f32 v105, v105, v119
    v_mul_f32 v106, v106, v119
    v_mul_f32 v107, v107, v119
    v_lshrrev_b32 v120, 4, v1
    v_lshlrev_b32 v120, 4, v120
    ds_bpermute_b32 v96, v120, v119 offset:0
    ds_bpermute_b32 v97, v120, v119 offset:4
    ds_bpermute_b32 v98, v120, v119 offset:8
    ds_bpermute_b32 v99, v120, v119 offset:12
    s_waitcnt lgkmcnt(3)
    v_mul_f32 v128, v128, v96
    s_waitcnt lgkmcnt(2)
    v_mul_f32 v129, v129, v97
    s_waitcnt lgkmcnt(1)
    v_mul_f32 v130, v130, v98
    s_waitcnt lgkmcnt(0)
    v_mul_f32 v131, v131, v99
    v_mul_f32 v136, v136, v96
    v_mul_f32 v137, v137, v97
    v_mul_f32 v138, v138, v98
    v_mul_f32 v139, v139, v99
    v_mul_f32 v144, v144, v96
    v_mul_f32 v145, v145, v97
    v_mul_f32 v146, v146, v98
    v_mul_f32 v147, v147, v99
    v_mul_f32 v152, v152, v96
    v_mul_f32 v153, v153, v97
    v_mul_f32 v154, v154, v98
    v_mul_f32 v155, v155, v99
    v_mul_f32 v160, v160, v96
    v_mul_f32 v161, v161, v97
    v_mul_f32 v162, v162, v98
    v_mul_f32 v163, v163, v99
    v_mul_f32 v168, v168, v96
    v_mul_f32 v169, v169, v97
    v_mul_f32 v170, v170, v98
    v_mul_f32 v171, v171, v99
    v_mul_f32 v176, v176, v96
    v_mul_f32 v177, v177, v97
    v_mul_f32 v178, v178, v98
    v_mul_f32 v179, v179, v99
    v_mul_f32 v184, v184, v96
    v_mul_f32 v185, v185, v97
    v_mul_f32 v186, v186, v98
    v_mul_f32 v187, v187, v99
    v_mul_f32 v192, v192, v96
    v_mul_f32 v193, v193, v97
    v_mul_f32 v194, v194, v98
    v_mul_f32 v195, v195, v99
    v_mul_f32 v200, v200, v96
    v_mul_f32 v201, v201, v97
    v_mul_f32 v202, v202, v98
    v_mul_f32 v203, v203, v99
    v_mul_f32 v208, v208, v96
    v_mul_f32 v209, v209, v97
    v_mul_f32 v210, v210, v98
    v_mul_f32 v211, v211, v99
    v_mul_f32 v216, v216, v96
    v_mul_f32 v217, v217, v97
    v_mul_f32 v218, v218, v98
    v_mul_f32 v219, v219, v99
    v_mul_f32 v224, v224, v96
    v_mul_f32 v225, v225, v97
    v_mul_f32 v226, v226, v98
    v_mul_f32 v227, v227, v99
    v_mul_f32 v232, v232, v96
    v_mul_f32 v233, v233, v97
    v_mul_f32 v234, v234, v98
    v_mul_f32 v235, v235, v99
    v_mul_f32 v240, v240, v96
    v_mul_f32 v241, v241, v97
    v_mul_f32 v242, v242, v98
    v_mul_f32 v243, v243, v99
    v_mul_f32 v248, v248, v96
    v_mul_f32 v249, v249, v97
    v_mul_f32 v250, v250, v98
    v_mul_f32 v251, v251, v99
    v_exp_f32 v96, v64
    v_exp_f32 v97, v65
    v_exp_f32 v98, v66
    v_cvt_pk_bf16_f32 v88, v96, v97
    v_exp_f32 v99, v67
    v_exp_f32 v100, v72
    v_cvt_pk_bf16_f32 v89, v98, v99
    v_exp_f32 v101, v73
    v_exp_f32 v102, v74
    v_cvt_pk_bf16_f32 v90, v100, v101
    v_exp_f32 v103, v75
    s_nop 0
    v_cvt_pk_bf16_f32 v91, v102, v103
    v_max3_f32 v122, v68, v69, v70
    v_max3_f32 v123, v71, v76, v77
    v_max3_f32 v122, v122, v78, v79
    v_max_f32 v122, v122, v123
    v_mov_b32 v123, v122
    s_nop 1
    v_permlane32_swap_b32 v122, v123
    v_max_f32 v122, v122, v123
    v_mov_b32 v123, v122
    s_nop 1
    v_permlane16_swap_b32 v122, v123
    v_max_f32 v122, v122, v123
    v_add_f32 v122, 0x40e00000, v122
    v_ceil_f32 v122, v122
    v_max_f32 v122, 0, v122
    v_exp_f32 v123, -v122
    v_sub_f32 v117, v117, v122
    v_sub_f32 v36, v36, v122
    v_sub_f32 v37, v37, v122
    v_sub_f32 v38, v38, v122
    v_sub_f32 v39, v39, v122
    v_sub_f32 v44, v44, v122
    v_sub_f32 v45, v45, v122
    v_sub_f32 v46, v46, v122
    v_sub_f32 v47, v47, v122
    v_sub_f32 v68, v68, v122
    v_sub_f32 v69, v69, v122
    v_sub_f32 v70, v70, v122
    v_sub_f32 v71, v71, v122
    v_sub_f32 v76, v76, v122
    v_sub_f32 v77, v77, v122
    v_sub_f32 v78, v78, v122
    v_sub_f32 v79, v79, v122
    v_sub_f32 v52, v52, v122
    v_sub_f32 v53, v53, v122
    v_sub_f32 v54, v54, v122
    v_sub_f32 v55, v55, v122
    v_sub_f32 v60, v60, v122
    v_sub_f32 v61, v61, v122
    v_sub_f32 v62, v62, v122
    v_sub_f32 v63, v63, v122
    v_mul_f32 v108, v108, v123
    v_mul_f32 v109, v109, v123
    v_mul_f32 v110, v110, v123
    v_mul_f32 v111, v111, v123
    v_lshrrev_b32 v124, 4, v1
    v_lshlrev_b32 v124, 4, v124
    ds_bpermute_b32 v96, v124, v123 offset:0
    ds_bpermute_b32 v97, v124, v123 offset:4
    ds_bpermute_b32 v98, v124, v123 offset:8
    ds_bpermute_b32 v99, v124, v123 offset:12
    s_waitcnt lgkmcnt(3)
    v_mul_f32 v132, v132, v96
    s_waitcnt lgkmcnt(2)
    v_mul_f32 v133, v133, v97
    s_waitcnt lgkmcnt(1)
    v_mul_f32 v134, v134, v98
    s_waitcnt lgkmcnt(0)
    v_mul_f32 v135, v135, v99
    v_mul_f32 v140, v140, v96
    v_mul_f32 v141, v141, v97
    v_mul_f32 v142, v142, v98
    v_mul_f32 v143, v143, v99
    v_mul_f32 v148, v148, v96
    v_mul_f32 v149, v149, v97
    v_mul_f32 v150, v150, v98
    v_mul_f32 v151, v151, v99
    v_mul_f32 v156, v156, v96
    v_mul_f32 v157, v157, v97
    v_mul_f32 v158, v158, v98
    v_mul_f32 v159, v159, v99
    v_mul_f32 v164, v164, v96
    v_mul_f32 v165, v165, v97
    v_mul_f32 v166, v166, v98
    v_mul_f32 v167, v167, v99
    v_mul_f32 v172, v172, v96
    v_mul_f32 v173, v173, v97
    v_mul_f32 v174, v174, v98
    v_mul_f32 v175, v175, v99
    v_mul_f32 v180, v180, v96
    v_mul_f32 v181, v181, v97
    v_mul_f32 v182, v182, v98
    v_mul_f32 v183, v183, v99
    v_mul_f32 v188, v188, v96
    v_mul_f32 v189, v189, v97
    v_mul_f32 v190, v190, v98
    v_mul_f32 v191, v191, v99
    v_mul_f32 v196, v196, v96
    v_mul_f32 v197, v197, v97
    v_mul_f32 v198, v198, v98
    v_mul_f32 v199, v199, v99
    v_mul_f32 v204, v204, v96
    v_mul_f32 v205, v205, v97
    v_mul_f32 v206, v206, v98
    v_mul_f32 v207, v207, v99
    v_mul_f32 v212, v212, v96
    v_mul_f32 v213, v213, v97
    v_mul_f32 v214, v214, v98
    v_mul_f32 v215, v215, v99
    v_mul_f32 v220, v220, v96
    v_mul_f32 v221, v221, v97
    v_mul_f32 v222, v222, v98
    v_mul_f32 v223, v223, v99
    v_mul_f32 v228, v228, v96
    v_mul_f32 v229, v229, v97
    v_mul_f32 v230, v230, v98
    v_mul_f32 v231, v231, v99
    v_mul_f32 v236, v236, v96
    v_mul_f32 v237, v237, v97
    v_mul_f32 v238, v238, v98
    v_mul_f32 v239, v239, v99
    v_mul_f32 v244, v244, v96
    v_mul_f32 v245, v245, v97
    v_mul_f32 v246, v246, v98
    v_mul_f32 v247, v247, v99
    v_mul_f32 v252, v252, v96
    v_mul_f32 v253, v253, v97
    v_mul_f32 v254, v254, v98
    v_mul_f32 v255, v255, v99
    v_exp_f32 v96, v68
    v_exp_f32 v97, v69
    v_exp_f32 v98, v70
    v_cvt_pk_bf16_f32 v92, v96, v97
    v_exp_f32 v99, v71
    v_exp_f32 v100, v76
    v_cvt_pk_bf16_f32 v93, v98, v99
    v_exp_f32 v101, v77
    v_exp_f32 v102, v78
    v_cvt_pk_bf16_f32 v94, v100, v101
    v_exp_f32 v103, v79
    s_nop 0
    v_cvt_pk_bf16_f32 v95, v102, v103
    s_branch at_x_rs1_ret
at_x_rt1:
    v_max3_f32 v118, v64, v65, v66
    v_max3_f32 v119, v67, v72, v73
    v_max3_f32 v118, v118, v74, v75
    v_max_f32 v118, v118, v119
    v_mov_b32 v119, v118
    s_nop 1
    v_permlane32_swap_b32 v118, v119
    v_max_f32 v118, v118, v119
    v_mov_b32 v119, v118
    s_nop 1
    v_permlane16_swap_b32 v118, v119
    v_max_f32 v118, v118, v119
    v_add_f32 v118, 0x40e00000, v118
    v_ceil_f32 v118, v118
    v_max_f32 v118, 0, v118
    v_exp_f32 v119, -v118
    v_sub_f32 v116, v116, v118
    v_sub_f32 v32, v32, v118
    v_sub_f32 v33, v33, v118
    v_sub_f32 v34, v34, v118
    v_sub_f32 v35, v35, v118
    v_sub_f32 v40, v40, v118
    v_sub_f32 v41, v41, v118
    v_sub_f32 v42, v42, v118
    v_sub_f32 v43, v43, v118
    v_sub_f32 v64, v64, v118
    v_sub_f32 v65, v65, v118
    v_sub_f32 v66, v66, v118
    v_sub_f32 v67, v67, v118
    v_sub_f32 v72, v72, v118
    v_sub_f32 v73, v73, v118
    v_sub_f32 v74, v74, v118
    v_sub_f32 v75, v75, v118
    v_mul_f32 v104, v104, v119
    v_mul_f32 v105, v105, v119
    v_mul_f32 v106, v106, v119
    v_mul_f32 v107, v107, v119
    v_lshrrev_b32 v120, 4, v1
    v_lshlrev_b32 v120, 4, v120
    ds_bpermute_b32 v96, v120, v119 offset:0
    ds_bpermute_b32 v97, v120, v119 offset:4
    ds_bpermute_b32 v98, v120, v119 offset:8
    ds_bpermute_b32 v99, v120, v119 offset:12
    s_waitcnt lgkmcnt(3)
    v_mul_f32 v128, v128, v96
    s_waitcnt lgkmcnt(2)
    v_mul_f32 v129, v129, v97
    s_waitcnt lgkmcnt(1)
    v_mul_f32 v130, v130, v98
    s_waitcnt lgkmcnt(0)
    v_mul_f32 v131, v131, v99
    v_mul_f32 v136, v136, v96
    v_mul_f32 v137, v137, v97
    v_mul_f32 v138, v138, v98
    v_mul_f32 v139, v139, v99
    v_mul_f32 v144, v144, v96
    v_mul_f32 v145, v145, v97
    v_mul_f32 v146, v146, v98
    v_mul_f32 v147, v147, v99
    v_mul_f32 v152, v152, v96
    v_mul_f32 v153, v153, v97
    v_mul_f32 v154, v154, v98
    v_mul_f32 v155, v155, v99
    v_mul_f32 v160, v160, v96
    v_mul_f32 v161, v161, v97
    v_mul_f32 v162, v162, v98
    v_mul_f32 v163, v163, v99
    v_mul_f32 v168, v168, v96
    v_mul_f32 v169, v169, v97
    v_mul_f32 v170, v170, v98
    v_mul_f32 v171, v171, v99
    v_mul_f32 v176, v176, v96
    v_mul_f32 v177, v177, v97
    v_mul_f32 v178, v178, v98
    v_mul_f32 v179, v179, v99
    v_mul_f32 v184, v184, v96
    v_mul_f32 v185, v185, v97
    v_mul_f32 v186, v186, v98
    v_mul_f32 v187, v187, v99
    v_mul_f32 v192, v192, v96
    v_mul_f32 v193, v193, v97
    v_mul_f32 v194, v194, v98
    v_mul_f32 v195, v195, v99
    v_mul_f32 v200, v200, v96
    v_mul_f32 v201, v201, v97
    v_mul_f32 v202, v202, v98
    v_mul_f32 v203, v203, v99
    v_mul_f32 v208, v208, v96
    v_mul_f32 v209, v209, v97
    v_mul_f32 v210, v210, v98
    v_mul_f32 v211, v211, v99
    v_mul_f32 v216, v216, v96
    v_mul_f32 v217, v217, v97
    v_mul_f32 v218, v218, v98
    v_mul_f32 v219, v219, v99
    v_mul_f32 v224, v224, v96
    v_mul_f32 v225, v225, v97
    v_mul_f32 v226, v226, v98
    v_mul_f32 v227, v227, v99
    v_mul_f32 v232, v232, v96
    v_mul_f32 v233, v233, v97
    v_mul_f32 v234, v234, v98
    v_mul_f32 v235, v235, v99
    v_mul_f32 v240, v240, v96
    v_mul_f32 v241, v241, v97
    v_mul_f32 v242, v242, v98
    v_mul_f32 v243, v243, v99
    v_mul_f32 v248, v248, v96
    v_mul_f32 v249, v249, v97
    v_mul_f32 v250, v250, v98
    v_mul_f32 v251, v251, v99
    v_exp_f32 v96, v64
    v_exp_f32 v97, v65
    v_exp_f32 v98, v66
    v_cvt_pk_bf16_f32 v88, v96, v97
    v_exp_f32 v99, v67
    v_exp_f32 v100, v72
    v_cvt_pk_bf16_f32 v89, v98, v99
    v_exp_f32 v101, v73
    v_exp_f32 v102, v74
    v_cvt_pk_bf16_f32 v90, v100, v101
    v_exp_f32 v103, v75
    s_nop 0
    v_cvt_pk_bf16_f32 v91, v102, v103
    v_max3_f32 v122, v68, v69, v70
    v_max3_f32 v123, v71, v76, v77
    v_max3_f32 v122, v122, v78, v79
    v_max_f32 v122, v122, v123
    v_mov_b32 v123, v122
    s_nop 1
    v_permlane32_swap_b32 v122, v123
    v_max_f32 v122, v122, v123
    v_mov_b32 v123, v122
    s_nop 1
    v_permlane16_swap_b32 v122, v123
    v_max_f32 v122, v122, v123
    v_add_f32 v122, 0x40e00000, v122
    v_ceil_f32 v122, v122
    v_max_f32 v122, 0, v122
    v_exp_f32 v123, -v122
    v_sub_f32 v117, v117, v122
    v_sub_f32 v36, v36, v122
    v_sub_f32 v37, v37, v122
    v_sub_f32 v38, v38, v122
    v_sub_f32 v39, v39, v122
    v_sub_f32 v44, v44, v122
    v_sub_f32 v45, v45, v122
    v_sub_f32 v46, v46, v122
    v_sub_f32 v47, v47, v122
    v_sub_f32 v68, v68, v122
    v_sub_f32 v69, v69, v122
    v_sub_f32 v70, v70, v122
    v_sub_f32 v71, v71, v122
    v_sub_f32 v76, v76, v122
    v_sub_f32 v77, v77, v122
    v_sub_f32 v78, v78, v122
    v_sub_f32 v79, v79, v122
    v_mul_f32 v108, v108, v123
    v_mul_f32 v109, v109, v123
    v_mul_f32 v110, v110, v123
    v_mul_f32 v111, v111, v123
    v_lshrrev_b32 v124, 4, v1
    v_lshlrev_b32 v124, 4, v124
    ds_bpermute_b32 v96, v124, v123 offset:0
    ds_bpermute_b32 v97, v124, v123 offset:4
    ds_bpermute_b32 v98, v124, v123 offset:8
    ds_bpermute_b32 v99, v124, v123 offset:12
    s_waitcnt lgkmcnt(3)
    v_mul_f32 v132, v132, v96
    s_waitcnt lgkmcnt(2)
    v_mul_f32 v133, v133, v97
    s_waitcnt lgkmcnt(1)
    v_mul_f32 v134, v134, v98
    s_waitcnt lgkmcnt(0)
    v_mul_f32 v135, v135, v99
    v_mul_f32 v140, v140, v96
    v_mul_f32 v141, v141, v97
    v_mul_f32 v142, v142, v98
    v_mul_f32 v143, v143, v99
    v_mul_f32 v148, v148, v96
    v_mul_f32 v149, v149, v97
    v_mul_f32 v150, v150, v98
    v_mul_f32 v151, v151, v99
    v_mul_f32 v156, v156, v96
    v_mul_f32 v157, v157, v97
    v_mul_f32 v158, v158, v98
    v_mul_f32 v159, v159, v99
    v_mul_f32 v164, v164, v96
    v_mul_f32 v165, v165, v97
    v_mul_f32 v166, v166, v98
    v_mul_f32 v167, v167, v99
    v_mul_f32 v172, v172, v96
    v_mul_f32 v173, v173, v97
    v_mul_f32 v174, v174, v98
    v_mul_f32 v175, v175, v99
    v_mul_f32 v180, v180, v96
    v_mul_f32 v181, v181, v97
    v_mul_f32 v182, v182, v98
    v_mul_f32 v183, v183, v99
    v_mul_f32 v188, v188, v96
    v_mul_f32 v189, v189, v97
    v_mul_f32 v190, v190, v98
    v_mul_f32 v191, v191, v99
    v_mul_f32 v196, v196, v96
    v_mul_f32 v197, v197, v97
    v_mul_f32 v198, v198, v98
    v_mul_f32 v199, v199, v99
    v_mul_f32 v204, v204, v96
    v_mul_f32 v205, v205, v97
    v_mul_f32 v206, v206, v98
    v_mul_f32 v207, v207, v99
    v_mul_f32 v212, v212, v96
    v_mul_f32 v213, v213, v97
    v_mul_f32 v214, v214, v98
    v_mul_f32 v215, v215, v99
    v_mul_f32 v220, v220, v96
    v_mul_f32 v221, v221, v97
    v_mul_f32 v222, v222, v98
    v_mul_f32 v223, v223, v99
    v_mul_f32 v228, v228, v96
    v_mul_f32 v229, v229, v97
    v_mul_f32 v230, v230, v98
    v_mul_f32 v231, v231, v99
    v_mul_f32 v236, v236, v96
    v_mul_f32 v237, v237, v97
    v_mul_f32 v238, v238, v98
    v_mul_f32 v239, v239, v99
    v_mul_f32 v244, v244, v96
    v_mul_f32 v245, v245, v97
    v_mul_f32 v246, v246, v98
    v_mul_f32 v247, v247, v99
    v_mul_f32 v252, v252, v96
    v_mul_f32 v253, v253, v97
    v_mul_f32 v254, v254, v98
    v_mul_f32 v255, v255, v99
    v_exp_f32 v96, v68
    v_exp_f32 v97, v69
    v_exp_f32 v98, v70
    v_cvt_pk_bf16_f32 v92, v96, v97
    v_exp_f32 v99, v71
    v_exp_f32 v100, v76
    v_cvt_pk_bf16_f32 v93, v98, v99
    v_exp_f32 v101, v77
    v_exp_f32 v102, v78
    v_cvt_pk_bf16_f32 v94, v100, v101
    v_exp_f32 v103, v79
    s_nop 0
    v_cvt_pk_bf16_f32 v95, v102, v103
    s_branch at_x_rt1_ret
at_x_tail0:
    s_waitcnt lgkmcnt(5)
    ds_read_b128 a[0:3], v6 offset:49152
    s_waitcnt lgkmcnt(5)
    ds_read_b128 a[4:7], v6 offset:50176
    s_waitcnt lgkmcnt(5)
    ds_read_b128 a[8:11], v6 offset:51200
    s_waitcnt lgkmcnt(5)
    ds_read_b128 a[12:15], v6 offset:52224
    s_waitcnt lgkmcnt(5)
    ds_read_b128 a[16:19], v6 offset:53248
    s_waitcnt lgkmcnt(5)
    ds_read_b128 a[20:23], v6 offset:54272
    s_add_u32 s29, s66, 16384
    s_mov_b32 s66, s24
    buffer_load_dwordx4 v30, s[4:7], s24 offen offset:0 sc1 lds
    v_exp_f32 v96, v52
    v_exp_f32 v97, v53
    v_exp_f32 v98, v54
    buffer_load_dwordx4 v30, s[4:7], s24 offen offset:1024 sc1 lds
    v_cvt_pk_bf16_f32 v84, v96, v97
    v_exp_f32 v99, v55
    v_exp_f32 v100, v60
    buffer_load_dwordx4 v30, s[4:7], s24 offen offset:2048 sc1 lds
    v_cvt_pk_bf16_f32 v85, v98, v99
    v_exp_f32 v101, v61
    v_exp_f32 v102, v62
    buffer_load_dwordx4 v30, s[4:7], s24 offen offset:3072 sc1 lds
    v_cvt_pk_bf16_f32 v86, v100, v101
    v_exp_f32 v103, v63
    s_nop 0
    v_cvt_pk_bf16_f32 v87, v102, v103
    s_add_u32 s24, s24, 32768
    s_cmp_eq_u32 s24, s25
    s_cselect_b32 s24, s26, s24
    s_cselect_b32 s25, s27, s25
    s_cselect_b32 s26, 1073741824, s26
    v_or3_b32 v11, v80, v81, v82
    v_or3_b32 v11, v11, v83, v84
    v_or3_b32 v11, v11, v85, v86
    v_bitop3_b32 v11, v11, v87, s65 bitop3:0xa8
    v_cmp_ne_u32 vcc, 0, v11
    s_nop 0
    s_cbranch_vccnz at_x_rt0
at_x_rt0_ret:
    v_mfma_f32_16x16x32_bf16 v[104:107], v[112:115], v[80:83], v[104:107]
    v_mfma_f32_16x16x32_bf16 v[108:111], v[112:115], v[84:87], v[108:111]
    s_waitcnt lgkmcnt(5)
    v_mfma_f32_16x16x32_bf16 v[132:135], v[84:87], a[0:3], v[132:135]
    ds_read_b128 a[24:27], v6 offset:55296
    v_mfma_f32_16x16x32_bf16 v[128:131], v[80:83], a[0:3], v[128:131]
    s_waitcnt lgkmcnt(5)
    v_mfma_f32_16x16x32_bf16 v[136:139], v[80:83], a[4:7], v[136:139]
    ds_read_b128 a[28:31], v6 offset:56320
    v_mfma_f32_16x16x32_bf16 v[140:143], v[84:87], a[4:7], v[140:143]
    s_waitcnt lgkmcnt(5)
    v_mfma_f32_16x16x32_bf16 v[148:151], v[84:87], a[8:11], v[148:151]
    ds_read_b128 a[0:3], v6 offset:57344
    v_mfma_f32_16x16x32_bf16 v[144:147], v[80:83], a[8:11], v[144:147]
    s_waitcnt lgkmcnt(5)
    v_mfma_f32_16x16x32_bf16 v[152:155], v[80:83], a[12:15], v[152:155]
    ds_read_b128 a[4:7], v6 offset:58368
    v_mfma_f32_16x16x32_bf16 v[156:159], v[84:87], a[12:15], v[156:159]
    s_waitcnt lgkmcnt(5)
    v_mfma_f32_16x16x32_bf16 v[164:167], v[84:87], a[16:19], v[164:167]
    ds_read_b128 a[8:11], v6 offset:59392
    v_mfma_f32_16x16x32_bf16 v[160:163], v[80:83], a[16:19], v[160:163]
    s_waitcnt lgkmcnt(5)
    v_mfma_f32_16x16x32_bf16 v[168:171], v[80:83], a[20:23], v[168:171]
    ds_read_b128 a[12:15], v6 offset:60416
    v_mfma_f32_16x16x32_bf16 v[172:175], v[84:87], a[20:23], v[172:175]
    s_waitcnt lgkmcnt(5)
    v_mfma_f32_16x16x32_bf16 v[180:183], v[84:87], a[24:27], v[180:183]
    ds_read_b128 a[16:19], v6 offset:61440
    v_mfma_f32_16x16x32_bf16 v[176:179], v[80:83], a[24:27], v[176:179]
    s_waitcnt lgkmcnt(5)
    v_mfma_f32_16x16x32_bf16 v[184:187], v[80:83], a[28:31], v[184:187]
    ds_read_b128 a[20:23], v6 offset:62464
    v_mfma_f32_16x16x32_bf16 v[188:191], v[84:87], a[28:31], v[188:191]
    s_waitcnt lgkmcnt(5)
    v_mfma_f32_16x16x32_bf16 v[196:199], v[84:87], a[0:3], v[196:199]
    ds_read_b128 a[24:27], v6 offset:63488
    v_mfma_f32_16x16x32_bf16 v[192:195], v[80:83], a[0:3], v[192:195]
    s_waitcnt lgkmcnt(5)
    v_mfma_f32_16x16x32_bf16 v[200:203], v[80:83], a[4:7], v[200:203]
    ds_read_b128 a[28:31], v6 offset:64512
    v_mfma_f32_16x16x32_bf16 v[204:207], v[84:87], a[4:7], v[204:207]
    s_waitcnt lgkmcnt(5)
    v_mfma_f32_16x16x32_bf16 v[212:215], v[84:87], a[8:11], v[212:215]
    v_mfma_f32_16x16x32_bf16 v[208:211], v[80:83], a[8:11], v[208:211]
    s_waitcnt lgkmcnt(4)
    v_mfma_f32_16x16x32_bf16 v[216:219], v[80:83], a[12:15], v[216:219]
    v_mfma_f32_16x16x32_bf16 v[220:223], v[84:87], a[12:15], v[220:223]
    s_waitcnt lgkmcnt(3)
    v_mfma_f32_16x16x32_bf16 v[228:231], v[84:87], a[16:19], v[228:231]
    v_mfma_f32_16x16x32_bf16 v[224:227], v[80:83], a[16:19], v[224:227]
    s_waitcnt lgkmcnt(2)
    v_mfma_f32_16x16x32_bf16 v[232:235], v[80:83], a[20:23], v[232:235]
    v_mfma_f32_16x16x32_bf16 v[236:239], v[84:87], a[20:23], v[236:239]
    s_waitcnt lgkmcnt(1)
    v_mfma_f32_16x16x32_bf16 v[244:247], v[84:87], a[24:27], v[244:247]
    v_mfma_f32_16x16x32_bf16 v[240:243], v[80:83], a[24:27], v[240:243]
    s_waitcnt lgkmcnt(0)
    v_mfma_f32_16x16x32_bf16 v[248:251], v[80:83], a[28:31], v[248:251]
    v_mfma_f32_16x16x32_bf16 v[252:255], v[84:87], a[28:31], v[252:255]
    v_xor_b32 v6, 0x10000, v6
    v_swap_b32 v6, v7
    s_branch at_x_join
at_x_tail1:
    s_waitcnt lgkmcnt(5)
    ds_read_b128 a[0:3], v7 offset:49152
    s_waitcnt lgkmcnt(5)
    ds_read_b128 a[4:7], v7 offset:50176
    s_waitcnt lgkmcnt(5)
    ds_read_b128 a[8:11], v7 offset:51200
    s_waitcnt lgkmcnt(5)
    ds_read_b128 a[12:15], v7 offset:52224
    s_waitcnt lgkmcnt(5)
    ds_read_b128 a[16:19], v7 offset:53248
    s_waitcnt lgkmcnt(5)
    ds_read_b128 a[20:23], v7 offset:54272
    s_add_u32 s29, s66, 16384
    s_mov_b32 s66, s24
    buffer_load_dwordx4 v30, s[4:7], s24 offen offset:0 sc1 lds
    v_exp_f32 v96, v68
    v_exp_f32 v97, v69
    v_exp_f32 v98, v70
    buffer_load_dwordx4 v30, s[4:7], s24 offen offset:1024 sc1 lds
    v_cvt_pk_bf16_f32 v92, v96, v97
    v_exp_f32 v99, v71
    v_exp_f32 v100, v76
    buffer_load_dwordx4 v30, s[4:7], s24 offen offset:2048 sc1 lds
    v_cvt_pk_bf16_f32 v93, v98, v99
    v_exp_f32 v101, v77
    v_exp_f32 v102, v78
    buffer_load_dwordx4 v30, s[4:7], s24 offen offset:3072 sc1 lds
    v_cvt_pk_bf16_f32 v94, v100, v101
    v_exp_f32 v103, v79
    s_nop 0
    v_cvt_pk_bf16_f32 v95, v102, v103
    s_add_u32 s24, s24, 32768
    s_cmp_eq_u32 s24, s25
    s_cselect_b32 s24, s26, s24
    s_cselect_b32 s25, s27, s25
    s_cselect_b32 s26, 1073741824, s26
    v_or3_b32 v11, v88, v89, v90
    v_or3_b32 v11, v11, v91, v92
    v_or3_b32 v11, v11, v93, v94
    v_bitop3_b32 v11, v11, v95, s65 bitop3:0xa8
    v_cmp_ne_u32 vcc, 0, v11
    s_nop 0
    s_cbranch_vccnz at_x_rt1
at_x_rt1_ret:
    v_mfma_f32_16x16x32_bf16 v[104:107], v[112:115], v[88:91], v[104:107]
    v_mfma_f32_16x16x32_bf16 v[108:111], v[112:115], v[92:95], v[108:111]
    s_waitcnt lgkmcnt(5)
    v_mfma_f32_16x16x32_bf16 v[132:135], v[92:95], a[0:3], v[132:135]
    ds_read_b128 a[24:27], v7 offset:55296
    v_mfma_f32_16x16x32_bf16 v[128:131], v[88:91], a[0:3], v[128:131]
    s_waitcnt lgkmcnt(5)
    v_mfma_f32_16x16x32_bf16 v[136:139], v[88:91], a[4:7], v[136:139]
    ds_read_b128 a[28:31], v7 offset:56320
    v_mfma_f32_16x16x32_bf16 v[140:143], v[92:95], a[4:7], v[140:143]
    s_waitcnt lgkmcnt(5)
    v_mfma_f32_16x16x32_bf16 v[148:151], v[92:95], a[8:11], v[148:151]
    ds_read_b128 a[0:3], v7 offset:57344
    v_mfma_f32_16x16x32_bf16 v[144:147], v[88:91], a[8:11], v[144:147]
    s_waitcnt lgkmcnt(5)
    v_mfma_f32_16x16x32_bf16 v[152:155], v[88:91], a[12:15], v[152:155]
    ds_read_b128 a[4:7], v7 offset:58368
    v_mfma_f32_16x16x32_bf16 v[156:159], v[92:95], a[12:15], v[156:159]
    s_waitcnt lgkmcnt(5)
    v_mfma_f32_16x16x32_bf16 v[164:167], v[92:95], a[16:19], v[164:167]
    ds_read_b128 a[8:11], v7 offset:59392
    v_mfma_f32_16x16x32_bf16 v[160:163], v[88:91], a[16:19], v[160:163]
    s_waitcnt lgkmcnt(5)
    v_mfma_f32_16x16x32_bf16 v[168:171], v[88:91], a[20:23], v[168:171]
    ds_read_b128 a[12:15], v7 offset:60416
    v_mfma_f32_16x16x32_bf16 v[172:175], v[92:95], a[20:23], v[172:175]
    s_waitcnt lgkmcnt(5)
    v_mfma_f32_16x16x32_bf16 v[180:183], v[92:95], a[24:27], v[180:183]
    ds_read_b128 a[16:19], v7 offset:61440
    v_mfma_f32_16x16x32_bf16 v[176:179], v[88:91], a[24:27], v[176:179]
    s_waitcnt lgkmcnt(5)
    v_mfma_f32_16x16x32_bf16 v[184:187], v[88:91], a[28:31], v[184:187]
    ds_read_b128 a[20:23], v7 offset:62464
    v_mfma_f32_16x16x32_bf16 v[188:191], v[92:95], a[28:31], v[188:191]
    s_waitcnt lgkmcnt(5)
    v_mfma_f32_16x16x32_bf16 v[196:199], v[92:95], a[0:3], v[196:199]
    ds_read_b128 a[24:27], v7 offset:63488
    v_mfma_f32_16x16x32_bf16 v[192:195], v[88:91], a[0:3], v[192:195]
    s_waitcnt lgkmcnt(5)
    v_mfma_f32_16x16x32_bf16 v[200:203], v[88:91], a[4:7], v[200:203]
    ds_read_b128 a[28:31], v7 offset:64512
    v_mfma_f32_16x16x32_bf16 v[204:207], v[92:95], a[4:7], v[204:207]
    s_waitcnt lgkmcnt(5)
    v_mfma_f32_16x16x32_bf16 v[212:215], v[92:95], a[8:11], v[212:215]
    v_mfma_f32_16x16x32_bf16 v[208:211], v[88:91], a[8:11], v[208:211]
    s_waitcnt lgkmcnt(4)
    v_mfma_f32_16x16x32_bf16 v[216:219], v[88:91], a[12:15], v[216:219]
    v_mfma_f32_16x16x32_bf16 v[220:223], v[92:95], a[12:15], v[220:223]
    s_waitcnt lgkmcnt(3)
    v_mfma_f32_16x16x32_bf16 v[228:231], v[92:95], a[16:19], v[228:231]
    v_mfma_f32_16x16x32_bf16 v[224:227], v[88:91], a[16:19], v[224:227]
    s_waitcnt lgkmcnt(2)
    v_mfma_f32_16x16x32_bf16 v[232:235], v[88:91], a[20:23], v[232:235]
    v_mfma_f32_16x16x32_bf16 v[236:239], v[92:95], a[20:23], v[236:239]
    s_waitcnt lgkmcnt(1)
    v_mfma_f32_16x16x32_bf16 v[244:247], v[92:95], a[24:27], v[244:247]
    v_mfma_f32_16x16x32_bf16 v[240:243], v[88:91], a[24:27], v[240:243]
    s_waitcnt lgkmcnt(0)
    v_mfma_f32_16x16x32_bf16 v[248:251], v[88:91], a[28:31], v[248:251]
    v_mfma_f32_16x16x32_bf16 v[252:255], v[92:95], a[28:31], v[252:255]
    v_xor_b32 v7, 0x10000, v7
at_x_join:
    v_mov_b32 v96, v116
    v_mov_b32 v97, v104
    v_mov_b32 v98, v117
    v_mov_b32 v99, v108
    s_add_u32 s3, s11, 8388608
    buffer_store_dwordx4 v[96:99], v25, s[4:7], s3 offen sc1
    s_add_u32 s3, s11, 0
    v_cvt_pk_bf16_f32 v128, v128, v129
    v_cvt_pk_bf16_f32 v129, v130, v131
    v_cvt_pk_bf16_f32 v130, v132, v133
    v_cvt_pk_bf16_f32 v131, v134, v135
    buffer_store_dwordx4 v[128:131], v25, s[4:7], s3 offen offset:0 sc1
    v_cvt_pk_bf16_f32 v136, v136, v137
    v_cvt_pk_bf16_f32 v137, v138, v139
    v_cvt_pk_bf16_f32 v138, v140, v141
    v_cvt_pk_bf16_f32 v139, v142, v143
    buffer_store_dwordx4 v[136:139], v25, s[4:7], s3 offen offset:1024 sc1
    v_cvt_pk_bf16_f32 v144, v144, v145
    v_cvt_pk_bf16_f32 v145, v146, v147
    v_cvt_pk_bf16_f32 v146, v148, v149
    v_cvt_pk_bf16_f32 v147, v150, v151
    buffer_store_dwordx4 v[144:147], v25, s[4:7], s3 offen offset:2048 sc1
    v_cvt_pk_bf16_f32 v152, v152, v153
    v_cvt_pk_bf16_f32 v153, v154, v155
    v_cvt_pk_bf16_f32 v154, v156, v157
    v_cvt_pk_bf16_f32 v155, v158, v159
    buffer_store_dwordx4 v[152:155], v25, s[4:7], s3 offen offset:3072 sc1
    s_add_u32 s3, s11, 4096
    v_cvt_pk_bf16_f32 v160, v160, v161
    v_cvt_pk_bf16_f32 v161, v162, v163
    v_cvt_pk_bf16_f32 v162, v164, v165
    v_cvt_pk_bf16_f32 v163, v166, v167
    buffer_store_dwordx4 v[160:163], v25, s[4:7], s3 offen offset:0 sc1
    v_cvt_pk_bf16_f32 v168, v168, v169
    v_cvt_pk_bf16_f32 v169, v170, v171
    v_cvt_pk_bf16_f32 v170, v172, v173
    v_cvt_pk_bf16_f32 v171, v174, v175
    buffer_store_dwordx4 v[168:171], v25, s[4:7], s3 offen offset:1024 sc1
    v_cvt_pk_bf16_f32 v176, v176, v177
    v_cvt_pk_bf16_f32 v177, v178, v179
    v_cvt_pk_bf16_f32 v178, v180, v181
    v_cvt_pk_bf16_f32 v179, v182, v183
    buffer_store_dwordx4 v[176:179], v25, s[4:7], s3 offen offset:2048 sc1
    v_cvt_pk_bf16_f32 v184, v184, v185
    v_cvt_pk_bf16_f32 v185, v186, v187
    v_cvt_pk_bf16_f32 v186, v188, v189
    v_cvt_pk_bf16_f32 v187, v190, v191
    buffer_store_dwordx4 v[184:187], v25, s[4:7], s3 offen offset:3072 sc1
    s_add_u32 s3, s11, 8192
    v_cvt_pk_bf16_f32 v192, v192, v193
    v_cvt_pk_bf16_f32 v193, v194, v195
    v_cvt_pk_bf16_f32 v194, v196, v197
    v_cvt_pk_bf16_f32 v195, v198, v199
    buffer_store_dwordx4 v[192:195], v25, s[4:7], s3 offen offset:0 sc1
    v_cvt_pk_bf16_f32 v200, v200, v201
    v_cvt_pk_bf16_f32 v201, v202, v203
    v_cvt_pk_bf16_f32 v202, v204, v205
    v_cvt_pk_bf16_f32 v203, v206, v207
    buffer_store_dwordx4 v[200:203], v25, s[4:7], s3 offen offset:1024 sc1
    v_cvt_pk_bf16_f32 v208, v208, v209
    v_cvt_pk_bf16_f32 v209, v210, v211
    v_cvt_pk_bf16_f32 v210, v212, v213
    v_cvt_pk_bf16_f32 v211, v214, v215
    buffer_store_dwordx4 v[208:211], v25, s[4:7], s3 offen offset:2048 sc1
    v_cvt_pk_bf16_f32 v216, v216, v217
    v_cvt_pk_bf16_f32 v217, v218, v219
    v_cvt_pk_bf16_f32 v218, v220, v221
    v_cvt_pk_bf16_f32 v219, v222, v223
    buffer_store_dwordx4 v[216:219], v25, s[4:7], s3 offen offset:3072 sc1
    s_add_u32 s3, s11, 12288
    v_cvt_pk_bf16_f32 v224, v224, v225
    v_cvt_pk_bf16_f32 v225, v226, v227
    v_cvt_pk_bf16_f32 v226, v228, v229
    v_cvt_pk_bf16_f32 v227, v230, v231
    buffer_store_dwordx4 v[224:227], v25, s[4:7], s3 offen offset:0 sc1
    v_cvt_pk_bf16_f32 v232, v232, v233
    v_cvt_pk_bf16_f32 v233, v234, v235
    v_cvt_pk_bf16_f32 v234, v236, v237
    v_cvt_pk_bf16_f32 v235, v238, v239
    buffer_store_dwordx4 v[232:235], v25, s[4:7], s3 offen offset:1024 sc1
    v_cvt_pk_bf16_f32 v240, v240, v241
    v_cvt_pk_bf16_f32 v241, v242, v243
    v_cvt_pk_bf16_f32 v242, v244, v245
    v_cvt_pk_bf16_f32 v243, v246, v247
    buffer_store_dwordx4 v[240:243], v25, s[4:7], s3 offen offset:2048 sc1
    v_cvt_pk_bf16_f32 v248, v248, v249
    v_cvt_pk_bf16_f32 v249, v250, v251
    v_cvt_pk_bf16_f32 v250, v252, v253
    v_cvt_pk_bf16_f32 v251, v254, v255
    buffer_store_dwordx4 v[248:251], v25, s[4:7], s3 offen offset:3072 sc1
at_own:
    s_cmp_ge_u32 s22, 8
    s_cselect_b32 s30, s8, 0
    s_cselect_b32 s3, s8, 0
    s_cmp_eq_u32 s3, 0
    s_cselect_b32 s11, 0, s11
    s_cselect_b32 s88, 1, 0
    s_lshl_b32 s31, s22, 2
    s_add_u32 s31, s31, s20
    s_sub_u32 s64, s31, 1
    s_sub_u32 s15, 3, s20
    s_sub_u32 s3, s64, 1
    s_min_i32 s9, s10, s3
    s_cmp_eq_u32 s13, 0
    s_cbranch_scc1 at_y_p_first
    v_mov_b32 v32, 0
    v_mov_b32 v33, 0
    v_mov_b32 v34, 0
    v_mov_b32 v35, 0
    v_mov_b32 v36, 0
    v_mov_b32 v37, 0
    v_mov_b32 v38, 0
    v_mov_b32 v39, 0
    v_mov_b32 v40, 0
    v_mov_b32 v41, 0
    v_mov_b32 v42, 0
    v_mov_b32 v43, 0
    v_mov_b32 v44, 0
    v_mov_b32 v45, 0
    v_mov_b32 v46, 0
    v_mov_b32 v47, 0
    v_mov_b32 v116, 0
    v_mov_b32 v117, 0
    s_cmp_eq_u32 s30, s31
    s_cbranch_scc0 at_y_pc_nomask
    s_add_u32 s3, s30, 0
    s_lshl_b32 s3, s3, 5
    v_subrev_u32 v11, s3, v9
    v_subrev_u32 v12, s3, v10
    v_cmp_le_i32 s[68:69], 0, v11
    v_cmp_le_i32 s[70:71], 1, v11
    v_cmp_le_i32 s[72:73], 2, v11
    v_cmp_le_i32 s[74:75], 3, v11
    v_cmp_le_i32 s[76:77], 0, v12
    v_cmp_le_i32 s[78:79], 1, v12
    v_cmp_le_i32 s[80:81], 2, v12
    v_cmp_le_i32 s[82:83], 3, v12
    v_cndmask_b32 v32, v126, v116, s[68:69]
    v_cndmask_b32 v33, v126, v116, s[70:71]
    v_cndmask_b32 v34, v126, v116, s[72:73]
    v_cndmask_b32 v35, v126, v116, s[74:75]
    v_cndmask_b32 v36, v126, v117, s[76:77]
    v_cndmask_b32 v37, v126, v117, s[78:79]
    v_cndmask_b32 v38, v126, v117, s[80:81]
    v_cndmask_b32 v39, v126, v117, s[82:83]
    v_cmp_le_i32 s[68:69], 16, v11
    v_cmp_le_i32 s[70:71], 17, v11
    v_cmp_le_i32 s[72:73], 18, v11
    v_cmp_le_i32 s[74:75], 19, v11
    v_cmp_le_i32 s[76:77], 16, v12
    v_cmp_le_i32 s[78:79], 17, v12
    v_cmp_le_i32 s[80:81], 18, v12
    v_cmp_le_i32 s[82:83], 19, v12
    v_cndmask_b32 v40, v126, v116, s[68:69]
    v_cndmask_b32 v41, v126, v116, s[70:71]
    v_cndmask_b32 v42, v126, v116, s[72:73]
    v_cndmask_b32 v43, v126, v116, s[74:75]
    v_cndmask_b32 v44, v126, v117, s[76:77]
    v_cndmask_b32 v45, v126, v117, s[78:79]
    v_cndmask_b32 v46, v126, v117, s[80:81]
    v_cndmask_b32 v47, v126, v117, s[82:83]
at_y_pc_nomask:
    ds_read_b128 a[0:3], v6 offset:32768
    ds_read_b128 a[4:7], v6 offset:40960
    ds_read_b128 a[8:11], v6 offset:33792
    ds_read_b128 a[12:15], v6 offset:41984
    ds_read_b128 a[16:19], v6 offset:34816
    ds_read_b128 a[20:23], v6 offset:43008
    s_waitcnt lgkmcnt(5)
    v_mfma_f32_16x16x32_bf16 v[48:51], a[0:3], a[32:35], v[32:35]
    ds_read_b128 a[24:27], v6 offset:35840
    v_mov_b32 v104, 0
    v_mfma_f32_16x16x32_bf16 v[52:55], a[0:3], a[80:83], v[36:39]
    v_mov_b32 v105, 0
    v_mov_b32 v106, 0
    s_waitcnt lgkmcnt(5)
    v_mfma_f32_16x16x32_bf16 v[60:63], a[4:7], a[80:83], v[44:47]
    ds_read_b128 a[28:31], v6 offset:44032
    v_mov_b32 v107, 0
    v_mfma_f32_16x16x32_bf16 v[56:59], a[4:7], a[32:35], v[40:43]
    v_mov_b32 v108, 0
    s_waitcnt lgkmcnt(5)
    v_mfma_f32_16x16x32_bf16 v[48:51], a[8:11], a[36:39], v[48:51]
    ds_read_b128 a[0:3], v6 offset:36864
    v_mov_b32 v109, 0
    v_mfma_f32_16x16x32_bf16 v[52:55], a[8:11], a[84:87], v[52:55]
    v_mov_b32 v110, 0
    v_mov_b32 v111, 0
    s_waitcnt lgkmcnt(5)
    v_mfma_f32_16x16x32_bf16 v[60:63], a[12:15], a[84:87], v[60:63]
    ds_read_b128 a[4:7], v6 offset:45056
    v_mov_b32 v128, 0
    v_mfma_f32_16x16x32_bf16 v[56:59], a[12:15], a[36:39], v[56:59]
    v_mov_b32 v129, 0
    s_waitcnt lgkmcnt(5)
    v_mfma_f32_16x16x32_bf16 v[48:51], a[16:19], a[40:43], v[48:51]
    ds_read_b128 a[8:11], v6 offset:37888
    v_mov_b32 v130, 0
    v_mfma_f32_16x16x32_bf16 v[52:55], a[16:19], a[88:91], v[52:55]
    v_mov_b32 v131, 0
    v_mov_b32 v132, 0
    s_waitcnt lgkmcnt(5)
    v_mfma_f32_16x16x32_bf16 v[60:63], a[20:23], a[88:91], v[60:63]
    ds_read_b128 a[12:15], v6 offset:46080
    v_mov_b32 v133, 0
    v_mfma_f32_16x16x32_bf16 v[56:59], a[20:23], a[40:43], v[56:59]
    v_mov_b32 v134, 0
    s_waitcnt lgkmcnt(5)
    v_mfma_f32_16x16x32_bf16 v[48:51], a[24:27], a[44:47], v[48:51]
    ds_read_b128 a[16:19], v6 offset:38912
    v_mov_b32 v135, 0
    v_mfma_f32_16x16x32_bf16 v[52:55], a[24:27], a[92:95], v[52:55]
    v_mov_b32 v136, 0
    v_mov_b32 v137, 0
    s_waitcnt lgkmcnt(5)
    v_mfma_f32_16x16x32_bf16 v[60:63], a[28:31], a[92:95], v[60:63]
    ds_read_b128 a[20:23], v6 offset:47104
    v_mov_b32 v138, 0
    v_mfma_f32_16x16x32_bf16 v[56:59], a[28:31], a[44:47], v[56:59]
    v_mov_b32 v139, 0
    s_waitcnt lgkmcnt(5)
    v_mfma_f32_16x16x32_bf16 v[48:51], a[0:3], a[48:51], v[48:51]
    ds_read_b128 a[24:27], v6 offset:39936
    v_mov_b32 v140, 0
    v_mfma_f32_16x16x32_bf16 v[52:55], a[0:3], a[96:99], v[52:55]
    v_mov_b32 v141, 0
    v_mov_b32 v142, 0
    s_waitcnt lgkmcnt(5)
    v_mfma_f32_16x16x32_bf16 v[60:63], a[4:7], a[96:99], v[60:63]
    ds_read_b128 a[28:31], v6 offset:48128
    v_mov_b32 v143, 0
    v_mfma_f32_16x16x32_bf16 v[56:59], a[4:7], a[48:51], v[56:59]
    v_mov_b32 v144, 0
    s_waitcnt lgkmcnt(5)
    v_mfma_f32_16x16x32_bf16 v[48:51], a[8:11], a[52:55], v[48:51]
    v_mov_b32 v145, 0
    v_mov_b32 v146, 0
    v_mfma_f32_16x16x32_bf16 v[52:55], a[8:11], a[100:103], v[52:55]
    v_mov_b32 v147, 0
    s_waitcnt lgkmcnt(4)
    v_mfma_f32_16x16x32_bf16 v[60:63], a[12:15], a[100:103], v[60:63]
    v_mov_b32 v148, 0
    v_mfma_f32_16x16x32_bf16 v[56:59], a[12:15], a[52:55], v[56:59]
    v_mov_b32 v149, 0
    s_waitcnt lgkmcnt(3)
    v_mfma_f32_16x16x32_bf16 v[48:51], a[16:19], a[56:59], v[48:51]
    v_mov_b32 v150, 0
    v_mov_b32 v151, 0
    v_mfma_f32_16x16x32_bf16 v[52:55], a[16:19], a[104:107], v[52:55]
    v_mov_b32 v152, 0
    s_waitcnt lgkmcnt(2)
    v_mfma_f32_16x16x32_bf16 v[60:63], a[20:23], a[104:107], v[60:63]
    v_mov_b32 v153, 0
    v_mfma_f32_16x16x32_bf16 v[56:59], a[20:23], a[56:59], v[56:59]
    v_mov_b32 v154, 0
    s_waitcnt lgkmcnt(1)
    v_mfma_f32_16x16x32_bf16 v[48:51], a[24:27], a[60:63], v[48:51]
    v_mov_b32 v155, 0
    v_mov_b32 v156, 0
    v_mfma_f32_16x16x32_bf16 v[52:55], a[24:27], a[108:111], v[52:55]
    v_mov_b32 v157, 0
    s_waitcnt lgkmcnt(0)
    v_mfma_f32_16x16x32_bf16 v[60:63], a[28:31], a[108:111], v[60:63]
    v_mov_b32 v158, 0
    v_mfma_f32_16x16x32_bf16 v[56:59], a[28:31], a[60:63], v[56:59]
    v_mov_b32 v159, 0
    v_mov_b32 v160, 0
    v_mov_b32 v161, 0
    v_mov_b32 v162, 0
    v_mov_b32 v163, 0
    v_mov_b32 v164, 0
    v_mov_b32 v165, 0
    v_mov_b32 v166, 0
    v_mov_b32 v167, 0
    v_mov_b32 v168, 0
    v_mov_b32 v169, 0
    v_mov_b32 v170, 0
    v_mov_b32 v171, 0
    v_mov_b32 v172, 0
    v_mov_b32 v173, 0
    v_mov_b32 v174, 0
    v_mov_b32 v175, 0
    v_mov_b32 v176, 0
    v_mov_b32 v177, 0
    v_mov_b32 v178, 0
    v_mov_b32 v179, 0
    v_mov_b32 v180, 0
    v_mov_b32 v181, 0
    v_mov_b32 v182, 0
    v_mov_b32 v183, 0
    v_mov_b32 v184, 0
    v_mov_b32 v185, 0
    v_mov_b32 v186, 0
    v_mov_b32 v187, 0
    v_mov_b32 v188, 0
    v_mov_b32 v189, 0
    v_mov_b32 v190, 0
    v_mov_b32 v191, 0
    v_mov_b32 v192, 0
    v_mov_b32 v193, 0
    v_mov_b32 v194, 0
    v_mov_b32 v195, 0
    v_mov_b32 v196, 0
    v_mov_b32 v197, 0
    v_mov_b32 v198, 0
    v_mov_b32 v199, 0
    v_mov_b32 v200, 0
    v_mov_b32 v201, 0
    v_mov_b32 v202, 0
    v_mov_b32 v203, 0
    v_mov_b32 v204, 0
    v_mov_b32 v205, 0
    v_mov_b32 v206, 0
    v_mov_b32 v207, 0
    s_mov_b32 m0, s67
    s_waitcnt vmcnt(0)
    s_branch at_y_p_qk
at_y_p_first:
    v_mov_b32 v32, 0
    v_mov_b32 v33, 0
    v_mov_b32 v34, 0
    v_mov_b32 v35, 0
    v_mov_b32 v36, 0
    v_mov_b32 v37, 0
    v_mov_b32 v38, 0
    v_mov_b32 v39, 0
    v_mov_b32 v40, 0
    v_mov_b32 v41, 0
    v_mov_b32 v42, 0
    v_mov_b32 v43, 0
    v_mov_b32 v44, 0
    v_mov_b32 v45, 0
    v_mov_b32 v46, 0
    v_mov_b32 v47, 0
    v_mov_b32 v116, 0
    v_mov_b32 v117, 0
    s_cmp_eq_u32 s30, s31
    s_cbranch_scc0 at_y_pf_nomask
    s_add_u32 s3, s30, 0
    s_lshl_b32 s3, s3, 5
    v_subrev_u32 v11, s3, v9
    v_subrev_u32 v12, s3, v10
    v_cmp_le_i32 s[68:69], 0, v11
    v_cmp_le_i32 s[70:71], 1, v11
    v_cmp_le_i32 s[72:73], 2, v11
    v_cmp_le_i32 s[74:75], 3, v11
    v_cmp_le_i32 s[76:77], 0, v12
    v_cmp_le_i32 s[78:79], 1, v12
    v_cmp_le_i32 s[80:81], 2, v12
    v_cmp_le_i32 s[82:83], 3, v12
    v_cndmask_b32 v32, v126, v116, s[68:69]
    v_cndmask_b32 v33, v126, v116, s[70:71]
    v_cndmask_b32 v34, v126, v116, s[72:73]
    v_cndmask_b32 v35, v126, v116, s[74:75]
    v_cndmask_b32 v36, v126, v117, s[76:77]
    v_cndmask_b32 v37, v126, v117, s[78:79]
    v_cndmask_b32 v38, v126, v117, s[80:81]
    v_cndmask_b32 v39, v126, v117, s[82:83]
    v_cmp_le_i32 s[68:69], 16, v11
    v_cmp_le_i32 s[70:71], 17, v11
    v_cmp_le_i32 s[72:73], 18, v11
    v_cmp_le_i32 s[74:75], 19, v11
    v_cmp_le_i32 s[76:77], 16, v12
    v_cmp_le_i32 s[78:79], 17, v12
    v_cmp_le_i32 s[80:81], 18, v12
    v_cmp_le_i32 s[82:83], 19, v12
    v_cndmask_b32 v40, v126, v116, s[68:69]
    v_cndmask_b32 v41, v126, v116, s[70:71]
    v_cndmask_b32 v42, v126, v116, s[72:73]
    v_cndmask_b32 v43, v126, v116, s[74:75]
    v_cndmask_b32 v44, v126, v117, s[76:77]
    v_cndmask_b32 v45, v126, v117, s[78:79]
    v_cndmask_b32 v46, v126, v117, s[80:81]
    v_cndmask_b32 v47, v126, v117, s[82:83]
at_y_pf_nomask:
    ds_read_b128 a[0:3], v6 offset:32768
    ds_read_b128 a[4:7], v6 offset:40960
    ds_read_b128 a[8:11], v6 offset:33792
    ds_read_b128 a[12:15], v6 offset:41984
    ds_read_b128 a[16:19], v6 offset:34816
    ds_read_b128 a[20:23], v6 offset:43008
    s_waitcnt lgkmcnt(5)
    v_mfma_f32_16x16x32_bf16 v[48:51], a[0:3], a[32:35], v[32:35]
    ds_read_b128 a[24:27], v6 offset:35840
    v_mov_b32 v104, 0
    v_mfma_f32_16x16x32_bf16 v[52:55], a[0:3], a[80:83], v[36:39]
    s_sub_u32 m0, s28, 32768
    s_add_u32 s3, s86, 0
    s_waitcnt lgkmcnt(5)
    v_mfma_f32_16x16x32_bf16 v[60:63], a[4:7], a[80:83], v[44:47]
    ds_read_b128 a[28:31], v6 offset:44032
    v_mov_b32 v105, 0
    v_mfma_f32_16x16x32_bf16 v[56:59], a[4:7], a[32:35], v[40:43]
    buffer_load_dwordx4 v30, s[4:7], s3 offen offset:0 sc1 lds
    v_mov_b32 v106, 0
    s_waitcnt lgkmcnt(5)
    v_mfma_f32_16x16x32_bf16 v[48:51], a[8:11], a[36:39], v[48:51]
    ds_read_b128 a[0:3], v6 offset:36864
    v_mov_b32 v107, 0
    v_mfma_f32_16x16x32_bf16 v[52:55], a[8:11], a[84:87], v[52:55]
    buffer_load_dwordx4 v30, s[4:7], s3 offen offset:1024 sc1 lds
    v_mov_b32 v108, 0
    s_waitcnt lgkmcnt(5)
    v_mfma_f32_16x16x32_bf16 v[60:63], a[12:15], a[84:87], v[60:63]
    ds_read_b128 a[4:7], v6 offset:45056
    v_mov_b32 v109, 0
    v_mfma_f32_16x16x32_bf16 v[56:59], a[12:15], a[36:39], v[56:59]
    buffer_load_dwordx4 v30, s[4:7], s3 offen offset:2048 sc1 lds
    v_mov_b32 v110, 0
    s_waitcnt lgkmcnt(5)
    v_mfma_f32_16x16x32_bf16 v[48:51], a[16:19], a[40:43], v[48:51]
    ds_read_b128 a[8:11], v6 offset:37888
    v_mov_b32 v111, 0
    v_mfma_f32_16x16x32_bf16 v[52:55], a[16:19], a[88:91], v[52:55]
    buffer_load_dwordx4 v30, s[4:7], s3 offen offset:3072 sc1 lds
    v_mov_b32 v128, 0
    s_waitcnt lgkmcnt(5)
    v_mfma_f32_16x16x32_bf16 v[60:63], a[20:23], a[88:91], v[60:63]
    ds_read_b128 a[12:15], v6 offset:46080
    v_mov_b32 v129, 0
    v_mfma_f32_16x16x32_bf16 v[56:59], a[20:23], a[40:43], v[56:59]
    s_sub_u32 m0, s28, 49152
    s_add_u32 s3, s85, 16384
    s_waitcnt lgkmcnt(5)
    v_mfma_f32_16x16x32_bf16 v[48:51], a[24:27], a[44:47], v[48:51]
    ds_read_b128 a[16:19], v6 offset:38912
    v_mov_b32 v130, 0
    v_mfma_f32_16x16x32_bf16 v[52:55], a[24:27], a[92:95], v[52:55]
    buffer_load_dwordx4 v30, s[4:7], s3 offen offset:0 sc1 lds
    v_mov_b32 v131, 0
    s_waitcnt lgkmcnt(5)
    v_mfma_f32_16x16x32_bf16 v[60:63], a[28:31], a[92:95], v[60:63]
    ds_read_b128 a[20:23], v6 offset:47104
    v_mov_b32 v132, 0
    v_mfma_f32_16x16x32_bf16 v[56:59], a[28:31], a[44:47], v[56:59]
    buffer_load_dwordx4 v30, s[4:7], s3 offen offset:1024 sc1 lds
    v_mov_b32 v133, 0
    s_waitcnt lgkmcnt(5)
    v_mfma_f32_16x16x32_bf16 v[48:51], a[0:3], a[48:51], v[48:51]
    ds_read_b128 a[24:27], v6 offset:39936
    v_mov_b32 v134, 0
    v_mfma_f32_16x16x32_bf16 v[52:55], a[0:3], a[96:99], v[52:55]
    buffer_load_dwordx4 v30, s[4:7], s3 offen offset:2048 sc1 lds
    v_mov_b32 v135, 0
    s_waitcnt lgkmcnt(5)
    v_mfma_f32_16x16x32_bf16 v[60:63], a[4:7], a[96:99], v[60:63]
    ds_read_b128 a[28:31], v6 offset:48128
    v_mov_b32 v136, 0
    v_mfma_f32_16x16x32_bf16 v[56:59], a[4:7], a[48:51], v[56:59]
    buffer_load_dwordx4 v30, s[4:7], s3 offen offset:3072 sc1 lds
    v_mov_b32 v137, 0
    s_waitcnt lgkmcnt(5)
    v_mfma_f32_16x16x32_bf16 v[48:51], a[8:11], a[52:55], v[48:51]
    v_mov_b32 v138, 0
    v_mov_b32 v139, 0
    v_mfma_f32_16x16x32_bf16 v[52:55], a[8:11], a[100:103], v[52:55]
    s_sub_u32 m0, s28, 0
    s_add_u32 s3, s87, 0
    s_waitcnt lgkmcnt(4)
    v_mfma_f32_16x16x32_bf16 v[60:63], a[12:15], a[100:103], v[60:63]
    v_mov_b32 v140, 0
    v_mov_b32 v141, 0
    v_mfma_f32_16x16x32_bf16 v[56:59], a[12:15], a[52:55], v[56:59]
    buffer_load_dwordx4 v30, s[4:7], s3 offen offset:0 sc1 lds
    v_mov_b32 v142, 0
    s_waitcnt lgkmcnt(3)
    v_mfma_f32_16x16x32_bf16 v[48:51], a[16:19], a[56:59], v[48:51]
    v_mov_b32 v143, 0
    v_mov_b32 v144, 0
    v_mfma_f32_16x16x32_bf16 v[52:55], a[16:19], a[104:107], v[52:55]
    buffer_load_dwordx4 v30, s[4:7], s3 offen offset:1024 sc1 lds
    v_mov_b32 v145, 0
    s_waitcnt lgkmcnt(2)
    v_mfma_f32_16x16x32_bf16 v[60:63], a[20:23], a[104:107], v[60:63]
    v_mov_b32 v146, 0
    v_mov_b32 v147, 0
    v_mfma_f32_16x16x32_bf16 v[56:59], a[20:23], a[56:59], v[56:59]
    buffer_load_dwordx4 v30, s[4:7], s3 offen offset:2048 sc1 lds
    v_mov_b32 v148, 0
    s_waitcnt lgkmcnt(1)
    v_mfma_f32_16x16x32_bf16 v[48:51], a[24:27], a[60:63], v[48:51]
    v_mov_b32 v149, 0
    v_mov_b32 v150, 0
    v_mfma_f32_16x16x32_bf16 v[52:55], a[24:27], a[108:111], v[52:55]
    buffer_load_dwordx4 v30, s[4:7], s3 offen offset:3072 sc1 lds
    v_mov_b32 v151, 0
    s_waitcnt lgkmcnt(0)
    v_mfma_f32_16x16x32_bf16 v[60:63], a[28:31], a[108:111], v[60:63]
    v_mov_b32 v152, 0
    v_mov_b32 v153, 0
    v_mfma_f32_16x16x32_bf16 v[56:59], a[28:31], a[60:63], v[56:59]
    v_mov_b32 v154, 0
    v_mov_b32 v155, 0
    v_mov_b32 v156, 0
    v_mov_b32 v157, 0
    v_mov_b32 v158, 0
    v_mov_b32 v159, 0
    s_add_u32 s29, s86, 16384
    s_mov_b32 s66, s87
    s_sub_u32 s67, s28, 16384
    s_sub_u32 s28, s28, 32768
    v_mov_b32 v160, 0
    v_mov_b32 v161, 0
    v_mov_b32 v162, 0
    v_mov_b32 v163, 0
    v_mov_b32 v164, 0
    v_mov_b32 v165, 0
    v_mov_b32 v166, 0
    v_mov_b32 v167, 0
    v_mov_b32 v168, 0
    v_mov_b32 v169, 0
    v_mov_b32 v170, 0
    v_mov_b32 v171, 0
    v_mov_b32 v172, 0
    v_mov_b32 v173, 0
    v_mov_b32 v174, 0
    v_mov_b32 v175, 0
    v_mov_b32 v176, 0
    v_mov_b32 v177, 0
    v_mov_b32 v178, 0
    v_mov_b32 v179, 0
    v_mov_b32 v180, 0
    v_mov_b32 v181, 0
    v_mov_b32 v182, 0
    v_mov_b32 v183, 0
    v_mov_b32 v184, 0
    v_mov_b32 v185, 0
    v_mov_b32 v186, 0
    v_mov_b32 v187, 0
    v_mov_b32 v188, 0
    v_mov_b32 v189, 0
    v_mov_b32 v190, 0
    v_mov_b32 v191, 0
    v_mov_b32 v192, 0
    v_mov_b32 v193, 0
    v_mov_b32 v194, 0
    v_mov_b32 v195, 0
    v_mov_b32 v196, 0
    v_mov_b32 v197, 0
    v_mov_b32 v198, 0
    v_mov_b32 v199, 0
    v_mov_b32 v200, 0
    v_mov_b32 v201, 0
    v_mov_b32 v202, 0
    v_mov_b32 v203, 0
    v_mov_b32 v204, 0
    v_mov_b32 v205, 0
    v_mov_b32 v206, 0
    v_mov_b32 v207, 0
    s_mov_b32 m0, s67
    s_waitcnt vmcnt(18)
at_y_p_qk:
    s_barrier
    s_cmp_eq_u32 s20, 0
    s_cbranch_scc0 sig_30
    s_cmp_lg_u32 s13, 0
    s_cbranch_scc0 sig_30
    v_mov_b32 v2, 1
    v_mov_b32 v3, 0
    s_mov_b64 exec, 1
    buffer_atomic_add v2, v3, s[4:7], s14 offen sc1
    s_mov_b64 exec, -1
sig_30:
    ds_read_b128 a[0:3], v7 offset:32768
    ds_read_b128 a[4:7], v7 offset:40960
    ds_read_b128 a[8:11], v7 offset:33792
    ds_read_b128 a[12:15], v7 offset:41984
    ds_read_b128 a[16:19], v7 offset:34816
    ds_read_b128 a[20:23], v7 offset:43008
    buffer_load_dwordx4 v30, s[4:7], s29 offen offset:0 sc1 lds
    v_max3_f32 v118, v48, v49, v50
    v_max3_f32 v119, v51, v56, v57
    v_max3_f32 v118, v118, v58, v59
    v_max_f32 v118, v118, v119
    v_mov_b32 v119, v118
    s_nop 1
    v_permlane32_swap_b32 v118, v119
    v_max_f32 v118, v118, v119
    v_mov_b32 v119, v118
    s_nop 1
    v_permlane16_swap_b32 v118, v119
    v_max_f32 v118, v118, v119
    v_add_f32 v118, 0x40e00000, v118
    v_ceil_f32 v118, v118
    buffer_load_dwordx4 v30, s[4:7], s29 offen offset:1024 sc1 lds
    v_sub_f32 v48, v48, v118
    v_sub_f32 v49, v49, v118
    v_sub_f32 v50, v50, v118
    v_sub_f32 v51, v51, v118
    v_sub_f32 v56, v56, v118
    v_sub_f32 v57, v57, v118
    v_sub_f32 v58, v58, v118
    v_sub_f32 v59, v59, v118
    v_sub_f32 v116, 0, v118
    v_mov_b32 v32, v116
    v_mov_b32 v33, v116
    v_mov_b32 v34, v116
    v_mov_b32 v35, v116
    v_mov_b32 v40, v116
    v_mov_b32 v41, v116
    v_mov_b32 v42, v116
    v_mov_b32 v43, v116
    buffer_load_dwordx4 v30, s[4:7], s29 offen offset:2048 sc1 lds
    v_max3_f32 v122, v52, v53, v54
    v_max3_f32 v123, v55, v60, v61
    v_max3_f32 v122, v122, v62, v63
    v_max_f32 v122, v122, v123
    v_mov_b32 v123, v122
    s_nop 1
    v_permlane32_swap_b32 v122, v123
    v_max_f32 v122, v122, v123
    v_mov_b32 v123, v122
    s_nop 1
    v_permlane16_swap_b32 v122, v123
    v_max_f32 v122, v122, v123
    v_add_f32 v122, 0x40e00000, v122
    v_ceil_f32 v122, v122
    buffer_load_dwordx4 v30, s[4:7], s29 offen offset:3072 sc1 lds
    v_sub_f32 v52, v52, v122
    v_sub_f32 v53, v53, v122
    v_sub_f32 v54, v54, v122
    v_sub_f32 v55, v55, v122
    v_sub_f32 v60, v60, v122
    v_sub_f32 v61, v61, v122
    v_sub_f32 v62, v62, v122
    v_sub_f32 v63, v63, v122
    v_sub_f32 v117, 0, v122
    v_mov_b32 v36, v117
    v_mov_b32 v37, v117
    v_mov_b32 v38, v117
    v_mov_b32 v39, v117
    v_mov_b32 v44, v117
    v_mov_b32 v45, v117
    v_mov_b32 v46, v117
    v_mov_b32 v47, v117
    s_add_u32 s67, s28, 49152
    s_add_u32 s28, s28, 32768
    s_and_b32 s28, s28, 0x1ffff
    s_add_u32 m0, s28, 32768
    v_exp_f32 v96, v48
    v_exp_f32 v97, v49
    v_exp_f32 v98, v50
    v_cvt_pk_bf16_f32 v80, v96, v97
    v_exp_f32 v99, v51
    v_exp_f32 v100, v56
    v_cvt_pk_bf16_f32 v81, v98, v99
    v_exp_f32 v101, v57
    v_exp_f32 v102, v58
    v_cvt_pk_bf16_f32 v82, v100, v101
    v_exp_f32 v103, v59
    s_nop 0
    v_cvt_pk_bf16_f32 v83, v102, v103
    v_mov_b32 v208, 0
    v_mov_b32 v209, 0
    v_mov_b32 v210, 0
    v_mov_b32 v211, 0
    v_mov_b32 v212, 0
    v_mov_b32 v213, 0
    v_mov_b32 v214, 0
    v_mov_b32 v215, 0
    v_mov_b32 v216, 0
    v_mov_b32 v217, 0
    v_mov_b32 v218, 0
    v_mov_b32 v219, 0
    v_mov_b32 v220, 0
    v_mov_b32 v221, 0
    v_mov_b32 v222, 0
    v_mov_b32 v223, 0
    v_mov_b32 v224, 0
    v_mov_b32 v225, 0
    v_mov_b32 v226, 0
    v_mov_b32 v227, 0
    v_mov_b32 v228, 0
    v_mov_b32 v229, 0
    v_mov_b32 v230, 0
    v_mov_b32 v231, 0
    v_mov_b32 v232, 0
    v_mov_b32 v233, 0
    v_mov_b32 v234, 0
    v_mov_b32 v235, 0
    v_mov_b32 v236, 0
    v_mov_b32 v237, 0
    v_mov_b32 v238, 0
    v_mov_b32 v239, 0
    v_mov_b32 v240, 0
    v_mov_b32 v241, 0
    v_mov_b32 v242, 0
    v_mov_b32 v243, 0
    v_mov_b32 v244, 0
    v_mov_b32 v245, 0
    v_mov_b32 v246, 0
    v_mov_b32 v247, 0
    v_mov_b32 v248, 0
    v_mov_b32 v249, 0
    v_mov_b32 v250, 0
    v_mov_b32 v251, 0
    v_mov_b32 v252, 0
    v_mov_b32 v253, 0
    v_mov_b32 v254, 0
    v_mov_b32 v255, 0
    buffer_load_dword v16, off, s[4:7], s34 sc1
    s_cmp_ge_i32 s30, s64
    s_cbranch_scc0 at_y_p_later
    s_mov_b32 s98, 0
spin_33:
    s_waitcnt vmcnt(0)
    v_readfirstlane_b32 s99, v16
    s_nop 0
    s_cmp_ge_u32 s99, 1
    s_cbranch_scc1 ok_34
    s_add_u32 s98, s98, 1
    s_cmp_gt_u32 s98, 0x80000
    s_cbranch_scc1 ok_34
    s_sleep 8
    buffer_load_dword v16, off, s[4:7], s34 sc1
    s_waitcnt vmcnt(0)
    s_branch spin_33
ok_34:
at_y_p_later:
    s_cmp_eq_u32 s30, s64
    s_cbranch_scc0 at_y_p_nomask1
    s_add_u32 s3, s30, 1
    s_lshl_b32 s3, s3, 5
    v_subrev_u32 v11, s3, v9
    v_subrev_u32 v12, s3, v10
    v_cmp_le_i32 s[68:69], 0, v11
    v_cmp_le_i32 s[70:71], 1, v11
    v_cmp_le_i32 s[72:73], 2, v11
    v_cmp_le_i32 s[74:75], 3, v11
    v_cmp_le_i32 s[76:77], 0, v12
    v_cmp_le_i32 s[78:79], 1, v12
    v_cmp_le_i32 s[80:81], 2, v12
    v_cmp_le_i32 s[82:83], 3, v12
    v_cndmask_b32 v32, v126, v116, s[68:69]
    v_cndmask_b32 v33, v126, v116, s[70:71]
    v_cndmask_b32 v34, v126, v116, s[72:73]
    v_cndmask_b32 v35, v126, v116, s[74:75]
    v_cndmask_b32 v36, v126, v117, s[76:77]
    v_cndmask_b32 v37, v126, v117, s[78:79]
    v_cndmask_b32 v38, v126, v117, s[80:81]
    v_cndmask_b32 v39, v126, v117, s[82:83]
    v_cmp_le_i32 s[68:69], 16, v11
    v_cmp_le_i32 s[70:71], 17, v11
    v_cmp_le_i32 s[72:73], 18, v11
    v_cmp_le_i32 s[74:75], 19, v11
    v_cmp_le_i32 s[76:77], 16, v12
    v_cmp_le_i32 s[78:79], 17, v12
    v_cmp_le_i32 s[80:81], 18, v12
    v_cmp_le_i32 s[82:83], 19, v12
    v_cndmask_b32 v40, v126, v116, s[68:69]
    v_cndmask_b32 v41, v126, v116, s[70:71]
    v_cndmask_b32 v42, v126, v116, s[72:73]
    v_cndmask_b32 v43, v126, v116, s[74:75]
    v_cndmask_b32 v44, v126, v117, s[76:77]
    v_cndmask_b32 v45, v126, v117, s[78:79]
    v_cndmask_b32 v46, v126, v117, s[80:81]
    v_cndmask_b32 v47, v126, v117, s[82:83]
at_y_p_nomask1:
    s_cmp_eq_u32 s30, s31
    s_cbranch_scc0 at_y_p_more
    s_branch at_y_tail0
at_y_p_more:
at_y_loop:
    s_waitcnt lgkmcnt(4)
    v_mfma_f32_16x16x32_bf16 v[64:67], a[0:3], a[32:35], v[32:35]
    ds_read_b128 a[24:27], v7 offset:35840
    ds_read_b128 a[28:31], v7 offset:44032
    v_mfma_f32_16x16x32_bf16 v[68:71], a[0:3], a[80:83], v[36:39]
    v_exp_f32 v96, v52
    v_mfma_f32_16x16x32_bf16 v[76:79], a[4:7], a[80:83], v[44:47]
    v_exp_f32 v97, v53
    v_mfma_f32_16x16x32_bf16 v[72:75], a[4:7], a[32:35], v[40:43]
    v_cvt_pk_bf16_f32 v84, v96, v97
    s_waitcnt lgkmcnt(4)
    v_mfma_f32_16x16x32_bf16 v[64:67], a[8:11], a[36:39], v[64:67]
    ds_read_b128 a[0:3], v7 offset:36864
    ds_read_b128 a[4:7], v7 offset:45056
    v_mfma_f32_16x16x32_bf16 v[68:71], a[8:11], a[84:87], v[68:71]
    v_exp_f32 v98, v54
    v_mfma_f32_16x16x32_bf16 v[76:79], a[12:15], a[84:87], v[76:79]
    buffer_load_dwordx4 v30, s[4:7], s24 offen offset:0 sc1 lds
    s_add_u32 s29, s66, 16384
    v_mfma_f32_16x16x32_bf16 v[72:75], a[12:15], a[36:39], v[72:75]
    s_mov_b32 s66, s24
    s_waitcnt lgkmcnt(4)
    v_mfma_f32_16x16x32_bf16 v[64:67], a[16:19], a[40:43], v[64:67]
    ds_read_b128 a[8:11], v7 offset:37888
    ds_read_b128 a[12:15], v7 offset:46080
    v_mfma_f32_16x16x32_bf16 v[68:71], a[16:19], a[88:91], v[68:71]
    v_exp_f32 v99, v55
    v_mfma_f32_16x16x32_bf16 v[76:79], a[20:23], a[88:91], v[76:79]
    v_exp_f32 v100, v60
    v_mfma_f32_16x16x32_bf16 v[72:75], a[20:23], a[40:43], v[72:75]
    v_cvt_pk_bf16_f32 v85, v98, v99
    s_waitcnt lgkmcnt(4)
    v_mfma_f32_16x16x32_bf16 v[64:67], a[24:27], a[44:47], v[64:67]
    ds_read_b128 a[16:19], v7 offset:38912
    ds_read_b128 a[20:23], v7 offset:47104
    v_mfma_f32_16x16x32_bf16 v[68:71], a[24:27], a[92:95], v[68:71]
    v_exp_f32 v101, v61
    v_mfma_f32_16x16x32_bf16 v[76:79], a[28:31], a[92:95], v[76:79]
    buffer_load_dwordx4 v30, s[4:7], s24 offen offset:1024 sc1 lds
    v_mfma_f32_16x16x32_bf16 v[72:75], a[28:31], a[44:47], v[72:75]
    v_cvt_pk_bf16_f32 v86, v100, v101
    s_waitcnt lgkmcnt(4)
    v_mfma_f32_16x16x32_bf16 v[64:67], a[0:3], a[48:51], v[64:67]
    ds_read_b128 a[24:27], v7 offset:39936
    ds_read_b128 a[28:31], v7 offset:48128
    v_mfma_f32_16x16x32_bf16 v[68:71], a[0:3], a[96:99], v[68:71]
    v_exp_f32 v102, v62
    v_mfma_f32_16x16x32_bf16 v[76:79], a[4:7], a[96:99], v[76:79]
    v_exp_f32 v103, v63
    v_mfma_f32_16x16x32_bf16 v[72:75], a[4:7], a[48:51], v[72:75]
    v_cvt_pk_bf16_f32 v87, v102, v103
    s_waitcnt lgkmcnt(4)
    v_mfma_f32_16x16x32_bf16 v[64:67], a[8:11], a[52:55], v[64:67]
    ds_read_b128 a[0:3], v6 offset:49152
    ds_read_b128 a[4:7], v6 offset:50176
    v_mfma_f32_16x16x32_bf16 v[68:71], a[8:11], a[100:103], v[68:71]
    v_or3_b32 v11, v80, v81, v82
    v_or3_b32 v11, v11, v83, v84
    v_mfma_f32_16x16x32_bf16 v[76:79], a[12:15], a[100:103], v[76:79]
    buffer_load_dwordx4 v30, s[4:7], s24 offen offset:2048 sc1 lds
    v_mfma_f32_16x16x32_bf16 v[72:75], a[12:15], a[52:55], v[72:75]
    v_or3_b32 v11, v11, v85, v86
    s_waitcnt lgkmcnt(4)
    v_mfma_f32_16x16x32_bf16 v[64:67], a[16:19], a[56:59], v[64:67]
    ds_read_b128 a[8:11], v6 offset:51200
    ds_read_b128 a[12:15], v6 offset:52224
    v_mfma_f32_16x16x32_bf16 v[68:71], a[16:19], a[104:107], v[68:71]
    v_bitop3_b32 v11, v11, v87, s65 bitop3:0xa8
    v_cmp_ne_u32 vcc, 0, v11
    v_mfma_f32_16x16x32_bf16 v[76:79], a[20:23], a[104:107], v[76:79]
    v_mfma_f32_16x16x32_bf16 v[72:75], a[20:23], a[56:59], v[72:75]
    s_cbranch_vccnz at_y_rs0
at_y_rs0_ret:
    s_waitcnt lgkmcnt(4)
    v_mfma_f32_16x16x32_bf16 v[64:67], a[24:27], a[60:63], v[64:67]
    ds_read_b128 a[16:19], v6 offset:53248
    ds_read_b128 a[20:23], v6 offset:54272
    v_mfma_f32_16x16x32_bf16 v[68:71], a[24:27], a[108:111], v[68:71]
    buffer_load_dwordx4 v30, s[4:7], s24 offen offset:3072 sc1 lds
    v_mfma_f32_16x16x32_bf16 v[76:79], a[28:31], a[108:111], v[76:79]
    s_add_u32 s24, s24, 32768
    s_mov_b32 m0, s67
    v_mfma_f32_16x16x32_bf16 v[72:75], a[28:31], a[60:63], v[72:75]
    s_waitcnt vmcnt(12)
    s_barrier
    v_mfma_f32_16x16x32_bf16 v[104:107], v[112:115], v[80:83], v[104:107]
    buffer_load_dwordx4 v30, s[4:7], s29 offen offset:0 sc1 lds
    v_mfma_f32_16x16x32_bf16 v[108:111], v[112:115], v[84:87], v[108:111]
    s_waitcnt lgkmcnt(4)
    v_mfma_f32_16x16x32_bf16 v[132:135], a[0:3], v[84:87], v[132:135]
    ds_read_b128 a[24:27], v6 offset:55296
    ds_read_b128 a[28:31], v6 offset:56320
    v_mfma_f32_16x16x32_bf16 v[128:131], a[0:3], v[80:83], v[128:131]
    v_exp_f32 v96, v64
    v_mfma_f32_16x16x32_bf16 v[136:139], a[4:7], v[80:83], v[136:139]
    v_exp_f32 v97, v65
    v_mfma_f32_16x16x32_bf16 v[140:143], a[4:7], v[84:87], v[140:143]
    v_cvt_pk_bf16_f32 v88, v96, v97
    s_waitcnt lgkmcnt(4)
    v_mfma_f32_16x16x32_bf16 v[148:151], a[8:11], v[84:87], v[148:151]
    ds_read_b128 a[0:3], v6 offset:57344
    ds_read_b128 a[4:7], v6 offset:58368
    v_mfma_f32_16x16x32_bf16 v[144:147], a[8:11], v[80:83], v[144:147]
    v_exp_f32 v98, v66
    v_mfma_f32_16x16x32_bf16 v[152:155], a[12:15], v[80:83], v[152:155]
    buffer_load_dwordx4 v30, s[4:7], s29 offen offset:1024 sc1 lds
    s_add_u32 s67, s28, 49152
    v_mfma_f32_16x16x32_bf16 v[156:159], a[12:15], v[84:87], v[156:159]
    s_add_u32 s28, s28, 32768
    s_waitcnt lgkmcnt(4)
    v_mfma_f32_16x16x32_bf16 v[164:167], a[16:19], v[84:87], v[164:167]
    ds_read_b128 a[8:11], v6 offset:59392
    ds_read_b128 a[12:15], v6 offset:60416
    v_mfma_f32_16x16x32_bf16 v[160:163], a[16:19], v[80:83], v[160:163]
    v_exp_f32 v99, v67
    v_mfma_f32_16x16x32_bf16 v[168:171], a[20:23], v[80:83], v[168:171]
    v_exp_f32 v100, v72
    v_mfma_f32_16x16x32_bf16 v[172:175], a[20:23], v[84:87], v[172:175]
    v_cvt_pk_bf16_f32 v89, v98, v99
    s_waitcnt lgkmcnt(4)
    v_mfma_f32_16x16x32_bf16 v[180:183], a[24:27], v[84:87], v[180:183]
    ds_read_b128 a[16:19], v6 offset:61440
    ds_read_b128 a[20:23], v6 offset:62464
    v_mfma_f32_16x16x32_bf16 v[176:179], a[24:27], v[80:83], v[176:179]
    v_exp_f32 v101, v73
    v_mfma_f32_16x16x32_bf16 v[184:187], a[28:31], v[80:83], v[184:187]
    buffer_load_dwordx4 v30, s[4:7], s29 offen offset:2048 sc1 lds
    s_and_b32 s28, s28, 0x1ffff
    v_mfma_f32_16x16x32_bf16 v[188:191], a[28:31], v[84:87], v[188:191]
    v_cvt_pk_bf16_f32 v90, v100, v101
    s_waitcnt lgkmcnt(4)
    v_mfma_f32_16x16x32_bf16 v[196:199], a[0:3], v[84:87], v[196:199]
    ds_read_b128 a[24:27], v6 offset:63488
    ds_read_b128 a[28:31], v6 offset:64512
    v_mfma_f32_16x16x32_bf16 v[192:195], a[0:3], v[80:83], v[192:195]
    v_exp_f32 v102, v74
    v_mfma_f32_16x16x32_bf16 v[200:203], a[4:7], v[80:83], v[200:203]
    v_xor_b32 v6, 0x10000, v6
    s_add_u32 s30, s30, 1
    v_mfma_f32_16x16x32_bf16 v[204:207], a[4:7], v[84:87], v[204:207]
    s_waitcnt lgkmcnt(4)
    v_mfma_f32_16x16x32_bf16 v[212:215], a[8:11], v[84:87], v[212:215]
    ds_read_b128 a[0:3], v6 offset:32768
    ds_read_b128 a[4:7], v6 offset:40960
    v_mfma_f32_16x16x32_bf16 v[208:211], a[8:11], v[80:83], v[208:211]
    v_exp_f32 v103, v75
    v_mfma_f32_16x16x32_bf16 v[216:219], a[12:15], v[80:83], v[216:219]
    buffer_load_dwordx4 v30, s[4:7], s29 offen offset:3072 sc1 lds
    v_mfma_f32_16x16x32_bf16 v[220:223], a[12:15], v[84:87], v[220:223]
    v_cvt_pk_bf16_f32 v91, v102, v103
    s_waitcnt lgkmcnt(4)
    v_mfma_f32_16x16x32_bf16 v[228:231], a[16:19], v[84:87], v[228:231]
    ds_read_b128 a[8:11], v6 offset:33792
    ds_read_b128 a[12:15], v6 offset:41984
    v_mfma_f32_16x16x32_bf16 v[224:227], a[16:19], v[80:83], v[224:227]
    s_cmp_eq_u32 s24, s25
    s_cselect_b32 s24, s26, s24
    v_mfma_f32_16x16x32_bf16 v[232:235], a[20:23], v[80:83], v[232:235]
    s_cselect_b32 s25, s27, s25
    s_cselect_b32 s26, 1073741824, s26
    v_mfma_f32_16x16x32_bf16 v[236:239], a[20:23], v[84:87], v[236:239]
    s_add_u32 m0, s28, 32768
    s_waitcnt lgkmcnt(4)
    v_mfma_f32_16x16x32_bf16 v[244:247], a[24:27], v[84:87], v[244:247]
    ds_read_b128 a[16:19], v6 offset:34816
    ds_read_b128 a[20:23], v6 offset:43008
    v_mfma_f32_16x16x32_bf16 v[240:243], a[24:27], v[80:83], v[240:243]
    s_cmp_ge_i32 s30, s9
    s_cbranch_scc1 at_y_ev1
at_y_ev1_ret:
    v_mfma_f32_16x16x32_bf16 v[248:251], a[28:31], v[80:83], v[248:251]
    s_cmp_eq_u32 s30, s31
    v_mfma_f32_16x16x32_bf16 v[252:255], a[28:31], v[84:87], v[252:255]
    s_cbranch_scc1 at_y_tail1
at_y_b1:
    s_waitcnt lgkmcnt(4)
    v_mfma_f32_16x16x32_bf16 v[48:51], a[0:3], a[32:35], v[32:35]
    ds_read_b128 a[24:27], v6 offset:35840
    ds_read_b128 a[28:31], v6 offset:44032
    v_mfma_f32_16x16x32_bf16 v[52:55], a[0:3], a[80:83], v[36:39]
    v_exp_f32 v96, v68
    v_mfma_f32_16x16x32_bf16 v[60:63], a[4:7], a[80:83], v[44:47]
    v_exp_f32 v97, v69
    v_mfma_f32_16x16x32_bf16 v[56:59], a[4:7], a[32:35], v[40:43]
    v_cvt_pk_bf16_f32 v92, v96, v97
    s_waitcnt lgkmcnt(4)
    v_mfma_f32_16x16x32_bf16 v[48:51], a[8:11], a[36:39], v[48:51]
    ds_read_b128 a[0:3], v6 offset:36864
    ds_read_b128 a[4:7], v6 offset:45056
    v_mfma_f32_16x16x32_bf16 v[52:55], a[8:11], a[84:87], v[52:55]
    v_exp_f32 v98, v70
    v_mfma_f32_16x16x32_bf16 v[60:63], a[12:15], a[84:87], v[60:63]
    buffer_load_dwordx4 v30, s[4:7], s24 offen offset:0 sc1 lds
    s_add_u32 s29, s66, 16384
    v_mfma_f32_16x16x32_bf16 v[56:59], a[12:15], a[36:39], v[56:59]
    s_mov_b32 s66, s24
    s_waitcnt lgkmcnt(4)
    v_mfma_f32_16x16x32_bf16 v[48:51], a[16:19], a[40:43], v[48:51]
    ds_read_b128 a[8:11], v6 offset:37888
    ds_read_b128 a[12:15], v6 offset:46080
    v_mfma_f32_16x16x32_bf16 v[52:55], a[16:19], a[88:91], v[52:55]
    v_exp_f32 v99, v71
    v_mfma_f32_16x16x32_bf16 v[60:63], a[20:23], a[88:91], v[60:63]
    v_exp_f32 v100, v76
    v_mfma_f32_16x16x32_bf16 v[56:59], a[20:23], a[40:43], v[56:59]
    v_cvt_pk_bf16_f32 v93, v98, v99
    s_waitcnt lgkmcnt(4)
    v_mfma_f32_16x16x32_bf16 v[48:51], a[24:27], a[44:47], v[48:51]
    ds_read_b128 a[16:19], v6 offset:38912
    ds_read_b128 a[20:23], v6 offset:47104
    v_mfma_f32_16x16x32_bf16 v[52:55], a[24:27], a[92:95], v[52:55]
    v_exp_f32 v101, v77
    v_mfma_f32_16x16x32_bf16 v[60:63], a[28:31], a[92:95], v[60:63]
    buffer_load_dwordx4 v30, s[4:7], s24 offen offset:1024 sc1 lds
    v_mfma_f32_16x16x32_bf16 v[56:59], a[28:31], a[44:47], v[56:59]
    v_cvt_pk_bf16_f32 v94, v100, v101
    s_waitcnt lgkmcnt(4)
    v_mfma_f32_16x16x32_bf16 v[48:51], a[0:3], a[48:51], v[48:51]
    ds_read_b128 a[24:27], v6 offset:39936
    ds_read_b128 a[28:31], v6 offset:48128
    v_mfma_f32_16x16x32_bf16 v[52:55], a[0:3], a[96:99], v[52:55]
    v_exp_f32 v102, v78
    v_mfma_f32_16x16x32_bf16 v[60:63], a[4:7], a[96:99], v[60:63]
    v_exp_f32 v103, v79
    v_mfma_f32_16x16x32_bf16 v[56:59], a[4:7], a[48:51], v[56:59]
    v_cvt_pk_bf16_f32 v95, v102, v103
    s_waitcnt lgkmcnt(4)
    v_mfma_f32_16x16x32_bf16 v[48:51], a[8:11], a[52:55], v[48:51]
    ds_read_b128 a[0:3], v7 offset:49152
    ds_read_b128 a[4:7], v7 offset:50176
    v_mfma_f32_16x16x32_bf16 v[52:55], a[8:11], a[100:103], v[52:55]
    v_or3_b32 v11, v88, v89, v90
    v_or3_b32 v11, v11, v91, v92
    v_mfma_f32_16x16x32_bf16 v[60:63], a[12:15], a[100:103], v[60:63]
    buffer_load_dwordx4 v30, s[4:7], s24 offen offset:2048 sc1 lds
    v_mfma_f32_16x16x32_bf16 v[56:59], a[12:15], a[52:55], v[56:59]
    v_or3_b32 v11, v11, v93, v94
    s_waitcnt lgkmcnt(4)
    v_mfma_f32_16x16x32_bf16 v[48:51], a[16:19], a[56:59], v[48:51]
    ds_read_b128 a[8:11], v7 offset:51200
    ds_read_b128 a[12:15], v7 offset:52224
    v_mfma_f32_16x16x32_bf16 v[52:55], a[16:19], a[104:107], v[52:55]
    v_bitop3_b32 v11, v11, v95, s65 bitop3:0xa8
    v_cmp_ne_u32 vcc, 0, v11
    v_mfma_f32_16x16x32_bf16 v[60:63], a[20:23], a[104:107], v[60:63]
    v_mfma_f32_16x16x32_bf16 v[56:59], a[20:23], a[56:59], v[56:59]
    s_cbranch_vccnz at_y_rs1
at_y_rs1_ret:
    s_waitcnt lgkmcnt(4)
    v_mfma_f32_16x16x32_bf16 v[48:51], a[24:27], a[60:63], v[48:51]
    ds_read_b128 a[16:19], v7 offset:53248
    ds_read_b128 a[20:23], v7 offset:54272
    v_mfma_f32_16x16x32_bf16 v[52:55], a[24:27], a[108:111], v[52:55]
    buffer_load_dwordx4 v30, s[4:7], s24 offen offset:3072 sc1 lds
    v_mfma_f32_16x16x32_bf16 v[60:63], a[28:31], a[108:111], v[60:63]
    s_add_u32 s24, s24, 32768
    s_mov_b32 m0, s67
    v_mfma_f32_16x16x32_bf16 v[56:59], a[28:31], a[60:63], v[56:59]
    s_waitcnt vmcnt(12)
    s_barrier
    v_mfma_f32_16x16x32_bf16 v[104:107], v[112:115], v[88:91], v[104:107]
    buffer_load_dwordx4 v30, s[4:7], s29 offen offset:0 sc1 lds
    v_mfma_f32_16x16x32_bf16 v[108:111], v[112:115], v[92:95], v[108:111]
    s_waitcnt lgkmcnt(4)
    v_mfma_f32_16x16x32_bf16 v[132:135], a[0:3], v[92:95], v[132:135]
    ds_read_b128 a[24:27], v7 offset:55296
    ds_read_b128 a[28:31], v7 offset:56320
    v_mfma_f32_16x16x32_bf16 v[128:131], a[0:3], v[88:91], v[128:131]
    v_exp_f32 v96, v48
    v_mfma_f32_16x16x32_bf16 v[136:139], a[4:7], v[88:91], v[136:139]
    v_exp_f32 v97, v49
    v_mfma_f32_16x16x32_bf16 v[140:143], a[4:7], v[92:95], v[140:143]
    v_cvt_pk_bf16_f32 v80, v96, v97
    s_waitcnt lgkmcnt(4)
    v_mfma_f32_16x16x32_bf16 v[148:151], a[8:11], v[92:95], v[148:151]
    ds_read_b128 a[0:3], v7 offset:57344
    ds_read_b128 a[4:7], v7 offset:58368
    v_mfma_f32_16x16x32_bf16 v[144:147], a[8:11], v[88:91], v[144:147]
    v_exp_f32 v98, v50
    v_mfma_f32_16x16x32_bf16 v[152:155], a[12:15], v[88:91], v[152:155]
    buffer_load_dwordx4 v30, s[4:7], s29 offen offset:1024 sc1 lds
    s_add_u32 s67, s28, 49152
    v_mfma_f32_16x16x32_bf16 v[156:159], a[12:15], v[92:95], v[156:159]
    s_add_u32 s28, s28, 32768
    s_waitcnt lgkmcnt(4)
    v_mfma_f32_16x16x32_bf16 v[164:167], a[16:19], v[92:95], v[164:167]
    ds_read_b128 a[8:11], v7 offset:59392
    ds_read_b128 a[12:15], v7 offset:60416
    v_mfma_f32_16x16x32_bf16 v[160:163], a[16:19], v[88:91], v[160:163]
    v_exp_f32 v99, v51
    v_mfma_f32_16x16x32_bf16 v[168:171], a[20:23], v[88:91], v[168:171]
    v_exp_f32 v100, v56
    v_mfma_f32_16x16x32_bf16 v[172:175], a[20:23], v[92:95], v[172:175]
    v_cvt_pk_bf16_f32 v81, v98, v99
    s_waitcnt lgkmcnt(4)
    v_mfma_f32_16x16x32_bf16 v[180:183], a[24:27], v[92:95], v[180:183]
    ds_read_b128 a[16:19], v7 offset:61440
    ds_read_b128 a[20:23], v7 offset:62464
    v_mfma_f32_16x16x32_bf16 v[176:179], a[24:27], v[88:91], v[176:179]
    v_exp_f32 v101, v57
    v_mfma_f32_16x16x32_bf16 v[184:187], a[28:31], v[88:91], v[184:187]
    buffer_load_dwordx4 v30, s[4:7], s29 offen offset:2048 sc1 lds
    s_and_b32 s28, s28, 0x1ffff
    v_mfma_f32_16x16x32_bf16 v[188:191], a[28:31], v[92:95], v[188:191]
    v_cvt_pk_bf16_f32 v82, v100, v101
    s_waitcnt lgkmcnt(4)
    v_mfma_f32_16x16x32_bf16 v[196:199], a[0:3], v[92:95], v[196:199]
    ds_read_b128 a[24:27], v7 offset:63488
    ds_read_b128 a[28:31], v7 offset:64512
    v_mfma_f32_16x16x32_bf16 v[192:195], a[0:3], v[88:91], v[192:195]
    v_exp_f32 v102, v58
    v_mfma_f32_16x16x32_bf16 v[200:203], a[4:7], v[88:91], v[200:203]
    v_xor_b32 v7, 0x10000, v7
    s_add_u32 s30, s30, 1
    v_mfma_f32_16x16x32_bf16 v[204:207], a[4:7], v[92:95], v[204:207]
    s_waitcnt lgkmcnt(4)
    v_mfma_f32_16x16x32_bf16 v[212:215], a[8:11], v[92:95], v[212:215]
    ds_read_b128 a[0:3], v7 offset:32768
    ds_read_b128 a[4:7], v7 offset:40960
    v_mfma_f32_16x16x32_bf16 v[208:211], a[8:11], v[88:91], v[208:211]
    v_exp_f32 v103, v59
    v_mfma_f32_16x16x32_bf16 v[216:219], a[12:15], v[88:91], v[216:219]
    buffer_load_dwordx4 v30, s[4:7], s29 offen offset:3072 sc1 lds
    v_mfma_f32_16x16x32_bf16 v[220:223], a[12:15], v[92:95], v[220:223]
    v_cvt_pk_bf16_f32 v83, v102, v103
    s_waitcnt lgkmcnt(4)
    v_mfma_f32_16x16x32_bf16 v[228:231], a[16:19], v[92:95], v[228:231]
    ds_read_b128 a[8:11], v7 offset:33792
    ds_read_b128 a[12:15], v7 offset:41984
    v_mfma_f32_16x16x32_bf16 v[224:227], a[16:19], v[88:91], v[224:227]
    s_cmp_eq_u32 s24, s25
    s_cselect_b32 s24, s26, s24
    v_mfma_f32_16x16x32_bf16 v[232:235], a[20:23], v[88:91], v[232:235]
    s_cselect_b32 s25, s27, s25
    s_cselect_b32 s26, 1073741824, s26
    v_mfma_f32_16x16x32_bf16 v[236:239], a[20:23], v[92:95], v[236:239]
    s_add_u32 m0, s28, 32768
    s_waitcnt lgkmcnt(4)
    v_mfma_f32_16x16x32_bf16 v[244:247], a[24:27], v[92:95], v[244:247]
    ds_read_b128 a[16:19], v7 offset:34816
    ds_read_b128 a[20:23], v7 offset:43008
    v_mfma_f32_16x16x32_bf16 v[240:243], a[24:27], v[88:91], v[240:243]
    s_cmp_ge_i32 s30, s9
    s_cbranch_scc1 at_y_ev0
at_y_ev0_ret:
    v_mfma_f32_16x16x32_bf16 v[248:251], a[28:31], v[88:91], v[248:251]
    s_cmp_lg_u32 s30, s31
    v_mfma_f32_16x16x32_bf16 v[252:255], a[28:31], v[92:95], v[252:255]
    s_cbranch_scc1 at_y_loop
    s_branch at_y_tail0
at_y_ev0:
    s_cmp_ge_i32 s30, s10
    s_cbranch_scc0 e_35
    s_cmp_eq_u32 s20, 0
    s_cbranch_scc0 sig_37
    v_mov_b32 v2, 1
    v_mov_b32 v3, 0
    s_mov_b64 exec, 1
    buffer_atomic_add v2, v3, s[4:7], s33 offen sc1
    s_mov_b64 exec, -1
sig_37:
    s_mov_b32 s10, 2147483647
    s_sub_u32 s9, s64, 1
e_35:
    s_add_u32 s3, s30, 1
    s_cmp_eq_u32 s3, s64
    s_cbranch_scc0 e_38
    s_waitcnt vmcnt(9)
    buffer_load_dword v31, off, s[4:7], s14 sc1
    s_waitcnt vmcnt(9)
    buffer_load_dword v16, off, s[4:7], s34 sc1
    s_branch at_y_ev0_ret
e_38:
    s_cmp_eq_u32 s30, s64
    s_cbranch_scc0 at_y_ev0_ret
    s_mov_b32 s98, 0
spin_41:
    s_waitcnt vmcnt(8)
    v_readfirstlane_b32 s99, v16
    s_nop 0
    s_cmp_ge_u32 s99, 1
    s_cbranch_scc1 ok_42
    s_add_u32 s98, s98, 1
    s_cmp_gt_u32 s98, 0x80000
    s_cbranch_scc1 ok_42
    s_sleep 8
    buffer_load_dword v16, off, s[4:7], s34 sc1
    s_waitcnt vmcnt(0)
    s_branch spin_41
ok_42:
    s_cmp_eq_u32 s88, 0
    s_cbranch_scc0 e_36
    v_readfirstlane_b32 s88, v31
    s_nop 0
    s_cmp_eq_u32 s88, 0
    s_cbranch_scc1 e_36
    s_add_u32 s3, s11, 0
    buffer_load_dwordx4 a[128:131], v25, s[4:7], s3 offen offset:0 sc1
    buffer_load_dwordx4 a[132:135], v25, s[4:7], s3 offen offset:1024 sc1
    buffer_load_dwordx4 a[136:139], v25, s[4:7], s3 offen offset:2048 sc1
    buffer_load_dwordx4 a[140:143], v25, s[4:7], s3 offen offset:3072 sc1
    s_add_u32 s3, s11, 4096
    buffer_load_dwordx4 a[144:147], v25, s[4:7], s3 offen offset:0 sc1
    buffer_load_dwordx4 a[148:151], v25, s[4:7], s3 offen offset:1024 sc1
    buffer_load_dwordx4 a[152:155], v25, s[4:7], s3 offen offset:2048 sc1
    buffer_load_dwordx4 a[156:159], v25, s[4:7], s3 offen offset:3072 sc1
    s_add_u32 s3, s11, 8192
    buffer_load_dwordx4 a[160:163], v25, s[4:7], s3 offen offset:0 sc1
    s_waitcnt vmcnt(25)
    buffer_load_dwordx4 a[164:167], v25, s[4:7], s3 offen offset:1024 sc1
    s_waitcnt vmcnt(25)
    buffer_load_dwordx4 a[168:171], v25, s[4:7], s3 offen offset:2048 sc1
    s_waitcnt vmcnt(25)
    buffer_load_dwordx4 a[172:175], v25, s[4:7], s3 offen offset:3072 sc1
    s_add_u32 s3, s11, 12288
    s_waitcnt vmcnt(25)
    buffer_load_dwordx4 a[176:179], v25, s[4:7], s3 offen offset:0 sc1
    s_waitcnt vmcnt(25)
    buffer_load_dwordx4 a[180:183], v25, s[4:7], s3 offen offset:1024 sc1
    s_waitcnt vmcnt(25)
    buffer_load_dwordx4 a[184:187], v25, s[4:7], s3 offen offset:2048 sc1
    s_waitcnt vmcnt(25)
    buffer_load_dwordx4 a[188:191], v25, s[4:7], s3 offen offset:3072 sc1
    s_add_u32 s3, s11, 8388608
    s_waitcnt vmcnt(25)
    buffer_load_dwordx4 a[192:195], v25, s[4:7], s3 offen sc1
e_36:
    s_add_u32 s3, s30, 1
    s_lshl_b32 s3, s3, 5
    v_subrev_u32 v11, s3, v9
    v_subrev_u32 v12, s3, v10
    v_cmp_le_i32 s[68:69], 0, v11
    v_cmp_le_i32 s[70:71], 1, v11
    v_cmp_le_i32 s[72:73], 2, v11
    v_cmp_le_i32 s[74:75], 3, v11
    v_cmp_le_i32 s[76:77], 0, v12
    v_cmp_le_i32 s[78:79], 1, v12
    v_cmp_le_i32 s[80:81], 2, v12
    v_cmp_le_i32 s[82:83], 3, v12
    v_cndmask_b32 v32, v126, v116, s[68:69]
    v_cndmask_b32 v33, v126, v116, s[70:71]
    v_cndmask_b32 v34, v126, v116, s[72:73]
    v_cndmask_b32 v35, v126, v116, s[74:75]
    v_cndmask_b32 v36, v126, v117, s[76:77]
    v_cndmask_b32 v37, v126, v117, s[78:79]
    v_cndmask_b32 v38, v126, v117, s[80:81]
    v_cndmask_b32 v39, v126, v117, s[82:83]
    v_cmp_le_i32 s[68:69], 16, v11
    v_cmp_le_i32 s[70:71], 17, v11
    v_cmp_le_i32 s[72:73], 18, v11
    v_cmp_le_i32 s[74:75], 19, v11
    v_cmp_le_i32 s[76:77], 16, v12
    v_cmp_le_i32 s[78:79], 17, v12
    v_cmp_le_i32 s[80:81], 18, v12
    v_cmp_le_i32 s[82:83], 19, v12
    v_cndmask_b32 v40, v126, v116, s[68:69]
    v_cndmask_b32 v41, v126, v116, s[70:71]
    v_cndmask_b32 v42, v126, v116, s[72:73]
    v_cndmask_b32 v43, v126, v116, s[74:75]
    v_cndmask_b32 v44, v126, v117, s[76:77]
    v_cndmask_b32 v45, v126, v117, s[78:79]
    v_cndmask_b32 v46, v126, v117, s[80:81]
    v_cndmask_b32 v47, v126, v117, s[82:83]
    s_branch at_y_ev0_ret
at_y_rs0:
    v_max3_f32 v118, v48, v49, v50
    v_max3_f32 v119, v51, v56, v57
    v_max3_f32 v118, v118, v58, v59
    v_max_f32 v118, v118, v119
    v_mov_b32 v119, v118
    s_nop 1
    v_permlane32_swap_b32 v118, v119
    v_max_f32 v118, v118, v119
    v_mov_b32 v119, v118
    s_nop 1
    v_permlane16_swap_b32 v118, v119
    v_max_f32 v118, v118, v119
    v_add_f32 v118, 0x40e00000, v118
    v_ceil_f32 v118, v118
    v_max_f32 v118, 0, v118
    v_exp_f32 v119, -v118
    v_sub_f32 v116, v116, v118
    v_sub_f32 v32, v32, v118
    v_sub_f32 v33, v33, v118
    v_sub_f32 v34, v34, v118
    v_sub_f32 v35, v35, v118
    v_sub_f32 v40, v40, v118
    v_sub_f32 v41, v41, v118
    v_sub_f32 v42, v42, v118
    v_sub_f32 v43, v43, v118
    v_sub_f32 v48, v48, v118
    v_sub_f32 v49, v49, v118
    v_sub_f32 v50, v50, v118
    v_sub_f32 v51, v51, v118
    v_sub_f32 v56, v56, v118
    v_sub_f32 v57, v57, v118
    v_sub_f32 v58, v58, v118
    v_sub_f32 v59, v59, v118
    v_sub_f32 v64, v64, v118
    v_sub_f32 v65, v65, v118
    v_sub_f32 v66, v66, v118
    v_sub_f32 v67, v67, v118
    v_sub_f32 v72, v72, v118
    v_sub_f32 v73, v73, v118
    v_sub_f32 v74, v74, v118
    v_sub_f32 v75, v75, v118
    v_mul_f32 v104, v104, v119
    v_mul_f32 v105, v105, v119
    v_mul_f32 v106, v106, v119
    v_mul_f32 v107, v107, v119
    v_mul_f32 v128, v128, v119
    v_mul_f32 v129, v129, v119
    v_mul_f32 v130, v130, v119
    v_mul_f32 v131, v131, v119
    v_mul_f32 v136, v136, v119
    v_mul_f32 v137, v137, v119
    v_mul_f32 v138, v138, v119
    v_mul_f32 v139, v139, v119
    v_mul_f32 v144, v144, v119
    v_mul_f32 v145, v145, v119
    v_mul_f32 v146, v146, v119
    v_mul_f32 v147, v147, v119
    v_mul_f32 v152, v152, v119
    v_mul_f32 v153, v153, v119
    v_mul_f32 v154, v154, v119
    v_mul_f32 v155, v155, v119
    v_mul_f32 v160, v160, v119
    v_mul_f32 v161, v161, v119
    v_mul_f32 v162, v162, v119
    v_mul_f32 v163, v163, v119
    v_mul_f32 v168, v168, v119
    v_mul_f32 v169, v169, v119
    v_mul_f32 v170, v170, v119
    v_mul_f32 v171, v171, v119
    v_mul_f32 v176, v176, v119
    v_mul_f32 v177, v177, v119
    v_mul_f32 v178, v178, v119
    v_mul_f32 v179, v179, v119
    v_mul_f32 v184, v184, v119
    v_mul_f32 v185, v185, v119
    v_mul_f32 v186, v186, v119
    v_mul_f32 v187, v187, v119
    v_mul_f32 v192, v192, v119
    v_mul_f32 v193, v193, v119
    v_mul_f32 v194, v194, v119
    v_mul_f32 v195, v195, v119
    v_mul_f32 v200, v200, v119
    v_mul_f32 v201, v201, v119
    v_mul_f32 v202, v202, v119
    v_mul_f32 v203, v203, v119
    v_mul_f32 v208, v208, v119
    v_mul_f32 v209, v209, v119
    v_mul_f32 v210, v210, v119
    v_mul_f32 v211, v211, v119
    v_mul_f32 v216, v216, v119
    v_mul_f32 v217, v217, v119
    v_mul_f32 v218, v218, v119
    v_mul_f32 v219, v219, v119
    v_mul_f32 v224, v224, v119
    v_mul_f32 v225, v225, v119
    v_mul_f32 v226, v226, v119
    v_mul_f32 v227, v227, v119
    v_mul_f32 v232, v232, v119
    v_mul_f32 v233, v233, v119
    v_mul_f32 v234, v234, v119
    v_mul_f32 v235, v235, v119
    v_mul_f32 v240, v240, v119
    v_mul_f32 v241, v241, v119
    v_mul_f32 v242, v242, v119
    v_mul_f32 v243, v243, v119
    v_mul_f32 v248, v248, v119
    v_mul_f32 v249, v249, v119
    v_mul_f32 v250, v250, v119
    v_mul_f32 v251, v251, v119
    v_exp_f32 v96, v48
    v_exp_f32 v97, v49
    v_exp_f32 v98, v50
    v_cvt_pk_bf16_f32 v80, v96, v97
    v_exp_f32 v99, v51
    v_exp_f32 v100, v56
    v_cvt_pk_bf16_f32 v81, v98, v99
    v_exp_f32 v101, v57
    v_exp_f32 v102, v58
    v_cvt_pk_bf16_f32 v82, v100, v101
    v_exp_f32 v103, v59
    s_nop 0
    v_cvt_pk_bf16_f32 v83, v102, v103
    v_max3_f32 v122, v52, v53, v54
    v_max3_f32 v123, v55, v60, v61
    v_max3_f32 v122, v122, v62, v63
    v_max_f32 v122, v122, v123
    v_mov_b32 v123, v122
    s_nop 1
    v_permlane32_swap_b32 v122, v123
    v_max_f32 v122, v122, v123
    v_mov_b32 v123, v122
    s_nop 1
    v_permlane16_swap_b32 v122, v123
    v_max_f32 v122, v122, v123
    v_add_f32 v122, 0x40e00000, v122
    v_ceil_f32 v122, v122
    v_max_f32 v122, 0, v122
    v_exp_f32 v123, -v122
    v_sub_f32 v117, v117, v122
    v_sub_f32 v36, v36, v122
    v_sub_f32 v37, v37, v122
    v_sub_f32 v38, v38, v122
    v_sub_f32 v39, v39, v122
    v_sub_f32 v44, v44, v122
    v_sub_f32 v45, v45, v122
    v_sub_f32 v46, v46, v122
    v_sub_f32 v47, v47, v122
    v_sub_f32 v52, v52, v122
    v_sub_f32 v53, v53, v122
    v_sub_f32 v54, v54, v122
    v_sub_f32 v55, v55, v122
    v_sub_f32 v60, v60, v122
    v_sub_f32 v61, v61, v122
    v_sub_f32 v62, v62, v122
    v_sub_f32 v63, v63, v122
    v_sub_f32 v68, v68, v122
    v_sub_f32 v69, v69, v122
    v_sub_f32 v70, v70, v122
    v_sub_f32 v71, v71, v122
    v_sub_f32 v76, v76, v122
    v_sub_f32 v77, v77, v122
    v_sub_f32 v78, v78, v122
    v_sub_f32 v79, v79, v122
    v_mul_f32 v108, v108, v123
    v_mul_f32 v109, v109, v123
    v_mul_f32 v110, v110, v123
    v_mul_f32 v111, v111, v123
    v_mul_f32 v132, v132, v123
    v_mul_f32 v133, v133, v123
    v_mul_f32 v134, v134, v123
    v_mul_f32 v135, v135, v123
    v_mul_f32 v140, v140, v123
    v_mul_f32 v141, v141, v123
    v_mul_f32 v142, v142, v123
    v_mul_f32 v143, v143, v123
    v_mul_f32 v148, v148, v123
    v_mul_f32 v149, v149, v123
    v_mul_f32 v150, v150, v123
    v_mul_f32 v151, v151, v123
    v_mul_f32 v156, v156, v123
    v_mul_f32 v157, v157, v123
    v_mul_f32 v158, v158, v123
    v_mul_f32 v159, v159, v123
    v_mul_f32 v164, v164, v123
    v_mul_f32 v165, v165, v123
    v_mul_f32 v166, v166, v123
    v_mul_f32 v167, v167, v123
    v_mul_f32 v172, v172, v123
    v_mul_f32 v173, v173, v123
    v_mul_f32 v174, v174, v123
    v_mul_f32 v175, v175, v123
    v_mul_f32 v180, v180, v123
    v_mul_f32 v181, v181, v123
    v_mul_f32 v182, v182, v123
    v_mul_f32 v183, v183, v123
    v_mul_f32 v188, v188, v123
    v_mul_f32 v189, v189, v123
    v_mul_f32 v190, v190, v123
    v_mul_f32 v191, v191, v123
    v_mul_f32 v196, v196, v123
    v_mul_f32 v197, v197, v123
    v_mul_f32 v198, v198, v123
    v_mul_f32 v199, v199, v123
    v_mul_f32 v204, v204, v123
    v_mul_f32 v205, v205, v123
    v_mul_f32 v206, v206, v123
    v_mul_f32 v207, v207, v123
    v_mul_f32 v212, v212, v123
    v_mul_f32 v213, v213, v123
    v_mul_f32 v214, v214, v123
    v_mul_f32 v215, v215, v123
    v_mul_f32 v220, v220, v123
    v_mul_f32 v221, v221, v123
    v_mul_f32 v222, v222, v123
    v_mul_f32 v223, v223, v123
    v_mul_f32 v228, v228, v123
    v_mul_f32 v229, v229, v123
    v_mul_f32 v230, v230, v123
    v_mul_f32 v231, v231, v123
    v_mul_f32 v236, v236, v123
    v_mul_f32 v237, v237, v123
    v_mul_f32 v238, v238, v123
    v_mul_f32 v239, v239, v123
    v_mul_f32 v244, v244, v123
    v_mul_f32 v245, v245, v123
    v_mul_f32 v246, v246, v123
    v_mul_f32 v247, v247, v123
    v_mul_f32 v252, v252, v123
    v_mul_f32 v253, v253, v123
    v_mul_f32 v254, v254, v123
    v_mul_f32 v255, v255, v123
    v_exp_f32 v96, v52
    v_exp_f32 v97, v53
    v_exp_f32 v98, v54
    v_cvt_pk_bf16_f32 v84, v96, v97
    v_exp_f32 v99, v55
    v_exp_f32 v100, v60
    v_cvt_pk_bf16_f32 v85, v98, v99
    v_exp_f32 v101, v61
    v_exp_f32 v102, v62
    v_cvt_pk_bf16_f32 v86, v100, v101
    v_exp_f32 v103, v63
    s_nop 0
    v_cvt_pk_bf16_f32 v87, v102, v103
    s_branch at_y_rs0_ret
at_y_rt0:
    v_max3_f32 v118, v48, v49, v50
    v_max3_f32 v119, v51, v56, v57
    v_max3_f32 v118, v118, v58, v59
    v_max_f32 v118, v118, v119
    v_mov_b32 v119, v118
    s_nop 1
    v_permlane32_swap_b32 v118, v119
    v_max_f32 v118, v118, v119
    v_mov_b32 v119, v118
    s_nop 1
    v_permlane16_swap_b32 v118, v119
    v_max_f32 v118, v118, v119
    v_add_f32 v118, 0x40e00000, v118
    v_ceil_f32 v118, v118
    v_max_f32 v118, 0, v118
    v_exp_f32 v119, -v118
    v_sub_f32 v116, v116, v118
    v_sub_f32 v32, v32, v118
    v_sub_f32 v33, v33, v118
    v_sub_f32 v34, v34, v118
    v_sub_f32 v35, v35, v118
    v_sub_f32 v40, v40, v118
    v_sub_f32 v41, v41, v118
    v_sub_f32 v42, v42, v118
    v_sub_f32 v43, v43, v118
    v_sub_f32 v48, v48, v118
    v_sub_f32 v49, v49, v118
    v_sub_f32 v50, v50, v118
    v_sub_f32 v51, v51, v118
    v_sub_f32 v56, v56, v118
    v_sub_f32 v57, v57, v118
    v_sub_f32 v58, v58, v118
    v_sub_f32 v59, v59, v118
    v_mul_f32 v104, v104, v119
    v_mul_f32 v105, v105, v119
    v_mul_f32 v106, v106, v119
    v_mul_f32 v107, v107, v119
    v_mul_f32 v128, v128, v119
    v_mul_f32 v129, v129, v119
    v_mul_f32 v130, v130, v119
    v_mul_f32 v131, v131, v119
    v_mul_f32 v136, v136, v119
    v_mul_f32 v137, v137, v119
    v_mul_f32 v138, v138, v119
    v_mul_f32 v139, v139, v119
    v_mul_f32 v144, v144, v119
    v_mul_f32 v145, v145, v119
    v_mul_f32 v146, v146, v119
    v_mul_f32 v147, v147, v119
    v_mul_f32 v152, v152, v119
    v_mul_f32 v153, v153, v119
    v_mul_f32 v154, v154, v119
    v_mul_f32 v155, v155, v119
    v_mul_f32 v160, v160, v119
    v_mul_f32 v161, v161, v119
    v_mul_f32 v162, v162, v119
    v_mul_f32 v163, v163, v119
    v_mul_f32 v168, v168, v119
    v_mul_f32 v169, v169, v119
    v_mul_f32 v170, v170, v119
    v_mul_f32 v171, v171, v119
    v_mul_f32 v176, v176, v119
    v_mul_f32 v177, v177, v119
    v_mul_f32 v178, v178, v119
    v_mul_f32 v179, v179, v119
    v_mul_f32 v184, v184, v119
    v_mul_f32 v185, v185, v119
    v_mul_f32 v186, v186, v119
    v_mul_f32 v187, v187, v119
    v_mul_f32 v192, v192, v119
    v_mul_f32 v193, v193, v119
    v_mul_f32 v194, v194, v119
    v_mul_f32 v195, v195, v119
    v_mul_f32 v200, v200, v119
    v_mul_f32 v201, v201, v119
    v_mul_f32 v202, v202, v119
    v_mul_f32 v203, v203, v119
    v_mul_f32 v208, v208, v119
    v_mul_f32 v209, v209, v119
    v_mul_f32 v210, v210, v119
    v_mul_f32 v211, v211, v119
    v_mul_f32 v216, v216, v119
    v_mul_f32 v217, v217, v119
    v_mul_f32 v218, v218, v119
    v_mul_f32 v219, v219, v119
    v_mul_f32 v224, v224, v119
    v_mul_f32 v225, v225, v119
    v_mul_f32 v226, v226, v119
    v_mul_f32 v227, v227, v119
    v_mul_f32 v232, v232, v119
    v_mul_f32 v233, v233, v119
    v_mul_f32 v234, v234, v119
    v_mul_f32 v235, v235, v119
    v_mul_f32 v240, v240, v119
    v_mul_f32 v241, v241, v119
    v_mul_f32 v242, v242, v119
    v_mul_f32 v243, v243, v119
    v_mul_f32 v248, v248, v119
    v_mul_f32 v249, v249, v119
    v_mul_f32 v250, v250, v119
    v_mul_f32 v251, v251, v119
    v_exp_f32 v96, v48
    v_exp_f32 v97, v49
    v_exp_f32 v98, v50
    v_cvt_pk_bf16_f32 v80, v96, v97
    v_exp_f32 v99, v51
    v_exp_f32 v100, v56
    v_cvt_pk_bf16_f32 v81, v98, v99
    v_exp_f32 v101, v57
    v_exp_f32 v102, v58
    v_cvt_pk_bf16_f32 v82, v100, v101
    v_exp_f32 v103, v59
    s_nop 0
    v_cvt_pk_bf16_f32 v83, v102, v103
    v_max3_f32 v122, v52, v53, v54
    v_max3_f32 v123, v55, v60, v61
    v_max3_f32 v122, v122, v62, v63
    v_max_f32 v122, v122, v123
    v_mov_b32 v123, v122
    s_nop 1
    v_permlane32_swap_b32 v122, v123
    v_max_f32 v122, v122, v123
    v_mov_b32 v123, v122
    s_nop 1
    v_permlane16_swap_b32 v122, v123
    v_max_f32 v122, v122, v123
    v_add_f32 v122, 0x40e00000, v122
    v_ceil_f32 v122, v122
    v_max_f32 v122, 0, v122
    v_exp_f32 v123, -v122
    v_sub_f32 v117, v117, v122
    v_sub_f32 v36, v36, v122
    v_sub_f32 v37, v37, v122
    v_sub_f32 v38, v38, v122
    v_sub_f32 v39, v39, v122
    v_sub_f32 v44, v44, v122
    v_sub_f32 v45, v45, v122
    v_sub_f32 v46, v46, v122
    v_sub_f32 v47, v47, v122
    v_sub_f32 v52, v52, v122
    v_sub_f32 v53, v53, v122
    v_sub_f32 v54, v54, v122
    v_sub_f32 v55, v55, v122
    v_sub_f32 v60, v60, v122
    v_sub_f32 v61, v61, v122
    v_sub_f32 v62, v62, v122
    v_sub_f32 v63, v63, v122
    v_mul_f32 v108, v108, v123
    v_mul_f32 v109, v109, v123
    v_mul_f32 v110, v110, v123
    v_mul_f32 v111, v111, v123
    v_mul_f32 v132, v132, v123
    v_mul_f32 v133, v133, v123
    v_mul_f32 v134, v134, v123
    v_mul_f32 v135, v135, v123
    v_mul_f32 v140, v140, v123
    v_mul_f32 v141, v141, v123
    v_mul_f32 v142, v142, v123
    v_mul_f32 v143, v143, v123
    v_mul_f32 v148, v148, v123
    v_mul_f32 v149, v149, v123
    v_mul_f32 v150, v150, v123
    v_mul_f32 v151, v151, v123
    v_mul_f32 v156, v156, v123
    v_mul_f32 v157, v157, v123
    v_mul_f32 v158, v158, v123
    v_mul_f32 v159, v159, v123
    v_mul_f32 v164, v164, v123
    v_mul_f32 v165, v165, v123
    v_mul_f32 v166, v166, v123
    v_mul_f32 v167, v167, v123
    v_mul_f32 v172, v172, v123
    v_mul_f32 v173, v173, v123
    v_mul_f32 v174, v174, v123
    v_mul_f32 v175, v175, v123
    v_mul_f32 v180, v180, v123
    v_mul_f32 v181, v181, v123
    v_mul_f32 v182, v182, v123
    v_mul_f32 v183, v183, v123
    v_mul_f32 v188, v188, v123
    v_mul_f32 v189, v189, v123
    v_mul_f32 v190, v190, v123
    v_mul_f32 v191, v191, v123
    v_mul_f32 v196, v196, v123
    v_mul_f32 v197, v197, v123
    v_mul_f32 v198, v198, v123
    v_mul_f32 v199, v199, v123
    v_mul_f32 v204, v204, v123
    v_mul_f32 v205, v205, v123
    v_mul_f32 v206, v206, v123
    v_mul_f32 v207, v207, v123
    v_mul_f32 v212, v212, v123
    v_mul_f32 v213, v213, v123
    v_mul_f32 v214, v214, v123
    v_mul_f32 v215, v215, v123
    v_mul_f32 v220, v220, v123
    v_mul_f32 v221, v221, v123
    v_mul_f32 v222, v222, v123
    v_mul_f32 v223, v223, v123
    v_mul_f32 v228, v228, v123
    v_mul_f32 v229, v229, v123
    v_mul_f32 v230, v230, v123
    v_mul_f32 v231, v231, v123
    v_mul_f32 v236, v236, v123
    v_mul_f32 v237, v237, v123
    v_mul_f32 v238, v238, v123
    v_mul_f32 v239, v239, v123
    v_mul_f32 v244, v244, v123
    v_mul_f32 v245, v245, v123
    v_mul_f32 v246, v246, v123
    v_mul_f32 v247, v247, v123
    v_mul_f32 v252, v252, v123
    v_mul_f32 v253, v253, v123
    v_mul_f32 v254, v254, v123
    v_mul_f32 v255, v255, v123
    v_exp_f32 v96, v52
    v_exp_f32 v97, v53
    v_exp_f32 v98, v54
    v_cvt_pk_bf16_f32 v84, v96, v97
    v_exp_f32 v99, v55
    v_exp_f32 v100, v60
    v_cvt_pk_bf16_f32 v85, v98, v99
    v_exp_f32 v101, v61
    v_exp_f32 v102, v62
    v_cvt_pk_bf16_f32 v86, v100, v101
    v_exp_f32 v103, v63
    s_nop 0
    v_cvt_pk_bf16_f32 v87, v102, v103
    s_branch at_y_rt0_ret
at_y_ev1:
    s_cmp_ge_i32 s30, s10
    s_cbranch_scc0 e_43
    s_cmp_eq_u32 s20, 0
    s_cbranch_scc0 sig_45
    v_mov_b32 v2, 1
    v_mov_b32 v3, 0
    s_mov_b64 exec, 1
    buffer_atomic_add v2, v3, s[4:7], s33 offen sc1
    s_mov_b64 exec, -1
sig_45:
    s_mov_b32 s10, 2147483647
    s_sub_u32 s9, s64, 1
e_43:
    s_add_u32 s3, s30, 1
    s_cmp_eq_u32 s3, s64
    s_cbranch_scc0 e_46
    s_waitcnt vmcnt(9)
    buffer_load_dword v31, off, s[4:7], s14 sc1
    s_waitcnt vmcnt(9)
    buffer_load_dword v16, off, s[4:7], s34 sc1
    s_branch at_y_ev1_ret
e_46:
    s_cmp_eq_u32 s30, s64
    s_cbranch_scc0 at_y_ev1_ret
    s_mov_b32 s98, 0
spin_49:
    s_waitcnt vmcnt(8)
    v_readfirstlane_b32 s99, v16
    s_nop 0
    s_cmp_ge_u32 s99, 1
    s_cbranch_scc1 ok_50
    s_add_u32 s98, s98, 1
    s_cmp_gt_u32 s98, 0x80000
    s_cbranch_scc1 ok_50
    s_sleep 8
    buffer_load_dword v16, off, s[4:7], s34 sc1
    s_waitcnt vmcnt(0)
    s_branch spin_49
ok_50:
    s_cmp_eq_u32 s88, 0
    s_cbranch_scc0 e_44
    v_readfirstlane_b32 s88, v31
    s_nop 0
    s_cmp_eq_u32 s88, 0
    s_cbranch_scc1 e_44
    s_add_u32 s3, s11, 0
    buffer_load_dwordx4 a[128:131], v25, s[4:7], s3 offen offset:0 sc1
    buffer_load_dwordx4 a[132:135], v25, s[4:7], s3 offen offset:1024 sc1
    buffer_load_dwordx4 a[136:139], v25, s[4:7], s3 offen offset:2048 sc1
    buffer_load_dwordx4 a[140:143], v25, s[4:7], s3 offen offset:3072 sc1
    s_add_u32 s3, s11, 4096
    buffer_load_dwordx4 a[144:147], v25, s[4:7], s3 offen offset:0 sc1
    buffer_load_dwordx4 a[148:151], v25, s[4:7], s3 offen offset:1024 sc1
    buffer_load_dwordx4 a[152:155], v25, s[4:7], s3 offen offset:2048 sc1
    buffer_load_dwordx4 a[156:159], v25, s[4:7], s3 offen offset:3072 sc1
    s_add_u32 s3, s11, 8192
    buffer_load_dwordx4 a[160:163], v25, s[4:7], s3 offen offset:0 sc1
    s_waitcnt vmcnt(24)
    buffer_load_dwordx4 a[164:167], v25, s[4:7], s3 offen offset:1024 sc1
    s_waitcnt vmcnt(24)
    buffer_load_dwordx4 a[168:171], v25, s[4:7], s3 offen offset:2048 sc1
    s_waitcnt vmcnt(24)
    buffer_load_dwordx4 a[172:175], v25, s[4:7], s3 offen offset:3072 sc1
    s_add_u32 s3, s11, 12288
    s_waitcnt vmcnt(24)
    buffer_load_dwordx4 a[176:179], v25, s[4:7], s3 offen offset:0 sc1
    s_waitcnt vmcnt(24)
    buffer_load_dwordx4 a[180:183], v25, s[4:7], s3 offen offset:1024 sc1
    s_waitcnt vmcnt(24)
    buffer_load_dwordx4 a[184:187], v25, s[4:7], s3 offen offset:2048 sc1
    s_waitcnt vmcnt(24)
    buffer_load_dwordx4 a[188:191], v25, s[4:7], s3 offen offset:3072 sc1
    s_add_u32 s3, s11, 8388608
    s_waitcnt vmcnt(24)
    buffer_load_dwordx4 a[192:195], v25, s[4:7], s3 offen sc1
e_44:
    s_add_u32 s3, s30, 1
    s_lshl_b32 s3, s3, 5
    v_subrev_u32 v11, s3, v9
    v_subrev_u32 v12, s3, v10
    v_cmp_le_i32 s[68:69], 0, v11
    v_cmp_le_i32 s[70:71], 1, v11
    v_cmp_le_i32 s[72:73], 2, v11
    v_cmp_le_i32 s[74:75], 3, v11
    v_cmp_le_i32 s[76:77], 0, v12
    v_cmp_le_i32 s[78:79], 1, v12
    v_cmp_le_i32 s[80:81], 2, v12
    v_cmp_le_i32 s[82:83], 3, v12
    v_cndmask_b32 v32, v126, v116, s[68:69]
    v_cndmask_b32 v33, v126, v116, s[70:71]
    v_cndmask_b32 v34, v126, v116, s[72:73]
    v_cndmask_b32 v35, v126, v116, s[74:75]
    v_cndmask_b32 v36, v126, v117, s[76:77]
    v_cndmask_b32 v37, v126, v117, s[78:79]
    v_cndmask_b32 v38, v126, v117, s[80:81]
    v_cndmask_b32 v39, v126, v117, s[82:83]
    v_cmp_le_i32 s[68:69], 16, v11
    v_cmp_le_i32 s[70:71], 17, v11
    v_cmp_le_i32 s[72:73], 18, v11
    v_cmp_le_i32 s[74:75], 19, v11
    v_cmp_le_i32 s[76:77], 16, v12
    v_cmp_le_i32 s[78:79], 17, v12
    v_cmp_le_i32 s[80:81], 18, v12
    v_cmp_le_i32 s[82:83], 19, v12
    v_cndmask_b32 v40, v126, v116, s[68:69]
    v_cndmask_b32 v41, v126, v116, s[70:71]
    v_cndmask_b32 v42, v126, v116, s[72:73]
    v_cndmask_b32 v43, v126, v116, s[74:75]
    v_cndmask_b32 v44, v126, v117, s[76:77]
    v_cndmask_b32 v45, v126, v117, s[78:79]
    v_cndmask_b32 v46, v126, v117, s[80:81]
    v_cndmask_b32 v47, v126, v117, s[82:83]
    s_branch at_y_ev1_ret
at_y_rs1:
    v_max3_f32 v118, v64, v65, v66
    v_max3_f32 v119, v67, v72, v73
    v_max3_f32 v118, v118, v74, v75
    v_max_f32 v118, v118, v119
    v_mov_b32 v119, v118
    s_nop 1
    v_permlane32_swap_b32 v118, v119
    v_max_f32 v118, v118, v119
    v_mov_b32 v119, v118
    s_nop 1
    v_permlane16_swap_b32 v118, v119
    v_max_f32 v118, v118, v119
    v_add_f32 v118, 0x40e00000, v118
    v_ceil_f32 v118, v118
    v_max_f32 v118, 0, v118
    v_exp_f32 v119, -v118
    v_sub_f32 v116, v116, v118
    v_sub_f32 v32, v32, v118
    v_sub_f32 v33, v33, v118
    v_sub_f32 v34, v34, v118
    v_sub_f32 v35, v35, v118
    v_sub_f32 v40, v40, v118
    v_sub_f32 v41, v41, v118
    v_sub_f32 v42, v42, v118
    v_sub_f32 v43, v43, v118
    v_sub_f32 v64, v64, v118
    v_sub_f32 v65, v65, v118
    v_sub_f32 v66, v66, v118
    v_sub_f32 v67, v67, v118
    v_sub_f32 v72, v72, v118
    v_sub_f32 v73, v73, v118
    v_sub_f32 v74, v74, v118
    v_sub_f32 v75, v75, v118
    v_sub_f32 v48, v48, v118
    v_sub_f32 v49, v49, v118
    v_sub_f32 v50, v50, v118
    v_sub_f32 v51, v51, v118
    v_sub_f32 v56, v56, v118
    v_sub_f32 v57, v57, v118
    v_sub_f32 v58, v58, v118
    v_sub_f32 v59, v59, v118
    v_mul_f32 v104, v104, v119
    v_mul_f32 v105, v105, v119
    v_mul_f32 v106, v106, v119
    v_mul_f32 v107, v107, v119
    v_mul_f32 v128, v128, v119
    v_mul_f32 v129, v129, v119
    v_mul_f32 v130, v130, v119
    v_mul_f32 v131, v131, v119
    v_mul_f32 v136, v136, v119
    v_mul_f32 v137, v137, v119
    v_mul_f32 v138, v138, v119
    v_mul_f32 v139, v139, v119
    v_mul_f32 v144, v144, v119
    v_mul_f32 v145, v145, v119
    v_mul_f32 v146, v146, v119
    v_mul_f32 v147, v147, v119
    v_mul_f32 v152, v152, v119
    v_mul_f32 v153, v153, v119
    v_mul_f32 v154, v154, v119
    v_mul_f32 v155, v155, v119
    v_mul_f32 v160, v160, v119
    v_mul_f32 v161, v161, v119
    v_mul_f32 v162, v162, v119
    v_mul_f32 v163, v163, v119
    v_mul_f32 v168, v168, v119
    v_mul_f32 v169, v169, v119
    v_mul_f32 v170, v170, v119
    v_mul_f32 v171, v171, v119
    v_mul_f32 v176, v176, v119
    v_mul_f32 v177, v177, v119
    v_mul_f32 v178, v178, v119
    v_mul_f32 v179, v179, v119
    v_mul_f32 v184, v184, v119
    v_mul_f32 v185, v185, v119
    v_mul_f32 v186, v186, v119
    v_mul_f32 v187, v187, v119
    v_mul_f32 v192, v192, v119
    v_mul_f32 v193, v193, v119
    v_mul_f32 v194, v194, v119
    v_mul_f32 v195, v195, v119
    v_mul_f32 v200, v200, v119
    v_mul_f32 v201, v201, v119
    v_mul_f32 v202, v202, v119
    v_mul_f32 v203, v203, v119
    v_mul_f32 v208, v208, v119
    v_mul_f32 v209, v209, v119
    v_mul_f32 v210, v210, v119
    v_mul_f32 v211, v211, v119
    v_mul_f32 v216, v216, v119
    v_mul_f32 v217, v217, v119
    v_mul_f32 v218, v218, v119
    v_mul_f32 v219, v219, v119
    v_mul_f32 v224, v224, v119
    v_mul_f32 v225, v225, v119
    v_mul_f32 v226, v226, v119
    v_mul_f32 v227, v227, v119
    v_mul_f32 v232, v232, v119
    v_mul_f32 v233, v233, v119
    v_mul_f32 v234, v234, v119
    v_mul_f32 v235, v235, v119
    v_mul_f32 v240, v240, v119
    v_mul_f32 v241, v241, v119
    v_mul_f32 v242, v242, v119
    v_mul_f32 v243, v243, v119
    v_mul_f32 v248, v248, v119
    v_mul_f32 v249, v249, v119
    v_mul_f32 v250, v250, v119
    v_mul_f32 v251, v251, v119
    v_exp_f32 v96, v64
    v_exp_f32 v97, v65
    v_exp_f32 v98, v66
    v_cvt_pk_bf16_f32 v88, v96, v97
    v_exp_f32 v99, v67
    v_exp_f32 v100, v72
    v_cvt_pk_bf16_f32 v89, v98, v99
    v_exp_f32 v101, v73
    v_exp_f32 v102, v74
    v_cvt_pk_bf16_f32 v90, v100, v101
    v_exp_f32 v103, v75
    s_nop 0
    v_cvt_pk_bf16_f32 v91, v102, v103
    v_max3_f32 v122, v68, v69, v70
    v_max3_f32 v123, v71, v76, v77
    v_max3_f32 v122, v122, v78, v79
    v_max_f32 v122, v122, v123
    v_mov_b32 v123, v122
    s_nop 1
    v_permlane32_swap_b32 v122, v123
    v_max_f32 v122, v122, v123
    v_mov_b32 v123, v122
    s_nop 1
    v_permlane16_swap_b32 v122, v123
    v_max_f32 v122, v122, v123
    v_add_f32 v122, 0x40e00000, v122
    v_ceil_f32 v122, v122
    v_max_f32 v122, 0, v122
    v_exp_f32 v123, -v122
    v_sub_f32 v117, v117, v122
    v_sub_f32 v36, v36, v122
    v_sub_f32 v37, v37, v122
    v_sub_f32 v38, v38, v122
    v_sub_f32 v39, v39, v122
    v_sub_f32 v44, v44, v122
    v_sub_f32 v45, v45, v122
    v_sub_f32 v46, v46, v122
    v_sub_f32 v47, v47, v122
    v_sub_f32 v68, v68, v122
    v_sub_f32 v69, v69, v122
    v_sub_f32 v70, v70, v122
    v_sub_f32 v71, v71, v122
    v_sub_f32 v76, v76, v122
    v_sub_f32 v77, v77, v122
    v_sub_f32 v78, v78, v122
    v_sub_f32 v79, v79, v122
    v_sub_f32 v52, v52, v122
    v_sub_f32 v53, v53, v122
    v_sub_f32 v54, v54, v122
    v_sub_f32 v55, v55, v122
    v_sub_f32 v60, v60, v122
    v_sub_f32 v61, v61, v122
    v_sub_f32 v62, v62, v122
    v_sub_f32 v63, v63, v122
    v_mul_f32 v108, v108, v123
    v_mul_f32 v109, v109, v123
    v_mul_f32 v110, v110, v123
    v_mul_f32 v111, v111, v123
    v_mul_f32 v132, v132, v123
    v_mul_f32 v133, v133, v123
    v_mul_f32 v134, v134, v123
    v_mul_f32 v135, v135, v123
    v_mul_f32 v140, v140, v123
    v_mul_f32 v141, v141, v123
    v_mul_f32 v142, v142, v123
    v_mul_f32 v143, v143, v123
    v_mul_f32 v148, v148, v123
    v_mul_f32 v149, v149, v123
    v_mul_f32 v150, v150, v123
    v_mul_f32 v151, v151, v123
    v_mul_f32 v156, v156, v123
    v_mul_f32 v157, v157, v123
    v_mul_f32 v158, v158, v123
    v_mul_f32 v159, v159, v123
    v_mul_f32 v164, v164, v123
    v_mul_f32 v165, v165, v123
    v_mul_f32 v166, v166, v123
    v_mul_f32 v167, v167, v123
    v_mul_f32 v172, v172, v123
    v_mul_f32 v173, v173, v123
    v_mul_f32 v174, v174, v123
    v_mul_f32 v175, v175, v123
    v_mul_f32 v180, v180, v123
    v_mul_f32 v181, v181, v123
    v_mul_f32 v182, v182, v123
    v_mul_f32 v183, v183, v123
    v_mul_f32 v188, v188, v123
    v_mul_f32 v189, v189, v123
    v_mul_f32 v190, v190, v123
    v_mul_f32 v191, v191, v123
    v_mul_f32 v196, v196, v123
    v_mul_f32 v197, v197, v123
    v_mul_f32 v198, v198, v123
    v_mul_f32 v199, v199, v123
    v_mul_f32 v204, v204, v123
    v_mul_f32 v205, v205, v123
    v_mul_f32 v206, v206, v123
    v_mul_f32 v207, v207, v123
    v_mul_f32 v212, v212, v123
    v_mul_f32 v213, v213, v123
    v_mul_f32 v214, v214, v123
    v_mul_f32 v215, v215, v123
    v_mul_f32 v220, v220, v123
    v_mul_f32 v221, v221, v123
    v_mul_f32 v222, v222, v123
    v_mul_f32 v223, v223, v123
    v_mul_f32 v228, v228, v123
    v_mul_f32 v229, v229, v123
    v_mul_f32 v230, v230, v123
    v_mul_f32 v231, v231, v123
    v_mul_f32 v236, v236, v123
    v_mul_f32 v237, v237, v123
    v_mul_f32 v238, v238, v123
    v_mul_f32 v239, v239, v123
    v_mul_f32 v244, v244, v123
    v_mul_f32 v245, v245, v123
    v_mul_f32 v246, v246, v123
    v_mul_f32 v247, v247, v123
    v_mul_f32 v252, v252, v123
    v_mul_f32 v253, v253, v123
    v_mul_f32 v254, v254, v123
    v_mul_f32 v255, v255, v123
    v_exp_f32 v96, v68
    v_exp_f32 v97, v69
    v_exp_f32 v98, v70
    v_cvt_pk_bf16_f32 v92, v96, v97
    v_exp_f32 v99, v71
    v_exp_f32 v100, v76
    v_cvt_pk_bf16_f32 v93, v98, v99
    v_exp_f32 v101, v77
    v_exp_f32 v102, v78
    v_cvt_pk_bf16_f32 v94, v100, v101
    v_exp_f32 v103, v79
    s_nop 0
    v_cvt_pk_bf16_f32 v95, v102, v103
    s_branch at_y_rs1_ret
at_y_rt1:
    v_max3_f32 v118, v64, v65, v66
    v_max3_f32 v119, v67, v72, v73
    v_max3_f32 v118, v118, v74, v75
    v_max_f32 v118, v118, v119
    v_mov_b32 v119, v118
    s_nop 1
    v_permlane32_swap_b32 v118, v119
    v_max_f32 v118, v118, v119
    v_mov_b32 v119, v118
    s_nop 1
    v_permlane16_swap_b32 v118, v119
    v_max_f32 v118, v118, v119
    v_add_f32 v118, 0x40e00000, v118
    v_ceil_f32 v118, v118
    v_max_f32 v118, 0, v118
    v_exp_f32 v119, -v118
    v_sub_f32 v116, v116, v118
    v_sub_f32 v32, v32, v118
    v_sub_f32 v33, v33, v118
    v_sub_f32 v34, v34, v118
    v_sub_f32 v35, v35, v118
    v_sub_f32 v40, v40, v118
    v_sub_f32 v41, v41, v118
    v_sub_f32 v42, v42, v118
    v_sub_f32 v43, v43, v118
    v_sub_f32 v64, v64, v118
    v_sub_f32 v65, v65, v118
    v_sub_f32 v66, v66, v118
    v_sub_f32 v67, v67, v118
    v_sub_f32 v72, v72, v118
    v_sub_f32 v73, v73, v118
    v_sub_f32 v74, v74, v118
    v_sub_f32 v75, v75, v118
    v_mul_f32 v104, v104, v119
    v_mul_f32 v105, v105, v119
    v_mul_f32 v106, v106, v119
    v_mul_f32 v107, v107, v119
    v_mul_f32 v128, v128, v119
    v_mul_f32 v129, v129, v119
    v_mul_f32 v130, v130, v119
    v_mul_f32 v131, v131, v119
    v_mul_f32 v136, v136, v119
    v_mul_f32 v137, v137, v119
    v_mul_f32 v138, v138, v119
    v_mul_f32 v139, v139, v119
    v_mul_f32 v144, v144, v119
    v_mul_f32 v145, v145, v119
    v_mul_f32 v146, v146, v119
    v_mul_f32 v147, v147, v119
    v_mul_f32 v152, v152, v119
    v_mul_f32 v153, v153, v119
    v_mul_f32 v154, v154, v119
    v_mul_f32 v155, v155, v119
    v_mul_f32 v160, v160, v119
    v_mul_f32 v161, v161, v119
    v_mul_f32 v162, v162, v119
    v_mul_f32 v163, v163, v119
    v_mul_f32 v168, v168, v119
    v_mul_f32 v169, v169, v119
    v_mul_f32 v170, v170, v119
    v_mul_f32 v171, v171, v119
    v_mul_f32 v176, v176, v119
    v_mul_f32 v177, v177, v119
    v_mul_f32 v178, v178, v119
    v_mul_f32 v179, v179, v119
    v_mul_f32 v184, v184, v119
    v_mul_f32 v185, v185, v119
    v_mul_f32 v186, v186, v119
    v_mul_f32 v187, v187, v119
    v_mul_f32 v192, v192, v119
    v_mul_f32 v193, v193, v119
    v_mul_f32 v194, v194, v119
    v_mul_f32 v195, v195, v119
    v_mul_f32 v200, v200, v119
    v_mul_f32 v201, v201, v119
    v_mul_f32 v202, v202, v119
    v_mul_f32 v203, v203, v119
    v_mul_f32 v208, v208, v119
    v_mul_f32 v209, v209, v119
    v_mul_f32 v210, v210, v119
    v_mul_f32 v211, v211, v119
    v_mul_f32 v216, v216, v119
    v_mul_f32 v217, v217, v119
    v_mul_f32 v218, v218, v119
    v_mul_f32 v219, v219, v119
    v_mul_f32 v224, v224, v119
    v_mul_f32 v225, v225, v119
    v_mul_f32 v226, v226, v119
    v_mul_f32 v227, v227, v119
    v_mul_f32 v232, v232, v119
    v_mul_f32 v233, v233, v119
    v_mul_f32 v234, v234, v119
    v_mul_f32 v235, v235, v119
    v_mul_f32 v240, v240, v119
    v_mul_f32 v241, v241, v119
    v_mul_f32 v242, v242, v119
    v_mul_f32 v243, v243, v119
    v_mul_f32 v248, v248, v119
    v_mul_f32 v249, v249, v119
    v_mul_f32 v250, v250, v119
    v_mul_f32 v251, v251, v119
    v_exp_f32 v96, v64
    v_exp_f32 v97, v65
    v_exp_f32 v98, v66
    v_cvt_pk_bf16_f32 v88, v96, v97
    v_exp_f32 v99, v67
    v_exp_f32 v100, v72
    v_cvt_pk_bf16_f32 v89, v98, v99
    v_exp_f32 v101, v73
    v_exp_f32 v102, v74
    v_cvt_pk_bf16_f32 v90, v100, v101
    v_exp_f32 v103, v75
    s_nop 0
    v_cvt_pk_bf16_f32 v91, v102, v103
    v_max3_f32 v122, v68, v69, v70
    v_max3_f32 v123, v71, v76, v77
    v_max3_f32 v122, v122, v78, v79
    v_max_f32 v122, v122, v123
    v_mov_b32 v123, v122
    s_nop 1
    v_permlane32_swap_b32 v122, v123
    v_max_f32 v122, v122, v123
    v_mov_b32 v123, v122
    s_nop 1
    v_permlane16_swap_b32 v122, v123
    v_max_f32 v122, v122, v123
    v_add_f32 v122, 0x40e00000, v122
    v_ceil_f32 v122, v122
    v_max_f32 v122, 0, v122
    v_exp_f32 v123, -v122
    v_sub_f32 v117, v117, v122
    v_sub_f32 v36, v36, v122
    v_sub_f32 v37, v37, v122
    v_sub_f32 v38, v38, v122
    v_sub_f32 v39, v39, v122
    v_sub_f32 v44, v44, v122
    v_sub_f32 v45, v45, v122
    v_sub_f32 v46, v46, v122
    v_sub_f32 v47, v47, v122
    v_sub_f32 v68, v68, v122
    v_sub_f32 v69, v69, v122
    v_sub_f32 v70, v70, v122
    v_sub_f32 v71, v71, v122
    v_sub_f32 v76, v76, v122
    v_sub_f32 v77, v77, v122
    v_sub_f32 v78, v78, v122
    v_sub_f32 v79, v79, v122
    v_mul_f32 v108, v108, v123
    v_mul_f32 v109, v109, v123
    v_mul_f32 v110, v110, v123
    v_mul_f32 v111, v111, v123
    v_mul_f32 v132, v132, v123
    v_mul_f32 v133, v133, v123
    v_mul_f32 v134, v134, v123
    v_mul_f32 v135, v135, v123
    v_mul_f32 v140, v140, v123
    v_mul_f32 v141, v141, v123
    v_mul_f32 v142, v142, v123
    v_mul_f32 v143, v143, v123
    v_mul_f32 v148, v148, v123
    v_mul_f32 v149, v149, v123
    v_mul_f32 v150, v150, v123
    v_mul_f32 v151, v151, v123
    v_mul_f32 v156, v156, v123
    v_mul_f32 v157, v157, v123
    v_mul_f32 v158, v158, v123
    v_mul_f32 v159, v159, v123
    v_mul_f32 v164, v164, v123
    v_mul_f32 v165, v165, v123
    v_mul_f32 v166, v166, v123
    v_mul_f32 v167, v167, v123
    v_mul_f32 v172, v172, v123
    v_mul_f32 v173, v173, v123
    v_mul_f32 v174, v174, v123
    v_mul_f32 v175, v175, v123
    v_mul_f32 v180, v180, v123
    v_mul_f32 v181, v181, v123
    v_mul_f32 v182, v182, v123
    v_mul_f32 v183, v183, v123
    v_mul_f32 v188, v188, v123
    v_mul_f32 v189, v189, v123
    v_mul_f32 v190, v190, v123
    v_mul_f32 v191, v191, v123
    v_mul_f32 v196, v196, v123
    v_mul_f32 v197, v197, v123
    v_mul_f32 v198, v198, v123
    v_mul_f32 v199, v199, v123
    v_mul_f32 v204, v204, v123
    v_mul_f32 v205, v205, v123
    v_mul_f32 v206, v206, v123
    v_mul_f32 v207, v207, v123
    v_mul_f32 v212, v212, v123
    v_mul_f32 v213, v213, v123
    v_mul_f32 v214, v214, v123
    v_mul_f32 v215, v215, v123
    v_mul_f32 v220, v220, v123
    v_mul_f32 v221, v221, v123
    v_mul_f32 v222, v222, v123
    v_mul_f32 v223, v223, v123
    v_mul_f32 v228, v228, v123
    v_mul_f32 v229, v229, v123
    v_mul_f32 v230, v230, v123
    v_mul_f32 v231, v231, v123
    v_mul_f32 v236, v236, v123
    v_mul_f32 v237, v237, v123
    v_mul_f32 v238, v238, v123
    v_mul_f32 v239, v239, v123
    v_mul_f32 v244, v244, v123
    v_mul_f32 v245, v245, v123
    v_mul_f32 v246, v246, v123
    v_mul_f32 v247, v247, v123
    v_mul_f32 v252, v252, v123
    v_mul_f32 v253, v253, v123
    v_mul_f32 v254, v254, v123
    v_mul_f32 v255, v255, v123
    v_exp_f32 v96, v68
    v_exp_f32 v97, v69
    v_exp_f32 v98, v70
    v_cvt_pk_bf16_f32 v92, v96, v97
    v_exp_f32 v99, v71
    v_exp_f32 v100, v76
    v_cvt_pk_bf16_f32 v93, v98, v99
    v_exp_f32 v101, v77
    v_exp_f32 v102, v78
    v_cvt_pk_bf16_f32 v94, v100, v101
    v_exp_f32 v103, v79
    s_nop 0
    v_cvt_pk_bf16_f32 v95, v102, v103
    s_branch at_y_rt1_ret
at_y_tail0:
    s_waitcnt lgkmcnt(5)
    ds_read_b128 a[0:3], v6 offset:49152
    s_waitcnt lgkmcnt(5)
    ds_read_b128 a[4:7], v6 offset:50176
    s_waitcnt lgkmcnt(5)
    ds_read_b128 a[8:11], v6 offset:51200
    s_waitcnt lgkmcnt(5)
    ds_read_b128 a[12:15], v6 offset:52224
    s_waitcnt lgkmcnt(5)
    ds_read_b128 a[16:19], v6 offset:53248
    s_waitcnt lgkmcnt(5)
    ds_read_b128 a[20:23], v6 offset:54272
    s_add_u32 s29, s66, 16384
    v_exp_f32 v96, v52
    v_exp_f32 v97, v53
    v_exp_f32 v98, v54
    v_cvt_pk_bf16_f32 v84, v96, v97
    v_exp_f32 v99, v55
    v_exp_f32 v100, v60
    v_cvt_pk_bf16_f32 v85, v98, v99
    v_exp_f32 v101, v61
    v_exp_f32 v102, v62
    v_cvt_pk_bf16_f32 v86, v100, v101
    v_exp_f32 v103, v63
    s_nop 0
    v_cvt_pk_bf16_f32 v87, v102, v103
    v_or3_b32 v11, v80, v81, v82
    v_or3_b32 v11, v11, v83, v84
    v_or3_b32 v11, v11, v85, v86
    v_bitop3_b32 v11, v11, v87, s65 bitop3:0xa8
    v_cmp_ne_u32 vcc, 0, v11
    s_nop 0
    s_cbranch_vccnz at_y_rt0
at_y_rt0_ret:
    s_cmp_eq_u32 s15, 0
    s_cbranch_scc1 t_51
    s_mov_b32 m0, s67
    s_waitcnt vmcnt(8)
    s_barrier
    buffer_load_dwordx4 v30, s[4:7], s29 offen offset:0 sc1 lds
    buffer_load_dwordx4 v30, s[4:7], s29 offen offset:1024 sc1 lds
    buffer_load_dwordx4 v30, s[4:7], s29 offen offset:2048 sc1 lds
    buffer_load_dwordx4 v30, s[4:7], s29 offen offset:3072 sc1 lds
t_51:
    v_mfma_f32_16x16x32_bf16 v[104:107], v[112:115], v[80:83], v[104:107]
    s_add_u32 s70, s44, 0
    v_mfma_f32_16x16x32_bf16 v[108:111], v[112:115], v[84:87], v[108:111]
    s_add_u32 m0, s32, 0
    s_waitcnt lgkmcnt(5)
    v_mfma_f32_16x16x32_bf16 v[132:135], a[0:3], v[84:87], v[132:135]
    ds_read_b128 a[24:27], v6 offset:55296
    v_mfma_f32_16x16x32_bf16 v[128:131], a[0:3], v[80:83], v[128:131]
    buffer_load_dwordx4 v21, s[16:19], s70 offen offset:0 sc1 lds
    s_waitcnt lgkmcnt(5)
    v_mfma_f32_16x16x32_bf16 v[136:139], a[4:7], v[80:83], v[136:139]
    ds_read_b128 a[28:31], v6 offset:56320
    buffer_load_dwordx4 v22, s[16:19], s70 offen offset:1024 sc1 lds
    v_mfma_f32_16x16x32_bf16 v[140:143], a[4:7], v[84:87], v[140:143]
    s_waitcnt lgkmcnt(5)
    v_mfma_f32_16x16x32_bf16 v[148:151], a[8:11], v[84:87], v[148:151]
    ds_read_b128 a[0:3], v6 offset:57344
    buffer_load_dwordx4 v23, s[16:19], s70 offen offset:2048 sc1 lds
    v_mfma_f32_16x16x32_bf16 v[144:147], a[8:11], v[80:83], v[144:147]
    buffer_load_dwordx4 v24, s[16:19], s70 offen offset:3072 sc1 lds
    s_waitcnt lgkmcnt(5)
    v_mfma_f32_16x16x32_bf16 v[152:155], a[12:15], v[80:83], v[152:155]
    ds_read_b128 a[4:7], v6 offset:58368
    v_mfma_f32_16x16x32_bf16 v[156:159], a[12:15], v[84:87], v[156:159]
    s_add_u32 s71, s35, 0
    s_waitcnt lgkmcnt(5)
    v_mfma_f32_16x16x32_bf16 v[164:167], a[16:19], v[84:87], v[164:167]
    ds_read_b128 a[8:11], v6 offset:59392
    buffer_load_dwordx4 a[32:35], v25, s[4:7], s71 offen offset:0 sc1
    v_mfma_f32_16x16x32_bf16 v[160:163], a[16:19], v[80:83], v[160:163]
    s_waitcnt lgkmcnt(5)
    v_mfma_f32_16x16x32_bf16 v[168:171], a[20:23], v[80:83], v[168:171]
    ds_read_b128 a[12:15], v6 offset:60416
    buffer_load_dwordx4 a[36:39], v25, s[4:7], s71 offen offset:1024 sc1
    v_mfma_f32_16x16x32_bf16 v[172:175], a[20:23], v[84:87], v[172:175]
    buffer_load_dwordx4 a[40:43], v25, s[4:7], s71 offen offset:2048 sc1
    s_waitcnt lgkmcnt(5)
    v_mfma_f32_16x16x32_bf16 v[180:183], a[24:27], v[84:87], v[180:183]
    ds_read_b128 a[16:19], v6 offset:61440
    v_mfma_f32_16x16x32_bf16 v[176:179], a[24:27], v[80:83], v[176:179]
    buffer_load_dwordx4 a[44:47], v25, s[4:7], s71 offen offset:3072 sc1
    s_waitcnt lgkmcnt(5)
    v_mfma_f32_16x16x32_bf16 v[184:187], a[28:31], v[80:83], v[184:187]
    ds_read_b128 a[20:23], v6 offset:62464
    v_mfma_f32_16x16x32_bf16 v[188:191], a[28:31], v[84:87], v[188:191]
    s_add_u32 s71, s35, 4096
    s_waitcnt lgkmcnt(5)
    v_mfma_f32_16x16x32_bf16 v[196:199], a[0:3], v[84:87], v[196:199]
    ds_read_b128 a[24:27], v6 offset:63488
    buffer_load_dwordx4 a[48:51], v25, s[4:7], s71 offen offset:0 sc1
    v_mfma_f32_16x16x32_bf16 v[192:195], a[0:3], v[80:83], v[192:195]
    s_waitcnt lgkmcnt(5)
    v_mfma_f32_16x16x32_bf16 v[200:203], a[4:7], v[80:83], v[200:203]
    ds_read_b128 a[28:31], v6 offset:64512
    buffer_load_dwordx4 a[52:55], v25, s[4:7], s71 offen offset:1024 sc1
    v_mfma_f32_16x16x32_bf16 v[204:207], a[4:7], v[84:87], v[204:207]
    buffer_load_dwordx4 a[56:59], v25, s[4:7], s52 offen offset:0 sc1
    s_waitcnt lgkmcnt(5)
    v_mfma_f32_16x16x32_bf16 v[212:215], a[8:11], v[84:87], v[212:215]
    v_mfma_f32_16x16x32_bf16 v[208:211], a[8:11], v[80:83], v[208:211]
    buffer_load_dwordx4 a[60:63], v25, s[4:7], s52 offen offset:1024 sc1
    s_waitcnt lgkmcnt(4)
    v_mfma_f32_16x16x32_bf16 v[216:219], a[12:15], v[80:83], v[216:219]
    s_add_u32 s70, s44, 28672
    v_mfma_f32_16x16x32_bf16 v[220:223], a[12:15], v[84:87], v[220:223]
    s_waitcnt lgkmcnt(3)
    v_mfma_f32_16x16x32_bf16 v[228:231], a[16:19], v[84:87], v[228:231]
    s_add_u32 m0, s32, 16384
    v_mfma_f32_16x16x32_bf16 v[224:227], a[16:19], v[80:83], v[224:227]
    buffer_load_dwordx4 v21, s[16:19], s70 offen offset:0 sc1 lds
    s_waitcnt lgkmcnt(2)
    v_mfma_f32_16x16x32_bf16 v[232:235], a[20:23], v[80:83], v[232:235]
    v_mfma_f32_16x16x32_bf16 v[236:239], a[20:23], v[84:87], v[236:239]
    buffer_load_dwordx4 v22, s[16:19], s70 offen offset:1024 sc1 lds
    s_waitcnt lgkmcnt(1)
    v_mfma_f32_16x16x32_bf16 v[244:247], a[24:27], v[84:87], v[244:247]
    buffer_load_dwordx4 v23, s[16:19], s70 offen offset:2048 sc1 lds
    v_mfma_f32_16x16x32_bf16 v[240:243], a[24:27], v[80:83], v[240:243]
    s_waitcnt lgkmcnt(0)
    v_mfma_f32_16x16x32_bf16 v[248:251], a[28:31], v[80:83], v[248:251]
    buffer_load_dwordx4 v24, s[16:19], s70 offen offset:3072 sc1 lds
    v_mfma_f32_16x16x32_bf16 v[252:255], a[28:31], v[84:87], v[252:255]
    s_branch at_y_join
at_y_tail1:
    s_waitcnt lgkmcnt(5)
    ds_read_b128 a[0:3], v7 offset:49152
    s_waitcnt lgkmcnt(5)
    ds_read_b128 a[4:7], v7 offset:50176
    s_waitcnt lgkmcnt(5)
    ds_read_b128 a[8:11], v7 offset:51200
    s_waitcnt lgkmcnt(5)
    ds_read_b128 a[12:15], v7 offset:52224
    s_waitcnt lgkmcnt(5)
    ds_read_b128 a[16:19], v7 offset:53248
    s_waitcnt lgkmcnt(5)
    ds_read_b128 a[20:23], v7 offset:54272
    s_add_u32 s29, s66, 16384
    v_exp_f32 v96, v68
    v_exp_f32 v97, v69
    v_exp_f32 v98, v70
    v_cvt_pk_bf16_f32 v92, v96, v97
    v_exp_f32 v99, v71
    v_exp_f32 v100, v76
    v_cvt_pk_bf16_f32 v93, v98, v99
    v_exp_f32 v101, v77
    v_exp_f32 v102, v78
    v_cvt_pk_bf16_f32 v94, v100, v101
    v_exp_f32 v103, v79
    s_nop 0
    v_cvt_pk_bf16_f32 v95, v102, v103
    v_or3_b32 v11, v88, v89, v90
    v_or3_b32 v11, v11, v91, v92
    v_or3_b32 v11, v11, v93, v94
    v_bitop3_b32 v11, v11, v95, s65 bitop3:0xa8
    v_cmp_ne_u32 vcc, 0, v11
    s_nop 0
    s_cbranch_vccnz at_y_rt1
at_y_rt1_ret:
    s_cmp_eq_u32 s15, 0
    s_cbranch_scc1 t_54
    s_mov_b32 m0, s67
    s_waitcnt vmcnt(8)
    s_barrier
    buffer_load_dwordx4 v30, s[4:7], s29 offen offset:0 sc1 lds
    buffer_load_dwordx4 v30, s[4:7], s29 offen offset:1024 sc1 lds
    buffer_load_dwordx4 v30, s[4:7], s29 offen offset:2048 sc1 lds
    buffer_load_dwordx4 v30, s[4:7], s29 offen offset:3072 sc1 lds
t_54:
    v_mfma_f32_16x16x32_bf16 v[104:107], v[112:115], v[88:91], v[104:107]
    s_add_u32 s70, s44, 0
    v_mfma_f32_16x16x32_bf16 v[108:111], v[112:115], v[92:95], v[108:111]
    s_add_u32 m0, s32, 0
    s_waitcnt lgkmcnt(5)
    v_mfma_f32_16x16x32_bf16 v[132:135], a[0:3], v[92:95], v[132:135]
    ds_read_b128 a[24:27], v7 offset:55296
    v_mfma_f32_16x16x32_bf16 v[128:131], a[0:3], v[88:91], v[128:131]
    buffer_load_dwordx4 v21, s[16:19], s70 offen offset:0 sc1 lds
    s_waitcnt lgkmcnt(5)
    v_mfma_f32_16x16x32_bf16 v[136:139], a[4:7], v[88:91], v[136:139]
    ds_read_b128 a[28:31], v7 offset:56320
    buffer_load_dwordx4 v22, s[16:19], s70 offen offset:1024 sc1 lds
    v_mfma_f32_16x16x32_bf16 v[140:143], a[4:7], v[92:95], v[140:143]
    s_waitcnt lgkmcnt(5)
    v_mfma_f32_16x16x32_bf16 v[148:151], a[8:11], v[92:95], v[148:151]
    ds_read_b128 a[0:3], v7 offset:57344
    buffer_load_dwordx4 v23, s[16:19], s70 offen offset:2048 sc1 lds
    v_mfma_f32_16x16x32_bf16 v[144:147], a[8:11], v[88:91], v[144:147]
    buffer_load_dwordx4 v24, s[16:19], s70 offen offset:3072 sc1 lds
    s_waitcnt lgkmcnt(5)
    v_mfma_f32_16x16x32_bf16 v[152:155], a[12:15], v[88:91], v[152:155]
    ds_read_b128 a[4:7], v7 offset:58368
    v_mfma_f32_16x16x32_bf16 v[156:159], a[12:15], v[92:95], v[156:159]
    s_add_u32 s71, s35, 0
    s_waitcnt lgkmcnt(5)
    v_mfma_f32_16x16x32_bf16 v[164:167], a[16:19], v[92:95], v[164:167]
    ds_read_b128 a[8:11], v7 offset:59392
    buffer_load_dwordx4 a[32:35], v25, s[4:7], s71 offen offset:0 sc1
    v_mfma_f32_16x16x32_bf16 v[160:163], a[16:19], v[88:91], v[160:163]
    s_waitcnt lgkmcnt(5)
    v_mfma_f32_16x16x32_bf16 v[168:171], a[20:23], v[88:91], v[168:171]
    ds_read_b128 a[12:15], v7 offset:60416
    buffer_load_dwordx4 a[36:39], v25, s[4:7], s71 offen offset:1024 sc1
    v_mfma_f32_16x16x32_bf16 v[172:175], a[20:23], v[92:95], v[172:175]
    buffer_load_dwordx4 a[40:43], v25, s[4:7], s71 offen offset:2048 sc1
    s_waitcnt lgkmcnt(5)
    v_mfma_f32_16x16x32_bf16 v[180:183], a[24:27], v[92:95], v[180:183]
    ds_read_b128 a[16:19], v7 offset:61440
    v_mfma_f32_16x16x32_bf16 v[176:179], a[24:27], v[88:91], v[176:179]
    buffer_load_dwordx4 a[44:47], v25, s[4:7], s71 offen offset:3072 sc1
    s_waitcnt lgkmcnt(5)
    v_mfma_f32_16x16x32_bf16 v[184:187], a[28:31], v[88:91], v[184:187]
    ds_read_b128 a[20:23], v7 offset:62464
    v_mfma_f32_16x16x32_bf16 v[188:191], a[28:31], v[92:95], v[188:191]
    s_add_u32 s71, s35, 4096
    s_waitcnt lgkmcnt(5)
    v_mfma_f32_16x16x32_bf16 v[196:199], a[0:3], v[92:95], v[196:199]
    ds_read_b128 a[24:27], v7 offset:63488
    buffer_load_dwordx4 a[48:51], v25, s[4:7], s71 offen offset:0 sc1
    v_mfma_f32_16x16x32_bf16 v[192:195], a[0:3], v[88:91], v[192:195]
    s_waitcnt lgkmcnt(5)
    v_mfma_f32_16x16x32_bf16 v[200:203], a[4:7], v[88:91], v[200:203]
    ds_read_b128 a[28:31], v7 offset:64512
    buffer_load_dwordx4 a[52:55], v25, s[4:7], s71 offen offset:1024 sc1
    v_mfma_f32_16x16x32_bf16 v[204:207], a[4:7], v[92:95], v[204:207]
    buffer_load_dwordx4 a[56:59], v25, s[4:7], s52 offen offset:0 sc1
    s_waitcnt lgkmcnt(5)
    v_mfma_f32_16x16x32_bf16 v[212:215], a[8:11], v[92:95], v[212:215]
    v_mfma_f32_16x16x32_bf16 v[208:211], a[8:11], v[88:91], v[208:211]
    buffer_load_dwordx4 a[60:63], v25, s[4:7], s52 offen offset:1024 sc1
    s_waitcnt lgkmcnt(4)
    v_mfma_f32_16x16x32_bf16 v[216:219], a[12:15], v[88:91], v[216:219]
    s_add_u32 s70, s44, 28672
    v_mfma_f32_16x16x32_bf16 v[220:223], a[12:15], v[92:95], v[220:223]
    s_waitcnt lgkmcnt(3)
    v_mfma_f32_16x16x32_bf16 v[228:231], a[16:19], v[92:95], v[228:231]
    s_add_u32 m0, s32, 16384
    v_mfma_f32_16x16x32_bf16 v[224:227], a[16:19], v[88:91], v[224:227]
    buffer_load_dwordx4 v21, s[16:19], s70 offen offset:0 sc1 lds
    s_waitcnt lgkmcnt(2)
    v_mfma_f32_16x16x32_bf16 v[232:235], a[20:23], v[88:91], v[232:235]
    v_mfma_f32_16x16x32_bf16 v[236:239], a[20:23], v[92:95], v[236:239]
    buffer_load_dwordx4 v22, s[16:19], s70 offen offset:1024 sc1 lds
    s_waitcnt lgkmcnt(1)
    v_mfma_f32_16x16x32_bf16 v[244:247], a[24:27], v[92:95], v[244:247]
    buffer_load_dwordx4 v23, s[16:19], s70 offen offset:2048 sc1 lds
    v_mfma_f32_16x16x32_bf16 v[240:243], a[24:27], v[88:91], v[240:243]
    s_waitcnt lgkmcnt(0)
    v_mfma_f32_16x16x32_bf16 v[248:251], a[28:31], v[88:91], v[248:251]
    buffer_load_dwordx4 v24, s[16:19], s70 offen offset:3072 sc1 lds
    v_mfma_f32_16x16x32_bf16 v[252:255], a[28:31], v[92:95], v[252:255]
at_y_join:
    s_cmp_eq_u32 s88, 0
    s_cbranch_scc0 at_y_end
    s_cmp_ge_u32 s15, 2
    s_cbranch_scc0 ob_57
    s_waitcnt vmcnt(20)
    s_barrier
ob_57:
    s_cmp_ge_u32 s15, 3
    s_cbranch_scc0 ob_58
    s_waitcnt vmcnt(16)
    s_barrier
ob_58:
    s_mov_b32 s15, 0
    s_waitcnt vmcnt(17)
    buffer_load_dword v31, off, s[4:7], s14 sc1
    s_mov_b32 s98, 0
spin_59:
    s_waitcnt vmcnt(0)
    v_readfirstlane_b32 s99, v31
    s_nop 0
    s_cmp_ge_u32 s99, 1
    s_cbranch_scc1 ok_60
    s_add_u32 s98, s98, 1
    s_cmp_gt_u32 s98, 0x80000
    s_cbranch_scc1 ok_60
    s_sleep 8
    buffer_load_dword v31, off, s[4:7], s14 sc1
    s_waitcnt vmcnt(0)
    s_branch spin_59
ok_60:
    s_add_u32 s3, s11, 0
    buffer_load_dwordx4 a[128:131], v25, s[4:7], s3 offen offset:0 sc1
    buffer_load_dwordx4 a[132:135], v25, s[4:7], s3 offen offset:1024 sc1
    buffer_load_dwordx4 a[136:139], v25, s[4:7], s3 offen offset:2048 sc1
    buffer_load_dwordx4 a[140:143], v25, s[4:7], s3 offen offset:3072 sc1
    s_add_u32 s3, s11, 4096
    buffer_load_dwordx4 a[144:147], v25, s[4:7], s3 offen offset:0 sc1
    buffer_load_dwordx4 a[148:151], v25, s[4:7], s3 offen offset:1024 sc1
    buffer_load_dwordx4 a[152:155], v25, s[4:7], s3 offen offset:2048 sc1
    buffer_load_dwordx4 a[156:159], v25, s[4:7], s3 offen offset:3072 sc1
    s_add_u32 s3, s11, 8192
    buffer_load_dwordx4 a[160:163], v25, s[4:7], s3 offen offset:0 sc1
    buffer_load_dwordx4 a[164:167], v25, s[4:7], s3 offen offset:1024 sc1
    buffer_load_dwordx4 a[168:171], v25, s[4:7], s3 offen offset:2048 sc1
    buffer_load_dwordx4 a[172:175], v25, s[4:7], s3 offen offset:3072 sc1
    s_add_u32 s3, s11, 12288
    buffer_load_dwordx4 a[176:179], v25, s[4:7], s3 offen offset:0 sc1
    buffer_load_dwordx4 a[180:183], v25, s[4:7], s3 offen offset:1024 sc1
    buffer_load_dwordx4 a[184:187], v25, s[4:7], s3 offen offset:2048 sc1
    buffer_load_dwordx4 a[188:191], v25, s[4:7], s3 offen offset:3072 sc1
    s_add_u32 s3, s11, 8388608
    buffer_load_dwordx4 a[192:195], v25, s[4:7], s3 offen sc1
    s_waitcnt vmcnt(0)
at_y_end:
    s_lshl_b32 s3, s21, 4
    s_add_u32 s3, s3, s22
    s_lshl_b32 s3, s3, 2
    s_add_u32 s3, s3, s20
    s_lshl_b32 s3, s3, 14
    s_add_u32 s23, s3, 58720256
    s_cmp_eq_u32 s11, 0
    s_cbranch_scc0 at_comb
    v_rcp_f32 v118, v104
    v_rcp_f32 v119, v108
    v_mul_f32 v118, v118, v14
    v_mul_f32 v119, v119, v15
    s_add_u32 s3, s23, 0
    v_mul_f32 v128, v128, v118
    v_mul_f32 v129, v129, v118
    v_mul_f32 v130, v130, v118
    v_mul_f32 v131, v131, v118
    v_mul_f32 v136, v136, v118
    v_mul_f32 v137, v137, v118
    v_mul_f32 v138, v138, v118
    v_mul_f32 v139, v139, v118
    v_cvt_pk_bf16_f32 v128, v128, v129
    v_cvt_pk_bf16_f32 v129, v130, v131
    v_cvt_pk_bf16_f32 v130, v136, v137
    v_cvt_pk_bf16_f32 v131, v138, v139
    buffer_store_dwordx4 v[128:131], v25, s[4:7], s3 offen offset:0 sc1
    v_mul_f32 v132, v132, v119
    v_mul_f32 v133, v133, v119
    v_mul_f32 v134, v134, v119
    v_mul_f32 v135, v135, v119
    v_mul_f32 v140, v140, v119
    v_mul_f32 v141, v141, v119
    v_mul_f32 v142, v142, v119
    v_mul_f32 v143, v143, v119
    v_cvt_pk_bf16_f32 v132, v132, v133
    v_cvt_pk_bf16_f32 v133, v134, v135
    v_cvt_pk_bf16_f32 v134, v140, v141
    v_cvt_pk_bf16_f32 v135, v142, v143
    buffer_store_dwordx4 v[132:135], v25, s[4:7], s3 offen offset:1024 sc1
    v_mul_f32 v144, v144, v118
    v_mul_f32 v145, v145, v118
    v_mul_f32 v146, v146, v118
    v_mul_f32 v147, v147, v118
    v_mul_f32 v152, v152, v118
    v_mul_f32 v153, v153, v118
    v_mul_f32 v154, v154, v118
    v_mul_f32 v155, v155, v118
    v_cvt_pk_bf16_f32 v144, v144, v145
    v_cvt_pk_bf16_f32 v145, v146, v147
    v_cvt_pk_bf16_f32 v146, v152, v153
    v_cvt_pk_bf16_f32 v147, v154, v155
    buffer_store_dwordx4 v[144:147], v25, s[4:7], s3 offen offset:2048 sc1
    v_mul_f32 v148, v148, v119
    v_mul_f32 v149, v149, v119
    v_mul_f32 v150, v150, v119
    v_mul_f32 v151, v151, v119
    v_mul_f32 v156, v156, v119
    v_mul_f32 v157, v157, v119
    v_mul_f32 v158, v158, v119
    v_mul_f32 v159, v159, v119
    v_cvt_pk_bf16_f32 v148, v148, v149
    v_cvt_pk_bf16_f32 v149, v150, v151
    v_cvt_pk_bf16_f32 v150, v156, v157
    v_cvt_pk_bf16_f32 v151, v158, v159
    buffer_store_dwordx4 v[148:151], v25, s[4:7], s3 offen offset:3072 sc1
    s_add_u32 s3, s23, 4096
    v_mul_f32 v160, v160, v118
    v_mul_f32 v161, v161, v118
    v_mul_f32 v162, v162, v118
    v_mul_f32 v163, v163, v118
    v_mul_f32 v168, v168, v118
    v_mul_f32 v169, v169, v118
    v_mul_f32 v170, v170, v118
    v_mul_f32 v171, v171, v118
    v_cvt_pk_bf16_f32 v160, v160, v161
    v_cvt_pk_bf16_f32 v161, v162, v163
    v_cvt_pk_bf16_f32 v162, v168, v169
    v_cvt_pk_bf16_f32 v163, v170, v171
    buffer_store_dwordx4 v[160:163], v25, s[4:7], s3 offen offset:0 sc1
    v_mul_f32 v164, v164, v119
    v_mul_f32 v165, v165, v119
    v_mul_f32 v166, v166, v119
    v_mul_f32 v167, v167, v119
    v_mul_f32 v172, v172, v119
    v_mul_f32 v173, v173, v119
    v_mul_f32 v174, v174, v119
    v_mul_f32 v175, v175, v119
    v_cvt_pk_bf16_f32 v164, v164, v165
    v_cvt_pk_bf16_f32 v165, v166, v167
    v_cvt_pk_bf16_f32 v166, v172, v173
    v_cvt_pk_bf16_f32 v167, v174, v175
    buffer_store_dwordx4 v[164:167], v25, s[4:7], s3 offen offset:1024 sc1
    v_mul_f32 v176, v176, v118
    v_mul_f32 v177, v177, v118
    v_mul_f32 v178, v178, v118
    v_mul_f32 v179, v179, v118
    v_mul_f32 v184, v184, v118
    v_mul_f32 v185, v185, v118
    v_mul_f32 v186, v186, v118
    v_mul_f32 v187, v187, v118
    v_cvt_pk_bf16_f32 v176, v176, v177
    v_cvt_pk_bf16_f32 v177, v178, v179
    v_cvt_pk_bf16_f32 v178, v184, v185
    v_cvt_pk_bf16_f32 v179, v186, v187
    buffer_store_dwordx4 v[176:179], v25, s[4:7], s3 offen offset:2048 sc1
    v_mul_f32 v180, v180, v119
    v_mul_f32 v181, v181, v119
    v_mul_f32 v182, v182, v119
    v_mul_f32 v183, v183, v119
    v_mul_f32 v188, v188, v119
    v_mul_f32 v189, v189, v119
    v_mul_f32 v190, v190, v119
    v_mul_f32 v191, v191, v119
    v_cvt_pk_bf16_f32 v180, v180, v181
    v_cvt_pk_bf16_f32 v181, v182, v183
    v_cvt_pk_bf16_f32 v182, v188, v189
    v_cvt_pk_bf16_f32 v183, v190, v191
    buffer_store_dwordx4 v[180:183], v25, s[4:7], s3 offen offset:3072 sc1
    s_cmp_ge_u32 s15, 2
    s_cbranch_scc0 ob_61
    s_waitcnt vmcnt(28)
    s_barrier
ob_61:
    s_add_u32 s3, s23, 8192
    v_mul_f32 v192, v192, v118
    v_mul_f32 v193, v193, v118
    v_mul_f32 v194, v194, v118
    v_mul_f32 v195, v195, v118
    v_mul_f32 v200, v200, v118
    v_mul_f32 v201, v201, v118
    v_mul_f32 v202, v202, v118
    v_mul_f32 v203, v203, v118
    v_cvt_pk_bf16_f32 v192, v192, v193
    v_cvt_pk_bf16_f32 v193, v194, v195
    v_cvt_pk_bf16_f32 v194, v200, v201
    v_cvt_pk_bf16_f32 v195, v202, v203
    buffer_store_dwordx4 v[192:195], v25, s[4:7], s3 offen offset:0 sc1
    v_mul_f32 v196, v196, v119
    v_mul_f32 v197, v197, v119
    v_mul_f32 v198, v198, v119
    v_mul_f32 v199, v199, v119
    v_mul_f32 v204, v204, v119
    v_mul_f32 v205, v205, v119
    v_mul_f32 v206, v206, v119
    v_mul_f32 v207, v207, v119
    v_cvt_pk_bf16_f32 v196, v196, v197
    v_cvt_pk_bf16_f32 v197, v198, v199
    v_cvt_pk_bf16_f32 v198, v204, v205
    v_cvt_pk_bf16_f32 v199, v206, v207
    buffer_store_dwordx4 v[196:199], v25, s[4:7], s3 offen offset:1024 sc1
    v_mul_f32 v208, v208, v118
    v_mul_f32 v209, v209, v118
    v_mul_f32 v210, v210, v118
    v_mul_f32 v211, v211, v118
    v_mul_f32 v216, v216, v118
    v_mul_f32 v217, v217, v118
    v_mul_f32 v218, v218, v118
    v_mul_f32 v219, v219, v118
    v_cvt_pk_bf16_f32 v208, v208, v209
    v_cvt_pk_bf16_f32 v209, v210, v211
    v_cvt_pk_bf16_f32 v210, v216, v217
    v_cvt_pk_bf16_f32 v211, v218, v219
    buffer_store_dwordx4 v[208:211], v25, s[4:7], s3 offen offset:2048 sc1
    v_mul_f32 v212, v212, v119
    v_mul_f32 v213, v213, v119
    v_mul_f32 v214, v214, v119
    v_mul_f32 v215, v215, v119
    v_mul_f32 v220, v220, v119
    v_mul_f32 v221, v221, v119
    v_mul_f32 v222, v222, v119
    v_mul_f32 v223, v223, v119
    v_cvt_pk_bf16_f32 v212, v212, v213
    v_cvt_pk_bf16_f32 v213, v214, v215
    v_cvt_pk_bf16_f32 v214, v220, v221
    v_cvt_pk_bf16_f32 v215, v222, v223
    buffer_store_dwordx4 v[212:215], v25, s[4:7], s3 offen offset:3072 sc1
    s_add_u32 s3, s23, 12288
    v_mul_f32 v224, v224, v118
    v_mul_f32 v225, v225, v118
    v_mul_f32 v226, v226, v118
    v_mul_f32 v227, v227, v118
    v_mul_f32 v232, v232, v118
    v_mul_f32 v233, v233, v118
    v_mul_f32 v234, v234, v118
    v_mul_f32 v235, v235, v118
    v_cvt_pk_bf16_f32 v224, v224, v225
    v_cvt_pk_bf16_f32 v225, v226, v227
    v_cvt_pk_bf16_f32 v226, v232, v233
    v_cvt_pk_bf16_f32 v227, v234, v235
    buffer_store_dwordx4 v[224:227], v25, s[4:7], s3 offen offset:0 sc1
    v_mul_f32 v228, v228, v119
    v_mul_f32 v229, v229, v119
    v_mul_f32 v230, v230, v119
    v_mul_f32 v231, v231, v119
    v_mul_f32 v236, v236, v119
    v_mul_f32 v237, v237, v119
    v_mul_f32 v238, v238, v119
    v_mul_f32 v239, v239, v119
    v_cvt_pk_bf16_f32 v228, v228, v229
    v_cvt_pk_bf16_f32 v229, v230, v231
    v_cvt_pk_bf16_f32 v230, v236, v237
    v_cvt_pk_bf16_f32 v231, v238, v239
    buffer_store_dwordx4 v[228:231], v25, s[4:7], s3 offen offset:1024 sc1
    v_mul_f32 v240, v240, v118
    v_mul_f32 v241, v241, v118
    v_mul_f32 v242, v242, v118
    v_mul_f32 v243, v243, v118
    v_mul_f32 v248, v248, v118
    v_mul_f32 v249, v249, v118
    v_mul_f32 v250, v250, v118
    v_mul_f32 v251, v251, v118
    v_cvt_pk_bf16_f32 v240, v240, v241
    v_cvt_pk_bf16_f32 v241, v242, v243
    v_cvt_pk_bf16_f32 v242, v248, v249
    v_cvt_pk_bf16_f32 v243, v250, v251
    buffer_store_dwordx4 v[240:243], v25, s[4:7], s3 offen offset:2048 sc1
    v_mul_f32 v244, v244, v119
    v_mul_f32 v245, v245, v119
    v_mul_f32 v246, v246, v119
    v_mul_f32 v247, v247, v119
    v_mul_f32 v252, v252, v119
    v_mul_f32 v253, v253, v119
    v_mul_f32 v254, v254, v119
    v_mul_f32 v255, v255, v119
    v_cvt_pk_bf16_f32 v244, v244, v245
    v_cvt_pk_bf16_f32 v245, v246, v247
    v_cvt_pk_bf16_f32 v246, v252, v253
    v_cvt_pk_bf16_f32 v247, v254, v255
    buffer_store_dwordx4 v[244:247], v25, s[4:7], s3 offen offset:3072 sc1
    s_cmp_ge_u32 s15, 3
    s_cbranch_scc0 ob_62
    s_waitcnt vmcnt(32)
    s_barrier
ob_62:
    s_branch at_done
at_comb:
    s_waitcnt vmcnt(16)
    v_accvgpr_read_b32 v96, a192
    v_accvgpr_read_b32 v98, a193
    v_accvgpr_read_b32 v97, a194
    v_accvgpr_read_b32 v99, a195
    v_sub_f32 v96, v116, v96
    v_sub_f32 v97, v117, v97
    v_max_f32 v11, v96, v97
    v_cmp_lt_f32 vcc, 0x42000000, v11
    s_nop 0
    s_cbranch_vccz at_c_near
    v_max_f32 v11, 0, v96
    v_sub_f32 v96, v96, v11
    v_exp_f32 v11, -v11
    s_nop 0
    v_mul_f32 v104, v104, v11
    v_mul_f32 v128, v128, v11
    v_mul_f32 v129, v129, v11
    v_mul_f32 v130, v130, v11
    v_mul_f32 v131, v131, v11
    v_mul_f32 v136, v136, v11
    v_mul_f32 v137, v137, v11
    v_mul_f32 v138, v138, v11
    v_mul_f32 v139, v139, v11
    v_mul_f32 v144, v144, v11
    v_mul_f32 v145, v145, v11
    v_mul_f32 v146, v146, v11
    v_mul_f32 v147, v147, v11
    v_mul_f32 v152, v152, v11
    v_mul_f32 v153, v153, v11
    v_mul_f32 v154, v154, v11
    v_mul_f32 v155, v155, v11
    v_mul_f32 v160, v160, v11
    v_mul_f32 v161, v161, v11
    v_mul_f32 v162, v162, v11
    v_mul_f32 v163, v163, v11
    v_mul_f32 v168, v168, v11
    v_mul_f32 v169, v169, v11
    v_mul_f32 v170, v170, v11
    v_mul_f32 v171, v171, v11
    v_mul_f32 v176, v176, v11
    v_mul_f32 v177, v177, v11
    v_mul_f32 v178, v178, v11
    v_mul_f32 v179, v179, v11
    v_mul_f32 v184, v184, v11
    v_mul_f32 v185, v185, v11
    v_mul_f32 v186, v186, v11
    v_mul_f32 v187, v187, v11
    v_mul_f32 v192, v192, v11
    v_mul_f32 v193, v193, v11
    v_mul_f32 v194, v194, v11
    v_mul_f32 v195, v195, v11
    v_mul_f32 v200, v200, v11
    v_mul_f32 v201, v201, v11
    v_mul_f32 v202, v202, v11
    v_mul_f32 v203, v203, v11
    v_mul_f32 v208, v208, v11
    v_mul_f32 v209, v209, v11
    v_mul_f32 v210, v210, v11
    v_mul_f32 v211, v211, v11
    v_mul_f32 v216, v216, v11
    v_mul_f32 v217, v217, v11
    v_mul_f32 v218, v218, v11
    v_mul_f32 v219, v219, v11
    v_mul_f32 v224, v224, v11
    v_mul_f32 v225, v225, v11
    v_mul_f32 v226, v226, v11
    v_mul_f32 v227, v227, v11
    v_mul_f32 v232, v232, v11
    v_mul_f32 v233, v233, v11
    v_mul_f32 v234, v234, v11
    v_mul_f32 v235, v235, v11
    v_mul_f32 v240, v240, v11
    v_mul_f32 v241, v241, v11
    v_mul_f32 v242, v242, v11
    v_mul_f32 v243, v243, v11
    v_mul_f32 v248, v248, v11
    v_mul_f32 v249, v249, v11
    v_mul_f32 v250, v250, v11
    v_mul_f32 v251, v251, v11
    v_max_f32 v11, 0, v97
    v_sub_f32 v97, v97, v11
    v_exp_f32 v11, -v11
    s_nop 0
    v_mul_f32 v108, v108, v11
    v_mul_f32 v132, v132, v11
    v_mul_f32 v133, v133, v11
    v_mul_f32 v134, v134, v11
    v_mul_f32 v135, v135, v11
    v_mul_f32 v140, v140, v11
    v_mul_f32 v141, v141, v11
    v_mul_f32 v142, v142, v11
    v_mul_f32 v143, v143, v11
    v_mul_f32 v148, v148, v11
    v_mul_f32 v149, v149, v11
    v_mul_f32 v150, v150, v11
    v_mul_f32 v151, v151, v11
    v_mul_f32 v156, v156, v11
    v_mul_f32 v157, v157, v11
    v_mul_f32 v158, v158, v11
    v_mul_f32 v159, v159, v11
    v_mul_f32 v164, v164, v11
    v_mul_f32 v165, v165, v11
    v_mul_f32 v166, v166, v11
    v_mul_f32 v167, v167, v11
    v_mul_f32 v172, v172, v11
    v_mul_f32 v173, v173, v11
    v_mul_f32 v174, v174, v11
    v_mul_f32 v175, v175, v11
    v_mul_f32 v180, v180, v11
    v_mul_f32 v181, v181, v11
    v_mul_f32 v182, v182, v11
    v_mul_f32 v183, v183, v11
    v_mul_f32 v188, v188, v11
    v_mul_f32 v189, v189, v11
    v_mul_f32 v190, v190, v11
    v_mul_f32 v191, v191, v11
    v_mul_f32 v196, v196, v11
    v_mul_f32 v197, v197, v11
    v_mul_f32 v198, v198, v11
    v_mul_f32 v199, v199, v11
    v_mul_f32 v204, v204, v11
    v_mul_f32 v205, v205, v11
    v_mul_f32 v206, v206, v11
    v_mul_f32 v207, v207, v11
    v_mul_f32 v212, v212, v11
    v_mul_f32 v213, v213, v11
    v_mul_f32 v214, v214, v11
    v_mul_f32 v215, v215, v11
    v_mul_f32 v220, v220, v11
    v_mul_f32 v221, v221, v11
    v_mul_f32 v222, v222, v11
    v_mul_f32 v223, v223, v11
    v_mul_f32 v228, v228, v11
    v_mul_f32 v229, v229, v11
    v_mul_f32 v230, v230, v11
    v_mul_f32 v231, v231, v11
    v_mul_f32 v236, v236, v11
    v_mul_f32 v237, v237, v11
    v_mul_f32 v238, v238, v11
    v_mul_f32 v239, v239, v11
    v_mul_f32 v244, v244, v11
    v_mul_f32 v245, v245, v11
    v_mul_f32 v246, v246, v11
    v_mul_f32 v247, v247, v11
    v_mul_f32 v252, v252, v11
    v_mul_f32 v253, v253, v11
    v_mul_f32 v254, v254, v11
    v_mul_f32 v255, v255, v11
at_c_near:
    v_bfe_u32 v2, v1, 2, 2
    v_lshrrev_b32 v3, 4, v1
    v_cmp_eq_u32 s[68:69], v2, v3
    v_bfe_u32 v2, v1, 1, 1
    v_cmp_eq_u32 s[70:71], 0, v2
    v_and_b32 v2, 1, v1
    v_xor_b32 v2, 1, v2
    v_lshlrev_b32 v2, 4, v2
    v_mov_b32 v34, 0
    v_mov_b32 v35, 0
    v_mov_b32 v36, 0
    v_mov_b32 v37, 0
    v_max_f32 v96, 0xc2f00000, v96
    v_cvt_i32_f32 v96, v96
    v_ldexp_f32 v96, 1.0, v96
    v_fma_f32 v98, v96, v98, v104
    v_rcp_f32 v98, v98
    v_lshrrev_b32 v96, v2, v96
    v_cndmask_b32 v96, 0, v96, s[68:69]
    v_mul_f32 v118, v98, v14
    v_cndmask_b32 v32, 0, v96, s[70:71]
    v_cndmask_b32 v33, v96, 0, s[70:71]
    v_max_f32 v97, 0xc2f00000, v97
    v_cvt_i32_f32 v97, v97
    v_ldexp_f32 v97, 1.0, v97
    v_fma_f32 v99, v97, v99, v108
    v_rcp_f32 v99, v99
    v_lshrrev_b32 v97, v2, v97
    v_cndmask_b32 v97, 0, v97, s[68:69]
    v_mul_f32 v119, v99, v15
    v_cndmask_b32 v38, 0, v97, s[70:71]
    v_cndmask_b32 v39, v97, 0, s[70:71]
    v_mfma_f32_16x16x32_bf16 v[128:131], a[128:131], v[32:35], v[128:131]
    s_nop 0
    v_mfma_f32_16x16x32_bf16 v[132:135], a[128:131], v[36:39], v[132:135]
    v_mfma_f32_16x16x32_bf16 v[136:139], a[132:135], v[32:35], v[136:139]
    v_mfma_f32_16x16x32_bf16 v[140:143], a[132:135], v[36:39], v[140:143]
    v_mfma_f32_16x16x32_bf16 v[144:147], a[136:139], v[32:35], v[144:147]
    v_mfma_f32_16x16x32_bf16 v[148:151], a[136:139], v[36:39], v[148:151]
    v_mfma_f32_16x16x32_bf16 v[152:155], a[140:143], v[32:35], v[152:155]
    v_mfma_f32_16x16x32_bf16 v[156:159], a[140:143], v[36:39], v[156:159]
    s_add_u32 s3, s23, 0
    v_mul_f32 v128, v128, v118
    v_mul_f32 v129, v129, v118
    v_mul_f32 v130, v130, v118
    v_mul_f32 v131, v131, v118
    v_mfma_f32_16x16x32_bf16 v[160:163], a[144:147], v[32:35], v[160:163]
    v_mul_f32 v136, v136, v118
    v_mul_f32 v137, v137, v118
    v_mul_f32 v138, v138, v118
    v_mul_f32 v139, v139, v118
    v_mfma_f32_16x16x32_bf16 v[164:167], a[144:147], v[36:39], v[164:167]
    v_cvt_pk_bf16_f32 v128, v128, v129
    v_cvt_pk_bf16_f32 v129, v130, v131
    v_cvt_pk_bf16_f32 v130, v136, v137
    v_cvt_pk_bf16_f32 v131, v138, v139
    buffer_store_dwordx4 v[128:131], v25, s[4:7], s3 offen offset:0 sc1
    v_mul_f32 v132, v132, v119
    v_mul_f32 v133, v133, v119
    v_mul_f32 v134, v134, v119
    v_mul_f32 v135, v135, v119
    v_mfma_f32_16x16x32_bf16 v[168:171], a[148:151], v[32:35], v[168:171]
    v_mul_f32 v140, v140, v119
    v_mul_f32 v141, v141, v119
    v_mul_f32 v142, v142, v119
    v_mul_f32 v143, v143, v119
    v_mfma_f32_16x16x32_bf16 v[172:175], a[148:151], v[36:39], v[172:175]
    v_cvt_pk_bf16_f32 v132, v132, v133
    v_cvt_pk_bf16_f32 v133, v134, v135
    v_cvt_pk_bf16_f32 v134, v140, v141
    v_cvt_pk_bf16_f32 v135, v142, v143
    buffer_store_dwordx4 v[132:135], v25, s[4:7], s3 offen offset:1024 sc1
    v_mul_f32 v144, v144, v118
    v_mul_f32 v145, v145, v118
    v_mul_f32 v146, v146, v118
    v_mul_f32 v147, v147, v118
    v_mfma_f32_16x16x32_bf16 v[176:179], a[152:155], v[32:35], v[176:179]
    v_mul_f32 v152, v152, v118
    v_mul_f32 v153, v153, v118
    v_mul_f32 v154, v154, v118
    v_mul_f32 v155, v155, v118
    v_mfma_f32_16x16x32_bf16 v[180:183], a[152:155], v[36:39], v[180:183]
    v_cvt_pk_bf16_f32 v144, v144, v145
    v_cvt_pk_bf16_f32 v145, v146, v147
    v_cvt_pk_bf16_f32 v146, v152, v153
    v_cvt_pk_bf16_f32 v147, v154, v155
    buffer_store_dwordx4 v[144:147], v25, s[4:7], s3 offen offset:2048 sc1
    v_mul_f32 v148, v148, v119
    v_mul_f32 v149, v149, v119
    v_mul_f32 v150, v150, v119
    v_mul_f32 v151, v151, v119
    v_mfma_f32_16x16x32_bf16 v[184:187], a[156:159], v[32:35], v[184:187]
    v_mul_f32 v156, v156, v119
    v_mul_f32 v157, v157, v119
    v_mul_f32 v158, v158, v119
    v_mul_f32 v159, v159, v119
    v_mfma_f32_16x16x32_bf16 v[188:191], a[156:159], v[36:39], v[188:191]
    v_cvt_pk_bf16_f32 v148, v148, v149
    v_cvt_pk_bf16_f32 v149, v150, v151
    v_cvt_pk_bf16_f32 v150, v156, v157
    v_cvt_pk_bf16_f32 v151, v158, v159
    buffer_store_dwordx4 v[148:151], v25, s[4:7], s3 offen offset:3072 sc1
    s_add_u32 s3, s23, 4096
    v_mul_f32 v160, v160, v118
    v_mul_f32 v161, v161, v118
    v_mul_f32 v162, v162, v118
    v_mul_f32 v163, v163, v118
    v_mfma_f32_16x16x32_bf16 v[192:195], a[160:163], v[32:35], v[192:195]
    v_mul_f32 v168, v168, v118
    v_mul_f32 v169, v169, v118
    v_mul_f32 v170, v170, v118
    v_mul_f32 v171, v171, v118
    v_mfma_f32_16x16x32_bf16 v[196:199], a[160:163], v[36:39], v[196:199]
    v_cvt_pk_bf16_f32 v160, v160, v161
    v_cvt_pk_bf16_f32 v161, v162, v163
    v_cvt_pk_bf16_f32 v162, v168, v169
    v_cvt_pk_bf16_f32 v163, v170, v171
    buffer_store_dwordx4 v[160:163], v25, s[4:7], s3 offen offset:0 sc1
    v_mul_f32 v164, v164, v119
    v_mul_f32 v165, v165, v119
    v_mul_f32 v166, v166, v119
    v_mul_f32 v167, v167, v119
    v_mfma_f32_16x16x32_bf16 v[200:203], a[164:167], v[32:35], v[200:203]
    v_mul_f32 v172, v172, v119
    v_mul_f32 v173, v173, v119
    v_mul_f32 v174, v174, v119
    v_mul_f32 v175, v175, v119
    v_mfma_f32_16x16x32_bf16 v[204:207], a[164:167], v[36:39], v[204:207]
    v_cvt_pk_bf16_f32 v164, v164, v165
    v_cvt_pk_bf16_f32 v165, v166, v167
    v_cvt_pk_bf16_f32 v166, v172, v173
    v_cvt_pk_bf16_f32 v167, v174, v175
    buffer_store_dwordx4 v[164:167], v25, s[4:7], s3 offen offset:1024 sc1
    v_mul_f32 v176, v176, v118
    v_mul_f32 v177, v177, v118
    v_mul_f32 v178, v178, v118
    v_mul_f32 v179, v179, v118
    v_mfma_f32_16x16x32_bf16 v[208:211], a[168:171], v[32:35], v[208:211]
    v_mul_f32 v184, v184, v118
    v_mul_f32 v185, v185, v118
    v_mul_f32 v186, v186, v118
    v_mul_f32 v187, v187, v118
    v_mfma_f32_16x16x32_bf16 v[212:215], a[168:171], v[36:39], v[212:215]
    v_cvt_pk_bf16_f32 v176, v176, v177
    v_cvt_pk_bf16_f32 v177, v178, v179
    v_cvt_pk_bf16_f32 v178, v184, v185
    v_cvt_pk_bf16_f32 v179, v186, v187
    buffer_store_dwordx4 v[176:179], v25, s[4:7], s3 offen offset:2048 sc1
    v_mul_f32 v180, v180, v119
    v_mul_f32 v181, v181, v119
    v_mul_f32 v182, v182, v119
    v_mul_f32 v183, v183, v119
    v_mfma_f32_16x16x32_bf16 v[216:219], a[172:175], v[32:35], v[216:219]
    v_mul_f32 v188, v188, v119
    v_mul_f32 v189, v189, v119
    v_mul_f32 v190, v190, v119
    v_mul_f32 v191, v191, v119
    v_mfma_f32_16x16x32_bf16 v[220:223], a[172:175], v[36:39], v[220:223]
    v_cvt_pk_bf16_f32 v180, v180, v181
    v_cvt_pk_bf16_f32 v181, v182, v183
    v_cvt_pk_bf16_f32 v182, v188, v189
    v_cvt_pk_bf16_f32 v183, v190, v191
    buffer_store_dwordx4 v[180:183], v25, s[4:7], s3 offen offset:3072 sc1
    s_cmp_ge_u32 s15, 2
    s_cbranch_scc0 ob_63
    s_waitcnt vmcnt(28)
    s_barrier
ob_63:
    s_add_u32 s3, s23, 8192
    v_mul_f32 v192, v192, v118
    v_mul_f32 v193, v193, v118
    v_mul_f32 v194, v194, v118
    v_mul_f32 v195, v195, v118
    v_mfma_f32_16x16x32_bf16 v[224:227], a[176:179], v[32:35], v[224:227]
    v_mul_f32 v200, v200, v118
    v_mul_f32 v201, v201, v118
    v_mul_f32 v202, v202, v118
    v_mul_f32 v203, v203, v118
    v_mfma_f32_16x16x32_bf16 v[228:231], a[176:179], v[36:39], v[228:231]
    v_cvt_pk_bf16_f32 v192, v192, v193
    v_cvt_pk_bf16_f32 v193, v194, v195
    v_cvt_pk_bf16_f32 v194, v200, v201
    v_cvt_pk_bf16_f32 v195, v202, v203
    buffer_store_dwordx4 v[192:195], v25, s[4:7], s3 offen offset:0 sc1
    v_mul_f32 v196, v196, v119
    v_mul_f32 v197, v197, v119
    v_mul_f32 v198, v198, v119
    v_mul_f32 v199, v199, v119
    v_mfma_f32_16x16x32_bf16 v[232:235], a[180:183], v[32:35], v[232:235]
    v_mul_f32 v204, v204, v119
    v_mul_f32 v205, v205, v119
    v_mul_f32 v206, v206, v119
    v_mul_f32 v207, v207, v119
    v_mfma_f32_16x16x32_bf16 v[236:239], a[180:183], v[36:39], v[236:239]
    v_cvt_pk_bf16_f32 v196, v196, v197
    v_cvt_pk_bf16_f32 v197, v198, v199
    v_cvt_pk_bf16_f32 v198, v204, v205
    v_cvt_pk_bf16_f32 v199, v206, v207
    buffer_store_dwordx4 v[196:199], v25, s[4:7], s3 offen offset:1024 sc1
    v_mul_f32 v208, v208, v118
    v_mul_f32 v209, v209, v118
    v_mul_f32 v210, v210, v118
    v_mul_f32 v211, v211, v118
    v_mfma_f32_16x16x32_bf16 v[240:243], a[184:187], v[32:35], v[240:243]
    v_mul_f32 v216, v216, v118
    v_mul_f32 v217, v217, v118
    v_mul_f32 v218, v218, v118
    v_mul_f32 v219, v219, v118
    v_mfma_f32_16x16x32_bf16 v[244:247], a[184:187], v[36:39], v[244:247]
    v_cvt_pk_bf16_f32 v208, v208, v209
    v_cvt_pk_bf16_f32 v209, v210, v211
    v_cvt_pk_bf16_f32 v210, v216, v217
    v_cvt_pk_bf16_f32 v211, v218, v219
    buffer_store_dwordx4 v[208:211], v25, s[4:7], s3 offen offset:2048 sc1
    v_mul_f32 v212, v212, v119
    v_mul_f32 v213, v213, v119
    v_mul_f32 v214, v214, v119
    v_mul_f32 v215, v215, v119
    v_mfma_f32_16x16x32_bf16 v[248:251], a[188:191], v[32:35], v[248:251]
    v_mul_f32 v220, v220, v119
    v_mul_f32 v221, v221, v119
    v_mul_f32 v222, v222, v119
    v_mul_f32 v223, v223, v119
    v_mfma_f32_16x16x32_bf16 v[252:255], a[188:191], v[36:39], v[252:255]
    v_cvt_pk_bf16_f32 v212, v212, v213
    v_cvt_pk_bf16_f32 v213, v214, v215
    v_cvt_pk_bf16_f32 v214, v220, v221
    v_cvt_pk_bf16_f32 v215, v222, v223
    buffer_store_dwordx4 v[212:215], v25, s[4:7], s3 offen offset:3072 sc1
    s_add_u32 s3, s23, 12288
    v_mul_f32 v224, v224, v118
    v_mul_f32 v225, v225, v118
    v_mul_f32 v226, v226, v118
    v_mul_f32 v227, v227, v118
    v_mul_f32 v232, v232, v118
    v_mul_f32 v233, v233, v118
    v_mul_f32 v234, v234, v118
    v_mul_f32 v235, v235, v118
    v_cvt_pk_bf16_f32 v224, v224, v225
    v_cvt_pk_bf16_f32 v225, v226, v227
    v_cvt_pk_bf16_f32 v226, v232, v233
    v_cvt_pk_bf16_f32 v227, v234, v235
    buffer_store_dwordx4 v[224:227], v25, s[4:7], s3 offen offset:0 sc1
    v_mul_f32 v228, v228, v119
    v_mul_f32 v229, v229, v119
    v_mul_f32 v230, v230, v119
    v_mul_f32 v231, v231, v119
    v_mul_f32 v236, v236, v119
    v_mul_f32 v237, v237, v119
    v_mul_f32 v238, v238, v119
    v_mul_f32 v239, v239, v119
    v_cvt_pk_bf16_f32 v228, v228, v229
    v_cvt_pk_bf16_f32 v229, v230, v231
    v_cvt_pk_bf16_f32 v230, v236, v237
    v_cvt_pk_bf16_f32 v231, v238, v239
    buffer_store_dwordx4 v[228:231], v25, s[4:7], s3 offen offset:1024 sc1
    v_mul_f32 v240, v240, v118
    v_mul_f32 v241, v241, v118
    v_mul_f32 v242, v242, v118
    v_mul_f32 v243, v243, v118
    v_mul_f32 v248, v248, v118
    v_mul_f32 v249, v249, v118
    v_mul_f32 v250, v250, v118
    v_mul_f32 v251, v251, v118
    v_cvt_pk_bf16_f32 v240, v240, v241
    v_cvt_pk_bf16_f32 v241, v242, v243
    v_cvt_pk_bf16_f32 v242, v248, v249
    v_cvt_pk_bf16_f32 v243, v250, v251
    buffer_store_dwordx4 v[240:243], v25, s[4:7], s3 offen offset:2048 sc1
    v_mul_f32 v244, v244, v119
    v_mul_f32 v245, v245, v119
    v_mul_f32 v246, v246, v119
    v_mul_f32 v247, v247, v119
    v_mul_f32 v252, v252, v119
    v_mul_f32 v253, v253, v119
    v_mul_f32 v254, v254, v119
    v_mul_f32 v255, v255, v119
    v_cvt_pk_bf16_f32 v244, v244, v245
    v_cvt_pk_bf16_f32 v245, v246, v247
    v_cvt_pk_bf16_f32 v246, v252, v253
    v_cvt_pk_bf16_f32 v247, v254, v255
    buffer_store_dwordx4 v[244:247], v25, s[4:7], s3 offen offset:3072 sc1
    s_cmp_ge_u32 s15, 3
    s_cbranch_scc0 ob_64
    s_waitcnt vmcnt(32)
    s_barrier
ob_64:
at_done:
    s_waitcnt vmcnt(16)
    s_barrier
    s_bitcmp1_b32 s2, 0
    s_cbranch_scc1 ou_odd
    ds_read_b64_tr_b16 a[0:1], v17 offset:0
    ds_read_b64_tr_b16 a[2:3], v17 offset:8192
    ds_read_b64_tr_b16 a[4:5], v18 offset:0
    ds_read_b64_tr_b16 a[6:7], v18 offset:8192
    ds_read_b64_tr_b16 a[8:9], v19 offset:0
    ds_read_b64_tr_b16 a[10:11], v19 offset:8192
    ds_read_b64_tr_b16 a[12:13], v20 offset:0
    ds_read_b64_tr_b16 a[14:15], v20 offset:8192
    s_mov_b32 s12, s42
    s_mov_b32 s13, s43
    s_mov_b32 s14, 3670016
    s_mov_b32 s15, 0x20000
    s_waitcnt lgkmcnt(4)
    v_mfma_f32_16x16x32_bf16 v[32:35], a[0:3], a[196:199], 0
    ds_read_b64_tr_b16 a[16:17], v26 offset:0
    v_add_u32 v5, 0x10000, v17
    v_mfma_f32_16x16x32_bf16 v[36:39], a[0:3], a[200:203], 0
    ds_read_b64_tr_b16 a[18:19], v26 offset:8192
    s_add_u32 s70, s44, 57344
    v_mfma_f32_16x16x32_bf16 v[44:47], a[4:7], a[200:203], 0
    ds_read_b64_tr_b16 a[20:21], v27 offset:0
    s_add_u32 m0, s32, 32768
    v_mfma_f32_16x16x32_bf16 v[40:43], a[4:7], a[196:199], 0
    ds_read_b64_tr_b16 a[22:23], v27 offset:8192
    s_waitcnt lgkmcnt(4)
    v_mfma_f32_16x16x32_bf16 v[48:51], a[8:11], a[196:199], 0
    ds_read_b64_tr_b16 a[24:25], v28 offset:0
    buffer_load_dwordx4 v21, s[16:19], s70 offen offset:0 sc1 lds
    v_mfma_f32_16x16x32_bf16 v[52:55], a[8:11], a[200:203], 0
    ds_read_b64_tr_b16 a[26:27], v28 offset:8192
    v_add_u32 v6, 0x10000, v18
    v_mfma_f32_16x16x32_bf16 v[60:63], a[12:15], a[200:203], 0
    ds_read_b64_tr_b16 a[28:29], v29 offset:0
    buffer_load_dwordx4 v22, s[16:19], s70 offen offset:1024 sc1 lds
    v_mfma_f32_16x16x32_bf16 v[56:59], a[12:15], a[196:199], 0
    ds_read_b64_tr_b16 a[30:31], v29 offset:8192
    s_waitcnt lgkmcnt(4)
    v_mfma_f32_16x16x32_bf16 v[64:67], a[16:19], a[196:199], 0
    ds_read_b64_tr_b16 a[0:1], v17 offset:256
    buffer_load_dwordx4 v23, s[16:19], s70 offen offset:2048 sc1 lds
    v_mfma_f32_16x16x32_bf16 v[68:71], a[16:19], a[200:203], 0
    ds_read_b64_tr_b16 a[2:3], v17 offset:8448
    v_mfma_f32_16x16x32_bf16 v[76:79], a[20:23], a[200:203], 0
    ds_read_b64_tr_b16 a[4:5], v18 offset:256
    buffer_load_dwordx4 v24, s[16:19], s70 offen offset:3072 sc1 lds
    v_mfma_f32_16x16x32_bf16 v[72:75], a[20:23], a[196:199], 0
    ds_read_b64_tr_b16 a[6:7], v18 offset:8448
    s_waitcnt lgkmcnt(4)
    v_mfma_f32_16x16x32_bf16 v[80:83], a[24:27], a[196:199], 0
    ds_read_b64_tr_b16 a[8:9], v19 offset:256
    v_add_u32 v7, 0x10000, v19
    v_mfma_f32_16x16x32_bf16 v[84:87], a[24:27], a[200:203], 0
    ds_read_b64_tr_b16 a[10:11], v19 offset:8448
    s_add_u32 s70, s44, 86016
    v_mfma_f32_16x16x32_bf16 v[92:95], a[28:31], a[200:203], 0
    ds_read_b64_tr_b16 a[12:13], v20 offset:256
    s_add_u32 m0, s32, 49152
    v_mfma_f32_16x16x32_bf16 v[88:91], a[28:31], a[196:199], 0
    ds_read_b64_tr_b16 a[14:15], v20 offset:8448
    s_waitcnt lgkmcnt(4)
    v_mfma_f32_16x16x32_bf16 v[96:99], a[0:3], a[196:199], 0
    ds_read_b64_tr_b16 a[16:17], v26 offset:256
    buffer_load_dwordx4 v21, s[16:19], s70 offen offset:0 sc1 lds
    v_mfma_f32_16x16x32_bf16 v[100:103], a[0:3], a[200:203], 0
    ds_read_b64_tr_b16 a[18:19], v26 offset:8448
    v_add_u32 v8, 0x10000, v20
    v_mfma_f32_16x16x32_bf16 v[108:111], a[4:7], a[200:203], 0
    ds_read_b64_tr_b16 a[20:21], v27 offset:256
    buffer_load_dwordx4 v22, s[16:19], s70 offen offset:1024 sc1 lds
    v_mfma_f32_16x16x32_bf16 v[104:107], a[4:7], a[196:199], 0
    ds_read_b64_tr_b16 a[22:23], v27 offset:8448
    s_waitcnt lgkmcnt(4)
    v_mfma_f32_16x16x32_bf16 v[112:115], a[8:11], a[196:199], 0
    ds_read_b64_tr_b16 a[24:25], v17 offset:16384
    buffer_load_dwordx4 v23, s[16:19], s70 offen offset:2048 sc1 lds
    v_mfma_f32_16x16x32_bf16 v[116:119], a[8:11], a[200:203], 0
    ds_read_b64_tr_b16 a[26:27], v17 offset:24576
    v_mfma_f32_16x16x32_bf16 v[124:127], a[12:15], a[200:203], 0
    ds_read_b64_tr_b16 a[28:29], v18 offset:16384
    buffer_load_dwordx4 v24, s[16:19], s70 offen offset:3072 sc1 lds
    v_mfma_f32_16x16x32_bf16 v[120:123], a[12:15], a[196:199], 0
    ds_read_b64_tr_b16 a[30:31], v18 offset:24576
    s_waitcnt lgkmcnt(4)
    v_mfma_f32_16x16x32_bf16 v[136:139], a[16:19], a[196:199], 0
    ds_read_b64_tr_b16 a[0:1], v19 offset:16384
    v_add_u32 v9, 0x10000, v26
    v_mfma_f32_16x16x32_bf16 v[140:143], a[16:19], a[200:203], 0
    ds_read_b64_tr_b16 a[2:3], v19 offset:24576
    s_add_u32 s70, s45, 0
    v_mfma_f32_16x16x32_bf16 v[156:159], a[20:23], a[200:203], 0
    ds_read_b64_tr_b16 a[4:5], v20 offset:16384
    s_add_u32 m0, s32, 65536
    v_mfma_f32_16x16x32_bf16 v[152:155], a[20:23], a[196:199], 0
    ds_read_b64_tr_b16 a[6:7], v20 offset:24576
    s_waitcnt lgkmcnt(4)
    v_mfma_f32_16x16x32_bf16 v[32:35], a[24:27], a[204:207], v[32:35]
    ds_read_b64_tr_b16 a[8:9], v26 offset:16384
    buffer_load_dwordx4 v21, s[16:19], s70 offen offset:0 sc1 lds
    v_mfma_f32_16x16x32_bf16 v[36:39], a[24:27], a[208:211], v[36:39]
    ds_read_b64_tr_b16 a[10:11], v26 offset:24576
    v_add_u32 v10, 0x10000, v27
    v_mfma_f32_16x16x32_bf16 v[44:47], a[28:31], a[208:211], v[44:47]
    ds_read_b64_tr_b16 a[12:13], v27 offset:16384
    buffer_load_dwordx4 v22, s[16:19], s70 offen offset:1024 sc1 lds
    v_mfma_f32_16x16x32_bf16 v[40:43], a[28:31], a[204:207], v[40:43]
    ds_read_b64_tr_b16 a[14:15], v27 offset:24576
    s_waitcnt lgkmcnt(4)
    v_mfma_f32_16x16x32_bf16 v[48:51], a[0:3], a[204:207], v[48:51]
    ds_read_b64_tr_b16 a[16:17], v28 offset:16384
    buffer_load_dwordx4 v23, s[16:19], s70 offen offset:2048 sc1 lds
    v_mfma_f32_16x16x32_bf16 v[52:55], a[0:3], a[208:211], v[52:55]
    ds_read_b64_tr_b16 a[18:19], v28 offset:24576
    buffer_load_dwordx4 v24, s[16:19], s70 offen offset:3072 sc1 lds
    v_mfma_f32_16x16x32_bf16 v[60:63], a[4:7], a[208:211], v[60:63]
    ds_read_b64_tr_b16 a[20:21], v29 offset:16384
    v_mfma_f32_16x16x32_bf16 v[56:59], a[4:7], a[204:207], v[56:59]
    ds_read_b64_tr_b16 a[22:23], v29 offset:24576
    s_waitcnt lgkmcnt(4)
    v_mfma_f32_16x16x32_bf16 v[64:67], a[8:11], a[204:207], v[64:67]
    ds_read_b64_tr_b16 a[24:25], v17 offset:16640
    v_add_u32 v11, 0x10000, v28
    v_mfma_f32_16x16x32_bf16 v[68:71], a[8:11], a[208:211], v[68:71]
    ds_read_b64_tr_b16 a[26:27], v17 offset:24832
    s_add_u32 s70, s45, 28672
    v_mfma_f32_16x16x32_bf16 v[76:79], a[12:15], a[208:211], v[76:79]
    ds_read_b64_tr_b16 a[28:29], v18 offset:16640
    s_add_u32 m0, s32, 81920
    v_mfma_f32_16x16x32_bf16 v[72:75], a[12:15], a[204:207], v[72:75]
    ds_read_b64_tr_b16 a[30:31], v18 offset:24832
    s_waitcnt lgkmcnt(4)
    v_mfma_f32_16x16x32_bf16 v[80:83], a[16:19], a[204:207], v[80:83]
    ds_read_b64_tr_b16 a[0:1], v19 offset:16640
    buffer_load_dwordx4 v21, s[16:19], s70 offen offset:0 sc1 lds
    v_mfma_f32_16x16x32_bf16 v[84:87], a[16:19], a[208:211], v[84:87]
    ds_read_b64_tr_b16 a[2:3], v19 offset:24832
    v_add_u32 v12, 0x10000, v29
    v_mfma_f32_16x16x32_bf16 v[92:95], a[20:23], a[208:211], v[92:95]
    ds_read_b64_tr_b16 a[4:5], v20 offset:16640
    buffer_load_dwordx4 v22, s[16:19], s70 offen offset:1024 sc1 lds
    v_mfma_f32_16x16x32_bf16 v[88:91], a[20:23], a[204:207], v[88:91]
    ds_read_b64_tr_b16 a[6:7], v20 offset:24832
    s_waitcnt lgkmcnt(4)
    v_mfma_f32_16x16x32_bf16 v[96:99], a[24:27], a[204:207], v[96:99]
    ds_read_b64_tr_b16 a[8:9], v26 offset:16640
    buffer_load_dwordx4 v23, s[16:19], s70 offen offset:2048 sc1 lds
    v_mfma_f32_16x16x32_bf16 v[100:103], a[24:27], a[208:211], v[100:103]
    ds_read_b64_tr_b16 a[10:11], v26 offset:24832
    buffer_load_dwordx4 v24, s[16:19], s70 offen offset:3072 sc1 lds
    v_mfma_f32_16x16x32_bf16 v[108:111], a[28:31], a[208:211], v[108:111]
    ds_read_b64_tr_b16 a[12:13], v27 offset:16640
    v_mfma_f32_16x16x32_bf16 v[104:107], a[28:31], a[204:207], v[104:107]
    ds_read_b64_tr_b16 a[14:15], v27 offset:24832
    s_waitcnt vmcnt(8)
    s_barrier
    s_waitcnt lgkmcnt(4)
    v_mfma_f32_16x16x32_bf16 v[112:115], a[0:3], a[204:207], v[112:115]
    ds_read_b64_tr_b16 a[16:17], v17 offset:32768
    v_mfma_f32_16x16x32_bf16 v[116:119], a[0:3], a[208:211], v[116:119]
    ds_read_b64_tr_b16 a[18:19], v17 offset:40960
    s_add_u32 s70, s45, 57344
    v_mfma_f32_16x16x32_bf16 v[124:127], a[4:7], a[208:211], v[124:127]
    ds_read_b64_tr_b16 a[20:21], v18 offset:32768
    v_mfma_f32_16x16x32_bf16 v[120:123], a[4:7], a[204:207], v[120:123]
    ds_read_b64_tr_b16 a[22:23], v18 offset:40960
    s_waitcnt lgkmcnt(4)
    v_mfma_f32_16x16x32_bf16 v[136:139], a[8:11], a[204:207], v[136:139]
    ds_read_b64_tr_b16 a[24:25], v19 offset:32768
    s_add_u32 m0, s32, 98304
    v_mfma_f32_16x16x32_bf16 v[140:143], a[8:11], a[208:211], v[140:143]
    ds_read_b64_tr_b16 a[26:27], v19 offset:40960
    v_mfma_f32_16x16x32_bf16 v[156:159], a[12:15], a[208:211], v[156:159]
    ds_read_b64_tr_b16 a[28:29], v20 offset:32768
    v_mfma_f32_16x16x32_bf16 v[152:155], a[12:15], a[204:207], v[152:155]
    ds_read_b64_tr_b16 a[30:31], v20 offset:40960
    s_waitcnt lgkmcnt(4)
    v_mfma_f32_16x16x32_bf16 v[32:35], a[16:19], a[212:215], v[32:35]
    ds_read_b64_tr_b16 a[0:1], v26 offset:32768
    buffer_load_dwordx4 v21, s[16:19], s70 offen offset:0 sc1 lds
    v_mfma_f32_16x16x32_bf16 v[36:39], a[16:19], a[216:219], v[36:39]
    ds_read_b64_tr_b16 a[2:3], v26 offset:40960
    v_mfma_f32_16x16x32_bf16 v[44:47], a[20:23], a[216:219], v[44:47]
    ds_read_b64_tr_b16 a[4:5], v27 offset:32768
    buffer_load_dwordx4 v22, s[16:19], s70 offen offset:1024 sc1 lds
    v_mfma_f32_16x16x32_bf16 v[40:43], a[20:23], a[212:215], v[40:43]
    ds_read_b64_tr_b16 a[6:7], v27 offset:40960
    s_waitcnt lgkmcnt(4)
    v_mfma_f32_16x16x32_bf16 v[48:51], a[24:27], a[212:215], v[48:51]
    ds_read_b64_tr_b16 a[8:9], v28 offset:32768
    v_mfma_f32_16x16x32_bf16 v[52:55], a[24:27], a[216:219], v[52:55]
    ds_read_b64_tr_b16 a[10:11], v28 offset:40960
    buffer_load_dwordx4 v23, s[16:19], s70 offen offset:2048 sc1 lds
    v_mfma_f32_16x16x32_bf16 v[60:63], a[28:31], a[216:219], v[60:63]
    ds_read_b64_tr_b16 a[12:13], v29 offset:32768
    v_mfma_f32_16x16x32_bf16 v[56:59], a[28:31], a[212:215], v[56:59]
    ds_read_b64_tr_b16 a[14:15], v29 offset:40960
    s_waitcnt lgkmcnt(4)
    v_mfma_f32_16x16x32_bf16 v[64:67], a[0:3], a[212:215], v[64:67]
    ds_read_b64_tr_b16 a[16:17], v17 offset:33024
    buffer_load_dwordx4 v24, s[16:19], s70 offen offset:3072 sc1 lds
    v_mfma_f32_16x16x32_bf16 v[68:71], a[0:3], a[216:219], v[68:71]
    ds_read_b64_tr_b16 a[18:19], v17 offset:41216
    v_mfma_f32_16x16x32_bf16 v[76:79], a[4:7], a[216:219], v[76:79]
    ds_read_b64_tr_b16 a[20:21], v18 offset:33024
    v_mfma_f32_16x16x32_bf16 v[72:75], a[4:7], a[212:215], v[72:75]
    ds_read_b64_tr_b16 a[22:23], v18 offset:41216
    s_waitcnt lgkmcnt(4)
    v_mfma_f32_16x16x32_bf16 v[80:83], a[8:11], a[212:215], v[80:83]
    ds_read_b64_tr_b16 a[24:25], v19 offset:33024
    s_add_u32 s70, s45, 86016
    v_mfma_f32_16x16x32_bf16 v[84:87], a[8:11], a[216:219], v[84:87]
    ds_read_b64_tr_b16 a[26:27], v19 offset:41216
    v_mfma_f32_16x16x32_bf16 v[92:95], a[12:15], a[216:219], v[92:95]
    ds_read_b64_tr_b16 a[28:29], v20 offset:33024
    s_add_u32 m0, s32, 114688
    v_mfma_f32_16x16x32_bf16 v[88:91], a[12:15], a[212:215], v[88:91]
    ds_read_b64_tr_b16 a[30:31], v20 offset:41216
    s_waitcnt lgkmcnt(4)
    v_mfma_f32_16x16x32_bf16 v[96:99], a[16:19], a[212:215], v[96:99]
    ds_read_b64_tr_b16 a[0:1], v26 offset:33024
    v_mfma_f32_16x16x32_bf16 v[100:103], a[16:19], a[216:219], v[100:103]
    ds_read_b64_tr_b16 a[2:3], v26 offset:41216
    buffer_load_dwordx4 v21, s[16:19], s70 offen offset:0 sc1 lds
    v_mfma_f32_16x16x32_bf16 v[108:111], a[20:23], a[216:219], v[108:111]
    ds_read_b64_tr_b16 a[4:5], v27 offset:33024
    v_mfma_f32_16x16x32_bf16 v[104:107], a[20:23], a[212:215], v[104:107]
    ds_read_b64_tr_b16 a[6:7], v27 offset:41216
    s_waitcnt lgkmcnt(4)
    v_mfma_f32_16x16x32_bf16 v[112:115], a[24:27], a[212:215], v[112:115]
    ds_read_b64_tr_b16 a[8:9], v17 offset:49152
    buffer_load_dwordx4 v22, s[16:19], s70 offen offset:1024 sc1 lds
    v_mfma_f32_16x16x32_bf16 v[116:119], a[24:27], a[216:219], v[116:119]
    ds_read_b64_tr_b16 a[10:11], v17 offset:57344
    v_mfma_f32_16x16x32_bf16 v[124:127], a[28:31], a[216:219], v[124:127]
    ds_read_b64_tr_b16 a[12:13], v18 offset:49152
    v_mfma_f32_16x16x32_bf16 v[120:123], a[28:31], a[212:215], v[120:123]
    ds_read_b64_tr_b16 a[14:15], v18 offset:57344
    s_waitcnt lgkmcnt(4)
    v_mfma_f32_16x16x32_bf16 v[136:139], a[0:3], a[212:215], v[136:139]
    ds_read_b64_tr_b16 a[16:17], v19 offset:49152
    buffer_load_dwordx4 v23, s[16:19], s70 offen offset:2048 sc1 lds
    v_mfma_f32_16x16x32_bf16 v[140:143], a[0:3], a[216:219], v[140:143]
    ds_read_b64_tr_b16 a[18:19], v19 offset:57344
    v_mfma_f32_16x16x32_bf16 v[156:159], a[4:7], a[216:219], v[156:159]
    ds_read_b64_tr_b16 a[20:21], v20 offset:49152
    buffer_load_dwordx4 v24, s[16:19], s70 offen offset:3072 sc1 lds
    v_mfma_f32_16x16x32_bf16 v[152:155], a[4:7], a[212:215], v[152:155]
    ds_read_b64_tr_b16 a[22:23], v20 offset:57344
    s_waitcnt lgkmcnt(4)
    v_mfma_f32_16x16x32_bf16 v[32:35], a[8:11], a[220:223], v[32:35]
    ds_read_b64_tr_b16 a[24:25], v26 offset:49152
    v_mfma_f32_16x16x32_bf16 v[36:39], a[8:11], a[224:227], v[36:39]
    ds_read_b64_tr_b16 a[26:27], v26 offset:57344
    s_add_u32 s70, s46, 0
    v_mfma_f32_16x16x32_bf16 v[44:47], a[12:15], a[224:227], v[44:47]
    ds_read_b64_tr_b16 a[28:29], v27 offset:49152
    v_mfma_f32_16x16x32_bf16 v[40:43], a[12:15], a[220:223], v[40:43]
    ds_read_b64_tr_b16 a[30:31], v27 offset:57344
    s_waitcnt lgkmcnt(4)
    v_mfma_f32_16x16x32_bf16 v[48:51], a[16:19], a[220:223], v[48:51]
    ds_read_b64_tr_b16 a[0:1], v28 offset:49152
    s_add_u32 m0, s32, 0
    v_mfma_f32_16x16x32_bf16 v[52:55], a[16:19], a[224:227], v[52:55]
    ds_read_b64_tr_b16 a[2:3], v28 offset:57344
    v_mfma_f32_16x16x32_bf16 v[60:63], a[20:23], a[224:227], v[60:63]
    ds_read_b64_tr_b16 a[4:5], v29 offset:49152
    v_mfma_f32_16x16x32_bf16 v[56:59], a[20:23], a[220:223], v[56:59]
    ds_read_b64_tr_b16 a[6:7], v29 offset:57344
    s_waitcnt lgkmcnt(4)
    v_mfma_f32_16x16x32_bf16 v[64:67], a[24:27], a[220:223], v[64:67]
    ds_read_b64_tr_b16 a[8:9], v17 offset:49408
    buffer_load_dwordx4 v21, s[12:15], s70 offen offset:0 sc1 lds
    v_mfma_f32_16x16x32_bf16 v[68:71], a[24:27], a[224:227], v[68:71]
    ds_read_b64_tr_b16 a[10:11], v17 offset:57600
    v_mfma_f32_16x16x32_bf16 v[76:79], a[28:31], a[224:227], v[76:79]
    ds_read_b64_tr_b16 a[12:13], v18 offset:49408
    buffer_load_dwordx4 v22, s[12:15], s70 offen offset:1024 sc1 lds
    v_mfma_f32_16x16x32_bf16 v[72:75], a[28:31], a[220:223], v[72:75]
    ds_read_b64_tr_b16 a[14:15], v18 offset:57600
    s_waitcnt lgkmcnt(4)
    v_mfma_f32_16x16x32_bf16 v[80:83], a[0:3], a[220:223], v[80:83]
    ds_read_b64_tr_b16 a[16:17], v19 offset:49408
    v_mfma_f32_16x16x32_bf16 v[84:87], a[0:3], a[224:227], v[84:87]
    ds_read_b64_tr_b16 a[18:19], v19 offset:57600
    buffer_load_dwordx4 v23, s[12:15], s70 offen offset:2048 sc1 lds
    v_mfma_f32_16x16x32_bf16 v[92:95], a[4:7], a[224:227], v[92:95]
    ds_read_b64_tr_b16 a[20:21], v20 offset:49408
    v_mfma_f32_16x16x32_bf16 v[88:91], a[4:7], a[220:223], v[88:91]
    ds_read_b64_tr_b16 a[22:23], v20 offset:57600
    s_waitcnt lgkmcnt(4)
    v_mfma_f32_16x16x32_bf16 v[96:99], a[8:11], a[220:223], v[96:99]
    ds_read_b64_tr_b16 a[24:25], v26 offset:49408
    buffer_load_dwordx4 v24, s[12:15], s70 offen offset:3072 sc1 lds
    v_mfma_f32_16x16x32_bf16 v[100:103], a[8:11], a[224:227], v[100:103]
    ds_read_b64_tr_b16 a[26:27], v26 offset:57600
    v_mfma_f32_16x16x32_bf16 v[108:111], a[12:15], a[224:227], v[108:111]
    ds_read_b64_tr_b16 a[28:29], v27 offset:49408
    v_mfma_f32_16x16x32_bf16 v[104:107], a[12:15], a[220:223], v[104:107]
    ds_read_b64_tr_b16 a[30:31], v27 offset:57600
    s_waitcnt vmcnt(12)
    s_barrier
    s_cmp_eq_u32 s20, 0
    s_cbranch_scc0 sig_65
    v_mov_b32 v2, 1
    v_mov_b32 v3, 0
    s_mov_b64 exec, 1
    buffer_atomic_add v2, v3, s[4:7], s33 offen sc1
    s_mov_b64 exec, -1
sig_65:
    s_waitcnt lgkmcnt(4)
    v_mfma_f32_16x16x32_bf16 v[112:115], a[16:19], a[220:223], v[112:115]
    ds_read_b64_tr_b16 a[0:1], v5 offset:0
    v_mfma_f32_16x16x32_bf16 v[116:119], a[16:19], a[224:227], v[116:119]
    ds_read_b64_tr_b16 a[2:3], v5 offset:8192
    s_add_u32 s70, s46, 28672
    v_mfma_f32_16x16x32_bf16 v[124:127], a[20:23], a[224:227], v[124:127]
    ds_read_b64_tr_b16 a[4:5], v6 offset:0
    v_mfma_f32_16x16x32_bf16 v[120:123], a[20:23], a[220:223], v[120:123]
    ds_read_b64_tr_b16 a[6:7], v6 offset:8192
    s_waitcnt lgkmcnt(4)
    v_mfma_f32_16x16x32_bf16 v[136:139], a[24:27], a[220:223], v[136:139]
    ds_read_b64_tr_b16 a[8:9], v7 offset:0
    v_mfma_f32_16x16x32_bf16 v[140:143], a[24:27], a[224:227], v[140:143]
    ds_read_b64_tr_b16 a[10:11], v7 offset:8192
    s_add_u32 m0, s32, 16384
    v_mfma_f32_16x16x32_bf16 v[156:159], a[28:31], a[224:227], v[156:159]
    ds_read_b64_tr_b16 a[12:13], v8 offset:0
    v_mfma_f32_16x16x32_bf16 v[152:155], a[28:31], a[220:223], v[152:155]
    ds_read_b64_tr_b16 a[14:15], v8 offset:8192
    s_waitcnt lgkmcnt(4)
    v_mfma_f32_16x16x32_bf16 v[32:35], a[0:3], a[32:35], v[32:35]
    ds_read_b64_tr_b16 a[16:17], v9 offset:0
    v_mfma_f32_16x16x32_bf16 v[36:39], a[0:3], a[36:39], v[36:39]
    ds_read_b64_tr_b16 a[18:19], v9 offset:8192
    v_mfma_f32_16x16x32_bf16 v[44:47], a[4:7], a[36:39], v[44:47]
    ds_read_b64_tr_b16 a[20:21], v10 offset:0
    buffer_load_dwordx4 v21, s[12:15], s70 offen offset:0 sc1 lds
    v_mfma_f32_16x16x32_bf16 v[40:43], a[4:7], a[32:35], v[40:43]
    ds_read_b64_tr_b16 a[22:23], v10 offset:8192
    s_waitcnt lgkmcnt(4)
    v_mfma_f32_16x16x32_bf16 v[48:51], a[8:11], a[32:35], v[48:51]
    ds_read_b64_tr_b16 a[24:25], v11 offset:0
    v_mfma_f32_16x16x32_bf16 v[52:55], a[8:11], a[36:39], v[52:55]
    ds_read_b64_tr_b16 a[26:27], v11 offset:8192
    v_mfma_f32_16x16x32_bf16 v[60:63], a[12:15], a[36:39], v[60:63]
    ds_read_b64_tr_b16 a[28:29], v12 offset:0
    buffer_load_dwordx4 v22, s[12:15], s70 offen offset:1024 sc1 lds
    v_mfma_f32_16x16x32_bf16 v[56:59], a[12:15], a[32:35], v[56:59]
    ds_read_b64_tr_b16 a[30:31], v12 offset:8192
    s_waitcnt lgkmcnt(4)
    v_mfma_f32_16x16x32_bf16 v[64:67], a[16:19], a[32:35], v[64:67]
    ds_read_b64_tr_b16 a[0:1], v5 offset:256
    v_mfma_f32_16x16x32_bf16 v[68:71], a[16:19], a[36:39], v[68:71]
    ds_read_b64_tr_b16 a[2:3], v5 offset:8448
    v_mfma_f32_16x16x32_bf16 v[76:79], a[20:23], a[36:39], v[76:79]
    ds_read_b64_tr_b16 a[4:5], v6 offset:256
    v_mfma_f32_16x16x32_bf16 v[72:75], a[20:23], a[32:35], v[72:75]
    ds_read_b64_tr_b16 a[6:7], v6 offset:8448
    s_waitcnt lgkmcnt(4)
    v_mfma_f32_16x16x32_bf16 v[80:83], a[24:27], a[32:35], v[80:83]
    ds_read_b64_tr_b16 a[8:9], v7 offset:256
    buffer_load_dwordx4 v23, s[12:15], s70 offen offset:2048 sc1 lds
    v_mfma_f32_16x16x32_bf16 v[84:87], a[24:27], a[36:39], v[84:87]
    ds_read_b64_tr_b16 a[10:11], v7 offset:8448
    v_mfma_f32_16x16x32_bf16 v[92:95], a[28:31], a[36:39], v[92:95]
    ds_read_b64_tr_b16 a[12:13], v8 offset:256
    v_mfma_f32_16x16x32_bf16 v[88:91], a[28:31], a[32:35], v[88:91]
    ds_read_b64_tr_b16 a[14:15], v8 offset:8448
    s_waitcnt lgkmcnt(4)
    v_mfma_f32_16x16x32_bf16 v[96:99], a[0:3], a[32:35], v[96:99]
    ds_read_b64_tr_b16 a[16:17], v9 offset:256
    buffer_load_dwordx4 v24, s[12:15], s70 offen offset:3072 sc1 lds
    v_mfma_f32_16x16x32_bf16 v[100:103], a[0:3], a[36:39], v[100:103]
    ds_read_b64_tr_b16 a[18:19], v9 offset:8448
    v_mfma_f32_16x16x32_bf16 v[108:111], a[4:7], a[36:39], v[108:111]
    ds_read_b64_tr_b16 a[20:21], v10 offset:256
    v_mfma_f32_16x16x32_bf16 v[104:107], a[4:7], a[32:35], v[104:107]
    ds_read_b64_tr_b16 a[22:23], v10 offset:8448
    s_waitcnt lgkmcnt(4)
    v_mfma_f32_16x16x32_bf16 v[112:115], a[8:11], a[32:35], v[112:115]
    ds_read_b64_tr_b16 a[24:25], v5 offset:16384
    s_add_u32 s70, s46, 57344
    v_mfma_f32_16x16x32_bf16 v[116:119], a[8:11], a[36:39], v[116:119]
    ds_read_b64_tr_b16 a[26:27], v5 offset:24576
    v_mfma_f32_16x16x32_bf16 v[124:127], a[12:15], a[36:39], v[124:127]
    ds_read_b64_tr_b16 a[28:29], v6 offset:16384
    v_mfma_f32_16x16x32_bf16 v[120:123], a[12:15], a[32:35], v[120:123]
    ds_read_b64_tr_b16 a[30:31], v6 offset:24576
    s_waitcnt lgkmcnt(4)
    v_mfma_f32_16x16x32_bf16 v[136:139], a[16:19], a[32:35], v[136:139]
    ds_read_b64_tr_b16 a[0:1], v7 offset:16384
    s_add_u32 m0, s32, 32768
    v_mfma_f32_16x16x32_bf16 v[140:143], a[16:19], a[36:39], v[140:143]
    ds_read_b64_tr_b16 a[2:3], v7 offset:24576
    v_mfma_f32_16x16x32_bf16 v[156:159], a[20:23], a[36:39], v[156:159]
    ds_read_b64_tr_b16 a[4:5], v8 offset:16384
    v_mfma_f32_16x16x32_bf16 v[152:155], a[20:23], a[32:35], v[152:155]
    ds_read_b64_tr_b16 a[6:7], v8 offset:24576
    s_waitcnt lgkmcnt(4)
    v_mfma_f32_16x16x32_bf16 v[32:35], a[24:27], a[40:43], v[32:35]
    ds_read_b64_tr_b16 a[8:9], v9 offset:16384
    v_mfma_f32_16x16x32_bf16 v[36:39], a[24:27], a[44:47], v[36:39]
    ds_read_b64_tr_b16 a[10:11], v9 offset:24576
    buffer_load_dwordx4 v21, s[12:15], s70 offen offset:0 sc1 lds
    v_mfma_f32_16x16x32_bf16 v[44:47], a[28:31], a[44:47], v[44:47]
    ds_read_b64_tr_b16 a[12:13], v10 offset:16384
    v_mfma_f32_16x16x32_bf16 v[40:43], a[28:31], a[40:43], v[40:43]
    ds_read_b64_tr_b16 a[14:15], v10 offset:24576
    s_waitcnt lgkmcnt(4)
    v_mfma_f32_16x16x32_bf16 v[48:51], a[0:3], a[40:43], v[48:51]
    ds_read_b64_tr_b16 a[16:17], v11 offset:16384
    v_mfma_f32_16x16x32_bf16 v[52:55], a[0:3], a[44:47], v[52:55]
    ds_read_b64_tr_b16 a[18:19], v11 offset:24576
    buffer_load_dwordx4 v22, s[12:15], s70 offen offset:1024 sc1 lds
    v_mfma_f32_16x16x32_bf16 v[60:63], a[4:7], a[44:47], v[60:63]
    ds_read_b64_tr_b16 a[20:21], v12 offset:16384
    v_mfma_f32_16x16x32_bf16 v[56:59], a[4:7], a[40:43], v[56:59]
    ds_read_b64_tr_b16 a[22:23], v12 offset:24576
    s_waitcnt lgkmcnt(4)
    v_mfma_f32_16x16x32_bf16 v[64:67], a[8:11], a[40:43], v[64:67]
    ds_read_b64_tr_b16 a[24:25], v5 offset:16640
    v_mfma_f32_16x16x32_bf16 v[68:71], a[8:11], a[44:47], v[68:71]
    ds_read_b64_tr_b16 a[26:27], v5 offset:24832
    v_mfma_f32_16x16x32_bf16 v[76:79], a[12:15], a[44:47], v[76:79]
    ds_read_b64_tr_b16 a[28:29], v6 offset:16640
    buffer_load_dwordx4 v23, s[12:15], s70 offen offset:2048 sc1 lds
    v_mfma_f32_16x16x32_bf16 v[72:75], a[12:15], a[40:43], v[72:75]
    ds_read_b64_tr_b16 a[30:31], v6 offset:24832
    s_waitcnt lgkmcnt(4)
    v_mfma_f32_16x16x32_bf16 v[80:83], a[16:19], a[40:43], v[80:83]
    ds_read_b64_tr_b16 a[0:1], v7 offset:16640
    v_mfma_f32_16x16x32_bf16 v[84:87], a[16:19], a[44:47], v[84:87]
    ds_read_b64_tr_b16 a[2:3], v7 offset:24832
    v_mfma_f32_16x16x32_bf16 v[92:95], a[20:23], a[44:47], v[92:95]
    ds_read_b64_tr_b16 a[4:5], v8 offset:16640
    buffer_load_dwordx4 v24, s[12:15], s70 offen offset:3072 sc1 lds
    v_mfma_f32_16x16x32_bf16 v[88:91], a[20:23], a[40:43], v[88:91]
    ds_read_b64_tr_b16 a[6:7], v8 offset:24832
    s_waitcnt lgkmcnt(4)
    v_mfma_f32_16x16x32_bf16 v[96:99], a[24:27], a[40:43], v[96:99]
    ds_read_b64_tr_b16 a[8:9], v9 offset:16640
    v_mfma_f32_16x16x32_bf16 v[100:103], a[24:27], a[44:47], v[100:103]
    ds_read_b64_tr_b16 a[10:11], v9 offset:24832
    v_mfma_f32_16x16x32_bf16 v[108:111], a[28:31], a[44:47], v[108:111]
    ds_read_b64_tr_b16 a[12:13], v10 offset:16640
    v_mfma_f32_16x16x32_bf16 v[104:107], a[28:31], a[40:43], v[104:107]
    ds_read_b64_tr_b16 a[14:15], v10 offset:24832
    s_waitcnt vmcnt(12)
    s_barrier
    s_waitcnt lgkmcnt(4)
    v_mfma_f32_16x16x32_bf16 v[112:115], a[0:3], a[40:43], v[112:115]
    ds_read_b64_tr_b16 a[16:17], v5 offset:32768
    v_mfma_f32_16x16x32_bf16 v[116:119], a[0:3], a[44:47], v[116:119]
    ds_read_b64_tr_b16 a[18:19], v5 offset:40960
    s_add_u32 s70, s46, 86016
    v_mfma_f32_16x16x32_bf16 v[124:127], a[4:7], a[44:47], v[124:127]
    ds_read_b64_tr_b16 a[20:21], v6 offset:32768
    v_mfma_f32_16x16x32_bf16 v[120:123], a[4:7], a[40:43], v[120:123]
    ds_read_b64_tr_b16 a[22:23], v6 offset:40960
    s_waitcnt lgkmcnt(4)
    v_mfma_f32_16x16x32_bf16 v[136:139], a[8:11], a[40:43], v[136:139]
    ds_read_b64_tr_b16 a[24:25], v7 offset:32768
    v_mfma_f32_16x16x32_bf16 v[140:143], a[8:11], a[44:47], v[140:143]
    ds_read_b64_tr_b16 a[26:27], v7 offset:40960
    s_add_u32 m0, s32, 49152
    v_mfma_f32_16x16x32_bf16 v[156:159], a[12:15], a[44:47], v[156:159]
    ds_read_b64_tr_b16 a[28:29], v8 offset:32768
    v_mfma_f32_16x16x32_bf16 v[152:155], a[12:15], a[40:43], v[152:155]
    ds_read_b64_tr_b16 a[30:31], v8 offset:40960
    s_waitcnt lgkmcnt(4)
    v_mfma_f32_16x16x32_bf16 v[32:35], a[16:19], a[48:51], v[32:35]
    ds_read_b64_tr_b16 a[0:1], v9 offset:32768
    v_mfma_f32_16x16x32_bf16 v[36:39], a[16:19], a[52:55], v[36:39]
    ds_read_b64_tr_b16 a[2:3], v9 offset:40960
    buffer_load_dwordx4 v21, s[12:15], s70 offen offset:0 sc1 lds
    v_mfma_f32_16x16x32_bf16 v[44:47], a[20:23], a[52:55], v[44:47]
    ds_read_b64_tr_b16 a[4:5], v10 offset:32768
    v_mfma_f32_16x16x32_bf16 v[40:43], a[20:23], a[48:51], v[40:43]
    ds_read_b64_tr_b16 a[6:7], v10 offset:40960
    s_waitcnt lgkmcnt(4)
    v_mfma_f32_16x16x32_bf16 v[48:51], a[24:27], a[48:51], v[48:51]
    ds_read_b64_tr_b16 a[8:9], v11 offset:32768
    v_mfma_f32_16x16x32_bf16 v[52:55], a[24:27], a[52:55], v[52:55]
    ds_read_b64_tr_b16 a[10:11], v11 offset:40960
    buffer_load_dwordx4 v22, s[12:15], s70 offen offset:1024 sc1 lds
    v_mfma_f32_16x16x32_bf16 v[60:63], a[28:31], a[52:55], v[60:63]
    ds_read_b64_tr_b16 a[12:13], v12 offset:32768
    v_mfma_f32_16x16x32_bf16 v[56:59], a[28:31], a[48:51], v[56:59]
    ds_read_b64_tr_b16 a[14:15], v12 offset:40960
    s_waitcnt lgkmcnt(4)
    v_mfma_f32_16x16x32_bf16 v[64:67], a[0:3], a[48:51], v[64:67]
    ds_read_b64_tr_b16 a[16:17], v5 offset:33024
    v_mfma_f32_16x16x32_bf16 v[68:71], a[0:3], a[52:55], v[68:71]
    ds_read_b64_tr_b16 a[18:19], v5 offset:41216
    buffer_load_dwordx4 v23, s[12:15], s70 offen offset:2048 sc1 lds
    v_mfma_f32_16x16x32_bf16 v[76:79], a[4:7], a[52:55], v[76:79]
    ds_read_b64_tr_b16 a[20:21], v6 offset:33024
    v_mfma_f32_16x16x32_bf16 v[72:75], a[4:7], a[48:51], v[72:75]
    ds_read_b64_tr_b16 a[22:23], v6 offset:41216
    s_waitcnt lgkmcnt(4)
    v_mfma_f32_16x16x32_bf16 v[80:83], a[8:11], a[48:51], v[80:83]
    ds_read_b64_tr_b16 a[24:25], v7 offset:33024
    v_mfma_f32_16x16x32_bf16 v[84:87], a[8:11], a[52:55], v[84:87]
    ds_read_b64_tr_b16 a[26:27], v7 offset:41216
    buffer_load_dwordx4 v24, s[12:15], s70 offen offset:3072 sc1 lds
    v_mfma_f32_16x16x32_bf16 v[92:95], a[12:15], a[52:55], v[92:95]
    ds_read_b64_tr_b16 a[28:29], v8 offset:33024
    v_mfma_f32_16x16x32_bf16 v[88:91], a[12:15], a[48:51], v[88:91]
    ds_read_b64_tr_b16 a[30:31], v8 offset:41216
    s_waitcnt lgkmcnt(4)
    v_mfma_f32_16x16x32_bf16 v[96:99], a[16:19], a[48:51], v[96:99]
    ds_read_b64_tr_b16 a[0:1], v9 offset:33024
    v_mfma_f32_16x16x32_bf16 v[100:103], a[16:19], a[52:55], v[100:103]
    ds_read_b64_tr_b16 a[2:3], v9 offset:41216
    s_add_u32 s70, s46, 114688
    v_mfma_f32_16x16x32_bf16 v[108:111], a[20:23], a[52:55], v[108:111]
    ds_read_b64_tr_b16 a[4:5], v10 offset:33024
    v_mfma_f32_16x16x32_bf16 v[104:107], a[20:23], a[48:51], v[104:107]
    ds_read_b64_tr_b16 a[6:7], v10 offset:41216
    s_waitcnt lgkmcnt(4)
    v_mfma_f32_16x16x32_bf16 v[112:115], a[24:27], a[48:51], v[112:115]
    ds_read_b64_tr_b16 a[8:9], v5 offset:49152
    v_mfma_f32_16x16x32_bf16 v[116:119], a[24:27], a[52:55], v[116:119]
    ds_read_b64_tr_b16 a[10:11], v5 offset:57344
    v_mfma_f32_16x16x32_bf16 v[124:127], a[28:31], a[52:55], v[124:127]
    ds_read_b64_tr_b16 a[12:13], v6 offset:49152
    s_add_u32 m0, s32, 65536
    v_mfma_f32_16x16x32_bf16 v[120:123], a[28:31], a[48:51], v[120:123]
    ds_read_b64_tr_b16 a[14:15], v6 offset:57344
    s_waitcnt lgkmcnt(4)
    v_mfma_f32_16x16x32_bf16 v[136:139], a[0:3], a[48:51], v[136:139]
    ds_read_b64_tr_b16 a[16:17], v7 offset:49152
    v_mfma_f32_16x16x32_bf16 v[140:143], a[0:3], a[52:55], v[140:143]
    ds_read_b64_tr_b16 a[18:19], v7 offset:57344
    v_mfma_f32_16x16x32_bf16 v[156:159], a[4:7], a[52:55], v[156:159]
    ds_read_b64_tr_b16 a[20:21], v8 offset:49152
    buffer_load_dwordx4 v21, s[12:15], s70 offen offset:0 sc1 lds
    v_mfma_f32_16x16x32_bf16 v[152:155], a[4:7], a[48:51], v[152:155]
    ds_read_b64_tr_b16 a[22:23], v8 offset:57344
    s_waitcnt lgkmcnt(4)
    v_mfma_f32_16x16x32_bf16 v[32:35], a[8:11], a[56:59], v[32:35]
    ds_read_b64_tr_b16 a[24:25], v9 offset:49152
    v_mfma_f32_16x16x32_bf16 v[36:39], a[8:11], a[60:63], v[36:39]
    ds_read_b64_tr_b16 a[26:27], v9 offset:57344
    v_mfma_f32_16x16x32_bf16 v[44:47], a[12:15], a[60:63], v[44:47]
    ds_read_b64_tr_b16 a[28:29], v10 offset:49152
    buffer_load_dwordx4 v22, s[12:15], s70 offen offset:1024 sc1 lds
    v_mfma_f32_16x16x32_bf16 v[40:43], a[12:15], a[56:59], v[40:43]
    ds_read_b64_tr_b16 a[30:31], v10 offset:57344
    s_waitcnt lgkmcnt(4)
    v_mfma_f32_16x16x32_bf16 v[48:51], a[16:19], a[56:59], v[48:51]
    ds_read_b64_tr_b16 a[0:1], v11 offset:49152
    v_mfma_f32_16x16x32_bf16 v[52:55], a[16:19], a[60:63], v[52:55]
    ds_read_b64_tr_b16 a[2:3], v11 offset:57344
    v_mfma_f32_16x16x32_bf16 v[60:63], a[20:23], a[60:63], v[60:63]
    ds_read_b64_tr_b16 a[4:5], v12 offset:49152
    buffer_load_dwordx4 v23, s[12:15], s70 offen offset:2048 sc1 lds
    v_mfma_f32_16x16x32_bf16 v[56:59], a[20:23], a[56:59], v[56:59]
    ds_read_b64_tr_b16 a[6:7], v12 offset:57344
    s_waitcnt lgkmcnt(4)
    v_mfma_f32_16x16x32_bf16 v[64:67], a[24:27], a[56:59], v[64:67]
    ds_read_b64_tr_b16 a[8:9], v5 offset:49408
    v_mfma_f32_16x16x32_bf16 v[68:71], a[24:27], a[60:63], v[68:71]
    ds_read_b64_tr_b16 a[10:11], v5 offset:57600
    v_mfma_f32_16x16x32_bf16 v[76:79], a[28:31], a[60:63], v[76:79]
    ds_read_b64_tr_b16 a[12:13], v6 offset:49408
    buffer_load_dwordx4 v24, s[12:15], s70 offen offset:3072 sc1 lds
    v_mfma_f32_16x16x32_bf16 v[72:75], a[28:31], a[56:59], v[72:75]
    ds_read_b64_tr_b16 a[14:15], v6 offset:57600
    s_waitcnt lgkmcnt(4)
    v_mfma_f32_16x16x32_bf16 v[80:83], a[0:3], a[56:59], v[80:83]
    ds_read_b64_tr_b16 a[16:17], v7 offset:49408
    v_mfma_f32_16x16x32_bf16 v[84:87], a[0:3], a[60:63], v[84:87]
    ds_read_b64_tr_b16 a[18:19], v7 offset:57600
    v_mfma_f32_16x16x32_bf16 v[92:95], a[4:7], a[60:63], v[92:95]
    ds_read_b64_tr_b16 a[20:21], v8 offset:49408
    buffer_load_dword v16, off, s[4:7], s34 sc1
    v_mfma_f32_16x16x32_bf16 v[88:91], a[4:7], a[56:59], v[88:91]
    ds_read_b64_tr_b16 a[22:23], v8 offset:57600
    s_waitcnt lgkmcnt(4)
    v_mfma_f32_16x16x32_bf16 v[96:99], a[8:11], a[56:59], v[96:99]
    ds_read_b64_tr_b16 a[24:25], v9 offset:49408
    v_mfma_f32_16x16x32_bf16 v[100:103], a[8:11], a[60:63], v[100:103]
    ds_read_b64_tr_b16 a[26:27], v9 offset:57600
    v_mfma_f32_16x16x32_bf16 v[108:111], a[12:15], a[60:63], v[108:111]
    ds_read_b64_tr_b16 a[28:29], v10 offset:49408
    v_mfma_f32_16x16x32_bf16 v[104:107], a[12:15], a[56:59], v[104:107]
    ds_read_b64_tr_b16 a[30:31], v10 offset:57600
    s_waitcnt vmcnt(13)
    s_barrier
    s_waitcnt lgkmcnt(4)
    v_mfma_f32_16x16x32_bf16 v[112:115], a[16:19], a[56:59], v[112:115]
    ds_read_b64_tr_b16 a[0:1], v17 offset:0
    v_mfma_f32_16x16x32_bf16 v[116:119], a[16:19], a[60:63], v[116:119]
    ds_read_b64_tr_b16 a[2:3], v17 offset:8192
    s_add_u32 s70, s46, 143360
    v_mfma_f32_16x16x32_bf16 v[124:127], a[20:23], a[60:63], v[124:127]
    ds_read_b64_tr_b16 a[4:5], v18 offset:0
    v_mfma_f32_16x16x32_bf16 v[120:123], a[20:23], a[56:59], v[120:123]
    ds_read_b64_tr_b16 a[6:7], v18 offset:8192
    s_waitcnt lgkmcnt(4)
    v_mfma_f32_16x16x32_bf16 v[136:139], a[24:27], a[56:59], v[136:139]
    ds_read_b64_tr_b16 a[8:9], v19 offset:0
    v_mfma_f32_16x16x32_bf16 v[140:143], a[24:27], a[60:63], v[140:143]
    ds_read_b64_tr_b16 a[10:11], v19 offset:8192
    s_add_u32 m0, s32, 81920
    v_mfma_f32_16x16x32_bf16 v[156:159], a[28:31], a[60:63], v[156:159]
    ds_read_b64_tr_b16 a[12:13], v20 offset:0
    v_mfma_f32_16x16x32_bf16 v[152:155], a[28:31], a[56:59], v[152:155]
    ds_read_b64_tr_b16 a[14:15], v20 offset:8192
    s_waitcnt lgkmcnt(4)
    v_mfma_f32_16x16x32_bf16 v[32:35], a[0:3], v[128:131], v[32:35]
    ds_read_b64_tr_b16 a[16:17], v26 offset:0
    v_mfma_f32_16x16x32_bf16 v[36:39], a[0:3], v[132:135], v[36:39]
    ds_read_b64_tr_b16 a[18:19], v26 offset:8192
    v_mfma_f32_16x16x32_bf16 v[44:47], a[4:7], v[132:135], v[44:47]
    ds_read_b64_tr_b16 a[20:21], v27 offset:0
    buffer_load_dwordx4 v21, s[12:15], s70 offen offset:0 sc1 lds
    v_mfma_f32_16x16x32_bf16 v[40:43], a[4:7], v[128:131], v[40:43]
    ds_read_b64_tr_b16 a[22:23], v27 offset:8192
    s_waitcnt lgkmcnt(4)
    v_mfma_f32_16x16x32_bf16 v[48:51], a[8:11], v[128:131], v[48:51]
    ds_read_b64_tr_b16 a[24:25], v28 offset:0
    v_mfma_f32_16x16x32_bf16 v[52:55], a[8:11], v[132:135], v[52:55]
    ds_read_b64_tr_b16 a[26:27], v28 offset:8192
    v_mfma_f32_16x16x32_bf16 v[60:63], a[12:15], v[132:135], v[60:63]
    ds_read_b64_tr_b16 a[28:29], v29 offset:0
    buffer_load_dwordx4 v22, s[12:15], s70 offen offset:1024 sc1 lds
    v_mfma_f32_16x16x32_bf16 v[56:59], a[12:15], v[128:131], v[56:59]
    ds_read_b64_tr_b16 a[30:31], v29 offset:8192
    s_waitcnt lgkmcnt(4)
    v_mfma_f32_16x16x32_bf16 v[64:67], a[16:19], v[128:131], v[64:67]
    ds_read_b64_tr_b16 a[0:1], v17 offset:256
    v_mfma_f32_16x16x32_bf16 v[68:71], a[16:19], v[132:135], v[68:71]
    ds_read_b64_tr_b16 a[2:3], v17 offset:8448
    v_mfma_f32_16x16x32_bf16 v[76:79], a[20:23], v[132:135], v[76:79]
    ds_read_b64_tr_b16 a[4:5], v18 offset:256
    v_mfma_f32_16x16x32_bf16 v[72:75], a[20:23], v[128:131], v[72:75]
    ds_read_b64_tr_b16 a[6:7], v18 offset:8448
    s_waitcnt lgkmcnt(4)
    v_mfma_f32_16x16x32_bf16 v[80:83], a[24:27], v[128:131], v[80:83]
    ds_read_b64_tr_b16 a[8:9], v19 offset:256
    buffer_load_dwordx4 v23, s[12:15], s70 offen offset:2048 sc1 lds
    v_mfma_f32_16x16x32_bf16 v[84:87], a[24:27], v[132:135], v[84:87]
    ds_read_b64_tr_b16 a[10:11], v19 offset:8448
    v_mfma_f32_16x16x32_bf16 v[92:95], a[28:31], v[132:135], v[92:95]
    ds_read_b64_tr_b16 a[12:13], v20 offset:256
    v_mfma_f32_16x16x32_bf16 v[88:91], a[28:31], v[128:131], v[88:91]
    ds_read_b64_tr_b16 a[14:15], v20 offset:8448
    s_waitcnt lgkmcnt(4)
    v_mfma_f32_16x16x32_bf16 v[96:99], a[0:3], v[128:131], v[96:99]
    ds_read_b64_tr_b16 a[16:17], v26 offset:256
    buffer_load_dwordx4 v24, s[12:15], s70 offen offset:3072 sc1 lds
    v_mfma_f32_16x16x32_bf16 v[100:103], a[0:3], v[132:135], v[100:103]
    ds_read_b64_tr_b16 a[18:19], v26 offset:8448
    v_mfma_f32_16x16x32_bf16 v[108:111], a[4:7], v[132:135], v[108:111]
    ds_read_b64_tr_b16 a[20:21], v27 offset:256
    v_mfma_f32_16x16x32_bf16 v[104:107], a[4:7], v[128:131], v[104:107]
    ds_read_b64_tr_b16 a[22:23], v27 offset:8448
    s_waitcnt lgkmcnt(4)
    v_mfma_f32_16x16x32_bf16 v[112:115], a[8:11], v[128:131], v[112:115]
    ds_read_b64_tr_b16 a[24:25], v17 offset:16384
    s_add_u32 s70, s46, 172032
    v_mfma_f32_16x16x32_bf16 v[116:119], a[8:11], v[132:135], v[116:119]
    ds_read_b64_tr_b16 a[26:27], v17 offset:24576
    v_mfma_f32_16x16x32_bf16 v[124:127], a[12:15], v[132:135], v[124:127]
    ds_read_b64_tr_b16 a[28:29], v18 offset:16384
    v_mfma_f32_16x16x32_bf16 v[120:123], a[12:15], v[128:131], v[120:123]
    ds_read_b64_tr_b16 a[30:31], v18 offset:24576
    s_waitcnt lgkmcnt(4)
    v_mfma_f32_16x16x32_bf16 v[136:139], a[16:19], v[128:131], v[136:139]
    ds_read_b64_tr_b16 a[0:1], v19 offset:16384
    s_add_u32 m0, s32, 98304
    v_mfma_f32_16x16x32_bf16 v[140:143], a[16:19], v[132:135], v[140:143]
    ds_read_b64_tr_b16 a[2:3], v19 offset:24576
    v_mfma_f32_16x16x32_bf16 v[156:159], a[20:23], v[132:135], v[156:159]
    ds_read_b64_tr_b16 a[4:5], v20 offset:16384
    v_mfma_f32_16x16x32_bf16 v[152:155], a[20:23], v[128:131], v[152:155]
    ds_read_b64_tr_b16 a[6:7], v20 offset:24576
    s_waitcnt lgkmcnt(4)
    v_mfma_f32_16x16x32_bf16 v[32:35], a[24:27], v[144:147], v[32:35]
    ds_read_b64_tr_b16 a[8:9], v26 offset:16384
    v_mfma_f32_16x16x32_bf16 v[36:39], a[24:27], v[148:151], v[36:39]
    ds_read_b64_tr_b16 a[10:11], v26 offset:24576
    buffer_load_dwordx4 v21, s[12:15], s70 offen offset:0 sc1 lds
    v_mfma_f32_16x16x32_bf16 v[44:47], a[28:31], v[148:151], v[44:47]
    ds_read_b64_tr_b16 a[12:13], v27 offset:16384
    v_mfma_f32_16x16x32_bf16 v[40:43], a[28:31], v[144:147], v[40:43]
    ds_read_b64_tr_b16 a[14:15], v27 offset:24576
    s_waitcnt lgkmcnt(4)
    v_mfma_f32_16x16x32_bf16 v[48:51], a[0:3], v[144:147], v[48:51]
    ds_read_b64_tr_b16 a[16:17], v28 offset:16384
    v_mfma_f32_16x16x32_bf16 v[52:55], a[0:3], v[148:151], v[52:55]
    ds_read_b64_tr_b16 a[18:19], v28 offset:24576
    buffer_load_dwordx4 v22, s[12:15], s70 offen offset:1024 sc1 lds
    v_mfma_f32_16x16x32_bf16 v[60:63], a[4:7], v[148:151], v[60:63]
    ds_read_b64_tr_b16 a[20:21], v29 offset:16384
    v_mfma_f32_16x16x32_bf16 v[56:59], a[4:7], v[144:147], v[56:59]
    ds_read_b64_tr_b16 a[22:23], v29 offset:24576
    s_waitcnt lgkmcnt(4)
    v_mfma_f32_16x16x32_bf16 v[64:67], a[8:11], v[144:147], v[64:67]
    ds_read_b64_tr_b16 a[24:25], v17 offset:16640
    v_mfma_f32_16x16x32_bf16 v[68:71], a[8:11], v[148:151], v[68:71]
    ds_read_b64_tr_b16 a[26:27], v17 offset:24832
    v_mfma_f32_16x16x32_bf16 v[76:79], a[12:15], v[148:151], v[76:79]
    ds_read_b64_tr_b16 a[28:29], v18 offset:16640
    buffer_load_dwordx4 v23, s[12:15], s70 offen offset:2048 sc1 lds
    v_mfma_f32_16x16x32_bf16 v[72:75], a[12:15], v[144:147], v[72:75]
    ds_read_b64_tr_b16 a[30:31], v18 offset:24832
    s_waitcnt lgkmcnt(4)
    v_mfma_f32_16x16x32_bf16 v[80:83], a[16:19], v[144:147], v[80:83]
    ds_read_b64_tr_b16 a[0:1], v19 offset:16640
    v_mfma_f32_16x16x32_bf16 v[84:87], a[16:19], v[148:151], v[84:87]
    ds_read_b64_tr_b16 a[2:3], v19 offset:24832
    v_mfma_f32_16x16x32_bf16 v[92:95], a[20:23], v[148:151], v[92:95]
    ds_read_b64_tr_b16 a[4:5], v20 offset:16640
    buffer_load_dwordx4 v24, s[12:15], s70 offen offset:3072 sc1 lds
    v_mfma_f32_16x16x32_bf16 v[88:91], a[20:23], v[144:147], v[88:91]
    ds_read_b64_tr_b16 a[6:7], v20 offset:24832
    s_waitcnt lgkmcnt(4)
    v_mfma_f32_16x16x32_bf16 v[96:99], a[24:27], v[144:147], v[96:99]
    ds_read_b64_tr_b16 a[8:9], v26 offset:16640
    v_mfma_f32_16x16x32_bf16 v[100:103], a[24:27], v[148:151], v[100:103]
    ds_read_b64_tr_b16 a[10:11], v26 offset:24832
    v_mfma_f32_16x16x32_bf16 v[108:111], a[28:31], v[148:151], v[108:111]
    ds_read_b64_tr_b16 a[12:13], v27 offset:16640
    v_mfma_f32_16x16x32_bf16 v[104:107], a[28:31], v[144:147], v[104:107]
    ds_read_b64_tr_b16 a[14:15], v27 offset:24832
    s_waitcnt vmcnt(13)
    s_barrier
    s_waitcnt lgkmcnt(4)
    v_mfma_f32_16x16x32_bf16 v[112:115], a[0:3], v[144:147], v[112:115]
    ds_read_b64_tr_b16 a[16:17], v17 offset:32768
    s_mov_b32 s98, 0
spin_66:
    s_waitcnt vmcnt(8)
    v_readfirstlane_b32 s99, v16
    s_nop 0
    s_cmp_ge_u32 s99, 2
    s_cbranch_scc1 ok_67
    s_add_u32 s98, s98, 1
    s_cmp_gt_u32 s98, 0x80000
    s_cbranch_scc1 ok_67
    s_sleep 8
    buffer_load_dword v16, off, s[4:7], s34 sc1
    s_waitcnt vmcnt(0)
    s_branch spin_66
ok_67:
    v_mfma_f32_16x16x32_bf16 v[116:119], a[0:3], v[148:151], v[116:119]
    ds_read_b64_tr_b16 a[18:19], v17 offset:40960
    s_add_u32 s70, s46, 200704
    v_mfma_f32_16x16x32_bf16 v[124:127], a[4:7], v[148:151], v[124:127]
    ds_read_b64_tr_b16 a[20:21], v18 offset:32768
    v_mfma_f32_16x16x32_bf16 v[120:123], a[4:7], v[144:147], v[120:123]
    ds_read_b64_tr_b16 a[22:23], v18 offset:40960
    s_waitcnt lgkmcnt(4)
    v_mfma_f32_16x16x32_bf16 v[136:139], a[8:11], v[144:147], v[136:139]
    ds_read_b64_tr_b16 a[24:25], v19 offset:32768
    s_add_u32 m0, s32, 114688
    v_mfma_f32_16x16x32_bf16 v[140:143], a[8:11], v[148:151], v[140:143]
    ds_read_b64_tr_b16 a[26:27], v19 offset:40960
    buffer_load_dwordx4 v21, s[12:15], s70 offen offset:0 sc1 lds
    v_mfma_f32_16x16x32_bf16 v[156:159], a[12:15], v[148:151], v[156:159]
    ds_read_b64_tr_b16 a[28:29], v20 offset:32768
    v_mfma_f32_16x16x32_bf16 v[152:155], a[12:15], v[144:147], v[152:155]
    ds_read_b64_tr_b16 a[30:31], v20 offset:40960
    s_waitcnt lgkmcnt(4)
    v_mfma_f32_16x16x32_bf16 v[32:35], a[16:19], v[160:163], v[32:35]
    ds_read_b64_tr_b16 a[0:1], v26 offset:32768
    buffer_load_dwordx4 v22, s[12:15], s70 offen offset:1024 sc1 lds
    v_mfma_f32_16x16x32_bf16 v[36:39], a[16:19], v[164:167], v[36:39]
    ds_read_b64_tr_b16 a[2:3], v26 offset:40960
    v_mfma_f32_16x16x32_bf16 v[44:47], a[20:23], v[164:167], v[44:47]
    ds_read_b64_tr_b16 a[4:5], v27 offset:32768
    buffer_load_dwordx4 v23, s[12:15], s70 offen offset:2048 sc1 lds
    v_mfma_f32_16x16x32_bf16 v[40:43], a[20:23], v[160:163], v[40:43]
    ds_read_b64_tr_b16 a[6:7], v27 offset:40960
    s_waitcnt lgkmcnt(4)
    v_mfma_f32_16x16x32_bf16 v[48:51], a[24:27], v[160:163], v[48:51]
    ds_read_b64_tr_b16 a[8:9], v28 offset:32768
    v_mfma_f32_16x16x32_bf16 v[52:55], a[24:27], v[164:167], v[52:55]
    ds_read_b64_tr_b16 a[10:11], v28 offset:40960
    buffer_load_dwordx4 v24, s[12:15], s70 offen offset:3072 sc1 lds
    v_mfma_f32_16x16x32_bf16 v[60:63], a[28:31], v[164:167], v[60:63]
    ds_read_b64_tr_b16 a[12:13], v29 offset:32768
    v_mfma_f32_16x16x32_bf16 v[56:59], a[28:31], v[160:163], v[56:59]
    ds_read_b64_tr_b16 a[14:15], v29 offset:40960
    s_waitcnt lgkmcnt(4)
    v_mfma_f32_16x16x32_bf16 v[64:67], a[0:3], v[160:163], v[64:67]
    ds_read_b64_tr_b16 a[16:17], v17 offset:33024
    s_add_u32 s70, s47, 0
    v_mfma_f32_16x16x32_bf16 v[68:71], a[0:3], v[164:167], v[68:71]
    ds_read_b64_tr_b16 a[18:19], v17 offset:41216
    v_mfma_f32_16x16x32_bf16 v[76:79], a[4:7], v[164:167], v[76:79]
    ds_read_b64_tr_b16 a[20:21], v18 offset:33024
    s_add_u32 m0, s32, 0
    v_mfma_f32_16x16x32_bf16 v[72:75], a[4:7], v[160:163], v[72:75]
    ds_read_b64_tr_b16 a[22:23], v18 offset:41216
    s_waitcnt lgkmcnt(4)
    v_mfma_f32_16x16x32_bf16 v[80:83], a[8:11], v[160:163], v[80:83]
    ds_read_b64_tr_b16 a[24:25], v19 offset:33024
    buffer_load_dwordx4 v21, s[12:15], s70 offen offset:0 sc1 lds
    v_mfma_f32_16x16x32_bf16 v[84:87], a[8:11], v[164:167], v[84:87]
    ds_read_b64_tr_b16 a[26:27], v19 offset:41216
    v_mfma_f32_16x16x32_bf16 v[92:95], a[12:15], v[164:167], v[92:95]
    ds_read_b64_tr_b16 a[28:29], v20 offset:33024
    v_mfma_f32_16x16x32_bf16 v[88:91], a[12:15], v[160:163], v[88:91]
    ds_read_b64_tr_b16 a[30:31], v20 offset:41216
    s_waitcnt lgkmcnt(4)
    v_mfma_f32_16x16x32_bf16 v[96:99], a[16:19], v[160:163], v[96:99]
    ds_read_b64_tr_b16 a[0:1], v26 offset:33024
    buffer_load_dwordx4 v22, s[12:15], s70 offen offset:1024 sc1 lds
    v_mfma_f32_16x16x32_bf16 v[100:103], a[16:19], v[164:167], v[100:103]
    ds_read_b64_tr_b16 a[2:3], v26 offset:41216
    buffer_load_dwordx4 v23, s[12:15], s70 offen offset:2048 sc1 lds
    v_mfma_f32_16x16x32_bf16 v[108:111], a[20:23], v[164:167], v[108:111]
    ds_read_b64_tr_b16 a[4:5], v27 offset:33024
    v_mfma_f32_16x16x32_bf16 v[104:107], a[20:23], v[160:163], v[104:107]
    ds_read_b64_tr_b16 a[6:7], v27 offset:41216
    s_waitcnt lgkmcnt(4)
    v_mfma_f32_16x16x32_bf16 v[112:115], a[24:27], v[160:163], v[112:115]
    ds_read_b64_tr_b16 a[8:9], v17 offset:49152
    buffer_load_dwordx4 v24, s[12:15], s70 offen offset:3072 sc1 lds
    v_mfma_f32_16x16x32_bf16 v[116:119], a[24:27], v[164:167], v[116:119]
    ds_read_b64_tr_b16 a[10:11], v17 offset:57344
    v_mfma_f32_16x16x32_bf16 v[124:127], a[28:31], v[164:167], v[124:127]
    ds_read_b64_tr_b16 a[12:13], v18 offset:49152
    s_add_u32 s71, s36, 0
    v_mfma_f32_16x16x32_bf16 v[120:123], a[28:31], v[160:163], v[120:123]
    ds_read_b64_tr_b16 a[14:15], v18 offset:57344
    s_waitcnt lgkmcnt(4)
    v_mfma_f32_16x16x32_bf16 v[136:139], a[0:3], v[160:163], v[136:139]
    ds_read_b64_tr_b16 a[16:17], v19 offset:49152
    buffer_load_dwordx4 a[64:67], v25, s[4:7], s71 offen offset:0 sc1
    v_mfma_f32_16x16x32_bf16 v[140:143], a[0:3], v[164:167], v[140:143]
    ds_read_b64_tr_b16 a[18:19], v19 offset:57344
    v_mfma_f32_16x16x32_bf16 v[156:159], a[4:7], v[164:167], v[156:159]
    ds_read_b64_tr_b16 a[20:21], v20 offset:49152
    v_mfma_f32_16x16x32_bf16 v[152:155], a[4:7], v[160:163], v[152:155]
    ds_read_b64_tr_b16 a[22:23], v20 offset:57344
    s_waitcnt lgkmcnt(4)
    v_mfma_f32_16x16x32_bf16 v[32:35], a[8:11], v[176:179], v[32:35]
    ds_read_b64_tr_b16 a[24:25], v26 offset:49152
    buffer_load_dwordx4 a[68:71], v25, s[4:7], s71 offen offset:1024 sc1
    v_mfma_f32_16x16x32_bf16 v[36:39], a[8:11], v[180:183], v[36:39]
    ds_read_b64_tr_b16 a[26:27], v26 offset:57344
    buffer_load_dwordx4 a[72:75], v25, s[4:7], s71 offen offset:2048 sc1
    v_mfma_f32_16x16x32_bf16 v[44:47], a[12:15], v[180:183], v[44:47]
    ds_read_b64_tr_b16 a[28:29], v27 offset:49152
    v_mfma_f32_16x16x32_bf16 v[40:43], a[12:15], v[176:179], v[40:43]
    ds_read_b64_tr_b16 a[30:31], v27 offset:57344
    s_waitcnt lgkmcnt(4)
    v_mfma_f32_16x16x32_bf16 v[48:51], a[16:19], v[176:179], v[48:51]
    ds_read_b64_tr_b16 a[0:1], v28 offset:49152
    buffer_load_dwordx4 a[76:79], v25, s[4:7], s71 offen offset:3072 sc1
    v_mfma_f32_16x16x32_bf16 v[52:55], a[16:19], v[180:183], v[52:55]
    ds_read_b64_tr_b16 a[2:3], v28 offset:57344
    v_mfma_f32_16x16x32_bf16 v[60:63], a[20:23], v[180:183], v[60:63]
    ds_read_b64_tr_b16 a[4:5], v29 offset:49152
    s_add_u32 s71, s36, 4096
    v_mfma_f32_16x16x32_bf16 v[56:59], a[20:23], v[176:179], v[56:59]
    ds_read_b64_tr_b16 a[6:7], v29 offset:57344
    s_waitcnt lgkmcnt(4)
    v_mfma_f32_16x16x32_bf16 v[64:67], a[24:27], v[176:179], v[64:67]
    ds_read_b64_tr_b16 a[8:9], v17 offset:49408
    v_mfma_f32_16x16x32_bf16 v[68:71], a[24:27], v[180:183], v[68:71]
    ds_read_b64_tr_b16 a[10:11], v17 offset:57600
    buffer_load_dwordx4 a[80:83], v25, s[4:7], s71 offen offset:0 sc1
    v_mfma_f32_16x16x32_bf16 v[76:79], a[28:31], v[180:183], v[76:79]
    ds_read_b64_tr_b16 a[12:13], v18 offset:49408
    v_mfma_f32_16x16x32_bf16 v[72:75], a[28:31], v[176:179], v[72:75]
    ds_read_b64_tr_b16 a[14:15], v18 offset:57600
    s_waitcnt lgkmcnt(4)
    v_mfma_f32_16x16x32_bf16 v[80:83], a[0:3], v[176:179], v[80:83]
    ds_read_b64_tr_b16 a[16:17], v19 offset:49408
    buffer_load_dwordx4 a[84:87], v25, s[4:7], s71 offen offset:1024 sc1
    v_mfma_f32_16x16x32_bf16 v[84:87], a[0:3], v[180:183], v[84:87]
    ds_read_b64_tr_b16 a[18:19], v19 offset:57600
    v_mfma_f32_16x16x32_bf16 v[92:95], a[4:7], v[180:183], v[92:95]
    ds_read_b64_tr_b16 a[20:21], v20 offset:49408
    buffer_load_dwordx4 a[88:91], v25, s[4:7], s71 offen offset:2048 sc1
    v_mfma_f32_16x16x32_bf16 v[88:91], a[4:7], v[176:179], v[88:91]
    ds_read_b64_tr_b16 a[22:23], v20 offset:57600
    s_waitcnt lgkmcnt(4)
    v_mfma_f32_16x16x32_bf16 v[96:99], a[8:11], v[176:179], v[96:99]
    ds_read_b64_tr_b16 a[24:25], v26 offset:49408
    buffer_load_dwordx4 a[92:95], v25, s[4:7], s71 offen offset:3072 sc1
    v_mfma_f32_16x16x32_bf16 v[100:103], a[8:11], v[180:183], v[100:103]
    ds_read_b64_tr_b16 a[26:27], v26 offset:57600
    v_mfma_f32_16x16x32_bf16 v[108:111], a[12:15], v[180:183], v[108:111]
    ds_read_b64_tr_b16 a[28:29], v27 offset:49408
    v_mfma_f32_16x16x32_bf16 v[104:107], a[12:15], v[176:179], v[104:107]
    ds_read_b64_tr_b16 a[30:31], v27 offset:57600
    s_waitcnt vmcnt(20)
    s_barrier
    s_waitcnt lgkmcnt(4)
    v_mfma_f32_16x16x32_bf16 v[112:115], a[16:19], v[176:179], v[112:115]
    ds_read_b64_tr_b16 a[0:1], v5 offset:0
    v_mfma_f32_16x16x32_bf16 v[116:119], a[16:19], v[180:183], v[116:119]
    ds_read_b64_tr_b16 a[2:3], v5 offset:8192
    s_add_u32 s70, s47, 28672
    v_mfma_f32_16x16x32_bf16 v[124:127], a[20:23], v[180:183], v[124:127]
    ds_read_b64_tr_b16 a[4:5], v6 offset:0
    v_mfma_f32_16x16x32_bf16 v[120:123], a[20:23], v[176:179], v[120:123]
    ds_read_b64_tr_b16 a[6:7], v6 offset:8192
    s_waitcnt lgkmcnt(4)
    v_mfma_f32_16x16x32_bf16 v[136:139], a[24:27], v[176:179], v[136:139]
    ds_read_b64_tr_b16 a[8:9], v7 offset:0
    s_add_u32 m0, s32, 16384
    v_mfma_f32_16x16x32_bf16 v[140:143], a[24:27], v[180:183], v[140:143]
    ds_read_b64_tr_b16 a[10:11], v7 offset:8192
    buffer_load_dwordx4 v21, s[12:15], s70 offen offset:0 sc1 lds
    v_mfma_f32_16x16x32_bf16 v[156:159], a[28:31], v[180:183], v[156:159]
    ds_read_b64_tr_b16 a[12:13], v8 offset:0
    v_mfma_f32_16x16x32_bf16 v[152:155], a[28:31], v[176:179], v[152:155]
    ds_read_b64_tr_b16 a[14:15], v8 offset:8192
    s_waitcnt lgkmcnt(4)
    v_mfma_f32_16x16x32_bf16 v[32:35], a[0:3], v[192:195], v[32:35]
    ds_read_b64_tr_b16 a[16:17], v9 offset:0
    buffer_load_dwordx4 v22, s[12:15], s70 offen offset:1024 sc1 lds
    v_mfma_f32_16x16x32_bf16 v[36:39], a[0:3], v[196:199], v[36:39]
    ds_read_b64_tr_b16 a[18:19], v9 offset:8192
    v_mfma_f32_16x16x32_bf16 v[44:47], a[4:7], v[196:199], v[44:47]
    ds_read_b64_tr_b16 a[20:21], v10 offset:0
    buffer_load_dwordx4 v23, s[12:15], s70 offen offset:2048 sc1 lds
    v_mfma_f32_16x16x32_bf16 v[40:43], a[4:7], v[192:195], v[40:43]
    ds_read_b64_tr_b16 a[22:23], v10 offset:8192
    s_waitcnt lgkmcnt(4)
    v_mfma_f32_16x16x32_bf16 v[48:51], a[8:11], v[192:195], v[48:51]
    ds_read_b64_tr_b16 a[24:25], v11 offset:0
    v_mfma_f32_16x16x32_bf16 v[52:55], a[8:11], v[196:199], v[52:55]
    ds_read_b64_tr_b16 a[26:27], v11 offset:8192
    buffer_load_dwordx4 v24, s[12:15], s70 offen offset:3072 sc1 lds
    v_mfma_f32_16x16x32_bf16 v[60:63], a[12:15], v[196:199], v[60:63]
    ds_read_b64_tr_b16 a[28:29], v12 offset:0
    v_mfma_f32_16x16x32_bf16 v[56:59], a[12:15], v[192:195], v[56:59]
    ds_read_b64_tr_b16 a[30:31], v12 offset:8192
    s_waitcnt lgkmcnt(4)
    v_mfma_f32_16x16x32_bf16 v[64:67], a[16:19], v[192:195], v[64:67]
    ds_read_b64_tr_b16 a[0:1], v5 offset:256
    s_add_u32 s70, s47, 57344
    v_mfma_f32_16x16x32_bf16 v[68:71], a[16:19], v[196:199], v[68:71]
    ds_read_b64_tr_b16 a[2:3], v5 offset:8448
    v_mfma_f32_16x16x32_bf16 v[76:79], a[20:23], v[196:199], v[76:79]
    ds_read_b64_tr_b16 a[4:5], v6 offset:256
    s_add_u32 m0, s32, 32768
    v_mfma_f32_16x16x32_bf16 v[72:75], a[20:23], v[192:195], v[72:75]
    ds_read_b64_tr_b16 a[6:7], v6 offset:8448
    s_waitcnt lgkmcnt(4)
    v_mfma_f32_16x16x32_bf16 v[80:83], a[24:27], v[192:195], v[80:83]
    ds_read_b64_tr_b16 a[8:9], v7 offset:256
    buffer_load_dwordx4 v21, s[12:15], s70 offen offset:0 sc1 lds
    v_mfma_f32_16x16x32_bf16 v[84:87], a[24:27], v[196:199], v[84:87]
    ds_read_b64_tr_b16 a[10:11], v7 offset:8448
    v_mfma_f32_16x16x32_bf16 v[92:95], a[28:31], v[196:199], v[92:95]
    ds_read_b64_tr_b16 a[12:13], v8 offset:256
    v_mfma_f32_16x16x32_bf16 v[88:91], a[28:31], v[192:195], v[88:91]
    ds_read_b64_tr_b16 a[14:15], v8 offset:8448
    s_waitcnt lgkmcnt(4)
    v_mfma_f32_16x16x32_bf16 v[96:99], a[0:3], v[192:195], v[96:99]
    ds_read_b64_tr_b16 a[16:17], v9 offset:256
    buffer_load_dwordx4 v22, s[12:15], s70 offen offset:1024 sc1 lds
    v_mfma_f32_16x16x32_bf16 v[100:103], a[0:3], v[196:199], v[100:103]
    ds_read_b64_tr_b16 a[18:19], v9 offset:8448
    buffer_load_dwordx4 v23, s[12:15], s70 offen offset:2048 sc1 lds
    v_mfma_f32_16x16x32_bf16 v[108:111], a[4:7], v[196:199], v[108:111]
    ds_read_b64_tr_b16 a[20:21], v10 offset:256
    v_mfma_f32_16x16x32_bf16 v[104:107], a[4:7], v[192:195], v[104:107]
    ds_read_b64_tr_b16 a[22:23], v10 offset:8448
    s_waitcnt lgkmcnt(4)
    v_mfma_f32_16x16x32_bf16 v[112:115], a[8:11], v[192:195], v[112:115]
    ds_read_b64_tr_b16 a[24:25], v5 offset:16384
    buffer_load_dwordx4 v24, s[12:15], s70 offen offset:3072 sc1 lds
    v_mfma_f32_16x16x32_bf16 v[116:119], a[8:11], v[196:199], v[116:119]
    ds_read_b64_tr_b16 a[26:27], v5 offset:24576
    v_mfma_f32_16x16x32_bf16 v[124:127], a[12:15], v[196:199], v[124:127]
    ds_read_b64_tr_b16 a[28:29], v6 offset:16384
    s_add_u32 s71, s36, 8192
    v_mfma_f32_16x16x32_bf16 v[120:123], a[12:15], v[192:195], v[120:123]
    ds_read_b64_tr_b16 a[30:31], v6 offset:24576
    s_waitcnt lgkmcnt(4)
    v_mfma_f32_16x16x32_bf16 v[136:139], a[16:19], v[192:195], v[136:139]
    ds_read_b64_tr_b16 a[0:1], v7 offset:16384
    buffer_load_dwordx4 a[96:99], v25, s[4:7], s71 offen offset:0 sc1
    v_mfma_f32_16x16x32_bf16 v[140:143], a[16:19], v[196:199], v[140:143]
    ds_read_b64_tr_b16 a[2:3], v7 offset:24576
    v_mfma_f32_16x16x32_bf16 v[156:159], a[20:23], v[196:199], v[156:159]
    ds_read_b64_tr_b16 a[4:5], v8 offset:16384
    v_mfma_f32_16x16x32_bf16 v[152:155], a[20:23], v[192:195], v[152:155]
    ds_read_b64_tr_b16 a[6:7], v8 offset:24576
    s_waitcnt lgkmcnt(4)
    v_mfma_f32_16x16x32_bf16 v[32:35], a[24:27], v[208:211], v[32:35]
    ds_read_b64_tr_b16 a[8:9], v9 offset:16384
    buffer_load_dwordx4 a[100:103], v25, s[4:7], s71 offen offset:1024 sc1
    v_mfma_f32_16x16x32_bf16 v[36:39], a[24:27], v[212:215], v[36:39]
    ds_read_b64_tr_b16 a[10:11], v9 offset:24576
    buffer_load_dwordx4 a[104:107], v25, s[4:7], s71 offen offset:2048 sc1
    v_mfma_f32_16x16x32_bf16 v[44:47], a[28:31], v[212:215], v[44:47]
    ds_read_b64_tr_b16 a[12:13], v10 offset:16384
    v_mfma_f32_16x16x32_bf16 v[40:43], a[28:31], v[208:211], v[40:43]
    ds_read_b64_tr_b16 a[14:15], v10 offset:24576
    s_waitcnt lgkmcnt(4)
    v_mfma_f32_16x16x32_bf16 v[48:51], a[0:3], v[208:211], v[48:51]
    ds_read_b64_tr_b16 a[16:17], v11 offset:16384
    buffer_load_dwordx4 a[108:111], v25, s[4:7], s71 offen offset:3072 sc1
    v_mfma_f32_16x16x32_bf16 v[52:55], a[0:3], v[212:215], v[52:55]
    ds_read_b64_tr_b16 a[18:19], v11 offset:24576
    v_mfma_f32_16x16x32_bf16 v[60:63], a[4:7], v[212:215], v[60:63]
    ds_read_b64_tr_b16 a[20:21], v12 offset:16384
    s_add_u32 s71, s36, 12288
    v_mfma_f32_16x16x32_bf16 v[56:59], a[4:7], v[208:211], v[56:59]
    ds_read_b64_tr_b16 a[22:23], v12 offset:24576
    s_waitcnt lgkmcnt(4)
    v_mfma_f32_16x16x32_bf16 v[64:67], a[8:11], v[208:211], v[64:67]
    ds_read_b64_tr_b16 a[24:25], v5 offset:16640
    v_mfma_f32_16x16x32_bf16 v[68:71], a[8:11], v[212:215], v[68:71]
    ds_read_b64_tr_b16 a[26:27], v5 offset:24832
    buffer_load_dwordx4 a[112:115], v25, s[4:7], s71 offen offset:0 sc1
    v_mfma_f32_16x16x32_bf16 v[76:79], a[12:15], v[212:215], v[76:79]
    ds_read_b64_tr_b16 a[28:29], v6 offset:16640
    v_mfma_f32_16x16x32_bf16 v[72:75], a[12:15], v[208:211], v[72:75]
    ds_read_b64_tr_b16 a[30:31], v6 offset:24832
    s_waitcnt lgkmcnt(4)
    v_mfma_f32_16x16x32_bf16 v[80:83], a[16:19], v[208:211], v[80:83]
    ds_read_b64_tr_b16 a[0:1], v7 offset:16640
    buffer_load_dwordx4 a[116:119], v25, s[4:7], s71 offen offset:1024 sc1
    v_mfma_f32_16x16x32_bf16 v[84:87], a[16:19], v[212:215], v[84:87]
    ds_read_b64_tr_b16 a[2:3], v7 offset:24832
    v_mfma_f32_16x16x32_bf16 v[92:95], a[20:23], v[212:215], v[92:95]
    ds_read_b64_tr_b16 a[4:5], v8 offset:16640
    buffer_load_dwordx4 a[120:123], v25, s[4:7], s71 offen offset:2048 sc1
    v_mfma_f32_16x16x32_bf16 v[88:91], a[20:23], v[208:211], v[88:91]
    ds_read_b64_tr_b16 a[6:7], v8 offset:24832
    s_waitcnt lgkmcnt(4)
    v_mfma_f32_16x16x32_bf16 v[96:99], a[24:27], v[208:211], v[96:99]
    ds_read_b64_tr_b16 a[8:9], v9 offset:16640
    buffer_load_dwordx4 a[124:127], v25, s[4:7], s71 offen offset:3072 sc1
    v_mfma_f32_16x16x32_bf16 v[100:103], a[24:27], v[212:215], v[100:103]
    ds_read_b64_tr_b16 a[10:11], v9 offset:24832
    v_mfma_f32_16x16x32_bf16 v[108:111], a[28:31], v[212:215], v[108:111]
    ds_read_b64_tr_b16 a[12:13], v10 offset:16640
    v_mfma_f32_16x16x32_bf16 v[104:107], a[28:31], v[208:211], v[104:107]
    ds_read_b64_tr_b16 a[14:15], v10 offset:24832
    s_waitcnt vmcnt(28)
    s_barrier
    s_waitcnt lgkmcnt(4)
    v_mfma_f32_16x16x32_bf16 v[112:115], a[0:3], v[208:211], v[112:115]
    ds_read_b64_tr_b16 a[16:17], v5 offset:32768
    v_mfma_f32_16x16x32_bf16 v[116:119], a[0:3], v[212:215], v[116:119]
    ds_read_b64_tr_b16 a[18:19], v5 offset:40960
    s_add_u32 s70, s47, 86016
    v_mfma_f32_16x16x32_bf16 v[124:127], a[4:7], v[212:215], v[124:127]
    ds_read_b64_tr_b16 a[20:21], v6 offset:32768
    v_mfma_f32_16x16x32_bf16 v[120:123], a[4:7], v[208:211], v[120:123]
    ds_read_b64_tr_b16 a[22:23], v6 offset:40960
    s_waitcnt lgkmcnt(4)
    v_mfma_f32_16x16x32_bf16 v[136:139], a[8:11], v[208:211], v[136:139]
    ds_read_b64_tr_b16 a[24:25], v7 offset:32768
    v_mfma_f32_16x16x32_bf16 v[140:143], a[8:11], v[212:215], v[140:143]
    ds_read_b64_tr_b16 a[26:27], v7 offset:40960
    s_add_u32 m0, s32, 49152
    v_mfma_f32_16x16x32_bf16 v[156:159], a[12:15], v[212:215], v[156:159]
    ds_read_b64_tr_b16 a[28:29], v8 offset:32768
    v_mfma_f32_16x16x32_bf16 v[152:155], a[12:15], v[208:211], v[152:155]
    ds_read_b64_tr_b16 a[30:31], v8 offset:40960
    s_waitcnt lgkmcnt(4)
    v_mfma_f32_16x16x32_bf16 v[32:35], a[16:19], v[224:227], v[32:35]
    ds_read_b64_tr_b16 a[0:1], v9 offset:32768
    v_mfma_f32_16x16x32_bf16 v[36:39], a[16:19], v[228:231], v[36:39]
    ds_read_b64_tr_b16 a[2:3], v9 offset:40960
    v_mfma_f32_16x16x32_bf16 v[44:47], a[20:23], v[228:231], v[44:47]
    ds_read_b64_tr_b16 a[4:5], v10 offset:32768
    buffer_load_dwordx4 v21, s[12:15], s70 offen offset:0 sc1 lds
    v_mfma_f32_16x16x32_bf16 v[40:43], a[20:23], v[224:227], v[40:43]
    ds_read_b64_tr_b16 a[6:7], v10 offset:40960
    s_waitcnt lgkmcnt(4)
    v_mfma_f32_16x16x32_bf16 v[48:51], a[24:27], v[224:227], v[48:51]
    ds_read_b64_tr_b16 a[8:9], v11 offset:32768
    v_mfma_f32_16x16x32_bf16 v[52:55], a[24:27], v[228:231], v[52:55]
    ds_read_b64_tr_b16 a[10:11], v11 offset:40960
    v_mfma_f32_16x16x32_bf16 v[60:63], a[28:31], v[228:231], v[60:63]
    ds_read_b64_tr_b16 a[12:13], v12 offset:32768
    buffer_load_dwordx4 v22, s[12:15], s70 offen offset:1024 sc1 lds
    v_mfma_f32_16x16x32_bf16 v[56:59], a[28:31], v[224:227], v[56:59]
    ds_read_b64_tr_b16 a[14:15], v12 offset:40960
    s_waitcnt lgkmcnt(4)
    v_mfma_f32_16x16x32_bf16 v[64:67], a[0:3], v[224:227], v[64:67]
    ds_read_b64_tr_b16 a[16:17], v5 offset:33024
    v_mfma_f32_16x16x32_bf16 v[68:71], a[0:3], v[228:231], v[68:71]
    ds_read_b64_tr_b16 a[18:19], v5 offset:41216
    v_mfma_f32_16x16x32_bf16 v[76:79], a[4:7], v[228:231], v[76:79]
    ds_read_b64_tr_b16 a[20:21], v6 offset:33024
    v_mfma_f32_16x16x32_bf16 v[72:75], a[4:7], v[224:227], v[72:75]
    ds_read_b64_tr_b16 a[22:23], v6 offset:41216
    s_waitcnt lgkmcnt(4)
    v_mfma_f32_16x16x32_bf16 v[80:83], a[8:11], v[224:227], v[80:83]
    ds_read_b64_tr_b16 a[24:25], v7 offset:33024
    buffer_load_dwordx4 v23, s[12:15], s70 offen offset:2048 sc1 lds
    v_mfma_f32_16x16x32_bf16 v[84:87], a[8:11], v[228:231], v[84:87]
    ds_read_b64_tr_b16 a[26:27], v7 offset:41216
    v_mfma_f32_16x16x32_bf16 v[92:95], a[12:15], v[228:231], v[92:95]
    ds_read_b64_tr_b16 a[28:29], v8 offset:33024
    v_mfma_f32_16x16x32_bf16 v[88:91], a[12:15], v[224:227], v[88:91]
    ds_read_b64_tr_b16 a[30:31], v8 offset:41216
    s_waitcnt lgkmcnt(4)
    v_mfma_f32_16x16x32_bf16 v[96:99], a[16:19], v[224:227], v[96:99]
    ds_read_b64_tr_b16 a[0:1], v9 offset:33024
    buffer_load_dwordx4 v24, s[12:15], s70 offen offset:3072 sc1 lds
    v_mfma_f32_16x16x32_bf16 v[100:103], a[16:19], v[228:231], v[100:103]
    ds_read_b64_tr_b16 a[2:3], v9 offset:41216
    v_mfma_f32_16x16x32_bf16 v[108:111], a[20:23], v[228:231], v[108:111]
    ds_read_b64_tr_b16 a[4:5], v10 offset:33024
    v_mfma_f32_16x16x32_bf16 v[104:107], a[20:23], v[224:227], v[104:107]
    ds_read_b64_tr_b16 a[6:7], v10 offset:41216
    s_waitcnt lgkmcnt(4)
    v_mfma_f32_16x16x32_bf16 v[112:115], a[24:27], v[224:227], v[112:115]
    ds_read_b64_tr_b16 a[8:9], v5 offset:49152
    s_add_u32 s70, s47, 114688
    v_mfma_f32_16x16x32_bf16 v[116:119], a[24:27], v[228:231], v[116:119]
    ds_read_b64_tr_b16 a[10:11], v5 offset:57344
    v_mfma_f32_16x16x32_bf16 v[124:127], a[28:31], v[228:231], v[124:127]
    ds_read_b64_tr_b16 a[12:13], v6 offset:49152
    v_mfma_f32_16x16x32_bf16 v[120:123], a[28:31], v[224:227], v[120:123]
    ds_read_b64_tr_b16 a[14:15], v6 offset:57344
    s_waitcnt lgkmcnt(4)
    v_mfma_f32_16x16x32_bf16 v[136:139], a[0:3], v[224:227], v[136:139]
    ds_read_b64_tr_b16 a[16:17], v7 offset:49152
    s_add_u32 m0, s32, 65536
    v_mfma_f32_16x16x32_bf16 v[140:143], a[0:3], v[228:231], v[140:143]
    ds_read_b64_tr_b16 a[18:19], v7 offset:57344
    v_mfma_f32_16x16x32_bf16 v[156:159], a[4:7], v[228:231], v[156:159]
    ds_read_b64_tr_b16 a[20:21], v8 offset:49152
    v_mfma_f32_16x16x32_bf16 v[152:155], a[4:7], v[224:227], v[152:155]
    ds_read_b64_tr_b16 a[22:23], v8 offset:57344
    s_waitcnt lgkmcnt(4)
    v_mfma_f32_16x16x32_bf16 v[32:35], a[8:11], v[240:243], v[32:35]
    ds_read_b64_tr_b16 a[24:25], v9 offset:49152
    v_mfma_f32_16x16x32_bf16 v[36:39], a[8:11], v[244:247], v[36:39]
    ds_read_b64_tr_b16 a[26:27], v9 offset:57344
    buffer_load_dwordx4 v21, s[12:15], s70 offen offset:0 sc1 lds
    v_mfma_f32_16x16x32_bf16 v[44:47], a[12:15], v[244:247], v[44:47]
    ds_read_b64_tr_b16 a[28:29], v10 offset:49152
    v_mfma_f32_16x16x32_bf16 v[40:43], a[12:15], v[240:243], v[40:43]
    ds_read_b64_tr_b16 a[30:31], v10 offset:57344
    s_waitcnt lgkmcnt(4)
    v_mfma_f32_16x16x32_bf16 v[48:51], a[16:19], v[240:243], v[48:51]
    ds_read_b64_tr_b16 a[0:1], v11 offset:49152
    v_mfma_f32_16x16x32_bf16 v[52:55], a[16:19], v[244:247], v[52:55]
    ds_read_b64_tr_b16 a[2:3], v11 offset:57344
    buffer_load_dwordx4 v22, s[12:15], s70 offen offset:1024 sc1 lds
    v_mfma_f32_16x16x32_bf16 v[60:63], a[20:23], v[244:247], v[60:63]
    ds_read_b64_tr_b16 a[4:5], v12 offset:49152
    v_mfma_f32_16x16x32_bf16 v[56:59], a[20:23], v[240:243], v[56:59]
    ds_read_b64_tr_b16 a[6:7], v12 offset:57344
    s_waitcnt lgkmcnt(4)
    v_mfma_f32_16x16x32_bf16 v[64:67], a[24:27], v[240:243], v[64:67]
    ds_read_b64_tr_b16 a[8:9], v5 offset:49408
    v_mfma_f32_16x16x32_bf16 v[68:71], a[24:27], v[244:247], v[68:71]
    ds_read_b64_tr_b16 a[10:11], v5 offset:57600
    v_mfma_f32_16x16x32_bf16 v[76:79], a[28:31], v[244:247], v[76:79]
    ds_read_b64_tr_b16 a[12:13], v6 offset:49408
    buffer_load_dwordx4 v23, s[12:15], s70 offen offset:2048 sc1 lds
    v_mfma_f32_16x16x32_bf16 v[72:75], a[28:31], v[240:243], v[72:75]
    ds_read_b64_tr_b16 a[14:15], v6 offset:57600
    s_waitcnt lgkmcnt(4)
    v_mfma_f32_16x16x32_bf16 v[80:83], a[0:3], v[240:243], v[80:83]
    ds_read_b64_tr_b16 a[16:17], v7 offset:49408
    v_mfma_f32_16x16x32_bf16 v[84:87], a[0:3], v[244:247], v[84:87]
    ds_read_b64_tr_b16 a[18:19], v7 offset:57600
    v_mfma_f32_16x16x32_bf16 v[92:95], a[4:7], v[244:247], v[92:95]
    ds_read_b64_tr_b16 a[20:21], v8 offset:49408
    buffer_load_dwordx4 v24, s[12:15], s70 offen offset:3072 sc1 lds
    v_mfma_f32_16x16x32_bf16 v[88:91], a[4:7], v[240:243], v[88:91]
    ds_read_b64_tr_b16 a[22:23], v8 offset:57600
    s_waitcnt lgkmcnt(4)
    v_mfma_f32_16x16x32_bf16 v[96:99], a[8:11], v[240:243], v[96:99]
    ds_read_b64_tr_b16 a[24:25], v9 offset:49408
    v_mfma_f32_16x16x32_bf16 v[100:103], a[8:11], v[244:247], v[100:103]
    ds_read_b64_tr_b16 a[26:27], v9 offset:57600
    v_mfma_f32_16x16x32_bf16 v[108:111], a[12:15], v[244:247], v[108:111]
    ds_read_b64_tr_b16 a[28:29], v10 offset:49408
    v_mfma_f32_16x16x32_bf16 v[104:107], a[12:15], v[240:243], v[104:107]
    ds_read_b64_tr_b16 a[30:31], v10 offset:57600
    s_waitcnt vmcnt(20)
    s_barrier
    s_waitcnt lgkmcnt(4)
    v_mfma_f32_16x16x32_bf16 v[112:115], a[16:19], v[240:243], v[112:115]
    ds_read_b64_tr_b16 a[0:1], v17 offset:0
    v_mfma_f32_16x16x32_bf16 v[116:119], a[16:19], v[244:247], v[116:119]
    ds_read_b64_tr_b16 a[2:3], v17 offset:8192
    s_add_u32 s70, s47, 143360
    v_mfma_f32_16x16x32_bf16 v[124:127], a[20:23], v[244:247], v[124:127]
    ds_read_b64_tr_b16 a[4:5], v18 offset:0
    v_mfma_f32_16x16x32_bf16 v[120:123], a[20:23], v[240:243], v[120:123]
    ds_read_b64_tr_b16 a[6:7], v18 offset:8192
    s_waitcnt lgkmcnt(4)
    v_mfma_f32_16x16x32_bf16 v[136:139], a[24:27], v[240:243], v[136:139]
    ds_read_b64_tr_b16 a[8:9], v19 offset:0
    s_add_u32 m0, s32, 81920
    v_mfma_f32_16x16x32_bf16 v[140:143], a[24:27], v[244:247], v[140:143]
    ds_read_b64_tr_b16 a[10:11], v19 offset:8192
    v_mfma_f32_16x16x32_bf16 v[156:159], a[28:31], v[244:247], v[156:159]
    ds_read_b64_tr_b16 a[12:13], v20 offset:0
    v_mfma_f32_16x16x32_bf16 v[152:155], a[28:31], v[240:243], v[152:155]
    ds_read_b64_tr_b16 a[14:15], v20 offset:8192
    s_waitcnt lgkmcnt(4)
    v_mfma_f32_16x16x32_bf16 v[32:35], a[0:3], a[64:67], v[32:35]
    ds_read_b64_tr_b16 a[16:17], v26 offset:0
    buffer_load_dwordx4 v21, s[12:15], s70 offen offset:0 sc1 lds
    v_mfma_f32_16x16x32_bf16 v[36:39], a[0:3], a[68:71], v[36:39]
    ds_read_b64_tr_b16 a[18:19], v26 offset:8192
    v_mfma_f32_16x16x32_bf16 v[44:47], a[4:7], a[68:71], v[44:47]
    ds_read_b64_tr_b16 a[20:21], v27 offset:0
    v_mfma_f32_16x16x32_bf16 v[40:43], a[4:7], a[64:67], v[40:43]
    ds_read_b64_tr_b16 a[22:23], v27 offset:8192
    s_waitcnt lgkmcnt(4)
    v_mfma_f32_16x16x32_bf16 v[48:51], a[8:11], a[64:67], v[48:51]
    ds_read_b64_tr_b16 a[24:25], v28 offset:0
    buffer_load_dwordx4 v22, s[12:15], s70 offen offset:1024 sc1 lds
    v_mfma_f32_16x16x32_bf16 v[52:55], a[8:11], a[68:71], v[52:55]
    ds_read_b64_tr_b16 a[26:27], v28 offset:8192
    v_mfma_f32_16x16x32_bf16 v[60:63], a[12:15], a[68:71], v[60:63]
    ds_read_b64_tr_b16 a[28:29], v29 offset:0
    buffer_load_dwordx4 v23, s[12:15], s70 offen offset:2048 sc1 lds
    v_mfma_f32_16x16x32_bf16 v[56:59], a[12:15], a[64:67], v[56:59]
    ds_read_b64_tr_b16 a[30:31], v29 offset:8192
    s_waitcnt lgkmcnt(4)
    v_mfma_f32_16x16x32_bf16 v[64:67], a[16:19], a[64:67], v[64:67]
    ds_read_b64_tr_b16 a[0:1], v17 offset:256
    v_mfma_f32_16x16x32_bf16 v[68:71], a[16:19], a[68:71], v[68:71]
    ds_read_b64_tr_b16 a[2:3], v17 offset:8448
    buffer_load_dwordx4 v24, s[12:15], s70 offen offset:3072 sc1 lds
    v_mfma_f32_16x16x32_bf16 v[76:79], a[20:23], a[68:71], v[76:79]
    ds_read_b64_tr_b16 a[4:5], v18 offset:256
    v_mfma_f32_16x16x32_bf16 v[72:75], a[20:23], a[64:67], v[72:75]
    ds_read_b64_tr_b16 a[6:7], v18 offset:8448
    s_waitcnt lgkmcnt(4)
    v_mfma_f32_16x16x32_bf16 v[80:83], a[24:27], a[64:67], v[80:83]
    ds_read_b64_tr_b16 a[8:9], v19 offset:256
    v_mfma_f32_16x16x32_bf16 v[84:87], a[24:27], a[68:71], v[84:87]
    ds_read_b64_tr_b16 a[10:11], v19 offset:8448
    s_add_u32 s70, s47, 172032
    v_mfma_f32_16x16x32_bf16 v[92:95], a[28:31], a[68:71], v[92:95]
    ds_read_b64_tr_b16 a[12:13], v20 offset:256
    v_mfma_f32_16x16x32_bf16 v[88:91], a[28:31], a[64:67], v[88:91]
    ds_read_b64_tr_b16 a[14:15], v20 offset:8448
    s_waitcnt lgkmcnt(4)
    v_mfma_f32_16x16x32_bf16 v[96:99], a[0:3], a[64:67], v[96:99]
    ds_read_b64_tr_b16 a[16:17], v26 offset:256
    s_add_u32 m0, s32, 98304
    v_mfma_f32_16x16x32_bf16 v[100:103], a[0:3], a[68:71], v[100:103]
    ds_read_b64_tr_b16 a[18:19], v26 offset:8448
    v_mfma_f32_16x16x32_bf16 v[108:111], a[4:7], a[68:71], v[108:111]
    ds_read_b64_tr_b16 a[20:21], v27 offset:256
    v_mfma_f32_16x16x32_bf16 v[104:107], a[4:7], a[64:67], v[104:107]
    ds_read_b64_tr_b16 a[22:23], v27 offset:8448
    s_waitcnt lgkmcnt(4)
    v_mfma_f32_16x16x32_bf16 v[112:115], a[8:11], a[64:67], v[112:115]
    ds_read_b64_tr_b16 a[24:25], v17 offset:16384
    buffer_load_dwordx4 v21, s[12:15], s70 offen offset:0 sc1 lds
    v_mfma_f32_16x16x32_bf16 v[116:119], a[8:11], a[68:71], v[116:119]
    ds_read_b64_tr_b16 a[26:27], v17 offset:24576
    v_mfma_f32_16x16x32_bf16 v[124:127], a[12:15], a[68:71], v[124:127]
    ds_read_b64_tr_b16 a[28:29], v18 offset:16384
    v_mfma_f32_16x16x32_bf16 v[120:123], a[12:15], a[64:67], v[120:123]
    ds_read_b64_tr_b16 a[30:31], v18 offset:24576
    s_waitcnt lgkmcnt(4)
    v_mfma_f32_16x16x32_bf16 v[136:139], a[16:19], a[64:67], v[136:139]
    ds_read_b64_tr_b16 a[0:1], v19 offset:16384
    buffer_load_dwordx4 v22, s[12:15], s70 offen offset:1024 sc1 lds
    v_mfma_f32_16x16x32_bf16 v[140:143], a[16:19], a[68:71], v[140:143]
    ds_read_b64_tr_b16 a[2:3], v19 offset:24576
    v_mfma_f32_16x16x32_bf16 v[156:159], a[20:23], a[68:71], v[156:159]
    ds_read_b64_tr_b16 a[4:5], v20 offset:16384
    buffer_load_dwordx4 v23, s[12:15], s70 offen offset:2048 sc1 lds
    v_mfma_f32_16x16x32_bf16 v[152:155], a[20:23], a[64:67], v[152:155]
    ds_read_b64_tr_b16 a[6:7], v20 offset:24576
    s_waitcnt lgkmcnt(4)
    v_mfma_f32_16x16x32_bf16 v[32:35], a[24:27], a[72:75], v[32:35]
    ds_read_b64_tr_b16 a[8:9], v26 offset:16384
    v_mfma_f32_16x16x32_bf16 v[36:39], a[24:27], a[76:79], v[36:39]
    ds_read_b64_tr_b16 a[10:11], v26 offset:24576
    v_mfma_f32_16x16x32_bf16 v[44:47], a[28:31], a[76:79], v[44:47]
    ds_read_b64_tr_b16 a[12:13], v27 offset:16384
    buffer_load_dwordx4 v24, s[12:15], s70 offen offset:3072 sc1 lds
    v_mfma_f32_16x16x32_bf16 v[40:43], a[28:31], a[72:75], v[40:43]
    ds_read_b64_tr_b16 a[14:15], v27 offset:24576
    s_waitcnt lgkmcnt(4)
    v_mfma_f32_16x16x32_bf16 v[48:51], a[0:3], a[72:75], v[48:51]
    ds_read_b64_tr_b16 a[16:17], v28 offset:16384
    v_mfma_f32_16x16x32_bf16 v[52:55], a[0:3], a[76:79], v[52:55]
    ds_read_b64_tr_b16 a[18:19], v28 offset:24576
    s_add_u32 s72, s37, 0
    v_mfma_f32_16x16x32_bf16 v[60:63], a[4:7], a[76:79], v[60:63]
    ds_read_b64_tr_b16 a[20:21], v29 offset:16384
    v_mfma_f32_16x16x32_bf16 v[56:59], a[4:7], a[72:75], v[56:59]
    ds_read_b64_tr_b16 a[22:23], v29 offset:24576
    s_waitcnt lgkmcnt(4)
    v_mfma_f32_16x16x32_bf16 v[64:67], a[8:11], a[72:75], v[64:67]
    ds_read_b64_tr_b16 a[24:25], v17 offset:16640
    s_add_u32 s73, s37, 4096
    v_mfma_f32_16x16x32_bf16 v[68:71], a[8:11], a[76:79], v[68:71]
    ds_read_b64_tr_b16 a[26:27], v17 offset:24832
    v_mfma_f32_16x16x32_bf16 v[76:79], a[12:15], a[76:79], v[76:79]
    ds_read_b64_tr_b16 a[28:29], v18 offset:16640
    v_mfma_f32_16x16x32_bf16 v[72:75], a[12:15], a[72:75], v[72:75]
    ds_read_b64_tr_b16 a[30:31], v18 offset:24832
    s_waitcnt lgkmcnt(4)
    v_mfma_f32_16x16x32_bf16 v[80:83], a[16:19], a[72:75], v[80:83]
    ds_read_b64_tr_b16 a[0:1], v19 offset:16640
    s_add_u32 s74, s37, 57344
    v_mfma_f32_16x16x32_bf16 v[84:87], a[16:19], a[76:79], v[84:87]
    ds_read_b64_tr_b16 a[2:3], v19 offset:24832
    v_mfma_f32_16x16x32_bf16 v[92:95], a[20:23], a[76:79], v[92:95]
    ds_read_b64_tr_b16 a[4:5], v20 offset:16640
    v_mfma_f32_16x16x32_bf16 v[88:91], a[20:23], a[72:75], v[88:91]
    ds_read_b64_tr_b16 a[6:7], v20 offset:24832
    s_waitcnt lgkmcnt(4)
    v_mfma_f32_16x16x32_bf16 v[96:99], a[24:27], a[72:75], v[96:99]
    ds_read_b64_tr_b16 a[8:9], v26 offset:16640
    s_add_u32 s75, s37, 61440
    v_mfma_f32_16x16x32_bf16 v[100:103], a[24:27], a[76:79], v[100:103]
    ds_read_b64_tr_b16 a[10:11], v26 offset:24832
    v_mfma_f32_16x16x32_bf16 v[108:111], a[28:31], a[76:79], v[108:111]
    ds_read_b64_tr_b16 a[12:13], v27 offset:16640
    v_mfma_f32_16x16x32_bf16 v[104:107], a[28:31], a[72:75], v[104:107]
    ds_read_b64_tr_b16 a[14:15], v27 offset:24832
    s_waitcnt vmcnt(12)
    s_barrier
    s_waitcnt lgkmcnt(4)
    v_mfma_f32_16x16x32_bf16 v[112:115], a[0:3], a[72:75], v[112:115]
    ds_read_b64_tr_b16 a[16:17], v17 offset:32768
    v_mfma_f32_16x16x32_bf16 v[116:119], a[0:3], a[76:79], v[116:119]
    ds_read_b64_tr_b16 a[18:19], v17 offset:40960
    s_add_u32 s70, s47, 200704
    v_mfma_f32_16x16x32_bf16 v[124:127], a[4:7], a[76:79], v[124:127]
    ds_read_b64_tr_b16 a[20:21], v18 offset:32768
    v_mfma_f32_16x16x32_bf16 v[120:123], a[4:7], a[72:75], v[120:123]
    ds_read_b64_tr_b16 a[22:23], v18 offset:40960
    s_waitcnt lgkmcnt(4)
    v_mfma_f32_16x16x32_bf16 v[136:139], a[8:11], a[72:75], v[136:139]
    ds_read_b64_tr_b16 a[24:25], v19 offset:32768
    v_mfma_f32_16x16x32_bf16 v[140:143], a[8:11], a[76:79], v[140:143]
    ds_read_b64_tr_b16 a[26:27], v19 offset:40960
    v_mfma_f32_16x16x32_bf16 v[156:159], a[12:15], a[76:79], v[156:159]
    ds_read_b64_tr_b16 a[28:29], v20 offset:32768
    v_mfma_f32_16x16x32_bf16 v[152:155], a[12:15], a[72:75], v[152:155]
    ds_read_b64_tr_b16 a[30:31], v20 offset:40960
    s_waitcnt lgkmcnt(4)
    v_mfma_f32_16x16x32_bf16 v[32:35], a[16:19], a[80:83], v[32:35]
    ds_read_b64_tr_b16 a[0:1], v26 offset:32768
    v_mfma_f32_16x16x32_bf16 v[36:39], a[16:19], a[84:87], v[36:39]
    ds_read_b64_tr_b16 a[2:3], v26 offset:40960
    v_mfma_f32_16x16x32_bf16 v[44:47], a[20:23], a[84:87], v[44:47]
    ds_read_b64_tr_b16 a[4:5], v27 offset:32768
    s_add_u32 m0, s32, 114688
    v_mfma_f32_16x16x32_bf16 v[40:43], a[20:23], a[80:83], v[40:43]
    ds_read_b64_tr_b16 a[6:7], v27 offset:40960
    s_waitcnt lgkmcnt(4)
    v_mfma_f32_16x16x32_bf16 v[48:51], a[24:27], a[80:83], v[48:51]
    ds_read_b64_tr_b16 a[8:9], v28 offset:32768
    v_mfma_f32_16x16x32_bf16 v[52:55], a[24:27], a[84:87], v[52:55]
    ds_read_b64_tr_b16 a[10:11], v28 offset:40960
    v_mfma_f32_16x16x32_bf16 v[60:63], a[28:31], a[84:87], v[60:63]
    ds_read_b64_tr_b16 a[12:13], v29 offset:32768
    v_mfma_f32_16x16x32_bf16 v[56:59], a[28:31], a[80:83], v[56:59]
    ds_read_b64_tr_b16 a[14:15], v29 offset:40960
    s_waitcnt lgkmcnt(4)
    v_mfma_f32_16x16x32_bf16 v[64:67], a[0:3], a[80:83], v[64:67]
    ds_read_b64_tr_b16 a[16:17], v17 offset:33024
    v_mfma_f32_16x16x32_bf16 v[68:71], a[0:3], a[84:87], v[68:71]
    ds_read_b64_tr_b16 a[18:19], v17 offset:41216
    v_mfma_f32_16x16x32_bf16 v[76:79], a[4:7], a[84:87], v[76:79]
    ds_read_b64_tr_b16 a[20:21], v18 offset:33024
    v_mfma_f32_16x16x32_bf16 v[72:75], a[4:7], a[80:83], v[72:75]
    ds_read_b64_tr_b16 a[22:23], v18 offset:41216
    s_waitcnt lgkmcnt(4)
    v_mfma_f32_16x16x32_bf16 v[80:83], a[8:11], a[80:83], v[80:83]
    ds_read_b64_tr_b16 a[24:25], v19 offset:33024
    buffer_load_dwordx4 v21, s[12:15], s70 offen offset:0 sc1 lds
    v_mfma_f32_16x16x32_bf16 v[84:87], a[8:11], a[84:87], v[84:87]
    ds_read_b64_tr_b16 a[26:27], v19 offset:41216
    v_mfma_f32_16x16x32_bf16 v[92:95], a[12:15], a[84:87], v[92:95]
    ds_read_b64_tr_b16 a[28:29], v20 offset:33024
    v_mfma_f32_16x16x32_bf16 v[88:91], a[12:15], a[80:83], v[88:91]
    ds_read_b64_tr_b16 a[30:31], v20 offset:41216
    s_waitcnt lgkmcnt(4)
    v_mfma_f32_16x16x32_bf16 v[96:99], a[16:19], a[80:83], v[96:99]
    ds_read_b64_tr_b16 a[0:1], v26 offset:33024
    v_mfma_f32_16x16x32_bf16 v[100:103], a[16:19], a[84:87], v[100:103]
    ds_read_b64_tr_b16 a[2:3], v26 offset:41216
    v_mfma_f32_16x16x32_bf16 v[108:111], a[20:23], a[84:87], v[108:111]
    ds_read_b64_tr_b16 a[4:5], v27 offset:33024
    v_mfma_f32_16x16x32_bf16 v[104:107], a[20:23], a[80:83], v[104:107]
    ds_read_b64_tr_b16 a[6:7], v27 offset:41216
    s_waitcnt lgkmcnt(4)
    v_mfma_f32_16x16x32_bf16 v[112:115], a[24:27], a[80:83], v[112:115]
    ds_read_b64_tr_b16 a[8:9], v17 offset:49152
    buffer_load_dwordx4 v22, s[12:15], s70 offen offset:1024 sc1 lds
    v_mfma_f32_16x16x32_bf16 v[116:119], a[24:27], a[84:87], v[116:119]
    ds_read_b64_tr_b16 a[10:11], v17 offset:57344
    v_mfma_f32_16x16x32_bf16 v[124:127], a[28:31], a[84:87], v[124:127]
    ds_read_b64_tr_b16 a[12:13], v18 offset:49152
    v_mfma_f32_16x16x32_bf16 v[120:123], a[28:31], a[80:83], v[120:123]
    ds_read_b64_tr_b16 a[14:15], v18 offset:57344
    s_waitcnt lgkmcnt(4)
    v_mfma_f32_16x16x32_bf16 v[136:139], a[0:3], a[80:83], v[136:139]
    ds_read_b64_tr_b16 a[16:17], v19 offset:49152
    v_mfma_f32_16x16x32_bf16 v[140:143], a[0:3], a[84:87], v[140:143]
    ds_read_b64_tr_b16 a[18:19], v19 offset:57344
    v_mfma_f32_16x16x32_bf16 v[156:159], a[4:7], a[84:87], v[156:159]
    ds_read_b64_tr_b16 a[20:21], v20 offset:49152
    v_mfma_f32_16x16x32_bf16 v[152:155], a[4:7], a[80:83], v[152:155]
    ds_read_b64_tr_b16 a[22:23], v20 offset:57344
    s_waitcnt lgkmcnt(4)
    v_mfma_f32_16x16x32_bf16 v[32:35], a[8:11], a[88:91], v[32:35]
    ds_read_b64_tr_b16 a[24:25], v26 offset:49152
    v_mfma_f32_16x16x32_bf16 v[36:39], a[8:11], a[92:95], v[36:39]
    ds_read_b64_tr_b16 a[26:27], v26 offset:57344
    buffer_load_dwordx4 v23, s[12:15], s70 offen offset:2048 sc1 lds
    v_mfma_f32_16x16x32_bf16 v[44:47], a[12:15], a[92:95], v[44:47]
    ds_read_b64_tr_b16 a[28:29], v27 offset:49152
    v_mfma_f32_16x16x32_bf16 v[40:43], a[12:15], a[88:91], v[40:43]
    ds_read_b64_tr_b16 a[30:31], v27 offset:57344
    s_waitcnt lgkmcnt(4)
    v_mfma_f32_16x16x32_bf16 v[48:51], a[16:19], a[88:91], v[48:51]
    ds_read_b64_tr_b16 a[0:1], v28 offset:49152
    v_mfma_f32_16x16x32_bf16 v[52:55], a[16:19], a[92:95], v[52:55]
    ds_read_b64_tr_b16 a[2:3], v28 offset:57344
    v_mfma_f32_16x16x32_bf16 v[60:63], a[20:23], a[92:95], v[60:63]
    ds_read_b64_tr_b16 a[4:5], v29 offset:49152
    v_mfma_f32_16x16x32_bf16 v[56:59], a[20:23], a[88:91], v[56:59]
    ds_read_b64_tr_b16 a[6:7], v29 offset:57344
    s_waitcnt lgkmcnt(4)
    v_mfma_f32_16x16x32_bf16 v[64:67], a[24:27], a[88:91], v[64:67]
    ds_read_b64_tr_b16 a[8:9], v17 offset:49408
    v_mfma_f32_16x16x32_bf16 v[68:71], a[24:27], a[92:95], v[68:71]
    ds_read_b64_tr_b16 a[10:11], v17 offset:57600
    v_mfma_f32_16x16x32_bf16 v[76:79], a[28:31], a[92:95], v[76:79]
    ds_read_b64_tr_b16 a[12:13], v18 offset:49408
    buffer_load_dwordx4 v24, s[12:15], s70 offen offset:3072 sc1 lds
    v_mfma_f32_16x16x32_bf16 v[72:75], a[28:31], a[88:91], v[72:75]
    ds_read_b64_tr_b16 a[14:15], v18 offset:57600
    s_waitcnt lgkmcnt(4)
    v_mfma_f32_16x16x32_bf16 v[80:83], a[0:3], a[88:91], v[80:83]
    ds_read_b64_tr_b16 a[16:17], v19 offset:49408
    v_mfma_f32_16x16x32_bf16 v[84:87], a[0:3], a[92:95], v[84:87]
    ds_read_b64_tr_b16 a[18:19], v19 offset:57600
    v_mfma_f32_16x16x32_bf16 v[92:95], a[4:7], a[92:95], v[92:95]
    ds_read_b64_tr_b16 a[20:21], v20 offset:49408
    v_mfma_f32_16x16x32_bf16 v[88:91], a[4:7], a[88:91], v[88:91]
    ds_read_b64_tr_b16 a[22:23], v20 offset:57600
    s_waitcnt lgkmcnt(4)
    v_mfma_f32_16x16x32_bf16 v[96:99], a[8:11], a[88:91], v[96:99]
    ds_read_b64_tr_b16 a[24:25], v26 offset:49408
    v_mfma_f32_16x16x32_bf16 v[100:103], a[8:11], a[92:95], v[100:103]
    ds_read_b64_tr_b16 a[26:27], v26 offset:57600
    v_mfma_f32_16x16x32_bf16 v[108:111], a[12:15], a[92:95], v[108:111]
    ds_read_b64_tr_b16 a[28:29], v27 offset:49408
    v_mfma_f32_16x16x32_bf16 v[104:107], a[12:15], a[88:91], v[104:107]
    ds_read_b64_tr_b16 a[30:31], v27 offset:57600
    s_waitcnt vmcnt(8)
    s_barrier
    s_waitcnt lgkmcnt(4)
    v_mfma_f32_16x16x32_bf16 v[112:115], a[16:19], a[88:91], v[112:115]
    ds_read_b64_tr_b16 a[0:1], v5 offset:0
    v_mfma_f32_16x16x32_bf16 v[116:119], a[16:19], a[92:95], v[116:119]
    ds_read_b64_tr_b16 a[2:3], v5 offset:8192
    v_mfma_f32_16x16x32_bf16 v[124:127], a[20:23], a[92:95], v[124:127]
    ds_read_b64_tr_b16 a[4:5], v6 offset:0
    v_mfma_f32_16x16x32_bf16 v[120:123], a[20:23], a[88:91], v[120:123]
    ds_read_b64_tr_b16 a[6:7], v6 offset:8192
    s_waitcnt lgkmcnt(4)
    v_mfma_f32_16x16x32_bf16 v[136:139], a[24:27], a[88:91], v[136:139]
    ds_read_b64_tr_b16 a[8:9], v7 offset:0
    v_mfma_f32_16x16x32_bf16 v[140:143], a[24:27], a[92:95], v[140:143]
    ds_read_b64_tr_b16 a[10:11], v7 offset:8192
    v_mfma_f32_16x16x32_bf16 v[156:159], a[28:31], a[92:95], v[156:159]
    ds_read_b64_tr_b16 a[12:13], v8 offset:0
    v_mfma_f32_16x16x32_bf16 v[152:155], a[28:31], a[88:91], v[152:155]
    ds_read_b64_tr_b16 a[14:15], v8 offset:8192
    s_waitcnt lgkmcnt(4)
    v_mfma_f32_16x16x32_bf16 v[32:35], a[0:3], a[96:99], v[32:35]
    ds_read_b64_tr_b16 a[16:17], v9 offset:0
    v_mfma_f32_16x16x32_bf16 v[36:39], a[0:3], a[100:103], v[36:39]
    ds_read_b64_tr_b16 a[18:19], v9 offset:8192
    v_mfma_f32_16x16x32_bf16 v[44:47], a[4:7], a[100:103], v[44:47]
    ds_read_b64_tr_b16 a[20:21], v10 offset:0
    v_mfma_f32_16x16x32_bf16 v[40:43], a[4:7], a[96:99], v[40:43]
    ds_read_b64_tr_b16 a[22:23], v10 offset:8192
    s_waitcnt lgkmcnt(4)
    v_mfma_f32_16x16x32_bf16 v[48:51], a[8:11], a[96:99], v[48:51]
    ds_read_b64_tr_b16 a[24:25], v11 offset:0
    v_mfma_f32_16x16x32_bf16 v[52:55], a[8:11], a[100:103], v[52:55]
    ds_read_b64_tr_b16 a[26:27], v11 offset:8192
    v_mfma_f32_16x16x32_bf16 v[60:63], a[12:15], a[100:103], v[60:63]
    ds_read_b64_tr_b16 a[28:29], v12 offset:0
    v_mfma_f32_16x16x32_bf16 v[56:59], a[12:15], a[96:99], v[56:59]
    ds_read_b64_tr_b16 a[30:31], v12 offset:8192
    s_waitcnt lgkmcnt(4)
    v_mfma_f32_16x16x32_bf16 v[64:67], a[16:19], a[96:99], v[64:67]
    ds_read_b64_tr_b16 a[0:1], v5 offset:256
    v_mfma_f32_16x16x32_bf16 v[68:71], a[16:19], a[100:103], v[68:71]
    ds_read_b64_tr_b16 a[2:3], v5 offset:8448
    v_mfma_f32_16x16x32_bf16 v[76:79], a[20:23], a[100:103], v[76:79]
    ds_read_b64_tr_b16 a[4:5], v6 offset:256
    v_mfma_f32_16x16x32_bf16 v[72:75], a[20:23], a[96:99], v[72:75]
    ds_read_b64_tr_b16 a[6:7], v6 offset:8448
    s_waitcnt lgkmcnt(4)
    v_mfma_f32_16x16x32_bf16 v[80:83], a[24:27], a[96:99], v[80:83]
    ds_read_b64_tr_b16 a[8:9], v7 offset:256
    v_mfma_f32_16x16x32_bf16 v[84:87], a[24:27], a[100:103], v[84:87]
    ds_read_b64_tr_b16 a[10:11], v7 offset:8448
    v_mfma_f32_16x16x32_bf16 v[92:95], a[28:31], a[100:103], v[92:95]
    ds_read_b64_tr_b16 a[12:13], v8 offset:256
    v_mfma_f32_16x16x32_bf16 v[88:91], a[28:31], a[96:99], v[88:91]
    ds_read_b64_tr_b16 a[14:15], v8 offset:8448
    s_waitcnt lgkmcnt(4)
    v_mfma_f32_16x16x32_bf16 v[96:99], a[0:3], a[96:99], v[96:99]
    ds_read_b64_tr_b16 a[16:17], v9 offset:256
    v_mfma_f32_16x16x32_bf16 v[100:103], a[0:3], a[100:103], v[100:103]
    ds_read_b64_tr_b16 a[18:19], v9 offset:8448
    v_mfma_f32_16x16x32_bf16 v[108:111], a[4:7], a[100:103], v[108:111]
    ds_read_b64_tr_b16 a[20:21], v10 offset:256
    v_mfma_f32_16x16x32_bf16 v[104:107], a[4:7], a[96:99], v[104:107]
    ds_read_b64_tr_b16 a[22:23], v10 offset:8448
    s_waitcnt lgkmcnt(4)
    v_mfma_f32_16x16x32_bf16 v[112:115], a[8:11], a[96:99], v[112:115]
    ds_read_b64_tr_b16 a[24:25], v5 offset:16384
    v_mfma_f32_16x16x32_bf16 v[116:119], a[8:11], a[100:103], v[116:119]
    ds_read_b64_tr_b16 a[26:27], v5 offset:24576
    v_mfma_f32_16x16x32_bf16 v[124:127], a[12:15], a[100:103], v[124:127]
    ds_read_b64_tr_b16 a[28:29], v6 offset:16384
    v_mfma_f32_16x16x32_bf16 v[120:123], a[12:15], a[96:99], v[120:123]
    ds_read_b64_tr_b16 a[30:31], v6 offset:24576
    s_waitcnt lgkmcnt(4)
    v_mfma_f32_16x16x32_bf16 v[136:139], a[16:19], a[96:99], v[136:139]
    ds_read_b64_tr_b16 a[0:1], v7 offset:16384
    v_mfma_f32_16x16x32_bf16 v[140:143], a[16:19], a[100:103], v[140:143]
    ds_read_b64_tr_b16 a[2:3], v7 offset:24576
    v_mfma_f32_16x16x32_bf16 v[156:159], a[20:23], a[100:103], v[156:159]
    ds_read_b64_tr_b16 a[4:5], v8 offset:16384
    v_mfma_f32_16x16x32_bf16 v[152:155], a[20:23], a[96:99], v[152:155]
    ds_read_b64_tr_b16 a[6:7], v8 offset:24576
    s_waitcnt lgkmcnt(4)
    v_mfma_f32_16x16x32_bf16 v[32:35], a[24:27], a[104:107], v[32:35]
    ds_read_b64_tr_b16 a[8:9], v9 offset:16384
    v_mfma_f32_16x16x32_bf16 v[36:39], a[24:27], a[108:111], v[36:39]
    ds_read_b64_tr_b16 a[10:11], v9 offset:24576
    v_mfma_f32_16x16x32_bf16 v[44:47], a[28:31], a[108:111], v[44:47]
    ds_read_b64_tr_b16 a[12:13], v10 offset:16384
    v_mfma_f32_16x16x32_bf16 v[40:43], a[28:31], a[104:107], v[40:43]
    ds_read_b64_tr_b16 a[14:15], v10 offset:24576
    s_waitcnt lgkmcnt(4)
    v_mfma_f32_16x16x32_bf16 v[48:51], a[0:3], a[104:107], v[48:51]
    ds_read_b64_tr_b16 a[16:17], v11 offset:16384
    v_mfma_f32_16x16x32_bf16 v[52:55], a[0:3], a[108:111], v[52:55]
    ds_read_b64_tr_b16 a[18:19], v11 offset:24576
    v_mfma_f32_16x16x32_bf16 v[60:63], a[4:7], a[108:111], v[60:63]
    ds_read_b64_tr_b16 a[20:21], v12 offset:16384
    v_mfma_f32_16x16x32_bf16 v[56:59], a[4:7], a[104:107], v[56:59]
    ds_read_b64_tr_b16 a[22:23], v12 offset:24576
    s_waitcnt lgkmcnt(4)
    v_mfma_f32_16x16x32_bf16 v[64:67], a[8:11], a[104:107], v[64:67]
    ds_read_b64_tr_b16 a[24:25], v5 offset:16640
    v_mfma_f32_16x16x32_bf16 v[68:71], a[8:11], a[108:111], v[68:71]
    ds_read_b64_tr_b16 a[26:27], v5 offset:24832
    v_mfma_f32_16x16x32_bf16 v[76:79], a[12:15], a[108:111], v[76:79]
    ds_read_b64_tr_b16 a[28:29], v6 offset:16640
    v_mfma_f32_16x16x32_bf16 v[72:75], a[12:15], a[104:107], v[72:75]
    ds_read_b64_tr_b16 a[30:31], v6 offset:24832
    s_waitcnt lgkmcnt(4)
    v_mfma_f32_16x16x32_bf16 v[80:83], a[16:19], a[104:107], v[80:83]
    ds_read_b64_tr_b16 a[0:1], v7 offset:16640
    v_mfma_f32_16x16x32_bf16 v[84:87], a[16:19], a[108:111], v[84:87]
    ds_read_b64_tr_b16 a[2:3], v7 offset:24832
    v_mfma_f32_16x16x32_bf16 v[92:95], a[20:23], a[108:111], v[92:95]
    ds_read_b64_tr_b16 a[4:5], v8 offset:16640
    v_mfma_f32_16x16x32_bf16 v[88:91], a[20:23], a[104:107], v[88:91]
    ds_read_b64_tr_b16 a[6:7], v8 offset:24832
    s_waitcnt lgkmcnt(4)
    v_mfma_f32_16x16x32_bf16 v[96:99], a[24:27], a[104:107], v[96:99]
    ds_read_b64_tr_b16 a[8:9], v9 offset:16640
    v_mfma_f32_16x16x32_bf16 v[100:103], a[24:27], a[108:111], v[100:103]
    ds_read_b64_tr_b16 a[10:11], v9 offset:24832
    v_mfma_f32_16x16x32_bf16 v[108:111], a[28:31], a[108:111], v[108:111]
    ds_read_b64_tr_b16 a[12:13], v10 offset:16640
    v_mfma_f32_16x16x32_bf16 v[104:107], a[28:31], a[104:107], v[104:107]
    ds_read_b64_tr_b16 a[14:15], v10 offset:24832
    s_waitcnt vmcnt(0)
    s_barrier
    s_waitcnt lgkmcnt(4)
    v_mfma_f32_16x16x32_bf16 v[112:115], a[0:3], a[104:107], v[112:115]
    ds_read_b64_tr_b16 a[16:17], v5 offset:32768
    v_mfma_f32_16x16x32_bf16 v[116:119], a[0:3], a[108:111], v[116:119]
    ds_read_b64_tr_b16 a[18:19], v5 offset:40960
    v_mfma_f32_16x16x32_bf16 v[124:127], a[4:7], a[108:111], v[124:127]
    ds_read_b64_tr_b16 a[20:21], v6 offset:32768
    v_mfma_f32_16x16x32_bf16 v[120:123], a[4:7], a[104:107], v[120:123]
    ds_read_b64_tr_b16 a[22:23], v6 offset:40960
    s_waitcnt lgkmcnt(4)
    v_mfma_f32_16x16x32_bf16 v[136:139], a[8:11], a[104:107], v[136:139]
    ds_read_b64_tr_b16 a[24:25], v7 offset:32768
    v_mfma_f32_16x16x32_bf16 v[140:143], a[8:11], a[108:111], v[140:143]
    ds_read_b64_tr_b16 a[26:27], v7 offset:40960
    v_mfma_f32_16x16x32_bf16 v[156:159], a[12:15], a[108:111], v[156:159]
    ds_read_b64_tr_b16 a[28:29], v8 offset:32768
    v_mfma_f32_16x16x32_bf16 v[152:155], a[12:15], a[104:107], v[152:155]
    ds_read_b64_tr_b16 a[30:31], v8 offset:40960
    s_waitcnt lgkmcnt(4)
    v_mfma_f32_16x16x32_bf16 v[32:35], a[16:19], a[112:115], v[32:35]
    ds_read_b64_tr_b16 a[0:1], v9 offset:32768
    v_mfma_f32_16x16x32_bf16 v[36:39], a[16:19], a[116:119], v[36:39]
    ds_read_b64_tr_b16 a[2:3], v9 offset:40960
    v_mfma_f32_16x16x32_bf16 v[44:47], a[20:23], a[116:119], v[44:47]
    ds_read_b64_tr_b16 a[4:5], v10 offset:32768
    v_mfma_f32_16x16x32_bf16 v[40:43], a[20:23], a[112:115], v[40:43]
    ds_read_b64_tr_b16 a[6:7], v10 offset:40960
    s_waitcnt lgkmcnt(4)
    v_mfma_f32_16x16x32_bf16 v[48:51], a[24:27], a[112:115], v[48:51]
    ds_read_b64_tr_b16 a[8:9], v11 offset:32768
    v_mfma_f32_16x16x32_bf16 v[52:55], a[24:27], a[116:119], v[52:55]
    ds_read_b64_tr_b16 a[10:11], v11 offset:40960
    v_mfma_f32_16x16x32_bf16 v[60:63], a[28:31], a[116:119], v[60:63]
    ds_read_b64_tr_b16 a[12:13], v12 offset:32768
    v_mfma_f32_16x16x32_bf16 v[56:59], a[28:31], a[112:115], v[56:59]
    ds_read_b64_tr_b16 a[14:15], v12 offset:40960
    s_waitcnt lgkmcnt(4)
    v_mfma_f32_16x16x32_bf16 v[64:67], a[0:3], a[112:115], v[64:67]
    ds_read_b64_tr_b16 a[16:17], v5 offset:33024
    v_mfma_f32_16x16x32_bf16 v[68:71], a[0:3], a[116:119], v[68:71]
    ds_read_b64_tr_b16 a[18:19], v5 offset:41216
    v_mfma_f32_16x16x32_bf16 v[76:79], a[4:7], a[116:119], v[76:79]
    ds_read_b64_tr_b16 a[20:21], v6 offset:33024
    v_mfma_f32_16x16x32_bf16 v[72:75], a[4:7], a[112:115], v[72:75]
    ds_read_b64_tr_b16 a[22:23], v6 offset:41216
    s_waitcnt lgkmcnt(4)
    v_mfma_f32_16x16x32_bf16 v[80:83], a[8:11], a[112:115], v[80:83]
    ds_read_b64_tr_b16 a[24:25], v7 offset:33024
    v_mfma_f32_16x16x32_bf16 v[84:87], a[8:11], a[116:119], v[84:87]
    ds_read_b64_tr_b16 a[26:27], v7 offset:41216
    v_mfma_f32_16x16x32_bf16 v[92:95], a[12:15], a[116:119], v[92:95]
    ds_read_b64_tr_b16 a[28:29], v8 offset:33024
    v_mfma_f32_16x16x32_bf16 v[88:91], a[12:15], a[112:115], v[88:91]
    ds_read_b64_tr_b16 a[30:31], v8 offset:41216
    s_waitcnt lgkmcnt(4)
    v_mfma_f32_16x16x32_bf16 v[96:99], a[16:19], a[112:115], v[96:99]
    ds_read_b64_tr_b16 a[0:1], v9 offset:33024
    v_mfma_f32_16x16x32_bf16 v[100:103], a[16:19], a[116:119], v[100:103]
    ds_read_b64_tr_b16 a[2:3], v9 offset:41216
    v_mfma_f32_16x16x32_bf16 v[108:111], a[20:23], a[116:119], v[108:111]
    ds_read_b64_tr_b16 a[4:5], v10 offset:33024
    v_mfma_f32_16x16x32_bf16 v[104:107], a[20:23], a[112:115], v[104:107]
    ds_read_b64_tr_b16 a[6:7], v10 offset:41216
    s_waitcnt lgkmcnt(4)
    v_mfma_f32_16x16x32_bf16 v[112:115], a[24:27], a[112:115], v[112:115]
    ds_read_b64_tr_b16 a[8:9], v5 offset:49152
    v_mfma_f32_16x16x32_bf16 v[116:119], a[24:27], a[116:119], v[116:119]
    ds_read_b64_tr_b16 a[10:11], v5 offset:57344
    v_mfma_f32_16x16x32_bf16 v[124:127], a[28:31], a[116:119], v[124:127]
    ds_read_b64_tr_b16 a[12:13], v6 offset:49152
    v_mfma_f32_16x16x32_bf16 v[120:123], a[28:31], a[112:115], v[120:123]
    ds_read_b64_tr_b16 a[14:15], v6 offset:57344
    s_waitcnt lgkmcnt(4)
    v_mfma_f32_16x16x32_bf16 v[136:139], a[0:3], a[112:115], v[136:139]
    ds_read_b64_tr_b16 a[16:17], v7 offset:49152
    v_mfma_f32_16x16x32_bf16 v[140:143], a[0:3], a[116:119], v[140:143]
    ds_read_b64_tr_b16 a[18:19], v7 offset:57344
    v_mfma_f32_16x16x32_bf16 v[156:159], a[4:7], a[116:119], v[156:159]
    ds_read_b64_tr_b16 a[20:21], v8 offset:49152
    v_mfma_f32_16x16x32_bf16 v[152:155], a[4:7], a[112:115], v[152:155]
    ds_read_b64_tr_b16 a[22:23], v8 offset:57344
    s_waitcnt lgkmcnt(4)
    v_mfma_f32_16x16x32_bf16 v[32:35], a[8:11], a[120:123], v[32:35]
    ds_read_b64_tr_b16 a[24:25], v9 offset:49152
    v_mfma_f32_16x16x32_bf16 v[36:39], a[8:11], a[124:127], v[36:39]
    ds_read_b64_tr_b16 a[26:27], v9 offset:57344
    v_mfma_f32_16x16x32_bf16 v[44:47], a[12:15], a[124:127], v[44:47]
    ds_read_b64_tr_b16 a[28:29], v10 offset:49152
    v_mfma_f32_16x16x32_bf16 v[40:43], a[12:15], a[120:123], v[40:43]
    ds_read_b64_tr_b16 a[30:31], v10 offset:57344
    s_waitcnt lgkmcnt(4)
    v_mfma_f32_16x16x32_bf16 v[48:51], a[16:19], a[120:123], v[48:51]
    ds_read_b64_tr_b16 a[0:1], v11 offset:49152
    v_mfma_f32_16x16x32_bf16 v[52:55], a[16:19], a[124:127], v[52:55]
    ds_read_b64_tr_b16 a[2:3], v11 offset:57344
    v_mfma_f32_16x16x32_bf16 v[60:63], a[20:23], a[124:127], v[60:63]
    ds_read_b64_tr_b16 a[4:5], v12 offset:49152
    v_mfma_f32_16x16x32_bf16 v[56:59], a[20:23], a[120:123], v[56:59]
    ds_read_b64_tr_b16 a[6:7], v12 offset:57344
    s_waitcnt lgkmcnt(4)
    v_mfma_f32_16x16x32_bf16 v[64:67], a[24:27], a[120:123], v[64:67]
    ds_read_b64_tr_b16 a[8:9], v5 offset:49408
    v_mfma_f32_16x16x32_bf16 v[68:71], a[24:27], a[124:127], v[68:71]
    ds_read_b64_tr_b16 a[10:11], v5 offset:57600
    v_mfma_f32_16x16x32_bf16 v[76:79], a[28:31], a[124:127], v[76:79]
    ds_read_b64_tr_b16 a[12:13], v6 offset:49408
    v_mfma_f32_16x16x32_bf16 v[72:75], a[28:31], a[120:123], v[72:75]
    ds_read_b64_tr_b16 a[14:15], v6 offset:57600
    s_waitcnt lgkmcnt(4)
    v_mfma_f32_16x16x32_bf16 v[80:83], a[0:3], a[120:123], v[80:83]
    ds_read_b64_tr_b16 a[16:17], v7 offset:49408
    v_mfma_f32_16x16x32_bf16 v[84:87], a[0:3], a[124:127], v[84:87]
    ds_read_b64_tr_b16 a[18:19], v7 offset:57600
    v_mfma_f32_16x16x32_bf16 v[92:95], a[4:7], a[124:127], v[92:95]
    ds_read_b64_tr_b16 a[20:21], v8 offset:49408
    v_mfma_f32_16x16x32_bf16 v[88:91], a[4:7], a[120:123], v[88:91]
    ds_read_b64_tr_b16 a[22:23], v8 offset:57600
    s_waitcnt lgkmcnt(4)
    v_mfma_f32_16x16x32_bf16 v[96:99], a[8:11], a[120:123], v[96:99]
    ds_read_b64_tr_b16 a[24:25], v9 offset:49408
    v_mfma_f32_16x16x32_bf16 v[100:103], a[8:11], a[124:127], v[100:103]
    ds_read_b64_tr_b16 a[26:27], v9 offset:57600
    v_mfma_f32_16x16x32_bf16 v[108:111], a[12:15], a[124:127], v[108:111]
    ds_read_b64_tr_b16 a[28:29], v10 offset:49408
    v_mfma_f32_16x16x32_bf16 v[104:107], a[12:15], a[120:123], v[104:107]
    ds_read_b64_tr_b16 a[30:31], v10 offset:57600
    s_waitcnt lgkmcnt(4)
    v_mfma_f32_16x16x32_bf16 v[112:115], a[16:19], a[120:123], v[112:115]
    v_mfma_f32_16x16x32_bf16 v[116:119], a[16:19], a[124:127], v[116:119]
    v_mfma_f32_16x16x32_bf16 v[124:127], a[20:23], a[124:127], v[124:127]
    v_mfma_f32_16x16x32_bf16 v[120:123], a[20:23], a[120:123], v[120:123]
    s_waitcnt lgkmcnt(0)
    v_mfma_f32_16x16x32_bf16 v[136:139], a[24:27], a[120:123], v[136:139]
    v_mfma_f32_16x16x32_bf16 v[140:143], a[24:27], a[124:127], v[140:143]
    v_mfma_f32_16x16x32_bf16 v[156:159], a[28:31], a[124:127], v[156:159]
    v_mfma_f32_16x16x32_bf16 v[152:155], a[28:31], a[120:123], v[152:155]
    s_branch ou_sum
ou_odd:
    ds_read_b64_tr_b16 a[0:1], v17 offset:0
    ds_read_b64_tr_b16 a[2:3], v17 offset:8192
    ds_read_b64_tr_b16 a[4:5], v18 offset:0
    ds_read_b64_tr_b16 a[6:7], v18 offset:8192
    ds_read_b64_tr_b16 a[8:9], v19 offset:0
    ds_read_b64_tr_b16 a[10:11], v19 offset:8192
    ds_read_b64_tr_b16 a[12:13], v20 offset:0
    ds_read_b64_tr_b16 a[14:15], v20 offset:8192
    s_mov_b32 s12, s42
    s_mov_b32 s13, s43
    s_mov_b32 s14, 3670016
    s_mov_b32 s15, 0x20000
    s_waitcnt lgkmcnt(4)
    v_mfma_f32_16x16x32_bf16 v[32:35], a[0:3], a[196:199], 0
    ds_read_b64_tr_b16 a[16:17], v26 offset:0
    v_add_u32 v5, 0x10000, v17
    v_mfma_f32_16x16x32_bf16 v[36:39], a[0:3], a[200:203], 0
    ds_read_b64_tr_b16 a[18:19], v26 offset:8192
    s_add_u32 s70, s44, 57344
    v_mfma_f32_16x16x32_bf16 v[44:47], a[4:7], a[200:203], 0
    ds_read_b64_tr_b16 a[20:21], v27 offset:0
    s_add_u32 m0, s32, 32768
    v_mfma_f32_16x16x32_bf16 v[40:43], a[4:7], a[196:199], 0
    ds_read_b64_tr_b16 a[22:23], v27 offset:8192
    s_waitcnt lgkmcnt(4)
    v_mfma_f32_16x16x32_bf16 v[48:51], a[8:11], a[196:199], 0
    ds_read_b64_tr_b16 a[24:25], v28 offset:0
    buffer_load_dwordx4 v21, s[16:19], s70 offen offset:0 sc1 lds
    v_mfma_f32_16x16x32_bf16 v[52:55], a[8:11], a[200:203], 0
    ds_read_b64_tr_b16 a[26:27], v28 offset:8192
    v_add_u32 v6, 0x10000, v18
    v_mfma_f32_16x16x32_bf16 v[60:63], a[12:15], a[200:203], 0
    ds_read_b64_tr_b16 a[28:29], v29 offset:0
    buffer_load_dwordx4 v22, s[16:19], s70 offen offset:1024 sc1 lds
    v_mfma_f32_16x16x32_bf16 v[56:59], a[12:15], a[196:199], 0
    ds_read_b64_tr_b16 a[30:31], v29 offset:8192
    s_waitcnt lgkmcnt(4)
    v_mfma_f32_16x16x32_bf16 v[64:67], a[16:19], a[196:199], 0
    ds_read_b64_tr_b16 a[0:1], v17 offset:256
    buffer_load_dwordx4 v23, s[16:19], s70 offen offset:2048 sc1 lds
    v_mfma_f32_16x16x32_bf16 v[68:71], a[16:19], a[200:203], 0
    ds_read_b64_tr_b16 a[2:3], v17 offset:8448
    v_mfma_f32_16x16x32_bf16 v[76:79], a[20:23], a[200:203], 0
    ds_read_b64_tr_b16 a[4:5], v18 offset:256
    buffer_load_dwordx4 v24, s[16:19], s70 offen offset:3072 sc1 lds
    v_mfma_f32_16x16x32_bf16 v[72:75], a[20:23], a[196:199], 0
    ds_read_b64_tr_b16 a[6:7], v18 offset:8448
    s_waitcnt lgkmcnt(4)
    v_mfma_f32_16x16x32_bf16 v[80:83], a[24:27], a[196:199], 0
    ds_read_b64_tr_b16 a[8:9], v19 offset:256
    v_add_u32 v7, 0x10000, v19
    v_mfma_f32_16x16x32_bf16 v[84:87], a[24:27], a[200:203], 0
    ds_read_b64_tr_b16 a[10:11], v19 offset:8448
    s_add_u32 s70, s45, 0
    v_mfma_f32_16x16x32_bf16 v[92:95], a[28:31], a[200:203], 0
    ds_read_b64_tr_b16 a[12:13], v20 offset:256
    s_add_u32 m0, s32, 49152
    v_mfma_f32_16x16x32_bf16 v[88:91], a[28:31], a[196:199], 0
    ds_read_b64_tr_b16 a[14:15], v20 offset:8448
    s_waitcnt lgkmcnt(4)
    v_mfma_f32_16x16x32_bf16 v[96:99], a[0:3], a[196:199], 0
    ds_read_b64_tr_b16 a[16:17], v26 offset:256
    buffer_load_dwordx4 v21, s[16:19], s70 offen offset:0 sc1 lds
    v_mfma_f32_16x16x32_bf16 v[100:103], a[0:3], a[200:203], 0
    ds_read_b64_tr_b16 a[18:19], v26 offset:8448
    v_add_u32 v8, 0x10000, v20
    v_mfma_f32_16x16x32_bf16 v[108:111], a[4:7], a[200:203], 0
    ds_read_b64_tr_b16 a[20:21], v27 offset:256
    buffer_load_dwordx4 v22, s[16:19], s70 offen offset:1024 sc1 lds
    v_mfma_f32_16x16x32_bf16 v[104:107], a[4:7], a[196:199], 0
    ds_read_b64_tr_b16 a[22:23], v27 offset:8448
    s_waitcnt lgkmcnt(4)
    v_mfma_f32_16x16x32_bf16 v[112:115], a[8:11], a[196:199], 0
    ds_read_b64_tr_b16 a[24:25], v17 offset:16384
    buffer_load_dwordx4 v23, s[16:19], s70 offen offset:2048 sc1 lds
    v_mfma_f32_16x16x32_bf16 v[116:119], a[8:11], a[200:203], 0
    ds_read_b64_tr_b16 a[26:27], v17 offset:24576
    v_mfma_f32_16x16x32_bf16 v[124:127], a[12:15], a[200:203], 0
    ds_read_b64_tr_b16 a[28:29], v18 offset:16384
    buffer_load_dwordx4 v24, s[16:19], s70 offen offset:3072 sc1 lds
    v_mfma_f32_16x16x32_bf16 v[120:123], a[12:15], a[196:199], 0
    ds_read_b64_tr_b16 a[30:31], v18 offset:24576
    s_waitcnt lgkmcnt(4)
    v_mfma_f32_16x16x32_bf16 v[136:139], a[16:19], a[196:199], 0
    ds_read_b64_tr_b16 a[0:1], v19 offset:16384
    v_add_u32 v9, 0x10000, v26
    v_mfma_f32_16x16x32_bf16 v[140:143], a[16:19], a[200:203], 0
    ds_read_b64_tr_b16 a[2:3], v19 offset:24576
    s_add_u32 s70, s45, 28672
    v_mfma_f32_16x16x32_bf16 v[156:159], a[20:23], a[200:203], 0
    ds_read_b64_tr_b16 a[4:5], v20 offset:16384
    s_add_u32 m0, s32, 65536
    v_mfma_f32_16x16x32_bf16 v[152:155], a[20:23], a[196:199], 0
    ds_read_b64_tr_b16 a[6:7], v20 offset:24576
    s_waitcnt lgkmcnt(4)
    v_mfma_f32_16x16x32_bf16 v[32:35], a[24:27], a[204:207], v[32:35]
    ds_read_b64_tr_b16 a[8:9], v26 offset:16384
    buffer_load_dwordx4 v21, s[16:19], s70 offen offset:0 sc1 lds
    v_mfma_f32_16x16x32_bf16 v[36:39], a[24:27], a[208:211], v[36:39]
    ds_read_b64_tr_b16 a[10:11], v26 offset:24576
    v_add_u32 v10, 0x10000, v27
    v_mfma_f32_16x16x32_bf16 v[44:47], a[28:31], a[208:211], v[44:47]
    ds_read_b64_tr_b16 a[12:13], v27 offset:16384
    buffer_load_dwordx4 v22, s[16:19], s70 offen offset:1024 sc1 lds
    v_mfma_f32_16x16x32_bf16 v[40:43], a[28:31], a[204:207], v[40:43]
    ds_read_b64_tr_b16 a[14:15], v27 offset:24576
    s_waitcnt lgkmcnt(4)
    v_mfma_f32_16x16x32_bf16 v[48:51], a[0:3], a[204:207], v[48:51]
    ds_read_b64_tr_b16 a[16:17], v28 offset:16384
    buffer_load_dwordx4 v23, s[16:19], s70 offen offset:2048 sc1 lds
    v_mfma_f32_16x16x32_bf16 v[52:55], a[0:3], a[208:211], v[52:55]
    ds_read_b64_tr_b16 a[18:19], v28 offset:24576
    buffer_load_dwordx4 v24, s[16:19], s70 offen offset:3072 sc1 lds
    v_mfma_f32_16x16x32_bf16 v[60:63], a[4:7], a[208:211], v[60:63]
    ds_read_b64_tr_b16 a[20:21], v29 offset:16384
    v_mfma_f32_16x16x32_bf16 v[56:59], a[4:7], a[204:207], v[56:59]
    ds_read_b64_tr_b16 a[22:23], v29 offset:24576
    s_waitcnt lgkmcnt(4)
    v_mfma_f32_16x16x32_bf16 v[64:67], a[8:11], a[204:207], v[64:67]
    ds_read_b64_tr_b16 a[24:25], v17 offset:16640
    v_add_u32 v11, 0x10000, v28
    v_mfma_f32_16x16x32_bf16 v[68:71], a[8:11], a[208:211], v[68:71]
    ds_read_b64_tr_b16 a[26:27], v17 offset:24832
    s_add_u32 s70, s45, 57344
    v_mfma_f32_16x16x32_bf16 v[76:79], a[12:15], a[208:211], v[76:79]
    ds_read_b64_tr_b16 a[28:29], v18 offset:16640
    s_add_u32 m0, s32, 81920
    v_mfma_f32_16x16x32_bf16 v[72:75], a[12:15], a[204:207], v[72:75]
    ds_read_b64_tr_b16 a[30:31], v18 offset:24832
    s_waitcnt lgkmcnt(4)
    v_mfma_f32_16x16x32_bf16 v[80:83], a[16:19], a[204:207], v[80:83]
    ds_read_b64_tr_b16 a[0:1], v19 offset:16640
    buffer_load_dwordx4 v21, s[16:19], s70 offen offset:0 sc1 lds
    v_mfma_f32_16x16x32_bf16 v[84:87], a[16:19], a[208:211], v[84:87]
    ds_read_b64_tr_b16 a[2:3], v19 offset:24832
    v_add_u32 v12, 0x10000, v29
    v_mfma_f32_16x16x32_bf16 v[92:95], a[20:23], a[208:211], v[92:95]
    ds_read_b64_tr_b16 a[4:5], v20 offset:16640
    buffer_load_dwordx4 v22, s[16:19], s70 offen offset:1024 sc1 lds
    v_mfma_f32_16x16x32_bf16 v[88:91], a[20:23], a[204:207], v[88:91]
    ds_read_b64_tr_b16 a[6:7], v20 offset:24832
    s_waitcnt lgkmcnt(4)
    v_mfma_f32_16x16x32_bf16 v[96:99], a[24:27], a[204:207], v[96:99]
    ds_read_b64_tr_b16 a[8:9], v26 offset:16640
    buffer_load_dwordx4 v23, s[16:19], s70 offen offset:2048 sc1 lds
    v_mfma_f32_16x16x32_bf16 v[100:103], a[24:27], a[208:211], v[100:103]
    ds_read_b64_tr_b16 a[10:11], v26 offset:24832
    buffer_load_dwordx4 v24, s[16:19], s70 offen offset:3072 sc1 lds
    v_mfma_f32_16x16x32_bf16 v[108:111], a[28:31], a[208:211], v[108:111]
    ds_read_b64_tr_b16 a[12:13], v27 offset:16640
    v_mfma_f32_16x16x32_bf16 v[104:107], a[28:31], a[204:207], v[104:107]
    ds_read_b64_tr_b16 a[14:15], v27 offset:24832
    s_waitcnt vmcnt(8)
    s_barrier
    s_waitcnt lgkmcnt(4)
    v_mfma_f32_16x16x32_bf16 v[112:115], a[0:3], a[204:207], v[112:115]
    ds_read_b64_tr_b16 a[16:17], v17 offset:32768
    v_mfma_f32_16x16x32_bf16 v[116:119], a[0:3], a[208:211], v[116:119]
    ds_read_b64_tr_b16 a[18:19], v17 offset:40960
    s_add_u32 s70, s46, 0
    v_mfma_f32_16x16x32_bf16 v[124:127], a[4:7], a[208:211], v[124:127]
    ds_read_b64_tr_b16 a[20:21], v18 offset:32768
    v_mfma_f32_16x16x32_bf16 v[120:123], a[4:7], a[204:207], v[120:123]
    ds_read_b64_tr_b16 a[22:23], v18 offset:40960
    s_waitcnt lgkmcnt(4)
    v_mfma_f32_16x16x32_bf16 v[136:139], a[8:11], a[204:207], v[136:139]
    ds_read_b64_tr_b16 a[24:25], v19 offset:32768
    s_add_u32 m0, s32, 98304
    v_mfma_f32_16x16x32_bf16 v[140:143], a[8:11], a[208:211], v[140:143]
    ds_read_b64_tr_b16 a[26:27], v19 offset:40960
    v_mfma_f32_16x16x32_bf16 v[156:159], a[12:15], a[208:211], v[156:159]
    ds_read_b64_tr_b16 a[28:29], v20 offset:32768
    v_mfma_f32_16x16x32_bf16 v[152:155], a[12:15], a[204:207], v[152:155]
    ds_read_b64_tr_b16 a[30:31], v20 offset:40960
    s_waitcnt lgkmcnt(4)
    v_mfma_f32_16x16x32_bf16 v[32:35], a[16:19], a[212:215], v[32:35]
    ds_read_b64_tr_b16 a[0:1], v26 offset:32768
    buffer_load_dwordx4 v21, s[12:15], s70 offen offset:0 sc1 lds
    v_mfma_f32_16x16x32_bf16 v[36:39], a[16:19], a[216:219], v[36:39]
    ds_read_b64_tr_b16 a[2:3], v26 offset:40960
    v_mfma_f32_16x16x32_bf16 v[44:47], a[20:23], a[216:219], v[44:47]
    ds_read_b64_tr_b16 a[4:5], v27 offset:32768
    buffer_load_dwordx4 v22, s[12:15], s70 offen offset:1024 sc1 lds
    v_mfma_f32_16x16x32_bf16 v[40:43], a[20:23], a[212:215], v[40:43]
    ds_read_b64_tr_b16 a[6:7], v27 offset:40960
    s_waitcnt lgkmcnt(4)
    v_mfma_f32_16x16x32_bf16 v[48:51], a[24:27], a[212:215], v[48:51]
    ds_read_b64_tr_b16 a[8:9], v28 offset:32768
    v_mfma_f32_16x16x32_bf16 v[52:55], a[24:27], a[216:219], v[52:55]
    ds_read_b64_tr_b16 a[10:11], v28 offset:40960
    buffer_load_dwordx4 v23, s[12:15], s70 offen offset:2048 sc1 lds
    v_mfma_f32_16x16x32_bf16 v[60:63], a[28:31], a[216:219], v[60:63]
    ds_read_b64_tr_b16 a[12:13], v29 offset:32768
    v_mfma_f32_16x16x32_bf16 v[56:59], a[28:31], a[212:215], v[56:59]
    ds_read_b64_tr_b16 a[14:15], v29 offset:40960
    s_waitcnt lgkmcnt(4)
    v_mfma_f32_16x16x32_bf16 v[64:67], a[0:3], a[212:215], v[64:67]
    ds_read_b64_tr_b16 a[16:17], v17 offset:33024
    buffer_load_dwordx4 v24, s[12:15], s70 offen offset:3072 sc1 lds
    v_mfma_f32_16x16x32_bf16 v[68:71], a[0:3], a[216:219], v[68:71]
    ds_read_b64_tr_b16 a[18:19], v17 offset:41216
    v_mfma_f32_16x16x32_bf16 v[76:79], a[4:7], a[216:219], v[76:79]
    ds_read_b64_tr_b16 a[20:21], v18 offset:33024
    v_mfma_f32_16x16x32_bf16 v[72:75], a[4:7], a[212:215], v[72:75]
    ds_read_b64_tr_b16 a[22:23], v18 offset:41216
    s_waitcnt lgkmcnt(4)
    v_mfma_f32_16x16x32_bf16 v[80:83], a[8:11], a[212:215], v[80:83]
    ds_read_b64_tr_b16 a[24:25], v19 offset:33024
    s_add_u32 s70, s46, 28672
    v_mfma_f32_16x16x32_bf16 v[84:87], a[8:11], a[216:219], v[84:87]
    ds_read_b64_tr_b16 a[26:27], v19 offset:41216
    v_mfma_f32_16x16x32_bf16 v[92:95], a[12:15], a[216:219], v[92:95]
    ds_read_b64_tr_b16 a[28:29], v20 offset:33024
    s_add_u32 m0, s32, 114688
    v_mfma_f32_16x16x32_bf16 v[88:91], a[12:15], a[212:215], v[88:91]
    ds_read_b64_tr_b16 a[30:31], v20 offset:41216
    s_waitcnt lgkmcnt(4)
    v_mfma_f32_16x16x32_bf16 v[96:99], a[16:19], a[212:215], v[96:99]
    ds_read_b64_tr_b16 a[0:1], v26 offset:33024
    v_mfma_f32_16x16x32_bf16 v[100:103], a[16:19], a[216:219], v[100:103]
    ds_read_b64_tr_b16 a[2:3], v26 offset:41216
    buffer_load_dwordx4 v21, s[12:15], s70 offen offset:0 sc1 lds
    v_mfma_f32_16x16x32_bf16 v[108:111], a[20:23], a[216:219], v[108:111]
    ds_read_b64_tr_b16 a[4:5], v27 offset:33024
    v_mfma_f32_16x16x32_bf16 v[104:107], a[20:23], a[212:215], v[104:107]
    ds_read_b64_tr_b16 a[6:7], v27 offset:41216
    s_waitcnt lgkmcnt(4)
    v_mfma_f32_16x16x32_bf16 v[112:115], a[24:27], a[212:215], v[112:115]
    ds_read_b64_tr_b16 a[8:9], v17 offset:49152
    buffer_load_dwordx4 v22, s[12:15], s70 offen offset:1024 sc1 lds
    v_mfma_f32_16x16x32_bf16 v[116:119], a[24:27], a[216:219], v[116:119]
    ds_read_b64_tr_b16 a[10:11], v17 offset:57344
    v_mfma_f32_16x16x32_bf16 v[124:127], a[28:31], a[216:219], v[124:127]
    ds_read_b64_tr_b16 a[12:13], v18 offset:49152
    v_mfma_f32_16x16x32_bf16 v[120:123], a[28:31], a[212:215], v[120:123]
    ds_read_b64_tr_b16 a[14:15], v18 offset:57344
    s_waitcnt lgkmcnt(4)
    v_mfma_f32_16x16x32_bf16 v[136:139], a[0:3], a[212:215], v[136:139]
    ds_read_b64_tr_b16 a[16:17], v19 offset:49152
    buffer_load_dwordx4 v23, s[12:15], s70 offen offset:2048 sc1 lds
    v_mfma_f32_16x16x32_bf16 v[140:143], a[0:3], a[216:219], v[140:143]
    ds_read_b64_tr_b16 a[18:19], v19 offset:57344
    v_mfma_f32_16x16x32_bf16 v[156:159], a[4:7], a[216:219], v[156:159]
    ds_read_b64_tr_b16 a[20:21], v20 offset:49152
    buffer_load_dwordx4 v24, s[12:15], s70 offen offset:3072 sc1 lds
    v_mfma_f32_16x16x32_bf16 v[152:155], a[4:7], a[212:215], v[152:155]
    ds_read_b64_tr_b16 a[22:23], v20 offset:57344
    s_waitcnt lgkmcnt(4)
    v_mfma_f32_16x16x32_bf16 v[32:35], a[8:11], a[32:35], v[32:35]
    ds_read_b64_tr_b16 a[24:25], v26 offset:49152
    v_mfma_f32_16x16x32_bf16 v[36:39], a[8:11], a[36:39], v[36:39]
    ds_read_b64_tr_b16 a[26:27], v26 offset:57344
    s_add_u32 s70, s46, 57344
    v_mfma_f32_16x16x32_bf16 v[44:47], a[12:15], a[36:39], v[44:47]
    ds_read_b64_tr_b16 a[28:29], v27 offset:49152
    v_mfma_f32_16x16x32_bf16 v[40:43], a[12:15], a[32:35], v[40:43]
    ds_read_b64_tr_b16 a[30:31], v27 offset:57344
    s_waitcnt lgkmcnt(4)
    v_mfma_f32_16x16x32_bf16 v[48:51], a[16:19], a[32:35], v[48:51]
    ds_read_b64_tr_b16 a[0:1], v28 offset:49152
    s_add_u32 m0, s32, 0
    v_mfma_f32_16x16x32_bf16 v[52:55], a[16:19], a[36:39], v[52:55]
    ds_read_b64_tr_b16 a[2:3], v28 offset:57344
    v_mfma_f32_16x16x32_bf16 v[60:63], a[20:23], a[36:39], v[60:63]
    ds_read_b64_tr_b16 a[4:5], v29 offset:49152
    v_mfma_f32_16x16x32_bf16 v[56:59], a[20:23], a[32:35], v[56:59]
    ds_read_b64_tr_b16 a[6:7], v29 offset:57344
    s_waitcnt lgkmcnt(4)
    v_mfma_f32_16x16x32_bf16 v[64:67], a[24:27], a[32:35], v[64:67]
    ds_read_b64_tr_b16 a[8:9], v17 offset:49408
    buffer_load_dwordx4 v21, s[12:15], s70 offen offset:0 sc1 lds
    v_mfma_f32_16x16x32_bf16 v[68:71], a[24:27], a[36:39], v[68:71]
    ds_read_b64_tr_b16 a[10:11], v17 offset:57600
    v_mfma_f32_16x16x32_bf16 v[76:79], a[28:31], a[36:39], v[76:79]
    ds_read_b64_tr_b16 a[12:13], v18 offset:49408
    buffer_load_dwordx4 v22, s[12:15], s70 offen offset:1024 sc1 lds
    v_mfma_f32_16x16x32_bf16 v[72:75], a[28:31], a[32:35], v[72:75]
    ds_read_b64_tr_b16 a[14:15], v18 offset:57600
    s_waitcnt lgkmcnt(4)
    v_mfma_f32_16x16x32_bf16 v[80:83], a[0:3], a[32:35], v[80:83]
    ds_read_b64_tr_b16 a[16:17], v19 offset:49408
    v_mfma_f32_16x16x32_bf16 v[84:87], a[0:3], a[36:39], v[84:87]
    ds_read_b64_tr_b16 a[18:19], v19 offset:57600
    buffer_load_dwordx4 v23, s[12:15], s70 offen offset:2048 sc1 lds
    v_mfma_f32_16x16x32_bf16 v[92:95], a[4:7], a[36:39], v[92:95]
    ds_read_b64_tr_b16 a[20:21], v20 offset:49408
    v_mfma_f32_16x16x32_bf16 v[88:91], a[4:7], a[32:35], v[88:91]
    ds_read_b64_tr_b16 a[22:23], v20 offset:57600
    s_waitcnt lgkmcnt(4)
    v_mfma_f32_16x16x32_bf16 v[96:99], a[8:11], a[32:35], v[96:99]
    ds_read_b64_tr_b16 a[24:25], v26 offset:49408
    buffer_load_dwordx4 v24, s[12:15], s70 offen offset:3072 sc1 lds
    v_mfma_f32_16x16x32_bf16 v[100:103], a[8:11], a[36:39], v[100:103]
    ds_read_b64_tr_b16 a[26:27], v26 offset:57600
    v_mfma_f32_16x16x32_bf16 v[108:111], a[12:15], a[36:39], v[108:111]
    ds_read_b64_tr_b16 a[28:29], v27 offset:49408
    v_mfma_f32_16x16x32_bf16 v[104:107], a[12:15], a[32:35], v[104:107]
    ds_read_b64_tr_b16 a[30:31], v27 offset:57600
    s_waitcnt vmcnt(12)
    s_barrier
    s_cmp_eq_u32 s20, 0
    s_cbranch_scc0 sig_68
    v_mov_b32 v2, 1
    v_mov_b32 v3, 0
    s_mov_b64 exec, 1
    buffer_atomic_add v2, v3, s[4:7], s33 offen sc1
    s_mov_b64 exec, -1
sig_68:
    s_waitcnt lgkmcnt(4)
    v_mfma_f32_16x16x32_bf16 v[112:115], a[16:19], a[32:35], v[112:115]
    ds_read_b64_tr_b16 a[0:1], v5 offset:0
    v_mfma_f32_16x16x32_bf16 v[116:119], a[16:19], a[36:39], v[116:119]
    ds_read_b64_tr_b16 a[2:3], v5 offset:8192
    s_add_u32 s70, s46, 86016
    v_mfma_f32_16x16x32_bf16 v[124:127], a[20:23], a[36:39], v[124:127]
    ds_read_b64_tr_b16 a[4:5], v6 offset:0
    v_mfma_f32_16x16x32_bf16 v[120:123], a[20:23], a[32:35], v[120:123]
    ds_read_b64_tr_b16 a[6:7], v6 offset:8192
    s_waitcnt lgkmcnt(4)
    v_mfma_f32_16x16x32_bf16 v[136:139], a[24:27], a[32:35], v[136:139]
    ds_read_b64_tr_b16 a[8:9], v7 offset:0
    v_mfma_f32_16x16x32_bf16 v[140:143], a[24:27], a[36:39], v[140:143]
    ds_read_b64_tr_b16 a[10:11], v7 offset:8192
    s_add_u32 m0, s32, 16384
    v_mfma_f32_16x16x32_bf16 v[156:159], a[28:31], a[36:39], v[156:159]
    ds_read_b64_tr_b16 a[12:13], v8 offset:0
    v_mfma_f32_16x16x32_bf16 v[152:155], a[28:31], a[32:35], v[152:155]
    ds_read_b64_tr_b16 a[14:15], v8 offset:8192
    s_waitcnt lgkmcnt(4)
    v_mfma_f32_16x16x32_bf16 v[32:35], a[0:3], a[40:43], v[32:35]
    ds_read_b64_tr_b16 a[16:17], v9 offset:0
    v_mfma_f32_16x16x32_bf16 v[36:39], a[0:3], a[44:47], v[36:39]
    ds_read_b64_tr_b16 a[18:19], v9 offset:8192
    buffer_load_dwordx4 v21, s[12:15], s70 offen offset:0 sc1 lds
    v_mfma_f32_16x16x32_bf16 v[44:47], a[4:7], a[44:47], v[44:47]
    ds_read_b64_tr_b16 a[20:21], v10 offset:0
    v_mfma_f32_16x16x32_bf16 v[40:43], a[4:7], a[40:43], v[40:43]
    ds_read_b64_tr_b16 a[22:23], v10 offset:8192
    s_waitcnt lgkmcnt(4)
    v_mfma_f32_16x16x32_bf16 v[48:51], a[8:11], a[40:43], v[48:51]
    ds_read_b64_tr_b16 a[24:25], v11 offset:0
    v_mfma_f32_16x16x32_bf16 v[52:55], a[8:11], a[44:47], v[52:55]
    ds_read_b64_tr_b16 a[26:27], v11 offset:8192
    buffer_load_dwordx4 v22, s[12:15], s70 offen offset:1024 sc1 lds
    v_mfma_f32_16x16x32_bf16 v[60:63], a[12:15], a[44:47], v[60:63]
    ds_read_b64_tr_b16 a[28:29], v12 offset:0
    v_mfma_f32_16x16x32_bf16 v[56:59], a[12:15], a[40:43], v[56:59]
    ds_read_b64_tr_b16 a[30:31], v12 offset:8192
    s_waitcnt lgkmcnt(4)
    v_mfma_f32_16x16x32_bf16 v[64:67], a[16:19], a[40:43], v[64:67]
    ds_read_b64_tr_b16 a[0:1], v5 offset:256
    v_mfma_f32_16x16x32_bf16 v[68:71], a[16:19], a[44:47], v[68:71]
    ds_read_b64_tr_b16 a[2:3], v5 offset:8448
    buffer_load_dwordx4 v23, s[12:15], s70 offen offset:2048 sc1 lds
    v_mfma_f32_16x16x32_bf16 v[76:79], a[20:23], a[44:47], v[76:79]
    ds_read_b64_tr_b16 a[4:5], v6 offset:256
    v_mfma_f32_16x16x32_bf16 v[72:75], a[20:23], a[40:43], v[72:75]
    ds_read_b64_tr_b16 a[6:7], v6 offset:8448
    s_waitcnt lgkmcnt(4)
    v_mfma_f32_16x16x32_bf16 v[80:83], a[24:27], a[40:43], v[80:83]
    ds_read_b64_tr_b16 a[8:9], v7 offset:256
    v_mfma_f32_16x16x32_bf16 v[84:87], a[24:27], a[44:47], v[84:87]
    ds_read_b64_tr_b16 a[10:11], v7 offset:8448
    buffer_load_dwordx4 v24, s[12:15], s70 offen offset:3072 sc1 lds
    v_mfma_f32_16x16x32_bf16 v[92:95], a[28:31], a[44:47], v[92:95]
    ds_read_b64_tr_b16 a[12:13], v8 offset:256
    v_mfma_f32_16x16x32_bf16 v[88:91], a[28:31], a[40:43], v[88:91]
    ds_read_b64_tr_b16 a[14:15], v8 offset:8448
    s_waitcnt lgkmcnt(4)
    v_mfma_f32_16x16x32_bf16 v[96:99], a[0:3], a[40:43], v[96:99]
    ds_read_b64_tr_b16 a[16:17], v9 offset:256
    v_mfma_f32_16x16x32_bf16 v[100:103], a[0:3], a[44:47], v[100:103]
    ds_read_b64_tr_b16 a[18:19], v9 offset:8448
    s_add_u32 s70, s46, 114688
    v_mfma_f32_16x16x32_bf16 v[108:111], a[4:7], a[44:47], v[108:111]
    ds_read_b64_tr_b16 a[20:21], v10 offset:256
    v_mfma_f32_16x16x32_bf16 v[104:107], a[4:7], a[40:43], v[104:107]
    ds_read_b64_tr_b16 a[22:23], v10 offset:8448
    s_waitcnt lgkmcnt(4)
    v_mfma_f32_16x16x32_bf16 v[112:115], a[8:11], a[40:43], v[112:115]
    ds_read_b64_tr_b16 a[24:25], v5 offset:16384
    v_mfma_f32_16x16x32_bf16 v[116:119], a[8:11], a[44:47], v[116:119]
    ds_read_b64_tr_b16 a[26:27], v5 offset:24576
    v_mfma_f32_16x16x32_bf16 v[124:127], a[12:15], a[44:47], v[124:127]
    ds_read_b64_tr_b16 a[28:29], v6 offset:16384
    s_add_u32 m0, s32, 32768
    v_mfma_f32_16x16x32_bf16 v[120:123], a[12:15], a[40:43], v[120:123]
    ds_read_b64_tr_b16 a[30:31], v6 offset:24576
    s_waitcnt lgkmcnt(4)
    v_mfma_f32_16x16x32_bf16 v[136:139], a[16:19], a[40:43], v[136:139]
    ds_read_b64_tr_b16 a[0:1], v7 offset:16384
    v_mfma_f32_16x16x32_bf16 v[140:143], a[16:19], a[44:47], v[140:143]
    ds_read_b64_tr_b16 a[2:3], v7 offset:24576
    v_mfma_f32_16x16x32_bf16 v[156:159], a[20:23], a[44:47], v[156:159]
    ds_read_b64_tr_b16 a[4:5], v8 offset:16384
    buffer_load_dwordx4 v21, s[12:15], s70 offen offset:0 sc1 lds
    v_mfma_f32_16x16x32_bf16 v[152:155], a[20:23], a[40:43], v[152:155]
    ds_read_b64_tr_b16 a[6:7], v8 offset:24576
    s_waitcnt lgkmcnt(4)
    v_mfma_f32_16x16x32_bf16 v[32:35], a[24:27], a[48:51], v[32:35]
    ds_read_b64_tr_b16 a[8:9], v9 offset:16384
    v_mfma_f32_16x16x32_bf16 v[36:39], a[24:27], a[52:55], v[36:39]
    ds_read_b64_tr_b16 a[10:11], v9 offset:24576
    v_mfma_f32_16x16x32_bf16 v[44:47], a[28:31], a[52:55], v[44:47]
    ds_read_b64_tr_b16 a[12:13], v10 offset:16384
    buffer_load_dwordx4 v22, s[12:15], s70 offen offset:1024 sc1 lds
    v_mfma_f32_16x16x32_bf16 v[40:43], a[28:31], a[48:51], v[40:43]
    ds_read_b64_tr_b16 a[14:15], v10 offset:24576
    s_waitcnt lgkmcnt(4)
    v_mfma_f32_16x16x32_bf16 v[48:51], a[0:3], a[48:51], v[48:51]
    ds_read_b64_tr_b16 a[16:17], v11 offset:16384
    v_mfma_f32_16x16x32_bf16 v[52:55], a[0:3], a[52:55], v[52:55]
    ds_read_b64_tr_b16 a[18:19], v11 offset:24576
    v_mfma_f32_16x16x32_bf16 v[60:63], a[4:7], a[52:55], v[60:63]
    ds_read_b64_tr_b16 a[20:21], v12 offset:16384
    buffer_load_dwordx4 v23, s[12:15], s70 offen offset:2048 sc1 lds
    v_mfma_f32_16x16x32_bf16 v[56:59], a[4:7], a[48:51], v[56:59]
    ds_read_b64_tr_b16 a[22:23], v12 offset:24576
    s_waitcnt lgkmcnt(4)
    v_mfma_f32_16x16x32_bf16 v[64:67], a[8:11], a[48:51], v[64:67]
    ds_read_b64_tr_b16 a[24:25], v5 offset:16640
    v_mfma_f32_16x16x32_bf16 v[68:71], a[8:11], a[52:55], v[68:71]
    ds_read_b64_tr_b16 a[26:27], v5 offset:24832
    v_mfma_f32_16x16x32_bf16 v[76:79], a[12:15], a[52:55], v[76:79]
    ds_read_b64_tr_b16 a[28:29], v6 offset:16640
    buffer_load_dwordx4 v24, s[12:15], s70 offen offset:3072 sc1 lds
    v_mfma_f32_16x16x32_bf16 v[72:75], a[12:15], a[48:51], v[72:75]
    ds_read_b64_tr_b16 a[30:31], v6 offset:24832
    s_waitcnt lgkmcnt(4)
    v_mfma_f32_16x16x32_bf16 v[80:83], a[16:19], a[48:51], v[80:83]
    ds_read_b64_tr_b16 a[0:1], v7 offset:16640
    v_mfma_f32_16x16x32_bf16 v[84:87], a[16:19], a[52:55], v[84:87]
    ds_read_b64_tr_b16 a[2:3], v7 offset:24832
    v_mfma_f32_16x16x32_bf16 v[92:95], a[20:23], a[52:55], v[92:95]
    ds_read_b64_tr_b16 a[4:5], v8 offset:16640
    buffer_load_dword v16, off, s[4:7], s34 sc1
    v_mfma_f32_16x16x32_bf16 v[88:91], a[20:23], a[48:51], v[88:91]
    ds_read_b64_tr_b16 a[6:7], v8 offset:24832
    s_waitcnt lgkmcnt(4)
    v_mfma_f32_16x16x32_bf16 v[96:99], a[24:27], a[48:51], v[96:99]
    ds_read_b64_tr_b16 a[8:9], v9 offset:16640
    v_mfma_f32_16x16x32_bf16 v[100:103], a[24:27], a[52:55], v[100:103]
    ds_read_b64_tr_b16 a[10:11], v9 offset:24832
    v_mfma_f32_16x16x32_bf16 v[108:111], a[28:31], a[52:55], v[108:111]
    ds_read_b64_tr_b16 a[12:13], v10 offset:16640
    v_mfma_f32_16x16x32_bf16 v[104:107], a[28:31], a[48:51], v[104:107]
    ds_read_b64_tr_b16 a[14:15], v10 offset:24832
    s_waitcnt vmcnt(13)
    s_barrier
    s_waitcnt lgkmcnt(4)
    v_mfma_f32_16x16x32_bf16 v[112:115], a[0:3], a[48:51], v[112:115]
    ds_read_b64_tr_b16 a[16:17], v5 offset:32768
    v_mfma_f32_16x16x32_bf16 v[116:119], a[0:3], a[52:55], v[116:119]
    ds_read_b64_tr_b16 a[18:19], v5 offset:40960
    s_add_u32 s70, s46, 143360
    v_mfma_f32_16x16x32_bf16 v[124:127], a[4:7], a[52:55], v[124:127]
    ds_read_b64_tr_b16 a[20:21], v6 offset:32768
    v_mfma_f32_16x16x32_bf16 v[120:123], a[4:7], a[48:51], v[120:123]
    ds_read_b64_tr_b16 a[22:23], v6 offset:40960
    s_waitcnt lgkmcnt(4)
    v_mfma_f32_16x16x32_bf16 v[136:139], a[8:11], a[48:51], v[136:139]
    ds_read_b64_tr_b16 a[24:25], v7 offset:32768
    v_mfma_f32_16x16x32_bf16 v[140:143], a[8:11], a[52:55], v[140:143]
    ds_read_b64_tr_b16 a[26:27], v7 offset:40960
    s_add_u32 m0, s32, 49152
    v_mfma_f32_16x16x32_bf16 v[156:159], a[12:15], a[52:55], v[156:159]
    ds_read_b64_tr_b16 a[28:29], v8 offset:32768
    v_mfma_f32_16x16x32_bf16 v[152:155], a[12:15], a[48:51], v[152:155]
    ds_read_b64_tr_b16 a[30:31], v8 offset:40960
    s_waitcnt lgkmcnt(4)
    v_mfma_f32_16x16x32_bf16 v[32:35], a[16:19], v[128:131], v[32:35]
    ds_read_b64_tr_b16 a[0:1], v9 offset:32768
    v_mfma_f32_16x16x32_bf16 v[36:39], a[16:19], v[132:135], v[36:39]
    ds_read_b64_tr_b16 a[2:3], v9 offset:40960
    v_mfma_f32_16x16x32_bf16 v[44:47], a[20:23], v[132:135], v[44:47]
    ds_read_b64_tr_b16 a[4:5], v10 offset:32768
    buffer_load_dwordx4 v21, s[12:15], s70 offen offset:0 sc1 lds
    v_mfma_f32_16x16x32_bf16 v[40:43], a[20:23], v[128:131], v[40:43]
    ds_read_b64_tr_b16 a[6:7], v10 offset:40960
    s_waitcnt lgkmcnt(4)
    v_mfma_f32_16x16x32_bf16 v[48:51], a[24:27], v[128:131], v[48:51]
    ds_read_b64_tr_b16 a[8:9], v11 offset:32768
    v_mfma_f32_16x16x32_bf16 v[52:55], a[24:27], v[132:135], v[52:55]
    ds_read_b64_tr_b16 a[10:11], v11 offset:40960
    v_mfma_f32_16x16x32_bf16 v[60:63], a[28:31], v[132:135], v[60:63]
    ds_read_b64_tr_b16 a[12:13], v12 offset:32768
    buffer_load_dwordx4 v22, s[12:15], s70 offen offset:1024 sc1 lds
    v_mfma_f32_16x16x32_bf16 v[56:59], a[28:31], v[128:131], v[56:59]
    ds_read_b64_tr_b16 a[14:15], v12 offset:40960
    s_waitcnt lgkmcnt(4)
    v_mfma_f32_16x16x32_bf16 v[64:67], a[0:3], v[128:131], v[64:67]
    ds_read_b64_tr_b16 a[16:17], v5 offset:33024
    v_mfma_f32_16x16x32_bf16 v[68:71], a[0:3], v[132:135], v[68:71]
    ds_read_b64_tr_b16 a[18:19], v5 offset:41216
    v_mfma_f32_16x16x32_bf16 v[76:79], a[4:7], v[132:135], v[76:79]
    ds_read_b64_tr_b16 a[20:21], v6 offset:33024
    v_mfma_f32_16x16x32_bf16 v[72:75], a[4:7], v[128:131], v[72:75]
    ds_read_b64_tr_b16 a[22:23], v6 offset:41216
    s_waitcnt lgkmcnt(4)
    v_mfma_f32_16x16x32_bf16 v[80:83], a[8:11], v[128:131], v[80:83]
    ds_read_b64_tr_b16 a[24:25], v7 offset:33024
    buffer_load_dwordx4 v23, s[12:15], s70 offen offset:2048 sc1 lds
    v_mfma_f32_16x16x32_bf16 v[84:87], a[8:11], v[132:135], v[84:87]
    ds_read_b64_tr_b16 a[26:27], v7 offset:41216
    v_mfma_f32_16x16x32_bf16 v[92:95], a[12:15], v[132:135], v[92:95]
    ds_read_b64_tr_b16 a[28:29], v8 offset:33024
    v_mfma_f32_16x16x32_bf16 v[88:91], a[12:15], v[128:131], v[88:91]
    ds_read_b64_tr_b16 a[30:31], v8 offset:41216
    s_waitcnt lgkmcnt(4)
    v_mfma_f32_16x16x32_bf16 v[96:99], a[16:19], v[128:131], v[96:99]
    ds_read_b64_tr_b16 a[0:1], v9 offset:33024
    buffer_load_dwordx4 v24, s[12:15], s70 offen offset:3072 sc1 lds
    v_mfma_f32_16x16x32_bf16 v[100:103], a[16:19], v[132:135], v[100:103]
    ds_read_b64_tr_b16 a[2:3], v9 offset:41216
    v_mfma_f32_16x16x32_bf16 v[108:111], a[20:23], v[132:135], v[108:111]
    ds_read_b64_tr_b16 a[4:5], v10 offset:33024
    v_mfma_f32_16x16x32_bf16 v[104:107], a[20:23], v[128:131], v[104:107]
    ds_read_b64_tr_b16 a[6:7], v10 offset:41216
    s_waitcnt lgkmcnt(4)
    v_mfma_f32_16x16x32_bf16 v[112:115], a[24:27], v[128:131], v[112:115]
    ds_read_b64_tr_b16 a[8:9], v5 offset:49152
    s_add_u32 s70, s46, 172032
    v_mfma_f32_16x16x32_bf16 v[116:119], a[24:27], v[132:135], v[116:119]
    ds_read_b64_tr_b16 a[10:11], v5 offset:57344
    v_mfma_f32_16x16x32_bf16 v[124:127], a[28:31], v[132:135], v[124:127]
    ds_read_b64_tr_b16 a[12:13], v6 offset:49152
    v_mfma_f32_16x16x32_bf16 v[120:123], a[28:31], v[128:131], v[120:123]
    ds_read_b64_tr_b16 a[14:15], v6 offset:57344
    s_waitcnt lgkmcnt(4)
    v_mfma_f32_16x16x32_bf16 v[136:139], a[0:3], v[128:131], v[136:139]
    ds_read_b64_tr_b16 a[16:17], v7 offset:49152
    s_add_u32 m0, s32, 65536
    v_mfma_f32_16x16x32_bf16 v[140:143], a[0:3], v[132:135], v[140:143]
    ds_read_b64_tr_b16 a[18:19], v7 offset:57344
    v_mfma_f32_16x16x32_bf16 v[156:159], a[4:7], v[132:135], v[156:159]
    ds_read_b64_tr_b16 a[20:21], v8 offset:49152
    v_mfma_f32_16x16x32_bf16 v[152:155], a[4:7], v[128:131], v[152:155]
    ds_read_b64_tr_b16 a[22:23], v8 offset:57344
    s_waitcnt lgkmcnt(4)
    v_mfma_f32_16x16x32_bf16 v[32:35], a[8:11], v[144:147], v[32:35]
    ds_read_b64_tr_b16 a[24:25], v9 offset:49152
    v_mfma_f32_16x16x32_bf16 v[36:39], a[8:11], v[148:151], v[36:39]
    ds_read_b64_tr_b16 a[26:27], v9 offset:57344
    buffer_load_dwordx4 v21, s[12:15], s70 offen offset:0 sc1 lds
    v_mfma_f32_16x16x32_bf16 v[44:47], a[12:15], v[148:151], v[44:47]
    ds_read_b64_tr_b16 a[28:29], v10 offset:49152
    v_mfma_f32_16x16x32_bf16 v[40:43], a[12:15], v[144:147], v[40:43]
    ds_read_b64_tr_b16 a[30:31], v10 offset:57344
    s_waitcnt lgkmcnt(4)
    v_mfma_f32_16x16x32_bf16 v[48:51], a[16:19], v[144:147], v[48:51]
    ds_read_b64_tr_b16 a[0:1], v11 offset:49152
    v_mfma_f32_16x16x32_bf16 v[52:55], a[16:19], v[148:151], v[52:55]
    ds_read_b64_tr_b16 a[2:3], v11 offset:57344
    buffer_load_dwordx4 v22, s[12:15], s70 offen offset:1024 sc1 lds
    v_mfma_f32_16x16x32_bf16 v[60:63], a[20:23], v[148:151], v[60:63]
    ds_read_b64_tr_b16 a[4:5], v12 offset:49152
    v_mfma_f32_16x16x32_bf16 v[56:59], a[20:23], v[144:147], v[56:59]
    ds_read_b64_tr_b16 a[6:7], v12 offset:57344
    s_waitcnt lgkmcnt(4)
    v_mfma_f32_16x16x32_bf16 v[64:67], a[24:27], v[144:147], v[64:67]
    ds_read_b64_tr_b16 a[8:9], v5 offset:49408
    v_mfma_f32_16x16x32_bf16 v[68:71], a[24:27], v[148:151], v[68:71]
    ds_read_b64_tr_b16 a[10:11], v5 offset:57600
    v_mfma_f32_16x16x32_bf16 v[76:79], a[28:31], v[148:151], v[76:79]
    ds_read_b64_tr_b16 a[12:13], v6 offset:49408
    buffer_load_dwordx4 v23, s[12:15], s70 offen offset:2048 sc1 lds
    v_mfma_f32_16x16x32_bf16 v[72:75], a[28:31], v[144:147], v[72:75]
    ds_read_b64_tr_b16 a[14:15], v6 offset:57600
    s_waitcnt lgkmcnt(4)
    v_mfma_f32_16x16x32_bf16 v[80:83], a[0:3], v[144:147], v[80:83]
    ds_read_b64_tr_b16 a[16:17], v7 offset:49408
    v_mfma_f32_16x16x32_bf16 v[84:87], a[0:3], v[148:151], v[84:87]
    ds_read_b64_tr_b16 a[18:19], v7 offset:57600
    v_mfma_f32_16x16x32_bf16 v[92:95], a[4:7], v[148:151], v[92:95]
    ds_read_b64_tr_b16 a[20:21], v8 offset:49408
    buffer_load_dwordx4 v24, s[12:15], s70 offen offset:3072 sc1 lds
    v_mfma_f32_16x16x32_bf16 v[88:91], a[4:7], v[144:147], v[88:91]
    ds_read_b64_tr_b16 a[22:23], v8 offset:57600
    s_waitcnt lgkmcnt(4)
    v_mfma_f32_16x16x32_bf16 v[96:99], a[8:11], v[144:147], v[96:99]
    ds_read_b64_tr_b16 a[24:25], v9 offset:49408
    v_mfma_f32_16x16x32_bf16 v[100:103], a[8:11], v[148:151], v[100:103]
    ds_read_b64_tr_b16 a[26:27], v9 offset:57600
    v_mfma_f32_16x16x32_bf16 v[108:111], a[12:15], v[148:151], v[108:111]
    ds_read_b64_tr_b16 a[28:29], v10 offset:49408
    v_mfma_f32_16x16x32_bf16 v[104:107], a[12:15], v[144:147], v[104:107]
    ds_read_b64_tr_b16 a[30:31], v10 offset:57600
    s_waitcnt vmcnt(13)
    s_barrier
    s_waitcnt lgkmcnt(4)
    v_mfma_f32_16x16x32_bf16 v[112:115], a[16:19], v[144:147], v[112:115]
    ds_read_b64_tr_b16 a[0:1], v17 offset:0
    s_mov_b32 s98, 0
spin_69:
    s_waitcnt vmcnt(8)
    v_readfirstlane_b32 s99, v16
    s_nop 0
    s_cmp_ge_u32 s99, 2
    s_cbranch_scc1 ok_70
    s_add_u32 s98, s98, 1
    s_cmp_gt_u32 s98, 0x80000
    s_cbranch_scc1 ok_70
    s_sleep 8
    buffer_load_dword v16, off, s[4:7], s34 sc1
    s_waitcnt vmcnt(0)
    s_branch spin_69
ok_70:
    v_mfma_f32_16x16x32_bf16 v[116:119], a[16:19], v[148:151], v[116:119]
    ds_read_b64_tr_b16 a[2:3], v17 offset:8192
    s_add_u32 s70, s46, 200704
    v_mfma_f32_16x16x32_bf16 v[124:127], a[20:23], v[148:151], v[124:127]
    ds_read_b64_tr_b16 a[4:5], v18 offset:0
    v_mfma_f32_16x16x32_bf16 v[120:123], a[20:23], v[144:147], v[120:123]
    ds_read_b64_tr_b16 a[6:7], v18 offset:8192
    s_waitcnt lgkmcnt(4)
    v_mfma_f32_16x16x32_bf16 v[136:139], a[24:27], v[144:147], v[136:139]
    ds_read_b64_tr_b16 a[8:9], v19 offset:0
    s_add_u32 m0, s32, 81920
    v_mfma_f32_16x16x32_bf16 v[140:143], a[24:27], v[148:151], v[140:143]
    ds_read_b64_tr_b16 a[10:11], v19 offset:8192
    buffer_load_dwordx4 v21, s[12:15], s70 offen offset:0 sc1 lds
    v_mfma_f32_16x16x32_bf16 v[156:159], a[28:31], v[148:151], v[156:159]
    ds_read_b64_tr_b16 a[12:13], v20 offset:0
    v_mfma_f32_16x16x32_bf16 v[152:155], a[28:31], v[144:147], v[152:155]
    ds_read_b64_tr_b16 a[14:15], v20 offset:8192
    s_waitcnt lgkmcnt(4)
    v_mfma_f32_16x16x32_bf16 v[32:35], a[0:3], v[160:163], v[32:35]
    ds_read_b64_tr_b16 a[16:17], v26 offset:0
    buffer_load_dwordx4 v22, s[12:15], s70 offen offset:1024 sc1 lds
    v_mfma_f32_16x16x32_bf16 v[36:39], a[0:3], v[164:167], v[36:39]
    ds_read_b64_tr_b16 a[18:19], v26 offset:8192
    v_mfma_f32_16x16x32_bf16 v[44:47], a[4:7], v[164:167], v[44:47]
    ds_read_b64_tr_b16 a[20:21], v27 offset:0
    buffer_load_dwordx4 v23, s[12:15], s70 offen offset:2048 sc1 lds
    v_mfma_f32_16x16x32_bf16 v[40:43], a[4:7], v[160:163], v[40:43]
    ds_read_b64_tr_b16 a[22:23], v27 offset:8192
    s_waitcnt lgkmcnt(4)
    v_mfma_f32_16x16x32_bf16 v[48:51], a[8:11], v[160:163], v[48:51]
    ds_read_b64_tr_b16 a[24:25], v28 offset:0
    v_mfma_f32_16x16x32_bf16 v[52:55], a[8:11], v[164:167], v[52:55]
    ds_read_b64_tr_b16 a[26:27], v28 offset:8192
    buffer_load_dwordx4 v24, s[12:15], s70 offen offset:3072 sc1 lds
    v_mfma_f32_16x16x32_bf16 v[60:63], a[12:15], v[164:167], v[60:63]
    ds_read_b64_tr_b16 a[28:29], v29 offset:0
    v_mfma_f32_16x16x32_bf16 v[56:59], a[12:15], v[160:163], v[56:59]
    ds_read_b64_tr_b16 a[30:31], v29 offset:8192
    s_waitcnt lgkmcnt(4)
    v_mfma_f32_16x16x32_bf16 v[64:67], a[16:19], v[160:163], v[64:67]
    ds_read_b64_tr_b16 a[0:1], v17 offset:256
    s_add_u32 s70, s47, 0
    v_mfma_f32_16x16x32_bf16 v[68:71], a[16:19], v[164:167], v[68:71]
    ds_read_b64_tr_b16 a[2:3], v17 offset:8448
    v_mfma_f32_16x16x32_bf16 v[76:79], a[20:23], v[164:167], v[76:79]
    ds_read_b64_tr_b16 a[4:5], v18 offset:256
    s_add_u32 m0, s32, 98304
    v_mfma_f32_16x16x32_bf16 v[72:75], a[20:23], v[160:163], v[72:75]
    ds_read_b64_tr_b16 a[6:7], v18 offset:8448
    s_waitcnt lgkmcnt(4)
    v_mfma_f32_16x16x32_bf16 v[80:83], a[24:27], v[160:163], v[80:83]
    ds_read_b64_tr_b16 a[8:9], v19 offset:256
    buffer_load_dwordx4 v21, s[12:15], s70 offen offset:0 sc1 lds
    v_mfma_f32_16x16x32_bf16 v[84:87], a[24:27], v[164:167], v[84:87]
    ds_read_b64_tr_b16 a[10:11], v19 offset:8448
    v_mfma_f32_16x16x32_bf16 v[92:95], a[28:31], v[164:167], v[92:95]
    ds_read_b64_tr_b16 a[12:13], v20 offset:256
    v_mfma_f32_16x16x32_bf16 v[88:91], a[28:31], v[160:163], v[88:91]
    ds_read_b64_tr_b16 a[14:15], v20 offset:8448
    s_waitcnt lgkmcnt(4)
    v_mfma_f32_16x16x32_bf16 v[96:99], a[0:3], v[160:163], v[96:99]
    ds_read_b64_tr_b16 a[16:17], v26 offset:256
    buffer_load_dwordx4 v22, s[12:15], s70 offen offset:1024 sc1 lds
    v_mfma_f32_16x16x32_bf16 v[100:103], a[0:3], v[164:167], v[100:103]
    ds_read_b64_tr_b16 a[18:19], v26 offset:8448
    buffer_load_dwordx4 v23, s[12:15], s70 offen offset:2048 sc1 lds
    v_mfma_f32_16x16x32_bf16 v[108:111], a[4:7], v[164:167], v[108:111]
    ds_read_b64_tr_b16 a[20:21], v27 offset:256
    v_mfma_f32_16x16x32_bf16 v[104:107], a[4:7], v[160:163], v[104:107]
    ds_read_b64_tr_b16 a[22:23], v27 offset:8448
    s_waitcnt lgkmcnt(4)
    v_mfma_f32_16x16x32_bf16 v[112:115], a[8:11], v[160:163], v[112:115]
    ds_read_b64_tr_b16 a[24:25], v17 offset:16384
    buffer_load_dwordx4 v24, s[12:15], s70 offen offset:3072 sc1 lds
    v_mfma_f32_16x16x32_bf16 v[116:119], a[8:11], v[164:167], v[116:119]
    ds_read_b64_tr_b16 a[26:27], v17 offset:24576
    v_mfma_f32_16x16x32_bf16 v[124:127], a[12:15], v[164:167], v[124:127]
    ds_read_b64_tr_b16 a[28:29], v18 offset:16384
    s_add_u32 s71, s36, 0
    v_mfma_f32_16x16x32_bf16 v[120:123], a[12:15], v[160:163], v[120:123]
    ds_read_b64_tr_b16 a[30:31], v18 offset:24576
    s_waitcnt lgkmcnt(4)
    v_mfma_f32_16x16x32_bf16 v[136:139], a[16:19], v[160:163], v[136:139]
    ds_read_b64_tr_b16 a[0:1], v19 offset:16384
    buffer_load_dwordx4 a[64:67], v25, s[4:7], s71 offen offset:0 sc1
    v_mfma_f32_16x16x32_bf16 v[140:143], a[16:19], v[164:167], v[140:143]
    ds_read_b64_tr_b16 a[2:3], v19 offset:24576
    v_mfma_f32_16x16x32_bf16 v[156:159], a[20:23], v[164:167], v[156:159]
    ds_read_b64_tr_b16 a[4:5], v20 offset:16384
    v_mfma_f32_16x16x32_bf16 v[152:155], a[20:23], v[160:163], v[152:155]
    ds_read_b64_tr_b16 a[6:7], v20 offset:24576
    s_waitcnt lgkmcnt(4)
    v_mfma_f32_16x16x32_bf16 v[32:35], a[24:27], v[176:179], v[32:35]
    ds_read_b64_tr_b16 a[8:9], v26 offset:16384
    buffer_load_dwordx4 a[68:71], v25, s[4:7], s71 offen offset:1024 sc1
    v_mfma_f32_16x16x32_bf16 v[36:39], a[24:27], v[180:183], v[36:39]
    ds_read_b64_tr_b16 a[10:11], v26 offset:24576
    buffer_load_dwordx4 a[72:75], v25, s[4:7], s71 offen offset:2048 sc1
    v_mfma_f32_16x16x32_bf16 v[44:47], a[28:31], v[180:183], v[44:47]
    ds_read_b64_tr_b16 a[12:13], v27 offset:16384
    v_mfma_f32_16x16x32_bf16 v[40:43], a[28:31], v[176:179], v[40:43]
    ds_read_b64_tr_b16 a[14:15], v27 offset:24576
    s_waitcnt lgkmcnt(4)
    v_mfma_f32_16x16x32_bf16 v[48:51], a[0:3], v[176:179], v[48:51]
    ds_read_b64_tr_b16 a[16:17], v28 offset:16384
    buffer_load_dwordx4 a[76:79], v25, s[4:7], s71 offen offset:3072 sc1
    v_mfma_f32_16x16x32_bf16 v[52:55], a[0:3], v[180:183], v[52:55]
    ds_read_b64_tr_b16 a[18:19], v28 offset:24576
    v_mfma_f32_16x16x32_bf16 v[60:63], a[4:7], v[180:183], v[60:63]
    ds_read_b64_tr_b16 a[20:21], v29 offset:16384
    s_add_u32 s71, s36, 4096
    v_mfma_f32_16x16x32_bf16 v[56:59], a[4:7], v[176:179], v[56:59]
    ds_read_b64_tr_b16 a[22:23], v29 offset:24576
    s_waitcnt lgkmcnt(4)
    v_mfma_f32_16x16x32_bf16 v[64:67], a[8:11], v[176:179], v[64:67]
    ds_read_b64_tr_b16 a[24:25], v17 offset:16640
    v_mfma_f32_16x16x32_bf16 v[68:71], a[8:11], v[180:183], v[68:71]
    ds_read_b64_tr_b16 a[26:27], v17 offset:24832
    buffer_load_dwordx4 a[80:83], v25, s[4:7], s71 offen offset:0 sc1
    v_mfma_f32_16x16x32_bf16 v[76:79], a[12:15], v[180:183], v[76:79]
    ds_read_b64_tr_b16 a[28:29], v18 offset:16640
    v_mfma_f32_16x16x32_bf16 v[72:75], a[12:15], v[176:179], v[72:75]
    ds_read_b64_tr_b16 a[30:31], v18 offset:24832
    s_waitcnt lgkmcnt(4)
    v_mfma_f32_16x16x32_bf16 v[80:83], a[16:19], v[176:179], v[80:83]
    ds_read_b64_tr_b16 a[0:1], v19 offset:16640
    buffer_load_dwordx4 a[84:87], v25, s[4:7], s71 offen offset:1024 sc1
    v_mfma_f32_16x16x32_bf16 v[84:87], a[16:19], v[180:183], v[84:87]
    ds_read_b64_tr_b16 a[2:3], v19 offset:24832
    v_mfma_f32_16x16x32_bf16 v[92:95], a[20:23], v[180:183], v[92:95]
    ds_read_b64_tr_b16 a[4:5], v20 offset:16640
    buffer_load_dwordx4 a[88:91], v25, s[4:7], s71 offen offset:2048 sc1
    v_mfma_f32_16x16x32_bf16 v[88:91], a[20:23], v[176:179], v[88:91]
    ds_read_b64_tr_b16 a[6:7], v20 offset:24832
    s_waitcnt lgkmcnt(4)
    v_mfma_f32_16x16x32_bf16 v[96:99], a[24:27], v[176:179], v[96:99]
    ds_read_b64_tr_b16 a[8:9], v26 offset:16640
    buffer_load_dwordx4 a[92:95], v25, s[4:7], s71 offen offset:3072 sc1
    v_mfma_f32_16x16x32_bf16 v[100:103], a[24:27], v[180:183], v[100:103]
    ds_read_b64_tr_b16 a[10:11], v26 offset:24832
    v_mfma_f32_16x16x32_bf16 v[108:111], a[28:31], v[180:183], v[108:111]
    ds_read_b64_tr_b16 a[12:13], v27 offset:16640
    v_mfma_f32_16x16x32_bf16 v[104:107], a[28:31], v[176:179], v[104:107]
    ds_read_b64_tr_b16 a[14:15], v27 offset:24832
    s_waitcnt vmcnt(20)
    s_barrier
    s_waitcnt lgkmcnt(4)
    v_mfma_f32_16x16x32_bf16 v[112:115], a[0:3], v[176:179], v[112:115]
    ds_read_b64_tr_b16 a[16:17], v17 offset:32768
    v_mfma_f32_16x16x32_bf16 v[116:119], a[0:3], v[180:183], v[116:119]
    ds_read_b64_tr_b16 a[18:19], v17 offset:40960
    s_add_u32 s70, s47, 28672
    v_mfma_f32_16x16x32_bf16 v[124:127], a[4:7], v[180:183], v[124:127]
    ds_read_b64_tr_b16 a[20:21], v18 offset:32768
    v_mfma_f32_16x16x32_bf16 v[120:123], a[4:7], v[176:179], v[120:123]
    ds_read_b64_tr_b16 a[22:23], v18 offset:40960
    s_waitcnt lgkmcnt(4)
    v_mfma_f32_16x16x32_bf16 v[136:139], a[8:11], v[176:179], v[136:139]
    ds_read_b64_tr_b16 a[24:25], v19 offset:32768
    s_add_u32 m0, s32, 114688
    v_mfma_f32_16x16x32_bf16 v[140:143], a[8:11], v[180:183], v[140:143]
    ds_read_b64_tr_b16 a[26:27], v19 offset:40960
    buffer_load_dwordx4 v21, s[12:15], s70 offen offset:0 sc1 lds
    v_mfma_f32_16x16x32_bf16 v[156:159], a[12:15], v[180:183], v[156:159]
    ds_read_b64_tr_b16 a[28:29], v20 offset:32768
    v_mfma_f32_16x16x32_bf16 v[152:155], a[12:15], v[176:179], v[152:155]
    ds_read_b64_tr_b16 a[30:31], v20 offset:40960
    s_waitcnt lgkmcnt(4)
    v_mfma_f32_16x16x32_bf16 v[32:35], a[16:19], v[192:195], v[32:35]
    ds_read_b64_tr_b16 a[0:1], v26 offset:32768
    buffer_load_dwordx4 v22, s[12:15], s70 offen offset:1024 sc1 lds
    v_mfma_f32_16x16x32_bf16 v[36:39], a[16:19], v[196:199], v[36:39]
    ds_read_b64_tr_b16 a[2:3], v26 offset:40960
    v_mfma_f32_16x16x32_bf16 v[44:47], a[20:23], v[196:199], v[44:47]
    ds_read_b64_tr_b16 a[4:5], v27 offset:32768
    buffer_load_dwordx4 v23, s[12:15], s70 offen offset:2048 sc1 lds
    v_mfma_f32_16x16x32_bf16 v[40:43], a[20:23], v[192:195], v[40:43]
    ds_read_b64_tr_b16 a[6:7], v27 offset:40960
    s_waitcnt lgkmcnt(4)
    v_mfma_f32_16x16x32_bf16 v[48:51], a[24:27], v[192:195], v[48:51]
    ds_read_b64_tr_b16 a[8:9], v28 offset:32768
    v_mfma_f32_16x16x32_bf16 v[52:55], a[24:27], v[196:199], v[52:55]
    ds_read_b64_tr_b16 a[10:11], v28 offset:40960
    buffer_load_dwordx4 v24, s[12:15], s70 offen offset:3072 sc1 lds
    v_mfma_f32_16x16x32_bf16 v[60:63], a[28:31], v[196:199], v[60:63]
    ds_read_b64_tr_b16 a[12:13], v29 offset:32768
    v_mfma_f32_16x16x32_bf16 v[56:59], a[28:31], v[192:195], v[56:59]
    ds_read_b64_tr_b16 a[14:15], v29 offset:40960
    s_waitcnt lgkmcnt(4)
    v_mfma_f32_16x16x32_bf16 v[64:67], a[0:3], v[192:195], v[64:67]
    ds_read_b64_tr_b16 a[16:17], v17 offset:33024
    s_add_u32 s70, s47, 57344
    v_mfma_f32_16x16x32_bf16 v[68:71], a[0:3], v[196:199], v[68:71]
    ds_read_b64_tr_b16 a[18:19], v17 offset:41216
    v_mfma_f32_16x16x32_bf16 v[76:79], a[4:7], v[196:199], v[76:79]
    ds_read_b64_tr_b16 a[20:21], v18 offset:33024
    s_add_u32 m0, s32, 0
    v_mfma_f32_16x16x32_bf16 v[72:75], a[4:7], v[192:195], v[72:75]
    ds_read_b64_tr_b16 a[22:23], v18 offset:41216
    s_waitcnt lgkmcnt(4)
    v_mfma_f32_16x16x32_bf16 v[80:83], a[8:11], v[192:195], v[80:83]
    ds_read_b64_tr_b16 a[24:25], v19 offset:33024
    buffer_load_dwordx4 v21, s[12:15], s70 offen offset:0 sc1 lds
    v_mfma_f32_16x16x32_bf16 v[84:87], a[8:11], v[196:199], v[84:87]
    ds_read_b64_tr_b16 a[26:27], v19 offset:41216
    v_mfma_f32_16x16x32_bf16 v[92:95], a[12:15], v[196:199], v[92:95]
    ds_read_b64_tr_b16 a[28:29], v20 offset:33024
    v_mfma_f32_16x16x32_bf16 v[88:91], a[12:15], v[192:195], v[88:91]
    ds_read_b64_tr_b16 a[30:31], v20 offset:41216
    s_waitcnt lgkmcnt(4)
    v_mfma_f32_16x16x32_bf16 v[96:99], a[16:19], v[192:195], v[96:99]
    ds_read_b64_tr_b16 a[0:1], v26 offset:33024
    buffer_load_dwordx4 v22, s[12:15], s70 offen offset:1024 sc1 lds
    v_mfma_f32_16x16x32_bf16 v[100:103], a[16:19], v[196:199], v[100:103]
    ds_read_b64_tr_b16 a[2:3], v26 offset:41216
    buffer_load_dwordx4 v23, s[12:15], s70 offen offset:2048 sc1 lds
    v_mfma_f32_16x16x32_bf16 v[108:111], a[20:23], v[196:199], v[108:111]
    ds_read_b64_tr_b16 a[4:5], v27 offset:33024
    v_mfma_f32_16x16x32_bf16 v[104:107], a[20:23], v[192:195], v[104:107]
    ds_read_b64_tr_b16 a[6:7], v27 offset:41216
    s_waitcnt lgkmcnt(4)
    v_mfma_f32_16x16x32_bf16 v[112:115], a[24:27], v[192:195], v[112:115]
    ds_read_b64_tr_b16 a[8:9], v17 offset:49152
    buffer_load_dwordx4 v24, s[12:15], s70 offen offset:3072 sc1 lds
    v_mfma_f32_16x16x32_bf16 v[116:119], a[24:27], v[196:199], v[116:119]
    ds_read_b64_tr_b16 a[10:11], v17 offset:57344
    v_mfma_f32_16x16x32_bf16 v[124:127], a[28:31], v[196:199], v[124:127]
    ds_read_b64_tr_b16 a[12:13], v18 offset:49152
    s_add_u32 s71, s36, 8192
    v_mfma_f32_16x16x32_bf16 v[120:123], a[28:31], v[192:195], v[120:123]
    ds_read_b64_tr_b16 a[14:15], v18 offset:57344
    s_waitcnt lgkmcnt(4)
    v_mfma_f32_16x16x32_bf16 v[136:139], a[0:3], v[192:195], v[136:139]
    ds_read_b64_tr_b16 a[16:17], v19 offset:49152
    buffer_load_dwordx4 a[96:99], v25, s[4:7], s71 offen offset:0 sc1
    v_mfma_f32_16x16x32_bf16 v[140:143], a[0:3], v[196:199], v[140:143]
    ds_read_b64_tr_b16 a[18:19], v19 offset:57344
    v_mfma_f32_16x16x32_bf16 v[156:159], a[4:7], v[196:199], v[156:159]
    ds_read_b64_tr_b16 a[20:21], v20 offset:49152
    v_mfma_f32_16x16x32_bf16 v[152:155], a[4:7], v[192:195], v[152:155]
    ds_read_b64_tr_b16 a[22:23], v20 offset:57344
    s_waitcnt lgkmcnt(4)
    v_mfma_f32_16x16x32_bf16 v[32:35], a[8:11], v[208:211], v[32:35]
    ds_read_b64_tr_b16 a[24:25], v26 offset:49152
    buffer_load_dwordx4 a[100:103], v25, s[4:7], s71 offen offset:1024 sc1
    v_mfma_f32_16x16x32_bf16 v[36:39], a[8:11], v[212:215], v[36:39]
    ds_read_b64_tr_b16 a[26:27], v26 offset:57344
    buffer_load_dwordx4 a[104:107], v25, s[4:7], s71 offen offset:2048 sc1
    v_mfma_f32_16x16x32_bf16 v[44:47], a[12:15], v[212:215], v[44:47]
    ds_read_b64_tr_b16 a[28:29], v27 offset:49152
    v_mfma_f32_16x16x32_bf16 v[40:43], a[12:15], v[208:211], v[40:43]
    ds_read_b64_tr_b16 a[30:31], v27 offset:57344
    s_waitcnt lgkmcnt(4)
    v_mfma_f32_16x16x32_bf16 v[48:51], a[16:19], v[208:211], v[48:51]
    ds_read_b64_tr_b16 a[0:1], v28 offset:49152
    buffer_load_dwordx4 a[108:111], v25, s[4:7], s71 offen offset:3072 sc1
    v_mfma_f32_16x16x32_bf16 v[52:55], a[16:19], v[212:215], v[52:55]
    ds_read_b64_tr_b16 a[2:3], v28 offset:57344
    v_mfma_f32_16x16x32_bf16 v[60:63], a[20:23], v[212:215], v[60:63]
    ds_read_b64_tr_b16 a[4:5], v29 offset:49152
    s_add_u32 s71, s36, 12288
    v_mfma_f32_16x16x32_bf16 v[56:59], a[20:23], v[208:211], v[56:59]
    ds_read_b64_tr_b16 a[6:7], v29 offset:57344
    s_waitcnt lgkmcnt(4)
    v_mfma_f32_16x16x32_bf16 v[64:67], a[24:27], v[208:211], v[64:67]
    ds_read_b64_tr_b16 a[8:9], v17 offset:49408
    v_mfma_f32_16x16x32_bf16 v[68:71], a[24:27], v[212:215], v[68:71]
    ds_read_b64_tr_b16 a[10:11], v17 offset:57600
    buffer_load_dwordx4 a[112:115], v25, s[4:7], s71 offen offset:0 sc1
    v_mfma_f32_16x16x32_bf16 v[76:79], a[28:31], v[212:215], v[76:79]
    ds_read_b64_tr_b16 a[12:13], v18 offset:49408
    v_mfma_f32_16x16x32_bf16 v[72:75], a[28:31], v[208:211], v[72:75]
    ds_read_b64_tr_b16 a[14:15], v18 offset:57600
    s_waitcnt lgkmcnt(4)
    v_mfma_f32_16x16x32_bf16 v[80:83], a[0:3], v[208:211], v[80:83]
    ds_read_b64_tr_b16 a[16:17], v19 offset:49408
    buffer_load_dwordx4 a[116:119], v25, s[4:7], s71 offen offset:1024 sc1
    v_mfma_f32_16x16x32_bf16 v[84:87], a[0:3], v[212:215], v[84:87]
    ds_read_b64_tr_b16 a[18:19], v19 offset:57600
    v_mfma_f32_16x16x32_bf16 v[92:95], a[4:7], v[212:215], v[92:95]
    ds_read_b64_tr_b16 a[20:21], v20 offset:49408
    buffer_load_dwordx4 a[120:123], v25, s[4:7], s71 offen offset:2048 sc1
    v_mfma_f32_16x16x32_bf16 v[88:91], a[4:7], v[208:211], v[88:91]
    ds_read_b64_tr_b16 a[22:23], v20 offset:57600
    s_waitcnt lgkmcnt(4)
    v_mfma_f32_16x16x32_bf16 v[96:99], a[8:11], v[208:211], v[96:99]
    ds_read_b64_tr_b16 a[24:25], v26 offset:49408
    buffer_load_dwordx4 a[124:127], v25, s[4:7], s71 offen offset:3072 sc1
    v_mfma_f32_16x16x32_bf16 v[100:103], a[8:11], v[212:215], v[100:103]
    ds_read_b64_tr_b16 a[26:27], v26 offset:57600
    v_mfma_f32_16x16x32_bf16 v[108:111], a[12:15], v[212:215], v[108:111]
    ds_read_b64_tr_b16 a[28:29], v27 offset:49408
    v_mfma_f32_16x16x32_bf16 v[104:107], a[12:15], v[208:211], v[104:107]
    ds_read_b64_tr_b16 a[30:31], v27 offset:57600
    s_waitcnt vmcnt(28)
    s_barrier
    s_waitcnt lgkmcnt(4)
    v_mfma_f32_16x16x32_bf16 v[112:115], a[16:19], v[208:211], v[112:115]
    ds_read_b64_tr_b16 a[0:1], v5 offset:0
    v_mfma_f32_16x16x32_bf16 v[116:119], a[16:19], v[212:215], v[116:119]
    ds_read_b64_tr_b16 a[2:3], v5 offset:8192
    s_add_u32 s70, s47, 86016
    v_mfma_f32_16x16x32_bf16 v[124:127], a[20:23], v[212:215], v[124:127]
    ds_read_b64_tr_b16 a[4:5], v6 offset:0
    v_mfma_f32_16x16x32_bf16 v[120:123], a[20:23], v[208:211], v[120:123]
    ds_read_b64_tr_b16 a[6:7], v6 offset:8192
    s_waitcnt lgkmcnt(4)
    v_mfma_f32_16x16x32_bf16 v[136:139], a[24:27], v[208:211], v[136:139]
    ds_read_b64_tr_b16 a[8:9], v7 offset:0
    v_mfma_f32_16x16x32_bf16 v[140:143], a[24:27], v[212:215], v[140:143]
    ds_read_b64_tr_b16 a[10:11], v7 offset:8192
    s_add_u32 m0, s32, 16384
    v_mfma_f32_16x16x32_bf16 v[156:159], a[28:31], v[212:215], v[156:159]
    ds_read_b64_tr_b16 a[12:13], v8 offset:0
    v_mfma_f32_16x16x32_bf16 v[152:155], a[28:31], v[208:211], v[152:155]
    ds_read_b64_tr_b16 a[14:15], v8 offset:8192
    s_waitcnt lgkmcnt(4)
    v_mfma_f32_16x16x32_bf16 v[32:35], a[0:3], v[224:227], v[32:35]
    ds_read_b64_tr_b16 a[16:17], v9 offset:0
    v_mfma_f32_16x16x32_bf16 v[36:39], a[0:3], v[228:231], v[36:39]
    ds_read_b64_tr_b16 a[18:19], v9 offset:8192
    v_mfma_f32_16x16x32_bf16 v[44:47], a[4:7], v[228:231], v[44:47]
    ds_read_b64_tr_b16 a[20:21], v10 offset:0
    buffer_load_dwordx4 v21, s[12:15], s70 offen offset:0 sc1 lds
    v_mfma_f32_16x16x32_bf16 v[40:43], a[4:7], v[224:227], v[40:43]
    ds_read_b64_tr_b16 a[22:23], v10 offset:8192
    s_waitcnt lgkmcnt(4)
    v_mfma_f32_16x16x32_bf16 v[48:51], a[8:11], v[224:227], v[48:51]
    ds_read_b64_tr_b16 a[24:25], v11 offset:0
    v_mfma_f32_16x16x32_bf16 v[52:55], a[8:11], v[228:231], v[52:55]
    ds_read_b64_tr_b16 a[26:27], v11 offset:8192
    v_mfma_f32_16x16x32_bf16 v[60:63], a[12:15], v[228:231], v[60:63]
    ds_read_b64_tr_b16 a[28:29], v12 offset:0
    buffer_load_dwordx4 v22, s[12:15], s70 offen offset:1024 sc1 lds
    v_mfma_f32_16x16x32_bf16 v[56:59], a[12:15], v[224:227], v[56:59]
    ds_read_b64_tr_b16 a[30:31], v12 offset:8192
    s_waitcnt lgkmcnt(4)
    v_mfma_f32_16x16x32_bf16 v[64:67], a[16:19], v[224:227], v[64:67]
    ds_read_b64_tr_b16 a[0:1], v5 offset:256
    v_mfma_f32_16x16x32_bf16 v[68:71], a[16:19], v[228:231], v[68:71]
    ds_read_b64_tr_b16 a[2:3], v5 offset:8448
    v_mfma_f32_16x16x32_bf16 v[76:79], a[20:23], v[228:231], v[76:79]
    ds_read_b64_tr_b16 a[4:5], v6 offset:256
    v_mfma_f32_16x16x32_bf16 v[72:75], a[20:23], v[224:227], v[72:75]
    ds_read_b64_tr_b16 a[6:7], v6 offset:8448
    s_waitcnt lgkmcnt(4)
    v_mfma_f32_16x16x32_bf16 v[80:83], a[24:27], v[224:227], v[80:83]
    ds_read_b64_tr_b16 a[8:9], v7 offset:256
    buffer_load_dwordx4 v23, s[12:15], s70 offen offset:2048 sc1 lds
    v_mfma_f32_16x16x32_bf16 v[84:87], a[24:27], v[228:231], v[84:87]
    ds_read_b64_tr_b16 a[10:11], v7 offset:8448
    v_mfma_f32_16x16x32_bf16 v[92:95], a[28:31], v[228:231], v[92:95]
    ds_read_b64_tr_b16 a[12:13], v8 offset:256
    v_mfma_f32_16x16x32_bf16 v[88:91], a[28:31], v[224:227], v[88:91]
    ds_read_b64_tr_b16 a[14:15], v8 offset:8448
    s_waitcnt lgkmcnt(4)
    v_mfma_f32_16x16x32_bf16 v[96:99], a[0:3], v[224:227], v[96:99]
    ds_read_b64_tr_b16 a[16:17], v9 offset:256
    buffer_load_dwordx4 v24, s[12:15], s70 offen offset:3072 sc1 lds
    v_mfma_f32_16x16x32_bf16 v[100:103], a[0:3], v[228:231], v[100:103]
    ds_read_b64_tr_b16 a[18:19], v9 offset:8448
    v_mfma_f32_16x16x32_bf16 v[108:111], a[4:7], v[228:231], v[108:111]
    ds_read_b64_tr_b16 a[20:21], v10 offset:256
    v_mfma_f32_16x16x32_bf16 v[104:107], a[4:7], v[224:227], v[104:107]
    ds_read_b64_tr_b16 a[22:23], v10 offset:8448
    s_waitcnt lgkmcnt(4)
    v_mfma_f32_16x16x32_bf16 v[112:115], a[8:11], v[224:227], v[112:115]
    ds_read_b64_tr_b16 a[24:25], v5 offset:16384
    s_add_u32 s70, s47, 114688
    v_mfma_f32_16x16x32_bf16 v[116:119], a[8:11], v[228:231], v[116:119]
    ds_read_b64_tr_b16 a[26:27], v5 offset:24576
    v_mfma_f32_16x16x32_bf16 v[124:127], a[12:15], v[228:231], v[124:127]
    ds_read_b64_tr_b16 a[28:29], v6 offset:16384
    v_mfma_f32_16x16x32_bf16 v[120:123], a[12:15], v[224:227], v[120:123]
    ds_read_b64_tr_b16 a[30:31], v6 offset:24576
    s_waitcnt lgkmcnt(4)
    v_mfma_f32_16x16x32_bf16 v[136:139], a[16:19], v[224:227], v[136:139]
    ds_read_b64_tr_b16 a[0:1], v7 offset:16384
    s_add_u32 m0, s32, 32768
    v_mfma_f32_16x16x32_bf16 v[140:143], a[16:19], v[228:231], v[140:143]
    ds_read_b64_tr_b16 a[2:3], v7 offset:24576
    v_mfma_f32_16x16x32_bf16 v[156:159], a[20:23], v[228:231], v[156:159]
    ds_read_b64_tr_b16 a[4:5], v8 offset:16384
    v_mfma_f32_16x16x32_bf16 v[152:155], a[20:23], v[224:227], v[152:155]
    ds_read_b64_tr_b16 a[6:7], v8 offset:24576
    s_waitcnt lgkmcnt(4)
    v_mfma_f32_16x16x32_bf16 v[32:35], a[24:27], v[240:243], v[32:35]
    ds_read_b64_tr_b16 a[8:9], v9 offset:16384
    v_mfma_f32_16x16x32_bf16 v[36:39], a[24:27], v[244:247], v[36:39]
    ds_read_b64_tr_b16 a[10:11], v9 offset:24576
    buffer_load_dwordx4 v21, s[12:15], s70 offen offset:0 sc1 lds
    v_mfma_f32_16x16x32_bf16 v[44:47], a[28:31], v[244:247], v[44:47]
    ds_read_b64_tr_b16 a[12:13], v10 offset:16384
    v_mfma_f32_16x16x32_bf16 v[40:43], a[28:31], v[240:243], v[40:43]
    ds_read_b64_tr_b16 a[14:15], v10 offset:24576
    s_waitcnt lgkmcnt(4)
    v_mfma_f32_16x16x32_bf16 v[48:51], a[0:3], v[240:243], v[48:51]
    ds_read_b64_tr_b16 a[16:17], v11 offset:16384
    v_mfma_f32_16x16x32_bf16 v[52:55], a[0:3], v[244:247], v[52:55]
    ds_read_b64_tr_b16 a[18:19], v11 offset:24576
    buffer_load_dwordx4 v22, s[12:15], s70 offen offset:1024 sc1 lds
    v_mfma_f32_16x16x32_bf16 v[60:63], a[4:7], v[244:247], v[60:63]
    ds_read_b64_tr_b16 a[20:21], v12 offset:16384
    v_mfma_f32_16x16x32_bf16 v[56:59], a[4:7], v[240:243], v[56:59]
    ds_read_b64_tr_b16 a[22:23], v12 offset:24576
    s_waitcnt lgkmcnt(4)
    v_mfma_f32_16x16x32_bf16 v[64:67], a[8:11], v[240:243], v[64:67]
    ds_read_b64_tr_b16 a[24:25], v5 offset:16640
    v_mfma_f32_16x16x32_bf16 v[68:71], a[8:11], v[244:247], v[68:71]
    ds_read_b64_tr_b16 a[26:27], v5 offset:24832
    v_mfma_f32_16x16x32_bf16 v[76:79], a[12:15], v[244:247], v[76:79]
    ds_read_b64_tr_b16 a[28:29], v6 offset:16640
    buffer_load_dwordx4 v23, s[12:15], s70 offen offset:2048 sc1 lds
    v_mfma_f32_16x16x32_bf16 v[72:75], a[12:15], v[240:243], v[72:75]
    ds_read_b64_tr_b16 a[30:31], v6 offset:24832
    s_waitcnt lgkmcnt(4)
    v_mfma_f32_16x16x32_bf16 v[80:83], a[16:19], v[240:243], v[80:83]
    ds_read_b64_tr_b16 a[0:1], v7 offset:16640
    v_mfma_f32_16x16x32_bf16 v[84:87], a[16:19], v[244:247], v[84:87]
    ds_read_b64_tr_b16 a[2:3], v7 offset:24832
    v_mfma_f32_16x16x32_bf16 v[92:95], a[20:23], v[244:247], v[92:95]
    ds_read_b64_tr_b16 a[4:5], v8 offset:16640
    buffer_load_dwordx4 v24, s[12:15], s70 offen offset:3072 sc1 lds
    v_mfma_f32_16x16x32_bf16 v[88:91], a[20:23], v[240:243], v[88:91]
    ds_read_b64_tr_b16 a[6:7], v8 offset:24832
    s_waitcnt lgkmcnt(4)
    v_mfma_f32_16x16x32_bf16 v[96:99], a[24:27], v[240:243], v[96:99]
    ds_read_b64_tr_b16 a[8:9], v9 offset:16640
    v_mfma_f32_16x16x32_bf16 v[100:103], a[24:27], v[244:247], v[100:103]
    ds_read_b64_tr_b16 a[10:11], v9 offset:24832
    v_mfma_f32_16x16x32_bf16 v[108:111], a[28:31], v[244:247], v[108:111]
    ds_read_b64_tr_b16 a[12:13], v10 offset:16640
    v_mfma_f32_16x16x32_bf16 v[104:107], a[28:31], v[240:243], v[104:107]
    ds_read_b64_tr_b16 a[14:15], v10 offset:24832
    s_waitcnt vmcnt(20)
    s_barrier
    s_waitcnt lgkmcnt(4)
    v_mfma_f32_16x16x32_bf16 v[112:115], a[0:3], v[240:243], v[112:115]
    ds_read_b64_tr_b16 a[16:17], v5 offset:32768
    v_mfma_f32_16x16x32_bf16 v[116:119], a[0:3], v[244:247], v[116:119]
    ds_read_b64_tr_b16 a[18:19], v5 offset:40960
    s_add_u32 s70, s47, 143360
    v_mfma_f32_16x16x32_bf16 v[124:127], a[4:7], v[244:247], v[124:127]
    ds_read_b64_tr_b16 a[20:21], v6 offset:32768
    v_mfma_f32_16x16x32_bf16 v[120:123], a[4:7], v[240:243], v[120:123]
    ds_read_b64_tr_b16 a[22:23], v6 offset:40960
    s_waitcnt lgkmcnt(4)
    v_mfma_f32_16x16x32_bf16 v[136:139], a[8:11], v[240:243], v[136:139]
    ds_read_b64_tr_b16 a[24:25], v7 offset:32768
    v_mfma_f32_16x16x32_bf16 v[140:143], a[8:11], v[244:247], v[140:143]
    ds_read_b64_tr_b16 a[26:27], v7 offset:40960
    s_add_u32 m0, s32, 49152
    v_mfma_f32_16x16x32_bf16 v[156:159], a[12:15], v[244:247], v[156:159]
    ds_read_b64_tr_b16 a[28:29], v8 offset:32768
    v_mfma_f32_16x16x32_bf16 v[152:155], a[12:15], v[240:243], v[152:155]
    ds_read_b64_tr_b16 a[30:31], v8 offset:40960
    s_waitcnt lgkmcnt(4)
    v_mfma_f32_16x16x32_bf16 v[32:35], a[16:19], a[64:67], v[32:35]
    ds_read_b64_tr_b16 a[0:1], v9 offset:32768
    v_mfma_f32_16x16x32_bf16 v[36:39], a[16:19], a[68:71], v[36:39]
    ds_read_b64_tr_b16 a[2:3], v9 offset:40960
    v_mfma_f32_16x16x32_bf16 v[44:47], a[20:23], a[68:71], v[44:47]
    ds_read_b64_tr_b16 a[4:5], v10 offset:32768
    buffer_load_dwordx4 v21, s[12:15], s70 offen offset:0 sc1 lds
    v_mfma_f32_16x16x32_bf16 v[40:43], a[20:23], a[64:67], v[40:43]
    ds_read_b64_tr_b16 a[6:7], v10 offset:40960
    s_waitcnt lgkmcnt(4)
    v_mfma_f32_16x16x32_bf16 v[48:51], a[24:27], a[64:67], v[48:51]
    ds_read_b64_tr_b16 a[8:9], v11 offset:32768
    v_mfma_f32_16x16x32_bf16 v[52:55], a[24:27], a[68:71], v[52:55]
    ds_read_b64_tr_b16 a[10:11], v11 offset:40960
    v_mfma_f32_16x16x32_bf16 v[60:63], a[28:31], a[68:71], v[60:63]
    ds_read_b64_tr_b16 a[12:13], v12 offset:32768
    buffer_load_dwordx4 v22, s[12:15], s70 offen offset:1024 sc1 lds
    v_mfma_f32_16x16x32_bf16 v[56:59], a[28:31], a[64:67], v[56:59]
    ds_read_b64_tr_b16 a[14:15], v12 offset:40960
    s_waitcnt lgkmcnt(4)
    v_mfma_f32_16x16x32_bf16 v[64:67], a[0:3], a[64:67], v[64:67]
    ds_read_b64_tr_b16 a[16:17], v5 offset:33024
    v_mfma_f32_16x16x32_bf16 v[68:71], a[0:3], a[68:71], v[68:71]
    ds_read_b64_tr_b16 a[18:19], v5 offset:41216
    v_mfma_f32_16x16x32_bf16 v[76:79], a[4:7], a[68:71], v[76:79]
    ds_read_b64_tr_b16 a[20:21], v6 offset:33024
    v_mfma_f32_16x16x32_bf16 v[72:75], a[4:7], a[64:67], v[72:75]
    ds_read_b64_tr_b16 a[22:23], v6 offset:41216
    s_waitcnt lgkmcnt(4)
    v_mfma_f32_16x16x32_bf16 v[80:83], a[8:11], a[64:67], v[80:83]
    ds_read_b64_tr_b16 a[24:25], v7 offset:33024
    buffer_load_dwordx4 v23, s[12:15], s70 offen offset:2048 sc1 lds
    v_mfma_f32_16x16x32_bf16 v[84:87], a[8:11], a[68:71], v[84:87]
    ds_read_b64_tr_b16 a[26:27], v7 offset:41216
    v_mfma_f32_16x16x32_bf16 v[92:95], a[12:15], a[68:71], v[92:95]
    ds_read_b64_tr_b16 a[28:29], v8 offset:33024
    v_mfma_f32_16x16x32_bf16 v[88:91], a[12:15], a[64:67], v[88:91]
    ds_read_b64_tr_b16 a[30:31], v8 offset:41216
    s_waitcnt lgkmcnt(4)
    v_mfma_f32_16x16x32_bf16 v[96:99], a[16:19], a[64:67], v[96:99]
    ds_read_b64_tr_b16 a[0:1], v9 offset:33024
    buffer_load_dwordx4 v24, s[12:15], s70 offen offset:3072 sc1 lds
    v_mfma_f32_16x16x32_bf16 v[100:103], a[16:19], a[68:71], v[100:103]
    ds_read_b64_tr_b16 a[2:3], v9 offset:41216
    v_mfma_f32_16x16x32_bf16 v[108:111], a[20:23], a[68:71], v[108:111]
    ds_read_b64_tr_b16 a[4:5], v10 offset:33024
    v_mfma_f32_16x16x32_bf16 v[104:107], a[20:23], a[64:67], v[104:107]
    ds_read_b64_tr_b16 a[6:7], v10 offset:41216
    s_waitcnt lgkmcnt(4)
    v_mfma_f32_16x16x32_bf16 v[112:115], a[24:27], a[64:67], v[112:115]
    ds_read_b64_tr_b16 a[8:9], v5 offset:49152
    s_add_u32 s70, s47, 172032
    v_mfma_f32_16x16x32_bf16 v[116:119], a[24:27], a[68:71], v[116:119]
    ds_read_b64_tr_b16 a[10:11], v5 offset:57344
    v_mfma_f32_16x16x32_bf16 v[124:127], a[28:31], a[68:71], v[124:127]
    ds_read_b64_tr_b16 a[12:13], v6 offset:49152
    v_mfma_f32_16x16x32_bf16 v[120:123], a[28:31], a[64:67], v[120:123]
    ds_read_b64_tr_b16 a[14:15], v6 offset:57344
    s_waitcnt lgkmcnt(4)
    v_mfma_f32_16x16x32_bf16 v[136:139], a[0:3], a[64:67], v[136:139]
    ds_read_b64_tr_b16 a[16:17], v7 offset:49152
    s_add_u32 m0, s32, 65536
    v_mfma_f32_16x16x32_bf16 v[140:143], a[0:3], a[68:71], v[140:143]
    ds_read_b64_tr_b16 a[18:19], v7 offset:57344
    v_mfma_f32_16x16x32_bf16 v[156:159], a[4:7], a[68:71], v[156:159]
    ds_read_b64_tr_b16 a[20:21], v8 offset:49152
    v_mfma_f32_16x16x32_bf16 v[152:155], a[4:7], a[64:67], v[152:155]
    ds_read_b64_tr_b16 a[22:23], v8 offset:57344
    s_waitcnt lgkmcnt(4)
    v_mfma_f32_16x16x32_bf16 v[32:35], a[8:11], a[72:75], v[32:35]
    ds_read_b64_tr_b16 a[24:25], v9 offset:49152
    v_mfma_f32_16x16x32_bf16 v[36:39], a[8:11], a[76:79], v[36:39]
    ds_read_b64_tr_b16 a[26:27], v9 offset:57344
    buffer_load_dwordx4 v21, s[12:15], s70 offen offset:0 sc1 lds
    v_mfma_f32_16x16x32_bf16 v[44:47], a[12:15], a[76:79], v[44:47]
    ds_read_b64_tr_b16 a[28:29], v10 offset:49152
    v_mfma_f32_16x16x32_bf16 v[40:43], a[12:15], a[72:75], v[40:43]
    ds_read_b64_tr_b16 a[30:31], v10 offset:57344
    s_waitcnt lgkmcnt(4)
    v_mfma_f32_16x16x32_bf16 v[48:51], a[16:19], a[72:75], v[48:51]
    ds_read_b64_tr_b16 a[0:1], v11 offset:49152
    v_mfma_f32_16x16x32_bf16 v[52:55], a[16:19], a[76:79], v[52:55]
    ds_read_b64_tr_b16 a[2:3], v11 offset:57344
    buffer_load_dwordx4 v22, s[12:15], s70 offen offset:1024 sc1 lds
    v_mfma_f32_16x16x32_bf16 v[60:63], a[20:23], a[76:79], v[60:63]
    ds_read_b64_tr_b16 a[4:5], v12 offset:49152
    v_mfma_f32_16x16x32_bf16 v[56:59], a[20:23], a[72:75], v[56:59]
    ds_read_b64_tr_b16 a[6:7], v12 offset:57344
    s_waitcnt lgkmcnt(4)
    v_mfma_f32_16x16x32_bf16 v[64:67], a[24:27], a[72:75], v[64:67]
    ds_read_b64_tr_b16 a[8:9], v5 offset:49408
    v_mfma_f32_16x16x32_bf16 v[68:71], a[24:27], a[76:79], v[68:71]
    ds_read_b64_tr_b16 a[10:11], v5 offset:57600
    v_mfma_f32_16x16x32_bf16 v[76:79], a[28:31], a[76:79], v[76:79]
    ds_read_b64_tr_b16 a[12:13], v6 offset:49408
    buffer_load_dwordx4 v23, s[12:15], s70 offen offset:2048 sc1 lds
    v_mfma_f32_16x16x32_bf16 v[72:75], a[28:31], a[72:75], v[72:75]
    ds_read_b64_tr_b16 a[14:15], v6 offset:57600
    s_waitcnt lgkmcnt(4)
    v_mfma_f32_16x16x32_bf16 v[80:83], a[0:3], a[72:75], v[80:83]
    ds_read_b64_tr_b16 a[16:17], v7 offset:49408
    v_mfma_f32_16x16x32_bf16 v[84:87], a[0:3], a[76:79], v[84:87]
    ds_read_b64_tr_b16 a[18:19], v7 offset:57600
    v_mfma_f32_16x16x32_bf16 v[92:95], a[4:7], a[76:79], v[92:95]
    ds_read_b64_tr_b16 a[20:21], v8 offset:49408
    buffer_load_dwordx4 v24, s[12:15], s70 offen offset:3072 sc1 lds
    v_mfma_f32_16x16x32_bf16 v[88:91], a[4:7], a[72:75], v[88:91]
    ds_read_b64_tr_b16 a[22:23], v8 offset:57600
    s_waitcnt lgkmcnt(4)
    v_mfma_f32_16x16x32_bf16 v[96:99], a[8:11], a[72:75], v[96:99]
    ds_read_b64_tr_b16 a[24:25], v9 offset:49408
    v_mfma_f32_16x16x32_bf16 v[100:103], a[8:11], a[76:79], v[100:103]
    ds_read_b64_tr_b16 a[26:27], v9 offset:57600
    v_mfma_f32_16x16x32_bf16 v[108:111], a[12:15], a[76:79], v[108:111]
    ds_read_b64_tr_b16 a[28:29], v10 offset:49408
    v_mfma_f32_16x16x32_bf16 v[104:107], a[12:15], a[72:75], v[104:107]
    ds_read_b64_tr_b16 a[30:31], v10 offset:57600
    s_waitcnt vmcnt(12)
    s_barrier
    s_waitcnt lgkmcnt(4)
    v_mfma_f32_16x16x32_bf16 v[112:115], a[16:19], a[72:75], v[112:115]
    ds_read_b64_tr_b16 a[0:1], v17 offset:0
    v_mfma_f32_16x16x32_bf16 v[116:119], a[16:19], a[76:79], v[116:119]
    ds_read_b64_tr_b16 a[2:3], v17 offset:8192
    s_add_u32 s70, s47, 200704
    v_mfma_f32_16x16x32_bf16 v[124:127], a[20:23], a[76:79], v[124:127]
    ds_read_b64_tr_b16 a[4:5], v18 offset:0
    v_mfma_f32_16x16x32_bf16 v[120:123], a[20:23], a[72:75], v[120:123]
    ds_read_b64_tr_b16 a[6:7], v18 offset:8192
    s_waitcnt lgkmcnt(4)
    v_mfma_f32_16x16x32_bf16 v[136:139], a[24:27], a[72:75], v[136:139]
    ds_read_b64_tr_b16 a[8:9], v19 offset:0
    v_mfma_f32_16x16x32_bf16 v[140:143], a[24:27], a[76:79], v[140:143]
    ds_read_b64_tr_b16 a[10:11], v19 offset:8192
    v_mfma_f32_16x16x32_bf16 v[156:159], a[28:31], a[76:79], v[156:159]
    ds_read_b64_tr_b16 a[12:13], v20 offset:0
    s_add_u32 m0, s32, 81920
    v_mfma_f32_16x16x32_bf16 v[152:155], a[28:31], a[72:75], v[152:155]
    ds_read_b64_tr_b16 a[14:15], v20 offset:8192
    s_waitcnt lgkmcnt(4)
    v_mfma_f32_16x16x32_bf16 v[32:35], a[0:3], a[80:83], v[32:35]
    ds_read_b64_tr_b16 a[16:17], v26 offset:0
    v_mfma_f32_16x16x32_bf16 v[36:39], a[0:3], a[84:87], v[36:39]
    ds_read_b64_tr_b16 a[18:19], v26 offset:8192
    v_mfma_f32_16x16x32_bf16 v[44:47], a[4:7], a[84:87], v[44:47]
    ds_read_b64_tr_b16 a[20:21], v27 offset:0
    v_mfma_f32_16x16x32_bf16 v[40:43], a[4:7], a[80:83], v[40:43]
    ds_read_b64_tr_b16 a[22:23], v27 offset:8192
    s_waitcnt lgkmcnt(4)
    v_mfma_f32_16x16x32_bf16 v[48:51], a[8:11], a[80:83], v[48:51]
    ds_read_b64_tr_b16 a[24:25], v28 offset:0
    buffer_load_dwordx4 v21, s[12:15], s70 offen offset:0 sc1 lds
    v_mfma_f32_16x16x32_bf16 v[52:55], a[8:11], a[84:87], v[52:55]
    ds_read_b64_tr_b16 a[26:27], v28 offset:8192
    v_mfma_f32_16x16x32_bf16 v[60:63], a[12:15], a[84:87], v[60:63]
    ds_read_b64_tr_b16 a[28:29], v29 offset:0
    v_mfma_f32_16x16x32_bf16 v[56:59], a[12:15], a[80:83], v[56:59]
    ds_read_b64_tr_b16 a[30:31], v29 offset:8192
    s_waitcnt lgkmcnt(4)
    v_mfma_f32_16x16x32_bf16 v[64:67], a[16:19], a[80:83], v[64:67]
    ds_read_b64_tr_b16 a[0:1], v17 offset:256
    v_mfma_f32_16x16x32_bf16 v[68:71], a[16:19], a[84:87], v[68:71]
    ds_read_b64_tr_b16 a[2:3], v17 offset:8448
    buffer_load_dwordx4 v22, s[12:15], s70 offen offset:1024 sc1 lds
    v_mfma_f32_16x16x32_bf16 v[76:79], a[20:23], a[84:87], v[76:79]
    ds_read_b64_tr_b16 a[4:5], v18 offset:256
    v_mfma_f32_16x16x32_bf16 v[72:75], a[20:23], a[80:83], v[72:75]
    ds_read_b64_tr_b16 a[6:7], v18 offset:8448
    s_waitcnt lgkmcnt(4)
    v_mfma_f32_16x16x32_bf16 v[80:83], a[24:27], a[80:83], v[80:83]
    ds_read_b64_tr_b16 a[8:9], v19 offset:256
    v_mfma_f32_16x16x32_bf16 v[84:87], a[24:27], a[84:87], v[84:87]
    ds_read_b64_tr_b16 a[10:11], v19 offset:8448
    v_mfma_f32_16x16x32_bf16 v[92:95], a[28:31], a[84:87], v[92:95]
    ds_read_b64_tr_b16 a[12:13], v20 offset:256
    buffer_load_dwordx4 v23, s[12:15], s70 offen offset:2048 sc1 lds
    v_mfma_f32_16x16x32_bf16 v[88:91], a[28:31], a[80:83], v[88:91]
    ds_read_b64_tr_b16 a[14:15], v20 offset:8448
    s_waitcnt lgkmcnt(4)
    v_mfma_f32_16x16x32_bf16 v[96:99], a[0:3], a[80:83], v[96:99]
    ds_read_b64_tr_b16 a[16:17], v26 offset:256
    v_mfma_f32_16x16x32_bf16 v[100:103], a[0:3], a[84:87], v[100:103]
    ds_read_b64_tr_b16 a[18:19], v26 offset:8448
    v_mfma_f32_16x16x32_bf16 v[108:111], a[4:7], a[84:87], v[108:111]
    ds_read_b64_tr_b16 a[20:21], v27 offset:256
    v_mfma_f32_16x16x32_bf16 v[104:107], a[4:7], a[80:83], v[104:107]
    ds_read_b64_tr_b16 a[22:23], v27 offset:8448
    s_waitcnt lgkmcnt(4)
    v_mfma_f32_16x16x32_bf16 v[112:115], a[8:11], a[80:83], v[112:115]
    ds_read_b64_tr_b16 a[24:25], v17 offset:16384
    buffer_load_dwordx4 v24, s[12:15], s70 offen offset:3072 sc1 lds
    v_mfma_f32_16x16x32_bf16 v[116:119], a[8:11], a[84:87], v[116:119]
    ds_read_b64_tr_b16 a[26:27], v17 offset:24576
    v_mfma_f32_16x16x32_bf16 v[124:127], a[12:15], a[84:87], v[124:127]
    ds_read_b64_tr_b16 a[28:29], v18 offset:16384
    v_mfma_f32_16x16x32_bf16 v[120:123], a[12:15], a[80:83], v[120:123]
    ds_read_b64_tr_b16 a[30:31], v18 offset:24576
    s_waitcnt lgkmcnt(4)
    v_mfma_f32_16x16x32_bf16 v[136:139], a[16:19], a[80:83], v[136:139]
    ds_read_b64_tr_b16 a[0:1], v19 offset:16384
    v_mfma_f32_16x16x32_bf16 v[140:143], a[16:19], a[84:87], v[140:143]
    ds_read_b64_tr_b16 a[2:3], v19 offset:24576
    s_add_u32 s72, s37, 0
    v_mfma_f32_16x16x32_bf16 v[156:159], a[20:23], a[84:87], v[156:159]
    ds_read_b64_tr_b16 a[4:5], v20 offset:16384
    v_mfma_f32_16x16x32_bf16 v[152:155], a[20:23], a[80:83], v[152:155]
    ds_read_b64_tr_b16 a[6:7], v20 offset:24576
    s_waitcnt lgkmcnt(4)
    v_mfma_f32_16x16x32_bf16 v[32:35], a[24:27], a[88:91], v[32:35]
    ds_read_b64_tr_b16 a[8:9], v26 offset:16384
    v_mfma_f32_16x16x32_bf16 v[36:39], a[24:27], a[92:95], v[36:39]
    ds_read_b64_tr_b16 a[10:11], v26 offset:24576
    v_mfma_f32_16x16x32_bf16 v[44:47], a[28:31], a[92:95], v[44:47]
    ds_read_b64_tr_b16 a[12:13], v27 offset:16384
    s_add_u32 s73, s37, 4096
    v_mfma_f32_16x16x32_bf16 v[40:43], a[28:31], a[88:91], v[40:43]
    ds_read_b64_tr_b16 a[14:15], v27 offset:24576
    s_waitcnt lgkmcnt(4)
    v_mfma_f32_16x16x32_bf16 v[48:51], a[0:3], a[88:91], v[48:51]
    ds_read_b64_tr_b16 a[16:17], v28 offset:16384
    v_mfma_f32_16x16x32_bf16 v[52:55], a[0:3], a[92:95], v[52:55]
    ds_read_b64_tr_b16 a[18:19], v28 offset:24576
    v_mfma_f32_16x16x32_bf16 v[60:63], a[4:7], a[92:95], v[60:63]
    ds_read_b64_tr_b16 a[20:21], v29 offset:16384
    v_mfma_f32_16x16x32_bf16 v[56:59], a[4:7], a[88:91], v[56:59]
    ds_read_b64_tr_b16 a[22:23], v29 offset:24576
    s_waitcnt lgkmcnt(4)
    v_mfma_f32_16x16x32_bf16 v[64:67], a[8:11], a[88:91], v[64:67]
    ds_read_b64_tr_b16 a[24:25], v17 offset:16640
    s_add_u32 s74, s37, 57344
    v_mfma_f32_16x16x32_bf16 v[68:71], a[8:11], a[92:95], v[68:71]
    ds_read_b64_tr_b16 a[26:27], v17 offset:24832
    v_mfma_f32_16x16x32_bf16 v[76:79], a[12:15], a[92:95], v[76:79]
    ds_read_b64_tr_b16 a[28:29], v18 offset:16640
    v_mfma_f32_16x16x32_bf16 v[72:75], a[12:15], a[88:91], v[72:75]
    ds_read_b64_tr_b16 a[30:31], v18 offset:24832
    s_waitcnt lgkmcnt(4)
    v_mfma_f32_16x16x32_bf16 v[80:83], a[16:19], a[88:91], v[80:83]
    ds_read_b64_tr_b16 a[0:1], v19 offset:16640
    v_mfma_f32_16x16x32_bf16 v[84:87], a[16:19], a[92:95], v[84:87]
    ds_read_b64_tr_b16 a[2:3], v19 offset:24832
    s_add_u32 s75, s37, 61440
    v_mfma_f32_16x16x32_bf16 v[92:95], a[20:23], a[92:95], v[92:95]
    ds_read_b64_tr_b16 a[4:5], v20 offset:16640
    v_mfma_f32_16x16x32_bf16 v[88:91], a[20:23], a[88:91], v[88:91]
    ds_read_b64_tr_b16 a[6:7], v20 offset:24832
    s_waitcnt lgkmcnt(4)
    v_mfma_f32_16x16x32_bf16 v[96:99], a[24:27], a[88:91], v[96:99]
    ds_read_b64_tr_b16 a[8:9], v26 offset:16640
    v_mfma_f32_16x16x32_bf16 v[100:103], a[24:27], a[92:95], v[100:103]
    ds_read_b64_tr_b16 a[10:11], v26 offset:24832
    v_mfma_f32_16x16x32_bf16 v[108:111], a[28:31], a[92:95], v[108:111]
    ds_read_b64_tr_b16 a[12:13], v27 offset:16640
    v_mfma_f32_16x16x32_bf16 v[104:107], a[28:31], a[88:91], v[104:107]
    ds_read_b64_tr_b16 a[14:15], v27 offset:24832
    s_waitcnt vmcnt(8)
    s_barrier
    s_waitcnt lgkmcnt(4)
    v_mfma_f32_16x16x32_bf16 v[112:115], a[0:3], a[88:91], v[112:115]
    ds_read_b64_tr_b16 a[16:17], v17 offset:32768
    v_mfma_f32_16x16x32_bf16 v[116:119], a[0:3], a[92:95], v[116:119]
    ds_read_b64_tr_b16 a[18:19], v17 offset:40960
    v_mfma_f32_16x16x32_bf16 v[124:127], a[4:7], a[92:95], v[124:127]
    ds_read_b64_tr_b16 a[20:21], v18 offset:32768
    v_mfma_f32_16x16x32_bf16 v[120:123], a[4:7], a[88:91], v[120:123]
    ds_read_b64_tr_b16 a[22:23], v18 offset:40960
    s_waitcnt lgkmcnt(4)
    v_mfma_f32_16x16x32_bf16 v[136:139], a[8:11], a[88:91], v[136:139]
    ds_read_b64_tr_b16 a[24:25], v19 offset:32768
    v_mfma_f32_16x16x32_bf16 v[140:143], a[8:11], a[92:95], v[140:143]
    ds_read_b64_tr_b16 a[26:27], v19 offset:40960
    v_mfma_f32_16x16x32_bf16 v[156:159], a[12:15], a[92:95], v[156:159]
    ds_read_b64_tr_b16 a[28:29], v20 offset:32768
    v_mfma_f32_16x16x32_bf16 v[152:155], a[12:15], a[88:91], v[152:155]
    ds_read_b64_tr_b16 a[30:31], v20 offset:40960
    s_waitcnt lgkmcnt(4)
    v_mfma_f32_16x16x32_bf16 v[32:35], a[16:19], a[96:99], v[32:35]
    ds_read_b64_tr_b16 a[0:1], v26 offset:32768
    v_mfma_f32_16x16x32_bf16 v[36:39], a[16:19], a[100:103], v[36:39]
    ds_read_b64_tr_b16 a[2:3], v26 offset:40960
    v_mfma_f32_16x16x32_bf16 v[44:47], a[20:23], a[100:103], v[44:47]
    ds_read_b64_tr_b16 a[4:5], v27 offset:32768
    v_mfma_f32_16x16x32_bf16 v[40:43], a[20:23], a[96:99], v[40:43]
    ds_read_b64_tr_b16 a[6:7], v27 offset:40960
    s_waitcnt lgkmcnt(4)
    v_mfma_f32_16x16x32_bf16 v[48:51], a[24:27], a[96:99], v[48:51]
    ds_read_b64_tr_b16 a[8:9], v28 offset:32768
    v_mfma_f32_16x16x32_bf16 v[52:55], a[24:27], a[100:103], v[52:55]
    ds_read_b64_tr_b16 a[10:11], v28 offset:40960
    v_mfma_f32_16x16x32_bf16 v[60:63], a[28:31], a[100:103], v[60:63]
    ds_read_b64_tr_b16 a[12:13], v29 offset:32768
    v_mfma_f32_16x16x32_bf16 v[56:59], a[28:31], a[96:99], v[56:59]
    ds_read_b64_tr_b16 a[14:15], v29 offset:40960
    s_waitcnt lgkmcnt(4)
    v_mfma_f32_16x16x32_bf16 v[64:67], a[0:3], a[96:99], v[64:67]
    ds_read_b64_tr_b16 a[16:17], v17 offset:33024
    v_mfma_f32_16x16x32_bf16 v[68:71], a[0:3], a[100:103], v[68:71]
    ds_read_b64_tr_b16 a[18:19], v17 offset:41216
    v_mfma_f32_16x16x32_bf16 v[76:79], a[4:7], a[100:103], v[76:79]
    ds_read_b64_tr_b16 a[20:21], v18 offset:33024
    v_mfma_f32_16x16x32_bf16 v[72:75], a[4:7], a[96:99], v[72:75]
    ds_read_b64_tr_b16 a[22:23], v18 offset:41216
    s_waitcnt lgkmcnt(4)
    v_mfma_f32_16x16x32_bf16 v[80:83], a[8:11], a[96:99], v[80:83]
    ds_read_b64_tr_b16 a[24:25], v19 offset:33024
    v_mfma_f32_16x16x32_bf16 v[84:87], a[8:11], a[100:103], v[84:87]
    ds_read_b64_tr_b16 a[26:27], v19 offset:41216
    v_mfma_f32_16x16x32_bf16 v[92:95], a[12:15], a[100:103], v[92:95]
    ds_read_b64_tr_b16 a[28:29], v20 offset:33024
    v_mfma_f32_16x16x32_bf16 v[88:91], a[12:15], a[96:99], v[88:91]
    ds_read_b64_tr_b16 a[30:31], v20 offset:41216
    s_waitcnt lgkmcnt(4)
    v_mfma_f32_16x16x32_bf16 v[96:99], a[16:19], a[96:99], v[96:99]
    ds_read_b64_tr_b16 a[0:1], v26 offset:33024
    v_mfma_f32_16x16x32_bf16 v[100:103], a[16:19], a[100:103], v[100:103]
    ds_read_b64_tr_b16 a[2:3], v26 offset:41216
    v_mfma_f32_16x16x32_bf16 v[108:111], a[20:23], a[100:103], v[108:111]
    ds_read_b64_tr_b16 a[4:5], v27 offset:33024
    v_mfma_f32_16x16x32_bf16 v[104:107], a[20:23], a[96:99], v[104:107]
    ds_read_b64_tr_b16 a[6:7], v27 offset:41216
    s_waitcnt lgkmcnt(4)
    v_mfma_f32_16x16x32_bf16 v[112:115], a[24:27], a[96:99], v[112:115]
    ds_read_b64_tr_b16 a[8:9], v17 offset:49152
    v_mfma_f32_16x16x32_bf16 v[116:119], a[24:27], a[100:103], v[116:119]
    ds_read_b64_tr_b16 a[10:11], v17 offset:57344
    v_mfma_f32_16x16x32_bf16 v[124:127], a[28:31], a[100:103], v[124:127]
    ds_read_b64_tr_b16 a[12:13], v18 offset:49152
    v_mfma_f32_16x16x32_bf16 v[120:123], a[28:31], a[96:99], v[120:123]
    ds_read_b64_tr_b16 a[14:15], v18 offset:57344
    s_waitcnt lgkmcnt(4)
    v_mfma_f32_16x16x32_bf16 v[136:139], a[0:3], a[96:99], v[136:139]
    ds_read_b64_tr_b16 a[16:17], v19 offset:49152
    v_mfma_f32_16x16x32_bf16 v[140:143], a[0:3], a[100:103], v[140:143]
    ds_read_b64_tr_b16 a[18:19], v19 offset:57344
    v_mfma_f32_16x16x32_bf16 v[156:159], a[4:7], a[100:103], v[156:159]
    ds_read_b64_tr_b16 a[20:21], v20 offset:49152
    v_mfma_f32_16x16x32_bf16 v[152:155], a[4:7], a[96:99], v[152:155]
    ds_read_b64_tr_b16 a[22:23], v20 offset:57344
    s_waitcnt lgkmcnt(4)
    v_mfma_f32_16x16x32_bf16 v[32:35], a[8:11], a[104:107], v[32:35]
    ds_read_b64_tr_b16 a[24:25], v26 offset:49152
    v_mfma_f32_16x16x32_bf16 v[36:39], a[8:11], a[108:111], v[36:39]
    ds_read_b64_tr_b16 a[26:27], v26 offset:57344
    v_mfma_f32_16x16x32_bf16 v[44:47], a[12:15], a[108:111], v[44:47]
    ds_read_b64_tr_b16 a[28:29], v27 offset:49152
    v_mfma_f32_16x16x32_bf16 v[40:43], a[12:15], a[104:107], v[40:43]
    ds_read_b64_tr_b16 a[30:31], v27 offset:57344
    s_waitcnt lgkmcnt(4)
    v_mfma_f32_16x16x32_bf16 v[48:51], a[16:19], a[104:107], v[48:51]
    ds_read_b64_tr_b16 a[0:1], v28 offset:49152
    v_mfma_f32_16x16x32_bf16 v[52:55], a[16:19], a[108:111], v[52:55]
    ds_read_b64_tr_b16 a[2:3], v28 offset:57344
    v_mfma_f32_16x16x32_bf16 v[60:63], a[20:23], a[108:111], v[60:63]
    ds_read_b64_tr_b16 a[4:5], v29 offset:49152
    v_mfma_f32_16x16x32_bf16 v[56:59], a[20:23], a[104:107], v[56:59]
    ds_read_b64_tr_b16 a[6:7], v29 offset:57344
    s_waitcnt lgkmcnt(4)
    v_mfma_f32_16x16x32_bf16 v[64:67], a[24:27], a[104:107], v[64:67]
    ds_read_b64_tr_b16 a[8:9], v17 offset:49408
    v_mfma_f32_16x16x32_bf16 v[68:71], a[24:27], a[108:111], v[68:71]
    ds_read_b64_tr_b16 a[10:11], v17 offset:57600
    v_mfma_f32_16x16x32_bf16 v[76:79], a[28:31], a[108:111], v[76:79]
    ds_read_b64_tr_b16 a[12:13], v18 offset:49408
    v_mfma_f32_16x16x32_bf16 v[72:75], a[28:31], a[104:107], v[72:75]
    ds_read_b64_tr_b16 a[14:15], v18 offset:57600
    s_waitcnt lgkmcnt(4)
    v_mfma_f32_16x16x32_bf16 v[80:83], a[0:3], a[104:107], v[80:83]
    ds_read_b64_tr_b16 a[16:17], v19 offset:49408
    v_mfma_f32_16x16x32_bf16 v[84:87], a[0:3], a[108:111], v[84:87]
    ds_read_b64_tr_b16 a[18:19], v19 offset:57600
    v_mfma_f32_16x16x32_bf16 v[92:95], a[4:7], a[108:111], v[92:95]
    ds_read_b64_tr_b16 a[20:21], v20 offset:49408
    v_mfma_f32_16x16x32_bf16 v[88:91], a[4:7], a[104:107], v[88:91]
    ds_read_b64_tr_b16 a[22:23], v20 offset:57600
    s_waitcnt lgkmcnt(4)
    v_mfma_f32_16x16x32_bf16 v[96:99], a[8:11], a[104:107], v[96:99]
    ds_read_b64_tr_b16 a[24:25], v26 offset:49408
    v_mfma_f32_16x16x32_bf16 v[100:103], a[8:11], a[108:111], v[100:103]
    ds_read_b64_tr_b16 a[26:27], v26 offset:57600
    v_mfma_f32_16x16x32_bf16 v[108:111], a[12:15], a[108:111], v[108:111]
    ds_read_b64_tr_b16 a[28:29], v27 offset:49408
    v_mfma_f32_16x16x32_bf16 v[104:107], a[12:15], a[104:107], v[104:107]
    ds_read_b64_tr_b16 a[30:31], v27 offset:57600
    s_waitcnt vmcnt(0)
    s_barrier
    s_waitcnt lgkmcnt(4)
    v_mfma_f32_16x16x32_bf16 v[112:115], a[16:19], a[104:107], v[112:115]
    ds_read_b64_tr_b16 a[0:1], v5 offset:0
    v_mfma_f32_16x16x32_bf16 v[116:119], a[16:19], a[108:111], v[116:119]
    ds_read_b64_tr_b16 a[2:3], v5 offset:8192
    v_mfma_f32_16x16x32_bf16 v[124:127], a[20:23], a[108:111], v[124:127]
    ds_read_b64_tr_b16 a[4:5], v6 offset:0
    v_mfma_f32_16x16x32_bf16 v[120:123], a[20:23], a[104:107], v[120:123]
    ds_read_b64_tr_b16 a[6:7], v6 offset:8192
    s_waitcnt lgkmcnt(4)
    v_mfma_f32_16x16x32_bf16 v[136:139], a[24:27], a[104:107], v[136:139]
    ds_read_b64_tr_b16 a[8:9], v7 offset:0
    v_mfma_f32_16x16x32_bf16 v[140:143], a[24:27], a[108:111], v[140:143]
    ds_read_b64_tr_b16 a[10:11], v7 offset:8192
    v_mfma_f32_16x16x32_bf16 v[156:159], a[28:31], a[108:111], v[156:159]
    ds_read_b64_tr_b16 a[12:13], v8 offset:0
    v_mfma_f32_16x16x32_bf16 v[152:155], a[28:31], a[104:107], v[152:155]
    ds_read_b64_tr_b16 a[14:15], v8 offset:8192
    s_waitcnt lgkmcnt(4)
    v_mfma_f32_16x16x32_bf16 v[32:35], a[0:3], a[112:115], v[32:35]
    ds_read_b64_tr_b16 a[16:17], v9 offset:0
    v_mfma_f32_16x16x32_bf16 v[36:39], a[0:3], a[116:119], v[36:39]
    ds_read_b64_tr_b16 a[18:19], v9 offset:8192
    v_mfma_f32_16x16x32_bf16 v[44:47], a[4:7], a[116:119], v[44:47]
    ds_read_b64_tr_b16 a[20:21], v10 offset:0
    v_mfma_f32_16x16x32_bf16 v[40:43], a[4:7], a[112:115], v[40:43]
    ds_read_b64_tr_b16 a[22:23], v10 offset:8192
    s_waitcnt lgkmcnt(4)
    v_mfma_f32_16x16x32_bf16 v[48:51], a[8:11], a[112:115], v[48:51]
    ds_read_b64_tr_b16 a[24:25], v11 offset:0
    v_mfma_f32_16x16x32_bf16 v[52:55], a[8:11], a[116:119], v[52:55]
    ds_read_b64_tr_b16 a[26:27], v11 offset:8192
    v_mfma_f32_16x16x32_bf16 v[60:63], a[12:15], a[116:119], v[60:63]
    ds_read_b64_tr_b16 a[28:29], v12 offset:0
    v_mfma_f32_16x16x32_bf16 v[56:59], a[12:15], a[112:115], v[56:59]
    ds_read_b64_tr_b16 a[30:31], v12 offset:8192
    s_waitcnt lgkmcnt(4)
    v_mfma_f32_16x16x32_bf16 v[64:67], a[16:19], a[112:115], v[64:67]
    ds_read_b64_tr_b16 a[0:1], v5 offset:256
    v_mfma_f32_16x16x32_bf16 v[68:71], a[16:19], a[116:119], v[68:71]
    ds_read_b64_tr_b16 a[2:3], v5 offset:8448
    v_mfma_f32_16x16x32_bf16 v[76:79], a[20:23], a[116:119], v[76:79]
    ds_read_b64_tr_b16 a[4:5], v6 offset:256
    v_mfma_f32_16x16x32_bf16 v[72:75], a[20:23], a[112:115], v[72:75]
    ds_read_b64_tr_b16 a[6:7], v6 offset:8448
    s_waitcnt lgkmcnt(4)
    v_mfma_f32_16x16x32_bf16 v[80:83], a[24:27], a[112:115], v[80:83]
    ds_read_b64_tr_b16 a[8:9], v7 offset:256
    v_mfma_f32_16x16x32_bf16 v[84:87], a[24:27], a[116:119], v[84:87]
    ds_read_b64_tr_b16 a[10:11], v7 offset:8448
    v_mfma_f32_16x16x32_bf16 v[92:95], a[28:31], a[116:119], v[92:95]
    ds_read_b64_tr_b16 a[12:13], v8 offset:256
    v_mfma_f32_16x16x32_bf16 v[88:91], a[28:31], a[112:115], v[88:91]
    ds_read_b64_tr_b16 a[14:15], v8 offset:8448
    s_waitcnt lgkmcnt(4)
    v_mfma_f32_16x16x32_bf16 v[96:99], a[0:3], a[112:115], v[96:99]
    ds_read_b64_tr_b16 a[16:17], v9 offset:256
    v_mfma_f32_16x16x32_bf16 v[100:103], a[0:3], a[116:119], v[100:103]
    ds_read_b64_tr_b16 a[18:19], v9 offset:8448
    v_mfma_f32_16x16x32_bf16 v[108:111], a[4:7], a[116:119], v[108:111]
    ds_read_b64_tr_b16 a[20:21], v10 offset:256
    v_mfma_f32_16x16x32_bf16 v[104:107], a[4:7], a[112:115], v[104:107]
    ds_read_b64_tr_b16 a[22:23], v10 offset:8448
    s_waitcnt lgkmcnt(4)
    v_mfma_f32_16x16x32_bf16 v[112:115], a[8:11], a[112:115], v[112:115]
    ds_read_b64_tr_b16 a[24:25], v5 offset:16384
    v_mfma_f32_16x16x32_bf16 v[116:119], a[8:11], a[116:119], v[116:119]
    ds_read_b64_tr_b16 a[26:27], v5 offset:24576
    v_mfma_f32_16x16x32_bf16 v[124:127], a[12:15], a[116:119], v[124:127]
    ds_read_b64_tr_b16 a[28:29], v6 offset:16384
    v_mfma_f32_16x16x32_bf16 v[120:123], a[12:15], a[112:115], v[120:123]
    ds_read_b64_tr_b16 a[30:31], v6 offset:24576
    s_waitcnt lgkmcnt(4)
    v_mfma_f32_16x16x32_bf16 v[136:139], a[16:19], a[112:115], v[136:139]
    ds_read_b64_tr_b16 a[0:1], v7 offset:16384
    v_mfma_f32_16x16x32_bf16 v[140:143], a[16:19], a[116:119], v[140:143]
    ds_read_b64_tr_b16 a[2:3], v7 offset:24576
    v_mfma_f32_16x16x32_bf16 v[156:159], a[20:23], a[116:119], v[156:159]
    ds_read_b64_tr_b16 a[4:5], v8 offset:16384
    v_mfma_f32_16x16x32_bf16 v[152:155], a[20:23], a[112:115], v[152:155]
    ds_read_b64_tr_b16 a[6:7], v8 offset:24576
    s_waitcnt lgkmcnt(4)
    v_mfma_f32_16x16x32_bf16 v[32:35], a[24:27], a[120:123], v[32:35]
    ds_read_b64_tr_b16 a[8:9], v9 offset:16384
    v_mfma_f32_16x16x32_bf16 v[36:39], a[24:27], a[124:127], v[36:39]
    ds_read_b64_tr_b16 a[10:11], v9 offset:24576
    v_mfma_f32_16x16x32_bf16 v[44:47], a[28:31], a[124:127], v[44:47]
    ds_read_b64_tr_b16 a[12:13], v10 offset:16384
    v_mfma_f32_16x16x32_bf16 v[40:43], a[28:31], a[120:123], v[40:43]
    ds_read_b64_tr_b16 a[14:15], v10 offset:24576
    s_waitcnt lgkmcnt(4)
    v_mfma_f32_16x16x32_bf16 v[48:51], a[0:3], a[120:123], v[48:51]
    ds_read_b64_tr_b16 a[16:17], v11 offset:16384
    v_mfma_f32_16x16x32_bf16 v[52:55], a[0:3], a[124:127], v[52:55]
    ds_read_b64_tr_b16 a[18:19], v11 offset:24576
    v_mfma_f32_16x16x32_bf16 v[60:63], a[4:7], a[124:127], v[60:63]
    ds_read_b64_tr_b16 a[20:21], v12 offset:16384
    v_mfma_f32_16x16x32_bf16 v[56:59], a[4:7], a[120:123], v[56:59]
    ds_read_b64_tr_b16 a[22:23], v12 offset:24576
    s_waitcnt lgkmcnt(4)
    v_mfma_f32_16x16x32_bf16 v[64:67], a[8:11], a[120:123], v[64:67]
    ds_read_b64_tr_b16 a[24:25], v5 offset:16640
    v_mfma_f32_16x16x32_bf16 v[68:71], a[8:11], a[124:127], v[68:71]
    ds_read_b64_tr_b16 a[26:27], v5 offset:24832
    v_mfma_f32_16x16x32_bf16 v[76:79], a[12:15], a[124:127], v[76:79]
    ds_read_b64_tr_b16 a[28:29], v6 offset:16640
    v_mfma_f32_16x16x32_bf16 v[72:75], a[12:15], a[120:123], v[72:75]
    ds_read_b64_tr_b16 a[30:31], v6 offset:24832
    s_waitcnt lgkmcnt(4)
    v_mfma_f32_16x16x32_bf16 v[80:83], a[16:19], a[120:123], v[80:83]
    ds_read_b64_tr_b16 a[0:1], v7 offset:16640
    v_mfma_f32_16x16x32_bf16 v[84:87], a[16:19], a[124:127], v[84:87]
    ds_read_b64_tr_b16 a[2:3], v7 offset:24832
    v_mfma_f32_16x16x32_bf16 v[92:95], a[20:23], a[124:127], v[92:95]
    ds_read_b64_tr_b16 a[4:5], v8 offset:16640
    v_mfma_f32_16x16x32_bf16 v[88:91], a[20:23], a[120:123], v[88:91]
    ds_read_b64_tr_b16 a[6:7], v8 offset:24832
    s_waitcnt lgkmcnt(4)
    v_mfma_f32_16x16x32_bf16 v[96:99], a[24:27], a[120:123], v[96:99]
    ds_read_b64_tr_b16 a[8:9], v9 offset:16640
    v_mfma_f32_16x16x32_bf16 v[100:103], a[24:27], a[124:127], v[100:103]
    ds_read_b64_tr_b16 a[10:11], v9 offset:24832
    v_mfma_f32_16x16x32_bf16 v[108:111], a[28:31], a[124:127], v[108:111]
    ds_read_b64_tr_b16 a[12:13], v10 offset:16640
    v_mfma_f32_16x16x32_bf16 v[104:107], a[28:31], a[120:123], v[104:107]
    ds_read_b64_tr_b16 a[14:15], v10 offset:24832
    s_waitcnt lgkmcnt(4)
    v_mfma_f32_16x16x32_bf16 v[112:115], a[0:3], a[120:123], v[112:115]
    v_mfma_f32_16x16x32_bf16 v[116:119], a[0:3], a[124:127], v[116:119]
    v_mfma_f32_16x16x32_bf16 v[124:127], a[4:7], a[124:127], v[124:127]
    v_mfma_f32_16x16x32_bf16 v[120:123], a[4:7], a[120:123], v[120:123]
    s_waitcnt lgkmcnt(0)
    v_mfma_f32_16x16x32_bf16 v[136:139], a[8:11], a[120:123], v[136:139]
    v_mfma_f32_16x16x32_bf16 v[140:143], a[8:11], a[124:127], v[140:143]
    v_mfma_f32_16x16x32_bf16 v[156:159], a[12:15], a[124:127], v[156:159]
    v_mfma_f32_16x16x32_bf16 v[152:155], a[12:15], a[120:123], v[152:155]
ou_sum:
    v_cvt_pk_bf16_f32 v32, v32, v33
    v_cvt_pk_bf16_f32 v33, v34, v35
    v_cvt_pk_bf16_f32 v34, v40, v41
    v_cvt_pk_bf16_f32 v35, v42, v43
    buffer_store_dwordx4 v[32:35], v25, s[4:7], s72 offen offset:0 sc1
    v_cvt_pk_bf16_f32 v36, v36, v37
    v_cvt_pk_bf16_f32 v37, v38, v39
    v_cvt_pk_bf16_f32 v38, v44, v45
    v_cvt_pk_bf16_f32 v39, v46, v47
    buffer_store_dwordx4 v[36:39], v25, s[4:7], s74 offen offset:0 sc1
    v_cvt_pk_bf16_f32 v48, v48, v49
    v_cvt_pk_bf16_f32 v49, v50, v51
    v_cvt_pk_bf16_f32 v50, v56, v57
    v_cvt_pk_bf16_f32 v51, v58, v59
    buffer_store_dwordx4 v[48:51], v25, s[4:7], s72 offen offset:1024 sc1
    v_cvt_pk_bf16_f32 v52, v52, v53
    v_cvt_pk_bf16_f32 v53, v54, v55
    v_cvt_pk_bf16_f32 v54, v60, v61
    v_cvt_pk_bf16_f32 v55, v62, v63
    buffer_store_dwordx4 v[52:55], v25, s[4:7], s74 offen offset:1024 sc1
    v_cvt_pk_bf16_f32 v64, v64, v65
    v_cvt_pk_bf16_f32 v65, v66, v67
    v_cvt_pk_bf16_f32 v66, v72, v73
    v_cvt_pk_bf16_f32 v67, v74, v75
    buffer_store_dwordx4 v[64:67], v25, s[4:7], s72 offen offset:2048 sc1
    v_cvt_pk_bf16_f32 v68, v68, v69
    v_cvt_pk_bf16_f32 v69, v70, v71
    v_cvt_pk_bf16_f32 v70, v76, v77
    v_cvt_pk_bf16_f32 v71, v78, v79
    buffer_store_dwordx4 v[68:71], v25, s[4:7], s74 offen offset:2048 sc1
    v_cvt_pk_bf16_f32 v80, v80, v81
    v_cvt_pk_bf16_f32 v81, v82, v83
    v_cvt_pk_bf16_f32 v82, v88, v89
    v_cvt_pk_bf16_f32 v83, v90, v91
    buffer_store_dwordx4 v[80:83], v25, s[4:7], s72 offen offset:3072 sc1
    v_cvt_pk_bf16_f32 v84, v84, v85
    v_cvt_pk_bf16_f32 v85, v86, v87
    v_cvt_pk_bf16_f32 v86, v92, v93
    v_cvt_pk_bf16_f32 v87, v94, v95
    buffer_store_dwordx4 v[84:87], v25, s[4:7], s74 offen offset:3072 sc1
    v_cvt_pk_bf16_f32 v96, v96, v97
    v_cvt_pk_bf16_f32 v97, v98, v99
    v_cvt_pk_bf16_f32 v98, v104, v105
    v_cvt_pk_bf16_f32 v99, v106, v107
    buffer_store_dwordx4 v[96:99], v25, s[4:7], s73 offen offset:0 sc1
    v_cvt_pk_bf16_f32 v100, v100, v101
    v_cvt_pk_bf16_f32 v101, v102, v103
    v_cvt_pk_bf16_f32 v102, v108, v109
    v_cvt_pk_bf16_f32 v103, v110, v111
    buffer_store_dwordx4 v[100:103], v25, s[4:7], s75 offen offset:0 sc1
    v_cvt_pk_bf16_f32 v112, v112, v113
    v_cvt_pk_bf16_f32 v113, v114, v115
    v_cvt_pk_bf16_f32 v114, v120, v121
    v_cvt_pk_bf16_f32 v115, v122, v123
    buffer_store_dwordx4 v[112:115], v25, s[4:7], s73 offen offset:1024 sc1
    v_cvt_pk_bf16_f32 v116, v116, v117
    v_cvt_pk_bf16_f32 v117, v118, v119
    v_cvt_pk_bf16_f32 v118, v124, v125
    v_cvt_pk_bf16_f32 v119, v126, v127
    buffer_store_dwordx4 v[116:119], v25, s[4:7], s75 offen offset:1024 sc1
    v_cvt_pk_bf16_f32 v136, v136, v137
    v_cvt_pk_bf16_f32 v137, v138, v139
    v_cvt_pk_bf16_f32 v138, v152, v153
    v_cvt_pk_bf16_f32 v139, v154, v155
    buffer_store_dwordx4 v[136:139], v25, s[4:7], s73 offen offset:2048 sc1
    v_cvt_pk_bf16_f32 v140, v140, v141
    v_cvt_pk_bf16_f32 v141, v142, v143
    v_cvt_pk_bf16_f32 v142, v156, v157
    v_cvt_pk_bf16_f32 v143, v158, v159
    buffer_store_dwordx4 v[140:143], v25, s[4:7], s75 offen offset:2048 sc1
    s_mov_b32 s12, s54
    s_mov_b32 s13, s55
    s_mov_b32 s14, 1835008
    s_mov_b32 s15, 0x20000
    v_and_b32 v2, 15, v1
    v_mul_u32_u24 v2, 896, v2
    v_bfe_u32 v3, v1, 4, 1
    v_lshl_add_u32 v2, v3, 5, v2
    v_lshrrev_b32 v3, 5, v1
    v_lshl_add_u32 v13, v3, 4, v2
    s_add_u32 s73, s40, 64
    s_cmp_eq_u32 s20, 3
    s_cselect_b32 s73, 1073741824, s73
    s_cselect_b32 s3, 1073741824, 0
    v_add_u32 v5, s3, v25
    v_and_b32 v4, 7, v1
    v_lshlrev_b32 v4, 2, v4
    buffer_load_dword v16, v4, s[4:7], s39 offen sc1
    s_lshr_b32 s3, s21, 1
    s_lshl_b32 s74, 1, s3
    s_lshl_b32 s3, s3, 2
    s_add_u32 s3, s3, s39
    v_mov_b32 v2, 1
    s_mov_b32 s75, 0
    s_mov_b32 s98, 0
    s_waitcnt vmcnt(0)
    s_barrier
    s_cmp_eq_u32 s20, 0
    s_cbranch_scc0 ou_xw
    s_mov_b64 exec, 1
    buffer_store_dword v2, off, s[4:7], s3 sc1
    s_mov_b64 exec, -1
ou_xw:
ou_xl:
    v_cmp_ne_u32 vcc, 0, v16
    s_nop 0
    s_or_b32 s72, vcc_lo, s74
    s_and_b32 s72, s72, 0xff
    s_andn2_b32 s72, s72, s75
    s_bitcmp1_b32 s72, 0
    s_cbranch_scc0 ou_xs0
    s_add_u32 s3, s38, 0
    buffer_load_dwordx4 v[64:67], v25, s[4:7], s3 offen offset:0 sc1
    buffer_load_dwordx4 v[68:71], v5, s[4:7], s3 offen offset:1024 sc1
ou_xs0:
    s_bitcmp1_b32 s72, 1
    s_cbranch_scc0 ou_xs1
    s_add_u32 s3, s38, 7168
    buffer_load_dwordx4 v[72:75], v25, s[4:7], s3 offen offset:0 sc1
    buffer_load_dwordx4 v[76:79], v5, s[4:7], s3 offen offset:1024 sc1
ou_xs1:
    s_bitcmp1_b32 s72, 2
    s_cbranch_scc0 ou_xs2
    s_add_u32 s3, s38, 14336
    buffer_load_dwordx4 v[80:83], v25, s[4:7], s3 offen offset:0 sc1
    buffer_load_dwordx4 v[84:87], v5, s[4:7], s3 offen offset:1024 sc1
ou_xs2:
    s_bitcmp1_b32 s72, 3
    s_cbranch_scc0 ou_xs3
    s_add_u32 s3, s38, 21504
    buffer_load_dwordx4 v[88:91], v25, s[4:7], s3 offen offset:0 sc1
    buffer_load_dwordx4 v[92:95], v5, s[4:7], s3 offen offset:1024 sc1
ou_xs3:
    s_bitcmp1_b32 s72, 4
    s_cbranch_scc0 ou_xs4
    s_add_u32 s3, s38, 28672
    buffer_load_dwordx4 v[96:99], v25, s[4:7], s3 offen offset:0 sc1
    buffer_load_dwordx4 v[100:103], v5, s[4:7], s3 offen offset:1024 sc1
ou_xs4:
    s_bitcmp1_b32 s72, 5
    s_cbranch_scc0 ou_xs5
    s_add_u32 s3, s38, 35840
    buffer_load_dwordx4 v[104:107], v25, s[4:7], s3 offen offset:0 sc1
    buffer_load_dwordx4 v[108:111], v5, s[4:7], s3 offen offset:1024 sc1
ou_xs5:
    s_bitcmp1_b32 s72, 6
    s_cbranch_scc0 ou_xs6
    s_add_u32 s3, s38, 43008
    buffer_load_dwordx4 v[112:115], v25, s[4:7], s3 offen offset:0 sc1
    buffer_load_dwordx4 v[116:119], v5, s[4:7], s3 offen offset:1024 sc1
ou_xs6:
    s_bitcmp1_b32 s72, 7
    s_cbranch_scc0 ou_xs7
    s_add_u32 s3, s38, 50176
    buffer_load_dwordx4 v[120:123], v25, s[4:7], s3 offen offset:0 sc1
    buffer_load_dwordx4 v[124:127], v5, s[4:7], s3 offen offset:1024 sc1
ou_xs7:
    s_or_b32 s75, s75, s72
    s_cmp_eq_u32 s75, 0xff
    s_cbranch_scc1 ou_xd
    s_add_u32 s98, s98, 1
    s_cmp_gt_u32 s98, 0x80000
    s_cbranch_scc1 ou_xd
    s_sleep 2
    buffer_load_dword v16, v4, s[4:7], s39 offen sc1
    s_waitcnt vmcnt(0)
    s_branch ou_xl
ou_xd:
    s_waitcnt vmcnt(0)
    v_and_b32 v33, 0xffff0000, v64
    v_lshlrev_b32 v32, 16, v64
    v_and_b32 v35, 0xffff0000, v65
    v_lshlrev_b32 v34, 16, v65
    v_and_b32 v37, 0xffff0000, v66
    v_lshlrev_b32 v36, 16, v66
    v_and_b32 v39, 0xffff0000, v67
    v_lshlrev_b32 v38, 16, v67
    v_and_b32 v41, 0xffff0000, v68
    v_lshlrev_b32 v40, 16, v68
    v_and_b32 v43, 0xffff0000, v69
    v_lshlrev_b32 v42, 16, v69
    v_and_b32 v45, 0xffff0000, v70
    v_lshlrev_b32 v44, 16, v70
    v_and_b32 v47, 0xffff0000, v71
    v_lshlrev_b32 v46, 16, v71
    v_and_b32 v49, 0xffff0000, v72
    v_lshlrev_b32 v48, 16, v72
    v_pk_add_f32 v[32:33], v[32:33], v[48:49]
    v_and_b32 v51, 0xffff0000, v73
    v_lshlrev_b32 v50, 16, v73
    v_pk_add_f32 v[34:35], v[34:35], v[50:51]
    v_and_b32 v53, 0xffff0000, v74
    v_lshlrev_b32 v52, 16, v74
    v_pk_add_f32 v[36:37], v[36:37], v[52:53]
    v_and_b32 v55, 0xffff0000, v75
    v_lshlrev_b32 v54, 16, v75
    v_pk_add_f32 v[38:39], v[38:39], v[54:55]
    v_and_b32 v49, 0xffff0000, v76
    v_lshlrev_b32 v48, 16, v76
    v_pk_add_f32 v[40:41], v[40:41], v[48:49]
    v_and_b32 v51, 0xffff0000, v77
    v_lshlrev_b32 v50, 16, v77
    v_pk_add_f32 v[42:43], v[42:43], v[50:51]
    v_and_b32 v53, 0xffff0000, v78
    v_lshlrev_b32 v52, 16, v78
    v_pk_add_f32 v[44:45], v[44:45], v[52:53]
    v_and_b32 v55, 0xffff0000, v79
    v_lshlrev_b32 v54, 16, v79
    v_pk_add_f32 v[46:47], v[46:47], v[54:55]
    v_and_b32 v49, 0xffff0000, v80
    v_lshlrev_b32 v48, 16, v80
    v_pk_add_f32 v[32:33], v[32:33], v[48:49]
    v_and_b32 v51, 0xffff0000, v81
    v_lshlrev_b32 v50, 16, v81
    v_pk_add_f32 v[34:35], v[34:35], v[50:51]
    v_and_b32 v53, 0xffff0000, v82
    v_lshlrev_b32 v52, 16, v82
    v_pk_add_f32 v[36:37], v[36:37], v[52:53]
    v_and_b32 v55, 0xffff0000, v83
    v_lshlrev_b32 v54, 16, v83
    v_pk_add_f32 v[38:39], v[38:39], v[54:55]
    v_and_b32 v49, 0xffff0000, v84
    v_lshlrev_b32 v48, 16, v84
    v_pk_add_f32 v[40:41], v[40:41], v[48:49]
    v_and_b32 v51, 0xffff0000, v85
    v_lshlrev_b32 v50, 16, v85
    v_pk_add_f32 v[42:43], v[42:43], v[50:51]
    v_and_b32 v53, 0xffff0000, v86
    v_lshlrev_b32 v52, 16, v86
    v_pk_add_f32 v[44:45], v[44:45], v[52:53]
    v_and_b32 v55, 0xffff0000, v87
    v_lshlrev_b32 v54, 16, v87
    v_pk_add_f32 v[46:47], v[46:47], v[54:55]
    v_and_b32 v49, 0xffff0000, v88
    v_lshlrev_b32 v48, 16, v88
    v_pk_add_f32 v[32:33], v[32:33], v[48:49]
    v_and_b32 v51, 0xffff0000, v89
    v_lshlrev_b32 v50, 16, v89
    v_pk_add_f32 v[34:35], v[34:35], v[50:51]
    v_and_b32 v53, 0xffff0000, v90
    v_lshlrev_b32 v52, 16, v90
    v_pk_add_f32 v[36:37], v[36:37], v[52:53]
    v_and_b32 v55, 0xffff0000, v91
    v_lshlrev_b32 v54, 16, v91
    v_pk_add_f32 v[38:39], v[38:39], v[54:55]
    v_and_b32 v49, 0xffff0000, v92
    v_lshlrev_b32 v48, 16, v92
    v_pk_add_f32 v[40:41], v[40:41], v[48:49]
    v_and_b32 v51, 0xffff0000, v93
    v_lshlrev_b32 v50, 16, v93
    v_pk_add_f32 v[42:43], v[42:43], v[50:51]
    v_and_b32 v53, 0xffff0000, v94
    v_lshlrev_b32 v52, 16, v94
    v_pk_add_f32 v[44:45], v[44:45], v[52:53]
    v_and_b32 v55, 0xffff0000, v95
    v_lshlrev_b32 v54, 16, v95
    v_pk_add_f32 v[46:47], v[46:47], v[54:55]
    v_and_b32 v49, 0xffff0000, v96
    v_lshlrev_b32 v48, 16, v96
    v_pk_add_f32 v[32:33], v[32:33], v[48:49]
    v_and_b32 v51, 0xffff0000, v97
    v_lshlrev_b32 v50, 16, v97
    v_pk_add_f32 v[34:35], v[34:35], v[50:51]
    v_and_b32 v53, 0xffff0000, v98
    v_lshlrev_b32 v52, 16, v98
    v_pk_add_f32 v[36:37], v[36:37], v[52:53]
    v_and_b32 v55, 0xffff0000, v99
    v_lshlrev_b32 v54, 16, v99
    v_pk_add_f32 v[38:39], v[38:39], v[54:55]
    v_and_b32 v49, 0xffff0000, v100
    v_lshlrev_b32 v48, 16, v100
    v_pk_add_f32 v[40:41], v[40:41], v[48:49]
    v_and_b32 v51, 0xffff0000, v101
    v_lshlrev_b32 v50, 16, v101
    v_pk_add_f32 v[42:43], v[42:43], v[50:51]
    v_and_b32 v53, 0xffff0000, v102
    v_lshlrev_b32 v52, 16, v102
    v_pk_add_f32 v[44:45], v[44:45], v[52:53]
    v_and_b32 v55, 0xffff0000, v103
    v_lshlrev_b32 v54, 16, v103
    v_pk_add_f32 v[46:47], v[46:47], v[54:55]
    v_and_b32 v49, 0xffff0000, v104
    v_lshlrev_b32 v48, 16, v104
    v_pk_add_f32 v[32:33], v[32:33], v[48:49]
    v_and_b32 v51, 0xffff0000, v105
    v_lshlrev_b32 v50, 16, v105
    v_pk_add_f32 v[34:35], v[34:35], v[50:51]
    v_and_b32 v53, 0xffff0000, v106
    v_lshlrev_b32 v52, 16, v106
    v_pk_add_f32 v[36:37], v[36:37], v[52:53]
    v_and_b32 v55, 0xffff0000, v107
    v_lshlrev_b32 v54, 16, v107
    v_pk_add_f32 v[38:39], v[38:39], v[54:55]
    v_and_b32 v49, 0xffff0000, v108
    v_lshlrev_b32 v48, 16, v108
    v_pk_add_f32 v[40:41], v[40:41], v[48:49]
    v_and_b32 v51, 0xffff0000, v109
    v_lshlrev_b32 v50, 16, v109
    v_pk_add_f32 v[42:43], v[42:43], v[50:51]
    v_and_b32 v53, 0xffff0000, v110
    v_lshlrev_b32 v52, 16, v110
    v_pk_add_f32 v[44:45], v[44:45], v[52:53]
    v_and_b32 v55, 0xffff0000, v111
    v_lshlrev_b32 v54, 16, v111
    v_pk_add_f32 v[46:47], v[46:47], v[54:55]
    v_and_b32 v49, 0xffff0000, v112
    v_lshlrev_b32 v48, 16, v112
    v_pk_add_f32 v[32:33], v[32:33], v[48:49]
    v_and_b32 v51, 0xffff0000, v113
    v_lshlrev_b32 v50, 16, v113
    v_pk_add_f32 v[34:35], v[34:35], v[50:51]
    v_and_b32 v53, 0xffff0000, v114
    v_lshlrev_b32 v52, 16, v114
    v_pk_add_f32 v[36:37], v[36:37], v[52:53]
    v_and_b32 v55, 0xffff0000, v115
    v_lshlrev_b32 v54, 16, v115
    v_pk_add_f32 v[38:39], v[38:39], v[54:55]
    v_and_b32 v49, 0xffff0000, v116
    v_lshlrev_b32 v48, 16, v116
    v_pk_add_f32 v[40:41], v[40:41], v[48:49]
    v_and_b32 v51, 0xffff0000, v117
    v_lshlrev_b32 v50, 16, v117
    v_pk_add_f32 v[42:43], v[42:43], v[50:51]
    v_and_b32 v53, 0xffff0000, v118
    v_lshlrev_b32 v52, 16, v118
    v_pk_add_f32 v[44:45], v[44:45], v[52:53]
    v_and_b32 v55, 0xffff0000, v119
    v_lshlrev_b32 v54, 16, v119
    v_pk_add_f32 v[46:47], v[46:47], v[54:55]
    v_and_b32 v49, 0xffff0000, v120
    v_lshlrev_b32 v48, 16, v120
    v_pk_add_f32 v[32:33], v[32:33], v[48:49]
    v_and_b32 v51, 0xffff0000, v121
    v_lshlrev_b32 v50, 16, v121
    v_pk_add_f32 v[34:35], v[34:35], v[50:51]
    v_and_b32 v53, 0xffff0000, v122
    v_lshlrev_b32 v52, 16, v122
    v_pk_add_f32 v[36:37], v[36:37], v[52:53]
    v_and_b32 v55, 0xffff0000, v123
    v_lshlrev_b32 v54, 16, v123
    v_pk_add_f32 v[38:39], v[38:39], v[54:55]
    v_and_b32 v49, 0xffff0000, v124
    v_lshlrev_b32 v48, 16, v124
    v_pk_add_f32 v[40:41], v[40:41], v[48:49]
    v_and_b32 v51, 0xffff0000, v125
    v_lshlrev_b32 v50, 16, v125
    v_pk_add_f32 v[42:43], v[42:43], v[50:51]
    v_and_b32 v53, 0xffff0000, v126
    v_lshlrev_b32 v52, 16, v126
    v_pk_add_f32 v[44:45], v[44:45], v[52:53]
    v_and_b32 v55, 0xffff0000, v127
    v_lshlrev_b32 v54, 16, v127
    v_pk_add_f32 v[46:47], v[46:47], v[54:55]
    v_cvt_pk_bf16_f32 v32, v32, v33
    v_cvt_pk_bf16_f32 v33, v34, v35
    v_cvt_pk_bf16_f32 v34, v36, v37
    v_cvt_pk_bf16_f32 v35, v38, v39
    s_nop 0
    v_permlane16_swap_b32 v32, v34
    v_permlane16_swap_b32 v33, v35
    buffer_store_dwordx4 v[32:35], v13, s[12:15], s40 offen
    v_cvt_pk_bf16_f32 v40, v40, v41
    v_cvt_pk_bf16_f32 v41, v42, v43
    v_cvt_pk_bf16_f32 v42, v44, v45
    v_cvt_pk_bf16_f32 v43, v46, v47
    s_nop 0
    v_permlane16_swap_b32 v40, v42
    v_permlane16_swap_b32 v41, v43
    buffer_store_dwordx4 v[40:43], v13, s[12:15], s73 offen
    s_endpgm
gated_mix__compressed_kv_cla__glu_gated_swiglu__prompt_kernel_last:
kernel_last:
.section .rodata,"a"
.p2align 6
.amdhsa_kernel gated_mix__compressed_kv_cla__glu_gated_swiglu__prompt_kernel
  .amdhsa_next_free_vgpr 512
  .amdhsa_next_free_sgpr 102
  .amdhsa_accum_offset 256
  .amdhsa_group_segment_fixed_size 0
  .amdhsa_kernarg_size 112
  .amdhsa_user_sgpr_count 2
  .amdhsa_user_sgpr_kernarg_segment_ptr 1
  .amdhsa_system_sgpr_workgroup_id_x 1
.end_amdhsa_kernel
```
